```python
import torch

def _softmax(x, axis=-1):
    return torch.softmax(x, dim=axis)
def _gelu(x):
    return torch.nn.functional.gelu(x, approximate="tanh")
def _silu(x):
    return torch.nn.functional.silu(x)
def _sigmoid(x):
    return torch.sigmoid(x)
def _layernorm(x, axis=-1, eps=1e-5):
    m = x.mean(dim=axis, keepdim=True)
    v = x.var(dim=axis, keepdim=True, unbiased=False)
    return (x - m) / torch.sqrt(v + eps)
def _scatter_add(tgt, idx, src, axis=0):
    return tgt.clone().index_add_(axis, idx, src)
def _segment_sum(src, seg, n):
    out = torch.zeros((n,) + src.shape[1:], dtype=src.dtype)
    return out.index_add_(0, seg, src)
def _pad(x, pw):
    flat = tuple(v for pair in reversed(pw) for v in pair)
    return torch.nn.functional.pad(x, flat)

kernel_name = 'interleave_layers__linear_kernel_hedgehog__glu_gated_geglu__prompt'

def setup_inputs():

    _w = (lambda a: (lambda t: t.to(torch.bfloat16) if t.is_floating_point() else t)(torch.as_tensor(a)))
    def _A_setup():
        B, S, D, H = 1, 2048, 640, 32
        Dh = D // H
        return {
            "x": _w((lambda *s: torch.randn(*s, dtype=torch.bfloat16) * 0.05)(B, S, D)),
            "wqkv": _w((lambda *s: torch.randn(*s, dtype=torch.bfloat16) * 0.4)(D, 3 * D)),
            "w_phi": _w((lambda *s: torch.randn(*s, dtype=torch.bfloat16) * 0.4)(H, Dh, Dh) * (Dh ** -0.5)),
            "wo": _w((lambda *s: torch.randn(*s, dtype=torch.bfloat16) * 0.05)(D, D)),
        }
    _A_in = _A_setup()

    def _B_setup():
        B, S, Dm, Df = 1, 2048, 640, 1728
        return {
            "x": _w((lambda *s: torch.randn(*s, dtype=torch.bfloat16) * 0.05)(B, S, Dm)),
            "w_gate": _w((lambda *s: torch.randn(*s, dtype=torch.bfloat16) * 1.6)(Dm, Df) * (Dm ** -0.5)),
            "w_up": _w((lambda *s: torch.randn(*s, dtype=torch.bfloat16) * 1.6)(Dm, Df) * (Dm ** -0.5)),
            "w_down": _w((lambda *s: torch.randn(*s, dtype=torch.bfloat16) * 1.6)(Df, Dm) * (Df ** -0.5)),
        }
    _B_in = _B_setup()

    return {
        "A_x": _A_in["x"],
        "A_wqkv": _A_in["wqkv"],
        "A_w_phi": _A_in["w_phi"],
        "A_wo": _A_in["wo"],
        "B_x": _B_in["x"],
        "B_w_gate": _B_in["w_gate"],
        "B_w_up": _B_in["w_up"],
        "B_w_down": _B_in["w_down"],
    }

def reference(A_x, A_wqkv, A_w_phi, A_wo, B_x, B_w_gate, B_w_up, B_w_down):
    def _A_ref(x, wqkv, w_phi, wo):
        B, S, D = x.shape
        H = 32; Dh = D // H
        qkv = (lambda x, *d: x.permute(*d))((x @ wqkv).reshape(B, S, 3, H, Dh), 2, 0, 3, 1, 4)
        q, k, v = qkv[0], qkv[1], qkv[2]
        pq = torch.einsum("bhsd,hdf->bhsf", q, w_phi)
        pk = torch.einsum("bhsd,hdf->bhsf", k, w_phi)
        phi_q = torch.concatenate([_softmax(pq, axis=-1), _softmax(-pq, axis=-1)], axis=-1)
        phi_k = torch.concatenate([_softmax(pk, axis=-1), _softmax(-pk, axis=-1)], axis=-1)
        kv = torch.einsum("bhsf,bhsd->bhfd", phi_k, v)
        z  = torch.einsum("bhsf->bhf", phi_k)
        num = torch.einsum("bhqf,bhfd->bhqd", phi_q, kv)
        den = torch.einsum("bhqf,bhf->bhq", phi_q, z)[..., None] + 1e-6
        o = num / den
        return (lambda x, *d: x.permute(*d))(o, 0, 2, 1, 3).reshape(B, S, D) @ wo

    def _B_ref(x, w_gate, w_up, w_down):
        g = torch.einsum("bsd,df->bsf", x, w_gate)
        u = torch.einsum("bsd,df->bsf", x, w_up)
        h = _gelu(g) * u
        return torch.einsum("bsf,fd->bsd", h, w_down)

    x = A_x
    x = x + _A_ref(_layernorm(x, axis=-1), A_wqkv, A_w_phi, A_wo)
    x = x + _B_ref(_layernorm(x, axis=-1), B_w_gate, B_w_up, B_w_down)
    x = x + _A_ref(_layernorm(x, axis=-1), A_wqkv, A_w_phi, A_wo)
    x = x + _B_ref(_layernorm(x, axis=-1), B_w_gate, B_w_up, B_w_down)
    return x
```

```asm
; @launch kernel=ln1_0_kernel grid=(512,1,1) block=(256,1,1) lds=0
; @launch kernel=qkv_0_kernel grid=(240,1,1) block=(256,1,1) lds=73728
; @launch kernel=kv_0_kernel grid=(256,1,1) block=(256,1,1) lds=43008
; @launch kernel=att_0_kernel grid=(256,1,1) block=(256,1,1) lds=5888
; @launch kernel=wo_0_kernel grid=(160,1,1) block=(256,1,1) lds=55296
; @launch kernel=ln2_0_kernel grid=(512,1,1) block=(256,1,1) lds=0
; @launch kernel=gu_0_kernel grid=(432,1,1) block=(256,1,1) lds=73728
; @launch kernel=down_0_kernel grid=(160,1,1) block=(256,1,1) lds=55296
; @launch kernel=ln1_1_kernel grid=(512,1,1) block=(256,1,1) lds=0
; @launch kernel=qkv_1_kernel grid=(240,1,1) block=(256,1,1) lds=73728
; @launch kernel=kv_1_kernel grid=(256,1,1) block=(256,1,1) lds=43008
; @launch kernel=att_1_kernel grid=(256,1,1) block=(256,1,1) lds=5888
; @launch kernel=wo_1_kernel grid=(160,1,1) block=(256,1,1) lds=55296
; @launch kernel=ln2_1_kernel grid=(512,1,1) block=(256,1,1) lds=0
; @launch kernel=gu_1_kernel grid=(432,1,1) block=(256,1,1) lds=73728
; @launch kernel=down_1_kernel grid=(160,1,1) block=(256,1,1) lds=55296
.amdgcn_target "amdgcn-amd-amdhsa--gfx950"
.text
.globl ln1_0_kernel
.p2align 8
.type ln1_0_kernel,@function
ln1_0_kernel:
    s_cmp_ge_u32 s2, 512
    s_cbranch_scc1 ln1_0_kernel_end
    s_load_dwordx16 s[16:31], s[0:1], 0
    s_load_dwordx4 s[32:35], s[0:1], 64
    s_load_dwordx2 s[36:37], s[0:1], 80
    s_waitcnt lgkmcnt(0)
    s_mov_b32 s40, s16
    s_mov_b32 s41, s17
    s_mov_b32 s42, 0x280000
    s_mov_b32 s43, 0x00020000
    s_mov_b32 s44, s36
    s_mov_b32 s45, s37
    s_mov_b32 s46, 0x280000
    s_mov_b32 s47, 0x00020000
    v_lshrrev_b32 v1, 6, v0
    v_and_b32 v2, 63, v0
    s_lshl_b32 s3, s2, 2
    v_add_u32 v1, s3, v1
    v_mul_u32_u24 v3, 1280, v1
    v_mul_u32_u24 v4, 20, v2
    v_add_u32 v3, v3, v4
    buffer_load_dwordx4 v[8:11], v3, s[40:43], 0 offen
    buffer_load_dword v12, v3, s[40:43], 0 offen offset:16
    s_waitcnt vmcnt(0)
    v_lshlrev_b32 v16, 16, v8
    v_and_b32 v17, 0xffff0000, v8
    v_lshlrev_b32 v18, 16, v9
    v_and_b32 v19, 0xffff0000, v9
    v_lshlrev_b32 v20, 16, v10
    v_and_b32 v21, 0xffff0000, v10
    v_lshlrev_b32 v22, 16, v11
    v_and_b32 v23, 0xffff0000, v11
    v_lshlrev_b32 v24, 16, v12
    v_and_b32 v25, 0xffff0000, v12
    v_add_f32 v30, v16, v17
    v_add_f32 v30, v30, v18
    v_add_f32 v30, v30, v19
    v_add_f32 v30, v30, v20
    v_add_f32 v30, v30, v21
    v_add_f32 v30, v30, v22
    v_add_f32 v30, v30, v23
    v_add_f32 v30, v30, v24
    v_add_f32 v30, v30, v25
    ds_swizzle_b32 v31, v30 offset:0x41f
    s_waitcnt lgkmcnt(0)
    v_add_f32 v30, v30, v31
    ds_swizzle_b32 v31, v30 offset:0x81f
    s_waitcnt lgkmcnt(0)
    v_add_f32 v30, v30, v31
    ds_swizzle_b32 v31, v30 offset:0x101f
    s_waitcnt lgkmcnt(0)
    v_add_f32 v30, v30, v31
    ds_swizzle_b32 v31, v30 offset:0x201f
    s_waitcnt lgkmcnt(0)
    v_add_f32 v30, v30, v31
    ds_swizzle_b32 v31, v30 offset:0x401f
    s_waitcnt lgkmcnt(0)
    v_add_f32 v30, v30, v31
    s_nop 1
    v_readlane_b32 s4, v30, 0
    v_readlane_b32 s5, v30, 32
    s_nop 1
    v_mov_b32 v30, s4
    v_add_f32 v30, s5, v30
    v_mul_f32 v30, 0x3acccccd, v30
    v_sub_f32 v16, v16, v30
    v_sub_f32 v17, v17, v30
    v_sub_f32 v18, v18, v30
    v_sub_f32 v19, v19, v30
    v_sub_f32 v20, v20, v30
    v_sub_f32 v21, v21, v30
    v_sub_f32 v22, v22, v30
    v_sub_f32 v23, v23, v30
    v_sub_f32 v24, v24, v30
    v_sub_f32 v25, v25, v30
    v_mul_f32 v32, v16, v16
    v_fmac_f32 v32, v17, v17
    v_fmac_f32 v32, v18, v18
    v_fmac_f32 v32, v19, v19
    v_fmac_f32 v32, v20, v20
    v_fmac_f32 v32, v21, v21
    v_fmac_f32 v32, v22, v22
    v_fmac_f32 v32, v23, v23
    v_fmac_f32 v32, v24, v24
    v_fmac_f32 v32, v25, v25
    ds_swizzle_b32 v31, v32 offset:0x41f
    s_waitcnt lgkmcnt(0)
    v_add_f32 v32, v32, v31
    ds_swizzle_b32 v31, v32 offset:0x81f
    s_waitcnt lgkmcnt(0)
    v_add_f32 v32, v32, v31
    ds_swizzle_b32 v31, v32 offset:0x101f
    s_waitcnt lgkmcnt(0)
    v_add_f32 v32, v32, v31
    ds_swizzle_b32 v31, v32 offset:0x201f
    s_waitcnt lgkmcnt(0)
    v_add_f32 v32, v32, v31
    ds_swizzle_b32 v31, v32 offset:0x401f
    s_waitcnt lgkmcnt(0)
    v_add_f32 v32, v32, v31
    s_nop 1
    v_readlane_b32 s4, v32, 0
    v_readlane_b32 s5, v32, 32
    s_nop 1
    v_mov_b32 v32, s4
    v_add_f32 v32, s5, v32
    v_mov_b32 v33, 0x3727c5ac
    v_fmac_f32 v33, 0x3acccccd, v32
    v_rsq_f32 v33, v33
    s_nop 0
    v_mul_f32 v16, v16, v33
    v_mul_f32 v17, v17, v33
    v_mul_f32 v18, v18, v33
    v_mul_f32 v19, v19, v33
    v_mul_f32 v20, v20, v33
    v_mul_f32 v21, v21, v33
    v_mul_f32 v22, v22, v33
    v_mul_f32 v23, v23, v33
    v_mul_f32 v24, v24, v33
    v_mul_f32 v25, v25, v33
    v_cvt_pk_bf16_f32 v8, v16, v17
    v_cvt_pk_bf16_f32 v9, v18, v19
    v_cvt_pk_bf16_f32 v10, v20, v21
    v_cvt_pk_bf16_f32 v11, v22, v23
    v_cvt_pk_bf16_f32 v12, v24, v25
    buffer_store_dwordx4 v[8:11], v3, s[44:47], 0 offen
    buffer_store_dword v12, v3, s[44:47], 0 offen offset:16
ln1_0_kernel_end:
    s_endpgm
.globl qkv_0_kernel
.p2align 8
.type qkv_0_kernel,@function
qkv_0_kernel:
    s_cmp_ge_u32 s2, 240
    s_cbranch_scc1 qkv_0_kernel_end
    s_load_dwordx16 s[16:31], s[0:1], 0
    s_load_dwordx4 s[32:35], s[0:1], 64
    s_load_dwordx2 s[36:37], s[0:1], 80
    s_waitcnt lgkmcnt(0)
    s_mov_b32 s40, s36
    s_mov_b32 s41, s37
    s_mov_b32 s42, 0x280000
    s_mov_b32 s43, 0x00020000
    s_mov_b32 s44, s18
    s_mov_b32 s45, s19
    s_mov_b32 s46, 0x258000
    s_mov_b32 s47, 0x00020000
    s_add_u32 s52, s36, 0x400000
    s_addc_u32 s53, s37, 0
    s_mov_b32 s54, 0x780000
    s_mov_b32 s55, 0x00020000
    s_and_b32 s4, s2, 15
    s_lshr_b32 s5, s2, 4
    v_lshrrev_b32 v1, 6, v0
    s_nop 0
    v_readfirstlane_b32 s6, v1
    v_and_b32 v2, 63, v0
    v_and_b32 v3, 15, v0
    v_bfe_u32 v4, v0, 4, 2
    v_lshrrev_b32 v5, 3, v0
    v_and_b32 v6, 7, v0
    s_mul_i32 s7, s4, 163840
    v_mul_u32_u24 v7, 1280, v5
    v_lshl_add_u32 v7, v6, 4, v7
    v_add_u32 v7, s7, v7
    v_mul_u32_u24 v8, 144, v5
    v_lshl_add_u32 v8, v6, 4, v8
    v_and_b32 v9, 127, v0
    v_lshrrev_b32 v9, 3, v9
    s_lshr_b32 s8, s6, 1
    v_mul_u32_u24 v10, 3840, v9
    v_lshl_add_u32 v10, v6, 4, v10
    s_lshl_b32 s9, s5, 8
    s_lshl_b32 s10, s8, 7
    s_add_u32 s9, s9, s10
    s_mov_b32 s60, s44
    s_mov_b32 s61, s45
    s_mov_b32 s62, s46
    s_mov_b32 s63, s47
    v_add_u32 v10, s9, v10
    v_mul_u32_u24 v11, 288, v9
    v_lshl_add_u32 v11, v6, 4, v11
    s_lshl_b32 s10, s8, 7
    v_add_u32 v11, s10, v11
    v_add_u32 v11, 18432, v11
    s_mov_b32 s64, 0
    s_mov_b32 s65, 40960
    s_mov_b32 s66, 81920
    s_mov_b32 s67, 122880
    s_mov_b32 s68, 0
    s_mov_b32 s69, 61440
    s_mov_b32 s70, 122880
    s_mov_b32 s71, 184320
    s_lshr_b32 s10, s6, 1
    s_and_b32 s11, s6, 1
    s_mul_i32 s12, s10, 9216
    v_mul_u32_u24 v12, 144, v3
    v_lshl_add_u32 v12, v4, 3, v12
    v_add_u32 v12, s12, v12
    v_lshrrev_b32 v13, 2, v3
    v_lshl_add_u32 v13, v4, 2, v13
    v_mul_u32_u24 v13, 288, v13
    v_and_b32 v14, 3, v3
    v_lshl_add_u32 v13, v14, 3, v13
    s_lshl_b32 s13, s11, 7
    s_add_u32 s13, s13, 18432
    v_add_u32 v13, s13, v13
    v_mov_b32 v16, 0
    v_mov_b32 v17, 0
    v_mov_b32 v18, 0
    v_mov_b32 v19, 0
    v_mov_b32 v20, 0
    v_mov_b32 v21, 0
    v_mov_b32 v22, 0
    v_mov_b32 v23, 0
    v_mov_b32 v24, 0
    v_mov_b32 v25, 0
    v_mov_b32 v26, 0
    v_mov_b32 v27, 0
    v_mov_b32 v28, 0
    v_mov_b32 v29, 0
    v_mov_b32 v30, 0
    v_mov_b32 v31, 0
    v_mov_b32 v32, 0
    v_mov_b32 v33, 0
    v_mov_b32 v34, 0
    v_mov_b32 v35, 0
    v_mov_b32 v36, 0
    v_mov_b32 v37, 0
    v_mov_b32 v38, 0
    v_mov_b32 v39, 0
    v_mov_b32 v40, 0
    v_mov_b32 v41, 0
    v_mov_b32 v42, 0
    v_mov_b32 v43, 0
    v_mov_b32 v44, 0
    v_mov_b32 v45, 0
    v_mov_b32 v46, 0
    v_mov_b32 v47, 0
    v_mov_b32 v48, 0
    v_mov_b32 v49, 0
    v_mov_b32 v50, 0
    v_mov_b32 v51, 0
    v_mov_b32 v52, 0
    v_mov_b32 v53, 0
    v_mov_b32 v54, 0
    v_mov_b32 v55, 0
    v_mov_b32 v56, 0
    v_mov_b32 v57, 0
    v_mov_b32 v58, 0
    v_mov_b32 v59, 0
    v_mov_b32 v60, 0
    v_mov_b32 v61, 0
    v_mov_b32 v62, 0
    v_mov_b32 v63, 0
    v_mov_b32 v64, 0
    v_mov_b32 v65, 0
    v_mov_b32 v66, 0
    v_mov_b32 v67, 0
    v_mov_b32 v68, 0
    v_mov_b32 v69, 0
    v_mov_b32 v70, 0
    v_mov_b32 v71, 0
    v_mov_b32 v72, 0
    v_mov_b32 v73, 0
    v_mov_b32 v74, 0
    v_mov_b32 v75, 0
    v_mov_b32 v76, 0
    v_mov_b32 v77, 0
    v_mov_b32 v78, 0
    v_mov_b32 v79, 0
    buffer_load_dwordx4 v[144:147], v7, s[40:43], s64 offen
    buffer_load_dwordx4 v[148:151], v7, s[40:43], s65 offen
    buffer_load_dwordx4 v[152:155], v7, s[40:43], s66 offen
    buffer_load_dwordx4 v[156:159], v7, s[40:43], s67 offen
    buffer_load_dwordx4 v[160:163], v10, s[60:63], s68 offen
    buffer_load_dwordx4 v[164:167], v10, s[60:63], s69 offen
    buffer_load_dwordx4 v[168:171], v10, s[60:63], s70 offen
    buffer_load_dwordx4 v[172:175], v10, s[60:63], s71 offen
    v_add_u32 v7, 128, v7
    v_add_u32 v10, 245760, v10
    buffer_load_dwordx4 v[176:179], v7, s[40:43], s64 offen
    buffer_load_dwordx4 v[180:183], v7, s[40:43], s65 offen
    buffer_load_dwordx4 v[184:187], v7, s[40:43], s66 offen
    buffer_load_dwordx4 v[188:191], v7, s[40:43], s67 offen
    buffer_load_dwordx4 v[192:195], v10, s[60:63], s68 offen
    buffer_load_dwordx4 v[196:199], v10, s[60:63], s69 offen
    buffer_load_dwordx4 v[200:203], v10, s[60:63], s70 offen
    buffer_load_dwordx4 v[204:207], v10, s[60:63], s71 offen
    v_add_u32 v7, 128, v7
    v_add_u32 v10, 245760, v10
    s_waitcnt vmcnt(8)
    ds_write_b128 v8, v[144:147] offset:0
    ds_write_b128 v8, v[148:151] offset:4608
    ds_write_b128 v8, v[152:155] offset:9216
    ds_write_b128 v8, v[156:159] offset:13824
    ds_write_b128 v11, v[160:163] offset:0
    ds_write_b128 v11, v[164:167] offset:4608
    ds_write_b128 v11, v[168:171] offset:9216
    ds_write_b128 v11, v[172:175] offset:13824
    s_waitcnt lgkmcnt(0)
    s_barrier
    buffer_load_dwordx4 v[144:147], v7, s[40:43], s64 offen
    buffer_load_dwordx4 v[148:151], v7, s[40:43], s65 offen
    buffer_load_dwordx4 v[152:155], v7, s[40:43], s66 offen
    buffer_load_dwordx4 v[156:159], v7, s[40:43], s67 offen
    buffer_load_dwordx4 v[160:163], v10, s[60:63], s68 offen
    buffer_load_dwordx4 v[164:167], v10, s[60:63], s69 offen
    buffer_load_dwordx4 v[168:171], v10, s[60:63], s70 offen
    buffer_load_dwordx4 v[172:175], v10, s[60:63], s71 offen
    v_add_u32 v7, 128, v7
    v_add_u32 v10, 245760, v10
    ds_read_b64_tr_b16 v[96:97], v13 offset:0
    ds_read_b64_tr_b16 v[98:99], v13 offset:4608
    ds_read_b64_tr_b16 v[100:101], v13 offset:32
    ds_read_b64_tr_b16 v[102:103], v13 offset:4640
    ds_read_b64_tr_b16 v[104:105], v13 offset:64
    ds_read_b64_tr_b16 v[106:107], v13 offset:4672
    ds_read_b64_tr_b16 v[108:109], v13 offset:96
    ds_read_b64_tr_b16 v[110:111], v13 offset:4704
    ds_read_b64 v[80:81], v12 offset:0
    ds_read_b64 v[82:83], v12 offset:32
    ds_read_b64 v[84:85], v12 offset:2304
    ds_read_b64 v[86:87], v12 offset:2336
    ds_read_b64 v[88:89], v12 offset:4608
    ds_read_b64 v[90:91], v12 offset:4640
    ds_read_b64 v[92:93], v12 offset:6912
    ds_read_b64 v[94:95], v12 offset:6944
    s_waitcnt lgkmcnt(0)
    ds_read_b64_tr_b16 v[128:129], v13 offset:9216
    ds_read_b64_tr_b16 v[130:131], v13 offset:13824
    ds_read_b64_tr_b16 v[132:133], v13 offset:9248
    ds_read_b64_tr_b16 v[134:135], v13 offset:13856
    ds_read_b64_tr_b16 v[136:137], v13 offset:9280
    ds_read_b64_tr_b16 v[138:139], v13 offset:13888
    ds_read_b64_tr_b16 v[140:141], v13 offset:9312
    ds_read_b64_tr_b16 v[142:143], v13 offset:13920
    ds_read_b64 v[112:113], v12 offset:64
    ds_read_b64 v[114:115], v12 offset:96
    ds_read_b64 v[116:117], v12 offset:2368
    ds_read_b64 v[118:119], v12 offset:2400
    ds_read_b64 v[120:121], v12 offset:4672
    ds_read_b64 v[122:123], v12 offset:4704
    ds_read_b64 v[124:125], v12 offset:6976
    ds_read_b64 v[126:127], v12 offset:7008
    v_mfma_f32_16x16x32_bf16 v[16:19], v[96:99], v[80:83], v[16:19]
    v_mfma_f32_16x16x32_bf16 v[20:23], v[100:103], v[80:83], v[20:23]
    v_mfma_f32_16x16x32_bf16 v[24:27], v[104:107], v[80:83], v[24:27]
    v_mfma_f32_16x16x32_bf16 v[28:31], v[108:111], v[80:83], v[28:31]
    v_mfma_f32_16x16x32_bf16 v[32:35], v[96:99], v[84:87], v[32:35]
    v_mfma_f32_16x16x32_bf16 v[36:39], v[100:103], v[84:87], v[36:39]
    v_mfma_f32_16x16x32_bf16 v[40:43], v[104:107], v[84:87], v[40:43]
    v_mfma_f32_16x16x32_bf16 v[44:47], v[108:111], v[84:87], v[44:47]
    v_mfma_f32_16x16x32_bf16 v[48:51], v[96:99], v[88:91], v[48:51]
    v_mfma_f32_16x16x32_bf16 v[52:55], v[100:103], v[88:91], v[52:55]
    v_mfma_f32_16x16x32_bf16 v[56:59], v[104:107], v[88:91], v[56:59]
    v_mfma_f32_16x16x32_bf16 v[60:63], v[108:111], v[88:91], v[60:63]
    v_mfma_f32_16x16x32_bf16 v[64:67], v[96:99], v[92:95], v[64:67]
    v_mfma_f32_16x16x32_bf16 v[68:71], v[100:103], v[92:95], v[68:71]
    v_mfma_f32_16x16x32_bf16 v[72:75], v[104:107], v[92:95], v[72:75]
    v_mfma_f32_16x16x32_bf16 v[76:79], v[108:111], v[92:95], v[76:79]
    s_waitcnt lgkmcnt(0)
    v_mfma_f32_16x16x32_bf16 v[16:19], v[128:131], v[112:115], v[16:19]
    v_mfma_f32_16x16x32_bf16 v[20:23], v[132:135], v[112:115], v[20:23]
    v_mfma_f32_16x16x32_bf16 v[24:27], v[136:139], v[112:115], v[24:27]
    v_mfma_f32_16x16x32_bf16 v[28:31], v[140:143], v[112:115], v[28:31]
    v_mfma_f32_16x16x32_bf16 v[32:35], v[128:131], v[116:119], v[32:35]
    v_mfma_f32_16x16x32_bf16 v[36:39], v[132:135], v[116:119], v[36:39]
    v_mfma_f32_16x16x32_bf16 v[40:43], v[136:139], v[116:119], v[40:43]
    v_mfma_f32_16x16x32_bf16 v[44:47], v[140:143], v[116:119], v[44:47]
    v_mfma_f32_16x16x32_bf16 v[48:51], v[128:131], v[120:123], v[48:51]
    v_mfma_f32_16x16x32_bf16 v[52:55], v[132:135], v[120:123], v[52:55]
    v_mfma_f32_16x16x32_bf16 v[56:59], v[136:139], v[120:123], v[56:59]
    v_mfma_f32_16x16x32_bf16 v[60:63], v[140:143], v[120:123], v[60:63]
    v_mfma_f32_16x16x32_bf16 v[64:67], v[128:131], v[124:127], v[64:67]
    v_mfma_f32_16x16x32_bf16 v[68:71], v[132:135], v[124:127], v[68:71]
    v_mfma_f32_16x16x32_bf16 v[72:75], v[136:139], v[124:127], v[72:75]
    v_mfma_f32_16x16x32_bf16 v[76:79], v[140:143], v[124:127], v[76:79]
    s_waitcnt vmcnt(8)
    ds_write_b128 v8, v[176:179] offset:36864
    ds_write_b128 v8, v[180:183] offset:41472
    ds_write_b128 v8, v[184:187] offset:46080
    ds_write_b128 v8, v[188:191] offset:50688
    ds_write_b128 v11, v[192:195] offset:36864
    ds_write_b128 v11, v[196:199] offset:41472
    ds_write_b128 v11, v[200:203] offset:46080
    ds_write_b128 v11, v[204:207] offset:50688
    s_waitcnt lgkmcnt(0)
    s_barrier
    buffer_load_dwordx4 v[176:179], v7, s[40:43], s64 offen
    buffer_load_dwordx4 v[180:183], v7, s[40:43], s65 offen
    buffer_load_dwordx4 v[184:187], v7, s[40:43], s66 offen
    buffer_load_dwordx4 v[188:191], v7, s[40:43], s67 offen
    buffer_load_dwordx4 v[192:195], v10, s[60:63], s68 offen
    buffer_load_dwordx4 v[196:199], v10, s[60:63], s69 offen
    buffer_load_dwordx4 v[200:203], v10, s[60:63], s70 offen
    buffer_load_dwordx4 v[204:207], v10, s[60:63], s71 offen
    v_add_u32 v7, 128, v7
    v_add_u32 v10, 245760, v10
    ds_read_b64_tr_b16 v[96:97], v13 offset:36864
    ds_read_b64_tr_b16 v[98:99], v13 offset:41472
    ds_read_b64_tr_b16 v[100:101], v13 offset:36896
    ds_read_b64_tr_b16 v[102:103], v13 offset:41504
    ds_read_b64_tr_b16 v[104:105], v13 offset:36928
    ds_read_b64_tr_b16 v[106:107], v13 offset:41536
    ds_read_b64_tr_b16 v[108:109], v13 offset:36960
    ds_read_b64_tr_b16 v[110:111], v13 offset:41568
    ds_read_b64 v[80:81], v12 offset:36864
    ds_read_b64 v[82:83], v12 offset:36896
    ds_read_b64 v[84:85], v12 offset:39168
    ds_read_b64 v[86:87], v12 offset:39200
    ds_read_b64 v[88:89], v12 offset:41472
    ds_read_b64 v[90:91], v12 offset:41504
    ds_read_b64 v[92:93], v12 offset:43776
    ds_read_b64 v[94:95], v12 offset:43808
    s_waitcnt lgkmcnt(0)
    ds_read_b64_tr_b16 v[128:129], v13 offset:46080
    ds_read_b64_tr_b16 v[130:131], v13 offset:50688
    ds_read_b64_tr_b16 v[132:133], v13 offset:46112
    ds_read_b64_tr_b16 v[134:135], v13 offset:50720
    ds_read_b64_tr_b16 v[136:137], v13 offset:46144
    ds_read_b64_tr_b16 v[138:139], v13 offset:50752
    ds_read_b64_tr_b16 v[140:141], v13 offset:46176
    ds_read_b64_tr_b16 v[142:143], v13 offset:50784
    ds_read_b64 v[112:113], v12 offset:36928
    ds_read_b64 v[114:115], v12 offset:36960
    ds_read_b64 v[116:117], v12 offset:39232
    ds_read_b64 v[118:119], v12 offset:39264
    ds_read_b64 v[120:121], v12 offset:41536
    ds_read_b64 v[122:123], v12 offset:41568
    ds_read_b64 v[124:125], v12 offset:43840
    ds_read_b64 v[126:127], v12 offset:43872
    v_mfma_f32_16x16x32_bf16 v[16:19], v[96:99], v[80:83], v[16:19]
    v_mfma_f32_16x16x32_bf16 v[20:23], v[100:103], v[80:83], v[20:23]
    v_mfma_f32_16x16x32_bf16 v[24:27], v[104:107], v[80:83], v[24:27]
    v_mfma_f32_16x16x32_bf16 v[28:31], v[108:111], v[80:83], v[28:31]
    v_mfma_f32_16x16x32_bf16 v[32:35], v[96:99], v[84:87], v[32:35]
    v_mfma_f32_16x16x32_bf16 v[36:39], v[100:103], v[84:87], v[36:39]
    v_mfma_f32_16x16x32_bf16 v[40:43], v[104:107], v[84:87], v[40:43]
    v_mfma_f32_16x16x32_bf16 v[44:47], v[108:111], v[84:87], v[44:47]
    v_mfma_f32_16x16x32_bf16 v[48:51], v[96:99], v[88:91], v[48:51]
    v_mfma_f32_16x16x32_bf16 v[52:55], v[100:103], v[88:91], v[52:55]
    v_mfma_f32_16x16x32_bf16 v[56:59], v[104:107], v[88:91], v[56:59]
    v_mfma_f32_16x16x32_bf16 v[60:63], v[108:111], v[88:91], v[60:63]
    v_mfma_f32_16x16x32_bf16 v[64:67], v[96:99], v[92:95], v[64:67]
    v_mfma_f32_16x16x32_bf16 v[68:71], v[100:103], v[92:95], v[68:71]
    v_mfma_f32_16x16x32_bf16 v[72:75], v[104:107], v[92:95], v[72:75]
    v_mfma_f32_16x16x32_bf16 v[76:79], v[108:111], v[92:95], v[76:79]
    s_waitcnt lgkmcnt(0)
    v_mfma_f32_16x16x32_bf16 v[16:19], v[128:131], v[112:115], v[16:19]
    v_mfma_f32_16x16x32_bf16 v[20:23], v[132:135], v[112:115], v[20:23]
    v_mfma_f32_16x16x32_bf16 v[24:27], v[136:139], v[112:115], v[24:27]
    v_mfma_f32_16x16x32_bf16 v[28:31], v[140:143], v[112:115], v[28:31]
    v_mfma_f32_16x16x32_bf16 v[32:35], v[128:131], v[116:119], v[32:35]
    v_mfma_f32_16x16x32_bf16 v[36:39], v[132:135], v[116:119], v[36:39]
    v_mfma_f32_16x16x32_bf16 v[40:43], v[136:139], v[116:119], v[40:43]
    v_mfma_f32_16x16x32_bf16 v[44:47], v[140:143], v[116:119], v[44:47]
    v_mfma_f32_16x16x32_bf16 v[48:51], v[128:131], v[120:123], v[48:51]
    v_mfma_f32_16x16x32_bf16 v[52:55], v[132:135], v[120:123], v[52:55]
    v_mfma_f32_16x16x32_bf16 v[56:59], v[136:139], v[120:123], v[56:59]
    v_mfma_f32_16x16x32_bf16 v[60:63], v[140:143], v[120:123], v[60:63]
    v_mfma_f32_16x16x32_bf16 v[64:67], v[128:131], v[124:127], v[64:67]
    v_mfma_f32_16x16x32_bf16 v[68:71], v[132:135], v[124:127], v[68:71]
    v_mfma_f32_16x16x32_bf16 v[72:75], v[136:139], v[124:127], v[72:75]
    v_mfma_f32_16x16x32_bf16 v[76:79], v[140:143], v[124:127], v[76:79]
    s_waitcnt vmcnt(8)
    ds_write_b128 v8, v[144:147] offset:0
    ds_write_b128 v8, v[148:151] offset:4608
    ds_write_b128 v8, v[152:155] offset:9216
    ds_write_b128 v8, v[156:159] offset:13824
    ds_write_b128 v11, v[160:163] offset:0
    ds_write_b128 v11, v[164:167] offset:4608
    ds_write_b128 v11, v[168:171] offset:9216
    ds_write_b128 v11, v[172:175] offset:13824
    s_waitcnt lgkmcnt(0)
    s_barrier
    buffer_load_dwordx4 v[144:147], v7, s[40:43], s64 offen
    buffer_load_dwordx4 v[148:151], v7, s[40:43], s65 offen
    buffer_load_dwordx4 v[152:155], v7, s[40:43], s66 offen
    buffer_load_dwordx4 v[156:159], v7, s[40:43], s67 offen
    buffer_load_dwordx4 v[160:163], v10, s[60:63], s68 offen
    buffer_load_dwordx4 v[164:167], v10, s[60:63], s69 offen
    buffer_load_dwordx4 v[168:171], v10, s[60:63], s70 offen
    buffer_load_dwordx4 v[172:175], v10, s[60:63], s71 offen
    v_add_u32 v7, 128, v7
    v_add_u32 v10, 245760, v10
    ds_read_b64_tr_b16 v[96:97], v13 offset:0
    ds_read_b64_tr_b16 v[98:99], v13 offset:4608
    ds_read_b64_tr_b16 v[100:101], v13 offset:32
    ds_read_b64_tr_b16 v[102:103], v13 offset:4640
    ds_read_b64_tr_b16 v[104:105], v13 offset:64
    ds_read_b64_tr_b16 v[106:107], v13 offset:4672
    ds_read_b64_tr_b16 v[108:109], v13 offset:96
    ds_read_b64_tr_b16 v[110:111], v13 offset:4704
    ds_read_b64 v[80:81], v12 offset:0
    ds_read_b64 v[82:83], v12 offset:32
    ds_read_b64 v[84:85], v12 offset:2304
    ds_read_b64 v[86:87], v12 offset:2336
    ds_read_b64 v[88:89], v12 offset:4608
    ds_read_b64 v[90:91], v12 offset:4640
    ds_read_b64 v[92:93], v12 offset:6912
    ds_read_b64 v[94:95], v12 offset:6944
    s_waitcnt lgkmcnt(0)
    ds_read_b64_tr_b16 v[128:129], v13 offset:9216
    ds_read_b64_tr_b16 v[130:131], v13 offset:13824
    ds_read_b64_tr_b16 v[132:133], v13 offset:9248
    ds_read_b64_tr_b16 v[134:135], v13 offset:13856
    ds_read_b64_tr_b16 v[136:137], v13 offset:9280
    ds_read_b64_tr_b16 v[138:139], v13 offset:13888
    ds_read_b64_tr_b16 v[140:141], v13 offset:9312
    ds_read_b64_tr_b16 v[142:143], v13 offset:13920
    ds_read_b64 v[112:113], v12 offset:64
    ds_read_b64 v[114:115], v12 offset:96
    ds_read_b64 v[116:117], v12 offset:2368
    ds_read_b64 v[118:119], v12 offset:2400
    ds_read_b64 v[120:121], v12 offset:4672
    ds_read_b64 v[122:123], v12 offset:4704
    ds_read_b64 v[124:125], v12 offset:6976
    ds_read_b64 v[126:127], v12 offset:7008
    v_mfma_f32_16x16x32_bf16 v[16:19], v[96:99], v[80:83], v[16:19]
    v_mfma_f32_16x16x32_bf16 v[20:23], v[100:103], v[80:83], v[20:23]
    v_mfma_f32_16x16x32_bf16 v[24:27], v[104:107], v[80:83], v[24:27]
    v_mfma_f32_16x16x32_bf16 v[28:31], v[108:111], v[80:83], v[28:31]
    v_mfma_f32_16x16x32_bf16 v[32:35], v[96:99], v[84:87], v[32:35]
    v_mfma_f32_16x16x32_bf16 v[36:39], v[100:103], v[84:87], v[36:39]
    v_mfma_f32_16x16x32_bf16 v[40:43], v[104:107], v[84:87], v[40:43]
    v_mfma_f32_16x16x32_bf16 v[44:47], v[108:111], v[84:87], v[44:47]
    v_mfma_f32_16x16x32_bf16 v[48:51], v[96:99], v[88:91], v[48:51]
    v_mfma_f32_16x16x32_bf16 v[52:55], v[100:103], v[88:91], v[52:55]
    v_mfma_f32_16x16x32_bf16 v[56:59], v[104:107], v[88:91], v[56:59]
    v_mfma_f32_16x16x32_bf16 v[60:63], v[108:111], v[88:91], v[60:63]
    v_mfma_f32_16x16x32_bf16 v[64:67], v[96:99], v[92:95], v[64:67]
    v_mfma_f32_16x16x32_bf16 v[68:71], v[100:103], v[92:95], v[68:71]
    v_mfma_f32_16x16x32_bf16 v[72:75], v[104:107], v[92:95], v[72:75]
    v_mfma_f32_16x16x32_bf16 v[76:79], v[108:111], v[92:95], v[76:79]
    s_waitcnt lgkmcnt(0)
    v_mfma_f32_16x16x32_bf16 v[16:19], v[128:131], v[112:115], v[16:19]
    v_mfma_f32_16x16x32_bf16 v[20:23], v[132:135], v[112:115], v[20:23]
    v_mfma_f32_16x16x32_bf16 v[24:27], v[136:139], v[112:115], v[24:27]
    v_mfma_f32_16x16x32_bf16 v[28:31], v[140:143], v[112:115], v[28:31]
    v_mfma_f32_16x16x32_bf16 v[32:35], v[128:131], v[116:119], v[32:35]
    v_mfma_f32_16x16x32_bf16 v[36:39], v[132:135], v[116:119], v[36:39]
    v_mfma_f32_16x16x32_bf16 v[40:43], v[136:139], v[116:119], v[40:43]
    v_mfma_f32_16x16x32_bf16 v[44:47], v[140:143], v[116:119], v[44:47]
    v_mfma_f32_16x16x32_bf16 v[48:51], v[128:131], v[120:123], v[48:51]
    v_mfma_f32_16x16x32_bf16 v[52:55], v[132:135], v[120:123], v[52:55]
    v_mfma_f32_16x16x32_bf16 v[56:59], v[136:139], v[120:123], v[56:59]
    v_mfma_f32_16x16x32_bf16 v[60:63], v[140:143], v[120:123], v[60:63]
    v_mfma_f32_16x16x32_bf16 v[64:67], v[128:131], v[124:127], v[64:67]
    v_mfma_f32_16x16x32_bf16 v[68:71], v[132:135], v[124:127], v[68:71]
    v_mfma_f32_16x16x32_bf16 v[72:75], v[136:139], v[124:127], v[72:75]
    v_mfma_f32_16x16x32_bf16 v[76:79], v[140:143], v[124:127], v[76:79]
    s_waitcnt vmcnt(8)
    ds_write_b128 v8, v[176:179] offset:36864
    ds_write_b128 v8, v[180:183] offset:41472
    ds_write_b128 v8, v[184:187] offset:46080
    ds_write_b128 v8, v[188:191] offset:50688
    ds_write_b128 v11, v[192:195] offset:36864
    ds_write_b128 v11, v[196:199] offset:41472
    ds_write_b128 v11, v[200:203] offset:46080
    ds_write_b128 v11, v[204:207] offset:50688
    s_waitcnt lgkmcnt(0)
    s_barrier
    buffer_load_dwordx4 v[176:179], v7, s[40:43], s64 offen
    buffer_load_dwordx4 v[180:183], v7, s[40:43], s65 offen
    buffer_load_dwordx4 v[184:187], v7, s[40:43], s66 offen
    buffer_load_dwordx4 v[188:191], v7, s[40:43], s67 offen
    buffer_load_dwordx4 v[192:195], v10, s[60:63], s68 offen
    buffer_load_dwordx4 v[196:199], v10, s[60:63], s69 offen
    buffer_load_dwordx4 v[200:203], v10, s[60:63], s70 offen
    buffer_load_dwordx4 v[204:207], v10, s[60:63], s71 offen
    v_add_u32 v7, 128, v7
    v_add_u32 v10, 245760, v10
    ds_read_b64_tr_b16 v[96:97], v13 offset:36864
    ds_read_b64_tr_b16 v[98:99], v13 offset:41472
    ds_read_b64_tr_b16 v[100:101], v13 offset:36896
    ds_read_b64_tr_b16 v[102:103], v13 offset:41504
    ds_read_b64_tr_b16 v[104:105], v13 offset:36928
    ds_read_b64_tr_b16 v[106:107], v13 offset:41536
    ds_read_b64_tr_b16 v[108:109], v13 offset:36960
    ds_read_b64_tr_b16 v[110:111], v13 offset:41568
    ds_read_b64 v[80:81], v12 offset:36864
    ds_read_b64 v[82:83], v12 offset:36896
    ds_read_b64 v[84:85], v12 offset:39168
    ds_read_b64 v[86:87], v12 offset:39200
    ds_read_b64 v[88:89], v12 offset:41472
    ds_read_b64 v[90:91], v12 offset:41504
    ds_read_b64 v[92:93], v12 offset:43776
    ds_read_b64 v[94:95], v12 offset:43808
    s_waitcnt lgkmcnt(0)
    ds_read_b64_tr_b16 v[128:129], v13 offset:46080
    ds_read_b64_tr_b16 v[130:131], v13 offset:50688
    ds_read_b64_tr_b16 v[132:133], v13 offset:46112
    ds_read_b64_tr_b16 v[134:135], v13 offset:50720
    ds_read_b64_tr_b16 v[136:137], v13 offset:46144
    ds_read_b64_tr_b16 v[138:139], v13 offset:50752
    ds_read_b64_tr_b16 v[140:141], v13 offset:46176
    ds_read_b64_tr_b16 v[142:143], v13 offset:50784
    ds_read_b64 v[112:113], v12 offset:36928
    ds_read_b64 v[114:115], v12 offset:36960
    ds_read_b64 v[116:117], v12 offset:39232
    ds_read_b64 v[118:119], v12 offset:39264
    ds_read_b64 v[120:121], v12 offset:41536
    ds_read_b64 v[122:123], v12 offset:41568
    ds_read_b64 v[124:125], v12 offset:43840
    ds_read_b64 v[126:127], v12 offset:43872
    v_mfma_f32_16x16x32_bf16 v[16:19], v[96:99], v[80:83], v[16:19]
    v_mfma_f32_16x16x32_bf16 v[20:23], v[100:103], v[80:83], v[20:23]
    v_mfma_f32_16x16x32_bf16 v[24:27], v[104:107], v[80:83], v[24:27]
    v_mfma_f32_16x16x32_bf16 v[28:31], v[108:111], v[80:83], v[28:31]
    v_mfma_f32_16x16x32_bf16 v[32:35], v[96:99], v[84:87], v[32:35]
    v_mfma_f32_16x16x32_bf16 v[36:39], v[100:103], v[84:87], v[36:39]
    v_mfma_f32_16x16x32_bf16 v[40:43], v[104:107], v[84:87], v[40:43]
    v_mfma_f32_16x16x32_bf16 v[44:47], v[108:111], v[84:87], v[44:47]
    v_mfma_f32_16x16x32_bf16 v[48:51], v[96:99], v[88:91], v[48:51]
    v_mfma_f32_16x16x32_bf16 v[52:55], v[100:103], v[88:91], v[52:55]
    v_mfma_f32_16x16x32_bf16 v[56:59], v[104:107], v[88:91], v[56:59]
    v_mfma_f32_16x16x32_bf16 v[60:63], v[108:111], v[88:91], v[60:63]
    v_mfma_f32_16x16x32_bf16 v[64:67], v[96:99], v[92:95], v[64:67]
    v_mfma_f32_16x16x32_bf16 v[68:71], v[100:103], v[92:95], v[68:71]
    v_mfma_f32_16x16x32_bf16 v[72:75], v[104:107], v[92:95], v[72:75]
    v_mfma_f32_16x16x32_bf16 v[76:79], v[108:111], v[92:95], v[76:79]
    s_waitcnt lgkmcnt(0)
    v_mfma_f32_16x16x32_bf16 v[16:19], v[128:131], v[112:115], v[16:19]
    v_mfma_f32_16x16x32_bf16 v[20:23], v[132:135], v[112:115], v[20:23]
    v_mfma_f32_16x16x32_bf16 v[24:27], v[136:139], v[112:115], v[24:27]
    v_mfma_f32_16x16x32_bf16 v[28:31], v[140:143], v[112:115], v[28:31]
    v_mfma_f32_16x16x32_bf16 v[32:35], v[128:131], v[116:119], v[32:35]
    v_mfma_f32_16x16x32_bf16 v[36:39], v[132:135], v[116:119], v[36:39]
    v_mfma_f32_16x16x32_bf16 v[40:43], v[136:139], v[116:119], v[40:43]
    v_mfma_f32_16x16x32_bf16 v[44:47], v[140:143], v[116:119], v[44:47]
    v_mfma_f32_16x16x32_bf16 v[48:51], v[128:131], v[120:123], v[48:51]
    v_mfma_f32_16x16x32_bf16 v[52:55], v[132:135], v[120:123], v[52:55]
    v_mfma_f32_16x16x32_bf16 v[56:59], v[136:139], v[120:123], v[56:59]
    v_mfma_f32_16x16x32_bf16 v[60:63], v[140:143], v[120:123], v[60:63]
    v_mfma_f32_16x16x32_bf16 v[64:67], v[128:131], v[124:127], v[64:67]
    v_mfma_f32_16x16x32_bf16 v[68:71], v[132:135], v[124:127], v[68:71]
    v_mfma_f32_16x16x32_bf16 v[72:75], v[136:139], v[124:127], v[72:75]
    v_mfma_f32_16x16x32_bf16 v[76:79], v[140:143], v[124:127], v[76:79]
    s_waitcnt vmcnt(8)
    ds_write_b128 v8, v[144:147] offset:0
    ds_write_b128 v8, v[148:151] offset:4608
    ds_write_b128 v8, v[152:155] offset:9216
    ds_write_b128 v8, v[156:159] offset:13824
    ds_write_b128 v11, v[160:163] offset:0
    ds_write_b128 v11, v[164:167] offset:4608
    ds_write_b128 v11, v[168:171] offset:9216
    ds_write_b128 v11, v[172:175] offset:13824
    s_waitcnt lgkmcnt(0)
    s_barrier
    buffer_load_dwordx4 v[144:147], v7, s[40:43], s64 offen
    buffer_load_dwordx4 v[148:151], v7, s[40:43], s65 offen
    buffer_load_dwordx4 v[152:155], v7, s[40:43], s66 offen
    buffer_load_dwordx4 v[156:159], v7, s[40:43], s67 offen
    buffer_load_dwordx4 v[160:163], v10, s[60:63], s68 offen
    buffer_load_dwordx4 v[164:167], v10, s[60:63], s69 offen
    buffer_load_dwordx4 v[168:171], v10, s[60:63], s70 offen
    buffer_load_dwordx4 v[172:175], v10, s[60:63], s71 offen
    v_add_u32 v7, 128, v7
    v_add_u32 v10, 245760, v10
    ds_read_b64_tr_b16 v[96:97], v13 offset:0
    ds_read_b64_tr_b16 v[98:99], v13 offset:4608
    ds_read_b64_tr_b16 v[100:101], v13 offset:32
    ds_read_b64_tr_b16 v[102:103], v13 offset:4640
    ds_read_b64_tr_b16 v[104:105], v13 offset:64
    ds_read_b64_tr_b16 v[106:107], v13 offset:4672
    ds_read_b64_tr_b16 v[108:109], v13 offset:96
    ds_read_b64_tr_b16 v[110:111], v13 offset:4704
    ds_read_b64 v[80:81], v12 offset:0
    ds_read_b64 v[82:83], v12 offset:32
    ds_read_b64 v[84:85], v12 offset:2304
    ds_read_b64 v[86:87], v12 offset:2336
    ds_read_b64 v[88:89], v12 offset:4608
    ds_read_b64 v[90:91], v12 offset:4640
    ds_read_b64 v[92:93], v12 offset:6912
    ds_read_b64 v[94:95], v12 offset:6944
    s_waitcnt lgkmcnt(0)
    ds_read_b64_tr_b16 v[128:129], v13 offset:9216
    ds_read_b64_tr_b16 v[130:131], v13 offset:13824
    ds_read_b64_tr_b16 v[132:133], v13 offset:9248
    ds_read_b64_tr_b16 v[134:135], v13 offset:13856
    ds_read_b64_tr_b16 v[136:137], v13 offset:9280
    ds_read_b64_tr_b16 v[138:139], v13 offset:13888
    ds_read_b64_tr_b16 v[140:141], v13 offset:9312
    ds_read_b64_tr_b16 v[142:143], v13 offset:13920
    ds_read_b64 v[112:113], v12 offset:64
    ds_read_b64 v[114:115], v12 offset:96
    ds_read_b64 v[116:117], v12 offset:2368
    ds_read_b64 v[118:119], v12 offset:2400
    ds_read_b64 v[120:121], v12 offset:4672
    ds_read_b64 v[122:123], v12 offset:4704
    ds_read_b64 v[124:125], v12 offset:6976
    ds_read_b64 v[126:127], v12 offset:7008
    v_mfma_f32_16x16x32_bf16 v[16:19], v[96:99], v[80:83], v[16:19]
    v_mfma_f32_16x16x32_bf16 v[20:23], v[100:103], v[80:83], v[20:23]
    v_mfma_f32_16x16x32_bf16 v[24:27], v[104:107], v[80:83], v[24:27]
    v_mfma_f32_16x16x32_bf16 v[28:31], v[108:111], v[80:83], v[28:31]
    v_mfma_f32_16x16x32_bf16 v[32:35], v[96:99], v[84:87], v[32:35]
    v_mfma_f32_16x16x32_bf16 v[36:39], v[100:103], v[84:87], v[36:39]
    v_mfma_f32_16x16x32_bf16 v[40:43], v[104:107], v[84:87], v[40:43]
    v_mfma_f32_16x16x32_bf16 v[44:47], v[108:111], v[84:87], v[44:47]
    v_mfma_f32_16x16x32_bf16 v[48:51], v[96:99], v[88:91], v[48:51]
    v_mfma_f32_16x16x32_bf16 v[52:55], v[100:103], v[88:91], v[52:55]
    v_mfma_f32_16x16x32_bf16 v[56:59], v[104:107], v[88:91], v[56:59]
    v_mfma_f32_16x16x32_bf16 v[60:63], v[108:111], v[88:91], v[60:63]
    v_mfma_f32_16x16x32_bf16 v[64:67], v[96:99], v[92:95], v[64:67]
    v_mfma_f32_16x16x32_bf16 v[68:71], v[100:103], v[92:95], v[68:71]
    v_mfma_f32_16x16x32_bf16 v[72:75], v[104:107], v[92:95], v[72:75]
    v_mfma_f32_16x16x32_bf16 v[76:79], v[108:111], v[92:95], v[76:79]
    s_waitcnt lgkmcnt(0)
    v_mfma_f32_16x16x32_bf16 v[16:19], v[128:131], v[112:115], v[16:19]
    v_mfma_f32_16x16x32_bf16 v[20:23], v[132:135], v[112:115], v[20:23]
    v_mfma_f32_16x16x32_bf16 v[24:27], v[136:139], v[112:115], v[24:27]
    v_mfma_f32_16x16x32_bf16 v[28:31], v[140:143], v[112:115], v[28:31]
    v_mfma_f32_16x16x32_bf16 v[32:35], v[128:131], v[116:119], v[32:35]
    v_mfma_f32_16x16x32_bf16 v[36:39], v[132:135], v[116:119], v[36:39]
    v_mfma_f32_16x16x32_bf16 v[40:43], v[136:139], v[116:119], v[40:43]
    v_mfma_f32_16x16x32_bf16 v[44:47], v[140:143], v[116:119], v[44:47]
    v_mfma_f32_16x16x32_bf16 v[48:51], v[128:131], v[120:123], v[48:51]
    v_mfma_f32_16x16x32_bf16 v[52:55], v[132:135], v[120:123], v[52:55]
    v_mfma_f32_16x16x32_bf16 v[56:59], v[136:139], v[120:123], v[56:59]
    v_mfma_f32_16x16x32_bf16 v[60:63], v[140:143], v[120:123], v[60:63]
    v_mfma_f32_16x16x32_bf16 v[64:67], v[128:131], v[124:127], v[64:67]
    v_mfma_f32_16x16x32_bf16 v[68:71], v[132:135], v[124:127], v[68:71]
    v_mfma_f32_16x16x32_bf16 v[72:75], v[136:139], v[124:127], v[72:75]
    v_mfma_f32_16x16x32_bf16 v[76:79], v[140:143], v[124:127], v[76:79]
    s_waitcnt vmcnt(8)
    ds_write_b128 v8, v[176:179] offset:36864
    ds_write_b128 v8, v[180:183] offset:41472
    ds_write_b128 v8, v[184:187] offset:46080
    ds_write_b128 v8, v[188:191] offset:50688
    ds_write_b128 v11, v[192:195] offset:36864
    ds_write_b128 v11, v[196:199] offset:41472
    ds_write_b128 v11, v[200:203] offset:46080
    ds_write_b128 v11, v[204:207] offset:50688
    s_waitcnt lgkmcnt(0)
    s_barrier
    buffer_load_dwordx4 v[176:179], v7, s[40:43], s64 offen
    buffer_load_dwordx4 v[180:183], v7, s[40:43], s65 offen
    buffer_load_dwordx4 v[184:187], v7, s[40:43], s66 offen
    buffer_load_dwordx4 v[188:191], v7, s[40:43], s67 offen
    buffer_load_dwordx4 v[192:195], v10, s[60:63], s68 offen
    buffer_load_dwordx4 v[196:199], v10, s[60:63], s69 offen
    buffer_load_dwordx4 v[200:203], v10, s[60:63], s70 offen
    buffer_load_dwordx4 v[204:207], v10, s[60:63], s71 offen
    v_add_u32 v7, 128, v7
    v_add_u32 v10, 245760, v10
    ds_read_b64_tr_b16 v[96:97], v13 offset:36864
    ds_read_b64_tr_b16 v[98:99], v13 offset:41472
    ds_read_b64_tr_b16 v[100:101], v13 offset:36896
    ds_read_b64_tr_b16 v[102:103], v13 offset:41504
    ds_read_b64_tr_b16 v[104:105], v13 offset:36928
    ds_read_b64_tr_b16 v[106:107], v13 offset:41536
    ds_read_b64_tr_b16 v[108:109], v13 offset:36960
    ds_read_b64_tr_b16 v[110:111], v13 offset:41568
    ds_read_b64 v[80:81], v12 offset:36864
    ds_read_b64 v[82:83], v12 offset:36896
    ds_read_b64 v[84:85], v12 offset:39168
    ds_read_b64 v[86:87], v12 offset:39200
    ds_read_b64 v[88:89], v12 offset:41472
    ds_read_b64 v[90:91], v12 offset:41504
    ds_read_b64 v[92:93], v12 offset:43776
    ds_read_b64 v[94:95], v12 offset:43808
    s_waitcnt lgkmcnt(0)
    ds_read_b64_tr_b16 v[128:129], v13 offset:46080
    ds_read_b64_tr_b16 v[130:131], v13 offset:50688
    ds_read_b64_tr_b16 v[132:133], v13 offset:46112
    ds_read_b64_tr_b16 v[134:135], v13 offset:50720
    ds_read_b64_tr_b16 v[136:137], v13 offset:46144
    ds_read_b64_tr_b16 v[138:139], v13 offset:50752
    ds_read_b64_tr_b16 v[140:141], v13 offset:46176
    ds_read_b64_tr_b16 v[142:143], v13 offset:50784
    ds_read_b64 v[112:113], v12 offset:36928
    ds_read_b64 v[114:115], v12 offset:36960
    ds_read_b64 v[116:117], v12 offset:39232
    ds_read_b64 v[118:119], v12 offset:39264
    ds_read_b64 v[120:121], v12 offset:41536
    ds_read_b64 v[122:123], v12 offset:41568
    ds_read_b64 v[124:125], v12 offset:43840
    ds_read_b64 v[126:127], v12 offset:43872
    v_mfma_f32_16x16x32_bf16 v[16:19], v[96:99], v[80:83], v[16:19]
    v_mfma_f32_16x16x32_bf16 v[20:23], v[100:103], v[80:83], v[20:23]
    v_mfma_f32_16x16x32_bf16 v[24:27], v[104:107], v[80:83], v[24:27]
    v_mfma_f32_16x16x32_bf16 v[28:31], v[108:111], v[80:83], v[28:31]
    v_mfma_f32_16x16x32_bf16 v[32:35], v[96:99], v[84:87], v[32:35]
    v_mfma_f32_16x16x32_bf16 v[36:39], v[100:103], v[84:87], v[36:39]
    v_mfma_f32_16x16x32_bf16 v[40:43], v[104:107], v[84:87], v[40:43]
    v_mfma_f32_16x16x32_bf16 v[44:47], v[108:111], v[84:87], v[44:47]
    v_mfma_f32_16x16x32_bf16 v[48:51], v[96:99], v[88:91], v[48:51]
    v_mfma_f32_16x16x32_bf16 v[52:55], v[100:103], v[88:91], v[52:55]
    v_mfma_f32_16x16x32_bf16 v[56:59], v[104:107], v[88:91], v[56:59]
    v_mfma_f32_16x16x32_bf16 v[60:63], v[108:111], v[88:91], v[60:63]
    v_mfma_f32_16x16x32_bf16 v[64:67], v[96:99], v[92:95], v[64:67]
    v_mfma_f32_16x16x32_bf16 v[68:71], v[100:103], v[92:95], v[68:71]
    v_mfma_f32_16x16x32_bf16 v[72:75], v[104:107], v[92:95], v[72:75]
    v_mfma_f32_16x16x32_bf16 v[76:79], v[108:111], v[92:95], v[76:79]
    s_waitcnt lgkmcnt(0)
    v_mfma_f32_16x16x32_bf16 v[16:19], v[128:131], v[112:115], v[16:19]
    v_mfma_f32_16x16x32_bf16 v[20:23], v[132:135], v[112:115], v[20:23]
    v_mfma_f32_16x16x32_bf16 v[24:27], v[136:139], v[112:115], v[24:27]
    v_mfma_f32_16x16x32_bf16 v[28:31], v[140:143], v[112:115], v[28:31]
    v_mfma_f32_16x16x32_bf16 v[32:35], v[128:131], v[116:119], v[32:35]
    v_mfma_f32_16x16x32_bf16 v[36:39], v[132:135], v[116:119], v[36:39]
    v_mfma_f32_16x16x32_bf16 v[40:43], v[136:139], v[116:119], v[40:43]
    v_mfma_f32_16x16x32_bf16 v[44:47], v[140:143], v[116:119], v[44:47]
    v_mfma_f32_16x16x32_bf16 v[48:51], v[128:131], v[120:123], v[48:51]
    v_mfma_f32_16x16x32_bf16 v[52:55], v[132:135], v[120:123], v[52:55]
    v_mfma_f32_16x16x32_bf16 v[56:59], v[136:139], v[120:123], v[56:59]
    v_mfma_f32_16x16x32_bf16 v[60:63], v[140:143], v[120:123], v[60:63]
    v_mfma_f32_16x16x32_bf16 v[64:67], v[128:131], v[124:127], v[64:67]
    v_mfma_f32_16x16x32_bf16 v[68:71], v[132:135], v[124:127], v[68:71]
    v_mfma_f32_16x16x32_bf16 v[72:75], v[136:139], v[124:127], v[72:75]
    v_mfma_f32_16x16x32_bf16 v[76:79], v[140:143], v[124:127], v[76:79]
    s_waitcnt vmcnt(8)
    ds_write_b128 v8, v[144:147] offset:0
    ds_write_b128 v8, v[148:151] offset:4608
    ds_write_b128 v8, v[152:155] offset:9216
    ds_write_b128 v8, v[156:159] offset:13824
    ds_write_b128 v11, v[160:163] offset:0
    ds_write_b128 v11, v[164:167] offset:4608
    ds_write_b128 v11, v[168:171] offset:9216
    ds_write_b128 v11, v[172:175] offset:13824
    s_waitcnt lgkmcnt(0)
    s_barrier
    buffer_load_dwordx4 v[144:147], v7, s[40:43], s64 offen
    buffer_load_dwordx4 v[148:151], v7, s[40:43], s65 offen
    buffer_load_dwordx4 v[152:155], v7, s[40:43], s66 offen
    buffer_load_dwordx4 v[156:159], v7, s[40:43], s67 offen
    buffer_load_dwordx4 v[160:163], v10, s[60:63], s68 offen
    buffer_load_dwordx4 v[164:167], v10, s[60:63], s69 offen
    buffer_load_dwordx4 v[168:171], v10, s[60:63], s70 offen
    buffer_load_dwordx4 v[172:175], v10, s[60:63], s71 offen
    v_add_u32 v7, 128, v7
    v_add_u32 v10, 245760, v10
    ds_read_b64_tr_b16 v[96:97], v13 offset:0
    ds_read_b64_tr_b16 v[98:99], v13 offset:4608
    ds_read_b64_tr_b16 v[100:101], v13 offset:32
    ds_read_b64_tr_b16 v[102:103], v13 offset:4640
    ds_read_b64_tr_b16 v[104:105], v13 offset:64
    ds_read_b64_tr_b16 v[106:107], v13 offset:4672
    ds_read_b64_tr_b16 v[108:109], v13 offset:96
    ds_read_b64_tr_b16 v[110:111], v13 offset:4704
    ds_read_b64 v[80:81], v12 offset:0
    ds_read_b64 v[82:83], v12 offset:32
    ds_read_b64 v[84:85], v12 offset:2304
    ds_read_b64 v[86:87], v12 offset:2336
    ds_read_b64 v[88:89], v12 offset:4608
    ds_read_b64 v[90:91], v12 offset:4640
    ds_read_b64 v[92:93], v12 offset:6912
    ds_read_b64 v[94:95], v12 offset:6944
    s_waitcnt lgkmcnt(0)
    ds_read_b64_tr_b16 v[128:129], v13 offset:9216
    ds_read_b64_tr_b16 v[130:131], v13 offset:13824
    ds_read_b64_tr_b16 v[132:133], v13 offset:9248
    ds_read_b64_tr_b16 v[134:135], v13 offset:13856
    ds_read_b64_tr_b16 v[136:137], v13 offset:9280
    ds_read_b64_tr_b16 v[138:139], v13 offset:13888
    ds_read_b64_tr_b16 v[140:141], v13 offset:9312
    ds_read_b64_tr_b16 v[142:143], v13 offset:13920
    ds_read_b64 v[112:113], v12 offset:64
    ds_read_b64 v[114:115], v12 offset:96
    ds_read_b64 v[116:117], v12 offset:2368
    ds_read_b64 v[118:119], v12 offset:2400
    ds_read_b64 v[120:121], v12 offset:4672
    ds_read_b64 v[122:123], v12 offset:4704
    ds_read_b64 v[124:125], v12 offset:6976
    ds_read_b64 v[126:127], v12 offset:7008
    v_mfma_f32_16x16x32_bf16 v[16:19], v[96:99], v[80:83], v[16:19]
    v_mfma_f32_16x16x32_bf16 v[20:23], v[100:103], v[80:83], v[20:23]
    v_mfma_f32_16x16x32_bf16 v[24:27], v[104:107], v[80:83], v[24:27]
    v_mfma_f32_16x16x32_bf16 v[28:31], v[108:111], v[80:83], v[28:31]
    v_mfma_f32_16x16x32_bf16 v[32:35], v[96:99], v[84:87], v[32:35]
    v_mfma_f32_16x16x32_bf16 v[36:39], v[100:103], v[84:87], v[36:39]
    v_mfma_f32_16x16x32_bf16 v[40:43], v[104:107], v[84:87], v[40:43]
    v_mfma_f32_16x16x32_bf16 v[44:47], v[108:111], v[84:87], v[44:47]
    v_mfma_f32_16x16x32_bf16 v[48:51], v[96:99], v[88:91], v[48:51]
    v_mfma_f32_16x16x32_bf16 v[52:55], v[100:103], v[88:91], v[52:55]
    v_mfma_f32_16x16x32_bf16 v[56:59], v[104:107], v[88:91], v[56:59]
    v_mfma_f32_16x16x32_bf16 v[60:63], v[108:111], v[88:91], v[60:63]
    v_mfma_f32_16x16x32_bf16 v[64:67], v[96:99], v[92:95], v[64:67]
    v_mfma_f32_16x16x32_bf16 v[68:71], v[100:103], v[92:95], v[68:71]
    v_mfma_f32_16x16x32_bf16 v[72:75], v[104:107], v[92:95], v[72:75]
    v_mfma_f32_16x16x32_bf16 v[76:79], v[108:111], v[92:95], v[76:79]
    s_waitcnt lgkmcnt(0)
    v_mfma_f32_16x16x32_bf16 v[16:19], v[128:131], v[112:115], v[16:19]
    v_mfma_f32_16x16x32_bf16 v[20:23], v[132:135], v[112:115], v[20:23]
    v_mfma_f32_16x16x32_bf16 v[24:27], v[136:139], v[112:115], v[24:27]
    v_mfma_f32_16x16x32_bf16 v[28:31], v[140:143], v[112:115], v[28:31]
    v_mfma_f32_16x16x32_bf16 v[32:35], v[128:131], v[116:119], v[32:35]
    v_mfma_f32_16x16x32_bf16 v[36:39], v[132:135], v[116:119], v[36:39]
    v_mfma_f32_16x16x32_bf16 v[40:43], v[136:139], v[116:119], v[40:43]
    v_mfma_f32_16x16x32_bf16 v[44:47], v[140:143], v[116:119], v[44:47]
    v_mfma_f32_16x16x32_bf16 v[48:51], v[128:131], v[120:123], v[48:51]
    v_mfma_f32_16x16x32_bf16 v[52:55], v[132:135], v[120:123], v[52:55]
    v_mfma_f32_16x16x32_bf16 v[56:59], v[136:139], v[120:123], v[56:59]
    v_mfma_f32_16x16x32_bf16 v[60:63], v[140:143], v[120:123], v[60:63]
    v_mfma_f32_16x16x32_bf16 v[64:67], v[128:131], v[124:127], v[64:67]
    v_mfma_f32_16x16x32_bf16 v[68:71], v[132:135], v[124:127], v[68:71]
    v_mfma_f32_16x16x32_bf16 v[72:75], v[136:139], v[124:127], v[72:75]
    v_mfma_f32_16x16x32_bf16 v[76:79], v[140:143], v[124:127], v[76:79]
    s_waitcnt vmcnt(8)
    ds_write_b128 v8, v[176:179] offset:36864
    ds_write_b128 v8, v[180:183] offset:41472
    ds_write_b128 v8, v[184:187] offset:46080
    ds_write_b128 v8, v[188:191] offset:50688
    ds_write_b128 v11, v[192:195] offset:36864
    ds_write_b128 v11, v[196:199] offset:41472
    ds_write_b128 v11, v[200:203] offset:46080
    ds_write_b128 v11, v[204:207] offset:50688
    s_waitcnt lgkmcnt(0)
    s_barrier
    buffer_load_dwordx4 v[176:179], v7, s[40:43], s64 offen
    buffer_load_dwordx4 v[180:183], v7, s[40:43], s65 offen
    buffer_load_dwordx4 v[184:187], v7, s[40:43], s66 offen
    buffer_load_dwordx4 v[188:191], v7, s[40:43], s67 offen
    buffer_load_dwordx4 v[192:195], v10, s[60:63], s68 offen
    buffer_load_dwordx4 v[196:199], v10, s[60:63], s69 offen
    buffer_load_dwordx4 v[200:203], v10, s[60:63], s70 offen
    buffer_load_dwordx4 v[204:207], v10, s[60:63], s71 offen
    v_add_u32 v7, 128, v7
    v_add_u32 v10, 245760, v10
    ds_read_b64_tr_b16 v[96:97], v13 offset:36864
    ds_read_b64_tr_b16 v[98:99], v13 offset:41472
    ds_read_b64_tr_b16 v[100:101], v13 offset:36896
    ds_read_b64_tr_b16 v[102:103], v13 offset:41504
    ds_read_b64_tr_b16 v[104:105], v13 offset:36928
    ds_read_b64_tr_b16 v[106:107], v13 offset:41536
    ds_read_b64_tr_b16 v[108:109], v13 offset:36960
    ds_read_b64_tr_b16 v[110:111], v13 offset:41568
    ds_read_b64 v[80:81], v12 offset:36864
    ds_read_b64 v[82:83], v12 offset:36896
    ds_read_b64 v[84:85], v12 offset:39168
    ds_read_b64 v[86:87], v12 offset:39200
    ds_read_b64 v[88:89], v12 offset:41472
    ds_read_b64 v[90:91], v12 offset:41504
    ds_read_b64 v[92:93], v12 offset:43776
    ds_read_b64 v[94:95], v12 offset:43808
    s_waitcnt lgkmcnt(0)
    ds_read_b64_tr_b16 v[128:129], v13 offset:46080
    ds_read_b64_tr_b16 v[130:131], v13 offset:50688
    ds_read_b64_tr_b16 v[132:133], v13 offset:46112
    ds_read_b64_tr_b16 v[134:135], v13 offset:50720
    ds_read_b64_tr_b16 v[136:137], v13 offset:46144
    ds_read_b64_tr_b16 v[138:139], v13 offset:50752
    ds_read_b64_tr_b16 v[140:141], v13 offset:46176
    ds_read_b64_tr_b16 v[142:143], v13 offset:50784
    ds_read_b64 v[112:113], v12 offset:36928
    ds_read_b64 v[114:115], v12 offset:36960
    ds_read_b64 v[116:117], v12 offset:39232
    ds_read_b64 v[118:119], v12 offset:39264
    ds_read_b64 v[120:121], v12 offset:41536
    ds_read_b64 v[122:123], v12 offset:41568
    ds_read_b64 v[124:125], v12 offset:43840
    ds_read_b64 v[126:127], v12 offset:43872
    v_mfma_f32_16x16x32_bf16 v[16:19], v[96:99], v[80:83], v[16:19]
    v_mfma_f32_16x16x32_bf16 v[20:23], v[100:103], v[80:83], v[20:23]
    v_mfma_f32_16x16x32_bf16 v[24:27], v[104:107], v[80:83], v[24:27]
    v_mfma_f32_16x16x32_bf16 v[28:31], v[108:111], v[80:83], v[28:31]
    v_mfma_f32_16x16x32_bf16 v[32:35], v[96:99], v[84:87], v[32:35]
    v_mfma_f32_16x16x32_bf16 v[36:39], v[100:103], v[84:87], v[36:39]
    v_mfma_f32_16x16x32_bf16 v[40:43], v[104:107], v[84:87], v[40:43]
    v_mfma_f32_16x16x32_bf16 v[44:47], v[108:111], v[84:87], v[44:47]
    v_mfma_f32_16x16x32_bf16 v[48:51], v[96:99], v[88:91], v[48:51]
    v_mfma_f32_16x16x32_bf16 v[52:55], v[100:103], v[88:91], v[52:55]
    v_mfma_f32_16x16x32_bf16 v[56:59], v[104:107], v[88:91], v[56:59]
    v_mfma_f32_16x16x32_bf16 v[60:63], v[108:111], v[88:91], v[60:63]
    v_mfma_f32_16x16x32_bf16 v[64:67], v[96:99], v[92:95], v[64:67]
    v_mfma_f32_16x16x32_bf16 v[68:71], v[100:103], v[92:95], v[68:71]
    v_mfma_f32_16x16x32_bf16 v[72:75], v[104:107], v[92:95], v[72:75]
    v_mfma_f32_16x16x32_bf16 v[76:79], v[108:111], v[92:95], v[76:79]
    s_waitcnt lgkmcnt(0)
    v_mfma_f32_16x16x32_bf16 v[16:19], v[128:131], v[112:115], v[16:19]
    v_mfma_f32_16x16x32_bf16 v[20:23], v[132:135], v[112:115], v[20:23]
    v_mfma_f32_16x16x32_bf16 v[24:27], v[136:139], v[112:115], v[24:27]
    v_mfma_f32_16x16x32_bf16 v[28:31], v[140:143], v[112:115], v[28:31]
    v_mfma_f32_16x16x32_bf16 v[32:35], v[128:131], v[116:119], v[32:35]
    v_mfma_f32_16x16x32_bf16 v[36:39], v[132:135], v[116:119], v[36:39]
    v_mfma_f32_16x16x32_bf16 v[40:43], v[136:139], v[116:119], v[40:43]
    v_mfma_f32_16x16x32_bf16 v[44:47], v[140:143], v[116:119], v[44:47]
    v_mfma_f32_16x16x32_bf16 v[48:51], v[128:131], v[120:123], v[48:51]
    v_mfma_f32_16x16x32_bf16 v[52:55], v[132:135], v[120:123], v[52:55]
    v_mfma_f32_16x16x32_bf16 v[56:59], v[136:139], v[120:123], v[56:59]
    v_mfma_f32_16x16x32_bf16 v[60:63], v[140:143], v[120:123], v[60:63]
    v_mfma_f32_16x16x32_bf16 v[64:67], v[128:131], v[124:127], v[64:67]
    v_mfma_f32_16x16x32_bf16 v[68:71], v[132:135], v[124:127], v[68:71]
    v_mfma_f32_16x16x32_bf16 v[72:75], v[136:139], v[124:127], v[72:75]
    v_mfma_f32_16x16x32_bf16 v[76:79], v[140:143], v[124:127], v[76:79]
    s_waitcnt vmcnt(8)
    ds_write_b128 v8, v[144:147] offset:0
    ds_write_b128 v8, v[148:151] offset:4608
    ds_write_b128 v8, v[152:155] offset:9216
    ds_write_b128 v8, v[156:159] offset:13824
    ds_write_b128 v11, v[160:163] offset:0
    ds_write_b128 v11, v[164:167] offset:4608
    ds_write_b128 v11, v[168:171] offset:9216
    ds_write_b128 v11, v[172:175] offset:13824
    s_waitcnt lgkmcnt(0)
    s_barrier
    ds_read_b64_tr_b16 v[96:97], v13 offset:0
    ds_read_b64_tr_b16 v[98:99], v13 offset:4608
    ds_read_b64_tr_b16 v[100:101], v13 offset:32
    ds_read_b64_tr_b16 v[102:103], v13 offset:4640
    ds_read_b64_tr_b16 v[104:105], v13 offset:64
    ds_read_b64_tr_b16 v[106:107], v13 offset:4672
    ds_read_b64_tr_b16 v[108:109], v13 offset:96
    ds_read_b64_tr_b16 v[110:111], v13 offset:4704
    ds_read_b64 v[80:81], v12 offset:0
    ds_read_b64 v[82:83], v12 offset:32
    ds_read_b64 v[84:85], v12 offset:2304
    ds_read_b64 v[86:87], v12 offset:2336
    ds_read_b64 v[88:89], v12 offset:4608
    ds_read_b64 v[90:91], v12 offset:4640
    ds_read_b64 v[92:93], v12 offset:6912
    ds_read_b64 v[94:95], v12 offset:6944
    s_waitcnt lgkmcnt(0)
    ds_read_b64_tr_b16 v[128:129], v13 offset:9216
    ds_read_b64_tr_b16 v[130:131], v13 offset:13824
    ds_read_b64_tr_b16 v[132:133], v13 offset:9248
    ds_read_b64_tr_b16 v[134:135], v13 offset:13856
    ds_read_b64_tr_b16 v[136:137], v13 offset:9280
    ds_read_b64_tr_b16 v[138:139], v13 offset:13888
    ds_read_b64_tr_b16 v[140:141], v13 offset:9312
    ds_read_b64_tr_b16 v[142:143], v13 offset:13920
    ds_read_b64 v[112:113], v12 offset:64
    ds_read_b64 v[114:115], v12 offset:96
    ds_read_b64 v[116:117], v12 offset:2368
    ds_read_b64 v[118:119], v12 offset:2400
    ds_read_b64 v[120:121], v12 offset:4672
    ds_read_b64 v[122:123], v12 offset:4704
    ds_read_b64 v[124:125], v12 offset:6976
    ds_read_b64 v[126:127], v12 offset:7008
    v_mfma_f32_16x16x32_bf16 v[16:19], v[96:99], v[80:83], v[16:19]
    v_mfma_f32_16x16x32_bf16 v[20:23], v[100:103], v[80:83], v[20:23]
    v_mfma_f32_16x16x32_bf16 v[24:27], v[104:107], v[80:83], v[24:27]
    v_mfma_f32_16x16x32_bf16 v[28:31], v[108:111], v[80:83], v[28:31]
    v_mfma_f32_16x16x32_bf16 v[32:35], v[96:99], v[84:87], v[32:35]
    v_mfma_f32_16x16x32_bf16 v[36:39], v[100:103], v[84:87], v[36:39]
    v_mfma_f32_16x16x32_bf16 v[40:43], v[104:107], v[84:87], v[40:43]
    v_mfma_f32_16x16x32_bf16 v[44:47], v[108:111], v[84:87], v[44:47]
    v_mfma_f32_16x16x32_bf16 v[48:51], v[96:99], v[88:91], v[48:51]
    v_mfma_f32_16x16x32_bf16 v[52:55], v[100:103], v[88:91], v[52:55]
    v_mfma_f32_16x16x32_bf16 v[56:59], v[104:107], v[88:91], v[56:59]
    v_mfma_f32_16x16x32_bf16 v[60:63], v[108:111], v[88:91], v[60:63]
    v_mfma_f32_16x16x32_bf16 v[64:67], v[96:99], v[92:95], v[64:67]
    v_mfma_f32_16x16x32_bf16 v[68:71], v[100:103], v[92:95], v[68:71]
    v_mfma_f32_16x16x32_bf16 v[72:75], v[104:107], v[92:95], v[72:75]
    v_mfma_f32_16x16x32_bf16 v[76:79], v[108:111], v[92:95], v[76:79]
    s_waitcnt lgkmcnt(0)
    v_mfma_f32_16x16x32_bf16 v[16:19], v[128:131], v[112:115], v[16:19]
    v_mfma_f32_16x16x32_bf16 v[20:23], v[132:135], v[112:115], v[20:23]
    v_mfma_f32_16x16x32_bf16 v[24:27], v[136:139], v[112:115], v[24:27]
    v_mfma_f32_16x16x32_bf16 v[28:31], v[140:143], v[112:115], v[28:31]
    v_mfma_f32_16x16x32_bf16 v[32:35], v[128:131], v[116:119], v[32:35]
    v_mfma_f32_16x16x32_bf16 v[36:39], v[132:135], v[116:119], v[36:39]
    v_mfma_f32_16x16x32_bf16 v[40:43], v[136:139], v[116:119], v[40:43]
    v_mfma_f32_16x16x32_bf16 v[44:47], v[140:143], v[116:119], v[44:47]
    v_mfma_f32_16x16x32_bf16 v[48:51], v[128:131], v[120:123], v[48:51]
    v_mfma_f32_16x16x32_bf16 v[52:55], v[132:135], v[120:123], v[52:55]
    v_mfma_f32_16x16x32_bf16 v[56:59], v[136:139], v[120:123], v[56:59]
    v_mfma_f32_16x16x32_bf16 v[60:63], v[140:143], v[120:123], v[60:63]
    v_mfma_f32_16x16x32_bf16 v[64:67], v[128:131], v[124:127], v[64:67]
    v_mfma_f32_16x16x32_bf16 v[68:71], v[132:135], v[124:127], v[68:71]
    v_mfma_f32_16x16x32_bf16 v[72:75], v[136:139], v[124:127], v[72:75]
    v_mfma_f32_16x16x32_bf16 v[76:79], v[140:143], v[124:127], v[76:79]
    s_waitcnt vmcnt(0)
    ds_write_b128 v8, v[176:179] offset:36864
    ds_write_b128 v8, v[180:183] offset:41472
    ds_write_b128 v8, v[184:187] offset:46080
    ds_write_b128 v8, v[188:191] offset:50688
    ds_write_b128 v11, v[192:195] offset:36864
    ds_write_b128 v11, v[196:199] offset:41472
    ds_write_b128 v11, v[200:203] offset:46080
    ds_write_b128 v11, v[204:207] offset:50688
    s_waitcnt lgkmcnt(0)
    s_barrier
    ds_read_b64_tr_b16 v[96:97], v13 offset:36864
    ds_read_b64_tr_b16 v[98:99], v13 offset:41472
    ds_read_b64_tr_b16 v[100:101], v13 offset:36896
    ds_read_b64_tr_b16 v[102:103], v13 offset:41504
    ds_read_b64_tr_b16 v[104:105], v13 offset:36928
    ds_read_b64_tr_b16 v[106:107], v13 offset:41536
    ds_read_b64_tr_b16 v[108:109], v13 offset:36960
    ds_read_b64_tr_b16 v[110:111], v13 offset:41568
    ds_read_b64 v[80:81], v12 offset:36864
    ds_read_b64 v[82:83], v12 offset:36896
    ds_read_b64 v[84:85], v12 offset:39168
    ds_read_b64 v[86:87], v12 offset:39200
    ds_read_b64 v[88:89], v12 offset:41472
    ds_read_b64 v[90:91], v12 offset:41504
    ds_read_b64 v[92:93], v12 offset:43776
    ds_read_b64 v[94:95], v12 offset:43808
    s_waitcnt lgkmcnt(0)
    ds_read_b64_tr_b16 v[128:129], v13 offset:46080
    ds_read_b64_tr_b16 v[130:131], v13 offset:50688
    ds_read_b64_tr_b16 v[132:133], v13 offset:46112
    ds_read_b64_tr_b16 v[134:135], v13 offset:50720
    ds_read_b64_tr_b16 v[136:137], v13 offset:46144
    ds_read_b64_tr_b16 v[138:139], v13 offset:50752
    ds_read_b64_tr_b16 v[140:141], v13 offset:46176
    ds_read_b64_tr_b16 v[142:143], v13 offset:50784
    ds_read_b64 v[112:113], v12 offset:36928
    ds_read_b64 v[114:115], v12 offset:36960
    ds_read_b64 v[116:117], v12 offset:39232
    ds_read_b64 v[118:119], v12 offset:39264
    ds_read_b64 v[120:121], v12 offset:41536
    ds_read_b64 v[122:123], v12 offset:41568
    ds_read_b64 v[124:125], v12 offset:43840
    ds_read_b64 v[126:127], v12 offset:43872
    v_mfma_f32_16x16x32_bf16 v[16:19], v[96:99], v[80:83], v[16:19]
    v_mfma_f32_16x16x32_bf16 v[20:23], v[100:103], v[80:83], v[20:23]
    v_mfma_f32_16x16x32_bf16 v[24:27], v[104:107], v[80:83], v[24:27]
    v_mfma_f32_16x16x32_bf16 v[28:31], v[108:111], v[80:83], v[28:31]
    v_mfma_f32_16x16x32_bf16 v[32:35], v[96:99], v[84:87], v[32:35]
    v_mfma_f32_16x16x32_bf16 v[36:39], v[100:103], v[84:87], v[36:39]
    v_mfma_f32_16x16x32_bf16 v[40:43], v[104:107], v[84:87], v[40:43]
    v_mfma_f32_16x16x32_bf16 v[44:47], v[108:111], v[84:87], v[44:47]
    v_mfma_f32_16x16x32_bf16 v[48:51], v[96:99], v[88:91], v[48:51]
    v_mfma_f32_16x16x32_bf16 v[52:55], v[100:103], v[88:91], v[52:55]
    v_mfma_f32_16x16x32_bf16 v[56:59], v[104:107], v[88:91], v[56:59]
    v_mfma_f32_16x16x32_bf16 v[60:63], v[108:111], v[88:91], v[60:63]
    v_mfma_f32_16x16x32_bf16 v[64:67], v[96:99], v[92:95], v[64:67]
    v_mfma_f32_16x16x32_bf16 v[68:71], v[100:103], v[92:95], v[68:71]
    v_mfma_f32_16x16x32_bf16 v[72:75], v[104:107], v[92:95], v[72:75]
    v_mfma_f32_16x16x32_bf16 v[76:79], v[108:111], v[92:95], v[76:79]
    s_waitcnt lgkmcnt(0)
    v_mfma_f32_16x16x32_bf16 v[16:19], v[128:131], v[112:115], v[16:19]
    v_mfma_f32_16x16x32_bf16 v[20:23], v[132:135], v[112:115], v[20:23]
    v_mfma_f32_16x16x32_bf16 v[24:27], v[136:139], v[112:115], v[24:27]
    v_mfma_f32_16x16x32_bf16 v[28:31], v[140:143], v[112:115], v[28:31]
    v_mfma_f32_16x16x32_bf16 v[32:35], v[128:131], v[116:119], v[32:35]
    v_mfma_f32_16x16x32_bf16 v[36:39], v[132:135], v[116:119], v[36:39]
    v_mfma_f32_16x16x32_bf16 v[40:43], v[136:139], v[116:119], v[40:43]
    v_mfma_f32_16x16x32_bf16 v[44:47], v[140:143], v[116:119], v[44:47]
    v_mfma_f32_16x16x32_bf16 v[48:51], v[128:131], v[120:123], v[48:51]
    v_mfma_f32_16x16x32_bf16 v[52:55], v[132:135], v[120:123], v[52:55]
    v_mfma_f32_16x16x32_bf16 v[56:59], v[136:139], v[120:123], v[56:59]
    v_mfma_f32_16x16x32_bf16 v[60:63], v[140:143], v[120:123], v[60:63]
    v_mfma_f32_16x16x32_bf16 v[64:67], v[128:131], v[124:127], v[64:67]
    v_mfma_f32_16x16x32_bf16 v[68:71], v[132:135], v[124:127], v[68:71]
    v_mfma_f32_16x16x32_bf16 v[72:75], v[136:139], v[124:127], v[72:75]
    v_mfma_f32_16x16x32_bf16 v[76:79], v[140:143], v[124:127], v[76:79]
    s_nop 7
    s_nop 7
    s_mul_i32 s7, s4, 128
    s_mul_i32 s12, s10, 64
    s_add_u32 s7, s7, s12
    v_add_u32 v5, s7, v3
    v_mul_u32_u24 v5, 3840, v5
    s_lshl_b32 s12, s5, 8
    s_lshl_b32 s13, s11, 7
    s_add_u32 s12, s12, s13
    v_lshl_add_u32 v5, v4, 3, v5
    v_add_u32 v5, s12, v5
    v_cvt_pk_bf16_f32 v154, v16, v17
    v_cvt_pk_bf16_f32 v155, v18, v19
    buffer_store_dwordx2 v[154:155], v5, s[52:55], 0 offen offset:0
    s_nop 1
    v_cvt_pk_bf16_f32 v154, v20, v21
    v_cvt_pk_bf16_f32 v155, v22, v23
    buffer_store_dwordx2 v[154:155], v5, s[52:55], 0 offen offset:32
    s_nop 1
    v_cvt_pk_bf16_f32 v154, v24, v25
    v_cvt_pk_bf16_f32 v155, v26, v27
    buffer_store_dwordx2 v[154:155], v5, s[52:55], 0 offen offset:64
    s_nop 1
    v_cvt_pk_bf16_f32 v154, v28, v29
    v_cvt_pk_bf16_f32 v155, v30, v31
    buffer_store_dwordx2 v[154:155], v5, s[52:55], 0 offen offset:96
    s_nop 1
    v_add_u32 v5, 61440, v5
    v_cvt_pk_bf16_f32 v154, v32, v33
    v_cvt_pk_bf16_f32 v155, v34, v35
    buffer_store_dwordx2 v[154:155], v5, s[52:55], 0 offen offset:0
    s_nop 1
    v_cvt_pk_bf16_f32 v154, v36, v37
    v_cvt_pk_bf16_f32 v155, v38, v39
    buffer_store_dwordx2 v[154:155], v5, s[52:55], 0 offen offset:32
    s_nop 1
    v_cvt_pk_bf16_f32 v154, v40, v41
    v_cvt_pk_bf16_f32 v155, v42, v43
    buffer_store_dwordx2 v[154:155], v5, s[52:55], 0 offen offset:64
    s_nop 1
    v_cvt_pk_bf16_f32 v154, v44, v45
    v_cvt_pk_bf16_f32 v155, v46, v47
    buffer_store_dwordx2 v[154:155], v5, s[52:55], 0 offen offset:96
    s_nop 1
    v_add_u32 v5, 61440, v5
    v_cvt_pk_bf16_f32 v154, v48, v49
    v_cvt_pk_bf16_f32 v155, v50, v51
    buffer_store_dwordx2 v[154:155], v5, s[52:55], 0 offen offset:0
    s_nop 1
    v_cvt_pk_bf16_f32 v154, v52, v53
    v_cvt_pk_bf16_f32 v155, v54, v55
    buffer_store_dwordx2 v[154:155], v5, s[52:55], 0 offen offset:32
    s_nop 1
    v_cvt_pk_bf16_f32 v154, v56, v57
    v_cvt_pk_bf16_f32 v155, v58, v59
    buffer_store_dwordx2 v[154:155], v5, s[52:55], 0 offen offset:64
    s_nop 1
    v_cvt_pk_bf16_f32 v154, v60, v61
    v_cvt_pk_bf16_f32 v155, v62, v63
    buffer_store_dwordx2 v[154:155], v5, s[52:55], 0 offen offset:96
    s_nop 1
    v_add_u32 v5, 61440, v5
    v_cvt_pk_bf16_f32 v154, v64, v65
    v_cvt_pk_bf16_f32 v155, v66, v67
    buffer_store_dwordx2 v[154:155], v5, s[52:55], 0 offen offset:0
    s_nop 1
    v_cvt_pk_bf16_f32 v154, v68, v69
    v_cvt_pk_bf16_f32 v155, v70, v71
    buffer_store_dwordx2 v[154:155], v5, s[52:55], 0 offen offset:32
    s_nop 1
    v_cvt_pk_bf16_f32 v154, v72, v73
    v_cvt_pk_bf16_f32 v155, v74, v75
    buffer_store_dwordx2 v[154:155], v5, s[52:55], 0 offen offset:64
    s_nop 1
    v_cvt_pk_bf16_f32 v154, v76, v77
    v_cvt_pk_bf16_f32 v155, v78, v79
    buffer_store_dwordx2 v[154:155], v5, s[52:55], 0 offen offset:96
    s_nop 1
qkv_0_kernel_end:
    s_endpgm
.globl kv_0_kernel
.p2align 8
.type kv_0_kernel,@function
kv_0_kernel:
    s_cmp_ge_u32 s2, 256
    s_cbranch_scc1 kv_0_kernel_end
    s_load_dwordx16 s[16:31], s[0:1], 0
    s_load_dwordx4 s[32:35], s[0:1], 64
    s_load_dwordx2 s[36:37], s[0:1], 80
    s_waitcnt lgkmcnt(0)
    s_and_b32 s4, s2, 31
    s_lshr_b32 s5, s2, 5
    s_mov_b32 s48, s20
    s_mov_b32 s49, s21
    s_mov_b32 s50, 0x6400
    s_mov_b32 s51, 0x00020000
    s_mul_i32 s7, s4, 800
    v_lshlrev_b32 v40, 2, v0
    v_cmp_gt_u32 vcc, 200, v0
    s_and_saveexec_b64 s[8:9], vcc
    buffer_load_dword v41, v40, s[48:51], s7 offen
    s_waitcnt vmcnt(0)
    v_lshlrev_b32 v42, 16, v41
    v_and_b32 v43, 0xffff0000, v41
    v_lshlrev_b32 v40, 3, v0
    ds_write_b64 v40, v[42:43] offset:0
    s_mov_b64 exec, s[8:9]
    s_add_u32 s40, s36, 0x400000
    s_addc_u32 s41, s37, 0
    s_mov_b32 s42, 0x780000
    s_mov_b32 s43, 0x00020000
    s_add_u32 s44, s36, 0xc00000
    s_addc_u32 s45, s37, 0
    s_mov_b32 s46, 0x180000
    s_mov_b32 s47, 0x00020000
    s_lshl_b32 s6, s5, 8
    v_add_u32 v1, s6, v0
    v_mul_u32_u24 v1, 3840, v1
    s_mul_i32 s7, s4, 40
    s_add_u32 s7, s7, 1280
    v_add_u32 v1, s7, v1
    buffer_load_dwordx2 v[44:45], v1, s[40:43], 0 offen offset:0
    buffer_load_dwordx2 v[46:47], v1, s[40:43], 0 offen offset:8
    buffer_load_dwordx2 v[48:49], v1, s[40:43], 0 offen offset:16
    buffer_load_dwordx2 v[50:51], v1, s[40:43], 0 offen offset:24
    buffer_load_dwordx2 v[52:53], v1, s[40:43], 0 offen offset:32
    buffer_load_dwordx2 v[54:55], v1, s[40:43], 0 offen offset:1280
    buffer_load_dwordx2 v[56:57], v1, s[40:43], 0 offen offset:1288
    buffer_load_dwordx2 v[58:59], v1, s[40:43], 0 offen offset:1296
    buffer_load_dwordx2 v[60:61], v1, s[40:43], 0 offen offset:1304
    buffer_load_dwordx2 v[62:63], v1, s[40:43], 0 offen offset:1312
    s_waitcnt vmcnt(0) lgkmcnt(0)
    s_barrier
    v_lshlrev_b32 v64, 16, v44
    v_and_b32 v65, 0xffff0000, v44
    v_lshlrev_b32 v66, 16, v45
    v_and_b32 v67, 0xffff0000, v45
    v_lshlrev_b32 v68, 16, v46
    v_and_b32 v69, 0xffff0000, v46
    v_lshlrev_b32 v70, 16, v47
    v_and_b32 v71, 0xffff0000, v47
    v_lshlrev_b32 v72, 16, v48
    v_and_b32 v73, 0xffff0000, v48
    v_lshlrev_b32 v74, 16, v49
    v_and_b32 v75, 0xffff0000, v49
    v_lshlrev_b32 v76, 16, v50
    v_and_b32 v77, 0xffff0000, v50
    v_lshlrev_b32 v78, 16, v51
    v_and_b32 v79, 0xffff0000, v51
    v_lshlrev_b32 v80, 16, v52
    v_and_b32 v81, 0xffff0000, v52
    v_lshlrev_b32 v82, 16, v53
    v_and_b32 v83, 0xffff0000, v53
    v_mov_b32 v2, 0
    v_mov_b32 v84, 0
    v_mov_b32 v85, 0
    v_mov_b32 v86, 0
    v_mov_b32 v87, 0
    v_mov_b32 v88, 0
    v_mov_b32 v89, 0
    v_mov_b32 v90, 0
    v_mov_b32 v91, 0
    v_mov_b32 v92, 0
    v_mov_b32 v93, 0
    v_mov_b32 v94, 0
    v_mov_b32 v95, 0
    v_mov_b32 v96, 0
    v_mov_b32 v97, 0
    v_mov_b32 v98, 0
    v_mov_b32 v99, 0
    v_mov_b32 v100, 0
    v_mov_b32 v101, 0
    v_mov_b32 v102, 0
    v_mov_b32 v103, 0
    ds_read_b128 v[128:131], v2 offset:0
    ds_read_b128 v[132:135], v2 offset:16
    ds_read_b128 v[136:139], v2 offset:32
    ds_read_b128 v[140:143], v2 offset:48
    ds_read_b128 v[144:147], v2 offset:64
    ds_read_b128 v[148:151], v2 offset:80
    ds_read_b128 v[152:155], v2 offset:96
    ds_read_b128 v[156:159], v2 offset:112
    ds_read_b128 v[160:163], v2 offset:128
    ds_read_b128 v[164:167], v2 offset:144
    s_waitcnt lgkmcnt(5)
    v_pk_fma_f32 v[84:85], v[64:65], v[128:129], v[84:85] op_sel:[0,0,0] op_sel_hi:[0,1,1]
    v_pk_fma_f32 v[86:87], v[64:65], v[130:131], v[86:87] op_sel:[0,0,0] op_sel_hi:[0,1,1]
    v_pk_fma_f32 v[88:89], v[64:65], v[132:133], v[88:89] op_sel:[0,0,0] op_sel_hi:[0,1,1]
    v_pk_fma_f32 v[90:91], v[64:65], v[134:135], v[90:91] op_sel:[0,0,0] op_sel_hi:[0,1,1]
    v_pk_fma_f32 v[92:93], v[64:65], v[136:137], v[92:93] op_sel:[0,0,0] op_sel_hi:[0,1,1]
    v_pk_fma_f32 v[94:95], v[64:65], v[138:139], v[94:95] op_sel:[0,0,0] op_sel_hi:[0,1,1]
    v_pk_fma_f32 v[96:97], v[64:65], v[140:141], v[96:97] op_sel:[0,0,0] op_sel_hi:[0,1,1]
    v_pk_fma_f32 v[98:99], v[64:65], v[142:143], v[98:99] op_sel:[0,0,0] op_sel_hi:[0,1,1]
    v_pk_fma_f32 v[100:101], v[64:65], v[144:145], v[100:101] op_sel:[0,0,0] op_sel_hi:[0,1,1]
    v_pk_fma_f32 v[102:103], v[64:65], v[146:147], v[102:103] op_sel:[0,0,0] op_sel_hi:[0,1,1]
    ds_read_b128 v[128:131], v2 offset:160
    ds_read_b128 v[132:135], v2 offset:176
    ds_read_b128 v[136:139], v2 offset:192
    ds_read_b128 v[140:143], v2 offset:208
    ds_read_b128 v[144:147], v2 offset:224
    s_waitcnt lgkmcnt(5)
    v_pk_fma_f32 v[84:85], v[64:65], v[148:149], v[84:85] op_sel:[1,0,0] op_sel_hi:[1,1,1]
    v_pk_fma_f32 v[86:87], v[64:65], v[150:151], v[86:87] op_sel:[1,0,0] op_sel_hi:[1,1,1]
    v_pk_fma_f32 v[88:89], v[64:65], v[152:153], v[88:89] op_sel:[1,0,0] op_sel_hi:[1,1,1]
    v_pk_fma_f32 v[90:91], v[64:65], v[154:155], v[90:91] op_sel:[1,0,0] op_sel_hi:[1,1,1]
    v_pk_fma_f32 v[92:93], v[64:65], v[156:157], v[92:93] op_sel:[1,0,0] op_sel_hi:[1,1,1]
    v_pk_fma_f32 v[94:95], v[64:65], v[158:159], v[94:95] op_sel:[1,0,0] op_sel_hi:[1,1,1]
    v_pk_fma_f32 v[96:97], v[64:65], v[160:161], v[96:97] op_sel:[1,0,0] op_sel_hi:[1,1,1]
    v_pk_fma_f32 v[98:99], v[64:65], v[162:163], v[98:99] op_sel:[1,0,0] op_sel_hi:[1,1,1]
    v_pk_fma_f32 v[100:101], v[64:65], v[164:165], v[100:101] op_sel:[1,0,0] op_sel_hi:[1,1,1]
    v_pk_fma_f32 v[102:103], v[64:65], v[166:167], v[102:103] op_sel:[1,0,0] op_sel_hi:[1,1,1]
    ds_read_b128 v[148:151], v2 offset:240
    ds_read_b128 v[152:155], v2 offset:256
    ds_read_b128 v[156:159], v2 offset:272
    ds_read_b128 v[160:163], v2 offset:288
    ds_read_b128 v[164:167], v2 offset:304
    s_waitcnt lgkmcnt(5)
    v_pk_fma_f32 v[84:85], v[66:67], v[128:129], v[84:85] op_sel:[0,0,0] op_sel_hi:[0,1,1]
    v_pk_fma_f32 v[86:87], v[66:67], v[130:131], v[86:87] op_sel:[0,0,0] op_sel_hi:[0,1,1]
    v_pk_fma_f32 v[88:89], v[66:67], v[132:133], v[88:89] op_sel:[0,0,0] op_sel_hi:[0,1,1]
    v_pk_fma_f32 v[90:91], v[66:67], v[134:135], v[90:91] op_sel:[0,0,0] op_sel_hi:[0,1,1]
    v_pk_fma_f32 v[92:93], v[66:67], v[136:137], v[92:93] op_sel:[0,0,0] op_sel_hi:[0,1,1]
    v_pk_fma_f32 v[94:95], v[66:67], v[138:139], v[94:95] op_sel:[0,0,0] op_sel_hi:[0,1,1]
    v_pk_fma_f32 v[96:97], v[66:67], v[140:141], v[96:97] op_sel:[0,0,0] op_sel_hi:[0,1,1]
    v_pk_fma_f32 v[98:99], v[66:67], v[142:143], v[98:99] op_sel:[0,0,0] op_sel_hi:[0,1,1]
    v_pk_fma_f32 v[100:101], v[66:67], v[144:145], v[100:101] op_sel:[0,0,0] op_sel_hi:[0,1,1]
    v_pk_fma_f32 v[102:103], v[66:67], v[146:147], v[102:103] op_sel:[0,0,0] op_sel_hi:[0,1,1]
    ds_read_b128 v[128:131], v2 offset:320
    ds_read_b128 v[132:135], v2 offset:336
    ds_read_b128 v[136:139], v2 offset:352
    ds_read_b128 v[140:143], v2 offset:368
    ds_read_b128 v[144:147], v2 offset:384
    s_waitcnt lgkmcnt(5)
    v_pk_fma_f32 v[84:85], v[66:67], v[148:149], v[84:85] op_sel:[1,0,0] op_sel_hi:[1,1,1]
    v_pk_fma_f32 v[86:87], v[66:67], v[150:151], v[86:87] op_sel:[1,0,0] op_sel_hi:[1,1,1]
    v_pk_fma_f32 v[88:89], v[66:67], v[152:153], v[88:89] op_sel:[1,0,0] op_sel_hi:[1,1,1]
    v_pk_fma_f32 v[90:91], v[66:67], v[154:155], v[90:91] op_sel:[1,0,0] op_sel_hi:[1,1,1]
    v_pk_fma_f32 v[92:93], v[66:67], v[156:157], v[92:93] op_sel:[1,0,0] op_sel_hi:[1,1,1]
    v_pk_fma_f32 v[94:95], v[66:67], v[158:159], v[94:95] op_sel:[1,0,0] op_sel_hi:[1,1,1]
    v_pk_fma_f32 v[96:97], v[66:67], v[160:161], v[96:97] op_sel:[1,0,0] op_sel_hi:[1,1,1]
    v_pk_fma_f32 v[98:99], v[66:67], v[162:163], v[98:99] op_sel:[1,0,0] op_sel_hi:[1,1,1]
    v_pk_fma_f32 v[100:101], v[66:67], v[164:165], v[100:101] op_sel:[1,0,0] op_sel_hi:[1,1,1]
    v_pk_fma_f32 v[102:103], v[66:67], v[166:167], v[102:103] op_sel:[1,0,0] op_sel_hi:[1,1,1]
    ds_read_b128 v[148:151], v2 offset:400
    ds_read_b128 v[152:155], v2 offset:416
    ds_read_b128 v[156:159], v2 offset:432
    ds_read_b128 v[160:163], v2 offset:448
    ds_read_b128 v[164:167], v2 offset:464
    s_waitcnt lgkmcnt(5)
    v_pk_fma_f32 v[84:85], v[68:69], v[128:129], v[84:85] op_sel:[0,0,0] op_sel_hi:[0,1,1]
    v_pk_fma_f32 v[86:87], v[68:69], v[130:131], v[86:87] op_sel:[0,0,0] op_sel_hi:[0,1,1]
    v_pk_fma_f32 v[88:89], v[68:69], v[132:133], v[88:89] op_sel:[0,0,0] op_sel_hi:[0,1,1]
    v_pk_fma_f32 v[90:91], v[68:69], v[134:135], v[90:91] op_sel:[0,0,0] op_sel_hi:[0,1,1]
    v_pk_fma_f32 v[92:93], v[68:69], v[136:137], v[92:93] op_sel:[0,0,0] op_sel_hi:[0,1,1]
    v_pk_fma_f32 v[94:95], v[68:69], v[138:139], v[94:95] op_sel:[0,0,0] op_sel_hi:[0,1,1]
    v_pk_fma_f32 v[96:97], v[68:69], v[140:141], v[96:97] op_sel:[0,0,0] op_sel_hi:[0,1,1]
    v_pk_fma_f32 v[98:99], v[68:69], v[142:143], v[98:99] op_sel:[0,0,0] op_sel_hi:[0,1,1]
    v_pk_fma_f32 v[100:101], v[68:69], v[144:145], v[100:101] op_sel:[0,0,0] op_sel_hi:[0,1,1]
    v_pk_fma_f32 v[102:103], v[68:69], v[146:147], v[102:103] op_sel:[0,0,0] op_sel_hi:[0,1,1]
    ds_read_b128 v[128:131], v2 offset:480
    ds_read_b128 v[132:135], v2 offset:496
    ds_read_b128 v[136:139], v2 offset:512
    ds_read_b128 v[140:143], v2 offset:528
    ds_read_b128 v[144:147], v2 offset:544
    s_waitcnt lgkmcnt(5)
    v_pk_fma_f32 v[84:85], v[68:69], v[148:149], v[84:85] op_sel:[1,0,0] op_sel_hi:[1,1,1]
    v_pk_fma_f32 v[86:87], v[68:69], v[150:151], v[86:87] op_sel:[1,0,0] op_sel_hi:[1,1,1]
    v_pk_fma_f32 v[88:89], v[68:69], v[152:153], v[88:89] op_sel:[1,0,0] op_sel_hi:[1,1,1]
    v_pk_fma_f32 v[90:91], v[68:69], v[154:155], v[90:91] op_sel:[1,0,0] op_sel_hi:[1,1,1]
    v_pk_fma_f32 v[92:93], v[68:69], v[156:157], v[92:93] op_sel:[1,0,0] op_sel_hi:[1,1,1]
    v_pk_fma_f32 v[94:95], v[68:69], v[158:159], v[94:95] op_sel:[1,0,0] op_sel_hi:[1,1,1]
    v_pk_fma_f32 v[96:97], v[68:69], v[160:161], v[96:97] op_sel:[1,0,0] op_sel_hi:[1,1,1]
    v_pk_fma_f32 v[98:99], v[68:69], v[162:163], v[98:99] op_sel:[1,0,0] op_sel_hi:[1,1,1]
    v_pk_fma_f32 v[100:101], v[68:69], v[164:165], v[100:101] op_sel:[1,0,0] op_sel_hi:[1,1,1]
    v_pk_fma_f32 v[102:103], v[68:69], v[166:167], v[102:103] op_sel:[1,0,0] op_sel_hi:[1,1,1]
    ds_read_b128 v[148:151], v2 offset:560
    ds_read_b128 v[152:155], v2 offset:576
    ds_read_b128 v[156:159], v2 offset:592
    ds_read_b128 v[160:163], v2 offset:608
    ds_read_b128 v[164:167], v2 offset:624
    s_waitcnt lgkmcnt(5)
    v_pk_fma_f32 v[84:85], v[70:71], v[128:129], v[84:85] op_sel:[0,0,0] op_sel_hi:[0,1,1]
    v_pk_fma_f32 v[86:87], v[70:71], v[130:131], v[86:87] op_sel:[0,0,0] op_sel_hi:[0,1,1]
    v_pk_fma_f32 v[88:89], v[70:71], v[132:133], v[88:89] op_sel:[0,0,0] op_sel_hi:[0,1,1]
    v_pk_fma_f32 v[90:91], v[70:71], v[134:135], v[90:91] op_sel:[0,0,0] op_sel_hi:[0,1,1]
    v_pk_fma_f32 v[92:93], v[70:71], v[136:137], v[92:93] op_sel:[0,0,0] op_sel_hi:[0,1,1]
    v_pk_fma_f32 v[94:95], v[70:71], v[138:139], v[94:95] op_sel:[0,0,0] op_sel_hi:[0,1,1]
    v_pk_fma_f32 v[96:97], v[70:71], v[140:141], v[96:97] op_sel:[0,0,0] op_sel_hi:[0,1,1]
    v_pk_fma_f32 v[98:99], v[70:71], v[142:143], v[98:99] op_sel:[0,0,0] op_sel_hi:[0,1,1]
    v_pk_fma_f32 v[100:101], v[70:71], v[144:145], v[100:101] op_sel:[0,0,0] op_sel_hi:[0,1,1]
    v_pk_fma_f32 v[102:103], v[70:71], v[146:147], v[102:103] op_sel:[0,0,0] op_sel_hi:[0,1,1]
    ds_read_b128 v[128:131], v2 offset:640
    ds_read_b128 v[132:135], v2 offset:656
    ds_read_b128 v[136:139], v2 offset:672
    ds_read_b128 v[140:143], v2 offset:688
    ds_read_b128 v[144:147], v2 offset:704
    s_waitcnt lgkmcnt(5)
    v_pk_fma_f32 v[84:85], v[70:71], v[148:149], v[84:85] op_sel:[1,0,0] op_sel_hi:[1,1,1]
    v_pk_fma_f32 v[86:87], v[70:71], v[150:151], v[86:87] op_sel:[1,0,0] op_sel_hi:[1,1,1]
    v_pk_fma_f32 v[88:89], v[70:71], v[152:153], v[88:89] op_sel:[1,0,0] op_sel_hi:[1,1,1]
    v_pk_fma_f32 v[90:91], v[70:71], v[154:155], v[90:91] op_sel:[1,0,0] op_sel_hi:[1,1,1]
    v_pk_fma_f32 v[92:93], v[70:71], v[156:157], v[92:93] op_sel:[1,0,0] op_sel_hi:[1,1,1]
    v_pk_fma_f32 v[94:95], v[70:71], v[158:159], v[94:95] op_sel:[1,0,0] op_sel_hi:[1,1,1]
    v_pk_fma_f32 v[96:97], v[70:71], v[160:161], v[96:97] op_sel:[1,0,0] op_sel_hi:[1,1,1]
    v_pk_fma_f32 v[98:99], v[70:71], v[162:163], v[98:99] op_sel:[1,0,0] op_sel_hi:[1,1,1]
    v_pk_fma_f32 v[100:101], v[70:71], v[164:165], v[100:101] op_sel:[1,0,0] op_sel_hi:[1,1,1]
    v_pk_fma_f32 v[102:103], v[70:71], v[166:167], v[102:103] op_sel:[1,0,0] op_sel_hi:[1,1,1]
    ds_read_b128 v[148:151], v2 offset:720
    ds_read_b128 v[152:155], v2 offset:736
    ds_read_b128 v[156:159], v2 offset:752
    ds_read_b128 v[160:163], v2 offset:768
    ds_read_b128 v[164:167], v2 offset:784
    s_waitcnt lgkmcnt(5)
    v_pk_fma_f32 v[84:85], v[72:73], v[128:129], v[84:85] op_sel:[0,0,0] op_sel_hi:[0,1,1]
    v_pk_fma_f32 v[86:87], v[72:73], v[130:131], v[86:87] op_sel:[0,0,0] op_sel_hi:[0,1,1]
    v_pk_fma_f32 v[88:89], v[72:73], v[132:133], v[88:89] op_sel:[0,0,0] op_sel_hi:[0,1,1]
    v_pk_fma_f32 v[90:91], v[72:73], v[134:135], v[90:91] op_sel:[0,0,0] op_sel_hi:[0,1,1]
    v_pk_fma_f32 v[92:93], v[72:73], v[136:137], v[92:93] op_sel:[0,0,0] op_sel_hi:[0,1,1]
    v_pk_fma_f32 v[94:95], v[72:73], v[138:139], v[94:95] op_sel:[0,0,0] op_sel_hi:[0,1,1]
    v_pk_fma_f32 v[96:97], v[72:73], v[140:141], v[96:97] op_sel:[0,0,0] op_sel_hi:[0,1,1]
    v_pk_fma_f32 v[98:99], v[72:73], v[142:143], v[98:99] op_sel:[0,0,0] op_sel_hi:[0,1,1]
    v_pk_fma_f32 v[100:101], v[72:73], v[144:145], v[100:101] op_sel:[0,0,0] op_sel_hi:[0,1,1]
    v_pk_fma_f32 v[102:103], v[72:73], v[146:147], v[102:103] op_sel:[0,0,0] op_sel_hi:[0,1,1]
    ds_read_b128 v[128:131], v2 offset:800
    ds_read_b128 v[132:135], v2 offset:816
    ds_read_b128 v[136:139], v2 offset:832
    ds_read_b128 v[140:143], v2 offset:848
    ds_read_b128 v[144:147], v2 offset:864
    s_waitcnt lgkmcnt(5)
    v_pk_fma_f32 v[84:85], v[72:73], v[148:149], v[84:85] op_sel:[1,0,0] op_sel_hi:[1,1,1]
    v_pk_fma_f32 v[86:87], v[72:73], v[150:151], v[86:87] op_sel:[1,0,0] op_sel_hi:[1,1,1]
    v_pk_fma_f32 v[88:89], v[72:73], v[152:153], v[88:89] op_sel:[1,0,0] op_sel_hi:[1,1,1]
    v_pk_fma_f32 v[90:91], v[72:73], v[154:155], v[90:91] op_sel:[1,0,0] op_sel_hi:[1,1,1]
    v_pk_fma_f32 v[92:93], v[72:73], v[156:157], v[92:93] op_sel:[1,0,0] op_sel_hi:[1,1,1]
    v_pk_fma_f32 v[94:95], v[72:73], v[158:159], v[94:95] op_sel:[1,0,0] op_sel_hi:[1,1,1]
    v_pk_fma_f32 v[96:97], v[72:73], v[160:161], v[96:97] op_sel:[1,0,0] op_sel_hi:[1,1,1]
    v_pk_fma_f32 v[98:99], v[72:73], v[162:163], v[98:99] op_sel:[1,0,0] op_sel_hi:[1,1,1]
    v_pk_fma_f32 v[100:101], v[72:73], v[164:165], v[100:101] op_sel:[1,0,0] op_sel_hi:[1,1,1]
    v_pk_fma_f32 v[102:103], v[72:73], v[166:167], v[102:103] op_sel:[1,0,0] op_sel_hi:[1,1,1]
    ds_read_b128 v[148:151], v2 offset:880
    ds_read_b128 v[152:155], v2 offset:896
    ds_read_b128 v[156:159], v2 offset:912
    ds_read_b128 v[160:163], v2 offset:928
    ds_read_b128 v[164:167], v2 offset:944
    s_waitcnt lgkmcnt(5)
    v_pk_fma_f32 v[84:85], v[74:75], v[128:129], v[84:85] op_sel:[0,0,0] op_sel_hi:[0,1,1]
    v_pk_fma_f32 v[86:87], v[74:75], v[130:131], v[86:87] op_sel:[0,0,0] op_sel_hi:[0,1,1]
    v_pk_fma_f32 v[88:89], v[74:75], v[132:133], v[88:89] op_sel:[0,0,0] op_sel_hi:[0,1,1]
    v_pk_fma_f32 v[90:91], v[74:75], v[134:135], v[90:91] op_sel:[0,0,0] op_sel_hi:[0,1,1]
    v_pk_fma_f32 v[92:93], v[74:75], v[136:137], v[92:93] op_sel:[0,0,0] op_sel_hi:[0,1,1]
    v_pk_fma_f32 v[94:95], v[74:75], v[138:139], v[94:95] op_sel:[0,0,0] op_sel_hi:[0,1,1]
    v_pk_fma_f32 v[96:97], v[74:75], v[140:141], v[96:97] op_sel:[0,0,0] op_sel_hi:[0,1,1]
    v_pk_fma_f32 v[98:99], v[74:75], v[142:143], v[98:99] op_sel:[0,0,0] op_sel_hi:[0,1,1]
    v_pk_fma_f32 v[100:101], v[74:75], v[144:145], v[100:101] op_sel:[0,0,0] op_sel_hi:[0,1,1]
    v_pk_fma_f32 v[102:103], v[74:75], v[146:147], v[102:103] op_sel:[0,0,0] op_sel_hi:[0,1,1]
    ds_read_b128 v[128:131], v2 offset:960
    ds_read_b128 v[132:135], v2 offset:976
    ds_read_b128 v[136:139], v2 offset:992
    ds_read_b128 v[140:143], v2 offset:1008
    ds_read_b128 v[144:147], v2 offset:1024
    s_waitcnt lgkmcnt(5)
    v_pk_fma_f32 v[84:85], v[74:75], v[148:149], v[84:85] op_sel:[1,0,0] op_sel_hi:[1,1,1]
    v_pk_fma_f32 v[86:87], v[74:75], v[150:151], v[86:87] op_sel:[1,0,0] op_sel_hi:[1,1,1]
    v_pk_fma_f32 v[88:89], v[74:75], v[152:153], v[88:89] op_sel:[1,0,0] op_sel_hi:[1,1,1]
    v_pk_fma_f32 v[90:91], v[74:75], v[154:155], v[90:91] op_sel:[1,0,0] op_sel_hi:[1,1,1]
    v_pk_fma_f32 v[92:93], v[74:75], v[156:157], v[92:93] op_sel:[1,0,0] op_sel_hi:[1,1,1]
    v_pk_fma_f32 v[94:95], v[74:75], v[158:159], v[94:95] op_sel:[1,0,0] op_sel_hi:[1,1,1]
    v_pk_fma_f32 v[96:97], v[74:75], v[160:161], v[96:97] op_sel:[1,0,0] op_sel_hi:[1,1,1]
    v_pk_fma_f32 v[98:99], v[74:75], v[162:163], v[98:99] op_sel:[1,0,0] op_sel_hi:[1,1,1]
    v_pk_fma_f32 v[100:101], v[74:75], v[164:165], v[100:101] op_sel:[1,0,0] op_sel_hi:[1,1,1]
    v_pk_fma_f32 v[102:103], v[74:75], v[166:167], v[102:103] op_sel:[1,0,0] op_sel_hi:[1,1,1]
    ds_read_b128 v[148:151], v2 offset:1040
    ds_read_b128 v[152:155], v2 offset:1056
    ds_read_b128 v[156:159], v2 offset:1072
    ds_read_b128 v[160:163], v2 offset:1088
    ds_read_b128 v[164:167], v2 offset:1104
    s_waitcnt lgkmcnt(5)
    v_pk_fma_f32 v[84:85], v[76:77], v[128:129], v[84:85] op_sel:[0,0,0] op_sel_hi:[0,1,1]
    v_pk_fma_f32 v[86:87], v[76:77], v[130:131], v[86:87] op_sel:[0,0,0] op_sel_hi:[0,1,1]
    v_pk_fma_f32 v[88:89], v[76:77], v[132:133], v[88:89] op_sel:[0,0,0] op_sel_hi:[0,1,1]
    v_pk_fma_f32 v[90:91], v[76:77], v[134:135], v[90:91] op_sel:[0,0,0] op_sel_hi:[0,1,1]
    v_pk_fma_f32 v[92:93], v[76:77], v[136:137], v[92:93] op_sel:[0,0,0] op_sel_hi:[0,1,1]
    v_pk_fma_f32 v[94:95], v[76:77], v[138:139], v[94:95] op_sel:[0,0,0] op_sel_hi:[0,1,1]
    v_pk_fma_f32 v[96:97], v[76:77], v[140:141], v[96:97] op_sel:[0,0,0] op_sel_hi:[0,1,1]
    v_pk_fma_f32 v[98:99], v[76:77], v[142:143], v[98:99] op_sel:[0,0,0] op_sel_hi:[0,1,1]
    v_pk_fma_f32 v[100:101], v[76:77], v[144:145], v[100:101] op_sel:[0,0,0] op_sel_hi:[0,1,1]
    v_pk_fma_f32 v[102:103], v[76:77], v[146:147], v[102:103] op_sel:[0,0,0] op_sel_hi:[0,1,1]
    ds_read_b128 v[128:131], v2 offset:1120
    ds_read_b128 v[132:135], v2 offset:1136
    ds_read_b128 v[136:139], v2 offset:1152
    ds_read_b128 v[140:143], v2 offset:1168
    ds_read_b128 v[144:147], v2 offset:1184
    s_waitcnt lgkmcnt(5)
    v_pk_fma_f32 v[84:85], v[76:77], v[148:149], v[84:85] op_sel:[1,0,0] op_sel_hi:[1,1,1]
    v_pk_fma_f32 v[86:87], v[76:77], v[150:151], v[86:87] op_sel:[1,0,0] op_sel_hi:[1,1,1]
    v_pk_fma_f32 v[88:89], v[76:77], v[152:153], v[88:89] op_sel:[1,0,0] op_sel_hi:[1,1,1]
    v_pk_fma_f32 v[90:91], v[76:77], v[154:155], v[90:91] op_sel:[1,0,0] op_sel_hi:[1,1,1]
    v_pk_fma_f32 v[92:93], v[76:77], v[156:157], v[92:93] op_sel:[1,0,0] op_sel_hi:[1,1,1]
    v_pk_fma_f32 v[94:95], v[76:77], v[158:159], v[94:95] op_sel:[1,0,0] op_sel_hi:[1,1,1]
    v_pk_fma_f32 v[96:97], v[76:77], v[160:161], v[96:97] op_sel:[1,0,0] op_sel_hi:[1,1,1]
    v_pk_fma_f32 v[98:99], v[76:77], v[162:163], v[98:99] op_sel:[1,0,0] op_sel_hi:[1,1,1]
    v_pk_fma_f32 v[100:101], v[76:77], v[164:165], v[100:101] op_sel:[1,0,0] op_sel_hi:[1,1,1]
    v_pk_fma_f32 v[102:103], v[76:77], v[166:167], v[102:103] op_sel:[1,0,0] op_sel_hi:[1,1,1]
    ds_read_b128 v[148:151], v2 offset:1200
    ds_read_b128 v[152:155], v2 offset:1216
    ds_read_b128 v[156:159], v2 offset:1232
    ds_read_b128 v[160:163], v2 offset:1248
    ds_read_b128 v[164:167], v2 offset:1264
    s_waitcnt lgkmcnt(5)
    v_pk_fma_f32 v[84:85], v[78:79], v[128:129], v[84:85] op_sel:[0,0,0] op_sel_hi:[0,1,1]
    v_pk_fma_f32 v[86:87], v[78:79], v[130:131], v[86:87] op_sel:[0,0,0] op_sel_hi:[0,1,1]
    v_pk_fma_f32 v[88:89], v[78:79], v[132:133], v[88:89] op_sel:[0,0,0] op_sel_hi:[0,1,1]
    v_pk_fma_f32 v[90:91], v[78:79], v[134:135], v[90:91] op_sel:[0,0,0] op_sel_hi:[0,1,1]
    v_pk_fma_f32 v[92:93], v[78:79], v[136:137], v[92:93] op_sel:[0,0,0] op_sel_hi:[0,1,1]
    v_pk_fma_f32 v[94:95], v[78:79], v[138:139], v[94:95] op_sel:[0,0,0] op_sel_hi:[0,1,1]
    v_pk_fma_f32 v[96:97], v[78:79], v[140:141], v[96:97] op_sel:[0,0,0] op_sel_hi:[0,1,1]
    v_pk_fma_f32 v[98:99], v[78:79], v[142:143], v[98:99] op_sel:[0,0,0] op_sel_hi:[0,1,1]
    v_pk_fma_f32 v[100:101], v[78:79], v[144:145], v[100:101] op_sel:[0,0,0] op_sel_hi:[0,1,1]
    v_pk_fma_f32 v[102:103], v[78:79], v[146:147], v[102:103] op_sel:[0,0,0] op_sel_hi:[0,1,1]
    ds_read_b128 v[128:131], v2 offset:1280
    ds_read_b128 v[132:135], v2 offset:1296
    ds_read_b128 v[136:139], v2 offset:1312
    ds_read_b128 v[140:143], v2 offset:1328
    ds_read_b128 v[144:147], v2 offset:1344
    s_waitcnt lgkmcnt(5)
    v_pk_fma_f32 v[84:85], v[78:79], v[148:149], v[84:85] op_sel:[1,0,0] op_sel_hi:[1,1,1]
    v_pk_fma_f32 v[86:87], v[78:79], v[150:151], v[86:87] op_sel:[1,0,0] op_sel_hi:[1,1,1]
    v_pk_fma_f32 v[88:89], v[78:79], v[152:153], v[88:89] op_sel:[1,0,0] op_sel_hi:[1,1,1]
    v_pk_fma_f32 v[90:91], v[78:79], v[154:155], v[90:91] op_sel:[1,0,0] op_sel_hi:[1,1,1]
    v_pk_fma_f32 v[92:93], v[78:79], v[156:157], v[92:93] op_sel:[1,0,0] op_sel_hi:[1,1,1]
    v_pk_fma_f32 v[94:95], v[78:79], v[158:159], v[94:95] op_sel:[1,0,0] op_sel_hi:[1,1,1]
    v_pk_fma_f32 v[96:97], v[78:79], v[160:161], v[96:97] op_sel:[1,0,0] op_sel_hi:[1,1,1]
    v_pk_fma_f32 v[98:99], v[78:79], v[162:163], v[98:99] op_sel:[1,0,0] op_sel_hi:[1,1,1]
    v_pk_fma_f32 v[100:101], v[78:79], v[164:165], v[100:101] op_sel:[1,0,0] op_sel_hi:[1,1,1]
    v_pk_fma_f32 v[102:103], v[78:79], v[166:167], v[102:103] op_sel:[1,0,0] op_sel_hi:[1,1,1]
    ds_read_b128 v[148:151], v2 offset:1360
    ds_read_b128 v[152:155], v2 offset:1376
    ds_read_b128 v[156:159], v2 offset:1392
    ds_read_b128 v[160:163], v2 offset:1408
    ds_read_b128 v[164:167], v2 offset:1424
    s_waitcnt lgkmcnt(5)
    v_pk_fma_f32 v[84:85], v[80:81], v[128:129], v[84:85] op_sel:[0,0,0] op_sel_hi:[0,1,1]
    v_pk_fma_f32 v[86:87], v[80:81], v[130:131], v[86:87] op_sel:[0,0,0] op_sel_hi:[0,1,1]
    v_pk_fma_f32 v[88:89], v[80:81], v[132:133], v[88:89] op_sel:[0,0,0] op_sel_hi:[0,1,1]
    v_pk_fma_f32 v[90:91], v[80:81], v[134:135], v[90:91] op_sel:[0,0,0] op_sel_hi:[0,1,1]
    v_pk_fma_f32 v[92:93], v[80:81], v[136:137], v[92:93] op_sel:[0,0,0] op_sel_hi:[0,1,1]
    v_pk_fma_f32 v[94:95], v[80:81], v[138:139], v[94:95] op_sel:[0,0,0] op_sel_hi:[0,1,1]
    v_pk_fma_f32 v[96:97], v[80:81], v[140:141], v[96:97] op_sel:[0,0,0] op_sel_hi:[0,1,1]
    v_pk_fma_f32 v[98:99], v[80:81], v[142:143], v[98:99] op_sel:[0,0,0] op_sel_hi:[0,1,1]
    v_pk_fma_f32 v[100:101], v[80:81], v[144:145], v[100:101] op_sel:[0,0,0] op_sel_hi:[0,1,1]
    v_pk_fma_f32 v[102:103], v[80:81], v[146:147], v[102:103] op_sel:[0,0,0] op_sel_hi:[0,1,1]
    ds_read_b128 v[128:131], v2 offset:1440
    ds_read_b128 v[132:135], v2 offset:1456
    ds_read_b128 v[136:139], v2 offset:1472
    ds_read_b128 v[140:143], v2 offset:1488
    ds_read_b128 v[144:147], v2 offset:1504
    s_waitcnt lgkmcnt(5)
    v_pk_fma_f32 v[84:85], v[80:81], v[148:149], v[84:85] op_sel:[1,0,0] op_sel_hi:[1,1,1]
    v_pk_fma_f32 v[86:87], v[80:81], v[150:151], v[86:87] op_sel:[1,0,0] op_sel_hi:[1,1,1]
    v_pk_fma_f32 v[88:89], v[80:81], v[152:153], v[88:89] op_sel:[1,0,0] op_sel_hi:[1,1,1]
    v_pk_fma_f32 v[90:91], v[80:81], v[154:155], v[90:91] op_sel:[1,0,0] op_sel_hi:[1,1,1]
    v_pk_fma_f32 v[92:93], v[80:81], v[156:157], v[92:93] op_sel:[1,0,0] op_sel_hi:[1,1,1]
    v_pk_fma_f32 v[94:95], v[80:81], v[158:159], v[94:95] op_sel:[1,0,0] op_sel_hi:[1,1,1]
    v_pk_fma_f32 v[96:97], v[80:81], v[160:161], v[96:97] op_sel:[1,0,0] op_sel_hi:[1,1,1]
    v_pk_fma_f32 v[98:99], v[80:81], v[162:163], v[98:99] op_sel:[1,0,0] op_sel_hi:[1,1,1]
    v_pk_fma_f32 v[100:101], v[80:81], v[164:165], v[100:101] op_sel:[1,0,0] op_sel_hi:[1,1,1]
    v_pk_fma_f32 v[102:103], v[80:81], v[166:167], v[102:103] op_sel:[1,0,0] op_sel_hi:[1,1,1]
    ds_read_b128 v[148:151], v2 offset:1520
    ds_read_b128 v[152:155], v2 offset:1536
    ds_read_b128 v[156:159], v2 offset:1552
    ds_read_b128 v[160:163], v2 offset:1568
    ds_read_b128 v[164:167], v2 offset:1584
    s_waitcnt lgkmcnt(5)
    v_pk_fma_f32 v[84:85], v[82:83], v[128:129], v[84:85] op_sel:[0,0,0] op_sel_hi:[0,1,1]
    v_pk_fma_f32 v[86:87], v[82:83], v[130:131], v[86:87] op_sel:[0,0,0] op_sel_hi:[0,1,1]
    v_pk_fma_f32 v[88:89], v[82:83], v[132:133], v[88:89] op_sel:[0,0,0] op_sel_hi:[0,1,1]
    v_pk_fma_f32 v[90:91], v[82:83], v[134:135], v[90:91] op_sel:[0,0,0] op_sel_hi:[0,1,1]
    v_pk_fma_f32 v[92:93], v[82:83], v[136:137], v[92:93] op_sel:[0,0,0] op_sel_hi:[0,1,1]
    v_pk_fma_f32 v[94:95], v[82:83], v[138:139], v[94:95] op_sel:[0,0,0] op_sel_hi:[0,1,1]
    v_pk_fma_f32 v[96:97], v[82:83], v[140:141], v[96:97] op_sel:[0,0,0] op_sel_hi:[0,1,1]
    v_pk_fma_f32 v[98:99], v[82:83], v[142:143], v[98:99] op_sel:[0,0,0] op_sel_hi:[0,1,1]
    v_pk_fma_f32 v[100:101], v[82:83], v[144:145], v[100:101] op_sel:[0,0,0] op_sel_hi:[0,1,1]
    v_pk_fma_f32 v[102:103], v[82:83], v[146:147], v[102:103] op_sel:[0,0,0] op_sel_hi:[0,1,1]
    s_waitcnt lgkmcnt(0)
    v_pk_fma_f32 v[84:85], v[82:83], v[148:149], v[84:85] op_sel:[1,0,0] op_sel_hi:[1,1,1]
    v_pk_fma_f32 v[86:87], v[82:83], v[150:151], v[86:87] op_sel:[1,0,0] op_sel_hi:[1,1,1]
    v_pk_fma_f32 v[88:89], v[82:83], v[152:153], v[88:89] op_sel:[1,0,0] op_sel_hi:[1,1,1]
    v_pk_fma_f32 v[90:91], v[82:83], v[154:155], v[90:91] op_sel:[1,0,0] op_sel_hi:[1,1,1]
    v_pk_fma_f32 v[92:93], v[82:83], v[156:157], v[92:93] op_sel:[1,0,0] op_sel_hi:[1,1,1]
    v_pk_fma_f32 v[94:95], v[82:83], v[158:159], v[94:95] op_sel:[1,0,0] op_sel_hi:[1,1,1]
    v_pk_fma_f32 v[96:97], v[82:83], v[160:161], v[96:97] op_sel:[1,0,0] op_sel_hi:[1,1,1]
    v_pk_fma_f32 v[98:99], v[82:83], v[162:163], v[98:99] op_sel:[1,0,0] op_sel_hi:[1,1,1]
    v_pk_fma_f32 v[100:101], v[82:83], v[164:165], v[100:101] op_sel:[1,0,0] op_sel_hi:[1,1,1]
    v_pk_fma_f32 v[102:103], v[82:83], v[166:167], v[102:103] op_sel:[1,0,0] op_sel_hi:[1,1,1]
    v_cvt_pk_bf16_f32 v124, v84, v85
    v_lshlrev_b32 v84, 16, v124
    v_and_b32 v85, 0xffff0000, v124
    v_cvt_pk_bf16_f32 v124, v86, v87
    v_lshlrev_b32 v86, 16, v124
    v_and_b32 v87, 0xffff0000, v124
    v_cvt_pk_bf16_f32 v124, v88, v89
    v_lshlrev_b32 v88, 16, v124
    v_and_b32 v89, 0xffff0000, v124
    v_cvt_pk_bf16_f32 v124, v90, v91
    v_lshlrev_b32 v90, 16, v124
    v_and_b32 v91, 0xffff0000, v124
    v_cvt_pk_bf16_f32 v124, v92, v93
    v_lshlrev_b32 v92, 16, v124
    v_and_b32 v93, 0xffff0000, v124
    v_cvt_pk_bf16_f32 v124, v94, v95
    v_lshlrev_b32 v94, 16, v124
    v_and_b32 v95, 0xffff0000, v124
    v_cvt_pk_bf16_f32 v124, v96, v97
    v_lshlrev_b32 v96, 16, v124
    v_and_b32 v97, 0xffff0000, v124
    v_cvt_pk_bf16_f32 v124, v98, v99
    v_lshlrev_b32 v98, 16, v124
    v_and_b32 v99, 0xffff0000, v124
    v_cvt_pk_bf16_f32 v124, v100, v101
    v_lshlrev_b32 v100, 16, v124
    v_and_b32 v101, 0xffff0000, v124
    v_cvt_pk_bf16_f32 v124, v102, v103
    v_lshlrev_b32 v102, 16, v124
    v_and_b32 v103, 0xffff0000, v124
    v_max_f32 v124, v84, v85
    v_min_f32 v125, v84, v85
    v_max_f32 v124, v124, v86
    v_min_f32 v125, v125, v86
    v_max_f32 v124, v124, v87
    v_min_f32 v125, v125, v87
    v_max_f32 v124, v124, v88
    v_min_f32 v125, v125, v88
    v_max_f32 v124, v124, v89
    v_min_f32 v125, v125, v89
    v_max_f32 v124, v124, v90
    v_min_f32 v125, v125, v90
    v_max_f32 v124, v124, v91
    v_min_f32 v125, v125, v91
    v_max_f32 v124, v124, v92
    v_min_f32 v125, v125, v92
    v_max_f32 v124, v124, v93
    v_min_f32 v125, v125, v93
    v_max_f32 v124, v124, v94
    v_min_f32 v125, v125, v94
    v_max_f32 v124, v124, v95
    v_min_f32 v125, v125, v95
    v_max_f32 v124, v124, v96
    v_min_f32 v125, v125, v96
    v_max_f32 v124, v124, v97
    v_min_f32 v125, v125, v97
    v_max_f32 v124, v124, v98
    v_min_f32 v125, v125, v98
    v_max_f32 v124, v124, v99
    v_min_f32 v125, v125, v99
    v_max_f32 v124, v124, v100
    v_min_f32 v125, v125, v100
    v_max_f32 v124, v124, v101
    v_min_f32 v125, v125, v101
    v_max_f32 v124, v124, v102
    v_min_f32 v125, v125, v102
    v_max_f32 v124, v124, v103
    v_min_f32 v125, v125, v103
    v_sub_f32 v104, v125, v84
    v_mul_f32 v104, 0x3fb8aa3b, v104
    v_exp_f32 v104, v104
    v_sub_f32 v84, v84, v124
    v_mul_f32 v84, 0x3fb8aa3b, v84
    v_exp_f32 v84, v84
    v_sub_f32 v105, v125, v85
    v_mul_f32 v105, 0x3fb8aa3b, v105
    v_exp_f32 v105, v105
    v_sub_f32 v85, v85, v124
    v_mul_f32 v85, 0x3fb8aa3b, v85
    v_exp_f32 v85, v85
    v_sub_f32 v106, v125, v86
    v_mul_f32 v106, 0x3fb8aa3b, v106
    v_exp_f32 v106, v106
    v_sub_f32 v86, v86, v124
    v_mul_f32 v86, 0x3fb8aa3b, v86
    v_exp_f32 v86, v86
    v_sub_f32 v107, v125, v87
    v_mul_f32 v107, 0x3fb8aa3b, v107
    v_exp_f32 v107, v107
    v_sub_f32 v87, v87, v124
    v_mul_f32 v87, 0x3fb8aa3b, v87
    v_exp_f32 v87, v87
    v_sub_f32 v108, v125, v88
    v_mul_f32 v108, 0x3fb8aa3b, v108
    v_exp_f32 v108, v108
    v_sub_f32 v88, v88, v124
    v_mul_f32 v88, 0x3fb8aa3b, v88
    v_exp_f32 v88, v88
    v_sub_f32 v109, v125, v89
    v_mul_f32 v109, 0x3fb8aa3b, v109
    v_exp_f32 v109, v109
    v_sub_f32 v89, v89, v124
    v_mul_f32 v89, 0x3fb8aa3b, v89
    v_exp_f32 v89, v89
    v_sub_f32 v110, v125, v90
    v_mul_f32 v110, 0x3fb8aa3b, v110
    v_exp_f32 v110, v110
    v_sub_f32 v90, v90, v124
    v_mul_f32 v90, 0x3fb8aa3b, v90
    v_exp_f32 v90, v90
    v_sub_f32 v111, v125, v91
    v_mul_f32 v111, 0x3fb8aa3b, v111
    v_exp_f32 v111, v111
    v_sub_f32 v91, v91, v124
    v_mul_f32 v91, 0x3fb8aa3b, v91
    v_exp_f32 v91, v91
    v_sub_f32 v112, v125, v92
    v_mul_f32 v112, 0x3fb8aa3b, v112
    v_exp_f32 v112, v112
    v_sub_f32 v92, v92, v124
    v_mul_f32 v92, 0x3fb8aa3b, v92
    v_exp_f32 v92, v92
    v_sub_f32 v113, v125, v93
    v_mul_f32 v113, 0x3fb8aa3b, v113
    v_exp_f32 v113, v113
    v_sub_f32 v93, v93, v124
    v_mul_f32 v93, 0x3fb8aa3b, v93
    v_exp_f32 v93, v93
    v_sub_f32 v114, v125, v94
    v_mul_f32 v114, 0x3fb8aa3b, v114
    v_exp_f32 v114, v114
    v_sub_f32 v94, v94, v124
    v_mul_f32 v94, 0x3fb8aa3b, v94
    v_exp_f32 v94, v94
    v_sub_f32 v115, v125, v95
    v_mul_f32 v115, 0x3fb8aa3b, v115
    v_exp_f32 v115, v115
    v_sub_f32 v95, v95, v124
    v_mul_f32 v95, 0x3fb8aa3b, v95
    v_exp_f32 v95, v95
    v_sub_f32 v116, v125, v96
    v_mul_f32 v116, 0x3fb8aa3b, v116
    v_exp_f32 v116, v116
    v_sub_f32 v96, v96, v124
    v_mul_f32 v96, 0x3fb8aa3b, v96
    v_exp_f32 v96, v96
    v_sub_f32 v117, v125, v97
    v_mul_f32 v117, 0x3fb8aa3b, v117
    v_exp_f32 v117, v117
    v_sub_f32 v97, v97, v124
    v_mul_f32 v97, 0x3fb8aa3b, v97
    v_exp_f32 v97, v97
    v_sub_f32 v118, v125, v98
    v_mul_f32 v118, 0x3fb8aa3b, v118
    v_exp_f32 v118, v118
    v_sub_f32 v98, v98, v124
    v_mul_f32 v98, 0x3fb8aa3b, v98
    v_exp_f32 v98, v98
    v_sub_f32 v119, v125, v99
    v_mul_f32 v119, 0x3fb8aa3b, v119
    v_exp_f32 v119, v119
    v_sub_f32 v99, v99, v124
    v_mul_f32 v99, 0x3fb8aa3b, v99
    v_exp_f32 v99, v99
    v_sub_f32 v120, v125, v100
    v_mul_f32 v120, 0x3fb8aa3b, v120
    v_exp_f32 v120, v120
    v_sub_f32 v100, v100, v124
    v_mul_f32 v100, 0x3fb8aa3b, v100
    v_exp_f32 v100, v100
    v_sub_f32 v121, v125, v101
    v_mul_f32 v121, 0x3fb8aa3b, v121
    v_exp_f32 v121, v121
    v_sub_f32 v101, v101, v124
    v_mul_f32 v101, 0x3fb8aa3b, v101
    v_exp_f32 v101, v101
    v_sub_f32 v122, v125, v102
    v_mul_f32 v122, 0x3fb8aa3b, v122
    v_exp_f32 v122, v122
    v_sub_f32 v102, v102, v124
    v_mul_f32 v102, 0x3fb8aa3b, v102
    v_exp_f32 v102, v102
    v_sub_f32 v123, v125, v103
    v_mul_f32 v123, 0x3fb8aa3b, v123
    v_exp_f32 v123, v123
    v_sub_f32 v103, v103, v124
    v_mul_f32 v103, 0x3fb8aa3b, v103
    v_exp_f32 v103, v103
    s_nop 0
    v_add_f32 v126, v84, v85
    v_add_f32 v127, v104, v105
    v_add_f32 v126, v126, v86
    v_add_f32 v127, v127, v106
    v_add_f32 v126, v126, v87
    v_add_f32 v127, v127, v107
    v_add_f32 v126, v126, v88
    v_add_f32 v127, v127, v108
    v_add_f32 v126, v126, v89
    v_add_f32 v127, v127, v109
    v_add_f32 v126, v126, v90
    v_add_f32 v127, v127, v110
    v_add_f32 v126, v126, v91
    v_add_f32 v127, v127, v111
    v_add_f32 v126, v126, v92
    v_add_f32 v127, v127, v112
    v_add_f32 v126, v126, v93
    v_add_f32 v127, v127, v113
    v_add_f32 v126, v126, v94
    v_add_f32 v127, v127, v114
    v_add_f32 v126, v126, v95
    v_add_f32 v127, v127, v115
    v_add_f32 v126, v126, v96
    v_add_f32 v127, v127, v116
    v_add_f32 v126, v126, v97
    v_add_f32 v127, v127, v117
    v_add_f32 v126, v126, v98
    v_add_f32 v127, v127, v118
    v_add_f32 v126, v126, v99
    v_add_f32 v127, v127, v119
    v_add_f32 v126, v126, v100
    v_add_f32 v127, v127, v120
    v_add_f32 v126, v126, v101
    v_add_f32 v127, v127, v121
    v_add_f32 v126, v126, v102
    v_add_f32 v127, v127, v122
    v_add_f32 v126, v126, v103
    v_add_f32 v127, v127, v123
    v_rcp_f32 v126, v126
    v_rcp_f32 v127, v127
    s_nop 0
    v_mul_f32 v84, v84, v126
    v_mul_f32 v104, v104, v127
    v_mul_f32 v85, v85, v126
    v_mul_f32 v105, v105, v127
    v_mul_f32 v86, v86, v126
    v_mul_f32 v106, v106, v127
    v_mul_f32 v87, v87, v126
    v_mul_f32 v107, v107, v127
    v_mul_f32 v88, v88, v126
    v_mul_f32 v108, v108, v127
    v_mul_f32 v89, v89, v126
    v_mul_f32 v109, v109, v127
    v_mul_f32 v90, v90, v126
    v_mul_f32 v110, v110, v127
    v_mul_f32 v91, v91, v126
    v_mul_f32 v111, v111, v127
    v_mul_f32 v92, v92, v126
    v_mul_f32 v112, v112, v127
    v_mul_f32 v93, v93, v126
    v_mul_f32 v113, v113, v127
    v_mul_f32 v94, v94, v126
    v_mul_f32 v114, v114, v127
    v_mul_f32 v95, v95, v126
    v_mul_f32 v115, v115, v127
    v_mul_f32 v96, v96, v126
    v_mul_f32 v116, v116, v127
    v_mul_f32 v97, v97, v126
    v_mul_f32 v117, v117, v127
    v_mul_f32 v98, v98, v126
    v_mul_f32 v118, v118, v127
    v_mul_f32 v99, v99, v126
    v_mul_f32 v119, v119, v127
    v_mul_f32 v100, v100, v126
    v_mul_f32 v120, v120, v127
    v_mul_f32 v101, v101, v126
    v_mul_f32 v121, v121, v127
    v_mul_f32 v102, v102, v126
    v_mul_f32 v122, v122, v127
    v_mul_f32 v103, v103, v126
    v_mul_f32 v123, v123, v127
    v_lshlrev_b32 v3, 1, v0
    v_cvt_pk_bf16_f32 v4, v84, v85
    ds_write_b16 v3, v4 offset:2048
    ds_write_b16_d16_hi v3, v4 offset:2560
    v_cvt_pk_bf16_f32 v4, v86, v87
    ds_write_b16 v3, v4 offset:3072
    ds_write_b16_d16_hi v3, v4 offset:3584
    v_cvt_pk_bf16_f32 v4, v88, v89
    ds_write_b16 v3, v4 offset:4096
    ds_write_b16_d16_hi v3, v4 offset:4608
    v_cvt_pk_bf16_f32 v4, v90, v91
    ds_write_b16 v3, v4 offset:5120
    ds_write_b16_d16_hi v3, v4 offset:5632
    v_cvt_pk_bf16_f32 v4, v92, v93
    ds_write_b16 v3, v4 offset:6144
    ds_write_b16_d16_hi v3, v4 offset:6656
    v_cvt_pk_bf16_f32 v4, v94, v95
    ds_write_b16 v3, v4 offset:7168
    ds_write_b16_d16_hi v3, v4 offset:7680
    v_cvt_pk_bf16_f32 v4, v96, v97
    ds_write_b16 v3, v4 offset:8192
    ds_write_b16_d16_hi v3, v4 offset:8704
    v_cvt_pk_bf16_f32 v4, v98, v99
    ds_write_b16 v3, v4 offset:9216
    ds_write_b16_d16_hi v3, v4 offset:9728
    v_cvt_pk_bf16_f32 v4, v100, v101
    ds_write_b16 v3, v4 offset:10240
    ds_write_b16_d16_hi v3, v4 offset:10752
    v_cvt_pk_bf16_f32 v4, v102, v103
    ds_write_b16 v3, v4 offset:11264
    ds_write_b16_d16_hi v3, v4 offset:11776
    v_cvt_pk_bf16_f32 v4, v104, v105
    ds_write_b16 v3, v4 offset:12288
    ds_write_b16_d16_hi v3, v4 offset:12800
    v_cvt_pk_bf16_f32 v4, v106, v107
    ds_write_b16 v3, v4 offset:13312
    ds_write_b16_d16_hi v3, v4 offset:13824
    v_cvt_pk_bf16_f32 v4, v108, v109
    ds_write_b16 v3, v4 offset:14336
    ds_write_b16_d16_hi v3, v4 offset:14848
    v_cvt_pk_bf16_f32 v4, v110, v111
    ds_write_b16 v3, v4 offset:15360
    ds_write_b16_d16_hi v3, v4 offset:15872
    v_cvt_pk_bf16_f32 v4, v112, v113
    ds_write_b16 v3, v4 offset:16384
    ds_write_b16_d16_hi v3, v4 offset:16896
    v_cvt_pk_bf16_f32 v4, v114, v115
    ds_write_b16 v3, v4 offset:17408
    ds_write_b16_d16_hi v3, v4 offset:17920
    v_cvt_pk_bf16_f32 v4, v116, v117
    ds_write_b16 v3, v4 offset:18432
    ds_write_b16_d16_hi v3, v4 offset:18944
    v_cvt_pk_bf16_f32 v4, v118, v119
    ds_write_b16 v3, v4 offset:19456
    ds_write_b16_d16_hi v3, v4 offset:19968
    v_cvt_pk_bf16_f32 v4, v120, v121
    ds_write_b16 v3, v4 offset:20480
    ds_write_b16_d16_hi v3, v4 offset:20992
    v_cvt_pk_bf16_f32 v4, v122, v123
    ds_write_b16 v3, v4 offset:21504
    ds_write_b16_d16_hi v3, v4 offset:22016
    ds_write_b16 v3, v54 offset:26624
    ds_write_b16_d16_hi v3, v54 offset:27136
    ds_write_b16 v3, v55 offset:27648
    ds_write_b16_d16_hi v3, v55 offset:28160
    ds_write_b16 v3, v56 offset:28672
    ds_write_b16_d16_hi v3, v56 offset:29184
    ds_write_b16 v3, v57 offset:29696
    ds_write_b16_d16_hi v3, v57 offset:30208
    ds_write_b16 v3, v58 offset:30720
    ds_write_b16_d16_hi v3, v58 offset:31232
    ds_write_b16 v3, v59 offset:31744
    ds_write_b16_d16_hi v3, v59 offset:32256
    ds_write_b16 v3, v60 offset:32768
    ds_write_b16_d16_hi v3, v60 offset:33280
    ds_write_b16 v3, v61 offset:33792
    ds_write_b16_d16_hi v3, v61 offset:34304
    ds_write_b16 v3, v62 offset:34816
    ds_write_b16_d16_hi v3, v62 offset:35328
    ds_write_b16 v3, v63 offset:35840
    ds_write_b16_d16_hi v3, v63 offset:36352
    v_mov_b32 v4, 0x3f80
    ds_write_b16 v3, v4 offset:36864
    s_waitcnt lgkmcnt(0)
    s_barrier
    v_cmp_gt_u32 vcc, 64, v0
    s_and_saveexec_b64 s[8:9], vcc
    s_cbranch_execz kv_0_kernel_end
    v_and_b32 v5, 15, v0
    v_lshrrev_b32 v6, 4, v0
    v_lshlrev_b32 v7, 9, v5
    v_lshl_add_u32 v7, v6, 4, v7
    v_mov_b32 v128, 0
    v_mov_b32 v129, 0
    v_mov_b32 v130, 0
    v_mov_b32 v131, 0
    v_mov_b32 v132, 0
    v_mov_b32 v133, 0
    v_mov_b32 v134, 0
    v_mov_b32 v135, 0
    v_mov_b32 v136, 0
    v_mov_b32 v137, 0
    v_mov_b32 v138, 0
    v_mov_b32 v139, 0
    v_mov_b32 v140, 0
    v_mov_b32 v141, 0
    v_mov_b32 v142, 0
    v_mov_b32 v143, 0
    v_mov_b32 v144, 0
    v_mov_b32 v145, 0
    v_mov_b32 v146, 0
    v_mov_b32 v147, 0
    v_mov_b32 v148, 0
    v_mov_b32 v149, 0
    v_mov_b32 v150, 0
    v_mov_b32 v151, 0
    ds_read_b128 v[152:155], v7 offset:2048
    ds_read_b128 v[156:159], v7 offset:10240
    ds_read_b128 v[160:163], v7 offset:18432
    ds_read_b128 v[164:167], v7 offset:26624
    ds_read_b128 v[168:171], v7 offset:34816
    s_waitcnt lgkmcnt(0)
    v_mfma_f32_16x16x32_bf16 v[128:131], v[152:155], v[164:167], v[128:131]
    v_mfma_f32_16x16x32_bf16 v[132:135], v[152:155], v[168:171], v[132:135]
    v_mfma_f32_16x16x32_bf16 v[136:139], v[156:159], v[164:167], v[136:139]
    v_mfma_f32_16x16x32_bf16 v[140:143], v[156:159], v[168:171], v[140:143]
    v_mfma_f32_16x16x32_bf16 v[144:147], v[160:163], v[164:167], v[144:147]
    v_mfma_f32_16x16x32_bf16 v[148:151], v[160:163], v[168:171], v[148:151]
    s_nop 7
    ds_read_b128 v[152:155], v7 offset:2112
    ds_read_b128 v[156:159], v7 offset:10304
    ds_read_b128 v[160:163], v7 offset:18496
    ds_read_b128 v[164:167], v7 offset:26688
    ds_read_b128 v[168:171], v7 offset:34880
    s_waitcnt lgkmcnt(0)
    v_mfma_f32_16x16x32_bf16 v[128:131], v[152:155], v[164:167], v[128:131]
    v_mfma_f32_16x16x32_bf16 v[132:135], v[152:155], v[168:171], v[132:135]
    v_mfma_f32_16x16x32_bf16 v[136:139], v[156:159], v[164:167], v[136:139]
    v_mfma_f32_16x16x32_bf16 v[140:143], v[156:159], v[168:171], v[140:143]
    v_mfma_f32_16x16x32_bf16 v[144:147], v[160:163], v[164:167], v[144:147]
    v_mfma_f32_16x16x32_bf16 v[148:151], v[160:163], v[168:171], v[148:151]
    s_nop 7
    ds_read_b128 v[152:155], v7 offset:2176
    ds_read_b128 v[156:159], v7 offset:10368
    ds_read_b128 v[160:163], v7 offset:18560
    ds_read_b128 v[164:167], v7 offset:26752
    ds_read_b128 v[168:171], v7 offset:34944
    s_waitcnt lgkmcnt(0)
    v_mfma_f32_16x16x32_bf16 v[128:131], v[152:155], v[164:167], v[128:131]
    v_mfma_f32_16x16x32_bf16 v[132:135], v[152:155], v[168:171], v[132:135]
    v_mfma_f32_16x16x32_bf16 v[136:139], v[156:159], v[164:167], v[136:139]
    v_mfma_f32_16x16x32_bf16 v[140:143], v[156:159], v[168:171], v[140:143]
    v_mfma_f32_16x16x32_bf16 v[144:147], v[160:163], v[164:167], v[144:147]
    v_mfma_f32_16x16x32_bf16 v[148:151], v[160:163], v[168:171], v[148:151]
    s_nop 7
    ds_read_b128 v[152:155], v7 offset:2240
    ds_read_b128 v[156:159], v7 offset:10432
    ds_read_b128 v[160:163], v7 offset:18624
    ds_read_b128 v[164:167], v7 offset:26816
    ds_read_b128 v[168:171], v7 offset:35008
    s_waitcnt lgkmcnt(0)
    v_mfma_f32_16x16x32_bf16 v[128:131], v[152:155], v[164:167], v[128:131]
    v_mfma_f32_16x16x32_bf16 v[132:135], v[152:155], v[168:171], v[132:135]
    v_mfma_f32_16x16x32_bf16 v[136:139], v[156:159], v[164:167], v[136:139]
    v_mfma_f32_16x16x32_bf16 v[140:143], v[156:159], v[168:171], v[140:143]
    v_mfma_f32_16x16x32_bf16 v[144:147], v[160:163], v[164:167], v[144:147]
    v_mfma_f32_16x16x32_bf16 v[148:151], v[160:163], v[168:171], v[148:151]
    s_nop 7
    ds_read_b128 v[152:155], v7 offset:2304
    ds_read_b128 v[156:159], v7 offset:10496
    ds_read_b128 v[160:163], v7 offset:18688
    ds_read_b128 v[164:167], v7 offset:26880
    ds_read_b128 v[168:171], v7 offset:35072
    s_waitcnt lgkmcnt(0)
    v_mfma_f32_16x16x32_bf16 v[128:131], v[152:155], v[164:167], v[128:131]
    v_mfma_f32_16x16x32_bf16 v[132:135], v[152:155], v[168:171], v[132:135]
    v_mfma_f32_16x16x32_bf16 v[136:139], v[156:159], v[164:167], v[136:139]
    v_mfma_f32_16x16x32_bf16 v[140:143], v[156:159], v[168:171], v[140:143]
    v_mfma_f32_16x16x32_bf16 v[144:147], v[160:163], v[164:167], v[144:147]
    v_mfma_f32_16x16x32_bf16 v[148:151], v[160:163], v[168:171], v[148:151]
    s_nop 7
    ds_read_b128 v[152:155], v7 offset:2368
    ds_read_b128 v[156:159], v7 offset:10560
    ds_read_b128 v[160:163], v7 offset:18752
    ds_read_b128 v[164:167], v7 offset:26944
    ds_read_b128 v[168:171], v7 offset:35136
    s_waitcnt lgkmcnt(0)
    v_mfma_f32_16x16x32_bf16 v[128:131], v[152:155], v[164:167], v[128:131]
    v_mfma_f32_16x16x32_bf16 v[132:135], v[152:155], v[168:171], v[132:135]
    v_mfma_f32_16x16x32_bf16 v[136:139], v[156:159], v[164:167], v[136:139]
    v_mfma_f32_16x16x32_bf16 v[140:143], v[156:159], v[168:171], v[140:143]
    v_mfma_f32_16x16x32_bf16 v[144:147], v[160:163], v[164:167], v[144:147]
    v_mfma_f32_16x16x32_bf16 v[148:151], v[160:163], v[168:171], v[148:151]
    s_nop 7
    ds_read_b128 v[152:155], v7 offset:2432
    ds_read_b128 v[156:159], v7 offset:10624
    ds_read_b128 v[160:163], v7 offset:18816
    ds_read_b128 v[164:167], v7 offset:27008
    ds_read_b128 v[168:171], v7 offset:35200
    s_waitcnt lgkmcnt(0)
    v_mfma_f32_16x16x32_bf16 v[128:131], v[152:155], v[164:167], v[128:131]
    v_mfma_f32_16x16x32_bf16 v[132:135], v[152:155], v[168:171], v[132:135]
    v_mfma_f32_16x16x32_bf16 v[136:139], v[156:159], v[164:167], v[136:139]
    v_mfma_f32_16x16x32_bf16 v[140:143], v[156:159], v[168:171], v[140:143]
    v_mfma_f32_16x16x32_bf16 v[144:147], v[160:163], v[164:167], v[144:147]
    v_mfma_f32_16x16x32_bf16 v[148:151], v[160:163], v[168:171], v[148:151]
    s_nop 7
    ds_read_b128 v[152:155], v7 offset:2496
    ds_read_b128 v[156:159], v7 offset:10688
    ds_read_b128 v[160:163], v7 offset:18880
    ds_read_b128 v[164:167], v7 offset:27072
    ds_read_b128 v[168:171], v7 offset:35264
    s_waitcnt lgkmcnt(0)
    v_mfma_f32_16x16x32_bf16 v[128:131], v[152:155], v[164:167], v[128:131]
    v_mfma_f32_16x16x32_bf16 v[132:135], v[152:155], v[168:171], v[132:135]
    v_mfma_f32_16x16x32_bf16 v[136:139], v[156:159], v[164:167], v[136:139]
    v_mfma_f32_16x16x32_bf16 v[140:143], v[156:159], v[168:171], v[140:143]
    v_mfma_f32_16x16x32_bf16 v[144:147], v[160:163], v[164:167], v[144:147]
    v_mfma_f32_16x16x32_bf16 v[148:151], v[160:163], v[168:171], v[148:151]
    s_nop 7
    s_nop 7
    s_nop 7
    s_lshl_b32 s6, s2, 0
    s_mul_i32 s6, s2, 6144
    v_lshlrev_b32 v8, 9, v6
    v_lshl_add_u32 v8, v5, 2, v8
    v_add_u32 v8, s6, v8
    buffer_store_dword v128, v8, s[44:47], 0 offen offset:0
    buffer_store_dword v129, v8, s[44:47], 0 offen offset:128
    buffer_store_dword v130, v8, s[44:47], 0 offen offset:256
    buffer_store_dword v131, v8, s[44:47], 0 offen offset:384
    buffer_store_dword v132, v8, s[44:47], 0 offen offset:64
    buffer_store_dword v133, v8, s[44:47], 0 offen offset:192
    buffer_store_dword v134, v8, s[44:47], 0 offen offset:320
    buffer_store_dword v135, v8, s[44:47], 0 offen offset:448
    v_add_u32 v8, 2048, v8
    buffer_store_dword v136, v8, s[44:47], 0 offen offset:0
    buffer_store_dword v137, v8, s[44:47], 0 offen offset:128
    buffer_store_dword v138, v8, s[44:47], 0 offen offset:256
    buffer_store_dword v139, v8, s[44:47], 0 offen offset:384
    buffer_store_dword v140, v8, s[44:47], 0 offen offset:64
    buffer_store_dword v141, v8, s[44:47], 0 offen offset:192
    buffer_store_dword v142, v8, s[44:47], 0 offen offset:320
    buffer_store_dword v143, v8, s[44:47], 0 offen offset:448
    v_add_u32 v8, 2048, v8
    buffer_store_dword v144, v8, s[44:47], 0 offen offset:0
    buffer_store_dword v145, v8, s[44:47], 0 offen offset:128
    buffer_store_dword v146, v8, s[44:47], 0 offen offset:256
    buffer_store_dword v147, v8, s[44:47], 0 offen offset:384
    buffer_store_dword v148, v8, s[44:47], 0 offen offset:64
    buffer_store_dword v149, v8, s[44:47], 0 offen offset:192
    buffer_store_dword v150, v8, s[44:47], 0 offen offset:320
    buffer_store_dword v151, v8, s[44:47], 0 offen offset:448
    v_add_u32 v8, 2048, v8
kv_0_kernel_end:
    s_endpgm
.globl att_0_kernel
.p2align 8
.type att_0_kernel,@function
att_0_kernel:
    s_cmp_ge_u32 s2, 256
    s_cbranch_scc1 att_0_kernel_end
    s_load_dwordx16 s[16:31], s[0:1], 0
    s_load_dwordx4 s[32:35], s[0:1], 64
    s_load_dwordx2 s[36:37], s[0:1], 80
    s_waitcnt lgkmcnt(0)
    s_and_b32 s4, s2, 31
    s_lshr_b32 s5, s2, 5
    s_mov_b32 s48, s20
    s_mov_b32 s49, s21
    s_mov_b32 s50, 0x6400
    s_mov_b32 s51, 0x00020000
    s_mul_i32 s7, s4, 800
    v_lshlrev_b32 v40, 2, v0
    v_cmp_gt_u32 vcc, 200, v0
    s_and_saveexec_b64 s[8:9], vcc
    buffer_load_dword v41, v40, s[48:51], s7 offen
    s_waitcnt vmcnt(0)
    v_lshlrev_b32 v42, 16, v41
    v_and_b32 v43, 0xffff0000, v41
    v_lshlrev_b32 v40, 3, v0
    ds_write_b64 v40, v[42:43] offset:0
    s_mov_b64 exec, s[8:9]
    s_add_u32 s40, s36, 0x400000
    s_addc_u32 s41, s37, 0
    s_mov_b32 s42, 0x780000
    s_mov_b32 s43, 0x00020000
    s_add_u32 s44, s36, 0xc00000
    s_addc_u32 s45, s37, 0
    s_mov_b32 s46, 0x180000
    s_mov_b32 s47, 0x00020000
    s_add_u32 s52, s36, 0x1000000
    s_addc_u32 s53, s37, 0
    s_mov_b32 s54, 0x280000
    s_mov_b32 s55, 0x00020000
    s_lshl_b32 s6, s5, 8
    v_add_u32 v1, s6, v0
    v_mul_u32_u24 v1, 3840, v1
    s_mul_i32 s7, s4, 40
    v_add_u32 v1, s7, v1
    buffer_load_dwordx2 v[44:45], v1, s[40:43], 0 offen offset:0
    buffer_load_dwordx2 v[46:47], v1, s[40:43], 0 offen offset:8
    buffer_load_dwordx2 v[48:49], v1, s[40:43], 0 offen offset:16
    buffer_load_dwordx2 v[50:51], v1, s[40:43], 0 offen offset:24
    buffer_load_dwordx2 v[52:53], v1, s[40:43], 0 offen offset:32
    s_mul_i32 s7, s4, 6144
    v_lshlrev_b32 v2, 2, v0
    v_add_u32 v6, 4096, v2
    v_mov_b32 v54, 0
    v_mov_b32 v55, 0
    v_mov_b32 v56, 0
    v_mov_b32 v57, 0
    v_mov_b32 v58, 0
    buffer_load_dword v60, v2, s[44:47], s7 offen offset:0
    buffer_load_dword v61, v2, s[44:47], s7 offen offset:1024
    buffer_load_dword v62, v2, s[44:47], s7 offen offset:2048
    buffer_load_dword v63, v2, s[44:47], s7 offen offset:3072
    buffer_load_dword v64, v6, s[44:47], s7 offen offset:0
    s_waitcnt vmcnt(0)
    v_add_f32 v54, v54, v60
    v_add_f32 v55, v55, v61
    v_add_f32 v56, v56, v62
    v_add_f32 v57, v57, v63
    v_add_f32 v58, v58, v64
    s_add_u32 s7, s7, 196608
    buffer_load_dword v60, v2, s[44:47], s7 offen offset:0
    buffer_load_dword v61, v2, s[44:47], s7 offen offset:1024
    buffer_load_dword v62, v2, s[44:47], s7 offen offset:2048
    buffer_load_dword v63, v2, s[44:47], s7 offen offset:3072
    buffer_load_dword v64, v6, s[44:47], s7 offen offset:0
    s_waitcnt vmcnt(0)
    v_add_f32 v54, v54, v60
    v_add_f32 v55, v55, v61
    v_add_f32 v56, v56, v62
    v_add_f32 v57, v57, v63
    v_add_f32 v58, v58, v64
    s_add_u32 s7, s7, 196608
    buffer_load_dword v60, v2, s[44:47], s7 offen offset:0
    buffer_load_dword v61, v2, s[44:47], s7 offen offset:1024
    buffer_load_dword v62, v2, s[44:47], s7 offen offset:2048
    buffer_load_dword v63, v2, s[44:47], s7 offen offset:3072
    buffer_load_dword v64, v6, s[44:47], s7 offen offset:0
    s_waitcnt vmcnt(0)
    v_add_f32 v54, v54, v60
    v_add_f32 v55, v55, v61
    v_add_f32 v56, v56, v62
    v_add_f32 v57, v57, v63
    v_add_f32 v58, v58, v64
    s_add_u32 s7, s7, 196608
    buffer_load_dword v60, v2, s[44:47], s7 offen offset:0
    buffer_load_dword v61, v2, s[44:47], s7 offen offset:1024
    buffer_load_dword v62, v2, s[44:47], s7 offen offset:2048
    buffer_load_dword v63, v2, s[44:47], s7 offen offset:3072
    buffer_load_dword v64, v6, s[44:47], s7 offen offset:0
    s_waitcnt vmcnt(0)
    v_add_f32 v54, v54, v60
    v_add_f32 v55, v55, v61
    v_add_f32 v56, v56, v62
    v_add_f32 v57, v57, v63
    v_add_f32 v58, v58, v64
    s_add_u32 s7, s7, 196608
    buffer_load_dword v60, v2, s[44:47], s7 offen offset:0
    buffer_load_dword v61, v2, s[44:47], s7 offen offset:1024
    buffer_load_dword v62, v2, s[44:47], s7 offen offset:2048
    buffer_load_dword v63, v2, s[44:47], s7 offen offset:3072
    buffer_load_dword v64, v6, s[44:47], s7 offen offset:0
    s_waitcnt vmcnt(0)
    v_add_f32 v54, v54, v60
    v_add_f32 v55, v55, v61
    v_add_f32 v56, v56, v62
    v_add_f32 v57, v57, v63
    v_add_f32 v58, v58, v64
    s_add_u32 s7, s7, 196608
    buffer_load_dword v60, v2, s[44:47], s7 offen offset:0
    buffer_load_dword v61, v2, s[44:47], s7 offen offset:1024
    buffer_load_dword v62, v2, s[44:47], s7 offen offset:2048
    buffer_load_dword v63, v2, s[44:47], s7 offen offset:3072
    buffer_load_dword v64, v6, s[44:47], s7 offen offset:0
    s_waitcnt vmcnt(0)
    v_add_f32 v54, v54, v60
    v_add_f32 v55, v55, v61
    v_add_f32 v56, v56, v62
    v_add_f32 v57, v57, v63
    v_add_f32 v58, v58, v64
    s_add_u32 s7, s7, 196608
    buffer_load_dword v60, v2, s[44:47], s7 offen offset:0
    buffer_load_dword v61, v2, s[44:47], s7 offen offset:1024
    buffer_load_dword v62, v2, s[44:47], s7 offen offset:2048
    buffer_load_dword v63, v2, s[44:47], s7 offen offset:3072
    buffer_load_dword v64, v6, s[44:47], s7 offen offset:0
    s_waitcnt vmcnt(0)
    v_add_f32 v54, v54, v60
    v_add_f32 v55, v55, v61
    v_add_f32 v56, v56, v62
    v_add_f32 v57, v57, v63
    v_add_f32 v58, v58, v64
    s_add_u32 s7, s7, 196608
    buffer_load_dword v60, v2, s[44:47], s7 offen offset:0
    buffer_load_dword v61, v2, s[44:47], s7 offen offset:1024
    buffer_load_dword v62, v2, s[44:47], s7 offen offset:2048
    buffer_load_dword v63, v2, s[44:47], s7 offen offset:3072
    buffer_load_dword v64, v6, s[44:47], s7 offen offset:0
    s_waitcnt vmcnt(0)
    v_add_f32 v54, v54, v60
    v_add_f32 v55, v55, v61
    v_add_f32 v56, v56, v62
    v_add_f32 v57, v57, v63
    v_add_f32 v58, v58, v64
    s_add_u32 s7, s7, 196608
    v_and_b32 v3, 31, v0
    v_lshrrev_b32 v4, 5, v0
    v_mul_u32_u24 v4, 96, v4
    v_lshl_add_u32 v4, v3, 2, v4
    v_cmp_gt_u32 vcc, 24, v3
    s_and_saveexec_b64 s[8:9], vcc
    v_cvt_pk_bf16_f32 v5, v54, v54
    v_and_b32 v5, 0xffff0000, v5
    ds_write_b32 v4, v5 offset:2048
    v_cvt_pk_bf16_f32 v5, v55, v55
    v_and_b32 v5, 0xffff0000, v5
    ds_write_b32 v4, v5 offset:2816
    v_cvt_pk_bf16_f32 v5, v56, v56
    v_and_b32 v5, 0xffff0000, v5
    ds_write_b32 v4, v5 offset:3584
    v_cvt_pk_bf16_f32 v5, v57, v57
    v_and_b32 v5, 0xffff0000, v5
    ds_write_b32 v4, v5 offset:4352
    v_cvt_pk_bf16_f32 v5, v58, v58
    v_and_b32 v5, 0xffff0000, v5
    ds_write_b32 v4, v5 offset:5120
    s_mov_b64 exec, s[8:9]
    s_waitcnt vmcnt(0) lgkmcnt(0)
    s_barrier
    v_lshlrev_b32 v64, 16, v44
    v_and_b32 v65, 0xffff0000, v44
    v_lshlrev_b32 v66, 16, v45
    v_and_b32 v67, 0xffff0000, v45
    v_lshlrev_b32 v68, 16, v46
    v_and_b32 v69, 0xffff0000, v46
    v_lshlrev_b32 v70, 16, v47
    v_and_b32 v71, 0xffff0000, v47
    v_lshlrev_b32 v72, 16, v48
    v_and_b32 v73, 0xffff0000, v48
    v_lshlrev_b32 v74, 16, v49
    v_and_b32 v75, 0xffff0000, v49
    v_lshlrev_b32 v76, 16, v50
    v_and_b32 v77, 0xffff0000, v50
    v_lshlrev_b32 v78, 16, v51
    v_and_b32 v79, 0xffff0000, v51
    v_lshlrev_b32 v80, 16, v52
    v_and_b32 v81, 0xffff0000, v52
    v_lshlrev_b32 v82, 16, v53
    v_and_b32 v83, 0xffff0000, v53
    v_mov_b32 v2, 0
    v_mov_b32 v84, 0
    v_mov_b32 v85, 0
    v_mov_b32 v86, 0
    v_mov_b32 v87, 0
    v_mov_b32 v88, 0
    v_mov_b32 v89, 0
    v_mov_b32 v90, 0
    v_mov_b32 v91, 0
    v_mov_b32 v92, 0
    v_mov_b32 v93, 0
    v_mov_b32 v94, 0
    v_mov_b32 v95, 0
    v_mov_b32 v96, 0
    v_mov_b32 v97, 0
    v_mov_b32 v98, 0
    v_mov_b32 v99, 0
    v_mov_b32 v100, 0
    v_mov_b32 v101, 0
    v_mov_b32 v102, 0
    v_mov_b32 v103, 0
    ds_read_b128 v[128:131], v2 offset:0
    ds_read_b128 v[132:135], v2 offset:16
    ds_read_b128 v[136:139], v2 offset:32
    ds_read_b128 v[140:143], v2 offset:48
    ds_read_b128 v[144:147], v2 offset:64
    ds_read_b128 v[148:151], v2 offset:80
    ds_read_b128 v[152:155], v2 offset:96
    ds_read_b128 v[156:159], v2 offset:112
    ds_read_b128 v[160:163], v2 offset:128
    ds_read_b128 v[164:167], v2 offset:144
    s_waitcnt lgkmcnt(5)
    v_pk_fma_f32 v[84:85], v[64:65], v[128:129], v[84:85] op_sel:[0,0,0] op_sel_hi:[0,1,1]
    v_pk_fma_f32 v[86:87], v[64:65], v[130:131], v[86:87] op_sel:[0,0,0] op_sel_hi:[0,1,1]
    v_pk_fma_f32 v[88:89], v[64:65], v[132:133], v[88:89] op_sel:[0,0,0] op_sel_hi:[0,1,1]
    v_pk_fma_f32 v[90:91], v[64:65], v[134:135], v[90:91] op_sel:[0,0,0] op_sel_hi:[0,1,1]
    v_pk_fma_f32 v[92:93], v[64:65], v[136:137], v[92:93] op_sel:[0,0,0] op_sel_hi:[0,1,1]
    v_pk_fma_f32 v[94:95], v[64:65], v[138:139], v[94:95] op_sel:[0,0,0] op_sel_hi:[0,1,1]
    v_pk_fma_f32 v[96:97], v[64:65], v[140:141], v[96:97] op_sel:[0,0,0] op_sel_hi:[0,1,1]
    v_pk_fma_f32 v[98:99], v[64:65], v[142:143], v[98:99] op_sel:[0,0,0] op_sel_hi:[0,1,1]
    v_pk_fma_f32 v[100:101], v[64:65], v[144:145], v[100:101] op_sel:[0,0,0] op_sel_hi:[0,1,1]
    v_pk_fma_f32 v[102:103], v[64:65], v[146:147], v[102:103] op_sel:[0,0,0] op_sel_hi:[0,1,1]
    ds_read_b128 v[128:131], v2 offset:160
    ds_read_b128 v[132:135], v2 offset:176
    ds_read_b128 v[136:139], v2 offset:192
    ds_read_b128 v[140:143], v2 offset:208
    ds_read_b128 v[144:147], v2 offset:224
    s_waitcnt lgkmcnt(5)
    v_pk_fma_f32 v[84:85], v[64:65], v[148:149], v[84:85] op_sel:[1,0,0] op_sel_hi:[1,1,1]
    v_pk_fma_f32 v[86:87], v[64:65], v[150:151], v[86:87] op_sel:[1,0,0] op_sel_hi:[1,1,1]
    v_pk_fma_f32 v[88:89], v[64:65], v[152:153], v[88:89] op_sel:[1,0,0] op_sel_hi:[1,1,1]
    v_pk_fma_f32 v[90:91], v[64:65], v[154:155], v[90:91] op_sel:[1,0,0] op_sel_hi:[1,1,1]
    v_pk_fma_f32 v[92:93], v[64:65], v[156:157], v[92:93] op_sel:[1,0,0] op_sel_hi:[1,1,1]
    v_pk_fma_f32 v[94:95], v[64:65], v[158:159], v[94:95] op_sel:[1,0,0] op_sel_hi:[1,1,1]
    v_pk_fma_f32 v[96:97], v[64:65], v[160:161], v[96:97] op_sel:[1,0,0] op_sel_hi:[1,1,1]
    v_pk_fma_f32 v[98:99], v[64:65], v[162:163], v[98:99] op_sel:[1,0,0] op_sel_hi:[1,1,1]
    v_pk_fma_f32 v[100:101], v[64:65], v[164:165], v[100:101] op_sel:[1,0,0] op_sel_hi:[1,1,1]
    v_pk_fma_f32 v[102:103], v[64:65], v[166:167], v[102:103] op_sel:[1,0,0] op_sel_hi:[1,1,1]
    ds_read_b128 v[148:151], v2 offset:240
    ds_read_b128 v[152:155], v2 offset:256
    ds_read_b128 v[156:159], v2 offset:272
    ds_read_b128 v[160:163], v2 offset:288
    ds_read_b128 v[164:167], v2 offset:304
    s_waitcnt lgkmcnt(5)
    v_pk_fma_f32 v[84:85], v[66:67], v[128:129], v[84:85] op_sel:[0,0,0] op_sel_hi:[0,1,1]
    v_pk_fma_f32 v[86:87], v[66:67], v[130:131], v[86:87] op_sel:[0,0,0] op_sel_hi:[0,1,1]
    v_pk_fma_f32 v[88:89], v[66:67], v[132:133], v[88:89] op_sel:[0,0,0] op_sel_hi:[0,1,1]
    v_pk_fma_f32 v[90:91], v[66:67], v[134:135], v[90:91] op_sel:[0,0,0] op_sel_hi:[0,1,1]
    v_pk_fma_f32 v[92:93], v[66:67], v[136:137], v[92:93] op_sel:[0,0,0] op_sel_hi:[0,1,1]
    v_pk_fma_f32 v[94:95], v[66:67], v[138:139], v[94:95] op_sel:[0,0,0] op_sel_hi:[0,1,1]
    v_pk_fma_f32 v[96:97], v[66:67], v[140:141], v[96:97] op_sel:[0,0,0] op_sel_hi:[0,1,1]
    v_pk_fma_f32 v[98:99], v[66:67], v[142:143], v[98:99] op_sel:[0,0,0] op_sel_hi:[0,1,1]
    v_pk_fma_f32 v[100:101], v[66:67], v[144:145], v[100:101] op_sel:[0,0,0] op_sel_hi:[0,1,1]
    v_pk_fma_f32 v[102:103], v[66:67], v[146:147], v[102:103] op_sel:[0,0,0] op_sel_hi:[0,1,1]
    ds_read_b128 v[128:131], v2 offset:320
    ds_read_b128 v[132:135], v2 offset:336
    ds_read_b128 v[136:139], v2 offset:352
    ds_read_b128 v[140:143], v2 offset:368
    ds_read_b128 v[144:147], v2 offset:384
    s_waitcnt lgkmcnt(5)
    v_pk_fma_f32 v[84:85], v[66:67], v[148:149], v[84:85] op_sel:[1,0,0] op_sel_hi:[1,1,1]
    v_pk_fma_f32 v[86:87], v[66:67], v[150:151], v[86:87] op_sel:[1,0,0] op_sel_hi:[1,1,1]
    v_pk_fma_f32 v[88:89], v[66:67], v[152:153], v[88:89] op_sel:[1,0,0] op_sel_hi:[1,1,1]
    v_pk_fma_f32 v[90:91], v[66:67], v[154:155], v[90:91] op_sel:[1,0,0] op_sel_hi:[1,1,1]
    v_pk_fma_f32 v[92:93], v[66:67], v[156:157], v[92:93] op_sel:[1,0,0] op_sel_hi:[1,1,1]
    v_pk_fma_f32 v[94:95], v[66:67], v[158:159], v[94:95] op_sel:[1,0,0] op_sel_hi:[1,1,1]
    v_pk_fma_f32 v[96:97], v[66:67], v[160:161], v[96:97] op_sel:[1,0,0] op_sel_hi:[1,1,1]
    v_pk_fma_f32 v[98:99], v[66:67], v[162:163], v[98:99] op_sel:[1,0,0] op_sel_hi:[1,1,1]
    v_pk_fma_f32 v[100:101], v[66:67], v[164:165], v[100:101] op_sel:[1,0,0] op_sel_hi:[1,1,1]
    v_pk_fma_f32 v[102:103], v[66:67], v[166:167], v[102:103] op_sel:[1,0,0] op_sel_hi:[1,1,1]
    ds_read_b128 v[148:151], v2 offset:400
    ds_read_b128 v[152:155], v2 offset:416
    ds_read_b128 v[156:159], v2 offset:432
    ds_read_b128 v[160:163], v2 offset:448
    ds_read_b128 v[164:167], v2 offset:464
    s_waitcnt lgkmcnt(5)
    v_pk_fma_f32 v[84:85], v[68:69], v[128:129], v[84:85] op_sel:[0,0,0] op_sel_hi:[0,1,1]
    v_pk_fma_f32 v[86:87], v[68:69], v[130:131], v[86:87] op_sel:[0,0,0] op_sel_hi:[0,1,1]
    v_pk_fma_f32 v[88:89], v[68:69], v[132:133], v[88:89] op_sel:[0,0,0] op_sel_hi:[0,1,1]
    v_pk_fma_f32 v[90:91], v[68:69], v[134:135], v[90:91] op_sel:[0,0,0] op_sel_hi:[0,1,1]
    v_pk_fma_f32 v[92:93], v[68:69], v[136:137], v[92:93] op_sel:[0,0,0] op_sel_hi:[0,1,1]
    v_pk_fma_f32 v[94:95], v[68:69], v[138:139], v[94:95] op_sel:[0,0,0] op_sel_hi:[0,1,1]
    v_pk_fma_f32 v[96:97], v[68:69], v[140:141], v[96:97] op_sel:[0,0,0] op_sel_hi:[0,1,1]
    v_pk_fma_f32 v[98:99], v[68:69], v[142:143], v[98:99] op_sel:[0,0,0] op_sel_hi:[0,1,1]
    v_pk_fma_f32 v[100:101], v[68:69], v[144:145], v[100:101] op_sel:[0,0,0] op_sel_hi:[0,1,1]
    v_pk_fma_f32 v[102:103], v[68:69], v[146:147], v[102:103] op_sel:[0,0,0] op_sel_hi:[0,1,1]
    ds_read_b128 v[128:131], v2 offset:480
    ds_read_b128 v[132:135], v2 offset:496
    ds_read_b128 v[136:139], v2 offset:512
    ds_read_b128 v[140:143], v2 offset:528
    ds_read_b128 v[144:147], v2 offset:544
    s_waitcnt lgkmcnt(5)
    v_pk_fma_f32 v[84:85], v[68:69], v[148:149], v[84:85] op_sel:[1,0,0] op_sel_hi:[1,1,1]
    v_pk_fma_f32 v[86:87], v[68:69], v[150:151], v[86:87] op_sel:[1,0,0] op_sel_hi:[1,1,1]
    v_pk_fma_f32 v[88:89], v[68:69], v[152:153], v[88:89] op_sel:[1,0,0] op_sel_hi:[1,1,1]
    v_pk_fma_f32 v[90:91], v[68:69], v[154:155], v[90:91] op_sel:[1,0,0] op_sel_hi:[1,1,1]
    v_pk_fma_f32 v[92:93], v[68:69], v[156:157], v[92:93] op_sel:[1,0,0] op_sel_hi:[1,1,1]
    v_pk_fma_f32 v[94:95], v[68:69], v[158:159], v[94:95] op_sel:[1,0,0] op_sel_hi:[1,1,1]
    v_pk_fma_f32 v[96:97], v[68:69], v[160:161], v[96:97] op_sel:[1,0,0] op_sel_hi:[1,1,1]
    v_pk_fma_f32 v[98:99], v[68:69], v[162:163], v[98:99] op_sel:[1,0,0] op_sel_hi:[1,1,1]
    v_pk_fma_f32 v[100:101], v[68:69], v[164:165], v[100:101] op_sel:[1,0,0] op_sel_hi:[1,1,1]
    v_pk_fma_f32 v[102:103], v[68:69], v[166:167], v[102:103] op_sel:[1,0,0] op_sel_hi:[1,1,1]
    ds_read_b128 v[148:151], v2 offset:560
    ds_read_b128 v[152:155], v2 offset:576
    ds_read_b128 v[156:159], v2 offset:592
    ds_read_b128 v[160:163], v2 offset:608
    ds_read_b128 v[164:167], v2 offset:624
    s_waitcnt lgkmcnt(5)
    v_pk_fma_f32 v[84:85], v[70:71], v[128:129], v[84:85] op_sel:[0,0,0] op_sel_hi:[0,1,1]
    v_pk_fma_f32 v[86:87], v[70:71], v[130:131], v[86:87] op_sel:[0,0,0] op_sel_hi:[0,1,1]
    v_pk_fma_f32 v[88:89], v[70:71], v[132:133], v[88:89] op_sel:[0,0,0] op_sel_hi:[0,1,1]
    v_pk_fma_f32 v[90:91], v[70:71], v[134:135], v[90:91] op_sel:[0,0,0] op_sel_hi:[0,1,1]
    v_pk_fma_f32 v[92:93], v[70:71], v[136:137], v[92:93] op_sel:[0,0,0] op_sel_hi:[0,1,1]
    v_pk_fma_f32 v[94:95], v[70:71], v[138:139], v[94:95] op_sel:[0,0,0] op_sel_hi:[0,1,1]
    v_pk_fma_f32 v[96:97], v[70:71], v[140:141], v[96:97] op_sel:[0,0,0] op_sel_hi:[0,1,1]
    v_pk_fma_f32 v[98:99], v[70:71], v[142:143], v[98:99] op_sel:[0,0,0] op_sel_hi:[0,1,1]
    v_pk_fma_f32 v[100:101], v[70:71], v[144:145], v[100:101] op_sel:[0,0,0] op_sel_hi:[0,1,1]
    v_pk_fma_f32 v[102:103], v[70:71], v[146:147], v[102:103] op_sel:[0,0,0] op_sel_hi:[0,1,1]
    ds_read_b128 v[128:131], v2 offset:640
    ds_read_b128 v[132:135], v2 offset:656
    ds_read_b128 v[136:139], v2 offset:672
    ds_read_b128 v[140:143], v2 offset:688
    ds_read_b128 v[144:147], v2 offset:704
    s_waitcnt lgkmcnt(5)
    v_pk_fma_f32 v[84:85], v[70:71], v[148:149], v[84:85] op_sel:[1,0,0] op_sel_hi:[1,1,1]
    v_pk_fma_f32 v[86:87], v[70:71], v[150:151], v[86:87] op_sel:[1,0,0] op_sel_hi:[1,1,1]
    v_pk_fma_f32 v[88:89], v[70:71], v[152:153], v[88:89] op_sel:[1,0,0] op_sel_hi:[1,1,1]
    v_pk_fma_f32 v[90:91], v[70:71], v[154:155], v[90:91] op_sel:[1,0,0] op_sel_hi:[1,1,1]
    v_pk_fma_f32 v[92:93], v[70:71], v[156:157], v[92:93] op_sel:[1,0,0] op_sel_hi:[1,1,1]
    v_pk_fma_f32 v[94:95], v[70:71], v[158:159], v[94:95] op_sel:[1,0,0] op_sel_hi:[1,1,1]
    v_pk_fma_f32 v[96:97], v[70:71], v[160:161], v[96:97] op_sel:[1,0,0] op_sel_hi:[1,1,1]
    v_pk_fma_f32 v[98:99], v[70:71], v[162:163], v[98:99] op_sel:[1,0,0] op_sel_hi:[1,1,1]
    v_pk_fma_f32 v[100:101], v[70:71], v[164:165], v[100:101] op_sel:[1,0,0] op_sel_hi:[1,1,1]
    v_pk_fma_f32 v[102:103], v[70:71], v[166:167], v[102:103] op_sel:[1,0,0] op_sel_hi:[1,1,1]
    ds_read_b128 v[148:151], v2 offset:720
    ds_read_b128 v[152:155], v2 offset:736
    ds_read_b128 v[156:159], v2 offset:752
    ds_read_b128 v[160:163], v2 offset:768
    ds_read_b128 v[164:167], v2 offset:784
    s_waitcnt lgkmcnt(5)
    v_pk_fma_f32 v[84:85], v[72:73], v[128:129], v[84:85] op_sel:[0,0,0] op_sel_hi:[0,1,1]
    v_pk_fma_f32 v[86:87], v[72:73], v[130:131], v[86:87] op_sel:[0,0,0] op_sel_hi:[0,1,1]
    v_pk_fma_f32 v[88:89], v[72:73], v[132:133], v[88:89] op_sel:[0,0,0] op_sel_hi:[0,1,1]
    v_pk_fma_f32 v[90:91], v[72:73], v[134:135], v[90:91] op_sel:[0,0,0] op_sel_hi:[0,1,1]
    v_pk_fma_f32 v[92:93], v[72:73], v[136:137], v[92:93] op_sel:[0,0,0] op_sel_hi:[0,1,1]
    v_pk_fma_f32 v[94:95], v[72:73], v[138:139], v[94:95] op_sel:[0,0,0] op_sel_hi:[0,1,1]
    v_pk_fma_f32 v[96:97], v[72:73], v[140:141], v[96:97] op_sel:[0,0,0] op_sel_hi:[0,1,1]
    v_pk_fma_f32 v[98:99], v[72:73], v[142:143], v[98:99] op_sel:[0,0,0] op_sel_hi:[0,1,1]
    v_pk_fma_f32 v[100:101], v[72:73], v[144:145], v[100:101] op_sel:[0,0,0] op_sel_hi:[0,1,1]
    v_pk_fma_f32 v[102:103], v[72:73], v[146:147], v[102:103] op_sel:[0,0,0] op_sel_hi:[0,1,1]
    ds_read_b128 v[128:131], v2 offset:800
    ds_read_b128 v[132:135], v2 offset:816
    ds_read_b128 v[136:139], v2 offset:832
    ds_read_b128 v[140:143], v2 offset:848
    ds_read_b128 v[144:147], v2 offset:864
    s_waitcnt lgkmcnt(5)
    v_pk_fma_f32 v[84:85], v[72:73], v[148:149], v[84:85] op_sel:[1,0,0] op_sel_hi:[1,1,1]
    v_pk_fma_f32 v[86:87], v[72:73], v[150:151], v[86:87] op_sel:[1,0,0] op_sel_hi:[1,1,1]
    v_pk_fma_f32 v[88:89], v[72:73], v[152:153], v[88:89] op_sel:[1,0,0] op_sel_hi:[1,1,1]
    v_pk_fma_f32 v[90:91], v[72:73], v[154:155], v[90:91] op_sel:[1,0,0] op_sel_hi:[1,1,1]
    v_pk_fma_f32 v[92:93], v[72:73], v[156:157], v[92:93] op_sel:[1,0,0] op_sel_hi:[1,1,1]
    v_pk_fma_f32 v[94:95], v[72:73], v[158:159], v[94:95] op_sel:[1,0,0] op_sel_hi:[1,1,1]
    v_pk_fma_f32 v[96:97], v[72:73], v[160:161], v[96:97] op_sel:[1,0,0] op_sel_hi:[1,1,1]
    v_pk_fma_f32 v[98:99], v[72:73], v[162:163], v[98:99] op_sel:[1,0,0] op_sel_hi:[1,1,1]
    v_pk_fma_f32 v[100:101], v[72:73], v[164:165], v[100:101] op_sel:[1,0,0] op_sel_hi:[1,1,1]
    v_pk_fma_f32 v[102:103], v[72:73], v[166:167], v[102:103] op_sel:[1,0,0] op_sel_hi:[1,1,1]
    ds_read_b128 v[148:151], v2 offset:880
    ds_read_b128 v[152:155], v2 offset:896
    ds_read_b128 v[156:159], v2 offset:912
    ds_read_b128 v[160:163], v2 offset:928
    ds_read_b128 v[164:167], v2 offset:944
    s_waitcnt lgkmcnt(5)
    v_pk_fma_f32 v[84:85], v[74:75], v[128:129], v[84:85] op_sel:[0,0,0] op_sel_hi:[0,1,1]
    v_pk_fma_f32 v[86:87], v[74:75], v[130:131], v[86:87] op_sel:[0,0,0] op_sel_hi:[0,1,1]
    v_pk_fma_f32 v[88:89], v[74:75], v[132:133], v[88:89] op_sel:[0,0,0] op_sel_hi:[0,1,1]
    v_pk_fma_f32 v[90:91], v[74:75], v[134:135], v[90:91] op_sel:[0,0,0] op_sel_hi:[0,1,1]
    v_pk_fma_f32 v[92:93], v[74:75], v[136:137], v[92:93] op_sel:[0,0,0] op_sel_hi:[0,1,1]
    v_pk_fma_f32 v[94:95], v[74:75], v[138:139], v[94:95] op_sel:[0,0,0] op_sel_hi:[0,1,1]
    v_pk_fma_f32 v[96:97], v[74:75], v[140:141], v[96:97] op_sel:[0,0,0] op_sel_hi:[0,1,1]
    v_pk_fma_f32 v[98:99], v[74:75], v[142:143], v[98:99] op_sel:[0,0,0] op_sel_hi:[0,1,1]
    v_pk_fma_f32 v[100:101], v[74:75], v[144:145], v[100:101] op_sel:[0,0,0] op_sel_hi:[0,1,1]
    v_pk_fma_f32 v[102:103], v[74:75], v[146:147], v[102:103] op_sel:[0,0,0] op_sel_hi:[0,1,1]
    ds_read_b128 v[128:131], v2 offset:960
    ds_read_b128 v[132:135], v2 offset:976
    ds_read_b128 v[136:139], v2 offset:992
    ds_read_b128 v[140:143], v2 offset:1008
    ds_read_b128 v[144:147], v2 offset:1024
    s_waitcnt lgkmcnt(5)
    v_pk_fma_f32 v[84:85], v[74:75], v[148:149], v[84:85] op_sel:[1,0,0] op_sel_hi:[1,1,1]
    v_pk_fma_f32 v[86:87], v[74:75], v[150:151], v[86:87] op_sel:[1,0,0] op_sel_hi:[1,1,1]
    v_pk_fma_f32 v[88:89], v[74:75], v[152:153], v[88:89] op_sel:[1,0,0] op_sel_hi:[1,1,1]
    v_pk_fma_f32 v[90:91], v[74:75], v[154:155], v[90:91] op_sel:[1,0,0] op_sel_hi:[1,1,1]
    v_pk_fma_f32 v[92:93], v[74:75], v[156:157], v[92:93] op_sel:[1,0,0] op_sel_hi:[1,1,1]
    v_pk_fma_f32 v[94:95], v[74:75], v[158:159], v[94:95] op_sel:[1,0,0] op_sel_hi:[1,1,1]
    v_pk_fma_f32 v[96:97], v[74:75], v[160:161], v[96:97] op_sel:[1,0,0] op_sel_hi:[1,1,1]
    v_pk_fma_f32 v[98:99], v[74:75], v[162:163], v[98:99] op_sel:[1,0,0] op_sel_hi:[1,1,1]
    v_pk_fma_f32 v[100:101], v[74:75], v[164:165], v[100:101] op_sel:[1,0,0] op_sel_hi:[1,1,1]
    v_pk_fma_f32 v[102:103], v[74:75], v[166:167], v[102:103] op_sel:[1,0,0] op_sel_hi:[1,1,1]
    ds_read_b128 v[148:151], v2 offset:1040
    ds_read_b128 v[152:155], v2 offset:1056
    ds_read_b128 v[156:159], v2 offset:1072
    ds_read_b128 v[160:163], v2 offset:1088
    ds_read_b128 v[164:167], v2 offset:1104
    s_waitcnt lgkmcnt(5)
    v_pk_fma_f32 v[84:85], v[76:77], v[128:129], v[84:85] op_sel:[0,0,0] op_sel_hi:[0,1,1]
    v_pk_fma_f32 v[86:87], v[76:77], v[130:131], v[86:87] op_sel:[0,0,0] op_sel_hi:[0,1,1]
    v_pk_fma_f32 v[88:89], v[76:77], v[132:133], v[88:89] op_sel:[0,0,0] op_sel_hi:[0,1,1]
    v_pk_fma_f32 v[90:91], v[76:77], v[134:135], v[90:91] op_sel:[0,0,0] op_sel_hi:[0,1,1]
    v_pk_fma_f32 v[92:93], v[76:77], v[136:137], v[92:93] op_sel:[0,0,0] op_sel_hi:[0,1,1]
    v_pk_fma_f32 v[94:95], v[76:77], v[138:139], v[94:95] op_sel:[0,0,0] op_sel_hi:[0,1,1]
    v_pk_fma_f32 v[96:97], v[76:77], v[140:141], v[96:97] op_sel:[0,0,0] op_sel_hi:[0,1,1]
    v_pk_fma_f32 v[98:99], v[76:77], v[142:143], v[98:99] op_sel:[0,0,0] op_sel_hi:[0,1,1]
    v_pk_fma_f32 v[100:101], v[76:77], v[144:145], v[100:101] op_sel:[0,0,0] op_sel_hi:[0,1,1]
    v_pk_fma_f32 v[102:103], v[76:77], v[146:147], v[102:103] op_sel:[0,0,0] op_sel_hi:[0,1,1]
    ds_read_b128 v[128:131], v2 offset:1120
    ds_read_b128 v[132:135], v2 offset:1136
    ds_read_b128 v[136:139], v2 offset:1152
    ds_read_b128 v[140:143], v2 offset:1168
    ds_read_b128 v[144:147], v2 offset:1184
    s_waitcnt lgkmcnt(5)
    v_pk_fma_f32 v[84:85], v[76:77], v[148:149], v[84:85] op_sel:[1,0,0] op_sel_hi:[1,1,1]
    v_pk_fma_f32 v[86:87], v[76:77], v[150:151], v[86:87] op_sel:[1,0,0] op_sel_hi:[1,1,1]
    v_pk_fma_f32 v[88:89], v[76:77], v[152:153], v[88:89] op_sel:[1,0,0] op_sel_hi:[1,1,1]
    v_pk_fma_f32 v[90:91], v[76:77], v[154:155], v[90:91] op_sel:[1,0,0] op_sel_hi:[1,1,1]
    v_pk_fma_f32 v[92:93], v[76:77], v[156:157], v[92:93] op_sel:[1,0,0] op_sel_hi:[1,1,1]
    v_pk_fma_f32 v[94:95], v[76:77], v[158:159], v[94:95] op_sel:[1,0,0] op_sel_hi:[1,1,1]
    v_pk_fma_f32 v[96:97], v[76:77], v[160:161], v[96:97] op_sel:[1,0,0] op_sel_hi:[1,1,1]
    v_pk_fma_f32 v[98:99], v[76:77], v[162:163], v[98:99] op_sel:[1,0,0] op_sel_hi:[1,1,1]
    v_pk_fma_f32 v[100:101], v[76:77], v[164:165], v[100:101] op_sel:[1,0,0] op_sel_hi:[1,1,1]
    v_pk_fma_f32 v[102:103], v[76:77], v[166:167], v[102:103] op_sel:[1,0,0] op_sel_hi:[1,1,1]
    ds_read_b128 v[148:151], v2 offset:1200
    ds_read_b128 v[152:155], v2 offset:1216
    ds_read_b128 v[156:159], v2 offset:1232
    ds_read_b128 v[160:163], v2 offset:1248
    ds_read_b128 v[164:167], v2 offset:1264
    s_waitcnt lgkmcnt(5)
    v_pk_fma_f32 v[84:85], v[78:79], v[128:129], v[84:85] op_sel:[0,0,0] op_sel_hi:[0,1,1]
    v_pk_fma_f32 v[86:87], v[78:79], v[130:131], v[86:87] op_sel:[0,0,0] op_sel_hi:[0,1,1]
    v_pk_fma_f32 v[88:89], v[78:79], v[132:133], v[88:89] op_sel:[0,0,0] op_sel_hi:[0,1,1]
    v_pk_fma_f32 v[90:91], v[78:79], v[134:135], v[90:91] op_sel:[0,0,0] op_sel_hi:[0,1,1]
    v_pk_fma_f32 v[92:93], v[78:79], v[136:137], v[92:93] op_sel:[0,0,0] op_sel_hi:[0,1,1]
    v_pk_fma_f32 v[94:95], v[78:79], v[138:139], v[94:95] op_sel:[0,0,0] op_sel_hi:[0,1,1]
    v_pk_fma_f32 v[96:97], v[78:79], v[140:141], v[96:97] op_sel:[0,0,0] op_sel_hi:[0,1,1]
    v_pk_fma_f32 v[98:99], v[78:79], v[142:143], v[98:99] op_sel:[0,0,0] op_sel_hi:[0,1,1]
    v_pk_fma_f32 v[100:101], v[78:79], v[144:145], v[100:101] op_sel:[0,0,0] op_sel_hi:[0,1,1]
    v_pk_fma_f32 v[102:103], v[78:79], v[146:147], v[102:103] op_sel:[0,0,0] op_sel_hi:[0,1,1]
    ds_read_b128 v[128:131], v2 offset:1280
    ds_read_b128 v[132:135], v2 offset:1296
    ds_read_b128 v[136:139], v2 offset:1312
    ds_read_b128 v[140:143], v2 offset:1328
    ds_read_b128 v[144:147], v2 offset:1344
    s_waitcnt lgkmcnt(5)
    v_pk_fma_f32 v[84:85], v[78:79], v[148:149], v[84:85] op_sel:[1,0,0] op_sel_hi:[1,1,1]
    v_pk_fma_f32 v[86:87], v[78:79], v[150:151], v[86:87] op_sel:[1,0,0] op_sel_hi:[1,1,1]
    v_pk_fma_f32 v[88:89], v[78:79], v[152:153], v[88:89] op_sel:[1,0,0] op_sel_hi:[1,1,1]
    v_pk_fma_f32 v[90:91], v[78:79], v[154:155], v[90:91] op_sel:[1,0,0] op_sel_hi:[1,1,1]
    v_pk_fma_f32 v[92:93], v[78:79], v[156:157], v[92:93] op_sel:[1,0,0] op_sel_hi:[1,1,1]
    v_pk_fma_f32 v[94:95], v[78:79], v[158:159], v[94:95] op_sel:[1,0,0] op_sel_hi:[1,1,1]
    v_pk_fma_f32 v[96:97], v[78:79], v[160:161], v[96:97] op_sel:[1,0,0] op_sel_hi:[1,1,1]
    v_pk_fma_f32 v[98:99], v[78:79], v[162:163], v[98:99] op_sel:[1,0,0] op_sel_hi:[1,1,1]
    v_pk_fma_f32 v[100:101], v[78:79], v[164:165], v[100:101] op_sel:[1,0,0] op_sel_hi:[1,1,1]
    v_pk_fma_f32 v[102:103], v[78:79], v[166:167], v[102:103] op_sel:[1,0,0] op_sel_hi:[1,1,1]
    ds_read_b128 v[148:151], v2 offset:1360
    ds_read_b128 v[152:155], v2 offset:1376
    ds_read_b128 v[156:159], v2 offset:1392
    ds_read_b128 v[160:163], v2 offset:1408
    ds_read_b128 v[164:167], v2 offset:1424
    s_waitcnt lgkmcnt(5)
    v_pk_fma_f32 v[84:85], v[80:81], v[128:129], v[84:85] op_sel:[0,0,0] op_sel_hi:[0,1,1]
    v_pk_fma_f32 v[86:87], v[80:81], v[130:131], v[86:87] op_sel:[0,0,0] op_sel_hi:[0,1,1]
    v_pk_fma_f32 v[88:89], v[80:81], v[132:133], v[88:89] op_sel:[0,0,0] op_sel_hi:[0,1,1]
    v_pk_fma_f32 v[90:91], v[80:81], v[134:135], v[90:91] op_sel:[0,0,0] op_sel_hi:[0,1,1]
    v_pk_fma_f32 v[92:93], v[80:81], v[136:137], v[92:93] op_sel:[0,0,0] op_sel_hi:[0,1,1]
    v_pk_fma_f32 v[94:95], v[80:81], v[138:139], v[94:95] op_sel:[0,0,0] op_sel_hi:[0,1,1]
    v_pk_fma_f32 v[96:97], v[80:81], v[140:141], v[96:97] op_sel:[0,0,0] op_sel_hi:[0,1,1]
    v_pk_fma_f32 v[98:99], v[80:81], v[142:143], v[98:99] op_sel:[0,0,0] op_sel_hi:[0,1,1]
    v_pk_fma_f32 v[100:101], v[80:81], v[144:145], v[100:101] op_sel:[0,0,0] op_sel_hi:[0,1,1]
    v_pk_fma_f32 v[102:103], v[80:81], v[146:147], v[102:103] op_sel:[0,0,0] op_sel_hi:[0,1,1]
    ds_read_b128 v[128:131], v2 offset:1440
    ds_read_b128 v[132:135], v2 offset:1456
    ds_read_b128 v[136:139], v2 offset:1472
    ds_read_b128 v[140:143], v2 offset:1488
    ds_read_b128 v[144:147], v2 offset:1504
    s_waitcnt lgkmcnt(5)
    v_pk_fma_f32 v[84:85], v[80:81], v[148:149], v[84:85] op_sel:[1,0,0] op_sel_hi:[1,1,1]
    v_pk_fma_f32 v[86:87], v[80:81], v[150:151], v[86:87] op_sel:[1,0,0] op_sel_hi:[1,1,1]
    v_pk_fma_f32 v[88:89], v[80:81], v[152:153], v[88:89] op_sel:[1,0,0] op_sel_hi:[1,1,1]
    v_pk_fma_f32 v[90:91], v[80:81], v[154:155], v[90:91] op_sel:[1,0,0] op_sel_hi:[1,1,1]
    v_pk_fma_f32 v[92:93], v[80:81], v[156:157], v[92:93] op_sel:[1,0,0] op_sel_hi:[1,1,1]
    v_pk_fma_f32 v[94:95], v[80:81], v[158:159], v[94:95] op_sel:[1,0,0] op_sel_hi:[1,1,1]
    v_pk_fma_f32 v[96:97], v[80:81], v[160:161], v[96:97] op_sel:[1,0,0] op_sel_hi:[1,1,1]
    v_pk_fma_f32 v[98:99], v[80:81], v[162:163], v[98:99] op_sel:[1,0,0] op_sel_hi:[1,1,1]
    v_pk_fma_f32 v[100:101], v[80:81], v[164:165], v[100:101] op_sel:[1,0,0] op_sel_hi:[1,1,1]
    v_pk_fma_f32 v[102:103], v[80:81], v[166:167], v[102:103] op_sel:[1,0,0] op_sel_hi:[1,1,1]
    ds_read_b128 v[148:151], v2 offset:1520
    ds_read_b128 v[152:155], v2 offset:1536
    ds_read_b128 v[156:159], v2 offset:1552
    ds_read_b128 v[160:163], v2 offset:1568
    ds_read_b128 v[164:167], v2 offset:1584
    s_waitcnt lgkmcnt(5)
    v_pk_fma_f32 v[84:85], v[82:83], v[128:129], v[84:85] op_sel:[0,0,0] op_sel_hi:[0,1,1]
    v_pk_fma_f32 v[86:87], v[82:83], v[130:131], v[86:87] op_sel:[0,0,0] op_sel_hi:[0,1,1]
    v_pk_fma_f32 v[88:89], v[82:83], v[132:133], v[88:89] op_sel:[0,0,0] op_sel_hi:[0,1,1]
    v_pk_fma_f32 v[90:91], v[82:83], v[134:135], v[90:91] op_sel:[0,0,0] op_sel_hi:[0,1,1]
    v_pk_fma_f32 v[92:93], v[82:83], v[136:137], v[92:93] op_sel:[0,0,0] op_sel_hi:[0,1,1]
    v_pk_fma_f32 v[94:95], v[82:83], v[138:139], v[94:95] op_sel:[0,0,0] op_sel_hi:[0,1,1]
    v_pk_fma_f32 v[96:97], v[82:83], v[140:141], v[96:97] op_sel:[0,0,0] op_sel_hi:[0,1,1]
    v_pk_fma_f32 v[98:99], v[82:83], v[142:143], v[98:99] op_sel:[0,0,0] op_sel_hi:[0,1,1]
    v_pk_fma_f32 v[100:101], v[82:83], v[144:145], v[100:101] op_sel:[0,0,0] op_sel_hi:[0,1,1]
    v_pk_fma_f32 v[102:103], v[82:83], v[146:147], v[102:103] op_sel:[0,0,0] op_sel_hi:[0,1,1]
    s_waitcnt lgkmcnt(0)
    v_pk_fma_f32 v[84:85], v[82:83], v[148:149], v[84:85] op_sel:[1,0,0] op_sel_hi:[1,1,1]
    v_pk_fma_f32 v[86:87], v[82:83], v[150:151], v[86:87] op_sel:[1,0,0] op_sel_hi:[1,1,1]
    v_pk_fma_f32 v[88:89], v[82:83], v[152:153], v[88:89] op_sel:[1,0,0] op_sel_hi:[1,1,1]
    v_pk_fma_f32 v[90:91], v[82:83], v[154:155], v[90:91] op_sel:[1,0,0] op_sel_hi:[1,1,1]
    v_pk_fma_f32 v[92:93], v[82:83], v[156:157], v[92:93] op_sel:[1,0,0] op_sel_hi:[1,1,1]
    v_pk_fma_f32 v[94:95], v[82:83], v[158:159], v[94:95] op_sel:[1,0,0] op_sel_hi:[1,1,1]
    v_pk_fma_f32 v[96:97], v[82:83], v[160:161], v[96:97] op_sel:[1,0,0] op_sel_hi:[1,1,1]
    v_pk_fma_f32 v[98:99], v[82:83], v[162:163], v[98:99] op_sel:[1,0,0] op_sel_hi:[1,1,1]
    v_pk_fma_f32 v[100:101], v[82:83], v[164:165], v[100:101] op_sel:[1,0,0] op_sel_hi:[1,1,1]
    v_pk_fma_f32 v[102:103], v[82:83], v[166:167], v[102:103] op_sel:[1,0,0] op_sel_hi:[1,1,1]
    v_cvt_pk_bf16_f32 v124, v84, v85
    v_lshlrev_b32 v84, 16, v124
    v_and_b32 v85, 0xffff0000, v124
    v_cvt_pk_bf16_f32 v124, v86, v87
    v_lshlrev_b32 v86, 16, v124
    v_and_b32 v87, 0xffff0000, v124
    v_cvt_pk_bf16_f32 v124, v88, v89
    v_lshlrev_b32 v88, 16, v124
    v_and_b32 v89, 0xffff0000, v124
    v_cvt_pk_bf16_f32 v124, v90, v91
    v_lshlrev_b32 v90, 16, v124
    v_and_b32 v91, 0xffff0000, v124
    v_cvt_pk_bf16_f32 v124, v92, v93
    v_lshlrev_b32 v92, 16, v124
    v_and_b32 v93, 0xffff0000, v124
    v_cvt_pk_bf16_f32 v124, v94, v95
    v_lshlrev_b32 v94, 16, v124
    v_and_b32 v95, 0xffff0000, v124
    v_cvt_pk_bf16_f32 v124, v96, v97
    v_lshlrev_b32 v96, 16, v124
    v_and_b32 v97, 0xffff0000, v124
    v_cvt_pk_bf16_f32 v124, v98, v99
    v_lshlrev_b32 v98, 16, v124
    v_and_b32 v99, 0xffff0000, v124
    v_cvt_pk_bf16_f32 v124, v100, v101
    v_lshlrev_b32 v100, 16, v124
    v_and_b32 v101, 0xffff0000, v124
    v_cvt_pk_bf16_f32 v124, v102, v103
    v_lshlrev_b32 v102, 16, v124
    v_and_b32 v103, 0xffff0000, v124
    v_max_f32 v124, v84, v85
    v_min_f32 v125, v84, v85
    v_max_f32 v124, v124, v86
    v_min_f32 v125, v125, v86
    v_max_f32 v124, v124, v87
    v_min_f32 v125, v125, v87
    v_max_f32 v124, v124, v88
    v_min_f32 v125, v125, v88
    v_max_f32 v124, v124, v89
    v_min_f32 v125, v125, v89
    v_max_f32 v124, v124, v90
    v_min_f32 v125, v125, v90
    v_max_f32 v124, v124, v91
    v_min_f32 v125, v125, v91
    v_max_f32 v124, v124, v92
    v_min_f32 v125, v125, v92
    v_max_f32 v124, v124, v93
    v_min_f32 v125, v125, v93
    v_max_f32 v124, v124, v94
    v_min_f32 v125, v125, v94
    v_max_f32 v124, v124, v95
    v_min_f32 v125, v125, v95
    v_max_f32 v124, v124, v96
    v_min_f32 v125, v125, v96
    v_max_f32 v124, v124, v97
    v_min_f32 v125, v125, v97
    v_max_f32 v124, v124, v98
    v_min_f32 v125, v125, v98
    v_max_f32 v124, v124, v99
    v_min_f32 v125, v125, v99
    v_max_f32 v124, v124, v100
    v_min_f32 v125, v125, v100
    v_max_f32 v124, v124, v101
    v_min_f32 v125, v125, v101
    v_max_f32 v124, v124, v102
    v_min_f32 v125, v125, v102
    v_max_f32 v124, v124, v103
    v_min_f32 v125, v125, v103
    v_sub_f32 v104, v125, v84
    v_mul_f32 v104, 0x3fb8aa3b, v104
    v_exp_f32 v104, v104
    v_sub_f32 v84, v84, v124
    v_mul_f32 v84, 0x3fb8aa3b, v84
    v_exp_f32 v84, v84
    v_sub_f32 v105, v125, v85
    v_mul_f32 v105, 0x3fb8aa3b, v105
    v_exp_f32 v105, v105
    v_sub_f32 v85, v85, v124
    v_mul_f32 v85, 0x3fb8aa3b, v85
    v_exp_f32 v85, v85
    v_sub_f32 v106, v125, v86
    v_mul_f32 v106, 0x3fb8aa3b, v106
    v_exp_f32 v106, v106
    v_sub_f32 v86, v86, v124
    v_mul_f32 v86, 0x3fb8aa3b, v86
    v_exp_f32 v86, v86
    v_sub_f32 v107, v125, v87
    v_mul_f32 v107, 0x3fb8aa3b, v107
    v_exp_f32 v107, v107
    v_sub_f32 v87, v87, v124
    v_mul_f32 v87, 0x3fb8aa3b, v87
    v_exp_f32 v87, v87
    v_sub_f32 v108, v125, v88
    v_mul_f32 v108, 0x3fb8aa3b, v108
    v_exp_f32 v108, v108
    v_sub_f32 v88, v88, v124
    v_mul_f32 v88, 0x3fb8aa3b, v88
    v_exp_f32 v88, v88
    v_sub_f32 v109, v125, v89
    v_mul_f32 v109, 0x3fb8aa3b, v109
    v_exp_f32 v109, v109
    v_sub_f32 v89, v89, v124
    v_mul_f32 v89, 0x3fb8aa3b, v89
    v_exp_f32 v89, v89
    v_sub_f32 v110, v125, v90
    v_mul_f32 v110, 0x3fb8aa3b, v110
    v_exp_f32 v110, v110
    v_sub_f32 v90, v90, v124
    v_mul_f32 v90, 0x3fb8aa3b, v90
    v_exp_f32 v90, v90
    v_sub_f32 v111, v125, v91
    v_mul_f32 v111, 0x3fb8aa3b, v111
    v_exp_f32 v111, v111
    v_sub_f32 v91, v91, v124
    v_mul_f32 v91, 0x3fb8aa3b, v91
    v_exp_f32 v91, v91
    v_sub_f32 v112, v125, v92
    v_mul_f32 v112, 0x3fb8aa3b, v112
    v_exp_f32 v112, v112
    v_sub_f32 v92, v92, v124
    v_mul_f32 v92, 0x3fb8aa3b, v92
    v_exp_f32 v92, v92
    v_sub_f32 v113, v125, v93
    v_mul_f32 v113, 0x3fb8aa3b, v113
    v_exp_f32 v113, v113
    v_sub_f32 v93, v93, v124
    v_mul_f32 v93, 0x3fb8aa3b, v93
    v_exp_f32 v93, v93
    v_sub_f32 v114, v125, v94
    v_mul_f32 v114, 0x3fb8aa3b, v114
    v_exp_f32 v114, v114
    v_sub_f32 v94, v94, v124
    v_mul_f32 v94, 0x3fb8aa3b, v94
    v_exp_f32 v94, v94
    v_sub_f32 v115, v125, v95
    v_mul_f32 v115, 0x3fb8aa3b, v115
    v_exp_f32 v115, v115
    v_sub_f32 v95, v95, v124
    v_mul_f32 v95, 0x3fb8aa3b, v95
    v_exp_f32 v95, v95
    v_sub_f32 v116, v125, v96
    v_mul_f32 v116, 0x3fb8aa3b, v116
    v_exp_f32 v116, v116
    v_sub_f32 v96, v96, v124
    v_mul_f32 v96, 0x3fb8aa3b, v96
    v_exp_f32 v96, v96
    v_sub_f32 v117, v125, v97
    v_mul_f32 v117, 0x3fb8aa3b, v117
    v_exp_f32 v117, v117
    v_sub_f32 v97, v97, v124
    v_mul_f32 v97, 0x3fb8aa3b, v97
    v_exp_f32 v97, v97
    v_sub_f32 v118, v125, v98
    v_mul_f32 v118, 0x3fb8aa3b, v118
    v_exp_f32 v118, v118
    v_sub_f32 v98, v98, v124
    v_mul_f32 v98, 0x3fb8aa3b, v98
    v_exp_f32 v98, v98
    v_sub_f32 v119, v125, v99
    v_mul_f32 v119, 0x3fb8aa3b, v119
    v_exp_f32 v119, v119
    v_sub_f32 v99, v99, v124
    v_mul_f32 v99, 0x3fb8aa3b, v99
    v_exp_f32 v99, v99
    v_sub_f32 v120, v125, v100
    v_mul_f32 v120, 0x3fb8aa3b, v120
    v_exp_f32 v120, v120
    v_sub_f32 v100, v100, v124
    v_mul_f32 v100, 0x3fb8aa3b, v100
    v_exp_f32 v100, v100
    v_sub_f32 v121, v125, v101
    v_mul_f32 v121, 0x3fb8aa3b, v121
    v_exp_f32 v121, v121
    v_sub_f32 v101, v101, v124
    v_mul_f32 v101, 0x3fb8aa3b, v101
    v_exp_f32 v101, v101
    v_sub_f32 v122, v125, v102
    v_mul_f32 v122, 0x3fb8aa3b, v122
    v_exp_f32 v122, v122
    v_sub_f32 v102, v102, v124
    v_mul_f32 v102, 0x3fb8aa3b, v102
    v_exp_f32 v102, v102
    v_sub_f32 v123, v125, v103
    v_mul_f32 v123, 0x3fb8aa3b, v123
    v_exp_f32 v123, v123
    v_sub_f32 v103, v103, v124
    v_mul_f32 v103, 0x3fb8aa3b, v103
    v_exp_f32 v103, v103
    s_nop 0
    v_add_f32 v126, v84, v85
    v_add_f32 v127, v104, v105
    v_add_f32 v126, v126, v86
    v_add_f32 v127, v127, v106
    v_add_f32 v126, v126, v87
    v_add_f32 v127, v127, v107
    v_add_f32 v126, v126, v88
    v_add_f32 v127, v127, v108
    v_add_f32 v126, v126, v89
    v_add_f32 v127, v127, v109
    v_add_f32 v126, v126, v90
    v_add_f32 v127, v127, v110
    v_add_f32 v126, v126, v91
    v_add_f32 v127, v127, v111
    v_add_f32 v126, v126, v92
    v_add_f32 v127, v127, v112
    v_add_f32 v126, v126, v93
    v_add_f32 v127, v127, v113
    v_add_f32 v126, v126, v94
    v_add_f32 v127, v127, v114
    v_add_f32 v126, v126, v95
    v_add_f32 v127, v127, v115
    v_add_f32 v126, v126, v96
    v_add_f32 v127, v127, v116
    v_add_f32 v126, v126, v97
    v_add_f32 v127, v127, v117
    v_add_f32 v126, v126, v98
    v_add_f32 v127, v127, v118
    v_add_f32 v126, v126, v99
    v_add_f32 v127, v127, v119
    v_add_f32 v126, v126, v100
    v_add_f32 v127, v127, v120
    v_add_f32 v126, v126, v101
    v_add_f32 v127, v127, v121
    v_add_f32 v126, v126, v102
    v_add_f32 v127, v127, v122
    v_add_f32 v126, v126, v103
    v_add_f32 v127, v127, v123
    v_rcp_f32 v126, v126
    v_rcp_f32 v127, v127
    s_nop 0
    v_mul_f32 v84, v84, v126
    v_mul_f32 v104, v104, v127
    v_mul_f32 v85, v85, v126
    v_mul_f32 v105, v105, v127
    v_mul_f32 v86, v86, v126
    v_mul_f32 v106, v106, v127
    v_mul_f32 v87, v87, v126
    v_mul_f32 v107, v107, v127
    v_mul_f32 v88, v88, v126
    v_mul_f32 v108, v108, v127
    v_mul_f32 v89, v89, v126
    v_mul_f32 v109, v109, v127
    v_mul_f32 v90, v90, v126
    v_mul_f32 v110, v110, v127
    v_mul_f32 v91, v91, v126
    v_mul_f32 v111, v111, v127
    v_mul_f32 v92, v92, v126
    v_mul_f32 v112, v112, v127
    v_mul_f32 v93, v93, v126
    v_mul_f32 v113, v113, v127
    v_mul_f32 v94, v94, v126
    v_mul_f32 v114, v114, v127
    v_mul_f32 v95, v95, v126
    v_mul_f32 v115, v115, v127
    v_mul_f32 v96, v96, v126
    v_mul_f32 v116, v116, v127
    v_mul_f32 v97, v97, v126
    v_mul_f32 v117, v117, v127
    v_mul_f32 v98, v98, v126
    v_mul_f32 v118, v118, v127
    v_mul_f32 v99, v99, v126
    v_mul_f32 v119, v119, v127
    v_mul_f32 v100, v100, v126
    v_mul_f32 v120, v120, v127
    v_mul_f32 v101, v101, v126
    v_mul_f32 v121, v121, v127
    v_mul_f32 v102, v102, v126
    v_mul_f32 v122, v122, v127
    v_mul_f32 v103, v103, v126
    v_mul_f32 v123, v123, v127
    v_cvt_pk_bf16_f32 v124, v84, v85
    v_lshlrev_b32 v84, 16, v124
    v_and_b32 v85, 0xffff0000, v124
    v_cvt_pk_bf16_f32 v124, v86, v87
    v_lshlrev_b32 v86, 16, v124
    v_and_b32 v87, 0xffff0000, v124
    v_cvt_pk_bf16_f32 v124, v88, v89
    v_lshlrev_b32 v88, 16, v124
    v_and_b32 v89, 0xffff0000, v124
    v_cvt_pk_bf16_f32 v124, v90, v91
    v_lshlrev_b32 v90, 16, v124
    v_and_b32 v91, 0xffff0000, v124
    v_cvt_pk_bf16_f32 v124, v92, v93
    v_lshlrev_b32 v92, 16, v124
    v_and_b32 v93, 0xffff0000, v124
    v_cvt_pk_bf16_f32 v124, v94, v95
    v_lshlrev_b32 v94, 16, v124
    v_and_b32 v95, 0xffff0000, v124
    v_cvt_pk_bf16_f32 v124, v96, v97
    v_lshlrev_b32 v96, 16, v124
    v_and_b32 v97, 0xffff0000, v124
    v_cvt_pk_bf16_f32 v124, v98, v99
    v_lshlrev_b32 v98, 16, v124
    v_and_b32 v99, 0xffff0000, v124
    v_cvt_pk_bf16_f32 v124, v100, v101
    v_lshlrev_b32 v100, 16, v124
    v_and_b32 v101, 0xffff0000, v124
    v_cvt_pk_bf16_f32 v124, v102, v103
    v_lshlrev_b32 v102, 16, v124
    v_and_b32 v103, 0xffff0000, v124
    v_cvt_pk_bf16_f32 v124, v104, v105
    v_lshlrev_b32 v104, 16, v124
    v_and_b32 v105, 0xffff0000, v124
    v_cvt_pk_bf16_f32 v124, v106, v107
    v_lshlrev_b32 v106, 16, v124
    v_and_b32 v107, 0xffff0000, v124
    v_cvt_pk_bf16_f32 v124, v108, v109
    v_lshlrev_b32 v108, 16, v124
    v_and_b32 v109, 0xffff0000, v124
    v_cvt_pk_bf16_f32 v124, v110, v111
    v_lshlrev_b32 v110, 16, v124
    v_and_b32 v111, 0xffff0000, v124
    v_cvt_pk_bf16_f32 v124, v112, v113
    v_lshlrev_b32 v112, 16, v124
    v_and_b32 v113, 0xffff0000, v124
    v_cvt_pk_bf16_f32 v124, v114, v115
    v_lshlrev_b32 v114, 16, v124
    v_and_b32 v115, 0xffff0000, v124
    v_cvt_pk_bf16_f32 v124, v116, v117
    v_lshlrev_b32 v116, 16, v124
    v_and_b32 v117, 0xffff0000, v124
    v_cvt_pk_bf16_f32 v124, v118, v119
    v_lshlrev_b32 v118, 16, v124
    v_and_b32 v119, 0xffff0000, v124
    v_cvt_pk_bf16_f32 v124, v120, v121
    v_lshlrev_b32 v120, 16, v124
    v_and_b32 v121, 0xffff0000, v124
    v_cvt_pk_bf16_f32 v124, v122, v123
    v_lshlrev_b32 v122, 16, v124
    v_and_b32 v123, 0xffff0000, v124
    v_mov_b32 v64, 0
    v_mov_b32 v65, 0
    v_mov_b32 v66, 0
    v_mov_b32 v67, 0
    v_mov_b32 v68, 0
    v_mov_b32 v69, 0
    v_mov_b32 v70, 0
    v_mov_b32 v71, 0
    v_mov_b32 v72, 0
    v_mov_b32 v73, 0
    v_mov_b32 v74, 0
    v_mov_b32 v75, 0
    v_mov_b32 v76, 0
    v_mov_b32 v77, 0
    v_mov_b32 v78, 0
    v_mov_b32 v79, 0
    v_mov_b32 v80, 0
    v_mov_b32 v81, 0
    v_mov_b32 v82, 0
    v_mov_b32 v83, 0
    v_mov_b32 v128, 0x358637bd
    ds_read_b128 v[168:171], v2 offset:2048
    ds_read_b128 v[172:175], v2 offset:2064
    ds_read_b128 v[176:179], v2 offset:2080
    ds_read_b128 v[180:183], v2 offset:2096
    ds_read_b128 v[184:187], v2 offset:2112
    ds_read_b128 v[188:191], v2 offset:2128
    ds_read_b128 v[192:195], v2 offset:2144
    ds_read_b128 v[196:199], v2 offset:2160
    ds_read_b128 v[200:203], v2 offset:2176
    ds_read_b128 v[204:207], v2 offset:2192
    ds_read_b128 v[208:211], v2 offset:2208
    ds_read_b128 v[212:215], v2 offset:2224
    s_waitcnt lgkmcnt(6)
    v_pk_fma_f32 v[64:65], v[84:85], v[168:169], v[64:65] op_sel:[0,0,0] op_sel_hi:[0,1,1]
    v_pk_fma_f32 v[66:67], v[84:85], v[170:171], v[66:67] op_sel:[0,0,0] op_sel_hi:[0,1,1]
    v_pk_fma_f32 v[68:69], v[84:85], v[172:173], v[68:69] op_sel:[0,0,0] op_sel_hi:[0,1,1]
    v_pk_fma_f32 v[70:71], v[84:85], v[174:175], v[70:71] op_sel:[0,0,0] op_sel_hi:[0,1,1]
    v_pk_fma_f32 v[72:73], v[84:85], v[176:177], v[72:73] op_sel:[0,0,0] op_sel_hi:[0,1,1]
    v_pk_fma_f32 v[74:75], v[84:85], v[178:179], v[74:75] op_sel:[0,0,0] op_sel_hi:[0,1,1]
    v_pk_fma_f32 v[76:77], v[84:85], v[180:181], v[76:77] op_sel:[0,0,0] op_sel_hi:[0,1,1]
    v_pk_fma_f32 v[78:79], v[84:85], v[182:183], v[78:79] op_sel:[0,0,0] op_sel_hi:[0,1,1]
    v_pk_fma_f32 v[80:81], v[84:85], v[184:185], v[80:81] op_sel:[0,0,0] op_sel_hi:[0,1,1]
    v_pk_fma_f32 v[82:83], v[84:85], v[186:187], v[82:83] op_sel:[0,0,0] op_sel_hi:[0,1,1]
    v_fmac_f32 v128, v84, v188
    ds_read_b128 v[168:171], v2 offset:2240
    ds_read_b128 v[172:175], v2 offset:2256
    ds_read_b128 v[176:179], v2 offset:2272
    ds_read_b128 v[180:183], v2 offset:2288
    ds_read_b128 v[184:187], v2 offset:2304
    ds_read_b128 v[188:191], v2 offset:2320
    s_waitcnt lgkmcnt(6)
    v_pk_fma_f32 v[64:65], v[84:85], v[192:193], v[64:65] op_sel:[1,0,0] op_sel_hi:[1,1,1]
    v_pk_fma_f32 v[66:67], v[84:85], v[194:195], v[66:67] op_sel:[1,0,0] op_sel_hi:[1,1,1]
    v_pk_fma_f32 v[68:69], v[84:85], v[196:197], v[68:69] op_sel:[1,0,0] op_sel_hi:[1,1,1]
    v_pk_fma_f32 v[70:71], v[84:85], v[198:199], v[70:71] op_sel:[1,0,0] op_sel_hi:[1,1,1]
    v_pk_fma_f32 v[72:73], v[84:85], v[200:201], v[72:73] op_sel:[1,0,0] op_sel_hi:[1,1,1]
    v_pk_fma_f32 v[74:75], v[84:85], v[202:203], v[74:75] op_sel:[1,0,0] op_sel_hi:[1,1,1]
    v_pk_fma_f32 v[76:77], v[84:85], v[204:205], v[76:77] op_sel:[1,0,0] op_sel_hi:[1,1,1]
    v_pk_fma_f32 v[78:79], v[84:85], v[206:207], v[78:79] op_sel:[1,0,0] op_sel_hi:[1,1,1]
    v_pk_fma_f32 v[80:81], v[84:85], v[208:209], v[80:81] op_sel:[1,0,0] op_sel_hi:[1,1,1]
    v_pk_fma_f32 v[82:83], v[84:85], v[210:211], v[82:83] op_sel:[1,0,0] op_sel_hi:[1,1,1]
    v_fmac_f32 v128, v85, v212
    ds_read_b128 v[192:195], v2 offset:2336
    ds_read_b128 v[196:199], v2 offset:2352
    ds_read_b128 v[200:203], v2 offset:2368
    ds_read_b128 v[204:207], v2 offset:2384
    ds_read_b128 v[208:211], v2 offset:2400
    ds_read_b128 v[212:215], v2 offset:2416
    s_waitcnt lgkmcnt(6)
    v_pk_fma_f32 v[64:65], v[86:87], v[168:169], v[64:65] op_sel:[0,0,0] op_sel_hi:[0,1,1]
    v_pk_fma_f32 v[66:67], v[86:87], v[170:171], v[66:67] op_sel:[0,0,0] op_sel_hi:[0,1,1]
    v_pk_fma_f32 v[68:69], v[86:87], v[172:173], v[68:69] op_sel:[0,0,0] op_sel_hi:[0,1,1]
    v_pk_fma_f32 v[70:71], v[86:87], v[174:175], v[70:71] op_sel:[0,0,0] op_sel_hi:[0,1,1]
    v_pk_fma_f32 v[72:73], v[86:87], v[176:177], v[72:73] op_sel:[0,0,0] op_sel_hi:[0,1,1]
    v_pk_fma_f32 v[74:75], v[86:87], v[178:179], v[74:75] op_sel:[0,0,0] op_sel_hi:[0,1,1]
    v_pk_fma_f32 v[76:77], v[86:87], v[180:181], v[76:77] op_sel:[0,0,0] op_sel_hi:[0,1,1]
    v_pk_fma_f32 v[78:79], v[86:87], v[182:183], v[78:79] op_sel:[0,0,0] op_sel_hi:[0,1,1]
    v_pk_fma_f32 v[80:81], v[86:87], v[184:185], v[80:81] op_sel:[0,0,0] op_sel_hi:[0,1,1]
    v_pk_fma_f32 v[82:83], v[86:87], v[186:187], v[82:83] op_sel:[0,0,0] op_sel_hi:[0,1,1]
    v_fmac_f32 v128, v86, v188
    ds_read_b128 v[168:171], v2 offset:2432
    ds_read_b128 v[172:175], v2 offset:2448
    ds_read_b128 v[176:179], v2 offset:2464
    ds_read_b128 v[180:183], v2 offset:2480
    ds_read_b128 v[184:187], v2 offset:2496
    ds_read_b128 v[188:191], v2 offset:2512
    s_waitcnt lgkmcnt(6)
    v_pk_fma_f32 v[64:65], v[86:87], v[192:193], v[64:65] op_sel:[1,0,0] op_sel_hi:[1,1,1]
    v_pk_fma_f32 v[66:67], v[86:87], v[194:195], v[66:67] op_sel:[1,0,0] op_sel_hi:[1,1,1]
    v_pk_fma_f32 v[68:69], v[86:87], v[196:197], v[68:69] op_sel:[1,0,0] op_sel_hi:[1,1,1]
    v_pk_fma_f32 v[70:71], v[86:87], v[198:199], v[70:71] op_sel:[1,0,0] op_sel_hi:[1,1,1]
    v_pk_fma_f32 v[72:73], v[86:87], v[200:201], v[72:73] op_sel:[1,0,0] op_sel_hi:[1,1,1]
    v_pk_fma_f32 v[74:75], v[86:87], v[202:203], v[74:75] op_sel:[1,0,0] op_sel_hi:[1,1,1]
    v_pk_fma_f32 v[76:77], v[86:87], v[204:205], v[76:77] op_sel:[1,0,0] op_sel_hi:[1,1,1]
    v_pk_fma_f32 v[78:79], v[86:87], v[206:207], v[78:79] op_sel:[1,0,0] op_sel_hi:[1,1,1]
    v_pk_fma_f32 v[80:81], v[86:87], v[208:209], v[80:81] op_sel:[1,0,0] op_sel_hi:[1,1,1]
    v_pk_fma_f32 v[82:83], v[86:87], v[210:211], v[82:83] op_sel:[1,0,0] op_sel_hi:[1,1,1]
    v_fmac_f32 v128, v87, v212
    ds_read_b128 v[192:195], v2 offset:2528
    ds_read_b128 v[196:199], v2 offset:2544
    ds_read_b128 v[200:203], v2 offset:2560
    ds_read_b128 v[204:207], v2 offset:2576
    ds_read_b128 v[208:211], v2 offset:2592
    ds_read_b128 v[212:215], v2 offset:2608
    s_waitcnt lgkmcnt(6)
    v_pk_fma_f32 v[64:65], v[88:89], v[168:169], v[64:65] op_sel:[0,0,0] op_sel_hi:[0,1,1]
    v_pk_fma_f32 v[66:67], v[88:89], v[170:171], v[66:67] op_sel:[0,0,0] op_sel_hi:[0,1,1]
    v_pk_fma_f32 v[68:69], v[88:89], v[172:173], v[68:69] op_sel:[0,0,0] op_sel_hi:[0,1,1]
    v_pk_fma_f32 v[70:71], v[88:89], v[174:175], v[70:71] op_sel:[0,0,0] op_sel_hi:[0,1,1]
    v_pk_fma_f32 v[72:73], v[88:89], v[176:177], v[72:73] op_sel:[0,0,0] op_sel_hi:[0,1,1]
    v_pk_fma_f32 v[74:75], v[88:89], v[178:179], v[74:75] op_sel:[0,0,0] op_sel_hi:[0,1,1]
    v_pk_fma_f32 v[76:77], v[88:89], v[180:181], v[76:77] op_sel:[0,0,0] op_sel_hi:[0,1,1]
    v_pk_fma_f32 v[78:79], v[88:89], v[182:183], v[78:79] op_sel:[0,0,0] op_sel_hi:[0,1,1]
    v_pk_fma_f32 v[80:81], v[88:89], v[184:185], v[80:81] op_sel:[0,0,0] op_sel_hi:[0,1,1]
    v_pk_fma_f32 v[82:83], v[88:89], v[186:187], v[82:83] op_sel:[0,0,0] op_sel_hi:[0,1,1]
    v_fmac_f32 v128, v88, v188
    ds_read_b128 v[168:171], v2 offset:2624
    ds_read_b128 v[172:175], v2 offset:2640
    ds_read_b128 v[176:179], v2 offset:2656
    ds_read_b128 v[180:183], v2 offset:2672
    ds_read_b128 v[184:187], v2 offset:2688
    ds_read_b128 v[188:191], v2 offset:2704
    s_waitcnt lgkmcnt(6)
    v_pk_fma_f32 v[64:65], v[88:89], v[192:193], v[64:65] op_sel:[1,0,0] op_sel_hi:[1,1,1]
    v_pk_fma_f32 v[66:67], v[88:89], v[194:195], v[66:67] op_sel:[1,0,0] op_sel_hi:[1,1,1]
    v_pk_fma_f32 v[68:69], v[88:89], v[196:197], v[68:69] op_sel:[1,0,0] op_sel_hi:[1,1,1]
    v_pk_fma_f32 v[70:71], v[88:89], v[198:199], v[70:71] op_sel:[1,0,0] op_sel_hi:[1,1,1]
    v_pk_fma_f32 v[72:73], v[88:89], v[200:201], v[72:73] op_sel:[1,0,0] op_sel_hi:[1,1,1]
    v_pk_fma_f32 v[74:75], v[88:89], v[202:203], v[74:75] op_sel:[1,0,0] op_sel_hi:[1,1,1]
    v_pk_fma_f32 v[76:77], v[88:89], v[204:205], v[76:77] op_sel:[1,0,0] op_sel_hi:[1,1,1]
    v_pk_fma_f32 v[78:79], v[88:89], v[206:207], v[78:79] op_sel:[1,0,0] op_sel_hi:[1,1,1]
    v_pk_fma_f32 v[80:81], v[88:89], v[208:209], v[80:81] op_sel:[1,0,0] op_sel_hi:[1,1,1]
    v_pk_fma_f32 v[82:83], v[88:89], v[210:211], v[82:83] op_sel:[1,0,0] op_sel_hi:[1,1,1]
    v_fmac_f32 v128, v89, v212
    ds_read_b128 v[192:195], v2 offset:2720
    ds_read_b128 v[196:199], v2 offset:2736
    ds_read_b128 v[200:203], v2 offset:2752
    ds_read_b128 v[204:207], v2 offset:2768
    ds_read_b128 v[208:211], v2 offset:2784
    ds_read_b128 v[212:215], v2 offset:2800
    s_waitcnt lgkmcnt(6)
    v_pk_fma_f32 v[64:65], v[90:91], v[168:169], v[64:65] op_sel:[0,0,0] op_sel_hi:[0,1,1]
    v_pk_fma_f32 v[66:67], v[90:91], v[170:171], v[66:67] op_sel:[0,0,0] op_sel_hi:[0,1,1]
    v_pk_fma_f32 v[68:69], v[90:91], v[172:173], v[68:69] op_sel:[0,0,0] op_sel_hi:[0,1,1]
    v_pk_fma_f32 v[70:71], v[90:91], v[174:175], v[70:71] op_sel:[0,0,0] op_sel_hi:[0,1,1]
    v_pk_fma_f32 v[72:73], v[90:91], v[176:177], v[72:73] op_sel:[0,0,0] op_sel_hi:[0,1,1]
    v_pk_fma_f32 v[74:75], v[90:91], v[178:179], v[74:75] op_sel:[0,0,0] op_sel_hi:[0,1,1]
    v_pk_fma_f32 v[76:77], v[90:91], v[180:181], v[76:77] op_sel:[0,0,0] op_sel_hi:[0,1,1]
    v_pk_fma_f32 v[78:79], v[90:91], v[182:183], v[78:79] op_sel:[0,0,0] op_sel_hi:[0,1,1]
    v_pk_fma_f32 v[80:81], v[90:91], v[184:185], v[80:81] op_sel:[0,0,0] op_sel_hi:[0,1,1]
    v_pk_fma_f32 v[82:83], v[90:91], v[186:187], v[82:83] op_sel:[0,0,0] op_sel_hi:[0,1,1]
    v_fmac_f32 v128, v90, v188
    ds_read_b128 v[168:171], v2 offset:2816
    ds_read_b128 v[172:175], v2 offset:2832
    ds_read_b128 v[176:179], v2 offset:2848
    ds_read_b128 v[180:183], v2 offset:2864
    ds_read_b128 v[184:187], v2 offset:2880
    ds_read_b128 v[188:191], v2 offset:2896
    s_waitcnt lgkmcnt(6)
    v_pk_fma_f32 v[64:65], v[90:91], v[192:193], v[64:65] op_sel:[1,0,0] op_sel_hi:[1,1,1]
    v_pk_fma_f32 v[66:67], v[90:91], v[194:195], v[66:67] op_sel:[1,0,0] op_sel_hi:[1,1,1]
    v_pk_fma_f32 v[68:69], v[90:91], v[196:197], v[68:69] op_sel:[1,0,0] op_sel_hi:[1,1,1]
    v_pk_fma_f32 v[70:71], v[90:91], v[198:199], v[70:71] op_sel:[1,0,0] op_sel_hi:[1,1,1]
    v_pk_fma_f32 v[72:73], v[90:91], v[200:201], v[72:73] op_sel:[1,0,0] op_sel_hi:[1,1,1]
    v_pk_fma_f32 v[74:75], v[90:91], v[202:203], v[74:75] op_sel:[1,0,0] op_sel_hi:[1,1,1]
    v_pk_fma_f32 v[76:77], v[90:91], v[204:205], v[76:77] op_sel:[1,0,0] op_sel_hi:[1,1,1]
    v_pk_fma_f32 v[78:79], v[90:91], v[206:207], v[78:79] op_sel:[1,0,0] op_sel_hi:[1,1,1]
    v_pk_fma_f32 v[80:81], v[90:91], v[208:209], v[80:81] op_sel:[1,0,0] op_sel_hi:[1,1,1]
    v_pk_fma_f32 v[82:83], v[90:91], v[210:211], v[82:83] op_sel:[1,0,0] op_sel_hi:[1,1,1]
    v_fmac_f32 v128, v91, v212
    ds_read_b128 v[192:195], v2 offset:2912
    ds_read_b128 v[196:199], v2 offset:2928
    ds_read_b128 v[200:203], v2 offset:2944
    ds_read_b128 v[204:207], v2 offset:2960
    ds_read_b128 v[208:211], v2 offset:2976
    ds_read_b128 v[212:215], v2 offset:2992
    s_waitcnt lgkmcnt(6)
    v_pk_fma_f32 v[64:65], v[92:93], v[168:169], v[64:65] op_sel:[0,0,0] op_sel_hi:[0,1,1]
    v_pk_fma_f32 v[66:67], v[92:93], v[170:171], v[66:67] op_sel:[0,0,0] op_sel_hi:[0,1,1]
    v_pk_fma_f32 v[68:69], v[92:93], v[172:173], v[68:69] op_sel:[0,0,0] op_sel_hi:[0,1,1]
    v_pk_fma_f32 v[70:71], v[92:93], v[174:175], v[70:71] op_sel:[0,0,0] op_sel_hi:[0,1,1]
    v_pk_fma_f32 v[72:73], v[92:93], v[176:177], v[72:73] op_sel:[0,0,0] op_sel_hi:[0,1,1]
    v_pk_fma_f32 v[74:75], v[92:93], v[178:179], v[74:75] op_sel:[0,0,0] op_sel_hi:[0,1,1]
    v_pk_fma_f32 v[76:77], v[92:93], v[180:181], v[76:77] op_sel:[0,0,0] op_sel_hi:[0,1,1]
    v_pk_fma_f32 v[78:79], v[92:93], v[182:183], v[78:79] op_sel:[0,0,0] op_sel_hi:[0,1,1]
    v_pk_fma_f32 v[80:81], v[92:93], v[184:185], v[80:81] op_sel:[0,0,0] op_sel_hi:[0,1,1]
    v_pk_fma_f32 v[82:83], v[92:93], v[186:187], v[82:83] op_sel:[0,0,0] op_sel_hi:[0,1,1]
    v_fmac_f32 v128, v92, v188
    ds_read_b128 v[168:171], v2 offset:3008
    ds_read_b128 v[172:175], v2 offset:3024
    ds_read_b128 v[176:179], v2 offset:3040
    ds_read_b128 v[180:183], v2 offset:3056
    ds_read_b128 v[184:187], v2 offset:3072
    ds_read_b128 v[188:191], v2 offset:3088
    s_waitcnt lgkmcnt(6)
    v_pk_fma_f32 v[64:65], v[92:93], v[192:193], v[64:65] op_sel:[1,0,0] op_sel_hi:[1,1,1]
    v_pk_fma_f32 v[66:67], v[92:93], v[194:195], v[66:67] op_sel:[1,0,0] op_sel_hi:[1,1,1]
    v_pk_fma_f32 v[68:69], v[92:93], v[196:197], v[68:69] op_sel:[1,0,0] op_sel_hi:[1,1,1]
    v_pk_fma_f32 v[70:71], v[92:93], v[198:199], v[70:71] op_sel:[1,0,0] op_sel_hi:[1,1,1]
    v_pk_fma_f32 v[72:73], v[92:93], v[200:201], v[72:73] op_sel:[1,0,0] op_sel_hi:[1,1,1]
    v_pk_fma_f32 v[74:75], v[92:93], v[202:203], v[74:75] op_sel:[1,0,0] op_sel_hi:[1,1,1]
    v_pk_fma_f32 v[76:77], v[92:93], v[204:205], v[76:77] op_sel:[1,0,0] op_sel_hi:[1,1,1]
    v_pk_fma_f32 v[78:79], v[92:93], v[206:207], v[78:79] op_sel:[1,0,0] op_sel_hi:[1,1,1]
    v_pk_fma_f32 v[80:81], v[92:93], v[208:209], v[80:81] op_sel:[1,0,0] op_sel_hi:[1,1,1]
    v_pk_fma_f32 v[82:83], v[92:93], v[210:211], v[82:83] op_sel:[1,0,0] op_sel_hi:[1,1,1]
    v_fmac_f32 v128, v93, v212
    ds_read_b128 v[192:195], v2 offset:3104
    ds_read_b128 v[196:199], v2 offset:3120
    ds_read_b128 v[200:203], v2 offset:3136
    ds_read_b128 v[204:207], v2 offset:3152
    ds_read_b128 v[208:211], v2 offset:3168
    ds_read_b128 v[212:215], v2 offset:3184
    s_waitcnt lgkmcnt(6)
    v_pk_fma_f32 v[64:65], v[94:95], v[168:169], v[64:65] op_sel:[0,0,0] op_sel_hi:[0,1,1]
    v_pk_fma_f32 v[66:67], v[94:95], v[170:171], v[66:67] op_sel:[0,0,0] op_sel_hi:[0,1,1]
    v_pk_fma_f32 v[68:69], v[94:95], v[172:173], v[68:69] op_sel:[0,0,0] op_sel_hi:[0,1,1]
    v_pk_fma_f32 v[70:71], v[94:95], v[174:175], v[70:71] op_sel:[0,0,0] op_sel_hi:[0,1,1]
    v_pk_fma_f32 v[72:73], v[94:95], v[176:177], v[72:73] op_sel:[0,0,0] op_sel_hi:[0,1,1]
    v_pk_fma_f32 v[74:75], v[94:95], v[178:179], v[74:75] op_sel:[0,0,0] op_sel_hi:[0,1,1]
    v_pk_fma_f32 v[76:77], v[94:95], v[180:181], v[76:77] op_sel:[0,0,0] op_sel_hi:[0,1,1]
    v_pk_fma_f32 v[78:79], v[94:95], v[182:183], v[78:79] op_sel:[0,0,0] op_sel_hi:[0,1,1]
    v_pk_fma_f32 v[80:81], v[94:95], v[184:185], v[80:81] op_sel:[0,0,0] op_sel_hi:[0,1,1]
    v_pk_fma_f32 v[82:83], v[94:95], v[186:187], v[82:83] op_sel:[0,0,0] op_sel_hi:[0,1,1]
    v_fmac_f32 v128, v94, v188
    ds_read_b128 v[168:171], v2 offset:3200
    ds_read_b128 v[172:175], v2 offset:3216
    ds_read_b128 v[176:179], v2 offset:3232
    ds_read_b128 v[180:183], v2 offset:3248
    ds_read_b128 v[184:187], v2 offset:3264
    ds_read_b128 v[188:191], v2 offset:3280
    s_waitcnt lgkmcnt(6)
    v_pk_fma_f32 v[64:65], v[94:95], v[192:193], v[64:65] op_sel:[1,0,0] op_sel_hi:[1,1,1]
    v_pk_fma_f32 v[66:67], v[94:95], v[194:195], v[66:67] op_sel:[1,0,0] op_sel_hi:[1,1,1]
    v_pk_fma_f32 v[68:69], v[94:95], v[196:197], v[68:69] op_sel:[1,0,0] op_sel_hi:[1,1,1]
    v_pk_fma_f32 v[70:71], v[94:95], v[198:199], v[70:71] op_sel:[1,0,0] op_sel_hi:[1,1,1]
    v_pk_fma_f32 v[72:73], v[94:95], v[200:201], v[72:73] op_sel:[1,0,0] op_sel_hi:[1,1,1]
    v_pk_fma_f32 v[74:75], v[94:95], v[202:203], v[74:75] op_sel:[1,0,0] op_sel_hi:[1,1,1]
    v_pk_fma_f32 v[76:77], v[94:95], v[204:205], v[76:77] op_sel:[1,0,0] op_sel_hi:[1,1,1]
    v_pk_fma_f32 v[78:79], v[94:95], v[206:207], v[78:79] op_sel:[1,0,0] op_sel_hi:[1,1,1]
    v_pk_fma_f32 v[80:81], v[94:95], v[208:209], v[80:81] op_sel:[1,0,0] op_sel_hi:[1,1,1]
    v_pk_fma_f32 v[82:83], v[94:95], v[210:211], v[82:83] op_sel:[1,0,0] op_sel_hi:[1,1,1]
    v_fmac_f32 v128, v95, v212
    ds_read_b128 v[192:195], v2 offset:3296
    ds_read_b128 v[196:199], v2 offset:3312
    ds_read_b128 v[200:203], v2 offset:3328
    ds_read_b128 v[204:207], v2 offset:3344
    ds_read_b128 v[208:211], v2 offset:3360
    ds_read_b128 v[212:215], v2 offset:3376
    s_waitcnt lgkmcnt(6)
    v_pk_fma_f32 v[64:65], v[96:97], v[168:169], v[64:65] op_sel:[0,0,0] op_sel_hi:[0,1,1]
    v_pk_fma_f32 v[66:67], v[96:97], v[170:171], v[66:67] op_sel:[0,0,0] op_sel_hi:[0,1,1]
    v_pk_fma_f32 v[68:69], v[96:97], v[172:173], v[68:69] op_sel:[0,0,0] op_sel_hi:[0,1,1]
    v_pk_fma_f32 v[70:71], v[96:97], v[174:175], v[70:71] op_sel:[0,0,0] op_sel_hi:[0,1,1]
    v_pk_fma_f32 v[72:73], v[96:97], v[176:177], v[72:73] op_sel:[0,0,0] op_sel_hi:[0,1,1]
    v_pk_fma_f32 v[74:75], v[96:97], v[178:179], v[74:75] op_sel:[0,0,0] op_sel_hi:[0,1,1]
    v_pk_fma_f32 v[76:77], v[96:97], v[180:181], v[76:77] op_sel:[0,0,0] op_sel_hi:[0,1,1]
    v_pk_fma_f32 v[78:79], v[96:97], v[182:183], v[78:79] op_sel:[0,0,0] op_sel_hi:[0,1,1]
    v_pk_fma_f32 v[80:81], v[96:97], v[184:185], v[80:81] op_sel:[0,0,0] op_sel_hi:[0,1,1]
    v_pk_fma_f32 v[82:83], v[96:97], v[186:187], v[82:83] op_sel:[0,0,0] op_sel_hi:[0,1,1]
    v_fmac_f32 v128, v96, v188
    ds_read_b128 v[168:171], v2 offset:3392
    ds_read_b128 v[172:175], v2 offset:3408
    ds_read_b128 v[176:179], v2 offset:3424
    ds_read_b128 v[180:183], v2 offset:3440
    ds_read_b128 v[184:187], v2 offset:3456
    ds_read_b128 v[188:191], v2 offset:3472
    s_waitcnt lgkmcnt(6)
    v_pk_fma_f32 v[64:65], v[96:97], v[192:193], v[64:65] op_sel:[1,0,0] op_sel_hi:[1,1,1]
    v_pk_fma_f32 v[66:67], v[96:97], v[194:195], v[66:67] op_sel:[1,0,0] op_sel_hi:[1,1,1]
    v_pk_fma_f32 v[68:69], v[96:97], v[196:197], v[68:69] op_sel:[1,0,0] op_sel_hi:[1,1,1]
    v_pk_fma_f32 v[70:71], v[96:97], v[198:199], v[70:71] op_sel:[1,0,0] op_sel_hi:[1,1,1]
    v_pk_fma_f32 v[72:73], v[96:97], v[200:201], v[72:73] op_sel:[1,0,0] op_sel_hi:[1,1,1]
    v_pk_fma_f32 v[74:75], v[96:97], v[202:203], v[74:75] op_sel:[1,0,0] op_sel_hi:[1,1,1]
    v_pk_fma_f32 v[76:77], v[96:97], v[204:205], v[76:77] op_sel:[1,0,0] op_sel_hi:[1,1,1]
    v_pk_fma_f32 v[78:79], v[96:97], v[206:207], v[78:79] op_sel:[1,0,0] op_sel_hi:[1,1,1]
    v_pk_fma_f32 v[80:81], v[96:97], v[208:209], v[80:81] op_sel:[1,0,0] op_sel_hi:[1,1,1]
    v_pk_fma_f32 v[82:83], v[96:97], v[210:211], v[82:83] op_sel:[1,0,0] op_sel_hi:[1,1,1]
    v_fmac_f32 v128, v97, v212
    ds_read_b128 v[192:195], v2 offset:3488
    ds_read_b128 v[196:199], v2 offset:3504
    ds_read_b128 v[200:203], v2 offset:3520
    ds_read_b128 v[204:207], v2 offset:3536
    ds_read_b128 v[208:211], v2 offset:3552
    ds_read_b128 v[212:215], v2 offset:3568
    s_waitcnt lgkmcnt(6)
    v_pk_fma_f32 v[64:65], v[98:99], v[168:169], v[64:65] op_sel:[0,0,0] op_sel_hi:[0,1,1]
    v_pk_fma_f32 v[66:67], v[98:99], v[170:171], v[66:67] op_sel:[0,0,0] op_sel_hi:[0,1,1]
    v_pk_fma_f32 v[68:69], v[98:99], v[172:173], v[68:69] op_sel:[0,0,0] op_sel_hi:[0,1,1]
    v_pk_fma_f32 v[70:71], v[98:99], v[174:175], v[70:71] op_sel:[0,0,0] op_sel_hi:[0,1,1]
    v_pk_fma_f32 v[72:73], v[98:99], v[176:177], v[72:73] op_sel:[0,0,0] op_sel_hi:[0,1,1]
    v_pk_fma_f32 v[74:75], v[98:99], v[178:179], v[74:75] op_sel:[0,0,0] op_sel_hi:[0,1,1]
    v_pk_fma_f32 v[76:77], v[98:99], v[180:181], v[76:77] op_sel:[0,0,0] op_sel_hi:[0,1,1]
    v_pk_fma_f32 v[78:79], v[98:99], v[182:183], v[78:79] op_sel:[0,0,0] op_sel_hi:[0,1,1]
    v_pk_fma_f32 v[80:81], v[98:99], v[184:185], v[80:81] op_sel:[0,0,0] op_sel_hi:[0,1,1]
    v_pk_fma_f32 v[82:83], v[98:99], v[186:187], v[82:83] op_sel:[0,0,0] op_sel_hi:[0,1,1]
    v_fmac_f32 v128, v98, v188
    ds_read_b128 v[168:171], v2 offset:3584
    ds_read_b128 v[172:175], v2 offset:3600
    ds_read_b128 v[176:179], v2 offset:3616
    ds_read_b128 v[180:183], v2 offset:3632
    ds_read_b128 v[184:187], v2 offset:3648
    ds_read_b128 v[188:191], v2 offset:3664
    s_waitcnt lgkmcnt(6)
    v_pk_fma_f32 v[64:65], v[98:99], v[192:193], v[64:65] op_sel:[1,0,0] op_sel_hi:[1,1,1]
    v_pk_fma_f32 v[66:67], v[98:99], v[194:195], v[66:67] op_sel:[1,0,0] op_sel_hi:[1,1,1]
    v_pk_fma_f32 v[68:69], v[98:99], v[196:197], v[68:69] op_sel:[1,0,0] op_sel_hi:[1,1,1]
    v_pk_fma_f32 v[70:71], v[98:99], v[198:199], v[70:71] op_sel:[1,0,0] op_sel_hi:[1,1,1]
    v_pk_fma_f32 v[72:73], v[98:99], v[200:201], v[72:73] op_sel:[1,0,0] op_sel_hi:[1,1,1]
    v_pk_fma_f32 v[74:75], v[98:99], v[202:203], v[74:75] op_sel:[1,0,0] op_sel_hi:[1,1,1]
    v_pk_fma_f32 v[76:77], v[98:99], v[204:205], v[76:77] op_sel:[1,0,0] op_sel_hi:[1,1,1]
    v_pk_fma_f32 v[78:79], v[98:99], v[206:207], v[78:79] op_sel:[1,0,0] op_sel_hi:[1,1,1]
    v_pk_fma_f32 v[80:81], v[98:99], v[208:209], v[80:81] op_sel:[1,0,0] op_sel_hi:[1,1,1]
    v_pk_fma_f32 v[82:83], v[98:99], v[210:211], v[82:83] op_sel:[1,0,0] op_sel_hi:[1,1,1]
    v_fmac_f32 v128, v99, v212
    ds_read_b128 v[192:195], v2 offset:3680
    ds_read_b128 v[196:199], v2 offset:3696
    ds_read_b128 v[200:203], v2 offset:3712
    ds_read_b128 v[204:207], v2 offset:3728
    ds_read_b128 v[208:211], v2 offset:3744
    ds_read_b128 v[212:215], v2 offset:3760
    s_waitcnt lgkmcnt(6)
    v_pk_fma_f32 v[64:65], v[100:101], v[168:169], v[64:65] op_sel:[0,0,0] op_sel_hi:[0,1,1]
    v_pk_fma_f32 v[66:67], v[100:101], v[170:171], v[66:67] op_sel:[0,0,0] op_sel_hi:[0,1,1]
    v_pk_fma_f32 v[68:69], v[100:101], v[172:173], v[68:69] op_sel:[0,0,0] op_sel_hi:[0,1,1]
    v_pk_fma_f32 v[70:71], v[100:101], v[174:175], v[70:71] op_sel:[0,0,0] op_sel_hi:[0,1,1]
    v_pk_fma_f32 v[72:73], v[100:101], v[176:177], v[72:73] op_sel:[0,0,0] op_sel_hi:[0,1,1]
    v_pk_fma_f32 v[74:75], v[100:101], v[178:179], v[74:75] op_sel:[0,0,0] op_sel_hi:[0,1,1]
    v_pk_fma_f32 v[76:77], v[100:101], v[180:181], v[76:77] op_sel:[0,0,0] op_sel_hi:[0,1,1]
    v_pk_fma_f32 v[78:79], v[100:101], v[182:183], v[78:79] op_sel:[0,0,0] op_sel_hi:[0,1,1]
    v_pk_fma_f32 v[80:81], v[100:101], v[184:185], v[80:81] op_sel:[0,0,0] op_sel_hi:[0,1,1]
    v_pk_fma_f32 v[82:83], v[100:101], v[186:187], v[82:83] op_sel:[0,0,0] op_sel_hi:[0,1,1]
    v_fmac_f32 v128, v100, v188
    ds_read_b128 v[168:171], v2 offset:3776
    ds_read_b128 v[172:175], v2 offset:3792
    ds_read_b128 v[176:179], v2 offset:3808
    ds_read_b128 v[180:183], v2 offset:3824
    ds_read_b128 v[184:187], v2 offset:3840
    ds_read_b128 v[188:191], v2 offset:3856
    s_waitcnt lgkmcnt(6)
    v_pk_fma_f32 v[64:65], v[100:101], v[192:193], v[64:65] op_sel:[1,0,0] op_sel_hi:[1,1,1]
    v_pk_fma_f32 v[66:67], v[100:101], v[194:195], v[66:67] op_sel:[1,0,0] op_sel_hi:[1,1,1]
    v_pk_fma_f32 v[68:69], v[100:101], v[196:197], v[68:69] op_sel:[1,0,0] op_sel_hi:[1,1,1]
    v_pk_fma_f32 v[70:71], v[100:101], v[198:199], v[70:71] op_sel:[1,0,0] op_sel_hi:[1,1,1]
    v_pk_fma_f32 v[72:73], v[100:101], v[200:201], v[72:73] op_sel:[1,0,0] op_sel_hi:[1,1,1]
    v_pk_fma_f32 v[74:75], v[100:101], v[202:203], v[74:75] op_sel:[1,0,0] op_sel_hi:[1,1,1]
    v_pk_fma_f32 v[76:77], v[100:101], v[204:205], v[76:77] op_sel:[1,0,0] op_sel_hi:[1,1,1]
    v_pk_fma_f32 v[78:79], v[100:101], v[206:207], v[78:79] op_sel:[1,0,0] op_sel_hi:[1,1,1]
    v_pk_fma_f32 v[80:81], v[100:101], v[208:209], v[80:81] op_sel:[1,0,0] op_sel_hi:[1,1,1]
    v_pk_fma_f32 v[82:83], v[100:101], v[210:211], v[82:83] op_sel:[1,0,0] op_sel_hi:[1,1,1]
    v_fmac_f32 v128, v101, v212
    ds_read_b128 v[192:195], v2 offset:3872
    ds_read_b128 v[196:199], v2 offset:3888
    ds_read_b128 v[200:203], v2 offset:3904
    ds_read_b128 v[204:207], v2 offset:3920
    ds_read_b128 v[208:211], v2 offset:3936
    ds_read_b128 v[212:215], v2 offset:3952
    s_waitcnt lgkmcnt(6)
    v_pk_fma_f32 v[64:65], v[102:103], v[168:169], v[64:65] op_sel:[0,0,0] op_sel_hi:[0,1,1]
    v_pk_fma_f32 v[66:67], v[102:103], v[170:171], v[66:67] op_sel:[0,0,0] op_sel_hi:[0,1,1]
    v_pk_fma_f32 v[68:69], v[102:103], v[172:173], v[68:69] op_sel:[0,0,0] op_sel_hi:[0,1,1]
    v_pk_fma_f32 v[70:71], v[102:103], v[174:175], v[70:71] op_sel:[0,0,0] op_sel_hi:[0,1,1]
    v_pk_fma_f32 v[72:73], v[102:103], v[176:177], v[72:73] op_sel:[0,0,0] op_sel_hi:[0,1,1]
    v_pk_fma_f32 v[74:75], v[102:103], v[178:179], v[74:75] op_sel:[0,0,0] op_sel_hi:[0,1,1]
    v_pk_fma_f32 v[76:77], v[102:103], v[180:181], v[76:77] op_sel:[0,0,0] op_sel_hi:[0,1,1]
    v_pk_fma_f32 v[78:79], v[102:103], v[182:183], v[78:79] op_sel:[0,0,0] op_sel_hi:[0,1,1]
    v_pk_fma_f32 v[80:81], v[102:103], v[184:185], v[80:81] op_sel:[0,0,0] op_sel_hi:[0,1,1]
    v_pk_fma_f32 v[82:83], v[102:103], v[186:187], v[82:83] op_sel:[0,0,0] op_sel_hi:[0,1,1]
    v_fmac_f32 v128, v102, v188
    ds_read_b128 v[168:171], v2 offset:3968
    ds_read_b128 v[172:175], v2 offset:3984
    ds_read_b128 v[176:179], v2 offset:4000
    ds_read_b128 v[180:183], v2 offset:4016
    ds_read_b128 v[184:187], v2 offset:4032
    ds_read_b128 v[188:191], v2 offset:4048
    s_waitcnt lgkmcnt(6)
    v_pk_fma_f32 v[64:65], v[102:103], v[192:193], v[64:65] op_sel:[1,0,0] op_sel_hi:[1,1,1]
    v_pk_fma_f32 v[66:67], v[102:103], v[194:195], v[66:67] op_sel:[1,0,0] op_sel_hi:[1,1,1]
    v_pk_fma_f32 v[68:69], v[102:103], v[196:197], v[68:69] op_sel:[1,0,0] op_sel_hi:[1,1,1]
    v_pk_fma_f32 v[70:71], v[102:103], v[198:199], v[70:71] op_sel:[1,0,0] op_sel_hi:[1,1,1]
    v_pk_fma_f32 v[72:73], v[102:103], v[200:201], v[72:73] op_sel:[1,0,0] op_sel_hi:[1,1,1]
    v_pk_fma_f32 v[74:75], v[102:103], v[202:203], v[74:75] op_sel:[1,0,0] op_sel_hi:[1,1,1]
    v_pk_fma_f32 v[76:77], v[102:103], v[204:205], v[76:77] op_sel:[1,0,0] op_sel_hi:[1,1,1]
    v_pk_fma_f32 v[78:79], v[102:103], v[206:207], v[78:79] op_sel:[1,0,0] op_sel_hi:[1,1,1]
    v_pk_fma_f32 v[80:81], v[102:103], v[208:209], v[80:81] op_sel:[1,0,0] op_sel_hi:[1,1,1]
    v_pk_fma_f32 v[82:83], v[102:103], v[210:211], v[82:83] op_sel:[1,0,0] op_sel_hi:[1,1,1]
    v_fmac_f32 v128, v103, v212
    ds_read_b128 v[192:195], v2 offset:4064
    ds_read_b128 v[196:199], v2 offset:4080
    ds_read_b128 v[200:203], v2 offset:4096
    ds_read_b128 v[204:207], v2 offset:4112
    ds_read_b128 v[208:211], v2 offset:4128
    ds_read_b128 v[212:215], v2 offset:4144
    s_waitcnt lgkmcnt(6)
    v_pk_fma_f32 v[64:65], v[104:105], v[168:169], v[64:65] op_sel:[0,0,0] op_sel_hi:[0,1,1]
    v_pk_fma_f32 v[66:67], v[104:105], v[170:171], v[66:67] op_sel:[0,0,0] op_sel_hi:[0,1,1]
    v_pk_fma_f32 v[68:69], v[104:105], v[172:173], v[68:69] op_sel:[0,0,0] op_sel_hi:[0,1,1]
    v_pk_fma_f32 v[70:71], v[104:105], v[174:175], v[70:71] op_sel:[0,0,0] op_sel_hi:[0,1,1]
    v_pk_fma_f32 v[72:73], v[104:105], v[176:177], v[72:73] op_sel:[0,0,0] op_sel_hi:[0,1,1]
    v_pk_fma_f32 v[74:75], v[104:105], v[178:179], v[74:75] op_sel:[0,0,0] op_sel_hi:[0,1,1]
    v_pk_fma_f32 v[76:77], v[104:105], v[180:181], v[76:77] op_sel:[0,0,0] op_sel_hi:[0,1,1]
    v_pk_fma_f32 v[78:79], v[104:105], v[182:183], v[78:79] op_sel:[0,0,0] op_sel_hi:[0,1,1]
    v_pk_fma_f32 v[80:81], v[104:105], v[184:185], v[80:81] op_sel:[0,0,0] op_sel_hi:[0,1,1]
    v_pk_fma_f32 v[82:83], v[104:105], v[186:187], v[82:83] op_sel:[0,0,0] op_sel_hi:[0,1,1]
    v_fmac_f32 v128, v104, v188
    ds_read_b128 v[168:171], v2 offset:4160
    ds_read_b128 v[172:175], v2 offset:4176
    ds_read_b128 v[176:179], v2 offset:4192
    ds_read_b128 v[180:183], v2 offset:4208
    ds_read_b128 v[184:187], v2 offset:4224
    ds_read_b128 v[188:191], v2 offset:4240
    s_waitcnt lgkmcnt(6)
    v_pk_fma_f32 v[64:65], v[104:105], v[192:193], v[64:65] op_sel:[1,0,0] op_sel_hi:[1,1,1]
    v_pk_fma_f32 v[66:67], v[104:105], v[194:195], v[66:67] op_sel:[1,0,0] op_sel_hi:[1,1,1]
    v_pk_fma_f32 v[68:69], v[104:105], v[196:197], v[68:69] op_sel:[1,0,0] op_sel_hi:[1,1,1]
    v_pk_fma_f32 v[70:71], v[104:105], v[198:199], v[70:71] op_sel:[1,0,0] op_sel_hi:[1,1,1]
    v_pk_fma_f32 v[72:73], v[104:105], v[200:201], v[72:73] op_sel:[1,0,0] op_sel_hi:[1,1,1]
    v_pk_fma_f32 v[74:75], v[104:105], v[202:203], v[74:75] op_sel:[1,0,0] op_sel_hi:[1,1,1]
    v_pk_fma_f32 v[76:77], v[104:105], v[204:205], v[76:77] op_sel:[1,0,0] op_sel_hi:[1,1,1]
    v_pk_fma_f32 v[78:79], v[104:105], v[206:207], v[78:79] op_sel:[1,0,0] op_sel_hi:[1,1,1]
    v_pk_fma_f32 v[80:81], v[104:105], v[208:209], v[80:81] op_sel:[1,0,0] op_sel_hi:[1,1,1]
    v_pk_fma_f32 v[82:83], v[104:105], v[210:211], v[82:83] op_sel:[1,0,0] op_sel_hi:[1,1,1]
    v_fmac_f32 v128, v105, v212
    ds_read_b128 v[192:195], v2 offset:4256
    ds_read_b128 v[196:199], v2 offset:4272
    ds_read_b128 v[200:203], v2 offset:4288
    ds_read_b128 v[204:207], v2 offset:4304
    ds_read_b128 v[208:211], v2 offset:4320
    ds_read_b128 v[212:215], v2 offset:4336
    s_waitcnt lgkmcnt(6)
    v_pk_fma_f32 v[64:65], v[106:107], v[168:169], v[64:65] op_sel:[0,0,0] op_sel_hi:[0,1,1]
    v_pk_fma_f32 v[66:67], v[106:107], v[170:171], v[66:67] op_sel:[0,0,0] op_sel_hi:[0,1,1]
    v_pk_fma_f32 v[68:69], v[106:107], v[172:173], v[68:69] op_sel:[0,0,0] op_sel_hi:[0,1,1]
    v_pk_fma_f32 v[70:71], v[106:107], v[174:175], v[70:71] op_sel:[0,0,0] op_sel_hi:[0,1,1]
    v_pk_fma_f32 v[72:73], v[106:107], v[176:177], v[72:73] op_sel:[0,0,0] op_sel_hi:[0,1,1]
    v_pk_fma_f32 v[74:75], v[106:107], v[178:179], v[74:75] op_sel:[0,0,0] op_sel_hi:[0,1,1]
    v_pk_fma_f32 v[76:77], v[106:107], v[180:181], v[76:77] op_sel:[0,0,0] op_sel_hi:[0,1,1]
    v_pk_fma_f32 v[78:79], v[106:107], v[182:183], v[78:79] op_sel:[0,0,0] op_sel_hi:[0,1,1]
    v_pk_fma_f32 v[80:81], v[106:107], v[184:185], v[80:81] op_sel:[0,0,0] op_sel_hi:[0,1,1]
    v_pk_fma_f32 v[82:83], v[106:107], v[186:187], v[82:83] op_sel:[0,0,0] op_sel_hi:[0,1,1]
    v_fmac_f32 v128, v106, v188
    ds_read_b128 v[168:171], v2 offset:4352
    ds_read_b128 v[172:175], v2 offset:4368
    ds_read_b128 v[176:179], v2 offset:4384
    ds_read_b128 v[180:183], v2 offset:4400
    ds_read_b128 v[184:187], v2 offset:4416
    ds_read_b128 v[188:191], v2 offset:4432
    s_waitcnt lgkmcnt(6)
    v_pk_fma_f32 v[64:65], v[106:107], v[192:193], v[64:65] op_sel:[1,0,0] op_sel_hi:[1,1,1]
    v_pk_fma_f32 v[66:67], v[106:107], v[194:195], v[66:67] op_sel:[1,0,0] op_sel_hi:[1,1,1]
    v_pk_fma_f32 v[68:69], v[106:107], v[196:197], v[68:69] op_sel:[1,0,0] op_sel_hi:[1,1,1]
    v_pk_fma_f32 v[70:71], v[106:107], v[198:199], v[70:71] op_sel:[1,0,0] op_sel_hi:[1,1,1]
    v_pk_fma_f32 v[72:73], v[106:107], v[200:201], v[72:73] op_sel:[1,0,0] op_sel_hi:[1,1,1]
    v_pk_fma_f32 v[74:75], v[106:107], v[202:203], v[74:75] op_sel:[1,0,0] op_sel_hi:[1,1,1]
    v_pk_fma_f32 v[76:77], v[106:107], v[204:205], v[76:77] op_sel:[1,0,0] op_sel_hi:[1,1,1]
    v_pk_fma_f32 v[78:79], v[106:107], v[206:207], v[78:79] op_sel:[1,0,0] op_sel_hi:[1,1,1]
    v_pk_fma_f32 v[80:81], v[106:107], v[208:209], v[80:81] op_sel:[1,0,0] op_sel_hi:[1,1,1]
    v_pk_fma_f32 v[82:83], v[106:107], v[210:211], v[82:83] op_sel:[1,0,0] op_sel_hi:[1,1,1]
    v_fmac_f32 v128, v107, v212
    ds_read_b128 v[192:195], v2 offset:4448
    ds_read_b128 v[196:199], v2 offset:4464
    ds_read_b128 v[200:203], v2 offset:4480
    ds_read_b128 v[204:207], v2 offset:4496
    ds_read_b128 v[208:211], v2 offset:4512
    ds_read_b128 v[212:215], v2 offset:4528
    s_waitcnt lgkmcnt(6)
    v_pk_fma_f32 v[64:65], v[108:109], v[168:169], v[64:65] op_sel:[0,0,0] op_sel_hi:[0,1,1]
    v_pk_fma_f32 v[66:67], v[108:109], v[170:171], v[66:67] op_sel:[0,0,0] op_sel_hi:[0,1,1]
    v_pk_fma_f32 v[68:69], v[108:109], v[172:173], v[68:69] op_sel:[0,0,0] op_sel_hi:[0,1,1]
    v_pk_fma_f32 v[70:71], v[108:109], v[174:175], v[70:71] op_sel:[0,0,0] op_sel_hi:[0,1,1]
    v_pk_fma_f32 v[72:73], v[108:109], v[176:177], v[72:73] op_sel:[0,0,0] op_sel_hi:[0,1,1]
    v_pk_fma_f32 v[74:75], v[108:109], v[178:179], v[74:75] op_sel:[0,0,0] op_sel_hi:[0,1,1]
    v_pk_fma_f32 v[76:77], v[108:109], v[180:181], v[76:77] op_sel:[0,0,0] op_sel_hi:[0,1,1]
    v_pk_fma_f32 v[78:79], v[108:109], v[182:183], v[78:79] op_sel:[0,0,0] op_sel_hi:[0,1,1]
    v_pk_fma_f32 v[80:81], v[108:109], v[184:185], v[80:81] op_sel:[0,0,0] op_sel_hi:[0,1,1]
    v_pk_fma_f32 v[82:83], v[108:109], v[186:187], v[82:83] op_sel:[0,0,0] op_sel_hi:[0,1,1]
    v_fmac_f32 v128, v108, v188
    ds_read_b128 v[168:171], v2 offset:4544
    ds_read_b128 v[172:175], v2 offset:4560
    ds_read_b128 v[176:179], v2 offset:4576
    ds_read_b128 v[180:183], v2 offset:4592
    ds_read_b128 v[184:187], v2 offset:4608
    ds_read_b128 v[188:191], v2 offset:4624
    s_waitcnt lgkmcnt(6)
    v_pk_fma_f32 v[64:65], v[108:109], v[192:193], v[64:65] op_sel:[1,0,0] op_sel_hi:[1,1,1]
    v_pk_fma_f32 v[66:67], v[108:109], v[194:195], v[66:67] op_sel:[1,0,0] op_sel_hi:[1,1,1]
    v_pk_fma_f32 v[68:69], v[108:109], v[196:197], v[68:69] op_sel:[1,0,0] op_sel_hi:[1,1,1]
    v_pk_fma_f32 v[70:71], v[108:109], v[198:199], v[70:71] op_sel:[1,0,0] op_sel_hi:[1,1,1]
    v_pk_fma_f32 v[72:73], v[108:109], v[200:201], v[72:73] op_sel:[1,0,0] op_sel_hi:[1,1,1]
    v_pk_fma_f32 v[74:75], v[108:109], v[202:203], v[74:75] op_sel:[1,0,0] op_sel_hi:[1,1,1]
    v_pk_fma_f32 v[76:77], v[108:109], v[204:205], v[76:77] op_sel:[1,0,0] op_sel_hi:[1,1,1]
    v_pk_fma_f32 v[78:79], v[108:109], v[206:207], v[78:79] op_sel:[1,0,0] op_sel_hi:[1,1,1]
    v_pk_fma_f32 v[80:81], v[108:109], v[208:209], v[80:81] op_sel:[1,0,0] op_sel_hi:[1,1,1]
    v_pk_fma_f32 v[82:83], v[108:109], v[210:211], v[82:83] op_sel:[1,0,0] op_sel_hi:[1,1,1]
    v_fmac_f32 v128, v109, v212
    ds_read_b128 v[192:195], v2 offset:4640
    ds_read_b128 v[196:199], v2 offset:4656
    ds_read_b128 v[200:203], v2 offset:4672
    ds_read_b128 v[204:207], v2 offset:4688
    ds_read_b128 v[208:211], v2 offset:4704
    ds_read_b128 v[212:215], v2 offset:4720
    s_waitcnt lgkmcnt(6)
    v_pk_fma_f32 v[64:65], v[110:111], v[168:169], v[64:65] op_sel:[0,0,0] op_sel_hi:[0,1,1]
    v_pk_fma_f32 v[66:67], v[110:111], v[170:171], v[66:67] op_sel:[0,0,0] op_sel_hi:[0,1,1]
    v_pk_fma_f32 v[68:69], v[110:111], v[172:173], v[68:69] op_sel:[0,0,0] op_sel_hi:[0,1,1]
    v_pk_fma_f32 v[70:71], v[110:111], v[174:175], v[70:71] op_sel:[0,0,0] op_sel_hi:[0,1,1]
    v_pk_fma_f32 v[72:73], v[110:111], v[176:177], v[72:73] op_sel:[0,0,0] op_sel_hi:[0,1,1]
    v_pk_fma_f32 v[74:75], v[110:111], v[178:179], v[74:75] op_sel:[0,0,0] op_sel_hi:[0,1,1]
    v_pk_fma_f32 v[76:77], v[110:111], v[180:181], v[76:77] op_sel:[0,0,0] op_sel_hi:[0,1,1]
    v_pk_fma_f32 v[78:79], v[110:111], v[182:183], v[78:79] op_sel:[0,0,0] op_sel_hi:[0,1,1]
    v_pk_fma_f32 v[80:81], v[110:111], v[184:185], v[80:81] op_sel:[0,0,0] op_sel_hi:[0,1,1]
    v_pk_fma_f32 v[82:83], v[110:111], v[186:187], v[82:83] op_sel:[0,0,0] op_sel_hi:[0,1,1]
    v_fmac_f32 v128, v110, v188
    ds_read_b128 v[168:171], v2 offset:4736
    ds_read_b128 v[172:175], v2 offset:4752
    ds_read_b128 v[176:179], v2 offset:4768
    ds_read_b128 v[180:183], v2 offset:4784
    ds_read_b128 v[184:187], v2 offset:4800
    ds_read_b128 v[188:191], v2 offset:4816
    s_waitcnt lgkmcnt(6)
    v_pk_fma_f32 v[64:65], v[110:111], v[192:193], v[64:65] op_sel:[1,0,0] op_sel_hi:[1,1,1]
    v_pk_fma_f32 v[66:67], v[110:111], v[194:195], v[66:67] op_sel:[1,0,0] op_sel_hi:[1,1,1]
    v_pk_fma_f32 v[68:69], v[110:111], v[196:197], v[68:69] op_sel:[1,0,0] op_sel_hi:[1,1,1]
    v_pk_fma_f32 v[70:71], v[110:111], v[198:199], v[70:71] op_sel:[1,0,0] op_sel_hi:[1,1,1]
    v_pk_fma_f32 v[72:73], v[110:111], v[200:201], v[72:73] op_sel:[1,0,0] op_sel_hi:[1,1,1]
    v_pk_fma_f32 v[74:75], v[110:111], v[202:203], v[74:75] op_sel:[1,0,0] op_sel_hi:[1,1,1]
    v_pk_fma_f32 v[76:77], v[110:111], v[204:205], v[76:77] op_sel:[1,0,0] op_sel_hi:[1,1,1]
    v_pk_fma_f32 v[78:79], v[110:111], v[206:207], v[78:79] op_sel:[1,0,0] op_sel_hi:[1,1,1]
    v_pk_fma_f32 v[80:81], v[110:111], v[208:209], v[80:81] op_sel:[1,0,0] op_sel_hi:[1,1,1]
    v_pk_fma_f32 v[82:83], v[110:111], v[210:211], v[82:83] op_sel:[1,0,0] op_sel_hi:[1,1,1]
    v_fmac_f32 v128, v111, v212
    ds_read_b128 v[192:195], v2 offset:4832
    ds_read_b128 v[196:199], v2 offset:4848
    ds_read_b128 v[200:203], v2 offset:4864
    ds_read_b128 v[204:207], v2 offset:4880
    ds_read_b128 v[208:211], v2 offset:4896
    ds_read_b128 v[212:215], v2 offset:4912
    s_waitcnt lgkmcnt(6)
    v_pk_fma_f32 v[64:65], v[112:113], v[168:169], v[64:65] op_sel:[0,0,0] op_sel_hi:[0,1,1]
    v_pk_fma_f32 v[66:67], v[112:113], v[170:171], v[66:67] op_sel:[0,0,0] op_sel_hi:[0,1,1]
    v_pk_fma_f32 v[68:69], v[112:113], v[172:173], v[68:69] op_sel:[0,0,0] op_sel_hi:[0,1,1]
    v_pk_fma_f32 v[70:71], v[112:113], v[174:175], v[70:71] op_sel:[0,0,0] op_sel_hi:[0,1,1]
    v_pk_fma_f32 v[72:73], v[112:113], v[176:177], v[72:73] op_sel:[0,0,0] op_sel_hi:[0,1,1]
    v_pk_fma_f32 v[74:75], v[112:113], v[178:179], v[74:75] op_sel:[0,0,0] op_sel_hi:[0,1,1]
    v_pk_fma_f32 v[76:77], v[112:113], v[180:181], v[76:77] op_sel:[0,0,0] op_sel_hi:[0,1,1]
    v_pk_fma_f32 v[78:79], v[112:113], v[182:183], v[78:79] op_sel:[0,0,0] op_sel_hi:[0,1,1]
    v_pk_fma_f32 v[80:81], v[112:113], v[184:185], v[80:81] op_sel:[0,0,0] op_sel_hi:[0,1,1]
    v_pk_fma_f32 v[82:83], v[112:113], v[186:187], v[82:83] op_sel:[0,0,0] op_sel_hi:[0,1,1]
    v_fmac_f32 v128, v112, v188
    ds_read_b128 v[168:171], v2 offset:4928
    ds_read_b128 v[172:175], v2 offset:4944
    ds_read_b128 v[176:179], v2 offset:4960
    ds_read_b128 v[180:183], v2 offset:4976
    ds_read_b128 v[184:187], v2 offset:4992
    ds_read_b128 v[188:191], v2 offset:5008
    s_waitcnt lgkmcnt(6)
    v_pk_fma_f32 v[64:65], v[112:113], v[192:193], v[64:65] op_sel:[1,0,0] op_sel_hi:[1,1,1]
    v_pk_fma_f32 v[66:67], v[112:113], v[194:195], v[66:67] op_sel:[1,0,0] op_sel_hi:[1,1,1]
    v_pk_fma_f32 v[68:69], v[112:113], v[196:197], v[68:69] op_sel:[1,0,0] op_sel_hi:[1,1,1]
    v_pk_fma_f32 v[70:71], v[112:113], v[198:199], v[70:71] op_sel:[1,0,0] op_sel_hi:[1,1,1]
    v_pk_fma_f32 v[72:73], v[112:113], v[200:201], v[72:73] op_sel:[1,0,0] op_sel_hi:[1,1,1]
    v_pk_fma_f32 v[74:75], v[112:113], v[202:203], v[74:75] op_sel:[1,0,0] op_sel_hi:[1,1,1]
    v_pk_fma_f32 v[76:77], v[112:113], v[204:205], v[76:77] op_sel:[1,0,0] op_sel_hi:[1,1,1]
    v_pk_fma_f32 v[78:79], v[112:113], v[206:207], v[78:79] op_sel:[1,0,0] op_sel_hi:[1,1,1]
    v_pk_fma_f32 v[80:81], v[112:113], v[208:209], v[80:81] op_sel:[1,0,0] op_sel_hi:[1,1,1]
    v_pk_fma_f32 v[82:83], v[112:113], v[210:211], v[82:83] op_sel:[1,0,0] op_sel_hi:[1,1,1]
    v_fmac_f32 v128, v113, v212
    ds_read_b128 v[192:195], v2 offset:5024
    ds_read_b128 v[196:199], v2 offset:5040
    ds_read_b128 v[200:203], v2 offset:5056
    ds_read_b128 v[204:207], v2 offset:5072
    ds_read_b128 v[208:211], v2 offset:5088
    ds_read_b128 v[212:215], v2 offset:5104
    s_waitcnt lgkmcnt(6)
    v_pk_fma_f32 v[64:65], v[114:115], v[168:169], v[64:65] op_sel:[0,0,0] op_sel_hi:[0,1,1]
    v_pk_fma_f32 v[66:67], v[114:115], v[170:171], v[66:67] op_sel:[0,0,0] op_sel_hi:[0,1,1]
    v_pk_fma_f32 v[68:69], v[114:115], v[172:173], v[68:69] op_sel:[0,0,0] op_sel_hi:[0,1,1]
    v_pk_fma_f32 v[70:71], v[114:115], v[174:175], v[70:71] op_sel:[0,0,0] op_sel_hi:[0,1,1]
    v_pk_fma_f32 v[72:73], v[114:115], v[176:177], v[72:73] op_sel:[0,0,0] op_sel_hi:[0,1,1]
    v_pk_fma_f32 v[74:75], v[114:115], v[178:179], v[74:75] op_sel:[0,0,0] op_sel_hi:[0,1,1]
    v_pk_fma_f32 v[76:77], v[114:115], v[180:181], v[76:77] op_sel:[0,0,0] op_sel_hi:[0,1,1]
    v_pk_fma_f32 v[78:79], v[114:115], v[182:183], v[78:79] op_sel:[0,0,0] op_sel_hi:[0,1,1]
    v_pk_fma_f32 v[80:81], v[114:115], v[184:185], v[80:81] op_sel:[0,0,0] op_sel_hi:[0,1,1]
    v_pk_fma_f32 v[82:83], v[114:115], v[186:187], v[82:83] op_sel:[0,0,0] op_sel_hi:[0,1,1]
    v_fmac_f32 v128, v114, v188
    ds_read_b128 v[168:171], v2 offset:5120
    ds_read_b128 v[172:175], v2 offset:5136
    ds_read_b128 v[176:179], v2 offset:5152
    ds_read_b128 v[180:183], v2 offset:5168
    ds_read_b128 v[184:187], v2 offset:5184
    ds_read_b128 v[188:191], v2 offset:5200
    s_waitcnt lgkmcnt(6)
    v_pk_fma_f32 v[64:65], v[114:115], v[192:193], v[64:65] op_sel:[1,0,0] op_sel_hi:[1,1,1]
    v_pk_fma_f32 v[66:67], v[114:115], v[194:195], v[66:67] op_sel:[1,0,0] op_sel_hi:[1,1,1]
    v_pk_fma_f32 v[68:69], v[114:115], v[196:197], v[68:69] op_sel:[1,0,0] op_sel_hi:[1,1,1]
    v_pk_fma_f32 v[70:71], v[114:115], v[198:199], v[70:71] op_sel:[1,0,0] op_sel_hi:[1,1,1]
    v_pk_fma_f32 v[72:73], v[114:115], v[200:201], v[72:73] op_sel:[1,0,0] op_sel_hi:[1,1,1]
    v_pk_fma_f32 v[74:75], v[114:115], v[202:203], v[74:75] op_sel:[1,0,0] op_sel_hi:[1,1,1]
    v_pk_fma_f32 v[76:77], v[114:115], v[204:205], v[76:77] op_sel:[1,0,0] op_sel_hi:[1,1,1]
    v_pk_fma_f32 v[78:79], v[114:115], v[206:207], v[78:79] op_sel:[1,0,0] op_sel_hi:[1,1,1]
    v_pk_fma_f32 v[80:81], v[114:115], v[208:209], v[80:81] op_sel:[1,0,0] op_sel_hi:[1,1,1]
    v_pk_fma_f32 v[82:83], v[114:115], v[210:211], v[82:83] op_sel:[1,0,0] op_sel_hi:[1,1,1]
    v_fmac_f32 v128, v115, v212
    ds_read_b128 v[192:195], v2 offset:5216
    ds_read_b128 v[196:199], v2 offset:5232
    ds_read_b128 v[200:203], v2 offset:5248
    ds_read_b128 v[204:207], v2 offset:5264
    ds_read_b128 v[208:211], v2 offset:5280
    ds_read_b128 v[212:215], v2 offset:5296
    s_waitcnt lgkmcnt(6)
    v_pk_fma_f32 v[64:65], v[116:117], v[168:169], v[64:65] op_sel:[0,0,0] op_sel_hi:[0,1,1]
    v_pk_fma_f32 v[66:67], v[116:117], v[170:171], v[66:67] op_sel:[0,0,0] op_sel_hi:[0,1,1]
    v_pk_fma_f32 v[68:69], v[116:117], v[172:173], v[68:69] op_sel:[0,0,0] op_sel_hi:[0,1,1]
    v_pk_fma_f32 v[70:71], v[116:117], v[174:175], v[70:71] op_sel:[0,0,0] op_sel_hi:[0,1,1]
    v_pk_fma_f32 v[72:73], v[116:117], v[176:177], v[72:73] op_sel:[0,0,0] op_sel_hi:[0,1,1]
    v_pk_fma_f32 v[74:75], v[116:117], v[178:179], v[74:75] op_sel:[0,0,0] op_sel_hi:[0,1,1]
    v_pk_fma_f32 v[76:77], v[116:117], v[180:181], v[76:77] op_sel:[0,0,0] op_sel_hi:[0,1,1]
    v_pk_fma_f32 v[78:79], v[116:117], v[182:183], v[78:79] op_sel:[0,0,0] op_sel_hi:[0,1,1]
    v_pk_fma_f32 v[80:81], v[116:117], v[184:185], v[80:81] op_sel:[0,0,0] op_sel_hi:[0,1,1]
    v_pk_fma_f32 v[82:83], v[116:117], v[186:187], v[82:83] op_sel:[0,0,0] op_sel_hi:[0,1,1]
    v_fmac_f32 v128, v116, v188
    ds_read_b128 v[168:171], v2 offset:5312
    ds_read_b128 v[172:175], v2 offset:5328
    ds_read_b128 v[176:179], v2 offset:5344
    ds_read_b128 v[180:183], v2 offset:5360
    ds_read_b128 v[184:187], v2 offset:5376
    ds_read_b128 v[188:191], v2 offset:5392
    s_waitcnt lgkmcnt(6)
    v_pk_fma_f32 v[64:65], v[116:117], v[192:193], v[64:65] op_sel:[1,0,0] op_sel_hi:[1,1,1]
    v_pk_fma_f32 v[66:67], v[116:117], v[194:195], v[66:67] op_sel:[1,0,0] op_sel_hi:[1,1,1]
    v_pk_fma_f32 v[68:69], v[116:117], v[196:197], v[68:69] op_sel:[1,0,0] op_sel_hi:[1,1,1]
    v_pk_fma_f32 v[70:71], v[116:117], v[198:199], v[70:71] op_sel:[1,0,0] op_sel_hi:[1,1,1]
    v_pk_fma_f32 v[72:73], v[116:117], v[200:201], v[72:73] op_sel:[1,0,0] op_sel_hi:[1,1,1]
    v_pk_fma_f32 v[74:75], v[116:117], v[202:203], v[74:75] op_sel:[1,0,0] op_sel_hi:[1,1,1]
    v_pk_fma_f32 v[76:77], v[116:117], v[204:205], v[76:77] op_sel:[1,0,0] op_sel_hi:[1,1,1]
    v_pk_fma_f32 v[78:79], v[116:117], v[206:207], v[78:79] op_sel:[1,0,0] op_sel_hi:[1,1,1]
    v_pk_fma_f32 v[80:81], v[116:117], v[208:209], v[80:81] op_sel:[1,0,0] op_sel_hi:[1,1,1]
    v_pk_fma_f32 v[82:83], v[116:117], v[210:211], v[82:83] op_sel:[1,0,0] op_sel_hi:[1,1,1]
    v_fmac_f32 v128, v117, v212
    ds_read_b128 v[192:195], v2 offset:5408
    ds_read_b128 v[196:199], v2 offset:5424
    ds_read_b128 v[200:203], v2 offset:5440
    ds_read_b128 v[204:207], v2 offset:5456
    ds_read_b128 v[208:211], v2 offset:5472
    ds_read_b128 v[212:215], v2 offset:5488
    s_waitcnt lgkmcnt(6)
    v_pk_fma_f32 v[64:65], v[118:119], v[168:169], v[64:65] op_sel:[0,0,0] op_sel_hi:[0,1,1]
    v_pk_fma_f32 v[66:67], v[118:119], v[170:171], v[66:67] op_sel:[0,0,0] op_sel_hi:[0,1,1]
    v_pk_fma_f32 v[68:69], v[118:119], v[172:173], v[68:69] op_sel:[0,0,0] op_sel_hi:[0,1,1]
    v_pk_fma_f32 v[70:71], v[118:119], v[174:175], v[70:71] op_sel:[0,0,0] op_sel_hi:[0,1,1]
    v_pk_fma_f32 v[72:73], v[118:119], v[176:177], v[72:73] op_sel:[0,0,0] op_sel_hi:[0,1,1]
    v_pk_fma_f32 v[74:75], v[118:119], v[178:179], v[74:75] op_sel:[0,0,0] op_sel_hi:[0,1,1]
    v_pk_fma_f32 v[76:77], v[118:119], v[180:181], v[76:77] op_sel:[0,0,0] op_sel_hi:[0,1,1]
    v_pk_fma_f32 v[78:79], v[118:119], v[182:183], v[78:79] op_sel:[0,0,0] op_sel_hi:[0,1,1]
    v_pk_fma_f32 v[80:81], v[118:119], v[184:185], v[80:81] op_sel:[0,0,0] op_sel_hi:[0,1,1]
    v_pk_fma_f32 v[82:83], v[118:119], v[186:187], v[82:83] op_sel:[0,0,0] op_sel_hi:[0,1,1]
    v_fmac_f32 v128, v118, v188
    ds_read_b128 v[168:171], v2 offset:5504
    ds_read_b128 v[172:175], v2 offset:5520
    ds_read_b128 v[176:179], v2 offset:5536
    ds_read_b128 v[180:183], v2 offset:5552
    ds_read_b128 v[184:187], v2 offset:5568
    ds_read_b128 v[188:191], v2 offset:5584
    s_waitcnt lgkmcnt(6)
    v_pk_fma_f32 v[64:65], v[118:119], v[192:193], v[64:65] op_sel:[1,0,0] op_sel_hi:[1,1,1]
    v_pk_fma_f32 v[66:67], v[118:119], v[194:195], v[66:67] op_sel:[1,0,0] op_sel_hi:[1,1,1]
    v_pk_fma_f32 v[68:69], v[118:119], v[196:197], v[68:69] op_sel:[1,0,0] op_sel_hi:[1,1,1]
    v_pk_fma_f32 v[70:71], v[118:119], v[198:199], v[70:71] op_sel:[1,0,0] op_sel_hi:[1,1,1]
    v_pk_fma_f32 v[72:73], v[118:119], v[200:201], v[72:73] op_sel:[1,0,0] op_sel_hi:[1,1,1]
    v_pk_fma_f32 v[74:75], v[118:119], v[202:203], v[74:75] op_sel:[1,0,0] op_sel_hi:[1,1,1]
    v_pk_fma_f32 v[76:77], v[118:119], v[204:205], v[76:77] op_sel:[1,0,0] op_sel_hi:[1,1,1]
    v_pk_fma_f32 v[78:79], v[118:119], v[206:207], v[78:79] op_sel:[1,0,0] op_sel_hi:[1,1,1]
    v_pk_fma_f32 v[80:81], v[118:119], v[208:209], v[80:81] op_sel:[1,0,0] op_sel_hi:[1,1,1]
    v_pk_fma_f32 v[82:83], v[118:119], v[210:211], v[82:83] op_sel:[1,0,0] op_sel_hi:[1,1,1]
    v_fmac_f32 v128, v119, v212
    ds_read_b128 v[192:195], v2 offset:5600
    ds_read_b128 v[196:199], v2 offset:5616
    ds_read_b128 v[200:203], v2 offset:5632
    ds_read_b128 v[204:207], v2 offset:5648
    ds_read_b128 v[208:211], v2 offset:5664
    ds_read_b128 v[212:215], v2 offset:5680
    s_waitcnt lgkmcnt(6)
    v_pk_fma_f32 v[64:65], v[120:121], v[168:169], v[64:65] op_sel:[0,0,0] op_sel_hi:[0,1,1]
    v_pk_fma_f32 v[66:67], v[120:121], v[170:171], v[66:67] op_sel:[0,0,0] op_sel_hi:[0,1,1]
    v_pk_fma_f32 v[68:69], v[120:121], v[172:173], v[68:69] op_sel:[0,0,0] op_sel_hi:[0,1,1]
    v_pk_fma_f32 v[70:71], v[120:121], v[174:175], v[70:71] op_sel:[0,0,0] op_sel_hi:[0,1,1]
    v_pk_fma_f32 v[72:73], v[120:121], v[176:177], v[72:73] op_sel:[0,0,0] op_sel_hi:[0,1,1]
    v_pk_fma_f32 v[74:75], v[120:121], v[178:179], v[74:75] op_sel:[0,0,0] op_sel_hi:[0,1,1]
    v_pk_fma_f32 v[76:77], v[120:121], v[180:181], v[76:77] op_sel:[0,0,0] op_sel_hi:[0,1,1]
    v_pk_fma_f32 v[78:79], v[120:121], v[182:183], v[78:79] op_sel:[0,0,0] op_sel_hi:[0,1,1]
    v_pk_fma_f32 v[80:81], v[120:121], v[184:185], v[80:81] op_sel:[0,0,0] op_sel_hi:[0,1,1]
    v_pk_fma_f32 v[82:83], v[120:121], v[186:187], v[82:83] op_sel:[0,0,0] op_sel_hi:[0,1,1]
    v_fmac_f32 v128, v120, v188
    ds_read_b128 v[168:171], v2 offset:5696
    ds_read_b128 v[172:175], v2 offset:5712
    ds_read_b128 v[176:179], v2 offset:5728
    ds_read_b128 v[180:183], v2 offset:5744
    ds_read_b128 v[184:187], v2 offset:5760
    ds_read_b128 v[188:191], v2 offset:5776
    s_waitcnt lgkmcnt(6)
    v_pk_fma_f32 v[64:65], v[120:121], v[192:193], v[64:65] op_sel:[1,0,0] op_sel_hi:[1,1,1]
    v_pk_fma_f32 v[66:67], v[120:121], v[194:195], v[66:67] op_sel:[1,0,0] op_sel_hi:[1,1,1]
    v_pk_fma_f32 v[68:69], v[120:121], v[196:197], v[68:69] op_sel:[1,0,0] op_sel_hi:[1,1,1]
    v_pk_fma_f32 v[70:71], v[120:121], v[198:199], v[70:71] op_sel:[1,0,0] op_sel_hi:[1,1,1]
    v_pk_fma_f32 v[72:73], v[120:121], v[200:201], v[72:73] op_sel:[1,0,0] op_sel_hi:[1,1,1]
    v_pk_fma_f32 v[74:75], v[120:121], v[202:203], v[74:75] op_sel:[1,0,0] op_sel_hi:[1,1,1]
    v_pk_fma_f32 v[76:77], v[120:121], v[204:205], v[76:77] op_sel:[1,0,0] op_sel_hi:[1,1,1]
    v_pk_fma_f32 v[78:79], v[120:121], v[206:207], v[78:79] op_sel:[1,0,0] op_sel_hi:[1,1,1]
    v_pk_fma_f32 v[80:81], v[120:121], v[208:209], v[80:81] op_sel:[1,0,0] op_sel_hi:[1,1,1]
    v_pk_fma_f32 v[82:83], v[120:121], v[210:211], v[82:83] op_sel:[1,0,0] op_sel_hi:[1,1,1]
    v_fmac_f32 v128, v121, v212
    ds_read_b128 v[192:195], v2 offset:5792
    ds_read_b128 v[196:199], v2 offset:5808
    ds_read_b128 v[200:203], v2 offset:5824
    ds_read_b128 v[204:207], v2 offset:5840
    ds_read_b128 v[208:211], v2 offset:5856
    ds_read_b128 v[212:215], v2 offset:5872
    s_waitcnt lgkmcnt(6)
    v_pk_fma_f32 v[64:65], v[122:123], v[168:169], v[64:65] op_sel:[0,0,0] op_sel_hi:[0,1,1]
    v_pk_fma_f32 v[66:67], v[122:123], v[170:171], v[66:67] op_sel:[0,0,0] op_sel_hi:[0,1,1]
    v_pk_fma_f32 v[68:69], v[122:123], v[172:173], v[68:69] op_sel:[0,0,0] op_sel_hi:[0,1,1]
    v_pk_fma_f32 v[70:71], v[122:123], v[174:175], v[70:71] op_sel:[0,0,0] op_sel_hi:[0,1,1]
    v_pk_fma_f32 v[72:73], v[122:123], v[176:177], v[72:73] op_sel:[0,0,0] op_sel_hi:[0,1,1]
    v_pk_fma_f32 v[74:75], v[122:123], v[178:179], v[74:75] op_sel:[0,0,0] op_sel_hi:[0,1,1]
    v_pk_fma_f32 v[76:77], v[122:123], v[180:181], v[76:77] op_sel:[0,0,0] op_sel_hi:[0,1,1]
    v_pk_fma_f32 v[78:79], v[122:123], v[182:183], v[78:79] op_sel:[0,0,0] op_sel_hi:[0,1,1]
    v_pk_fma_f32 v[80:81], v[122:123], v[184:185], v[80:81] op_sel:[0,0,0] op_sel_hi:[0,1,1]
    v_pk_fma_f32 v[82:83], v[122:123], v[186:187], v[82:83] op_sel:[0,0,0] op_sel_hi:[0,1,1]
    v_fmac_f32 v128, v122, v188
    s_waitcnt lgkmcnt(0)
    v_pk_fma_f32 v[64:65], v[122:123], v[192:193], v[64:65] op_sel:[1,0,0] op_sel_hi:[1,1,1]
    v_pk_fma_f32 v[66:67], v[122:123], v[194:195], v[66:67] op_sel:[1,0,0] op_sel_hi:[1,1,1]
    v_pk_fma_f32 v[68:69], v[122:123], v[196:197], v[68:69] op_sel:[1,0,0] op_sel_hi:[1,1,1]
    v_pk_fma_f32 v[70:71], v[122:123], v[198:199], v[70:71] op_sel:[1,0,0] op_sel_hi:[1,1,1]
    v_pk_fma_f32 v[72:73], v[122:123], v[200:201], v[72:73] op_sel:[1,0,0] op_sel_hi:[1,1,1]
    v_pk_fma_f32 v[74:75], v[122:123], v[202:203], v[74:75] op_sel:[1,0,0] op_sel_hi:[1,1,1]
    v_pk_fma_f32 v[76:77], v[122:123], v[204:205], v[76:77] op_sel:[1,0,0] op_sel_hi:[1,1,1]
    v_pk_fma_f32 v[78:79], v[122:123], v[206:207], v[78:79] op_sel:[1,0,0] op_sel_hi:[1,1,1]
    v_pk_fma_f32 v[80:81], v[122:123], v[208:209], v[80:81] op_sel:[1,0,0] op_sel_hi:[1,1,1]
    v_pk_fma_f32 v[82:83], v[122:123], v[210:211], v[82:83] op_sel:[1,0,0] op_sel_hi:[1,1,1]
    v_fmac_f32 v128, v123, v212
    v_rcp_f32 v128, v128
    s_nop 0
    v_mul_f32 v64, v64, v128
    v_mul_f32 v65, v65, v128
    v_mul_f32 v66, v66, v128
    v_mul_f32 v67, v67, v128
    v_mul_f32 v68, v68, v128
    v_mul_f32 v69, v69, v128
    v_mul_f32 v70, v70, v128
    v_mul_f32 v71, v71, v128
    v_mul_f32 v72, v72, v128
    v_mul_f32 v73, v73, v128
    v_mul_f32 v74, v74, v128
    v_mul_f32 v75, v75, v128
    v_mul_f32 v76, v76, v128
    v_mul_f32 v77, v77, v128
    v_mul_f32 v78, v78, v128
    v_mul_f32 v79, v79, v128
    v_mul_f32 v80, v80, v128
    v_mul_f32 v81, v81, v128
    v_mul_f32 v82, v82, v128
    v_mul_f32 v83, v83, v128
    v_cvt_pk_bf16_f32 v44, v64, v65
    v_cvt_pk_bf16_f32 v45, v66, v67
    v_cvt_pk_bf16_f32 v46, v68, v69
    v_cvt_pk_bf16_f32 v47, v70, v71
    v_cvt_pk_bf16_f32 v48, v72, v73
    v_cvt_pk_bf16_f32 v49, v74, v75
    v_cvt_pk_bf16_f32 v50, v76, v77
    v_cvt_pk_bf16_f32 v51, v78, v79
    v_cvt_pk_bf16_f32 v52, v80, v81
    v_cvt_pk_bf16_f32 v53, v82, v83
    s_lshl_b32 s6, s5, 8
    v_add_u32 v1, s6, v0
    v_mul_u32_u24 v1, 1280, v1
    s_mul_i32 s7, s4, 40
    v_add_u32 v1, s7, v1
    buffer_store_dwordx2 v[44:45], v1, s[52:55], 0 offen offset:0
    buffer_store_dwordx2 v[46:47], v1, s[52:55], 0 offen offset:8
    buffer_store_dwordx2 v[48:49], v1, s[52:55], 0 offen offset:16
    buffer_store_dwordx2 v[50:51], v1, s[52:55], 0 offen offset:24
    buffer_store_dwordx2 v[52:53], v1, s[52:55], 0 offen offset:32
att_0_kernel_end:
    s_endpgm
.globl wo_0_kernel
.p2align 8
.type wo_0_kernel,@function
wo_0_kernel:
    s_cmp_ge_u32 s2, 160
    s_cbranch_scc1 wo_0_kernel_end
    s_load_dwordx16 s[16:31], s[0:1], 0
    s_load_dwordx4 s[32:35], s[0:1], 64
    s_load_dwordx2 s[36:37], s[0:1], 80
    s_waitcnt lgkmcnt(0)
    s_add_u32 s40, s36, 0x1000000
    s_addc_u32 s41, s37, 0
    s_mov_b32 s42, 0x280000
    s_mov_b32 s43, 0x00020000
    s_mov_b32 s44, s22
    s_mov_b32 s45, s23
    s_mov_b32 s46, 0xc8000
    s_mov_b32 s47, 0x00020000
    s_add_u32 s52, s36, 0x1400000
    s_addc_u32 s53, s37, 0
    s_mov_b32 s54, 0x280000
    s_mov_b32 s55, 0x00020000
    s_mov_b32 s56, s16
    s_mov_b32 s57, s17
    s_mov_b32 s58, 0x280000
    s_mov_b32 s59, 0x00020000
    s_and_b32 s4, s2, 31
    s_lshr_b32 s5, s2, 5
    v_lshrrev_b32 v1, 6, v0
    s_nop 0
    v_readfirstlane_b32 s6, v1
    v_and_b32 v2, 63, v0
    v_and_b32 v3, 15, v0
    v_bfe_u32 v4, v0, 4, 2
    v_lshrrev_b32 v5, 3, v0
    v_and_b32 v6, 7, v0
    s_mul_i32 s7, s4, 81920
    v_mul_u32_u24 v7, 1280, v5
    v_lshl_add_u32 v7, v6, 4, v7
    v_add_u32 v7, s7, v7
    v_mul_u32_u24 v8, 144, v5
    v_lshl_add_u32 v8, v6, 4, v8
    v_and_b32 v9, 127, v0
    v_lshrrev_b32 v9, 3, v9
    s_lshr_b32 s8, s6, 1
    v_mul_u32_u24 v10, 1280, v9
    v_lshl_add_u32 v10, v6, 4, v10
    s_lshl_b32 s9, s5, 8
    s_lshl_b32 s10, s8, 7
    s_add_u32 s9, s9, s10
    s_mov_b32 s60, s44
    s_mov_b32 s61, s45
    s_mov_b32 s62, s46
    s_mov_b32 s63, s47
    v_add_u32 v10, s9, v10
    v_mul_u32_u24 v11, 288, v9
    v_lshl_add_u32 v11, v6, 4, v11
    s_lshl_b32 s10, s8, 7
    v_add_u32 v11, s10, v11
    v_add_u32 v11, 9216, v11
    s_mov_b32 s64, 0
    s_mov_b32 s65, 40960
    s_mov_b32 s68, 0
    s_mov_b32 s69, 20480
    s_mov_b32 s70, 40960
    s_mov_b32 s71, 61440
    s_lshr_b32 s10, s6, 1
    s_and_b32 s11, s6, 1
    s_mul_i32 s12, s10, 4608
    v_mul_u32_u24 v12, 144, v3
    v_lshl_add_u32 v12, v4, 3, v12
    v_add_u32 v12, s12, v12
    v_lshrrev_b32 v13, 2, v3
    v_lshl_add_u32 v13, v4, 2, v13
    v_mul_u32_u24 v13, 288, v13
    v_and_b32 v14, 3, v3
    v_lshl_add_u32 v13, v14, 3, v13
    s_lshl_b32 s13, s11, 7
    s_add_u32 s13, s13, 9216
    v_add_u32 v13, s13, v13
    v_mov_b32 v16, 0
    v_mov_b32 v17, 0
    v_mov_b32 v18, 0
    v_mov_b32 v19, 0
    v_mov_b32 v20, 0
    v_mov_b32 v21, 0
    v_mov_b32 v22, 0
    v_mov_b32 v23, 0
    v_mov_b32 v24, 0
    v_mov_b32 v25, 0
    v_mov_b32 v26, 0
    v_mov_b32 v27, 0
    v_mov_b32 v28, 0
    v_mov_b32 v29, 0
    v_mov_b32 v30, 0
    v_mov_b32 v31, 0
    v_mov_b32 v32, 0
    v_mov_b32 v33, 0
    v_mov_b32 v34, 0
    v_mov_b32 v35, 0
    v_mov_b32 v36, 0
    v_mov_b32 v37, 0
    v_mov_b32 v38, 0
    v_mov_b32 v39, 0
    v_mov_b32 v40, 0
    v_mov_b32 v41, 0
    v_mov_b32 v42, 0
    v_mov_b32 v43, 0
    v_mov_b32 v44, 0
    v_mov_b32 v45, 0
    v_mov_b32 v46, 0
    v_mov_b32 v47, 0
    buffer_load_dwordx4 v[96:99], v7, s[40:43], s64 offen
    buffer_load_dwordx4 v[100:103], v7, s[40:43], s65 offen
    buffer_load_dwordx4 v[104:107], v10, s[60:63], s68 offen
    buffer_load_dwordx4 v[108:111], v10, s[60:63], s69 offen
    buffer_load_dwordx4 v[112:115], v10, s[60:63], s70 offen
    buffer_load_dwordx4 v[116:119], v10, s[60:63], s71 offen
    v_add_u32 v7, 128, v7
    v_add_u32 v10, 81920, v10
    buffer_load_dwordx4 v[120:123], v7, s[40:43], s64 offen
    buffer_load_dwordx4 v[124:127], v7, s[40:43], s65 offen
    buffer_load_dwordx4 v[128:131], v10, s[60:63], s68 offen
    buffer_load_dwordx4 v[132:135], v10, s[60:63], s69 offen
    buffer_load_dwordx4 v[136:139], v10, s[60:63], s70 offen
    buffer_load_dwordx4 v[140:143], v10, s[60:63], s71 offen
    v_add_u32 v7, 128, v7
    v_add_u32 v10, 81920, v10
    s_waitcnt vmcnt(6)
    ds_write_b128 v8, v[96:99] offset:0
    ds_write_b128 v8, v[100:103] offset:4608
    ds_write_b128 v11, v[104:107] offset:0
    ds_write_b128 v11, v[108:111] offset:4608
    ds_write_b128 v11, v[112:115] offset:9216
    ds_write_b128 v11, v[116:119] offset:13824
    s_waitcnt lgkmcnt(0)
    s_barrier
    buffer_load_dwordx4 v[96:99], v7, s[40:43], s64 offen
    buffer_load_dwordx4 v[100:103], v7, s[40:43], s65 offen
    buffer_load_dwordx4 v[104:107], v10, s[60:63], s68 offen
    buffer_load_dwordx4 v[108:111], v10, s[60:63], s69 offen
    buffer_load_dwordx4 v[112:115], v10, s[60:63], s70 offen
    buffer_load_dwordx4 v[116:119], v10, s[60:63], s71 offen
    v_add_u32 v7, 128, v7
    v_add_u32 v10, 81920, v10
    ds_read_b64_tr_b16 v[56:57], v13 offset:0
    ds_read_b64_tr_b16 v[58:59], v13 offset:4608
    ds_read_b64_tr_b16 v[60:61], v13 offset:32
    ds_read_b64_tr_b16 v[62:63], v13 offset:4640
    ds_read_b64_tr_b16 v[64:65], v13 offset:64
    ds_read_b64_tr_b16 v[66:67], v13 offset:4672
    ds_read_b64_tr_b16 v[68:69], v13 offset:96
    ds_read_b64_tr_b16 v[70:71], v13 offset:4704
    ds_read_b64 v[48:49], v12 offset:0
    ds_read_b64 v[50:51], v12 offset:32
    ds_read_b64 v[52:53], v12 offset:2304
    ds_read_b64 v[54:55], v12 offset:2336
    s_waitcnt lgkmcnt(0)
    ds_read_b64_tr_b16 v[80:81], v13 offset:9216
    ds_read_b64_tr_b16 v[82:83], v13 offset:13824
    ds_read_b64_tr_b16 v[84:85], v13 offset:9248
    ds_read_b64_tr_b16 v[86:87], v13 offset:13856
    ds_read_b64_tr_b16 v[88:89], v13 offset:9280
    ds_read_b64_tr_b16 v[90:91], v13 offset:13888
    ds_read_b64_tr_b16 v[92:93], v13 offset:9312
    ds_read_b64_tr_b16 v[94:95], v13 offset:13920
    ds_read_b64 v[72:73], v12 offset:64
    ds_read_b64 v[74:75], v12 offset:96
    ds_read_b64 v[76:77], v12 offset:2368
    ds_read_b64 v[78:79], v12 offset:2400
    v_mfma_f32_16x16x32_bf16 v[16:19], v[56:59], v[48:51], v[16:19]
    v_mfma_f32_16x16x32_bf16 v[20:23], v[60:63], v[48:51], v[20:23]
    v_mfma_f32_16x16x32_bf16 v[24:27], v[64:67], v[48:51], v[24:27]
    v_mfma_f32_16x16x32_bf16 v[28:31], v[68:71], v[48:51], v[28:31]
    v_mfma_f32_16x16x32_bf16 v[32:35], v[56:59], v[52:55], v[32:35]
    v_mfma_f32_16x16x32_bf16 v[36:39], v[60:63], v[52:55], v[36:39]
    v_mfma_f32_16x16x32_bf16 v[40:43], v[64:67], v[52:55], v[40:43]
    v_mfma_f32_16x16x32_bf16 v[44:47], v[68:71], v[52:55], v[44:47]
    s_waitcnt lgkmcnt(0)
    v_mfma_f32_16x16x32_bf16 v[16:19], v[80:83], v[72:75], v[16:19]
    v_mfma_f32_16x16x32_bf16 v[20:23], v[84:87], v[72:75], v[20:23]
    v_mfma_f32_16x16x32_bf16 v[24:27], v[88:91], v[72:75], v[24:27]
    v_mfma_f32_16x16x32_bf16 v[28:31], v[92:95], v[72:75], v[28:31]
    v_mfma_f32_16x16x32_bf16 v[32:35], v[80:83], v[76:79], v[32:35]
    v_mfma_f32_16x16x32_bf16 v[36:39], v[84:87], v[76:79], v[36:39]
    v_mfma_f32_16x16x32_bf16 v[40:43], v[88:91], v[76:79], v[40:43]
    v_mfma_f32_16x16x32_bf16 v[44:47], v[92:95], v[76:79], v[44:47]
    s_waitcnt vmcnt(6)
    ds_write_b128 v8, v[120:123] offset:27648
    ds_write_b128 v8, v[124:127] offset:32256
    ds_write_b128 v11, v[128:131] offset:27648
    ds_write_b128 v11, v[132:135] offset:32256
    ds_write_b128 v11, v[136:139] offset:36864
    ds_write_b128 v11, v[140:143] offset:41472
    s_waitcnt lgkmcnt(0)
    s_barrier
    buffer_load_dwordx4 v[120:123], v7, s[40:43], s64 offen
    buffer_load_dwordx4 v[124:127], v7, s[40:43], s65 offen
    buffer_load_dwordx4 v[128:131], v10, s[60:63], s68 offen
    buffer_load_dwordx4 v[132:135], v10, s[60:63], s69 offen
    buffer_load_dwordx4 v[136:139], v10, s[60:63], s70 offen
    buffer_load_dwordx4 v[140:143], v10, s[60:63], s71 offen
    v_add_u32 v7, 128, v7
    v_add_u32 v10, 81920, v10
    ds_read_b64_tr_b16 v[56:57], v13 offset:27648
    ds_read_b64_tr_b16 v[58:59], v13 offset:32256
    ds_read_b64_tr_b16 v[60:61], v13 offset:27680
    ds_read_b64_tr_b16 v[62:63], v13 offset:32288
    ds_read_b64_tr_b16 v[64:65], v13 offset:27712
    ds_read_b64_tr_b16 v[66:67], v13 offset:32320
    ds_read_b64_tr_b16 v[68:69], v13 offset:27744
    ds_read_b64_tr_b16 v[70:71], v13 offset:32352
    ds_read_b64 v[48:49], v12 offset:27648
    ds_read_b64 v[50:51], v12 offset:27680
    ds_read_b64 v[52:53], v12 offset:29952
    ds_read_b64 v[54:55], v12 offset:29984
    s_waitcnt lgkmcnt(0)
    ds_read_b64_tr_b16 v[80:81], v13 offset:36864
    ds_read_b64_tr_b16 v[82:83], v13 offset:41472
    ds_read_b64_tr_b16 v[84:85], v13 offset:36896
    ds_read_b64_tr_b16 v[86:87], v13 offset:41504
    ds_read_b64_tr_b16 v[88:89], v13 offset:36928
    ds_read_b64_tr_b16 v[90:91], v13 offset:41536
    ds_read_b64_tr_b16 v[92:93], v13 offset:36960
    ds_read_b64_tr_b16 v[94:95], v13 offset:41568
    ds_read_b64 v[72:73], v12 offset:27712
    ds_read_b64 v[74:75], v12 offset:27744
    ds_read_b64 v[76:77], v12 offset:30016
    ds_read_b64 v[78:79], v12 offset:30048
    v_mfma_f32_16x16x32_bf16 v[16:19], v[56:59], v[48:51], v[16:19]
    v_mfma_f32_16x16x32_bf16 v[20:23], v[60:63], v[48:51], v[20:23]
    v_mfma_f32_16x16x32_bf16 v[24:27], v[64:67], v[48:51], v[24:27]
    v_mfma_f32_16x16x32_bf16 v[28:31], v[68:71], v[48:51], v[28:31]
    v_mfma_f32_16x16x32_bf16 v[32:35], v[56:59], v[52:55], v[32:35]
    v_mfma_f32_16x16x32_bf16 v[36:39], v[60:63], v[52:55], v[36:39]
    v_mfma_f32_16x16x32_bf16 v[40:43], v[64:67], v[52:55], v[40:43]
    v_mfma_f32_16x16x32_bf16 v[44:47], v[68:71], v[52:55], v[44:47]
    s_waitcnt lgkmcnt(0)
    v_mfma_f32_16x16x32_bf16 v[16:19], v[80:83], v[72:75], v[16:19]
    v_mfma_f32_16x16x32_bf16 v[20:23], v[84:87], v[72:75], v[20:23]
    v_mfma_f32_16x16x32_bf16 v[24:27], v[88:91], v[72:75], v[24:27]
    v_mfma_f32_16x16x32_bf16 v[28:31], v[92:95], v[72:75], v[28:31]
    v_mfma_f32_16x16x32_bf16 v[32:35], v[80:83], v[76:79], v[32:35]
    v_mfma_f32_16x16x32_bf16 v[36:39], v[84:87], v[76:79], v[36:39]
    v_mfma_f32_16x16x32_bf16 v[40:43], v[88:91], v[76:79], v[40:43]
    v_mfma_f32_16x16x32_bf16 v[44:47], v[92:95], v[76:79], v[44:47]
    s_waitcnt vmcnt(6)
    ds_write_b128 v8, v[96:99] offset:0
    ds_write_b128 v8, v[100:103] offset:4608
    ds_write_b128 v11, v[104:107] offset:0
    ds_write_b128 v11, v[108:111] offset:4608
    ds_write_b128 v11, v[112:115] offset:9216
    ds_write_b128 v11, v[116:119] offset:13824
    s_waitcnt lgkmcnt(0)
    s_barrier
    buffer_load_dwordx4 v[96:99], v7, s[40:43], s64 offen
    buffer_load_dwordx4 v[100:103], v7, s[40:43], s65 offen
    buffer_load_dwordx4 v[104:107], v10, s[60:63], s68 offen
    buffer_load_dwordx4 v[108:111], v10, s[60:63], s69 offen
    buffer_load_dwordx4 v[112:115], v10, s[60:63], s70 offen
    buffer_load_dwordx4 v[116:119], v10, s[60:63], s71 offen
    v_add_u32 v7, 128, v7
    v_add_u32 v10, 81920, v10
    ds_read_b64_tr_b16 v[56:57], v13 offset:0
    ds_read_b64_tr_b16 v[58:59], v13 offset:4608
    ds_read_b64_tr_b16 v[60:61], v13 offset:32
    ds_read_b64_tr_b16 v[62:63], v13 offset:4640
    ds_read_b64_tr_b16 v[64:65], v13 offset:64
    ds_read_b64_tr_b16 v[66:67], v13 offset:4672
    ds_read_b64_tr_b16 v[68:69], v13 offset:96
    ds_read_b64_tr_b16 v[70:71], v13 offset:4704
    ds_read_b64 v[48:49], v12 offset:0
    ds_read_b64 v[50:51], v12 offset:32
    ds_read_b64 v[52:53], v12 offset:2304
    ds_read_b64 v[54:55], v12 offset:2336
    s_waitcnt lgkmcnt(0)
    ds_read_b64_tr_b16 v[80:81], v13 offset:9216
    ds_read_b64_tr_b16 v[82:83], v13 offset:13824
    ds_read_b64_tr_b16 v[84:85], v13 offset:9248
    ds_read_b64_tr_b16 v[86:87], v13 offset:13856
    ds_read_b64_tr_b16 v[88:89], v13 offset:9280
    ds_read_b64_tr_b16 v[90:91], v13 offset:13888
    ds_read_b64_tr_b16 v[92:93], v13 offset:9312
    ds_read_b64_tr_b16 v[94:95], v13 offset:13920
    ds_read_b64 v[72:73], v12 offset:64
    ds_read_b64 v[74:75], v12 offset:96
    ds_read_b64 v[76:77], v12 offset:2368
    ds_read_b64 v[78:79], v12 offset:2400
    v_mfma_f32_16x16x32_bf16 v[16:19], v[56:59], v[48:51], v[16:19]
    v_mfma_f32_16x16x32_bf16 v[20:23], v[60:63], v[48:51], v[20:23]
    v_mfma_f32_16x16x32_bf16 v[24:27], v[64:67], v[48:51], v[24:27]
    v_mfma_f32_16x16x32_bf16 v[28:31], v[68:71], v[48:51], v[28:31]
    v_mfma_f32_16x16x32_bf16 v[32:35], v[56:59], v[52:55], v[32:35]
    v_mfma_f32_16x16x32_bf16 v[36:39], v[60:63], v[52:55], v[36:39]
    v_mfma_f32_16x16x32_bf16 v[40:43], v[64:67], v[52:55], v[40:43]
    v_mfma_f32_16x16x32_bf16 v[44:47], v[68:71], v[52:55], v[44:47]
    s_waitcnt lgkmcnt(0)
    v_mfma_f32_16x16x32_bf16 v[16:19], v[80:83], v[72:75], v[16:19]
    v_mfma_f32_16x16x32_bf16 v[20:23], v[84:87], v[72:75], v[20:23]
    v_mfma_f32_16x16x32_bf16 v[24:27], v[88:91], v[72:75], v[24:27]
    v_mfma_f32_16x16x32_bf16 v[28:31], v[92:95], v[72:75], v[28:31]
    v_mfma_f32_16x16x32_bf16 v[32:35], v[80:83], v[76:79], v[32:35]
    v_mfma_f32_16x16x32_bf16 v[36:39], v[84:87], v[76:79], v[36:39]
    v_mfma_f32_16x16x32_bf16 v[40:43], v[88:91], v[76:79], v[40:43]
    v_mfma_f32_16x16x32_bf16 v[44:47], v[92:95], v[76:79], v[44:47]
    s_waitcnt vmcnt(6)
    ds_write_b128 v8, v[120:123] offset:27648
    ds_write_b128 v8, v[124:127] offset:32256
    ds_write_b128 v11, v[128:131] offset:27648
    ds_write_b128 v11, v[132:135] offset:32256
    ds_write_b128 v11, v[136:139] offset:36864
    ds_write_b128 v11, v[140:143] offset:41472
    s_waitcnt lgkmcnt(0)
    s_barrier
    buffer_load_dwordx4 v[120:123], v7, s[40:43], s64 offen
    buffer_load_dwordx4 v[124:127], v7, s[40:43], s65 offen
    buffer_load_dwordx4 v[128:131], v10, s[60:63], s68 offen
    buffer_load_dwordx4 v[132:135], v10, s[60:63], s69 offen
    buffer_load_dwordx4 v[136:139], v10, s[60:63], s70 offen
    buffer_load_dwordx4 v[140:143], v10, s[60:63], s71 offen
    v_add_u32 v7, 128, v7
    v_add_u32 v10, 81920, v10
    ds_read_b64_tr_b16 v[56:57], v13 offset:27648
    ds_read_b64_tr_b16 v[58:59], v13 offset:32256
    ds_read_b64_tr_b16 v[60:61], v13 offset:27680
    ds_read_b64_tr_b16 v[62:63], v13 offset:32288
    ds_read_b64_tr_b16 v[64:65], v13 offset:27712
    ds_read_b64_tr_b16 v[66:67], v13 offset:32320
    ds_read_b64_tr_b16 v[68:69], v13 offset:27744
    ds_read_b64_tr_b16 v[70:71], v13 offset:32352
    ds_read_b64 v[48:49], v12 offset:27648
    ds_read_b64 v[50:51], v12 offset:27680
    ds_read_b64 v[52:53], v12 offset:29952
    ds_read_b64 v[54:55], v12 offset:29984
    s_waitcnt lgkmcnt(0)
    ds_read_b64_tr_b16 v[80:81], v13 offset:36864
    ds_read_b64_tr_b16 v[82:83], v13 offset:41472
    ds_read_b64_tr_b16 v[84:85], v13 offset:36896
    ds_read_b64_tr_b16 v[86:87], v13 offset:41504
    ds_read_b64_tr_b16 v[88:89], v13 offset:36928
    ds_read_b64_tr_b16 v[90:91], v13 offset:41536
    ds_read_b64_tr_b16 v[92:93], v13 offset:36960
    ds_read_b64_tr_b16 v[94:95], v13 offset:41568
    ds_read_b64 v[72:73], v12 offset:27712
    ds_read_b64 v[74:75], v12 offset:27744
    ds_read_b64 v[76:77], v12 offset:30016
    ds_read_b64 v[78:79], v12 offset:30048
    v_mfma_f32_16x16x32_bf16 v[16:19], v[56:59], v[48:51], v[16:19]
    v_mfma_f32_16x16x32_bf16 v[20:23], v[60:63], v[48:51], v[20:23]
    v_mfma_f32_16x16x32_bf16 v[24:27], v[64:67], v[48:51], v[24:27]
    v_mfma_f32_16x16x32_bf16 v[28:31], v[68:71], v[48:51], v[28:31]
    v_mfma_f32_16x16x32_bf16 v[32:35], v[56:59], v[52:55], v[32:35]
    v_mfma_f32_16x16x32_bf16 v[36:39], v[60:63], v[52:55], v[36:39]
    v_mfma_f32_16x16x32_bf16 v[40:43], v[64:67], v[52:55], v[40:43]
    v_mfma_f32_16x16x32_bf16 v[44:47], v[68:71], v[52:55], v[44:47]
    s_waitcnt lgkmcnt(0)
    v_mfma_f32_16x16x32_bf16 v[16:19], v[80:83], v[72:75], v[16:19]
    v_mfma_f32_16x16x32_bf16 v[20:23], v[84:87], v[72:75], v[20:23]
    v_mfma_f32_16x16x32_bf16 v[24:27], v[88:91], v[72:75], v[24:27]
    v_mfma_f32_16x16x32_bf16 v[28:31], v[92:95], v[72:75], v[28:31]
    v_mfma_f32_16x16x32_bf16 v[32:35], v[80:83], v[76:79], v[32:35]
    v_mfma_f32_16x16x32_bf16 v[36:39], v[84:87], v[76:79], v[36:39]
    v_mfma_f32_16x16x32_bf16 v[40:43], v[88:91], v[76:79], v[40:43]
    v_mfma_f32_16x16x32_bf16 v[44:47], v[92:95], v[76:79], v[44:47]
    s_waitcnt vmcnt(6)
    ds_write_b128 v8, v[96:99] offset:0
    ds_write_b128 v8, v[100:103] offset:4608
    ds_write_b128 v11, v[104:107] offset:0
    ds_write_b128 v11, v[108:111] offset:4608
    ds_write_b128 v11, v[112:115] offset:9216
    ds_write_b128 v11, v[116:119] offset:13824
    s_waitcnt lgkmcnt(0)
    s_barrier
    buffer_load_dwordx4 v[96:99], v7, s[40:43], s64 offen
    buffer_load_dwordx4 v[100:103], v7, s[40:43], s65 offen
    buffer_load_dwordx4 v[104:107], v10, s[60:63], s68 offen
    buffer_load_dwordx4 v[108:111], v10, s[60:63], s69 offen
    buffer_load_dwordx4 v[112:115], v10, s[60:63], s70 offen
    buffer_load_dwordx4 v[116:119], v10, s[60:63], s71 offen
    v_add_u32 v7, 128, v7
    v_add_u32 v10, 81920, v10
    ds_read_b64_tr_b16 v[56:57], v13 offset:0
    ds_read_b64_tr_b16 v[58:59], v13 offset:4608
    ds_read_b64_tr_b16 v[60:61], v13 offset:32
    ds_read_b64_tr_b16 v[62:63], v13 offset:4640
    ds_read_b64_tr_b16 v[64:65], v13 offset:64
    ds_read_b64_tr_b16 v[66:67], v13 offset:4672
    ds_read_b64_tr_b16 v[68:69], v13 offset:96
    ds_read_b64_tr_b16 v[70:71], v13 offset:4704
    ds_read_b64 v[48:49], v12 offset:0
    ds_read_b64 v[50:51], v12 offset:32
    ds_read_b64 v[52:53], v12 offset:2304
    ds_read_b64 v[54:55], v12 offset:2336
    s_waitcnt lgkmcnt(0)
    ds_read_b64_tr_b16 v[80:81], v13 offset:9216
    ds_read_b64_tr_b16 v[82:83], v13 offset:13824
    ds_read_b64_tr_b16 v[84:85], v13 offset:9248
    ds_read_b64_tr_b16 v[86:87], v13 offset:13856
    ds_read_b64_tr_b16 v[88:89], v13 offset:9280
    ds_read_b64_tr_b16 v[90:91], v13 offset:13888
    ds_read_b64_tr_b16 v[92:93], v13 offset:9312
    ds_read_b64_tr_b16 v[94:95], v13 offset:13920
    ds_read_b64 v[72:73], v12 offset:64
    ds_read_b64 v[74:75], v12 offset:96
    ds_read_b64 v[76:77], v12 offset:2368
    ds_read_b64 v[78:79], v12 offset:2400
    v_mfma_f32_16x16x32_bf16 v[16:19], v[56:59], v[48:51], v[16:19]
    v_mfma_f32_16x16x32_bf16 v[20:23], v[60:63], v[48:51], v[20:23]
    v_mfma_f32_16x16x32_bf16 v[24:27], v[64:67], v[48:51], v[24:27]
    v_mfma_f32_16x16x32_bf16 v[28:31], v[68:71], v[48:51], v[28:31]
    v_mfma_f32_16x16x32_bf16 v[32:35], v[56:59], v[52:55], v[32:35]
    v_mfma_f32_16x16x32_bf16 v[36:39], v[60:63], v[52:55], v[36:39]
    v_mfma_f32_16x16x32_bf16 v[40:43], v[64:67], v[52:55], v[40:43]
    v_mfma_f32_16x16x32_bf16 v[44:47], v[68:71], v[52:55], v[44:47]
    s_waitcnt lgkmcnt(0)
    v_mfma_f32_16x16x32_bf16 v[16:19], v[80:83], v[72:75], v[16:19]
    v_mfma_f32_16x16x32_bf16 v[20:23], v[84:87], v[72:75], v[20:23]
    v_mfma_f32_16x16x32_bf16 v[24:27], v[88:91], v[72:75], v[24:27]
    v_mfma_f32_16x16x32_bf16 v[28:31], v[92:95], v[72:75], v[28:31]
    v_mfma_f32_16x16x32_bf16 v[32:35], v[80:83], v[76:79], v[32:35]
    v_mfma_f32_16x16x32_bf16 v[36:39], v[84:87], v[76:79], v[36:39]
    v_mfma_f32_16x16x32_bf16 v[40:43], v[88:91], v[76:79], v[40:43]
    v_mfma_f32_16x16x32_bf16 v[44:47], v[92:95], v[76:79], v[44:47]
    s_waitcnt vmcnt(6)
    ds_write_b128 v8, v[120:123] offset:27648
    ds_write_b128 v8, v[124:127] offset:32256
    ds_write_b128 v11, v[128:131] offset:27648
    ds_write_b128 v11, v[132:135] offset:32256
    ds_write_b128 v11, v[136:139] offset:36864
    ds_write_b128 v11, v[140:143] offset:41472
    s_waitcnt lgkmcnt(0)
    s_barrier
    buffer_load_dwordx4 v[120:123], v7, s[40:43], s64 offen
    buffer_load_dwordx4 v[124:127], v7, s[40:43], s65 offen
    buffer_load_dwordx4 v[128:131], v10, s[60:63], s68 offen
    buffer_load_dwordx4 v[132:135], v10, s[60:63], s69 offen
    buffer_load_dwordx4 v[136:139], v10, s[60:63], s70 offen
    buffer_load_dwordx4 v[140:143], v10, s[60:63], s71 offen
    v_add_u32 v7, 128, v7
    v_add_u32 v10, 81920, v10
    ds_read_b64_tr_b16 v[56:57], v13 offset:27648
    ds_read_b64_tr_b16 v[58:59], v13 offset:32256
    ds_read_b64_tr_b16 v[60:61], v13 offset:27680
    ds_read_b64_tr_b16 v[62:63], v13 offset:32288
    ds_read_b64_tr_b16 v[64:65], v13 offset:27712
    ds_read_b64_tr_b16 v[66:67], v13 offset:32320
    ds_read_b64_tr_b16 v[68:69], v13 offset:27744
    ds_read_b64_tr_b16 v[70:71], v13 offset:32352
    ds_read_b64 v[48:49], v12 offset:27648
    ds_read_b64 v[50:51], v12 offset:27680
    ds_read_b64 v[52:53], v12 offset:29952
    ds_read_b64 v[54:55], v12 offset:29984
    s_waitcnt lgkmcnt(0)
    ds_read_b64_tr_b16 v[80:81], v13 offset:36864
    ds_read_b64_tr_b16 v[82:83], v13 offset:41472
    ds_read_b64_tr_b16 v[84:85], v13 offset:36896
    ds_read_b64_tr_b16 v[86:87], v13 offset:41504
    ds_read_b64_tr_b16 v[88:89], v13 offset:36928
    ds_read_b64_tr_b16 v[90:91], v13 offset:41536
    ds_read_b64_tr_b16 v[92:93], v13 offset:36960
    ds_read_b64_tr_b16 v[94:95], v13 offset:41568
    ds_read_b64 v[72:73], v12 offset:27712
    ds_read_b64 v[74:75], v12 offset:27744
    ds_read_b64 v[76:77], v12 offset:30016
    ds_read_b64 v[78:79], v12 offset:30048
    v_mfma_f32_16x16x32_bf16 v[16:19], v[56:59], v[48:51], v[16:19]
    v_mfma_f32_16x16x32_bf16 v[20:23], v[60:63], v[48:51], v[20:23]
    v_mfma_f32_16x16x32_bf16 v[24:27], v[64:67], v[48:51], v[24:27]
    v_mfma_f32_16x16x32_bf16 v[28:31], v[68:71], v[48:51], v[28:31]
    v_mfma_f32_16x16x32_bf16 v[32:35], v[56:59], v[52:55], v[32:35]
    v_mfma_f32_16x16x32_bf16 v[36:39], v[60:63], v[52:55], v[36:39]
    v_mfma_f32_16x16x32_bf16 v[40:43], v[64:67], v[52:55], v[40:43]
    v_mfma_f32_16x16x32_bf16 v[44:47], v[68:71], v[52:55], v[44:47]
    s_waitcnt lgkmcnt(0)
    v_mfma_f32_16x16x32_bf16 v[16:19], v[80:83], v[72:75], v[16:19]
    v_mfma_f32_16x16x32_bf16 v[20:23], v[84:87], v[72:75], v[20:23]
    v_mfma_f32_16x16x32_bf16 v[24:27], v[88:91], v[72:75], v[24:27]
    v_mfma_f32_16x16x32_bf16 v[28:31], v[92:95], v[72:75], v[28:31]
    v_mfma_f32_16x16x32_bf16 v[32:35], v[80:83], v[76:79], v[32:35]
    v_mfma_f32_16x16x32_bf16 v[36:39], v[84:87], v[76:79], v[36:39]
    v_mfma_f32_16x16x32_bf16 v[40:43], v[88:91], v[76:79], v[40:43]
    v_mfma_f32_16x16x32_bf16 v[44:47], v[92:95], v[76:79], v[44:47]
    s_waitcnt vmcnt(6)
    ds_write_b128 v8, v[96:99] offset:0
    ds_write_b128 v8, v[100:103] offset:4608
    ds_write_b128 v11, v[104:107] offset:0
    ds_write_b128 v11, v[108:111] offset:4608
    ds_write_b128 v11, v[112:115] offset:9216
    ds_write_b128 v11, v[116:119] offset:13824
    s_waitcnt lgkmcnt(0)
    s_barrier
    buffer_load_dwordx4 v[96:99], v7, s[40:43], s64 offen
    buffer_load_dwordx4 v[100:103], v7, s[40:43], s65 offen
    buffer_load_dwordx4 v[104:107], v10, s[60:63], s68 offen
    buffer_load_dwordx4 v[108:111], v10, s[60:63], s69 offen
    buffer_load_dwordx4 v[112:115], v10, s[60:63], s70 offen
    buffer_load_dwordx4 v[116:119], v10, s[60:63], s71 offen
    v_add_u32 v7, 128, v7
    v_add_u32 v10, 81920, v10
    ds_read_b64_tr_b16 v[56:57], v13 offset:0
    ds_read_b64_tr_b16 v[58:59], v13 offset:4608
    ds_read_b64_tr_b16 v[60:61], v13 offset:32
    ds_read_b64_tr_b16 v[62:63], v13 offset:4640
    ds_read_b64_tr_b16 v[64:65], v13 offset:64
    ds_read_b64_tr_b16 v[66:67], v13 offset:4672
    ds_read_b64_tr_b16 v[68:69], v13 offset:96
    ds_read_b64_tr_b16 v[70:71], v13 offset:4704
    ds_read_b64 v[48:49], v12 offset:0
    ds_read_b64 v[50:51], v12 offset:32
    ds_read_b64 v[52:53], v12 offset:2304
    ds_read_b64 v[54:55], v12 offset:2336
    s_waitcnt lgkmcnt(0)
    ds_read_b64_tr_b16 v[80:81], v13 offset:9216
    ds_read_b64_tr_b16 v[82:83], v13 offset:13824
    ds_read_b64_tr_b16 v[84:85], v13 offset:9248
    ds_read_b64_tr_b16 v[86:87], v13 offset:13856
    ds_read_b64_tr_b16 v[88:89], v13 offset:9280
    ds_read_b64_tr_b16 v[90:91], v13 offset:13888
    ds_read_b64_tr_b16 v[92:93], v13 offset:9312
    ds_read_b64_tr_b16 v[94:95], v13 offset:13920
    ds_read_b64 v[72:73], v12 offset:64
    ds_read_b64 v[74:75], v12 offset:96
    ds_read_b64 v[76:77], v12 offset:2368
    ds_read_b64 v[78:79], v12 offset:2400
    v_mfma_f32_16x16x32_bf16 v[16:19], v[56:59], v[48:51], v[16:19]
    v_mfma_f32_16x16x32_bf16 v[20:23], v[60:63], v[48:51], v[20:23]
    v_mfma_f32_16x16x32_bf16 v[24:27], v[64:67], v[48:51], v[24:27]
    v_mfma_f32_16x16x32_bf16 v[28:31], v[68:71], v[48:51], v[28:31]
    v_mfma_f32_16x16x32_bf16 v[32:35], v[56:59], v[52:55], v[32:35]
    v_mfma_f32_16x16x32_bf16 v[36:39], v[60:63], v[52:55], v[36:39]
    v_mfma_f32_16x16x32_bf16 v[40:43], v[64:67], v[52:55], v[40:43]
    v_mfma_f32_16x16x32_bf16 v[44:47], v[68:71], v[52:55], v[44:47]
    s_waitcnt lgkmcnt(0)
    v_mfma_f32_16x16x32_bf16 v[16:19], v[80:83], v[72:75], v[16:19]
    v_mfma_f32_16x16x32_bf16 v[20:23], v[84:87], v[72:75], v[20:23]
    v_mfma_f32_16x16x32_bf16 v[24:27], v[88:91], v[72:75], v[24:27]
    v_mfma_f32_16x16x32_bf16 v[28:31], v[92:95], v[72:75], v[28:31]
    v_mfma_f32_16x16x32_bf16 v[32:35], v[80:83], v[76:79], v[32:35]
    v_mfma_f32_16x16x32_bf16 v[36:39], v[84:87], v[76:79], v[36:39]
    v_mfma_f32_16x16x32_bf16 v[40:43], v[88:91], v[76:79], v[40:43]
    v_mfma_f32_16x16x32_bf16 v[44:47], v[92:95], v[76:79], v[44:47]
    s_waitcnt vmcnt(6)
    ds_write_b128 v8, v[120:123] offset:27648
    ds_write_b128 v8, v[124:127] offset:32256
    ds_write_b128 v11, v[128:131] offset:27648
    ds_write_b128 v11, v[132:135] offset:32256
    ds_write_b128 v11, v[136:139] offset:36864
    ds_write_b128 v11, v[140:143] offset:41472
    s_waitcnt lgkmcnt(0)
    s_barrier
    buffer_load_dwordx4 v[120:123], v7, s[40:43], s64 offen
    buffer_load_dwordx4 v[124:127], v7, s[40:43], s65 offen
    buffer_load_dwordx4 v[128:131], v10, s[60:63], s68 offen
    buffer_load_dwordx4 v[132:135], v10, s[60:63], s69 offen
    buffer_load_dwordx4 v[136:139], v10, s[60:63], s70 offen
    buffer_load_dwordx4 v[140:143], v10, s[60:63], s71 offen
    v_add_u32 v7, 128, v7
    v_add_u32 v10, 81920, v10
    ds_read_b64_tr_b16 v[56:57], v13 offset:27648
    ds_read_b64_tr_b16 v[58:59], v13 offset:32256
    ds_read_b64_tr_b16 v[60:61], v13 offset:27680
    ds_read_b64_tr_b16 v[62:63], v13 offset:32288
    ds_read_b64_tr_b16 v[64:65], v13 offset:27712
    ds_read_b64_tr_b16 v[66:67], v13 offset:32320
    ds_read_b64_tr_b16 v[68:69], v13 offset:27744
    ds_read_b64_tr_b16 v[70:71], v13 offset:32352
    ds_read_b64 v[48:49], v12 offset:27648
    ds_read_b64 v[50:51], v12 offset:27680
    ds_read_b64 v[52:53], v12 offset:29952
    ds_read_b64 v[54:55], v12 offset:29984
    s_waitcnt lgkmcnt(0)
    ds_read_b64_tr_b16 v[80:81], v13 offset:36864
    ds_read_b64_tr_b16 v[82:83], v13 offset:41472
    ds_read_b64_tr_b16 v[84:85], v13 offset:36896
    ds_read_b64_tr_b16 v[86:87], v13 offset:41504
    ds_read_b64_tr_b16 v[88:89], v13 offset:36928
    ds_read_b64_tr_b16 v[90:91], v13 offset:41536
    ds_read_b64_tr_b16 v[92:93], v13 offset:36960
    ds_read_b64_tr_b16 v[94:95], v13 offset:41568
    ds_read_b64 v[72:73], v12 offset:27712
    ds_read_b64 v[74:75], v12 offset:27744
    ds_read_b64 v[76:77], v12 offset:30016
    ds_read_b64 v[78:79], v12 offset:30048
    v_mfma_f32_16x16x32_bf16 v[16:19], v[56:59], v[48:51], v[16:19]
    v_mfma_f32_16x16x32_bf16 v[20:23], v[60:63], v[48:51], v[20:23]
    v_mfma_f32_16x16x32_bf16 v[24:27], v[64:67], v[48:51], v[24:27]
    v_mfma_f32_16x16x32_bf16 v[28:31], v[68:71], v[48:51], v[28:31]
    v_mfma_f32_16x16x32_bf16 v[32:35], v[56:59], v[52:55], v[32:35]
    v_mfma_f32_16x16x32_bf16 v[36:39], v[60:63], v[52:55], v[36:39]
    v_mfma_f32_16x16x32_bf16 v[40:43], v[64:67], v[52:55], v[40:43]
    v_mfma_f32_16x16x32_bf16 v[44:47], v[68:71], v[52:55], v[44:47]
    s_waitcnt lgkmcnt(0)
    v_mfma_f32_16x16x32_bf16 v[16:19], v[80:83], v[72:75], v[16:19]
    v_mfma_f32_16x16x32_bf16 v[20:23], v[84:87], v[72:75], v[20:23]
    v_mfma_f32_16x16x32_bf16 v[24:27], v[88:91], v[72:75], v[24:27]
    v_mfma_f32_16x16x32_bf16 v[28:31], v[92:95], v[72:75], v[28:31]
    v_mfma_f32_16x16x32_bf16 v[32:35], v[80:83], v[76:79], v[32:35]
    v_mfma_f32_16x16x32_bf16 v[36:39], v[84:87], v[76:79], v[36:39]
    v_mfma_f32_16x16x32_bf16 v[40:43], v[88:91], v[76:79], v[40:43]
    v_mfma_f32_16x16x32_bf16 v[44:47], v[92:95], v[76:79], v[44:47]
    s_waitcnt vmcnt(6)
    ds_write_b128 v8, v[96:99] offset:0
    ds_write_b128 v8, v[100:103] offset:4608
    ds_write_b128 v11, v[104:107] offset:0
    ds_write_b128 v11, v[108:111] offset:4608
    ds_write_b128 v11, v[112:115] offset:9216
    ds_write_b128 v11, v[116:119] offset:13824
    s_waitcnt lgkmcnt(0)
    s_barrier
    ds_read_b64_tr_b16 v[56:57], v13 offset:0
    ds_read_b64_tr_b16 v[58:59], v13 offset:4608
    ds_read_b64_tr_b16 v[60:61], v13 offset:32
    ds_read_b64_tr_b16 v[62:63], v13 offset:4640
    ds_read_b64_tr_b16 v[64:65], v13 offset:64
    ds_read_b64_tr_b16 v[66:67], v13 offset:4672
    ds_read_b64_tr_b16 v[68:69], v13 offset:96
    ds_read_b64_tr_b16 v[70:71], v13 offset:4704
    ds_read_b64 v[48:49], v12 offset:0
    ds_read_b64 v[50:51], v12 offset:32
    ds_read_b64 v[52:53], v12 offset:2304
    ds_read_b64 v[54:55], v12 offset:2336
    s_waitcnt lgkmcnt(0)
    ds_read_b64_tr_b16 v[80:81], v13 offset:9216
    ds_read_b64_tr_b16 v[82:83], v13 offset:13824
    ds_read_b64_tr_b16 v[84:85], v13 offset:9248
    ds_read_b64_tr_b16 v[86:87], v13 offset:13856
    ds_read_b64_tr_b16 v[88:89], v13 offset:9280
    ds_read_b64_tr_b16 v[90:91], v13 offset:13888
    ds_read_b64_tr_b16 v[92:93], v13 offset:9312
    ds_read_b64_tr_b16 v[94:95], v13 offset:13920
    ds_read_b64 v[72:73], v12 offset:64
    ds_read_b64 v[74:75], v12 offset:96
    ds_read_b64 v[76:77], v12 offset:2368
    ds_read_b64 v[78:79], v12 offset:2400
    v_mfma_f32_16x16x32_bf16 v[16:19], v[56:59], v[48:51], v[16:19]
    v_mfma_f32_16x16x32_bf16 v[20:23], v[60:63], v[48:51], v[20:23]
    v_mfma_f32_16x16x32_bf16 v[24:27], v[64:67], v[48:51], v[24:27]
    v_mfma_f32_16x16x32_bf16 v[28:31], v[68:71], v[48:51], v[28:31]
    v_mfma_f32_16x16x32_bf16 v[32:35], v[56:59], v[52:55], v[32:35]
    v_mfma_f32_16x16x32_bf16 v[36:39], v[60:63], v[52:55], v[36:39]
    v_mfma_f32_16x16x32_bf16 v[40:43], v[64:67], v[52:55], v[40:43]
    v_mfma_f32_16x16x32_bf16 v[44:47], v[68:71], v[52:55], v[44:47]
    s_waitcnt lgkmcnt(0)
    v_mfma_f32_16x16x32_bf16 v[16:19], v[80:83], v[72:75], v[16:19]
    v_mfma_f32_16x16x32_bf16 v[20:23], v[84:87], v[72:75], v[20:23]
    v_mfma_f32_16x16x32_bf16 v[24:27], v[88:91], v[72:75], v[24:27]
    v_mfma_f32_16x16x32_bf16 v[28:31], v[92:95], v[72:75], v[28:31]
    v_mfma_f32_16x16x32_bf16 v[32:35], v[80:83], v[76:79], v[32:35]
    v_mfma_f32_16x16x32_bf16 v[36:39], v[84:87], v[76:79], v[36:39]
    v_mfma_f32_16x16x32_bf16 v[40:43], v[88:91], v[76:79], v[40:43]
    v_mfma_f32_16x16x32_bf16 v[44:47], v[92:95], v[76:79], v[44:47]
    s_waitcnt vmcnt(0)
    ds_write_b128 v8, v[120:123] offset:27648
    ds_write_b128 v8, v[124:127] offset:32256
    ds_write_b128 v11, v[128:131] offset:27648
    ds_write_b128 v11, v[132:135] offset:32256
    ds_write_b128 v11, v[136:139] offset:36864
    ds_write_b128 v11, v[140:143] offset:41472
    s_waitcnt lgkmcnt(0)
    s_barrier
    ds_read_b64_tr_b16 v[56:57], v13 offset:27648
    ds_read_b64_tr_b16 v[58:59], v13 offset:32256
    ds_read_b64_tr_b16 v[60:61], v13 offset:27680
    ds_read_b64_tr_b16 v[62:63], v13 offset:32288
    ds_read_b64_tr_b16 v[64:65], v13 offset:27712
    ds_read_b64_tr_b16 v[66:67], v13 offset:32320
    ds_read_b64_tr_b16 v[68:69], v13 offset:27744
    ds_read_b64_tr_b16 v[70:71], v13 offset:32352
    ds_read_b64 v[48:49], v12 offset:27648
    ds_read_b64 v[50:51], v12 offset:27680
    ds_read_b64 v[52:53], v12 offset:29952
    ds_read_b64 v[54:55], v12 offset:29984
    s_waitcnt lgkmcnt(0)
    ds_read_b64_tr_b16 v[80:81], v13 offset:36864
    ds_read_b64_tr_b16 v[82:83], v13 offset:41472
    ds_read_b64_tr_b16 v[84:85], v13 offset:36896
    ds_read_b64_tr_b16 v[86:87], v13 offset:41504
    ds_read_b64_tr_b16 v[88:89], v13 offset:36928
    ds_read_b64_tr_b16 v[90:91], v13 offset:41536
    ds_read_b64_tr_b16 v[92:93], v13 offset:36960
    ds_read_b64_tr_b16 v[94:95], v13 offset:41568
    ds_read_b64 v[72:73], v12 offset:27712
    ds_read_b64 v[74:75], v12 offset:27744
    ds_read_b64 v[76:77], v12 offset:30016
    ds_read_b64 v[78:79], v12 offset:30048
    v_mfma_f32_16x16x32_bf16 v[16:19], v[56:59], v[48:51], v[16:19]
    v_mfma_f32_16x16x32_bf16 v[20:23], v[60:63], v[48:51], v[20:23]
    v_mfma_f32_16x16x32_bf16 v[24:27], v[64:67], v[48:51], v[24:27]
    v_mfma_f32_16x16x32_bf16 v[28:31], v[68:71], v[48:51], v[28:31]
    v_mfma_f32_16x16x32_bf16 v[32:35], v[56:59], v[52:55], v[32:35]
    v_mfma_f32_16x16x32_bf16 v[36:39], v[60:63], v[52:55], v[36:39]
    v_mfma_f32_16x16x32_bf16 v[40:43], v[64:67], v[52:55], v[40:43]
    v_mfma_f32_16x16x32_bf16 v[44:47], v[68:71], v[52:55], v[44:47]
    s_waitcnt lgkmcnt(0)
    v_mfma_f32_16x16x32_bf16 v[16:19], v[80:83], v[72:75], v[16:19]
    v_mfma_f32_16x16x32_bf16 v[20:23], v[84:87], v[72:75], v[20:23]
    v_mfma_f32_16x16x32_bf16 v[24:27], v[88:91], v[72:75], v[24:27]
    v_mfma_f32_16x16x32_bf16 v[28:31], v[92:95], v[72:75], v[28:31]
    v_mfma_f32_16x16x32_bf16 v[32:35], v[80:83], v[76:79], v[32:35]
    v_mfma_f32_16x16x32_bf16 v[36:39], v[84:87], v[76:79], v[36:39]
    v_mfma_f32_16x16x32_bf16 v[40:43], v[88:91], v[76:79], v[40:43]
    v_mfma_f32_16x16x32_bf16 v[44:47], v[92:95], v[76:79], v[44:47]
    s_nop 7
    s_nop 7
    s_mul_i32 s7, s4, 64
    s_mul_i32 s12, s10, 32
    s_add_u32 s7, s7, s12
    v_add_u32 v5, s7, v3
    v_mul_u32_u24 v5, 1280, v5
    s_lshl_b32 s12, s5, 8
    s_lshl_b32 s13, s11, 7
    s_add_u32 s12, s12, s13
    v_lshl_add_u32 v5, v4, 3, v5
    v_add_u32 v5, s12, v5
    buffer_load_dwordx2 v[96:97], v5, s[56:59], 0 offen offset:0
    buffer_load_dwordx2 v[98:99], v5, s[56:59], 0 offen offset:32
    buffer_load_dwordx2 v[100:101], v5, s[56:59], 0 offen offset:64
    buffer_load_dwordx2 v[102:103], v5, s[56:59], 0 offen offset:96
    s_waitcnt vmcnt(0)
    v_lshlrev_b32 v104, 16, v96
    v_and_b32 v105, 0xffff0000, v96
    v_add_f32 v16, v16, v104
    v_add_f32 v17, v17, v105
    v_lshlrev_b32 v104, 16, v97
    v_and_b32 v105, 0xffff0000, v97
    v_add_f32 v18, v18, v104
    v_add_f32 v19, v19, v105
    v_cvt_pk_bf16_f32 v106, v16, v17
    v_cvt_pk_bf16_f32 v107, v18, v19
    buffer_store_dwordx2 v[106:107], v5, s[52:55], 0 offen offset:0
    s_nop 1
    v_lshlrev_b32 v104, 16, v98
    v_and_b32 v105, 0xffff0000, v98
    v_add_f32 v20, v20, v104
    v_add_f32 v21, v21, v105
    v_lshlrev_b32 v104, 16, v99
    v_and_b32 v105, 0xffff0000, v99
    v_add_f32 v22, v22, v104
    v_add_f32 v23, v23, v105
    v_cvt_pk_bf16_f32 v106, v20, v21
    v_cvt_pk_bf16_f32 v107, v22, v23
    buffer_store_dwordx2 v[106:107], v5, s[52:55], 0 offen offset:32
    s_nop 1
    v_lshlrev_b32 v104, 16, v100
    v_and_b32 v105, 0xffff0000, v100
    v_add_f32 v24, v24, v104
    v_add_f32 v25, v25, v105
    v_lshlrev_b32 v104, 16, v101
    v_and_b32 v105, 0xffff0000, v101
    v_add_f32 v26, v26, v104
    v_add_f32 v27, v27, v105
    v_cvt_pk_bf16_f32 v106, v24, v25
    v_cvt_pk_bf16_f32 v107, v26, v27
    buffer_store_dwordx2 v[106:107], v5, s[52:55], 0 offen offset:64
    s_nop 1
    v_lshlrev_b32 v104, 16, v102
    v_and_b32 v105, 0xffff0000, v102
    v_add_f32 v28, v28, v104
    v_add_f32 v29, v29, v105
    v_lshlrev_b32 v104, 16, v103
    v_and_b32 v105, 0xffff0000, v103
    v_add_f32 v30, v30, v104
    v_add_f32 v31, v31, v105
    v_cvt_pk_bf16_f32 v106, v28, v29
    v_cvt_pk_bf16_f32 v107, v30, v31
    buffer_store_dwordx2 v[106:107], v5, s[52:55], 0 offen offset:96
    s_nop 1
    v_add_u32 v5, 20480, v5
    buffer_load_dwordx2 v[96:97], v5, s[56:59], 0 offen offset:0
    buffer_load_dwordx2 v[98:99], v5, s[56:59], 0 offen offset:32
    buffer_load_dwordx2 v[100:101], v5, s[56:59], 0 offen offset:64
    buffer_load_dwordx2 v[102:103], v5, s[56:59], 0 offen offset:96
    s_waitcnt vmcnt(0)
    v_lshlrev_b32 v104, 16, v96
    v_and_b32 v105, 0xffff0000, v96
    v_add_f32 v32, v32, v104
    v_add_f32 v33, v33, v105
    v_lshlrev_b32 v104, 16, v97
    v_and_b32 v105, 0xffff0000, v97
    v_add_f32 v34, v34, v104
    v_add_f32 v35, v35, v105
    v_cvt_pk_bf16_f32 v106, v32, v33
    v_cvt_pk_bf16_f32 v107, v34, v35
    buffer_store_dwordx2 v[106:107], v5, s[52:55], 0 offen offset:0
    s_nop 1
    v_lshlrev_b32 v104, 16, v98
    v_and_b32 v105, 0xffff0000, v98
    v_add_f32 v36, v36, v104
    v_add_f32 v37, v37, v105
    v_lshlrev_b32 v104, 16, v99
    v_and_b32 v105, 0xffff0000, v99
    v_add_f32 v38, v38, v104
    v_add_f32 v39, v39, v105
    v_cvt_pk_bf16_f32 v106, v36, v37
    v_cvt_pk_bf16_f32 v107, v38, v39
    buffer_store_dwordx2 v[106:107], v5, s[52:55], 0 offen offset:32
    s_nop 1
    v_lshlrev_b32 v104, 16, v100
    v_and_b32 v105, 0xffff0000, v100
    v_add_f32 v40, v40, v104
    v_add_f32 v41, v41, v105
    v_lshlrev_b32 v104, 16, v101
    v_and_b32 v105, 0xffff0000, v101
    v_add_f32 v42, v42, v104
    v_add_f32 v43, v43, v105
    v_cvt_pk_bf16_f32 v106, v40, v41
    v_cvt_pk_bf16_f32 v107, v42, v43
    buffer_store_dwordx2 v[106:107], v5, s[52:55], 0 offen offset:64
    s_nop 1
    v_lshlrev_b32 v104, 16, v102
    v_and_b32 v105, 0xffff0000, v102
    v_add_f32 v44, v44, v104
    v_add_f32 v45, v45, v105
    v_lshlrev_b32 v104, 16, v103
    v_and_b32 v105, 0xffff0000, v103
    v_add_f32 v46, v46, v104
    v_add_f32 v47, v47, v105
    v_cvt_pk_bf16_f32 v106, v44, v45
    v_cvt_pk_bf16_f32 v107, v46, v47
    buffer_store_dwordx2 v[106:107], v5, s[52:55], 0 offen offset:96
    s_nop 1
wo_0_kernel_end:
    s_endpgm
.globl ln2_0_kernel
.p2align 8
.type ln2_0_kernel,@function
ln2_0_kernel:
    s_cmp_ge_u32 s2, 512
    s_cbranch_scc1 ln2_0_kernel_end
    s_load_dwordx16 s[16:31], s[0:1], 0
    s_load_dwordx4 s[32:35], s[0:1], 64
    s_load_dwordx2 s[36:37], s[0:1], 80
    s_waitcnt lgkmcnt(0)
    s_add_u32 s40, s36, 0x1400000
    s_addc_u32 s41, s37, 0
    s_mov_b32 s42, 0x280000
    s_mov_b32 s43, 0x00020000
    s_mov_b32 s44, s36
    s_mov_b32 s45, s37
    s_mov_b32 s46, 0x280000
    s_mov_b32 s47, 0x00020000
    v_lshrrev_b32 v1, 6, v0
    v_and_b32 v2, 63, v0
    s_lshl_b32 s3, s2, 2
    v_add_u32 v1, s3, v1
    v_mul_u32_u24 v3, 1280, v1
    v_mul_u32_u24 v4, 20, v2
    v_add_u32 v3, v3, v4
    buffer_load_dwordx4 v[8:11], v3, s[40:43], 0 offen
    buffer_load_dword v12, v3, s[40:43], 0 offen offset:16
    s_waitcnt vmcnt(0)
    v_lshlrev_b32 v16, 16, v8
    v_and_b32 v17, 0xffff0000, v8
    v_lshlrev_b32 v18, 16, v9
    v_and_b32 v19, 0xffff0000, v9
    v_lshlrev_b32 v20, 16, v10
    v_and_b32 v21, 0xffff0000, v10
    v_lshlrev_b32 v22, 16, v11
    v_and_b32 v23, 0xffff0000, v11
    v_lshlrev_b32 v24, 16, v12
    v_and_b32 v25, 0xffff0000, v12
    v_add_f32 v30, v16, v17
    v_add_f32 v30, v30, v18
    v_add_f32 v30, v30, v19
    v_add_f32 v30, v30, v20
    v_add_f32 v30, v30, v21
    v_add_f32 v30, v30, v22
    v_add_f32 v30, v30, v23
    v_add_f32 v30, v30, v24
    v_add_f32 v30, v30, v25
    ds_swizzle_b32 v31, v30 offset:0x41f
    s_waitcnt lgkmcnt(0)
    v_add_f32 v30, v30, v31
    ds_swizzle_b32 v31, v30 offset:0x81f
    s_waitcnt lgkmcnt(0)
    v_add_f32 v30, v30, v31
    ds_swizzle_b32 v31, v30 offset:0x101f
    s_waitcnt lgkmcnt(0)
    v_add_f32 v30, v30, v31
    ds_swizzle_b32 v31, v30 offset:0x201f
    s_waitcnt lgkmcnt(0)
    v_add_f32 v30, v30, v31
    ds_swizzle_b32 v31, v30 offset:0x401f
    s_waitcnt lgkmcnt(0)
    v_add_f32 v30, v30, v31
    s_nop 1
    v_readlane_b32 s4, v30, 0
    v_readlane_b32 s5, v30, 32
    s_nop 1
    v_mov_b32 v30, s4
    v_add_f32 v30, s5, v30
    v_mul_f32 v30, 0x3acccccd, v30
    v_sub_f32 v16, v16, v30
    v_sub_f32 v17, v17, v30
    v_sub_f32 v18, v18, v30
    v_sub_f32 v19, v19, v30
    v_sub_f32 v20, v20, v30
    v_sub_f32 v21, v21, v30
    v_sub_f32 v22, v22, v30
    v_sub_f32 v23, v23, v30
    v_sub_f32 v24, v24, v30
    v_sub_f32 v25, v25, v30
    v_mul_f32 v32, v16, v16
    v_fmac_f32 v32, v17, v17
    v_fmac_f32 v32, v18, v18
    v_fmac_f32 v32, v19, v19
    v_fmac_f32 v32, v20, v20
    v_fmac_f32 v32, v21, v21
    v_fmac_f32 v32, v22, v22
    v_fmac_f32 v32, v23, v23
    v_fmac_f32 v32, v24, v24
    v_fmac_f32 v32, v25, v25
    ds_swizzle_b32 v31, v32 offset:0x41f
    s_waitcnt lgkmcnt(0)
    v_add_f32 v32, v32, v31
    ds_swizzle_b32 v31, v32 offset:0x81f
    s_waitcnt lgkmcnt(0)
    v_add_f32 v32, v32, v31
    ds_swizzle_b32 v31, v32 offset:0x101f
    s_waitcnt lgkmcnt(0)
    v_add_f32 v32, v32, v31
    ds_swizzle_b32 v31, v32 offset:0x201f
    s_waitcnt lgkmcnt(0)
    v_add_f32 v32, v32, v31
    ds_swizzle_b32 v31, v32 offset:0x401f
    s_waitcnt lgkmcnt(0)
    v_add_f32 v32, v32, v31
    s_nop 1
    v_readlane_b32 s4, v32, 0
    v_readlane_b32 s5, v32, 32
    s_nop 1
    v_mov_b32 v32, s4
    v_add_f32 v32, s5, v32
    v_mov_b32 v33, 0x3727c5ac
    v_fmac_f32 v33, 0x3acccccd, v32
    v_rsq_f32 v33, v33
    s_nop 0
    v_mul_f32 v16, v16, v33
    v_mul_f32 v17, v17, v33
    v_mul_f32 v18, v18, v33
    v_mul_f32 v19, v19, v33
    v_mul_f32 v20, v20, v33
    v_mul_f32 v21, v21, v33
    v_mul_f32 v22, v22, v33
    v_mul_f32 v23, v23, v33
    v_mul_f32 v24, v24, v33
    v_mul_f32 v25, v25, v33
    v_cvt_pk_bf16_f32 v8, v16, v17
    v_cvt_pk_bf16_f32 v9, v18, v19
    v_cvt_pk_bf16_f32 v10, v20, v21
    v_cvt_pk_bf16_f32 v11, v22, v23
    v_cvt_pk_bf16_f32 v12, v24, v25
    buffer_store_dwordx4 v[8:11], v3, s[44:47], 0 offen
    buffer_store_dword v12, v3, s[44:47], 0 offen offset:16
ln2_0_kernel_end:
    s_endpgm
.globl gu_0_kernel
.p2align 8
.type gu_0_kernel,@function
gu_0_kernel:
    s_cmp_ge_u32 s2, 432
    s_cbranch_scc1 gu_0_kernel_end
    s_load_dwordx16 s[16:31], s[0:1], 0
    s_load_dwordx4 s[32:35], s[0:1], 64
    s_load_dwordx2 s[36:37], s[0:1], 80
    s_waitcnt lgkmcnt(0)
    s_mov_b32 s40, s36
    s_mov_b32 s41, s37
    s_mov_b32 s42, 0x280000
    s_mov_b32 s43, 0x00020000
    s_mov_b32 s44, s26
    s_mov_b32 s45, s27
    s_mov_b32 s46, 0x21c000
    s_mov_b32 s47, 0x00020000
    s_mov_b32 s48, s28
    s_mov_b32 s49, s29
    s_mov_b32 s50, 0x21c000
    s_mov_b32 s51, 0x00020000
    s_add_u32 s52, s36, 0x1800000
    s_addc_u32 s53, s37, 0
    s_mov_b32 s54, 0x6c0000
    s_mov_b32 s55, 0x00020000
    s_and_b32 s4, s2, 15
    s_lshr_b32 s5, s2, 4
    v_lshrrev_b32 v1, 6, v0
    s_nop 0
    v_readfirstlane_b32 s6, v1
    v_and_b32 v2, 63, v0
    v_and_b32 v3, 15, v0
    v_bfe_u32 v4, v0, 4, 2
    v_lshrrev_b32 v5, 3, v0
    v_and_b32 v6, 7, v0
    s_mul_i32 s7, s4, 163840
    v_mul_u32_u24 v7, 1280, v5
    v_lshl_add_u32 v7, v6, 4, v7
    v_add_u32 v7, s7, v7
    v_mul_u32_u24 v8, 144, v5
    v_lshl_add_u32 v8, v6, 4, v8
    v_and_b32 v9, 127, v0
    v_lshrrev_b32 v9, 3, v9
    s_lshr_b32 s8, s6, 1
    v_mul_u32_u24 v10, 3456, v9
    v_lshl_add_u32 v10, v6, 4, v10
    s_lshl_b32 s9, s5, 7
    s_cmp_eq_u32 s8, 0
    s_cselect_b32 s60, s44, s48
    s_cselect_b32 s61, s45, s49
    s_cselect_b32 s62, s46, s50
    s_cselect_b32 s63, s47, s51
    v_add_u32 v10, s9, v10
    v_mul_u32_u24 v11, 288, v9
    v_lshl_add_u32 v11, v6, 4, v11
    s_lshl_b32 s10, s8, 7
    v_add_u32 v11, s10, v11
    v_add_u32 v11, 18432, v11
    s_mov_b32 s64, 0
    s_mov_b32 s65, 40960
    s_mov_b32 s66, 81920
    s_mov_b32 s67, 122880
    s_mov_b32 s68, 0
    s_mov_b32 s69, 55296
    s_mov_b32 s70, 110592
    s_mov_b32 s71, 165888
    s_lshr_b32 s10, s6, 1
    s_and_b32 s11, s6, 1
    s_mul_i32 s12, s10, 9216
    v_mul_u32_u24 v12, 144, v3
    v_lshl_add_u32 v12, v4, 3, v12
    v_add_u32 v12, s12, v12
    v_lshrrev_b32 v13, 2, v3
    v_lshl_add_u32 v13, v4, 2, v13
    v_mul_u32_u24 v13, 288, v13
    v_and_b32 v14, 3, v3
    v_lshl_add_u32 v13, v14, 3, v13
    s_lshl_b32 s13, s11, 6
    s_add_u32 s13, s13, 18432
    v_add_u32 v13, s13, v13
    v_mov_b32 v16, 0
    v_mov_b32 v17, 0
    v_mov_b32 v18, 0
    v_mov_b32 v19, 0
    v_mov_b32 v20, 0
    v_mov_b32 v21, 0
    v_mov_b32 v22, 0
    v_mov_b32 v23, 0
    v_mov_b32 v24, 0
    v_mov_b32 v25, 0
    v_mov_b32 v26, 0
    v_mov_b32 v27, 0
    v_mov_b32 v28, 0
    v_mov_b32 v29, 0
    v_mov_b32 v30, 0
    v_mov_b32 v31, 0
    v_mov_b32 v32, 0
    v_mov_b32 v33, 0
    v_mov_b32 v34, 0
    v_mov_b32 v35, 0
    v_mov_b32 v36, 0
    v_mov_b32 v37, 0
    v_mov_b32 v38, 0
    v_mov_b32 v39, 0
    v_mov_b32 v40, 0
    v_mov_b32 v41, 0
    v_mov_b32 v42, 0
    v_mov_b32 v43, 0
    v_mov_b32 v44, 0
    v_mov_b32 v45, 0
    v_mov_b32 v46, 0
    v_mov_b32 v47, 0
    v_mov_b32 v48, 0
    v_mov_b32 v49, 0
    v_mov_b32 v50, 0
    v_mov_b32 v51, 0
    v_mov_b32 v52, 0
    v_mov_b32 v53, 0
    v_mov_b32 v54, 0
    v_mov_b32 v55, 0
    v_mov_b32 v56, 0
    v_mov_b32 v57, 0
    v_mov_b32 v58, 0
    v_mov_b32 v59, 0
    v_mov_b32 v60, 0
    v_mov_b32 v61, 0
    v_mov_b32 v62, 0
    v_mov_b32 v63, 0
    v_mov_b32 v64, 0
    v_mov_b32 v65, 0
    v_mov_b32 v66, 0
    v_mov_b32 v67, 0
    v_mov_b32 v68, 0
    v_mov_b32 v69, 0
    v_mov_b32 v70, 0
    v_mov_b32 v71, 0
    v_mov_b32 v72, 0
    v_mov_b32 v73, 0
    v_mov_b32 v74, 0
    v_mov_b32 v75, 0
    v_mov_b32 v76, 0
    v_mov_b32 v77, 0
    v_mov_b32 v78, 0
    v_mov_b32 v79, 0
    buffer_load_dwordx4 v[144:147], v7, s[40:43], s64 offen
    buffer_load_dwordx4 v[148:151], v7, s[40:43], s65 offen
    buffer_load_dwordx4 v[152:155], v7, s[40:43], s66 offen
    buffer_load_dwordx4 v[156:159], v7, s[40:43], s67 offen
    buffer_load_dwordx4 v[160:163], v10, s[60:63], s68 offen
    buffer_load_dwordx4 v[164:167], v10, s[60:63], s69 offen
    buffer_load_dwordx4 v[168:171], v10, s[60:63], s70 offen
    buffer_load_dwordx4 v[172:175], v10, s[60:63], s71 offen
    v_add_u32 v7, 128, v7
    v_add_u32 v10, 221184, v10
    buffer_load_dwordx4 v[176:179], v7, s[40:43], s64 offen
    buffer_load_dwordx4 v[180:183], v7, s[40:43], s65 offen
    buffer_load_dwordx4 v[184:187], v7, s[40:43], s66 offen
    buffer_load_dwordx4 v[188:191], v7, s[40:43], s67 offen
    buffer_load_dwordx4 v[192:195], v10, s[60:63], s68 offen
    buffer_load_dwordx4 v[196:199], v10, s[60:63], s69 offen
    buffer_load_dwordx4 v[200:203], v10, s[60:63], s70 offen
    buffer_load_dwordx4 v[204:207], v10, s[60:63], s71 offen
    v_add_u32 v7, 128, v7
    v_add_u32 v10, 221184, v10
    s_waitcnt vmcnt(8)
    ds_write_b128 v8, v[144:147] offset:0
    ds_write_b128 v8, v[148:151] offset:4608
    ds_write_b128 v8, v[152:155] offset:9216
    ds_write_b128 v8, v[156:159] offset:13824
    ds_write_b128 v11, v[160:163] offset:0
    ds_write_b128 v11, v[164:167] offset:4608
    ds_write_b128 v11, v[168:171] offset:9216
    ds_write_b128 v11, v[172:175] offset:13824
    s_waitcnt lgkmcnt(0)
    s_barrier
    buffer_load_dwordx4 v[144:147], v7, s[40:43], s64 offen
    buffer_load_dwordx4 v[148:151], v7, s[40:43], s65 offen
    buffer_load_dwordx4 v[152:155], v7, s[40:43], s66 offen
    buffer_load_dwordx4 v[156:159], v7, s[40:43], s67 offen
    buffer_load_dwordx4 v[160:163], v10, s[60:63], s68 offen
    buffer_load_dwordx4 v[164:167], v10, s[60:63], s69 offen
    buffer_load_dwordx4 v[168:171], v10, s[60:63], s70 offen
    buffer_load_dwordx4 v[172:175], v10, s[60:63], s71 offen
    v_add_u32 v7, 128, v7
    v_add_u32 v10, 221184, v10
    ds_read_b64_tr_b16 v[96:97], v13 offset:0
    ds_read_b64_tr_b16 v[98:99], v13 offset:4608
    ds_read_b64_tr_b16 v[100:101], v13 offset:32
    ds_read_b64_tr_b16 v[102:103], v13 offset:4640
    ds_read_b64_tr_b16 v[104:105], v13 offset:128
    ds_read_b64_tr_b16 v[106:107], v13 offset:4736
    ds_read_b64_tr_b16 v[108:109], v13 offset:160
    ds_read_b64_tr_b16 v[110:111], v13 offset:4768
    ds_read_b64 v[80:81], v12 offset:0
    ds_read_b64 v[82:83], v12 offset:32
    ds_read_b64 v[84:85], v12 offset:2304
    ds_read_b64 v[86:87], v12 offset:2336
    ds_read_b64 v[88:89], v12 offset:4608
    ds_read_b64 v[90:91], v12 offset:4640
    ds_read_b64 v[92:93], v12 offset:6912
    ds_read_b64 v[94:95], v12 offset:6944
    s_waitcnt lgkmcnt(0)
    ds_read_b64_tr_b16 v[128:129], v13 offset:9216
    ds_read_b64_tr_b16 v[130:131], v13 offset:13824
    ds_read_b64_tr_b16 v[132:133], v13 offset:9248
    ds_read_b64_tr_b16 v[134:135], v13 offset:13856
    ds_read_b64_tr_b16 v[136:137], v13 offset:9344
    ds_read_b64_tr_b16 v[138:139], v13 offset:13952
    ds_read_b64_tr_b16 v[140:141], v13 offset:9376
    ds_read_b64_tr_b16 v[142:143], v13 offset:13984
    ds_read_b64 v[112:113], v12 offset:64
    ds_read_b64 v[114:115], v12 offset:96
    ds_read_b64 v[116:117], v12 offset:2368
    ds_read_b64 v[118:119], v12 offset:2400
    ds_read_b64 v[120:121], v12 offset:4672
    ds_read_b64 v[122:123], v12 offset:4704
    ds_read_b64 v[124:125], v12 offset:6976
    ds_read_b64 v[126:127], v12 offset:7008
    v_mfma_f32_16x16x32_bf16 v[16:19], v[96:99], v[80:83], v[16:19]
    v_mfma_f32_16x16x32_bf16 v[20:23], v[100:103], v[80:83], v[20:23]
    v_mfma_f32_16x16x32_bf16 v[24:27], v[104:107], v[80:83], v[24:27]
    v_mfma_f32_16x16x32_bf16 v[28:31], v[108:111], v[80:83], v[28:31]
    v_mfma_f32_16x16x32_bf16 v[32:35], v[96:99], v[84:87], v[32:35]
    v_mfma_f32_16x16x32_bf16 v[36:39], v[100:103], v[84:87], v[36:39]
    v_mfma_f32_16x16x32_bf16 v[40:43], v[104:107], v[84:87], v[40:43]
    v_mfma_f32_16x16x32_bf16 v[44:47], v[108:111], v[84:87], v[44:47]
    v_mfma_f32_16x16x32_bf16 v[48:51], v[96:99], v[88:91], v[48:51]
    v_mfma_f32_16x16x32_bf16 v[52:55], v[100:103], v[88:91], v[52:55]
    v_mfma_f32_16x16x32_bf16 v[56:59], v[104:107], v[88:91], v[56:59]
    v_mfma_f32_16x16x32_bf16 v[60:63], v[108:111], v[88:91], v[60:63]
    v_mfma_f32_16x16x32_bf16 v[64:67], v[96:99], v[92:95], v[64:67]
    v_mfma_f32_16x16x32_bf16 v[68:71], v[100:103], v[92:95], v[68:71]
    v_mfma_f32_16x16x32_bf16 v[72:75], v[104:107], v[92:95], v[72:75]
    v_mfma_f32_16x16x32_bf16 v[76:79], v[108:111], v[92:95], v[76:79]
    s_waitcnt lgkmcnt(0)
    v_mfma_f32_16x16x32_bf16 v[16:19], v[128:131], v[112:115], v[16:19]
    v_mfma_f32_16x16x32_bf16 v[20:23], v[132:135], v[112:115], v[20:23]
    v_mfma_f32_16x16x32_bf16 v[24:27], v[136:139], v[112:115], v[24:27]
    v_mfma_f32_16x16x32_bf16 v[28:31], v[140:143], v[112:115], v[28:31]
    v_mfma_f32_16x16x32_bf16 v[32:35], v[128:131], v[116:119], v[32:35]
    v_mfma_f32_16x16x32_bf16 v[36:39], v[132:135], v[116:119], v[36:39]
    v_mfma_f32_16x16x32_bf16 v[40:43], v[136:139], v[116:119], v[40:43]
    v_mfma_f32_16x16x32_bf16 v[44:47], v[140:143], v[116:119], v[44:47]
    v_mfma_f32_16x16x32_bf16 v[48:51], v[128:131], v[120:123], v[48:51]
    v_mfma_f32_16x16x32_bf16 v[52:55], v[132:135], v[120:123], v[52:55]
    v_mfma_f32_16x16x32_bf16 v[56:59], v[136:139], v[120:123], v[56:59]
    v_mfma_f32_16x16x32_bf16 v[60:63], v[140:143], v[120:123], v[60:63]
    v_mfma_f32_16x16x32_bf16 v[64:67], v[128:131], v[124:127], v[64:67]
    v_mfma_f32_16x16x32_bf16 v[68:71], v[132:135], v[124:127], v[68:71]
    v_mfma_f32_16x16x32_bf16 v[72:75], v[136:139], v[124:127], v[72:75]
    v_mfma_f32_16x16x32_bf16 v[76:79], v[140:143], v[124:127], v[76:79]
    s_waitcnt vmcnt(8)
    ds_write_b128 v8, v[176:179] offset:36864
    ds_write_b128 v8, v[180:183] offset:41472
    ds_write_b128 v8, v[184:187] offset:46080
    ds_write_b128 v8, v[188:191] offset:50688
    ds_write_b128 v11, v[192:195] offset:36864
    ds_write_b128 v11, v[196:199] offset:41472
    ds_write_b128 v11, v[200:203] offset:46080
    ds_write_b128 v11, v[204:207] offset:50688
    s_waitcnt lgkmcnt(0)
    s_barrier
    buffer_load_dwordx4 v[176:179], v7, s[40:43], s64 offen
    buffer_load_dwordx4 v[180:183], v7, s[40:43], s65 offen
    buffer_load_dwordx4 v[184:187], v7, s[40:43], s66 offen
    buffer_load_dwordx4 v[188:191], v7, s[40:43], s67 offen
    buffer_load_dwordx4 v[192:195], v10, s[60:63], s68 offen
    buffer_load_dwordx4 v[196:199], v10, s[60:63], s69 offen
    buffer_load_dwordx4 v[200:203], v10, s[60:63], s70 offen
    buffer_load_dwordx4 v[204:207], v10, s[60:63], s71 offen
    v_add_u32 v7, 128, v7
    v_add_u32 v10, 221184, v10
    ds_read_b64_tr_b16 v[96:97], v13 offset:36864
    ds_read_b64_tr_b16 v[98:99], v13 offset:41472
    ds_read_b64_tr_b16 v[100:101], v13 offset:36896
    ds_read_b64_tr_b16 v[102:103], v13 offset:41504
    ds_read_b64_tr_b16 v[104:105], v13 offset:36992
    ds_read_b64_tr_b16 v[106:107], v13 offset:41600
    ds_read_b64_tr_b16 v[108:109], v13 offset:37024
    ds_read_b64_tr_b16 v[110:111], v13 offset:41632
    ds_read_b64 v[80:81], v12 offset:36864
    ds_read_b64 v[82:83], v12 offset:36896
    ds_read_b64 v[84:85], v12 offset:39168
    ds_read_b64 v[86:87], v12 offset:39200
    ds_read_b64 v[88:89], v12 offset:41472
    ds_read_b64 v[90:91], v12 offset:41504
    ds_read_b64 v[92:93], v12 offset:43776
    ds_read_b64 v[94:95], v12 offset:43808
    s_waitcnt lgkmcnt(0)
    ds_read_b64_tr_b16 v[128:129], v13 offset:46080
    ds_read_b64_tr_b16 v[130:131], v13 offset:50688
    ds_read_b64_tr_b16 v[132:133], v13 offset:46112
    ds_read_b64_tr_b16 v[134:135], v13 offset:50720
    ds_read_b64_tr_b16 v[136:137], v13 offset:46208
    ds_read_b64_tr_b16 v[138:139], v13 offset:50816
    ds_read_b64_tr_b16 v[140:141], v13 offset:46240
    ds_read_b64_tr_b16 v[142:143], v13 offset:50848
    ds_read_b64 v[112:113], v12 offset:36928
    ds_read_b64 v[114:115], v12 offset:36960
    ds_read_b64 v[116:117], v12 offset:39232
    ds_read_b64 v[118:119], v12 offset:39264
    ds_read_b64 v[120:121], v12 offset:41536
    ds_read_b64 v[122:123], v12 offset:41568
    ds_read_b64 v[124:125], v12 offset:43840
    ds_read_b64 v[126:127], v12 offset:43872
    v_mfma_f32_16x16x32_bf16 v[16:19], v[96:99], v[80:83], v[16:19]
    v_mfma_f32_16x16x32_bf16 v[20:23], v[100:103], v[80:83], v[20:23]
    v_mfma_f32_16x16x32_bf16 v[24:27], v[104:107], v[80:83], v[24:27]
    v_mfma_f32_16x16x32_bf16 v[28:31], v[108:111], v[80:83], v[28:31]
    v_mfma_f32_16x16x32_bf16 v[32:35], v[96:99], v[84:87], v[32:35]
    v_mfma_f32_16x16x32_bf16 v[36:39], v[100:103], v[84:87], v[36:39]
    v_mfma_f32_16x16x32_bf16 v[40:43], v[104:107], v[84:87], v[40:43]
    v_mfma_f32_16x16x32_bf16 v[44:47], v[108:111], v[84:87], v[44:47]
    v_mfma_f32_16x16x32_bf16 v[48:51], v[96:99], v[88:91], v[48:51]
    v_mfma_f32_16x16x32_bf16 v[52:55], v[100:103], v[88:91], v[52:55]
    v_mfma_f32_16x16x32_bf16 v[56:59], v[104:107], v[88:91], v[56:59]
    v_mfma_f32_16x16x32_bf16 v[60:63], v[108:111], v[88:91], v[60:63]
    v_mfma_f32_16x16x32_bf16 v[64:67], v[96:99], v[92:95], v[64:67]
    v_mfma_f32_16x16x32_bf16 v[68:71], v[100:103], v[92:95], v[68:71]
    v_mfma_f32_16x16x32_bf16 v[72:75], v[104:107], v[92:95], v[72:75]
    v_mfma_f32_16x16x32_bf16 v[76:79], v[108:111], v[92:95], v[76:79]
    s_waitcnt lgkmcnt(0)
    v_mfma_f32_16x16x32_bf16 v[16:19], v[128:131], v[112:115], v[16:19]
    v_mfma_f32_16x16x32_bf16 v[20:23], v[132:135], v[112:115], v[20:23]
    v_mfma_f32_16x16x32_bf16 v[24:27], v[136:139], v[112:115], v[24:27]
    v_mfma_f32_16x16x32_bf16 v[28:31], v[140:143], v[112:115], v[28:31]
    v_mfma_f32_16x16x32_bf16 v[32:35], v[128:131], v[116:119], v[32:35]
    v_mfma_f32_16x16x32_bf16 v[36:39], v[132:135], v[116:119], v[36:39]
    v_mfma_f32_16x16x32_bf16 v[40:43], v[136:139], v[116:119], v[40:43]
    v_mfma_f32_16x16x32_bf16 v[44:47], v[140:143], v[116:119], v[44:47]
    v_mfma_f32_16x16x32_bf16 v[48:51], v[128:131], v[120:123], v[48:51]
    v_mfma_f32_16x16x32_bf16 v[52:55], v[132:135], v[120:123], v[52:55]
    v_mfma_f32_16x16x32_bf16 v[56:59], v[136:139], v[120:123], v[56:59]
    v_mfma_f32_16x16x32_bf16 v[60:63], v[140:143], v[120:123], v[60:63]
    v_mfma_f32_16x16x32_bf16 v[64:67], v[128:131], v[124:127], v[64:67]
    v_mfma_f32_16x16x32_bf16 v[68:71], v[132:135], v[124:127], v[68:71]
    v_mfma_f32_16x16x32_bf16 v[72:75], v[136:139], v[124:127], v[72:75]
    v_mfma_f32_16x16x32_bf16 v[76:79], v[140:143], v[124:127], v[76:79]
    s_waitcnt vmcnt(8)
    ds_write_b128 v8, v[144:147] offset:0
    ds_write_b128 v8, v[148:151] offset:4608
    ds_write_b128 v8, v[152:155] offset:9216
    ds_write_b128 v8, v[156:159] offset:13824
    ds_write_b128 v11, v[160:163] offset:0
    ds_write_b128 v11, v[164:167] offset:4608
    ds_write_b128 v11, v[168:171] offset:9216
    ds_write_b128 v11, v[172:175] offset:13824
    s_waitcnt lgkmcnt(0)
    s_barrier
    buffer_load_dwordx4 v[144:147], v7, s[40:43], s64 offen
    buffer_load_dwordx4 v[148:151], v7, s[40:43], s65 offen
    buffer_load_dwordx4 v[152:155], v7, s[40:43], s66 offen
    buffer_load_dwordx4 v[156:159], v7, s[40:43], s67 offen
    buffer_load_dwordx4 v[160:163], v10, s[60:63], s68 offen
    buffer_load_dwordx4 v[164:167], v10, s[60:63], s69 offen
    buffer_load_dwordx4 v[168:171], v10, s[60:63], s70 offen
    buffer_load_dwordx4 v[172:175], v10, s[60:63], s71 offen
    v_add_u32 v7, 128, v7
    v_add_u32 v10, 221184, v10
    ds_read_b64_tr_b16 v[96:97], v13 offset:0
    ds_read_b64_tr_b16 v[98:99], v13 offset:4608
    ds_read_b64_tr_b16 v[100:101], v13 offset:32
    ds_read_b64_tr_b16 v[102:103], v13 offset:4640
    ds_read_b64_tr_b16 v[104:105], v13 offset:128
    ds_read_b64_tr_b16 v[106:107], v13 offset:4736
    ds_read_b64_tr_b16 v[108:109], v13 offset:160
    ds_read_b64_tr_b16 v[110:111], v13 offset:4768
    ds_read_b64 v[80:81], v12 offset:0
    ds_read_b64 v[82:83], v12 offset:32
    ds_read_b64 v[84:85], v12 offset:2304
    ds_read_b64 v[86:87], v12 offset:2336
    ds_read_b64 v[88:89], v12 offset:4608
    ds_read_b64 v[90:91], v12 offset:4640
    ds_read_b64 v[92:93], v12 offset:6912
    ds_read_b64 v[94:95], v12 offset:6944
    s_waitcnt lgkmcnt(0)
    ds_read_b64_tr_b16 v[128:129], v13 offset:9216
    ds_read_b64_tr_b16 v[130:131], v13 offset:13824
    ds_read_b64_tr_b16 v[132:133], v13 offset:9248
    ds_read_b64_tr_b16 v[134:135], v13 offset:13856
    ds_read_b64_tr_b16 v[136:137], v13 offset:9344
    ds_read_b64_tr_b16 v[138:139], v13 offset:13952
    ds_read_b64_tr_b16 v[140:141], v13 offset:9376
    ds_read_b64_tr_b16 v[142:143], v13 offset:13984
    ds_read_b64 v[112:113], v12 offset:64
    ds_read_b64 v[114:115], v12 offset:96
    ds_read_b64 v[116:117], v12 offset:2368
    ds_read_b64 v[118:119], v12 offset:2400
    ds_read_b64 v[120:121], v12 offset:4672
    ds_read_b64 v[122:123], v12 offset:4704
    ds_read_b64 v[124:125], v12 offset:6976
    ds_read_b64 v[126:127], v12 offset:7008
    v_mfma_f32_16x16x32_bf16 v[16:19], v[96:99], v[80:83], v[16:19]
    v_mfma_f32_16x16x32_bf16 v[20:23], v[100:103], v[80:83], v[20:23]
    v_mfma_f32_16x16x32_bf16 v[24:27], v[104:107], v[80:83], v[24:27]
    v_mfma_f32_16x16x32_bf16 v[28:31], v[108:111], v[80:83], v[28:31]
    v_mfma_f32_16x16x32_bf16 v[32:35], v[96:99], v[84:87], v[32:35]
    v_mfma_f32_16x16x32_bf16 v[36:39], v[100:103], v[84:87], v[36:39]
    v_mfma_f32_16x16x32_bf16 v[40:43], v[104:107], v[84:87], v[40:43]
    v_mfma_f32_16x16x32_bf16 v[44:47], v[108:111], v[84:87], v[44:47]
    v_mfma_f32_16x16x32_bf16 v[48:51], v[96:99], v[88:91], v[48:51]
    v_mfma_f32_16x16x32_bf16 v[52:55], v[100:103], v[88:91], v[52:55]
    v_mfma_f32_16x16x32_bf16 v[56:59], v[104:107], v[88:91], v[56:59]
    v_mfma_f32_16x16x32_bf16 v[60:63], v[108:111], v[88:91], v[60:63]
    v_mfma_f32_16x16x32_bf16 v[64:67], v[96:99], v[92:95], v[64:67]
    v_mfma_f32_16x16x32_bf16 v[68:71], v[100:103], v[92:95], v[68:71]
    v_mfma_f32_16x16x32_bf16 v[72:75], v[104:107], v[92:95], v[72:75]
    v_mfma_f32_16x16x32_bf16 v[76:79], v[108:111], v[92:95], v[76:79]
    s_waitcnt lgkmcnt(0)
    v_mfma_f32_16x16x32_bf16 v[16:19], v[128:131], v[112:115], v[16:19]
    v_mfma_f32_16x16x32_bf16 v[20:23], v[132:135], v[112:115], v[20:23]
    v_mfma_f32_16x16x32_bf16 v[24:27], v[136:139], v[112:115], v[24:27]
    v_mfma_f32_16x16x32_bf16 v[28:31], v[140:143], v[112:115], v[28:31]
    v_mfma_f32_16x16x32_bf16 v[32:35], v[128:131], v[116:119], v[32:35]
    v_mfma_f32_16x16x32_bf16 v[36:39], v[132:135], v[116:119], v[36:39]
    v_mfma_f32_16x16x32_bf16 v[40:43], v[136:139], v[116:119], v[40:43]
    v_mfma_f32_16x16x32_bf16 v[44:47], v[140:143], v[116:119], v[44:47]
    v_mfma_f32_16x16x32_bf16 v[48:51], v[128:131], v[120:123], v[48:51]
    v_mfma_f32_16x16x32_bf16 v[52:55], v[132:135], v[120:123], v[52:55]
    v_mfma_f32_16x16x32_bf16 v[56:59], v[136:139], v[120:123], v[56:59]
    v_mfma_f32_16x16x32_bf16 v[60:63], v[140:143], v[120:123], v[60:63]
    v_mfma_f32_16x16x32_bf16 v[64:67], v[128:131], v[124:127], v[64:67]
    v_mfma_f32_16x16x32_bf16 v[68:71], v[132:135], v[124:127], v[68:71]
    v_mfma_f32_16x16x32_bf16 v[72:75], v[136:139], v[124:127], v[72:75]
    v_mfma_f32_16x16x32_bf16 v[76:79], v[140:143], v[124:127], v[76:79]
    s_waitcnt vmcnt(8)
    ds_write_b128 v8, v[176:179] offset:36864
    ds_write_b128 v8, v[180:183] offset:41472
    ds_write_b128 v8, v[184:187] offset:46080
    ds_write_b128 v8, v[188:191] offset:50688
    ds_write_b128 v11, v[192:195] offset:36864
    ds_write_b128 v11, v[196:199] offset:41472
    ds_write_b128 v11, v[200:203] offset:46080
    ds_write_b128 v11, v[204:207] offset:50688
    s_waitcnt lgkmcnt(0)
    s_barrier
    buffer_load_dwordx4 v[176:179], v7, s[40:43], s64 offen
    buffer_load_dwordx4 v[180:183], v7, s[40:43], s65 offen
    buffer_load_dwordx4 v[184:187], v7, s[40:43], s66 offen
    buffer_load_dwordx4 v[188:191], v7, s[40:43], s67 offen
    buffer_load_dwordx4 v[192:195], v10, s[60:63], s68 offen
    buffer_load_dwordx4 v[196:199], v10, s[60:63], s69 offen
    buffer_load_dwordx4 v[200:203], v10, s[60:63], s70 offen
    buffer_load_dwordx4 v[204:207], v10, s[60:63], s71 offen
    v_add_u32 v7, 128, v7
    v_add_u32 v10, 221184, v10
    ds_read_b64_tr_b16 v[96:97], v13 offset:36864
    ds_read_b64_tr_b16 v[98:99], v13 offset:41472
    ds_read_b64_tr_b16 v[100:101], v13 offset:36896
    ds_read_b64_tr_b16 v[102:103], v13 offset:41504
    ds_read_b64_tr_b16 v[104:105], v13 offset:36992
    ds_read_b64_tr_b16 v[106:107], v13 offset:41600
    ds_read_b64_tr_b16 v[108:109], v13 offset:37024
    ds_read_b64_tr_b16 v[110:111], v13 offset:41632
    ds_read_b64 v[80:81], v12 offset:36864
    ds_read_b64 v[82:83], v12 offset:36896
    ds_read_b64 v[84:85], v12 offset:39168
    ds_read_b64 v[86:87], v12 offset:39200
    ds_read_b64 v[88:89], v12 offset:41472
    ds_read_b64 v[90:91], v12 offset:41504
    ds_read_b64 v[92:93], v12 offset:43776
    ds_read_b64 v[94:95], v12 offset:43808
    s_waitcnt lgkmcnt(0)
    ds_read_b64_tr_b16 v[128:129], v13 offset:46080
    ds_read_b64_tr_b16 v[130:131], v13 offset:50688
    ds_read_b64_tr_b16 v[132:133], v13 offset:46112
    ds_read_b64_tr_b16 v[134:135], v13 offset:50720
    ds_read_b64_tr_b16 v[136:137], v13 offset:46208
    ds_read_b64_tr_b16 v[138:139], v13 offset:50816
    ds_read_b64_tr_b16 v[140:141], v13 offset:46240
    ds_read_b64_tr_b16 v[142:143], v13 offset:50848
    ds_read_b64 v[112:113], v12 offset:36928
    ds_read_b64 v[114:115], v12 offset:36960
    ds_read_b64 v[116:117], v12 offset:39232
    ds_read_b64 v[118:119], v12 offset:39264
    ds_read_b64 v[120:121], v12 offset:41536
    ds_read_b64 v[122:123], v12 offset:41568
    ds_read_b64 v[124:125], v12 offset:43840
    ds_read_b64 v[126:127], v12 offset:43872
    v_mfma_f32_16x16x32_bf16 v[16:19], v[96:99], v[80:83], v[16:19]
    v_mfma_f32_16x16x32_bf16 v[20:23], v[100:103], v[80:83], v[20:23]
    v_mfma_f32_16x16x32_bf16 v[24:27], v[104:107], v[80:83], v[24:27]
    v_mfma_f32_16x16x32_bf16 v[28:31], v[108:111], v[80:83], v[28:31]
    v_mfma_f32_16x16x32_bf16 v[32:35], v[96:99], v[84:87], v[32:35]
    v_mfma_f32_16x16x32_bf16 v[36:39], v[100:103], v[84:87], v[36:39]
    v_mfma_f32_16x16x32_bf16 v[40:43], v[104:107], v[84:87], v[40:43]
    v_mfma_f32_16x16x32_bf16 v[44:47], v[108:111], v[84:87], v[44:47]
    v_mfma_f32_16x16x32_bf16 v[48:51], v[96:99], v[88:91], v[48:51]
    v_mfma_f32_16x16x32_bf16 v[52:55], v[100:103], v[88:91], v[52:55]
    v_mfma_f32_16x16x32_bf16 v[56:59], v[104:107], v[88:91], v[56:59]
    v_mfma_f32_16x16x32_bf16 v[60:63], v[108:111], v[88:91], v[60:63]
    v_mfma_f32_16x16x32_bf16 v[64:67], v[96:99], v[92:95], v[64:67]
    v_mfma_f32_16x16x32_bf16 v[68:71], v[100:103], v[92:95], v[68:71]
    v_mfma_f32_16x16x32_bf16 v[72:75], v[104:107], v[92:95], v[72:75]
    v_mfma_f32_16x16x32_bf16 v[76:79], v[108:111], v[92:95], v[76:79]
    s_waitcnt lgkmcnt(0)
    v_mfma_f32_16x16x32_bf16 v[16:19], v[128:131], v[112:115], v[16:19]
    v_mfma_f32_16x16x32_bf16 v[20:23], v[132:135], v[112:115], v[20:23]
    v_mfma_f32_16x16x32_bf16 v[24:27], v[136:139], v[112:115], v[24:27]
    v_mfma_f32_16x16x32_bf16 v[28:31], v[140:143], v[112:115], v[28:31]
    v_mfma_f32_16x16x32_bf16 v[32:35], v[128:131], v[116:119], v[32:35]
    v_mfma_f32_16x16x32_bf16 v[36:39], v[132:135], v[116:119], v[36:39]
    v_mfma_f32_16x16x32_bf16 v[40:43], v[136:139], v[116:119], v[40:43]
    v_mfma_f32_16x16x32_bf16 v[44:47], v[140:143], v[116:119], v[44:47]
    v_mfma_f32_16x16x32_bf16 v[48:51], v[128:131], v[120:123], v[48:51]
    v_mfma_f32_16x16x32_bf16 v[52:55], v[132:135], v[120:123], v[52:55]
    v_mfma_f32_16x16x32_bf16 v[56:59], v[136:139], v[120:123], v[56:59]
    v_mfma_f32_16x16x32_bf16 v[60:63], v[140:143], v[120:123], v[60:63]
    v_mfma_f32_16x16x32_bf16 v[64:67], v[128:131], v[124:127], v[64:67]
    v_mfma_f32_16x16x32_bf16 v[68:71], v[132:135], v[124:127], v[68:71]
    v_mfma_f32_16x16x32_bf16 v[72:75], v[136:139], v[124:127], v[72:75]
    v_mfma_f32_16x16x32_bf16 v[76:79], v[140:143], v[124:127], v[76:79]
    s_waitcnt vmcnt(8)
    ds_write_b128 v8, v[144:147] offset:0
    ds_write_b128 v8, v[148:151] offset:4608
    ds_write_b128 v8, v[152:155] offset:9216
    ds_write_b128 v8, v[156:159] offset:13824
    ds_write_b128 v11, v[160:163] offset:0
    ds_write_b128 v11, v[164:167] offset:4608
    ds_write_b128 v11, v[168:171] offset:9216
    ds_write_b128 v11, v[172:175] offset:13824
    s_waitcnt lgkmcnt(0)
    s_barrier
    buffer_load_dwordx4 v[144:147], v7, s[40:43], s64 offen
    buffer_load_dwordx4 v[148:151], v7, s[40:43], s65 offen
    buffer_load_dwordx4 v[152:155], v7, s[40:43], s66 offen
    buffer_load_dwordx4 v[156:159], v7, s[40:43], s67 offen
    buffer_load_dwordx4 v[160:163], v10, s[60:63], s68 offen
    buffer_load_dwordx4 v[164:167], v10, s[60:63], s69 offen
    buffer_load_dwordx4 v[168:171], v10, s[60:63], s70 offen
    buffer_load_dwordx4 v[172:175], v10, s[60:63], s71 offen
    v_add_u32 v7, 128, v7
    v_add_u32 v10, 221184, v10
    ds_read_b64_tr_b16 v[96:97], v13 offset:0
    ds_read_b64_tr_b16 v[98:99], v13 offset:4608
    ds_read_b64_tr_b16 v[100:101], v13 offset:32
    ds_read_b64_tr_b16 v[102:103], v13 offset:4640
    ds_read_b64_tr_b16 v[104:105], v13 offset:128
    ds_read_b64_tr_b16 v[106:107], v13 offset:4736
    ds_read_b64_tr_b16 v[108:109], v13 offset:160
    ds_read_b64_tr_b16 v[110:111], v13 offset:4768
    ds_read_b64 v[80:81], v12 offset:0
    ds_read_b64 v[82:83], v12 offset:32
    ds_read_b64 v[84:85], v12 offset:2304
    ds_read_b64 v[86:87], v12 offset:2336
    ds_read_b64 v[88:89], v12 offset:4608
    ds_read_b64 v[90:91], v12 offset:4640
    ds_read_b64 v[92:93], v12 offset:6912
    ds_read_b64 v[94:95], v12 offset:6944
    s_waitcnt lgkmcnt(0)
    ds_read_b64_tr_b16 v[128:129], v13 offset:9216
    ds_read_b64_tr_b16 v[130:131], v13 offset:13824
    ds_read_b64_tr_b16 v[132:133], v13 offset:9248
    ds_read_b64_tr_b16 v[134:135], v13 offset:13856
    ds_read_b64_tr_b16 v[136:137], v13 offset:9344
    ds_read_b64_tr_b16 v[138:139], v13 offset:13952
    ds_read_b64_tr_b16 v[140:141], v13 offset:9376
    ds_read_b64_tr_b16 v[142:143], v13 offset:13984
    ds_read_b64 v[112:113], v12 offset:64
    ds_read_b64 v[114:115], v12 offset:96
    ds_read_b64 v[116:117], v12 offset:2368
    ds_read_b64 v[118:119], v12 offset:2400
    ds_read_b64 v[120:121], v12 offset:4672
    ds_read_b64 v[122:123], v12 offset:4704
    ds_read_b64 v[124:125], v12 offset:6976
    ds_read_b64 v[126:127], v12 offset:7008
    v_mfma_f32_16x16x32_bf16 v[16:19], v[96:99], v[80:83], v[16:19]
    v_mfma_f32_16x16x32_bf16 v[20:23], v[100:103], v[80:83], v[20:23]
    v_mfma_f32_16x16x32_bf16 v[24:27], v[104:107], v[80:83], v[24:27]
    v_mfma_f32_16x16x32_bf16 v[28:31], v[108:111], v[80:83], v[28:31]
    v_mfma_f32_16x16x32_bf16 v[32:35], v[96:99], v[84:87], v[32:35]
    v_mfma_f32_16x16x32_bf16 v[36:39], v[100:103], v[84:87], v[36:39]
    v_mfma_f32_16x16x32_bf16 v[40:43], v[104:107], v[84:87], v[40:43]
    v_mfma_f32_16x16x32_bf16 v[44:47], v[108:111], v[84:87], v[44:47]
    v_mfma_f32_16x16x32_bf16 v[48:51], v[96:99], v[88:91], v[48:51]
    v_mfma_f32_16x16x32_bf16 v[52:55], v[100:103], v[88:91], v[52:55]
    v_mfma_f32_16x16x32_bf16 v[56:59], v[104:107], v[88:91], v[56:59]
    v_mfma_f32_16x16x32_bf16 v[60:63], v[108:111], v[88:91], v[60:63]
    v_mfma_f32_16x16x32_bf16 v[64:67], v[96:99], v[92:95], v[64:67]
    v_mfma_f32_16x16x32_bf16 v[68:71], v[100:103], v[92:95], v[68:71]
    v_mfma_f32_16x16x32_bf16 v[72:75], v[104:107], v[92:95], v[72:75]
    v_mfma_f32_16x16x32_bf16 v[76:79], v[108:111], v[92:95], v[76:79]
    s_waitcnt lgkmcnt(0)
    v_mfma_f32_16x16x32_bf16 v[16:19], v[128:131], v[112:115], v[16:19]
    v_mfma_f32_16x16x32_bf16 v[20:23], v[132:135], v[112:115], v[20:23]
    v_mfma_f32_16x16x32_bf16 v[24:27], v[136:139], v[112:115], v[24:27]
    v_mfma_f32_16x16x32_bf16 v[28:31], v[140:143], v[112:115], v[28:31]
    v_mfma_f32_16x16x32_bf16 v[32:35], v[128:131], v[116:119], v[32:35]
    v_mfma_f32_16x16x32_bf16 v[36:39], v[132:135], v[116:119], v[36:39]
    v_mfma_f32_16x16x32_bf16 v[40:43], v[136:139], v[116:119], v[40:43]
    v_mfma_f32_16x16x32_bf16 v[44:47], v[140:143], v[116:119], v[44:47]
    v_mfma_f32_16x16x32_bf16 v[48:51], v[128:131], v[120:123], v[48:51]
    v_mfma_f32_16x16x32_bf16 v[52:55], v[132:135], v[120:123], v[52:55]
    v_mfma_f32_16x16x32_bf16 v[56:59], v[136:139], v[120:123], v[56:59]
    v_mfma_f32_16x16x32_bf16 v[60:63], v[140:143], v[120:123], v[60:63]
    v_mfma_f32_16x16x32_bf16 v[64:67], v[128:131], v[124:127], v[64:67]
    v_mfma_f32_16x16x32_bf16 v[68:71], v[132:135], v[124:127], v[68:71]
    v_mfma_f32_16x16x32_bf16 v[72:75], v[136:139], v[124:127], v[72:75]
    v_mfma_f32_16x16x32_bf16 v[76:79], v[140:143], v[124:127], v[76:79]
    s_waitcnt vmcnt(8)
    ds_write_b128 v8, v[176:179] offset:36864
    ds_write_b128 v8, v[180:183] offset:41472
    ds_write_b128 v8, v[184:187] offset:46080
    ds_write_b128 v8, v[188:191] offset:50688
    ds_write_b128 v11, v[192:195] offset:36864
    ds_write_b128 v11, v[196:199] offset:41472
    ds_write_b128 v11, v[200:203] offset:46080
    ds_write_b128 v11, v[204:207] offset:50688
    s_waitcnt lgkmcnt(0)
    s_barrier
    buffer_load_dwordx4 v[176:179], v7, s[40:43], s64 offen
    buffer_load_dwordx4 v[180:183], v7, s[40:43], s65 offen
    buffer_load_dwordx4 v[184:187], v7, s[40:43], s66 offen
    buffer_load_dwordx4 v[188:191], v7, s[40:43], s67 offen
    buffer_load_dwordx4 v[192:195], v10, s[60:63], s68 offen
    buffer_load_dwordx4 v[196:199], v10, s[60:63], s69 offen
    buffer_load_dwordx4 v[200:203], v10, s[60:63], s70 offen
    buffer_load_dwordx4 v[204:207], v10, s[60:63], s71 offen
    v_add_u32 v7, 128, v7
    v_add_u32 v10, 221184, v10
    ds_read_b64_tr_b16 v[96:97], v13 offset:36864
    ds_read_b64_tr_b16 v[98:99], v13 offset:41472
    ds_read_b64_tr_b16 v[100:101], v13 offset:36896
    ds_read_b64_tr_b16 v[102:103], v13 offset:41504
    ds_read_b64_tr_b16 v[104:105], v13 offset:36992
    ds_read_b64_tr_b16 v[106:107], v13 offset:41600
    ds_read_b64_tr_b16 v[108:109], v13 offset:37024
    ds_read_b64_tr_b16 v[110:111], v13 offset:41632
    ds_read_b64 v[80:81], v12 offset:36864
    ds_read_b64 v[82:83], v12 offset:36896
    ds_read_b64 v[84:85], v12 offset:39168
    ds_read_b64 v[86:87], v12 offset:39200
    ds_read_b64 v[88:89], v12 offset:41472
    ds_read_b64 v[90:91], v12 offset:41504
    ds_read_b64 v[92:93], v12 offset:43776
    ds_read_b64 v[94:95], v12 offset:43808
    s_waitcnt lgkmcnt(0)
    ds_read_b64_tr_b16 v[128:129], v13 offset:46080
    ds_read_b64_tr_b16 v[130:131], v13 offset:50688
    ds_read_b64_tr_b16 v[132:133], v13 offset:46112
    ds_read_b64_tr_b16 v[134:135], v13 offset:50720
    ds_read_b64_tr_b16 v[136:137], v13 offset:46208
    ds_read_b64_tr_b16 v[138:139], v13 offset:50816
    ds_read_b64_tr_b16 v[140:141], v13 offset:46240
    ds_read_b64_tr_b16 v[142:143], v13 offset:50848
    ds_read_b64 v[112:113], v12 offset:36928
    ds_read_b64 v[114:115], v12 offset:36960
    ds_read_b64 v[116:117], v12 offset:39232
    ds_read_b64 v[118:119], v12 offset:39264
    ds_read_b64 v[120:121], v12 offset:41536
    ds_read_b64 v[122:123], v12 offset:41568
    ds_read_b64 v[124:125], v12 offset:43840
    ds_read_b64 v[126:127], v12 offset:43872
    v_mfma_f32_16x16x32_bf16 v[16:19], v[96:99], v[80:83], v[16:19]
    v_mfma_f32_16x16x32_bf16 v[20:23], v[100:103], v[80:83], v[20:23]
    v_mfma_f32_16x16x32_bf16 v[24:27], v[104:107], v[80:83], v[24:27]
    v_mfma_f32_16x16x32_bf16 v[28:31], v[108:111], v[80:83], v[28:31]
    v_mfma_f32_16x16x32_bf16 v[32:35], v[96:99], v[84:87], v[32:35]
    v_mfma_f32_16x16x32_bf16 v[36:39], v[100:103], v[84:87], v[36:39]
    v_mfma_f32_16x16x32_bf16 v[40:43], v[104:107], v[84:87], v[40:43]
    v_mfma_f32_16x16x32_bf16 v[44:47], v[108:111], v[84:87], v[44:47]
    v_mfma_f32_16x16x32_bf16 v[48:51], v[96:99], v[88:91], v[48:51]
    v_mfma_f32_16x16x32_bf16 v[52:55], v[100:103], v[88:91], v[52:55]
    v_mfma_f32_16x16x32_bf16 v[56:59], v[104:107], v[88:91], v[56:59]
    v_mfma_f32_16x16x32_bf16 v[60:63], v[108:111], v[88:91], v[60:63]
    v_mfma_f32_16x16x32_bf16 v[64:67], v[96:99], v[92:95], v[64:67]
    v_mfma_f32_16x16x32_bf16 v[68:71], v[100:103], v[92:95], v[68:71]
    v_mfma_f32_16x16x32_bf16 v[72:75], v[104:107], v[92:95], v[72:75]
    v_mfma_f32_16x16x32_bf16 v[76:79], v[108:111], v[92:95], v[76:79]
    s_waitcnt lgkmcnt(0)
    v_mfma_f32_16x16x32_bf16 v[16:19], v[128:131], v[112:115], v[16:19]
    v_mfma_f32_16x16x32_bf16 v[20:23], v[132:135], v[112:115], v[20:23]
    v_mfma_f32_16x16x32_bf16 v[24:27], v[136:139], v[112:115], v[24:27]
    v_mfma_f32_16x16x32_bf16 v[28:31], v[140:143], v[112:115], v[28:31]
    v_mfma_f32_16x16x32_bf16 v[32:35], v[128:131], v[116:119], v[32:35]
    v_mfma_f32_16x16x32_bf16 v[36:39], v[132:135], v[116:119], v[36:39]
    v_mfma_f32_16x16x32_bf16 v[40:43], v[136:139], v[116:119], v[40:43]
    v_mfma_f32_16x16x32_bf16 v[44:47], v[140:143], v[116:119], v[44:47]
    v_mfma_f32_16x16x32_bf16 v[48:51], v[128:131], v[120:123], v[48:51]
    v_mfma_f32_16x16x32_bf16 v[52:55], v[132:135], v[120:123], v[52:55]
    v_mfma_f32_16x16x32_bf16 v[56:59], v[136:139], v[120:123], v[56:59]
    v_mfma_f32_16x16x32_bf16 v[60:63], v[140:143], v[120:123], v[60:63]
    v_mfma_f32_16x16x32_bf16 v[64:67], v[128:131], v[124:127], v[64:67]
    v_mfma_f32_16x16x32_bf16 v[68:71], v[132:135], v[124:127], v[68:71]
    v_mfma_f32_16x16x32_bf16 v[72:75], v[136:139], v[124:127], v[72:75]
    v_mfma_f32_16x16x32_bf16 v[76:79], v[140:143], v[124:127], v[76:79]
    s_waitcnt vmcnt(8)
    ds_write_b128 v8, v[144:147] offset:0
    ds_write_b128 v8, v[148:151] offset:4608
    ds_write_b128 v8, v[152:155] offset:9216
    ds_write_b128 v8, v[156:159] offset:13824
    ds_write_b128 v11, v[160:163] offset:0
    ds_write_b128 v11, v[164:167] offset:4608
    ds_write_b128 v11, v[168:171] offset:9216
    ds_write_b128 v11, v[172:175] offset:13824
    s_waitcnt lgkmcnt(0)
    s_barrier
    buffer_load_dwordx4 v[144:147], v7, s[40:43], s64 offen
    buffer_load_dwordx4 v[148:151], v7, s[40:43], s65 offen
    buffer_load_dwordx4 v[152:155], v7, s[40:43], s66 offen
    buffer_load_dwordx4 v[156:159], v7, s[40:43], s67 offen
    buffer_load_dwordx4 v[160:163], v10, s[60:63], s68 offen
    buffer_load_dwordx4 v[164:167], v10, s[60:63], s69 offen
    buffer_load_dwordx4 v[168:171], v10, s[60:63], s70 offen
    buffer_load_dwordx4 v[172:175], v10, s[60:63], s71 offen
    v_add_u32 v7, 128, v7
    v_add_u32 v10, 221184, v10
    ds_read_b64_tr_b16 v[96:97], v13 offset:0
    ds_read_b64_tr_b16 v[98:99], v13 offset:4608
    ds_read_b64_tr_b16 v[100:101], v13 offset:32
    ds_read_b64_tr_b16 v[102:103], v13 offset:4640
    ds_read_b64_tr_b16 v[104:105], v13 offset:128
    ds_read_b64_tr_b16 v[106:107], v13 offset:4736
    ds_read_b64_tr_b16 v[108:109], v13 offset:160
    ds_read_b64_tr_b16 v[110:111], v13 offset:4768
    ds_read_b64 v[80:81], v12 offset:0
    ds_read_b64 v[82:83], v12 offset:32
    ds_read_b64 v[84:85], v12 offset:2304
    ds_read_b64 v[86:87], v12 offset:2336
    ds_read_b64 v[88:89], v12 offset:4608
    ds_read_b64 v[90:91], v12 offset:4640
    ds_read_b64 v[92:93], v12 offset:6912
    ds_read_b64 v[94:95], v12 offset:6944
    s_waitcnt lgkmcnt(0)
    ds_read_b64_tr_b16 v[128:129], v13 offset:9216
    ds_read_b64_tr_b16 v[130:131], v13 offset:13824
    ds_read_b64_tr_b16 v[132:133], v13 offset:9248
    ds_read_b64_tr_b16 v[134:135], v13 offset:13856
    ds_read_b64_tr_b16 v[136:137], v13 offset:9344
    ds_read_b64_tr_b16 v[138:139], v13 offset:13952
    ds_read_b64_tr_b16 v[140:141], v13 offset:9376
    ds_read_b64_tr_b16 v[142:143], v13 offset:13984
    ds_read_b64 v[112:113], v12 offset:64
    ds_read_b64 v[114:115], v12 offset:96
    ds_read_b64 v[116:117], v12 offset:2368
    ds_read_b64 v[118:119], v12 offset:2400
    ds_read_b64 v[120:121], v12 offset:4672
    ds_read_b64 v[122:123], v12 offset:4704
    ds_read_b64 v[124:125], v12 offset:6976
    ds_read_b64 v[126:127], v12 offset:7008
    v_mfma_f32_16x16x32_bf16 v[16:19], v[96:99], v[80:83], v[16:19]
    v_mfma_f32_16x16x32_bf16 v[20:23], v[100:103], v[80:83], v[20:23]
    v_mfma_f32_16x16x32_bf16 v[24:27], v[104:107], v[80:83], v[24:27]
    v_mfma_f32_16x16x32_bf16 v[28:31], v[108:111], v[80:83], v[28:31]
    v_mfma_f32_16x16x32_bf16 v[32:35], v[96:99], v[84:87], v[32:35]
    v_mfma_f32_16x16x32_bf16 v[36:39], v[100:103], v[84:87], v[36:39]
    v_mfma_f32_16x16x32_bf16 v[40:43], v[104:107], v[84:87], v[40:43]
    v_mfma_f32_16x16x32_bf16 v[44:47], v[108:111], v[84:87], v[44:47]
    v_mfma_f32_16x16x32_bf16 v[48:51], v[96:99], v[88:91], v[48:51]
    v_mfma_f32_16x16x32_bf16 v[52:55], v[100:103], v[88:91], v[52:55]
    v_mfma_f32_16x16x32_bf16 v[56:59], v[104:107], v[88:91], v[56:59]
    v_mfma_f32_16x16x32_bf16 v[60:63], v[108:111], v[88:91], v[60:63]
    v_mfma_f32_16x16x32_bf16 v[64:67], v[96:99], v[92:95], v[64:67]
    v_mfma_f32_16x16x32_bf16 v[68:71], v[100:103], v[92:95], v[68:71]
    v_mfma_f32_16x16x32_bf16 v[72:75], v[104:107], v[92:95], v[72:75]
    v_mfma_f32_16x16x32_bf16 v[76:79], v[108:111], v[92:95], v[76:79]
    s_waitcnt lgkmcnt(0)
    v_mfma_f32_16x16x32_bf16 v[16:19], v[128:131], v[112:115], v[16:19]
    v_mfma_f32_16x16x32_bf16 v[20:23], v[132:135], v[112:115], v[20:23]
    v_mfma_f32_16x16x32_bf16 v[24:27], v[136:139], v[112:115], v[24:27]
    v_mfma_f32_16x16x32_bf16 v[28:31], v[140:143], v[112:115], v[28:31]
    v_mfma_f32_16x16x32_bf16 v[32:35], v[128:131], v[116:119], v[32:35]
    v_mfma_f32_16x16x32_bf16 v[36:39], v[132:135], v[116:119], v[36:39]
    v_mfma_f32_16x16x32_bf16 v[40:43], v[136:139], v[116:119], v[40:43]
    v_mfma_f32_16x16x32_bf16 v[44:47], v[140:143], v[116:119], v[44:47]
    v_mfma_f32_16x16x32_bf16 v[48:51], v[128:131], v[120:123], v[48:51]
    v_mfma_f32_16x16x32_bf16 v[52:55], v[132:135], v[120:123], v[52:55]
    v_mfma_f32_16x16x32_bf16 v[56:59], v[136:139], v[120:123], v[56:59]
    v_mfma_f32_16x16x32_bf16 v[60:63], v[140:143], v[120:123], v[60:63]
    v_mfma_f32_16x16x32_bf16 v[64:67], v[128:131], v[124:127], v[64:67]
    v_mfma_f32_16x16x32_bf16 v[68:71], v[132:135], v[124:127], v[68:71]
    v_mfma_f32_16x16x32_bf16 v[72:75], v[136:139], v[124:127], v[72:75]
    v_mfma_f32_16x16x32_bf16 v[76:79], v[140:143], v[124:127], v[76:79]
    s_waitcnt vmcnt(8)
    ds_write_b128 v8, v[176:179] offset:36864
    ds_write_b128 v8, v[180:183] offset:41472
    ds_write_b128 v8, v[184:187] offset:46080
    ds_write_b128 v8, v[188:191] offset:50688
    ds_write_b128 v11, v[192:195] offset:36864
    ds_write_b128 v11, v[196:199] offset:41472
    ds_write_b128 v11, v[200:203] offset:46080
    ds_write_b128 v11, v[204:207] offset:50688
    s_waitcnt lgkmcnt(0)
    s_barrier
    buffer_load_dwordx4 v[176:179], v7, s[40:43], s64 offen
    buffer_load_dwordx4 v[180:183], v7, s[40:43], s65 offen
    buffer_load_dwordx4 v[184:187], v7, s[40:43], s66 offen
    buffer_load_dwordx4 v[188:191], v7, s[40:43], s67 offen
    buffer_load_dwordx4 v[192:195], v10, s[60:63], s68 offen
    buffer_load_dwordx4 v[196:199], v10, s[60:63], s69 offen
    buffer_load_dwordx4 v[200:203], v10, s[60:63], s70 offen
    buffer_load_dwordx4 v[204:207], v10, s[60:63], s71 offen
    v_add_u32 v7, 128, v7
    v_add_u32 v10, 221184, v10
    ds_read_b64_tr_b16 v[96:97], v13 offset:36864
    ds_read_b64_tr_b16 v[98:99], v13 offset:41472
    ds_read_b64_tr_b16 v[100:101], v13 offset:36896
    ds_read_b64_tr_b16 v[102:103], v13 offset:41504
    ds_read_b64_tr_b16 v[104:105], v13 offset:36992
    ds_read_b64_tr_b16 v[106:107], v13 offset:41600
    ds_read_b64_tr_b16 v[108:109], v13 offset:37024
    ds_read_b64_tr_b16 v[110:111], v13 offset:41632
    ds_read_b64 v[80:81], v12 offset:36864
    ds_read_b64 v[82:83], v12 offset:36896
    ds_read_b64 v[84:85], v12 offset:39168
    ds_read_b64 v[86:87], v12 offset:39200
    ds_read_b64 v[88:89], v12 offset:41472
    ds_read_b64 v[90:91], v12 offset:41504
    ds_read_b64 v[92:93], v12 offset:43776
    ds_read_b64 v[94:95], v12 offset:43808
    s_waitcnt lgkmcnt(0)
    ds_read_b64_tr_b16 v[128:129], v13 offset:46080
    ds_read_b64_tr_b16 v[130:131], v13 offset:50688
    ds_read_b64_tr_b16 v[132:133], v13 offset:46112
    ds_read_b64_tr_b16 v[134:135], v13 offset:50720
    ds_read_b64_tr_b16 v[136:137], v13 offset:46208
    ds_read_b64_tr_b16 v[138:139], v13 offset:50816
    ds_read_b64_tr_b16 v[140:141], v13 offset:46240
    ds_read_b64_tr_b16 v[142:143], v13 offset:50848
    ds_read_b64 v[112:113], v12 offset:36928
    ds_read_b64 v[114:115], v12 offset:36960
    ds_read_b64 v[116:117], v12 offset:39232
    ds_read_b64 v[118:119], v12 offset:39264
    ds_read_b64 v[120:121], v12 offset:41536
    ds_read_b64 v[122:123], v12 offset:41568
    ds_read_b64 v[124:125], v12 offset:43840
    ds_read_b64 v[126:127], v12 offset:43872
    v_mfma_f32_16x16x32_bf16 v[16:19], v[96:99], v[80:83], v[16:19]
    v_mfma_f32_16x16x32_bf16 v[20:23], v[100:103], v[80:83], v[20:23]
    v_mfma_f32_16x16x32_bf16 v[24:27], v[104:107], v[80:83], v[24:27]
    v_mfma_f32_16x16x32_bf16 v[28:31], v[108:111], v[80:83], v[28:31]
    v_mfma_f32_16x16x32_bf16 v[32:35], v[96:99], v[84:87], v[32:35]
    v_mfma_f32_16x16x32_bf16 v[36:39], v[100:103], v[84:87], v[36:39]
    v_mfma_f32_16x16x32_bf16 v[40:43], v[104:107], v[84:87], v[40:43]
    v_mfma_f32_16x16x32_bf16 v[44:47], v[108:111], v[84:87], v[44:47]
    v_mfma_f32_16x16x32_bf16 v[48:51], v[96:99], v[88:91], v[48:51]
    v_mfma_f32_16x16x32_bf16 v[52:55], v[100:103], v[88:91], v[52:55]
    v_mfma_f32_16x16x32_bf16 v[56:59], v[104:107], v[88:91], v[56:59]
    v_mfma_f32_16x16x32_bf16 v[60:63], v[108:111], v[88:91], v[60:63]
    v_mfma_f32_16x16x32_bf16 v[64:67], v[96:99], v[92:95], v[64:67]
    v_mfma_f32_16x16x32_bf16 v[68:71], v[100:103], v[92:95], v[68:71]
    v_mfma_f32_16x16x32_bf16 v[72:75], v[104:107], v[92:95], v[72:75]
    v_mfma_f32_16x16x32_bf16 v[76:79], v[108:111], v[92:95], v[76:79]
    s_waitcnt lgkmcnt(0)
    v_mfma_f32_16x16x32_bf16 v[16:19], v[128:131], v[112:115], v[16:19]
    v_mfma_f32_16x16x32_bf16 v[20:23], v[132:135], v[112:115], v[20:23]
    v_mfma_f32_16x16x32_bf16 v[24:27], v[136:139], v[112:115], v[24:27]
    v_mfma_f32_16x16x32_bf16 v[28:31], v[140:143], v[112:115], v[28:31]
    v_mfma_f32_16x16x32_bf16 v[32:35], v[128:131], v[116:119], v[32:35]
    v_mfma_f32_16x16x32_bf16 v[36:39], v[132:135], v[116:119], v[36:39]
    v_mfma_f32_16x16x32_bf16 v[40:43], v[136:139], v[116:119], v[40:43]
    v_mfma_f32_16x16x32_bf16 v[44:47], v[140:143], v[116:119], v[44:47]
    v_mfma_f32_16x16x32_bf16 v[48:51], v[128:131], v[120:123], v[48:51]
    v_mfma_f32_16x16x32_bf16 v[52:55], v[132:135], v[120:123], v[52:55]
    v_mfma_f32_16x16x32_bf16 v[56:59], v[136:139], v[120:123], v[56:59]
    v_mfma_f32_16x16x32_bf16 v[60:63], v[140:143], v[120:123], v[60:63]
    v_mfma_f32_16x16x32_bf16 v[64:67], v[128:131], v[124:127], v[64:67]
    v_mfma_f32_16x16x32_bf16 v[68:71], v[132:135], v[124:127], v[68:71]
    v_mfma_f32_16x16x32_bf16 v[72:75], v[136:139], v[124:127], v[72:75]
    v_mfma_f32_16x16x32_bf16 v[76:79], v[140:143], v[124:127], v[76:79]
    s_waitcnt vmcnt(8)
    ds_write_b128 v8, v[144:147] offset:0
    ds_write_b128 v8, v[148:151] offset:4608
    ds_write_b128 v8, v[152:155] offset:9216
    ds_write_b128 v8, v[156:159] offset:13824
    ds_write_b128 v11, v[160:163] offset:0
    ds_write_b128 v11, v[164:167] offset:4608
    ds_write_b128 v11, v[168:171] offset:9216
    ds_write_b128 v11, v[172:175] offset:13824
    s_waitcnt lgkmcnt(0)
    s_barrier
    ds_read_b64_tr_b16 v[96:97], v13 offset:0
    ds_read_b64_tr_b16 v[98:99], v13 offset:4608
    ds_read_b64_tr_b16 v[100:101], v13 offset:32
    ds_read_b64_tr_b16 v[102:103], v13 offset:4640
    ds_read_b64_tr_b16 v[104:105], v13 offset:128
    ds_read_b64_tr_b16 v[106:107], v13 offset:4736
    ds_read_b64_tr_b16 v[108:109], v13 offset:160
    ds_read_b64_tr_b16 v[110:111], v13 offset:4768
    ds_read_b64 v[80:81], v12 offset:0
    ds_read_b64 v[82:83], v12 offset:32
    ds_read_b64 v[84:85], v12 offset:2304
    ds_read_b64 v[86:87], v12 offset:2336
    ds_read_b64 v[88:89], v12 offset:4608
    ds_read_b64 v[90:91], v12 offset:4640
    ds_read_b64 v[92:93], v12 offset:6912
    ds_read_b64 v[94:95], v12 offset:6944
    s_waitcnt lgkmcnt(0)
    ds_read_b64_tr_b16 v[128:129], v13 offset:9216
    ds_read_b64_tr_b16 v[130:131], v13 offset:13824
    ds_read_b64_tr_b16 v[132:133], v13 offset:9248
    ds_read_b64_tr_b16 v[134:135], v13 offset:13856
    ds_read_b64_tr_b16 v[136:137], v13 offset:9344
    ds_read_b64_tr_b16 v[138:139], v13 offset:13952
    ds_read_b64_tr_b16 v[140:141], v13 offset:9376
    ds_read_b64_tr_b16 v[142:143], v13 offset:13984
    ds_read_b64 v[112:113], v12 offset:64
    ds_read_b64 v[114:115], v12 offset:96
    ds_read_b64 v[116:117], v12 offset:2368
    ds_read_b64 v[118:119], v12 offset:2400
    ds_read_b64 v[120:121], v12 offset:4672
    ds_read_b64 v[122:123], v12 offset:4704
    ds_read_b64 v[124:125], v12 offset:6976
    ds_read_b64 v[126:127], v12 offset:7008
    v_mfma_f32_16x16x32_bf16 v[16:19], v[96:99], v[80:83], v[16:19]
    v_mfma_f32_16x16x32_bf16 v[20:23], v[100:103], v[80:83], v[20:23]
    v_mfma_f32_16x16x32_bf16 v[24:27], v[104:107], v[80:83], v[24:27]
    v_mfma_f32_16x16x32_bf16 v[28:31], v[108:111], v[80:83], v[28:31]
    v_mfma_f32_16x16x32_bf16 v[32:35], v[96:99], v[84:87], v[32:35]
    v_mfma_f32_16x16x32_bf16 v[36:39], v[100:103], v[84:87], v[36:39]
    v_mfma_f32_16x16x32_bf16 v[40:43], v[104:107], v[84:87], v[40:43]
    v_mfma_f32_16x16x32_bf16 v[44:47], v[108:111], v[84:87], v[44:47]
    v_mfma_f32_16x16x32_bf16 v[48:51], v[96:99], v[88:91], v[48:51]
    v_mfma_f32_16x16x32_bf16 v[52:55], v[100:103], v[88:91], v[52:55]
    v_mfma_f32_16x16x32_bf16 v[56:59], v[104:107], v[88:91], v[56:59]
    v_mfma_f32_16x16x32_bf16 v[60:63], v[108:111], v[88:91], v[60:63]
    v_mfma_f32_16x16x32_bf16 v[64:67], v[96:99], v[92:95], v[64:67]
    v_mfma_f32_16x16x32_bf16 v[68:71], v[100:103], v[92:95], v[68:71]
    v_mfma_f32_16x16x32_bf16 v[72:75], v[104:107], v[92:95], v[72:75]
    v_mfma_f32_16x16x32_bf16 v[76:79], v[108:111], v[92:95], v[76:79]
    s_waitcnt lgkmcnt(0)
    v_mfma_f32_16x16x32_bf16 v[16:19], v[128:131], v[112:115], v[16:19]
    v_mfma_f32_16x16x32_bf16 v[20:23], v[132:135], v[112:115], v[20:23]
    v_mfma_f32_16x16x32_bf16 v[24:27], v[136:139], v[112:115], v[24:27]
    v_mfma_f32_16x16x32_bf16 v[28:31], v[140:143], v[112:115], v[28:31]
    v_mfma_f32_16x16x32_bf16 v[32:35], v[128:131], v[116:119], v[32:35]
    v_mfma_f32_16x16x32_bf16 v[36:39], v[132:135], v[116:119], v[36:39]
    v_mfma_f32_16x16x32_bf16 v[40:43], v[136:139], v[116:119], v[40:43]
    v_mfma_f32_16x16x32_bf16 v[44:47], v[140:143], v[116:119], v[44:47]
    v_mfma_f32_16x16x32_bf16 v[48:51], v[128:131], v[120:123], v[48:51]
    v_mfma_f32_16x16x32_bf16 v[52:55], v[132:135], v[120:123], v[52:55]
    v_mfma_f32_16x16x32_bf16 v[56:59], v[136:139], v[120:123], v[56:59]
    v_mfma_f32_16x16x32_bf16 v[60:63], v[140:143], v[120:123], v[60:63]
    v_mfma_f32_16x16x32_bf16 v[64:67], v[128:131], v[124:127], v[64:67]
    v_mfma_f32_16x16x32_bf16 v[68:71], v[132:135], v[124:127], v[68:71]
    v_mfma_f32_16x16x32_bf16 v[72:75], v[136:139], v[124:127], v[72:75]
    v_mfma_f32_16x16x32_bf16 v[76:79], v[140:143], v[124:127], v[76:79]
    s_waitcnt vmcnt(0)
    ds_write_b128 v8, v[176:179] offset:36864
    ds_write_b128 v8, v[180:183] offset:41472
    ds_write_b128 v8, v[184:187] offset:46080
    ds_write_b128 v8, v[188:191] offset:50688
    ds_write_b128 v11, v[192:195] offset:36864
    ds_write_b128 v11, v[196:199] offset:41472
    ds_write_b128 v11, v[200:203] offset:46080
    ds_write_b128 v11, v[204:207] offset:50688
    s_waitcnt lgkmcnt(0)
    s_barrier
    ds_read_b64_tr_b16 v[96:97], v13 offset:36864
    ds_read_b64_tr_b16 v[98:99], v13 offset:41472
    ds_read_b64_tr_b16 v[100:101], v13 offset:36896
    ds_read_b64_tr_b16 v[102:103], v13 offset:41504
    ds_read_b64_tr_b16 v[104:105], v13 offset:36992
    ds_read_b64_tr_b16 v[106:107], v13 offset:41600
    ds_read_b64_tr_b16 v[108:109], v13 offset:37024
    ds_read_b64_tr_b16 v[110:111], v13 offset:41632
    ds_read_b64 v[80:81], v12 offset:36864
    ds_read_b64 v[82:83], v12 offset:36896
    ds_read_b64 v[84:85], v12 offset:39168
    ds_read_b64 v[86:87], v12 offset:39200
    ds_read_b64 v[88:89], v12 offset:41472
    ds_read_b64 v[90:91], v12 offset:41504
    ds_read_b64 v[92:93], v12 offset:43776
    ds_read_b64 v[94:95], v12 offset:43808
    s_waitcnt lgkmcnt(0)
    ds_read_b64_tr_b16 v[128:129], v13 offset:46080
    ds_read_b64_tr_b16 v[130:131], v13 offset:50688
    ds_read_b64_tr_b16 v[132:133], v13 offset:46112
    ds_read_b64_tr_b16 v[134:135], v13 offset:50720
    ds_read_b64_tr_b16 v[136:137], v13 offset:46208
    ds_read_b64_tr_b16 v[138:139], v13 offset:50816
    ds_read_b64_tr_b16 v[140:141], v13 offset:46240
    ds_read_b64_tr_b16 v[142:143], v13 offset:50848
    ds_read_b64 v[112:113], v12 offset:36928
    ds_read_b64 v[114:115], v12 offset:36960
    ds_read_b64 v[116:117], v12 offset:39232
    ds_read_b64 v[118:119], v12 offset:39264
    ds_read_b64 v[120:121], v12 offset:41536
    ds_read_b64 v[122:123], v12 offset:41568
    ds_read_b64 v[124:125], v12 offset:43840
    ds_read_b64 v[126:127], v12 offset:43872
    v_mfma_f32_16x16x32_bf16 v[16:19], v[96:99], v[80:83], v[16:19]
    v_mfma_f32_16x16x32_bf16 v[20:23], v[100:103], v[80:83], v[20:23]
    v_mfma_f32_16x16x32_bf16 v[24:27], v[104:107], v[80:83], v[24:27]
    v_mfma_f32_16x16x32_bf16 v[28:31], v[108:111], v[80:83], v[28:31]
    v_mfma_f32_16x16x32_bf16 v[32:35], v[96:99], v[84:87], v[32:35]
    v_mfma_f32_16x16x32_bf16 v[36:39], v[100:103], v[84:87], v[36:39]
    v_mfma_f32_16x16x32_bf16 v[40:43], v[104:107], v[84:87], v[40:43]
    v_mfma_f32_16x16x32_bf16 v[44:47], v[108:111], v[84:87], v[44:47]
    v_mfma_f32_16x16x32_bf16 v[48:51], v[96:99], v[88:91], v[48:51]
    v_mfma_f32_16x16x32_bf16 v[52:55], v[100:103], v[88:91], v[52:55]
    v_mfma_f32_16x16x32_bf16 v[56:59], v[104:107], v[88:91], v[56:59]
    v_mfma_f32_16x16x32_bf16 v[60:63], v[108:111], v[88:91], v[60:63]
    v_mfma_f32_16x16x32_bf16 v[64:67], v[96:99], v[92:95], v[64:67]
    v_mfma_f32_16x16x32_bf16 v[68:71], v[100:103], v[92:95], v[68:71]
    v_mfma_f32_16x16x32_bf16 v[72:75], v[104:107], v[92:95], v[72:75]
    v_mfma_f32_16x16x32_bf16 v[76:79], v[108:111], v[92:95], v[76:79]
    s_waitcnt lgkmcnt(0)
    v_mfma_f32_16x16x32_bf16 v[16:19], v[128:131], v[112:115], v[16:19]
    v_mfma_f32_16x16x32_bf16 v[20:23], v[132:135], v[112:115], v[20:23]
    v_mfma_f32_16x16x32_bf16 v[24:27], v[136:139], v[112:115], v[24:27]
    v_mfma_f32_16x16x32_bf16 v[28:31], v[140:143], v[112:115], v[28:31]
    v_mfma_f32_16x16x32_bf16 v[32:35], v[128:131], v[116:119], v[32:35]
    v_mfma_f32_16x16x32_bf16 v[36:39], v[132:135], v[116:119], v[36:39]
    v_mfma_f32_16x16x32_bf16 v[40:43], v[136:139], v[116:119], v[40:43]
    v_mfma_f32_16x16x32_bf16 v[44:47], v[140:143], v[116:119], v[44:47]
    v_mfma_f32_16x16x32_bf16 v[48:51], v[128:131], v[120:123], v[48:51]
    v_mfma_f32_16x16x32_bf16 v[52:55], v[132:135], v[120:123], v[52:55]
    v_mfma_f32_16x16x32_bf16 v[56:59], v[136:139], v[120:123], v[56:59]
    v_mfma_f32_16x16x32_bf16 v[60:63], v[140:143], v[120:123], v[60:63]
    v_mfma_f32_16x16x32_bf16 v[64:67], v[128:131], v[124:127], v[64:67]
    v_mfma_f32_16x16x32_bf16 v[68:71], v[132:135], v[124:127], v[68:71]
    v_mfma_f32_16x16x32_bf16 v[72:75], v[136:139], v[124:127], v[72:75]
    v_mfma_f32_16x16x32_bf16 v[76:79], v[140:143], v[124:127], v[76:79]
    s_nop 7
    s_nop 7
    s_mul_i32 s7, s4, 128
    s_mul_i32 s12, s10, 64
    s_add_u32 s7, s7, s12
    v_add_u32 v5, s7, v3
    v_mul_u32_u24 v5, 3456, v5
    s_lshl_b32 s12, s5, 7
    s_lshl_b32 s13, s11, 6
    s_add_u32 s12, s12, s13
    v_lshl_add_u32 v5, v4, 3, v5
    v_add_u32 v5, s12, v5
    v_mov_b32 v6, 0x3d372713
    v_mul_f32 v144, v16, v16
    v_fma_f32 v144, v144, v6, 1.0
    v_mul_f32 v144, v144, v16
    v_mul_f32 v144, 0xc0135761, v144
    v_exp_f32 v144, v144
    s_nop 0
    v_add_f32 v144, 1.0, v144
    v_rcp_f32 v144, v144
    s_nop 0
    v_mul_f32 v144, v144, v16
    v_mul_f32 v144, v144, v24
    v_mul_f32 v145, v17, v17
    v_fma_f32 v145, v145, v6, 1.0
    v_mul_f32 v145, v145, v17
    v_mul_f32 v145, 0xc0135761, v145
    v_exp_f32 v145, v145
    s_nop 0
    v_add_f32 v145, 1.0, v145
    v_rcp_f32 v145, v145
    s_nop 0
    v_mul_f32 v145, v145, v17
    v_mul_f32 v145, v145, v25
    v_mul_f32 v146, v18, v18
    v_fma_f32 v146, v146, v6, 1.0
    v_mul_f32 v146, v146, v18
    v_mul_f32 v146, 0xc0135761, v146
    v_exp_f32 v146, v146
    s_nop 0
    v_add_f32 v146, 1.0, v146
    v_rcp_f32 v146, v146
    s_nop 0
    v_mul_f32 v146, v146, v18
    v_mul_f32 v146, v146, v26
    v_mul_f32 v147, v19, v19
    v_fma_f32 v147, v147, v6, 1.0
    v_mul_f32 v147, v147, v19
    v_mul_f32 v147, 0xc0135761, v147
    v_exp_f32 v147, v147
    s_nop 0
    v_add_f32 v147, 1.0, v147
    v_rcp_f32 v147, v147
    s_nop 0
    v_mul_f32 v147, v147, v19
    v_mul_f32 v147, v147, v27
    v_cvt_pk_bf16_f32 v148, v144, v145
    v_cvt_pk_bf16_f32 v149, v146, v147
    buffer_store_dwordx2 v[148:149], v5, s[52:55], 0 offen offset:0
    s_nop 1
    v_mul_f32 v144, v20, v20
    v_fma_f32 v144, v144, v6, 1.0
    v_mul_f32 v144, v144, v20
    v_mul_f32 v144, 0xc0135761, v144
    v_exp_f32 v144, v144
    s_nop 0
    v_add_f32 v144, 1.0, v144
    v_rcp_f32 v144, v144
    s_nop 0
    v_mul_f32 v144, v144, v20
    v_mul_f32 v144, v144, v28
    v_mul_f32 v145, v21, v21
    v_fma_f32 v145, v145, v6, 1.0
    v_mul_f32 v145, v145, v21
    v_mul_f32 v145, 0xc0135761, v145
    v_exp_f32 v145, v145
    s_nop 0
    v_add_f32 v145, 1.0, v145
    v_rcp_f32 v145, v145
    s_nop 0
    v_mul_f32 v145, v145, v21
    v_mul_f32 v145, v145, v29
    v_mul_f32 v146, v22, v22
    v_fma_f32 v146, v146, v6, 1.0
    v_mul_f32 v146, v146, v22
    v_mul_f32 v146, 0xc0135761, v146
    v_exp_f32 v146, v146
    s_nop 0
    v_add_f32 v146, 1.0, v146
    v_rcp_f32 v146, v146
    s_nop 0
    v_mul_f32 v146, v146, v22
    v_mul_f32 v146, v146, v30
    v_mul_f32 v147, v23, v23
    v_fma_f32 v147, v147, v6, 1.0
    v_mul_f32 v147, v147, v23
    v_mul_f32 v147, 0xc0135761, v147
    v_exp_f32 v147, v147
    s_nop 0
    v_add_f32 v147, 1.0, v147
    v_rcp_f32 v147, v147
    s_nop 0
    v_mul_f32 v147, v147, v23
    v_mul_f32 v147, v147, v31
    v_cvt_pk_bf16_f32 v148, v144, v145
    v_cvt_pk_bf16_f32 v149, v146, v147
    buffer_store_dwordx2 v[148:149], v5, s[52:55], 0 offen offset:32
    s_nop 1
    v_add_u32 v5, 55296, v5
    v_mul_f32 v144, v32, v32
    v_fma_f32 v144, v144, v6, 1.0
    v_mul_f32 v144, v144, v32
    v_mul_f32 v144, 0xc0135761, v144
    v_exp_f32 v144, v144
    s_nop 0
    v_add_f32 v144, 1.0, v144
    v_rcp_f32 v144, v144
    s_nop 0
    v_mul_f32 v144, v144, v32
    v_mul_f32 v144, v144, v40
    v_mul_f32 v145, v33, v33
    v_fma_f32 v145, v145, v6, 1.0
    v_mul_f32 v145, v145, v33
    v_mul_f32 v145, 0xc0135761, v145
    v_exp_f32 v145, v145
    s_nop 0
    v_add_f32 v145, 1.0, v145
    v_rcp_f32 v145, v145
    s_nop 0
    v_mul_f32 v145, v145, v33
    v_mul_f32 v145, v145, v41
    v_mul_f32 v146, v34, v34
    v_fma_f32 v146, v146, v6, 1.0
    v_mul_f32 v146, v146, v34
    v_mul_f32 v146, 0xc0135761, v146
    v_exp_f32 v146, v146
    s_nop 0
    v_add_f32 v146, 1.0, v146
    v_rcp_f32 v146, v146
    s_nop 0
    v_mul_f32 v146, v146, v34
    v_mul_f32 v146, v146, v42
    v_mul_f32 v147, v35, v35
    v_fma_f32 v147, v147, v6, 1.0
    v_mul_f32 v147, v147, v35
    v_mul_f32 v147, 0xc0135761, v147
    v_exp_f32 v147, v147
    s_nop 0
    v_add_f32 v147, 1.0, v147
    v_rcp_f32 v147, v147
    s_nop 0
    v_mul_f32 v147, v147, v35
    v_mul_f32 v147, v147, v43
    v_cvt_pk_bf16_f32 v148, v144, v145
    v_cvt_pk_bf16_f32 v149, v146, v147
    buffer_store_dwordx2 v[148:149], v5, s[52:55], 0 offen offset:0
    s_nop 1
    v_mul_f32 v144, v36, v36
    v_fma_f32 v144, v144, v6, 1.0
    v_mul_f32 v144, v144, v36
    v_mul_f32 v144, 0xc0135761, v144
    v_exp_f32 v144, v144
    s_nop 0
    v_add_f32 v144, 1.0, v144
    v_rcp_f32 v144, v144
    s_nop 0
    v_mul_f32 v144, v144, v36
    v_mul_f32 v144, v144, v44
    v_mul_f32 v145, v37, v37
    v_fma_f32 v145, v145, v6, 1.0
    v_mul_f32 v145, v145, v37
    v_mul_f32 v145, 0xc0135761, v145
    v_exp_f32 v145, v145
    s_nop 0
    v_add_f32 v145, 1.0, v145
    v_rcp_f32 v145, v145
    s_nop 0
    v_mul_f32 v145, v145, v37
    v_mul_f32 v145, v145, v45
    v_mul_f32 v146, v38, v38
    v_fma_f32 v146, v146, v6, 1.0
    v_mul_f32 v146, v146, v38
    v_mul_f32 v146, 0xc0135761, v146
    v_exp_f32 v146, v146
    s_nop 0
    v_add_f32 v146, 1.0, v146
    v_rcp_f32 v146, v146
    s_nop 0
    v_mul_f32 v146, v146, v38
    v_mul_f32 v146, v146, v46
    v_mul_f32 v147, v39, v39
    v_fma_f32 v147, v147, v6, 1.0
    v_mul_f32 v147, v147, v39
    v_mul_f32 v147, 0xc0135761, v147
    v_exp_f32 v147, v147
    s_nop 0
    v_add_f32 v147, 1.0, v147
    v_rcp_f32 v147, v147
    s_nop 0
    v_mul_f32 v147, v147, v39
    v_mul_f32 v147, v147, v47
    v_cvt_pk_bf16_f32 v148, v144, v145
    v_cvt_pk_bf16_f32 v149, v146, v147
    buffer_store_dwordx2 v[148:149], v5, s[52:55], 0 offen offset:32
    s_nop 1
    v_add_u32 v5, 55296, v5
    v_mul_f32 v144, v48, v48
    v_fma_f32 v144, v144, v6, 1.0
    v_mul_f32 v144, v144, v48
    v_mul_f32 v144, 0xc0135761, v144
    v_exp_f32 v144, v144
    s_nop 0
    v_add_f32 v144, 1.0, v144
    v_rcp_f32 v144, v144
    s_nop 0
    v_mul_f32 v144, v144, v48
    v_mul_f32 v144, v144, v56
    v_mul_f32 v145, v49, v49
    v_fma_f32 v145, v145, v6, 1.0
    v_mul_f32 v145, v145, v49
    v_mul_f32 v145, 0xc0135761, v145
    v_exp_f32 v145, v145
    s_nop 0
    v_add_f32 v145, 1.0, v145
    v_rcp_f32 v145, v145
    s_nop 0
    v_mul_f32 v145, v145, v49
    v_mul_f32 v145, v145, v57
    v_mul_f32 v146, v50, v50
    v_fma_f32 v146, v146, v6, 1.0
    v_mul_f32 v146, v146, v50
    v_mul_f32 v146, 0xc0135761, v146
    v_exp_f32 v146, v146
    s_nop 0
    v_add_f32 v146, 1.0, v146
    v_rcp_f32 v146, v146
    s_nop 0
    v_mul_f32 v146, v146, v50
    v_mul_f32 v146, v146, v58
    v_mul_f32 v147, v51, v51
    v_fma_f32 v147, v147, v6, 1.0
    v_mul_f32 v147, v147, v51
    v_mul_f32 v147, 0xc0135761, v147
    v_exp_f32 v147, v147
    s_nop 0
    v_add_f32 v147, 1.0, v147
    v_rcp_f32 v147, v147
    s_nop 0
    v_mul_f32 v147, v147, v51
    v_mul_f32 v147, v147, v59
    v_cvt_pk_bf16_f32 v148, v144, v145
    v_cvt_pk_bf16_f32 v149, v146, v147
    buffer_store_dwordx2 v[148:149], v5, s[52:55], 0 offen offset:0
    s_nop 1
    v_mul_f32 v144, v52, v52
    v_fma_f32 v144, v144, v6, 1.0
    v_mul_f32 v144, v144, v52
    v_mul_f32 v144, 0xc0135761, v144
    v_exp_f32 v144, v144
    s_nop 0
    v_add_f32 v144, 1.0, v144
    v_rcp_f32 v144, v144
    s_nop 0
    v_mul_f32 v144, v144, v52
    v_mul_f32 v144, v144, v60
    v_mul_f32 v145, v53, v53
    v_fma_f32 v145, v145, v6, 1.0
    v_mul_f32 v145, v145, v53
    v_mul_f32 v145, 0xc0135761, v145
    v_exp_f32 v145, v145
    s_nop 0
    v_add_f32 v145, 1.0, v145
    v_rcp_f32 v145, v145
    s_nop 0
    v_mul_f32 v145, v145, v53
    v_mul_f32 v145, v145, v61
    v_mul_f32 v146, v54, v54
    v_fma_f32 v146, v146, v6, 1.0
    v_mul_f32 v146, v146, v54
    v_mul_f32 v146, 0xc0135761, v146
    v_exp_f32 v146, v146
    s_nop 0
    v_add_f32 v146, 1.0, v146
    v_rcp_f32 v146, v146
    s_nop 0
    v_mul_f32 v146, v146, v54
    v_mul_f32 v146, v146, v62
    v_mul_f32 v147, v55, v55
    v_fma_f32 v147, v147, v6, 1.0
    v_mul_f32 v147, v147, v55
    v_mul_f32 v147, 0xc0135761, v147
    v_exp_f32 v147, v147
    s_nop 0
    v_add_f32 v147, 1.0, v147
    v_rcp_f32 v147, v147
    s_nop 0
    v_mul_f32 v147, v147, v55
    v_mul_f32 v147, v147, v63
    v_cvt_pk_bf16_f32 v148, v144, v145
    v_cvt_pk_bf16_f32 v149, v146, v147
    buffer_store_dwordx2 v[148:149], v5, s[52:55], 0 offen offset:32
    s_nop 1
    v_add_u32 v5, 55296, v5
    v_mul_f32 v144, v64, v64
    v_fma_f32 v144, v144, v6, 1.0
    v_mul_f32 v144, v144, v64
    v_mul_f32 v144, 0xc0135761, v144
    v_exp_f32 v144, v144
    s_nop 0
    v_add_f32 v144, 1.0, v144
    v_rcp_f32 v144, v144
    s_nop 0
    v_mul_f32 v144, v144, v64
    v_mul_f32 v144, v144, v72
    v_mul_f32 v145, v65, v65
    v_fma_f32 v145, v145, v6, 1.0
    v_mul_f32 v145, v145, v65
    v_mul_f32 v145, 0xc0135761, v145
    v_exp_f32 v145, v145
    s_nop 0
    v_add_f32 v145, 1.0, v145
    v_rcp_f32 v145, v145
    s_nop 0
    v_mul_f32 v145, v145, v65
    v_mul_f32 v145, v145, v73
    v_mul_f32 v146, v66, v66
    v_fma_f32 v146, v146, v6, 1.0
    v_mul_f32 v146, v146, v66
    v_mul_f32 v146, 0xc0135761, v146
    v_exp_f32 v146, v146
    s_nop 0
    v_add_f32 v146, 1.0, v146
    v_rcp_f32 v146, v146
    s_nop 0
    v_mul_f32 v146, v146, v66
    v_mul_f32 v146, v146, v74
    v_mul_f32 v147, v67, v67
    v_fma_f32 v147, v147, v6, 1.0
    v_mul_f32 v147, v147, v67
    v_mul_f32 v147, 0xc0135761, v147
    v_exp_f32 v147, v147
    s_nop 0
    v_add_f32 v147, 1.0, v147
    v_rcp_f32 v147, v147
    s_nop 0
    v_mul_f32 v147, v147, v67
    v_mul_f32 v147, v147, v75
    v_cvt_pk_bf16_f32 v148, v144, v145
    v_cvt_pk_bf16_f32 v149, v146, v147
    buffer_store_dwordx2 v[148:149], v5, s[52:55], 0 offen offset:0
    s_nop 1
    v_mul_f32 v144, v68, v68
    v_fma_f32 v144, v144, v6, 1.0
    v_mul_f32 v144, v144, v68
    v_mul_f32 v144, 0xc0135761, v144
    v_exp_f32 v144, v144
    s_nop 0
    v_add_f32 v144, 1.0, v144
    v_rcp_f32 v144, v144
    s_nop 0
    v_mul_f32 v144, v144, v68
    v_mul_f32 v144, v144, v76
    v_mul_f32 v145, v69, v69
    v_fma_f32 v145, v145, v6, 1.0
    v_mul_f32 v145, v145, v69
    v_mul_f32 v145, 0xc0135761, v145
    v_exp_f32 v145, v145
    s_nop 0
    v_add_f32 v145, 1.0, v145
    v_rcp_f32 v145, v145
    s_nop 0
    v_mul_f32 v145, v145, v69
    v_mul_f32 v145, v145, v77
    v_mul_f32 v146, v70, v70
    v_fma_f32 v146, v146, v6, 1.0
    v_mul_f32 v146, v146, v70
    v_mul_f32 v146, 0xc0135761, v146
    v_exp_f32 v146, v146
    s_nop 0
    v_add_f32 v146, 1.0, v146
    v_rcp_f32 v146, v146
    s_nop 0
    v_mul_f32 v146, v146, v70
    v_mul_f32 v146, v146, v78
    v_mul_f32 v147, v71, v71
    v_fma_f32 v147, v147, v6, 1.0
    v_mul_f32 v147, v147, v71
    v_mul_f32 v147, 0xc0135761, v147
    v_exp_f32 v147, v147
    s_nop 0
    v_add_f32 v147, 1.0, v147
    v_rcp_f32 v147, v147
    s_nop 0
    v_mul_f32 v147, v147, v71
    v_mul_f32 v147, v147, v79
    v_cvt_pk_bf16_f32 v148, v144, v145
    v_cvt_pk_bf16_f32 v149, v146, v147
    buffer_store_dwordx2 v[148:149], v5, s[52:55], 0 offen offset:32
    s_nop 1
gu_0_kernel_end:
    s_endpgm
.globl down_0_kernel
.p2align 8
.type down_0_kernel,@function
down_0_kernel:
    s_cmp_ge_u32 s2, 160
    s_cbranch_scc1 down_0_kernel_end
    s_load_dwordx16 s[16:31], s[0:1], 0
    s_load_dwordx4 s[32:35], s[0:1], 64
    s_load_dwordx2 s[36:37], s[0:1], 80
    s_waitcnt lgkmcnt(0)
    s_add_u32 s40, s36, 0x1800000
    s_addc_u32 s41, s37, 0
    s_mov_b32 s42, 0x6c0000
    s_mov_b32 s43, 0x00020000
    s_mov_b32 s44, s30
    s_mov_b32 s45, s31
    s_mov_b32 s46, 0x21c000
    s_mov_b32 s47, 0x00020000
    s_add_u32 s52, s36, 0x2000000
    s_addc_u32 s53, s37, 0
    s_mov_b32 s54, 0x280000
    s_mov_b32 s55, 0x00020000
    s_add_u32 s56, s36, 0x1400000
    s_addc_u32 s57, s37, 0
    s_mov_b32 s58, 0x280000
    s_mov_b32 s59, 0x00020000
    s_and_b32 s4, s2, 31
    s_lshr_b32 s5, s2, 5
    v_lshrrev_b32 v1, 6, v0
    s_nop 0
    v_readfirstlane_b32 s6, v1
    v_and_b32 v2, 63, v0
    v_and_b32 v3, 15, v0
    v_bfe_u32 v4, v0, 4, 2
    v_lshrrev_b32 v5, 3, v0
    v_and_b32 v6, 7, v0
    s_mul_i32 s7, s4, 221184
    v_mul_u32_u24 v7, 3456, v5
    v_lshl_add_u32 v7, v6, 4, v7
    v_add_u32 v7, s7, v7
    v_mul_u32_u24 v8, 144, v5
    v_lshl_add_u32 v8, v6, 4, v8
    v_and_b32 v9, 127, v0
    v_lshrrev_b32 v9, 3, v9
    s_lshr_b32 s8, s6, 1
    v_mul_u32_u24 v10, 1280, v9
    v_lshl_add_u32 v10, v6, 4, v10
    s_lshl_b32 s9, s5, 8
    s_lshl_b32 s10, s8, 7
    s_add_u32 s9, s9, s10
    s_mov_b32 s60, s44
    s_mov_b32 s61, s45
    s_mov_b32 s62, s46
    s_mov_b32 s63, s47
    v_add_u32 v10, s9, v10
    v_mul_u32_u24 v11, 288, v9
    v_lshl_add_u32 v11, v6, 4, v11
    s_lshl_b32 s10, s8, 7
    v_add_u32 v11, s10, v11
    v_add_u32 v11, 9216, v11
    s_mov_b32 s64, 0
    s_mov_b32 s65, 110592
    s_mov_b32 s68, 0
    s_mov_b32 s69, 20480
    s_mov_b32 s70, 40960
    s_mov_b32 s71, 61440
    s_lshr_b32 s10, s6, 1
    s_and_b32 s11, s6, 1
    s_mul_i32 s12, s10, 4608
    v_mul_u32_u24 v12, 144, v3
    v_lshl_add_u32 v12, v4, 3, v12
    v_add_u32 v12, s12, v12
    v_lshrrev_b32 v13, 2, v3
    v_lshl_add_u32 v13, v4, 2, v13
    v_mul_u32_u24 v13, 288, v13
    v_and_b32 v14, 3, v3
    v_lshl_add_u32 v13, v14, 3, v13
    s_lshl_b32 s13, s11, 7
    s_add_u32 s13, s13, 9216
    v_add_u32 v13, s13, v13
    v_mov_b32 v16, 0
    v_mov_b32 v17, 0
    v_mov_b32 v18, 0
    v_mov_b32 v19, 0
    v_mov_b32 v20, 0
    v_mov_b32 v21, 0
    v_mov_b32 v22, 0
    v_mov_b32 v23, 0
    v_mov_b32 v24, 0
    v_mov_b32 v25, 0
    v_mov_b32 v26, 0
    v_mov_b32 v27, 0
    v_mov_b32 v28, 0
    v_mov_b32 v29, 0
    v_mov_b32 v30, 0
    v_mov_b32 v31, 0
    v_mov_b32 v32, 0
    v_mov_b32 v33, 0
    v_mov_b32 v34, 0
    v_mov_b32 v35, 0
    v_mov_b32 v36, 0
    v_mov_b32 v37, 0
    v_mov_b32 v38, 0
    v_mov_b32 v39, 0
    v_mov_b32 v40, 0
    v_mov_b32 v41, 0
    v_mov_b32 v42, 0
    v_mov_b32 v43, 0
    v_mov_b32 v44, 0
    v_mov_b32 v45, 0
    v_mov_b32 v46, 0
    v_mov_b32 v47, 0
    buffer_load_dwordx4 v[96:99], v7, s[40:43], s64 offen
    buffer_load_dwordx4 v[100:103], v7, s[40:43], s65 offen
    buffer_load_dwordx4 v[104:107], v10, s[60:63], s68 offen
    buffer_load_dwordx4 v[108:111], v10, s[60:63], s69 offen
    buffer_load_dwordx4 v[112:115], v10, s[60:63], s70 offen
    buffer_load_dwordx4 v[116:119], v10, s[60:63], s71 offen
    v_add_u32 v7, 128, v7
    v_add_u32 v10, 81920, v10
    buffer_load_dwordx4 v[120:123], v7, s[40:43], s64 offen
    buffer_load_dwordx4 v[124:127], v7, s[40:43], s65 offen
    buffer_load_dwordx4 v[128:131], v10, s[60:63], s68 offen
    buffer_load_dwordx4 v[132:135], v10, s[60:63], s69 offen
    buffer_load_dwordx4 v[136:139], v10, s[60:63], s70 offen
    buffer_load_dwordx4 v[140:143], v10, s[60:63], s71 offen
    v_add_u32 v7, 128, v7
    v_add_u32 v10, 81920, v10
    s_waitcnt vmcnt(6)
    ds_write_b128 v8, v[96:99] offset:0
    ds_write_b128 v8, v[100:103] offset:4608
    ds_write_b128 v11, v[104:107] offset:0
    ds_write_b128 v11, v[108:111] offset:4608
    ds_write_b128 v11, v[112:115] offset:9216
    ds_write_b128 v11, v[116:119] offset:13824
    s_waitcnt lgkmcnt(0)
    s_barrier
    buffer_load_dwordx4 v[96:99], v7, s[40:43], s64 offen
    buffer_load_dwordx4 v[100:103], v7, s[40:43], s65 offen
    buffer_load_dwordx4 v[104:107], v10, s[60:63], s68 offen
    buffer_load_dwordx4 v[108:111], v10, s[60:63], s69 offen
    buffer_load_dwordx4 v[112:115], v10, s[60:63], s70 offen
    buffer_load_dwordx4 v[116:119], v10, s[60:63], s71 offen
    v_add_u32 v7, 128, v7
    v_add_u32 v10, 81920, v10
    ds_read_b64_tr_b16 v[56:57], v13 offset:0
    ds_read_b64_tr_b16 v[58:59], v13 offset:4608
    ds_read_b64_tr_b16 v[60:61], v13 offset:32
    ds_read_b64_tr_b16 v[62:63], v13 offset:4640
    ds_read_b64_tr_b16 v[64:65], v13 offset:64
    ds_read_b64_tr_b16 v[66:67], v13 offset:4672
    ds_read_b64_tr_b16 v[68:69], v13 offset:96
    ds_read_b64_tr_b16 v[70:71], v13 offset:4704
    ds_read_b64 v[48:49], v12 offset:0
    ds_read_b64 v[50:51], v12 offset:32
    ds_read_b64 v[52:53], v12 offset:2304
    ds_read_b64 v[54:55], v12 offset:2336
    s_waitcnt lgkmcnt(0)
    ds_read_b64_tr_b16 v[80:81], v13 offset:9216
    ds_read_b64_tr_b16 v[82:83], v13 offset:13824
    ds_read_b64_tr_b16 v[84:85], v13 offset:9248
    ds_read_b64_tr_b16 v[86:87], v13 offset:13856
    ds_read_b64_tr_b16 v[88:89], v13 offset:9280
    ds_read_b64_tr_b16 v[90:91], v13 offset:13888
    ds_read_b64_tr_b16 v[92:93], v13 offset:9312
    ds_read_b64_tr_b16 v[94:95], v13 offset:13920
    ds_read_b64 v[72:73], v12 offset:64
    ds_read_b64 v[74:75], v12 offset:96
    ds_read_b64 v[76:77], v12 offset:2368
    ds_read_b64 v[78:79], v12 offset:2400
    v_mfma_f32_16x16x32_bf16 v[16:19], v[56:59], v[48:51], v[16:19]
    v_mfma_f32_16x16x32_bf16 v[20:23], v[60:63], v[48:51], v[20:23]
    v_mfma_f32_16x16x32_bf16 v[24:27], v[64:67], v[48:51], v[24:27]
    v_mfma_f32_16x16x32_bf16 v[28:31], v[68:71], v[48:51], v[28:31]
    v_mfma_f32_16x16x32_bf16 v[32:35], v[56:59], v[52:55], v[32:35]
    v_mfma_f32_16x16x32_bf16 v[36:39], v[60:63], v[52:55], v[36:39]
    v_mfma_f32_16x16x32_bf16 v[40:43], v[64:67], v[52:55], v[40:43]
    v_mfma_f32_16x16x32_bf16 v[44:47], v[68:71], v[52:55], v[44:47]
    s_waitcnt lgkmcnt(0)
    v_mfma_f32_16x16x32_bf16 v[16:19], v[80:83], v[72:75], v[16:19]
    v_mfma_f32_16x16x32_bf16 v[20:23], v[84:87], v[72:75], v[20:23]
    v_mfma_f32_16x16x32_bf16 v[24:27], v[88:91], v[72:75], v[24:27]
    v_mfma_f32_16x16x32_bf16 v[28:31], v[92:95], v[72:75], v[28:31]
    v_mfma_f32_16x16x32_bf16 v[32:35], v[80:83], v[76:79], v[32:35]
    v_mfma_f32_16x16x32_bf16 v[36:39], v[84:87], v[76:79], v[36:39]
    v_mfma_f32_16x16x32_bf16 v[40:43], v[88:91], v[76:79], v[40:43]
    v_mfma_f32_16x16x32_bf16 v[44:47], v[92:95], v[76:79], v[44:47]
    s_waitcnt vmcnt(6)
    ds_write_b128 v8, v[120:123] offset:27648
    ds_write_b128 v8, v[124:127] offset:32256
    ds_write_b128 v11, v[128:131] offset:27648
    ds_write_b128 v11, v[132:135] offset:32256
    ds_write_b128 v11, v[136:139] offset:36864
    ds_write_b128 v11, v[140:143] offset:41472
    s_waitcnt lgkmcnt(0)
    s_barrier
    buffer_load_dwordx4 v[120:123], v7, s[40:43], s64 offen
    buffer_load_dwordx4 v[124:127], v7, s[40:43], s65 offen
    buffer_load_dwordx4 v[128:131], v10, s[60:63], s68 offen
    buffer_load_dwordx4 v[132:135], v10, s[60:63], s69 offen
    buffer_load_dwordx4 v[136:139], v10, s[60:63], s70 offen
    buffer_load_dwordx4 v[140:143], v10, s[60:63], s71 offen
    v_add_u32 v7, 128, v7
    v_add_u32 v10, 81920, v10
    ds_read_b64_tr_b16 v[56:57], v13 offset:27648
    ds_read_b64_tr_b16 v[58:59], v13 offset:32256
    ds_read_b64_tr_b16 v[60:61], v13 offset:27680
    ds_read_b64_tr_b16 v[62:63], v13 offset:32288
    ds_read_b64_tr_b16 v[64:65], v13 offset:27712
    ds_read_b64_tr_b16 v[66:67], v13 offset:32320
    ds_read_b64_tr_b16 v[68:69], v13 offset:27744
    ds_read_b64_tr_b16 v[70:71], v13 offset:32352
    ds_read_b64 v[48:49], v12 offset:27648
    ds_read_b64 v[50:51], v12 offset:27680
    ds_read_b64 v[52:53], v12 offset:29952
    ds_read_b64 v[54:55], v12 offset:29984
    s_waitcnt lgkmcnt(0)
    ds_read_b64_tr_b16 v[80:81], v13 offset:36864
    ds_read_b64_tr_b16 v[82:83], v13 offset:41472
    ds_read_b64_tr_b16 v[84:85], v13 offset:36896
    ds_read_b64_tr_b16 v[86:87], v13 offset:41504
    ds_read_b64_tr_b16 v[88:89], v13 offset:36928
    ds_read_b64_tr_b16 v[90:91], v13 offset:41536
    ds_read_b64_tr_b16 v[92:93], v13 offset:36960
    ds_read_b64_tr_b16 v[94:95], v13 offset:41568
    ds_read_b64 v[72:73], v12 offset:27712
    ds_read_b64 v[74:75], v12 offset:27744
    ds_read_b64 v[76:77], v12 offset:30016
    ds_read_b64 v[78:79], v12 offset:30048
    v_mfma_f32_16x16x32_bf16 v[16:19], v[56:59], v[48:51], v[16:19]
    v_mfma_f32_16x16x32_bf16 v[20:23], v[60:63], v[48:51], v[20:23]
    v_mfma_f32_16x16x32_bf16 v[24:27], v[64:67], v[48:51], v[24:27]
    v_mfma_f32_16x16x32_bf16 v[28:31], v[68:71], v[48:51], v[28:31]
    v_mfma_f32_16x16x32_bf16 v[32:35], v[56:59], v[52:55], v[32:35]
    v_mfma_f32_16x16x32_bf16 v[36:39], v[60:63], v[52:55], v[36:39]
    v_mfma_f32_16x16x32_bf16 v[40:43], v[64:67], v[52:55], v[40:43]
    v_mfma_f32_16x16x32_bf16 v[44:47], v[68:71], v[52:55], v[44:47]
    s_waitcnt lgkmcnt(0)
    v_mfma_f32_16x16x32_bf16 v[16:19], v[80:83], v[72:75], v[16:19]
    v_mfma_f32_16x16x32_bf16 v[20:23], v[84:87], v[72:75], v[20:23]
    v_mfma_f32_16x16x32_bf16 v[24:27], v[88:91], v[72:75], v[24:27]
    v_mfma_f32_16x16x32_bf16 v[28:31], v[92:95], v[72:75], v[28:31]
    v_mfma_f32_16x16x32_bf16 v[32:35], v[80:83], v[76:79], v[32:35]
    v_mfma_f32_16x16x32_bf16 v[36:39], v[84:87], v[76:79], v[36:39]
    v_mfma_f32_16x16x32_bf16 v[40:43], v[88:91], v[76:79], v[40:43]
    v_mfma_f32_16x16x32_bf16 v[44:47], v[92:95], v[76:79], v[44:47]
    s_waitcnt vmcnt(6)
    ds_write_b128 v8, v[96:99] offset:0
    ds_write_b128 v8, v[100:103] offset:4608
    ds_write_b128 v11, v[104:107] offset:0
    ds_write_b128 v11, v[108:111] offset:4608
    ds_write_b128 v11, v[112:115] offset:9216
    ds_write_b128 v11, v[116:119] offset:13824
    s_waitcnt lgkmcnt(0)
    s_barrier
    buffer_load_dwordx4 v[96:99], v7, s[40:43], s64 offen
    buffer_load_dwordx4 v[100:103], v7, s[40:43], s65 offen
    buffer_load_dwordx4 v[104:107], v10, s[60:63], s68 offen
    buffer_load_dwordx4 v[108:111], v10, s[60:63], s69 offen
    buffer_load_dwordx4 v[112:115], v10, s[60:63], s70 offen
    buffer_load_dwordx4 v[116:119], v10, s[60:63], s71 offen
    v_add_u32 v7, 128, v7
    v_add_u32 v10, 81920, v10
    ds_read_b64_tr_b16 v[56:57], v13 offset:0
    ds_read_b64_tr_b16 v[58:59], v13 offset:4608
    ds_read_b64_tr_b16 v[60:61], v13 offset:32
    ds_read_b64_tr_b16 v[62:63], v13 offset:4640
    ds_read_b64_tr_b16 v[64:65], v13 offset:64
    ds_read_b64_tr_b16 v[66:67], v13 offset:4672
    ds_read_b64_tr_b16 v[68:69], v13 offset:96
    ds_read_b64_tr_b16 v[70:71], v13 offset:4704
    ds_read_b64 v[48:49], v12 offset:0
    ds_read_b64 v[50:51], v12 offset:32
    ds_read_b64 v[52:53], v12 offset:2304
    ds_read_b64 v[54:55], v12 offset:2336
    s_waitcnt lgkmcnt(0)
    ds_read_b64_tr_b16 v[80:81], v13 offset:9216
    ds_read_b64_tr_b16 v[82:83], v13 offset:13824
    ds_read_b64_tr_b16 v[84:85], v13 offset:9248
    ds_read_b64_tr_b16 v[86:87], v13 offset:13856
    ds_read_b64_tr_b16 v[88:89], v13 offset:9280
    ds_read_b64_tr_b16 v[90:91], v13 offset:13888
    ds_read_b64_tr_b16 v[92:93], v13 offset:9312
    ds_read_b64_tr_b16 v[94:95], v13 offset:13920
    ds_read_b64 v[72:73], v12 offset:64
    ds_read_b64 v[74:75], v12 offset:96
    ds_read_b64 v[76:77], v12 offset:2368
    ds_read_b64 v[78:79], v12 offset:2400
    v_mfma_f32_16x16x32_bf16 v[16:19], v[56:59], v[48:51], v[16:19]
    v_mfma_f32_16x16x32_bf16 v[20:23], v[60:63], v[48:51], v[20:23]
    v_mfma_f32_16x16x32_bf16 v[24:27], v[64:67], v[48:51], v[24:27]
    v_mfma_f32_16x16x32_bf16 v[28:31], v[68:71], v[48:51], v[28:31]
    v_mfma_f32_16x16x32_bf16 v[32:35], v[56:59], v[52:55], v[32:35]
    v_mfma_f32_16x16x32_bf16 v[36:39], v[60:63], v[52:55], v[36:39]
    v_mfma_f32_16x16x32_bf16 v[40:43], v[64:67], v[52:55], v[40:43]
    v_mfma_f32_16x16x32_bf16 v[44:47], v[68:71], v[52:55], v[44:47]
    s_waitcnt lgkmcnt(0)
    v_mfma_f32_16x16x32_bf16 v[16:19], v[80:83], v[72:75], v[16:19]
    v_mfma_f32_16x16x32_bf16 v[20:23], v[84:87], v[72:75], v[20:23]
    v_mfma_f32_16x16x32_bf16 v[24:27], v[88:91], v[72:75], v[24:27]
    v_mfma_f32_16x16x32_bf16 v[28:31], v[92:95], v[72:75], v[28:31]
    v_mfma_f32_16x16x32_bf16 v[32:35], v[80:83], v[76:79], v[32:35]
    v_mfma_f32_16x16x32_bf16 v[36:39], v[84:87], v[76:79], v[36:39]
    v_mfma_f32_16x16x32_bf16 v[40:43], v[88:91], v[76:79], v[40:43]
    v_mfma_f32_16x16x32_bf16 v[44:47], v[92:95], v[76:79], v[44:47]
    s_waitcnt vmcnt(6)
    ds_write_b128 v8, v[120:123] offset:27648
    ds_write_b128 v8, v[124:127] offset:32256
    ds_write_b128 v11, v[128:131] offset:27648
    ds_write_b128 v11, v[132:135] offset:32256
    ds_write_b128 v11, v[136:139] offset:36864
    ds_write_b128 v11, v[140:143] offset:41472
    s_waitcnt lgkmcnt(0)
    s_barrier
    buffer_load_dwordx4 v[120:123], v7, s[40:43], s64 offen
    buffer_load_dwordx4 v[124:127], v7, s[40:43], s65 offen
    buffer_load_dwordx4 v[128:131], v10, s[60:63], s68 offen
    buffer_load_dwordx4 v[132:135], v10, s[60:63], s69 offen
    buffer_load_dwordx4 v[136:139], v10, s[60:63], s70 offen
    buffer_load_dwordx4 v[140:143], v10, s[60:63], s71 offen
    v_add_u32 v7, 128, v7
    v_add_u32 v10, 81920, v10
    ds_read_b64_tr_b16 v[56:57], v13 offset:27648
    ds_read_b64_tr_b16 v[58:59], v13 offset:32256
    ds_read_b64_tr_b16 v[60:61], v13 offset:27680
    ds_read_b64_tr_b16 v[62:63], v13 offset:32288
    ds_read_b64_tr_b16 v[64:65], v13 offset:27712
    ds_read_b64_tr_b16 v[66:67], v13 offset:32320
    ds_read_b64_tr_b16 v[68:69], v13 offset:27744
    ds_read_b64_tr_b16 v[70:71], v13 offset:32352
    ds_read_b64 v[48:49], v12 offset:27648
    ds_read_b64 v[50:51], v12 offset:27680
    ds_read_b64 v[52:53], v12 offset:29952
    ds_read_b64 v[54:55], v12 offset:29984
    s_waitcnt lgkmcnt(0)
    ds_read_b64_tr_b16 v[80:81], v13 offset:36864
    ds_read_b64_tr_b16 v[82:83], v13 offset:41472
    ds_read_b64_tr_b16 v[84:85], v13 offset:36896
    ds_read_b64_tr_b16 v[86:87], v13 offset:41504
    ds_read_b64_tr_b16 v[88:89], v13 offset:36928
    ds_read_b64_tr_b16 v[90:91], v13 offset:41536
    ds_read_b64_tr_b16 v[92:93], v13 offset:36960
    ds_read_b64_tr_b16 v[94:95], v13 offset:41568
    ds_read_b64 v[72:73], v12 offset:27712
    ds_read_b64 v[74:75], v12 offset:27744
    ds_read_b64 v[76:77], v12 offset:30016
    ds_read_b64 v[78:79], v12 offset:30048
    v_mfma_f32_16x16x32_bf16 v[16:19], v[56:59], v[48:51], v[16:19]
    v_mfma_f32_16x16x32_bf16 v[20:23], v[60:63], v[48:51], v[20:23]
    v_mfma_f32_16x16x32_bf16 v[24:27], v[64:67], v[48:51], v[24:27]
    v_mfma_f32_16x16x32_bf16 v[28:31], v[68:71], v[48:51], v[28:31]
    v_mfma_f32_16x16x32_bf16 v[32:35], v[56:59], v[52:55], v[32:35]
    v_mfma_f32_16x16x32_bf16 v[36:39], v[60:63], v[52:55], v[36:39]
    v_mfma_f32_16x16x32_bf16 v[40:43], v[64:67], v[52:55], v[40:43]
    v_mfma_f32_16x16x32_bf16 v[44:47], v[68:71], v[52:55], v[44:47]
    s_waitcnt lgkmcnt(0)
    v_mfma_f32_16x16x32_bf16 v[16:19], v[80:83], v[72:75], v[16:19]
    v_mfma_f32_16x16x32_bf16 v[20:23], v[84:87], v[72:75], v[20:23]
    v_mfma_f32_16x16x32_bf16 v[24:27], v[88:91], v[72:75], v[24:27]
    v_mfma_f32_16x16x32_bf16 v[28:31], v[92:95], v[72:75], v[28:31]
    v_mfma_f32_16x16x32_bf16 v[32:35], v[80:83], v[76:79], v[32:35]
    v_mfma_f32_16x16x32_bf16 v[36:39], v[84:87], v[76:79], v[36:39]
    v_mfma_f32_16x16x32_bf16 v[40:43], v[88:91], v[76:79], v[40:43]
    v_mfma_f32_16x16x32_bf16 v[44:47], v[92:95], v[76:79], v[44:47]
    s_waitcnt vmcnt(6)
    ds_write_b128 v8, v[96:99] offset:0
    ds_write_b128 v8, v[100:103] offset:4608
    ds_write_b128 v11, v[104:107] offset:0
    ds_write_b128 v11, v[108:111] offset:4608
    ds_write_b128 v11, v[112:115] offset:9216
    ds_write_b128 v11, v[116:119] offset:13824
    s_waitcnt lgkmcnt(0)
    s_barrier
    buffer_load_dwordx4 v[96:99], v7, s[40:43], s64 offen
    buffer_load_dwordx4 v[100:103], v7, s[40:43], s65 offen
    buffer_load_dwordx4 v[104:107], v10, s[60:63], s68 offen
    buffer_load_dwordx4 v[108:111], v10, s[60:63], s69 offen
    buffer_load_dwordx4 v[112:115], v10, s[60:63], s70 offen
    buffer_load_dwordx4 v[116:119], v10, s[60:63], s71 offen
    v_add_u32 v7, 128, v7
    v_add_u32 v10, 81920, v10
    ds_read_b64_tr_b16 v[56:57], v13 offset:0
    ds_read_b64_tr_b16 v[58:59], v13 offset:4608
    ds_read_b64_tr_b16 v[60:61], v13 offset:32
    ds_read_b64_tr_b16 v[62:63], v13 offset:4640
    ds_read_b64_tr_b16 v[64:65], v13 offset:64
    ds_read_b64_tr_b16 v[66:67], v13 offset:4672
    ds_read_b64_tr_b16 v[68:69], v13 offset:96
    ds_read_b64_tr_b16 v[70:71], v13 offset:4704
    ds_read_b64 v[48:49], v12 offset:0
    ds_read_b64 v[50:51], v12 offset:32
    ds_read_b64 v[52:53], v12 offset:2304
    ds_read_b64 v[54:55], v12 offset:2336
    s_waitcnt lgkmcnt(0)
    ds_read_b64_tr_b16 v[80:81], v13 offset:9216
    ds_read_b64_tr_b16 v[82:83], v13 offset:13824
    ds_read_b64_tr_b16 v[84:85], v13 offset:9248
    ds_read_b64_tr_b16 v[86:87], v13 offset:13856
    ds_read_b64_tr_b16 v[88:89], v13 offset:9280
    ds_read_b64_tr_b16 v[90:91], v13 offset:13888
    ds_read_b64_tr_b16 v[92:93], v13 offset:9312
    ds_read_b64_tr_b16 v[94:95], v13 offset:13920
    ds_read_b64 v[72:73], v12 offset:64
    ds_read_b64 v[74:75], v12 offset:96
    ds_read_b64 v[76:77], v12 offset:2368
    ds_read_b64 v[78:79], v12 offset:2400
    v_mfma_f32_16x16x32_bf16 v[16:19], v[56:59], v[48:51], v[16:19]
    v_mfma_f32_16x16x32_bf16 v[20:23], v[60:63], v[48:51], v[20:23]
    v_mfma_f32_16x16x32_bf16 v[24:27], v[64:67], v[48:51], v[24:27]
    v_mfma_f32_16x16x32_bf16 v[28:31], v[68:71], v[48:51], v[28:31]
    v_mfma_f32_16x16x32_bf16 v[32:35], v[56:59], v[52:55], v[32:35]
    v_mfma_f32_16x16x32_bf16 v[36:39], v[60:63], v[52:55], v[36:39]
    v_mfma_f32_16x16x32_bf16 v[40:43], v[64:67], v[52:55], v[40:43]
    v_mfma_f32_16x16x32_bf16 v[44:47], v[68:71], v[52:55], v[44:47]
    s_waitcnt lgkmcnt(0)
    v_mfma_f32_16x16x32_bf16 v[16:19], v[80:83], v[72:75], v[16:19]
    v_mfma_f32_16x16x32_bf16 v[20:23], v[84:87], v[72:75], v[20:23]
    v_mfma_f32_16x16x32_bf16 v[24:27], v[88:91], v[72:75], v[24:27]
    v_mfma_f32_16x16x32_bf16 v[28:31], v[92:95], v[72:75], v[28:31]
    v_mfma_f32_16x16x32_bf16 v[32:35], v[80:83], v[76:79], v[32:35]
    v_mfma_f32_16x16x32_bf16 v[36:39], v[84:87], v[76:79], v[36:39]
    v_mfma_f32_16x16x32_bf16 v[40:43], v[88:91], v[76:79], v[40:43]
    v_mfma_f32_16x16x32_bf16 v[44:47], v[92:95], v[76:79], v[44:47]
    s_waitcnt vmcnt(6)
    ds_write_b128 v8, v[120:123] offset:27648
    ds_write_b128 v8, v[124:127] offset:32256
    ds_write_b128 v11, v[128:131] offset:27648
    ds_write_b128 v11, v[132:135] offset:32256
    ds_write_b128 v11, v[136:139] offset:36864
    ds_write_b128 v11, v[140:143] offset:41472
    s_waitcnt lgkmcnt(0)
    s_barrier
    buffer_load_dwordx4 v[120:123], v7, s[40:43], s64 offen
    buffer_load_dwordx4 v[124:127], v7, s[40:43], s65 offen
    buffer_load_dwordx4 v[128:131], v10, s[60:63], s68 offen
    buffer_load_dwordx4 v[132:135], v10, s[60:63], s69 offen
    buffer_load_dwordx4 v[136:139], v10, s[60:63], s70 offen
    buffer_load_dwordx4 v[140:143], v10, s[60:63], s71 offen
    v_add_u32 v7, 128, v7
    v_add_u32 v10, 81920, v10
    ds_read_b64_tr_b16 v[56:57], v13 offset:27648
    ds_read_b64_tr_b16 v[58:59], v13 offset:32256
    ds_read_b64_tr_b16 v[60:61], v13 offset:27680
    ds_read_b64_tr_b16 v[62:63], v13 offset:32288
    ds_read_b64_tr_b16 v[64:65], v13 offset:27712
    ds_read_b64_tr_b16 v[66:67], v13 offset:32320
    ds_read_b64_tr_b16 v[68:69], v13 offset:27744
    ds_read_b64_tr_b16 v[70:71], v13 offset:32352
    ds_read_b64 v[48:49], v12 offset:27648
    ds_read_b64 v[50:51], v12 offset:27680
    ds_read_b64 v[52:53], v12 offset:29952
    ds_read_b64 v[54:55], v12 offset:29984
    s_waitcnt lgkmcnt(0)
    ds_read_b64_tr_b16 v[80:81], v13 offset:36864
    ds_read_b64_tr_b16 v[82:83], v13 offset:41472
    ds_read_b64_tr_b16 v[84:85], v13 offset:36896
    ds_read_b64_tr_b16 v[86:87], v13 offset:41504
    ds_read_b64_tr_b16 v[88:89], v13 offset:36928
    ds_read_b64_tr_b16 v[90:91], v13 offset:41536
    ds_read_b64_tr_b16 v[92:93], v13 offset:36960
    ds_read_b64_tr_b16 v[94:95], v13 offset:41568
    ds_read_b64 v[72:73], v12 offset:27712
    ds_read_b64 v[74:75], v12 offset:27744
    ds_read_b64 v[76:77], v12 offset:30016
    ds_read_b64 v[78:79], v12 offset:30048
    v_mfma_f32_16x16x32_bf16 v[16:19], v[56:59], v[48:51], v[16:19]
    v_mfma_f32_16x16x32_bf16 v[20:23], v[60:63], v[48:51], v[20:23]
    v_mfma_f32_16x16x32_bf16 v[24:27], v[64:67], v[48:51], v[24:27]
    v_mfma_f32_16x16x32_bf16 v[28:31], v[68:71], v[48:51], v[28:31]
    v_mfma_f32_16x16x32_bf16 v[32:35], v[56:59], v[52:55], v[32:35]
    v_mfma_f32_16x16x32_bf16 v[36:39], v[60:63], v[52:55], v[36:39]
    v_mfma_f32_16x16x32_bf16 v[40:43], v[64:67], v[52:55], v[40:43]
    v_mfma_f32_16x16x32_bf16 v[44:47], v[68:71], v[52:55], v[44:47]
    s_waitcnt lgkmcnt(0)
    v_mfma_f32_16x16x32_bf16 v[16:19], v[80:83], v[72:75], v[16:19]
    v_mfma_f32_16x16x32_bf16 v[20:23], v[84:87], v[72:75], v[20:23]
    v_mfma_f32_16x16x32_bf16 v[24:27], v[88:91], v[72:75], v[24:27]
    v_mfma_f32_16x16x32_bf16 v[28:31], v[92:95], v[72:75], v[28:31]
    v_mfma_f32_16x16x32_bf16 v[32:35], v[80:83], v[76:79], v[32:35]
    v_mfma_f32_16x16x32_bf16 v[36:39], v[84:87], v[76:79], v[36:39]
    v_mfma_f32_16x16x32_bf16 v[40:43], v[88:91], v[76:79], v[40:43]
    v_mfma_f32_16x16x32_bf16 v[44:47], v[92:95], v[76:79], v[44:47]
    s_waitcnt vmcnt(6)
    ds_write_b128 v8, v[96:99] offset:0
    ds_write_b128 v8, v[100:103] offset:4608
    ds_write_b128 v11, v[104:107] offset:0
    ds_write_b128 v11, v[108:111] offset:4608
    ds_write_b128 v11, v[112:115] offset:9216
    ds_write_b128 v11, v[116:119] offset:13824
    s_waitcnt lgkmcnt(0)
    s_barrier
    buffer_load_dwordx4 v[96:99], v7, s[40:43], s64 offen
    buffer_load_dwordx4 v[100:103], v7, s[40:43], s65 offen
    buffer_load_dwordx4 v[104:107], v10, s[60:63], s68 offen
    buffer_load_dwordx4 v[108:111], v10, s[60:63], s69 offen
    buffer_load_dwordx4 v[112:115], v10, s[60:63], s70 offen
    buffer_load_dwordx4 v[116:119], v10, s[60:63], s71 offen
    v_add_u32 v7, 128, v7
    v_add_u32 v10, 81920, v10
    ds_read_b64_tr_b16 v[56:57], v13 offset:0
    ds_read_b64_tr_b16 v[58:59], v13 offset:4608
    ds_read_b64_tr_b16 v[60:61], v13 offset:32
    ds_read_b64_tr_b16 v[62:63], v13 offset:4640
    ds_read_b64_tr_b16 v[64:65], v13 offset:64
    ds_read_b64_tr_b16 v[66:67], v13 offset:4672
    ds_read_b64_tr_b16 v[68:69], v13 offset:96
    ds_read_b64_tr_b16 v[70:71], v13 offset:4704
    ds_read_b64 v[48:49], v12 offset:0
    ds_read_b64 v[50:51], v12 offset:32
    ds_read_b64 v[52:53], v12 offset:2304
    ds_read_b64 v[54:55], v12 offset:2336
    s_waitcnt lgkmcnt(0)
    ds_read_b64_tr_b16 v[80:81], v13 offset:9216
    ds_read_b64_tr_b16 v[82:83], v13 offset:13824
    ds_read_b64_tr_b16 v[84:85], v13 offset:9248
    ds_read_b64_tr_b16 v[86:87], v13 offset:13856
    ds_read_b64_tr_b16 v[88:89], v13 offset:9280
    ds_read_b64_tr_b16 v[90:91], v13 offset:13888
    ds_read_b64_tr_b16 v[92:93], v13 offset:9312
    ds_read_b64_tr_b16 v[94:95], v13 offset:13920
    ds_read_b64 v[72:73], v12 offset:64
    ds_read_b64 v[74:75], v12 offset:96
    ds_read_b64 v[76:77], v12 offset:2368
    ds_read_b64 v[78:79], v12 offset:2400
    v_mfma_f32_16x16x32_bf16 v[16:19], v[56:59], v[48:51], v[16:19]
    v_mfma_f32_16x16x32_bf16 v[20:23], v[60:63], v[48:51], v[20:23]
    v_mfma_f32_16x16x32_bf16 v[24:27], v[64:67], v[48:51], v[24:27]
    v_mfma_f32_16x16x32_bf16 v[28:31], v[68:71], v[48:51], v[28:31]
    v_mfma_f32_16x16x32_bf16 v[32:35], v[56:59], v[52:55], v[32:35]
    v_mfma_f32_16x16x32_bf16 v[36:39], v[60:63], v[52:55], v[36:39]
    v_mfma_f32_16x16x32_bf16 v[40:43], v[64:67], v[52:55], v[40:43]
    v_mfma_f32_16x16x32_bf16 v[44:47], v[68:71], v[52:55], v[44:47]
    s_waitcnt lgkmcnt(0)
    v_mfma_f32_16x16x32_bf16 v[16:19], v[80:83], v[72:75], v[16:19]
    v_mfma_f32_16x16x32_bf16 v[20:23], v[84:87], v[72:75], v[20:23]
    v_mfma_f32_16x16x32_bf16 v[24:27], v[88:91], v[72:75], v[24:27]
    v_mfma_f32_16x16x32_bf16 v[28:31], v[92:95], v[72:75], v[28:31]
    v_mfma_f32_16x16x32_bf16 v[32:35], v[80:83], v[76:79], v[32:35]
    v_mfma_f32_16x16x32_bf16 v[36:39], v[84:87], v[76:79], v[36:39]
    v_mfma_f32_16x16x32_bf16 v[40:43], v[88:91], v[76:79], v[40:43]
    v_mfma_f32_16x16x32_bf16 v[44:47], v[92:95], v[76:79], v[44:47]
    s_waitcnt vmcnt(6)
    ds_write_b128 v8, v[120:123] offset:27648
    ds_write_b128 v8, v[124:127] offset:32256
    ds_write_b128 v11, v[128:131] offset:27648
    ds_write_b128 v11, v[132:135] offset:32256
    ds_write_b128 v11, v[136:139] offset:36864
    ds_write_b128 v11, v[140:143] offset:41472
    s_waitcnt lgkmcnt(0)
    s_barrier
    buffer_load_dwordx4 v[120:123], v7, s[40:43], s64 offen
    buffer_load_dwordx4 v[124:127], v7, s[40:43], s65 offen
    buffer_load_dwordx4 v[128:131], v10, s[60:63], s68 offen
    buffer_load_dwordx4 v[132:135], v10, s[60:63], s69 offen
    buffer_load_dwordx4 v[136:139], v10, s[60:63], s70 offen
    buffer_load_dwordx4 v[140:143], v10, s[60:63], s71 offen
    v_add_u32 v7, 128, v7
    v_add_u32 v10, 81920, v10
    ds_read_b64_tr_b16 v[56:57], v13 offset:27648
    ds_read_b64_tr_b16 v[58:59], v13 offset:32256
    ds_read_b64_tr_b16 v[60:61], v13 offset:27680
    ds_read_b64_tr_b16 v[62:63], v13 offset:32288
    ds_read_b64_tr_b16 v[64:65], v13 offset:27712
    ds_read_b64_tr_b16 v[66:67], v13 offset:32320
    ds_read_b64_tr_b16 v[68:69], v13 offset:27744
    ds_read_b64_tr_b16 v[70:71], v13 offset:32352
    ds_read_b64 v[48:49], v12 offset:27648
    ds_read_b64 v[50:51], v12 offset:27680
    ds_read_b64 v[52:53], v12 offset:29952
    ds_read_b64 v[54:55], v12 offset:29984
    s_waitcnt lgkmcnt(0)
    ds_read_b64_tr_b16 v[80:81], v13 offset:36864
    ds_read_b64_tr_b16 v[82:83], v13 offset:41472
    ds_read_b64_tr_b16 v[84:85], v13 offset:36896
    ds_read_b64_tr_b16 v[86:87], v13 offset:41504
    ds_read_b64_tr_b16 v[88:89], v13 offset:36928
    ds_read_b64_tr_b16 v[90:91], v13 offset:41536
    ds_read_b64_tr_b16 v[92:93], v13 offset:36960
    ds_read_b64_tr_b16 v[94:95], v13 offset:41568
    ds_read_b64 v[72:73], v12 offset:27712
    ds_read_b64 v[74:75], v12 offset:27744
    ds_read_b64 v[76:77], v12 offset:30016
    ds_read_b64 v[78:79], v12 offset:30048
    v_mfma_f32_16x16x32_bf16 v[16:19], v[56:59], v[48:51], v[16:19]
    v_mfma_f32_16x16x32_bf16 v[20:23], v[60:63], v[48:51], v[20:23]
    v_mfma_f32_16x16x32_bf16 v[24:27], v[64:67], v[48:51], v[24:27]
    v_mfma_f32_16x16x32_bf16 v[28:31], v[68:71], v[48:51], v[28:31]
    v_mfma_f32_16x16x32_bf16 v[32:35], v[56:59], v[52:55], v[32:35]
    v_mfma_f32_16x16x32_bf16 v[36:39], v[60:63], v[52:55], v[36:39]
    v_mfma_f32_16x16x32_bf16 v[40:43], v[64:67], v[52:55], v[40:43]
    v_mfma_f32_16x16x32_bf16 v[44:47], v[68:71], v[52:55], v[44:47]
    s_waitcnt lgkmcnt(0)
    v_mfma_f32_16x16x32_bf16 v[16:19], v[80:83], v[72:75], v[16:19]
    v_mfma_f32_16x16x32_bf16 v[20:23], v[84:87], v[72:75], v[20:23]
    v_mfma_f32_16x16x32_bf16 v[24:27], v[88:91], v[72:75], v[24:27]
    v_mfma_f32_16x16x32_bf16 v[28:31], v[92:95], v[72:75], v[28:31]
    v_mfma_f32_16x16x32_bf16 v[32:35], v[80:83], v[76:79], v[32:35]
    v_mfma_f32_16x16x32_bf16 v[36:39], v[84:87], v[76:79], v[36:39]
    v_mfma_f32_16x16x32_bf16 v[40:43], v[88:91], v[76:79], v[40:43]
    v_mfma_f32_16x16x32_bf16 v[44:47], v[92:95], v[76:79], v[44:47]
    s_waitcnt vmcnt(6)
    ds_write_b128 v8, v[96:99] offset:0
    ds_write_b128 v8, v[100:103] offset:4608
    ds_write_b128 v11, v[104:107] offset:0
    ds_write_b128 v11, v[108:111] offset:4608
    ds_write_b128 v11, v[112:115] offset:9216
    ds_write_b128 v11, v[116:119] offset:13824
    s_waitcnt lgkmcnt(0)
    s_barrier
    buffer_load_dwordx4 v[96:99], v7, s[40:43], s64 offen
    buffer_load_dwordx4 v[100:103], v7, s[40:43], s65 offen
    buffer_load_dwordx4 v[104:107], v10, s[60:63], s68 offen
    buffer_load_dwordx4 v[108:111], v10, s[60:63], s69 offen
    buffer_load_dwordx4 v[112:115], v10, s[60:63], s70 offen
    buffer_load_dwordx4 v[116:119], v10, s[60:63], s71 offen
    v_add_u32 v7, 128, v7
    v_add_u32 v10, 81920, v10
    ds_read_b64_tr_b16 v[56:57], v13 offset:0
    ds_read_b64_tr_b16 v[58:59], v13 offset:4608
    ds_read_b64_tr_b16 v[60:61], v13 offset:32
    ds_read_b64_tr_b16 v[62:63], v13 offset:4640
    ds_read_b64_tr_b16 v[64:65], v13 offset:64
    ds_read_b64_tr_b16 v[66:67], v13 offset:4672
    ds_read_b64_tr_b16 v[68:69], v13 offset:96
    ds_read_b64_tr_b16 v[70:71], v13 offset:4704
    ds_read_b64 v[48:49], v12 offset:0
    ds_read_b64 v[50:51], v12 offset:32
    ds_read_b64 v[52:53], v12 offset:2304
    ds_read_b64 v[54:55], v12 offset:2336
    s_waitcnt lgkmcnt(0)
    ds_read_b64_tr_b16 v[80:81], v13 offset:9216
    ds_read_b64_tr_b16 v[82:83], v13 offset:13824
    ds_read_b64_tr_b16 v[84:85], v13 offset:9248
    ds_read_b64_tr_b16 v[86:87], v13 offset:13856
    ds_read_b64_tr_b16 v[88:89], v13 offset:9280
    ds_read_b64_tr_b16 v[90:91], v13 offset:13888
    ds_read_b64_tr_b16 v[92:93], v13 offset:9312
    ds_read_b64_tr_b16 v[94:95], v13 offset:13920
    ds_read_b64 v[72:73], v12 offset:64
    ds_read_b64 v[74:75], v12 offset:96
    ds_read_b64 v[76:77], v12 offset:2368
    ds_read_b64 v[78:79], v12 offset:2400
    v_mfma_f32_16x16x32_bf16 v[16:19], v[56:59], v[48:51], v[16:19]
    v_mfma_f32_16x16x32_bf16 v[20:23], v[60:63], v[48:51], v[20:23]
    v_mfma_f32_16x16x32_bf16 v[24:27], v[64:67], v[48:51], v[24:27]
    v_mfma_f32_16x16x32_bf16 v[28:31], v[68:71], v[48:51], v[28:31]
    v_mfma_f32_16x16x32_bf16 v[32:35], v[56:59], v[52:55], v[32:35]
    v_mfma_f32_16x16x32_bf16 v[36:39], v[60:63], v[52:55], v[36:39]
    v_mfma_f32_16x16x32_bf16 v[40:43], v[64:67], v[52:55], v[40:43]
    v_mfma_f32_16x16x32_bf16 v[44:47], v[68:71], v[52:55], v[44:47]
    s_waitcnt lgkmcnt(0)
    v_mfma_f32_16x16x32_bf16 v[16:19], v[80:83], v[72:75], v[16:19]
    v_mfma_f32_16x16x32_bf16 v[20:23], v[84:87], v[72:75], v[20:23]
    v_mfma_f32_16x16x32_bf16 v[24:27], v[88:91], v[72:75], v[24:27]
    v_mfma_f32_16x16x32_bf16 v[28:31], v[92:95], v[72:75], v[28:31]
    v_mfma_f32_16x16x32_bf16 v[32:35], v[80:83], v[76:79], v[32:35]
    v_mfma_f32_16x16x32_bf16 v[36:39], v[84:87], v[76:79], v[36:39]
    v_mfma_f32_16x16x32_bf16 v[40:43], v[88:91], v[76:79], v[40:43]
    v_mfma_f32_16x16x32_bf16 v[44:47], v[92:95], v[76:79], v[44:47]
    s_waitcnt vmcnt(6)
    ds_write_b128 v8, v[120:123] offset:27648
    ds_write_b128 v8, v[124:127] offset:32256
    ds_write_b128 v11, v[128:131] offset:27648
    ds_write_b128 v11, v[132:135] offset:32256
    ds_write_b128 v11, v[136:139] offset:36864
    ds_write_b128 v11, v[140:143] offset:41472
    s_waitcnt lgkmcnt(0)
    s_barrier
    buffer_load_dwordx4 v[120:123], v7, s[40:43], s64 offen
    buffer_load_dwordx4 v[124:127], v7, s[40:43], s65 offen
    buffer_load_dwordx4 v[128:131], v10, s[60:63], s68 offen
    buffer_load_dwordx4 v[132:135], v10, s[60:63], s69 offen
    buffer_load_dwordx4 v[136:139], v10, s[60:63], s70 offen
    buffer_load_dwordx4 v[140:143], v10, s[60:63], s71 offen
    v_add_u32 v7, 128, v7
    v_add_u32 v10, 81920, v10
    ds_read_b64_tr_b16 v[56:57], v13 offset:27648
    ds_read_b64_tr_b16 v[58:59], v13 offset:32256
    ds_read_b64_tr_b16 v[60:61], v13 offset:27680
    ds_read_b64_tr_b16 v[62:63], v13 offset:32288
    ds_read_b64_tr_b16 v[64:65], v13 offset:27712
    ds_read_b64_tr_b16 v[66:67], v13 offset:32320
    ds_read_b64_tr_b16 v[68:69], v13 offset:27744
    ds_read_b64_tr_b16 v[70:71], v13 offset:32352
    ds_read_b64 v[48:49], v12 offset:27648
    ds_read_b64 v[50:51], v12 offset:27680
    ds_read_b64 v[52:53], v12 offset:29952
    ds_read_b64 v[54:55], v12 offset:29984
    s_waitcnt lgkmcnt(0)
    ds_read_b64_tr_b16 v[80:81], v13 offset:36864
    ds_read_b64_tr_b16 v[82:83], v13 offset:41472
    ds_read_b64_tr_b16 v[84:85], v13 offset:36896
    ds_read_b64_tr_b16 v[86:87], v13 offset:41504
    ds_read_b64_tr_b16 v[88:89], v13 offset:36928
    ds_read_b64_tr_b16 v[90:91], v13 offset:41536
    ds_read_b64_tr_b16 v[92:93], v13 offset:36960
    ds_read_b64_tr_b16 v[94:95], v13 offset:41568
    ds_read_b64 v[72:73], v12 offset:27712
    ds_read_b64 v[74:75], v12 offset:27744
    ds_read_b64 v[76:77], v12 offset:30016
    ds_read_b64 v[78:79], v12 offset:30048
    v_mfma_f32_16x16x32_bf16 v[16:19], v[56:59], v[48:51], v[16:19]
    v_mfma_f32_16x16x32_bf16 v[20:23], v[60:63], v[48:51], v[20:23]
    v_mfma_f32_16x16x32_bf16 v[24:27], v[64:67], v[48:51], v[24:27]
    v_mfma_f32_16x16x32_bf16 v[28:31], v[68:71], v[48:51], v[28:31]
    v_mfma_f32_16x16x32_bf16 v[32:35], v[56:59], v[52:55], v[32:35]
    v_mfma_f32_16x16x32_bf16 v[36:39], v[60:63], v[52:55], v[36:39]
    v_mfma_f32_16x16x32_bf16 v[40:43], v[64:67], v[52:55], v[40:43]
    v_mfma_f32_16x16x32_bf16 v[44:47], v[68:71], v[52:55], v[44:47]
    s_waitcnt lgkmcnt(0)
    v_mfma_f32_16x16x32_bf16 v[16:19], v[80:83], v[72:75], v[16:19]
    v_mfma_f32_16x16x32_bf16 v[20:23], v[84:87], v[72:75], v[20:23]
    v_mfma_f32_16x16x32_bf16 v[24:27], v[88:91], v[72:75], v[24:27]
    v_mfma_f32_16x16x32_bf16 v[28:31], v[92:95], v[72:75], v[28:31]
    v_mfma_f32_16x16x32_bf16 v[32:35], v[80:83], v[76:79], v[32:35]
    v_mfma_f32_16x16x32_bf16 v[36:39], v[84:87], v[76:79], v[36:39]
    v_mfma_f32_16x16x32_bf16 v[40:43], v[88:91], v[76:79], v[40:43]
    v_mfma_f32_16x16x32_bf16 v[44:47], v[92:95], v[76:79], v[44:47]
    s_waitcnt vmcnt(6)
    ds_write_b128 v8, v[96:99] offset:0
    ds_write_b128 v8, v[100:103] offset:4608
    ds_write_b128 v11, v[104:107] offset:0
    ds_write_b128 v11, v[108:111] offset:4608
    ds_write_b128 v11, v[112:115] offset:9216
    ds_write_b128 v11, v[116:119] offset:13824
    s_waitcnt lgkmcnt(0)
    s_barrier
    buffer_load_dwordx4 v[96:99], v7, s[40:43], s64 offen
    buffer_load_dwordx4 v[100:103], v7, s[40:43], s65 offen
    buffer_load_dwordx4 v[104:107], v10, s[60:63], s68 offen
    buffer_load_dwordx4 v[108:111], v10, s[60:63], s69 offen
    buffer_load_dwordx4 v[112:115], v10, s[60:63], s70 offen
    buffer_load_dwordx4 v[116:119], v10, s[60:63], s71 offen
    v_add_u32 v7, 128, v7
    v_add_u32 v10, 81920, v10
    ds_read_b64_tr_b16 v[56:57], v13 offset:0
    ds_read_b64_tr_b16 v[58:59], v13 offset:4608
    ds_read_b64_tr_b16 v[60:61], v13 offset:32
    ds_read_b64_tr_b16 v[62:63], v13 offset:4640
    ds_read_b64_tr_b16 v[64:65], v13 offset:64
    ds_read_b64_tr_b16 v[66:67], v13 offset:4672
    ds_read_b64_tr_b16 v[68:69], v13 offset:96
    ds_read_b64_tr_b16 v[70:71], v13 offset:4704
    ds_read_b64 v[48:49], v12 offset:0
    ds_read_b64 v[50:51], v12 offset:32
    ds_read_b64 v[52:53], v12 offset:2304
    ds_read_b64 v[54:55], v12 offset:2336
    s_waitcnt lgkmcnt(0)
    ds_read_b64_tr_b16 v[80:81], v13 offset:9216
    ds_read_b64_tr_b16 v[82:83], v13 offset:13824
    ds_read_b64_tr_b16 v[84:85], v13 offset:9248
    ds_read_b64_tr_b16 v[86:87], v13 offset:13856
    ds_read_b64_tr_b16 v[88:89], v13 offset:9280
    ds_read_b64_tr_b16 v[90:91], v13 offset:13888
    ds_read_b64_tr_b16 v[92:93], v13 offset:9312
    ds_read_b64_tr_b16 v[94:95], v13 offset:13920
    ds_read_b64 v[72:73], v12 offset:64
    ds_read_b64 v[74:75], v12 offset:96
    ds_read_b64 v[76:77], v12 offset:2368
    ds_read_b64 v[78:79], v12 offset:2400
    v_mfma_f32_16x16x32_bf16 v[16:19], v[56:59], v[48:51], v[16:19]
    v_mfma_f32_16x16x32_bf16 v[20:23], v[60:63], v[48:51], v[20:23]
    v_mfma_f32_16x16x32_bf16 v[24:27], v[64:67], v[48:51], v[24:27]
    v_mfma_f32_16x16x32_bf16 v[28:31], v[68:71], v[48:51], v[28:31]
    v_mfma_f32_16x16x32_bf16 v[32:35], v[56:59], v[52:55], v[32:35]
    v_mfma_f32_16x16x32_bf16 v[36:39], v[60:63], v[52:55], v[36:39]
    v_mfma_f32_16x16x32_bf16 v[40:43], v[64:67], v[52:55], v[40:43]
    v_mfma_f32_16x16x32_bf16 v[44:47], v[68:71], v[52:55], v[44:47]
    s_waitcnt lgkmcnt(0)
    v_mfma_f32_16x16x32_bf16 v[16:19], v[80:83], v[72:75], v[16:19]
    v_mfma_f32_16x16x32_bf16 v[20:23], v[84:87], v[72:75], v[20:23]
    v_mfma_f32_16x16x32_bf16 v[24:27], v[88:91], v[72:75], v[24:27]
    v_mfma_f32_16x16x32_bf16 v[28:31], v[92:95], v[72:75], v[28:31]
    v_mfma_f32_16x16x32_bf16 v[32:35], v[80:83], v[76:79], v[32:35]
    v_mfma_f32_16x16x32_bf16 v[36:39], v[84:87], v[76:79], v[36:39]
    v_mfma_f32_16x16x32_bf16 v[40:43], v[88:91], v[76:79], v[40:43]
    v_mfma_f32_16x16x32_bf16 v[44:47], v[92:95], v[76:79], v[44:47]
    s_waitcnt vmcnt(6)
    ds_write_b128 v8, v[120:123] offset:27648
    ds_write_b128 v8, v[124:127] offset:32256
    ds_write_b128 v11, v[128:131] offset:27648
    ds_write_b128 v11, v[132:135] offset:32256
    ds_write_b128 v11, v[136:139] offset:36864
    ds_write_b128 v11, v[140:143] offset:41472
    s_waitcnt lgkmcnt(0)
    s_barrier
    buffer_load_dwordx4 v[120:123], v7, s[40:43], s64 offen
    buffer_load_dwordx4 v[124:127], v7, s[40:43], s65 offen
    buffer_load_dwordx4 v[128:131], v10, s[60:63], s68 offen
    buffer_load_dwordx4 v[132:135], v10, s[60:63], s69 offen
    buffer_load_dwordx4 v[136:139], v10, s[60:63], s70 offen
    buffer_load_dwordx4 v[140:143], v10, s[60:63], s71 offen
    v_add_u32 v7, 128, v7
    v_add_u32 v10, 81920, v10
    ds_read_b64_tr_b16 v[56:57], v13 offset:27648
    ds_read_b64_tr_b16 v[58:59], v13 offset:32256
    ds_read_b64_tr_b16 v[60:61], v13 offset:27680
    ds_read_b64_tr_b16 v[62:63], v13 offset:32288
    ds_read_b64_tr_b16 v[64:65], v13 offset:27712
    ds_read_b64_tr_b16 v[66:67], v13 offset:32320
    ds_read_b64_tr_b16 v[68:69], v13 offset:27744
    ds_read_b64_tr_b16 v[70:71], v13 offset:32352
    ds_read_b64 v[48:49], v12 offset:27648
    ds_read_b64 v[50:51], v12 offset:27680
    ds_read_b64 v[52:53], v12 offset:29952
    ds_read_b64 v[54:55], v12 offset:29984
    s_waitcnt lgkmcnt(0)
    ds_read_b64_tr_b16 v[80:81], v13 offset:36864
    ds_read_b64_tr_b16 v[82:83], v13 offset:41472
    ds_read_b64_tr_b16 v[84:85], v13 offset:36896
    ds_read_b64_tr_b16 v[86:87], v13 offset:41504
    ds_read_b64_tr_b16 v[88:89], v13 offset:36928
    ds_read_b64_tr_b16 v[90:91], v13 offset:41536
    ds_read_b64_tr_b16 v[92:93], v13 offset:36960
    ds_read_b64_tr_b16 v[94:95], v13 offset:41568
    ds_read_b64 v[72:73], v12 offset:27712
    ds_read_b64 v[74:75], v12 offset:27744
    ds_read_b64 v[76:77], v12 offset:30016
    ds_read_b64 v[78:79], v12 offset:30048
    v_mfma_f32_16x16x32_bf16 v[16:19], v[56:59], v[48:51], v[16:19]
    v_mfma_f32_16x16x32_bf16 v[20:23], v[60:63], v[48:51], v[20:23]
    v_mfma_f32_16x16x32_bf16 v[24:27], v[64:67], v[48:51], v[24:27]
    v_mfma_f32_16x16x32_bf16 v[28:31], v[68:71], v[48:51], v[28:31]
    v_mfma_f32_16x16x32_bf16 v[32:35], v[56:59], v[52:55], v[32:35]
    v_mfma_f32_16x16x32_bf16 v[36:39], v[60:63], v[52:55], v[36:39]
    v_mfma_f32_16x16x32_bf16 v[40:43], v[64:67], v[52:55], v[40:43]
    v_mfma_f32_16x16x32_bf16 v[44:47], v[68:71], v[52:55], v[44:47]
    s_waitcnt lgkmcnt(0)
    v_mfma_f32_16x16x32_bf16 v[16:19], v[80:83], v[72:75], v[16:19]
    v_mfma_f32_16x16x32_bf16 v[20:23], v[84:87], v[72:75], v[20:23]
    v_mfma_f32_16x16x32_bf16 v[24:27], v[88:91], v[72:75], v[24:27]
    v_mfma_f32_16x16x32_bf16 v[28:31], v[92:95], v[72:75], v[28:31]
    v_mfma_f32_16x16x32_bf16 v[32:35], v[80:83], v[76:79], v[32:35]
    v_mfma_f32_16x16x32_bf16 v[36:39], v[84:87], v[76:79], v[36:39]
    v_mfma_f32_16x16x32_bf16 v[40:43], v[88:91], v[76:79], v[40:43]
    v_mfma_f32_16x16x32_bf16 v[44:47], v[92:95], v[76:79], v[44:47]
    s_waitcnt vmcnt(6)
    ds_write_b128 v8, v[96:99] offset:0
    ds_write_b128 v8, v[100:103] offset:4608
    ds_write_b128 v11, v[104:107] offset:0
    ds_write_b128 v11, v[108:111] offset:4608
    ds_write_b128 v11, v[112:115] offset:9216
    ds_write_b128 v11, v[116:119] offset:13824
    s_waitcnt lgkmcnt(0)
    s_barrier
    buffer_load_dwordx4 v[96:99], v7, s[40:43], s64 offen
    buffer_load_dwordx4 v[100:103], v7, s[40:43], s65 offen
    buffer_load_dwordx4 v[104:107], v10, s[60:63], s68 offen
    buffer_load_dwordx4 v[108:111], v10, s[60:63], s69 offen
    buffer_load_dwordx4 v[112:115], v10, s[60:63], s70 offen
    buffer_load_dwordx4 v[116:119], v10, s[60:63], s71 offen
    v_add_u32 v7, 128, v7
    v_add_u32 v10, 81920, v10
    ds_read_b64_tr_b16 v[56:57], v13 offset:0
    ds_read_b64_tr_b16 v[58:59], v13 offset:4608
    ds_read_b64_tr_b16 v[60:61], v13 offset:32
    ds_read_b64_tr_b16 v[62:63], v13 offset:4640
    ds_read_b64_tr_b16 v[64:65], v13 offset:64
    ds_read_b64_tr_b16 v[66:67], v13 offset:4672
    ds_read_b64_tr_b16 v[68:69], v13 offset:96
    ds_read_b64_tr_b16 v[70:71], v13 offset:4704
    ds_read_b64 v[48:49], v12 offset:0
    ds_read_b64 v[50:51], v12 offset:32
    ds_read_b64 v[52:53], v12 offset:2304
    ds_read_b64 v[54:55], v12 offset:2336
    s_waitcnt lgkmcnt(0)
    ds_read_b64_tr_b16 v[80:81], v13 offset:9216
    ds_read_b64_tr_b16 v[82:83], v13 offset:13824
    ds_read_b64_tr_b16 v[84:85], v13 offset:9248
    ds_read_b64_tr_b16 v[86:87], v13 offset:13856
    ds_read_b64_tr_b16 v[88:89], v13 offset:9280
    ds_read_b64_tr_b16 v[90:91], v13 offset:13888
    ds_read_b64_tr_b16 v[92:93], v13 offset:9312
    ds_read_b64_tr_b16 v[94:95], v13 offset:13920
    ds_read_b64 v[72:73], v12 offset:64
    ds_read_b64 v[74:75], v12 offset:96
    ds_read_b64 v[76:77], v12 offset:2368
    ds_read_b64 v[78:79], v12 offset:2400
    v_mfma_f32_16x16x32_bf16 v[16:19], v[56:59], v[48:51], v[16:19]
    v_mfma_f32_16x16x32_bf16 v[20:23], v[60:63], v[48:51], v[20:23]
    v_mfma_f32_16x16x32_bf16 v[24:27], v[64:67], v[48:51], v[24:27]
    v_mfma_f32_16x16x32_bf16 v[28:31], v[68:71], v[48:51], v[28:31]
    v_mfma_f32_16x16x32_bf16 v[32:35], v[56:59], v[52:55], v[32:35]
    v_mfma_f32_16x16x32_bf16 v[36:39], v[60:63], v[52:55], v[36:39]
    v_mfma_f32_16x16x32_bf16 v[40:43], v[64:67], v[52:55], v[40:43]
    v_mfma_f32_16x16x32_bf16 v[44:47], v[68:71], v[52:55], v[44:47]
    s_waitcnt lgkmcnt(0)
    v_mfma_f32_16x16x32_bf16 v[16:19], v[80:83], v[72:75], v[16:19]
    v_mfma_f32_16x16x32_bf16 v[20:23], v[84:87], v[72:75], v[20:23]
    v_mfma_f32_16x16x32_bf16 v[24:27], v[88:91], v[72:75], v[24:27]
    v_mfma_f32_16x16x32_bf16 v[28:31], v[92:95], v[72:75], v[28:31]
    v_mfma_f32_16x16x32_bf16 v[32:35], v[80:83], v[76:79], v[32:35]
    v_mfma_f32_16x16x32_bf16 v[36:39], v[84:87], v[76:79], v[36:39]
    v_mfma_f32_16x16x32_bf16 v[40:43], v[88:91], v[76:79], v[40:43]
    v_mfma_f32_16x16x32_bf16 v[44:47], v[92:95], v[76:79], v[44:47]
    s_waitcnt vmcnt(6)
    ds_write_b128 v8, v[120:123] offset:27648
    ds_write_b128 v8, v[124:127] offset:32256
    ds_write_b128 v11, v[128:131] offset:27648
    ds_write_b128 v11, v[132:135] offset:32256
    ds_write_b128 v11, v[136:139] offset:36864
    ds_write_b128 v11, v[140:143] offset:41472
    s_waitcnt lgkmcnt(0)
    s_barrier
    buffer_load_dwordx4 v[120:123], v7, s[40:43], s64 offen
    buffer_load_dwordx4 v[124:127], v7, s[40:43], s65 offen
    buffer_load_dwordx4 v[128:131], v10, s[60:63], s68 offen
    buffer_load_dwordx4 v[132:135], v10, s[60:63], s69 offen
    buffer_load_dwordx4 v[136:139], v10, s[60:63], s70 offen
    buffer_load_dwordx4 v[140:143], v10, s[60:63], s71 offen
    v_add_u32 v7, 128, v7
    v_add_u32 v10, 81920, v10
    ds_read_b64_tr_b16 v[56:57], v13 offset:27648
    ds_read_b64_tr_b16 v[58:59], v13 offset:32256
    ds_read_b64_tr_b16 v[60:61], v13 offset:27680
    ds_read_b64_tr_b16 v[62:63], v13 offset:32288
    ds_read_b64_tr_b16 v[64:65], v13 offset:27712
    ds_read_b64_tr_b16 v[66:67], v13 offset:32320
    ds_read_b64_tr_b16 v[68:69], v13 offset:27744
    ds_read_b64_tr_b16 v[70:71], v13 offset:32352
    ds_read_b64 v[48:49], v12 offset:27648
    ds_read_b64 v[50:51], v12 offset:27680
    ds_read_b64 v[52:53], v12 offset:29952
    ds_read_b64 v[54:55], v12 offset:29984
    s_waitcnt lgkmcnt(0)
    ds_read_b64_tr_b16 v[80:81], v13 offset:36864
    ds_read_b64_tr_b16 v[82:83], v13 offset:41472
    ds_read_b64_tr_b16 v[84:85], v13 offset:36896
    ds_read_b64_tr_b16 v[86:87], v13 offset:41504
    ds_read_b64_tr_b16 v[88:89], v13 offset:36928
    ds_read_b64_tr_b16 v[90:91], v13 offset:41536
    ds_read_b64_tr_b16 v[92:93], v13 offset:36960
    ds_read_b64_tr_b16 v[94:95], v13 offset:41568
    ds_read_b64 v[72:73], v12 offset:27712
    ds_read_b64 v[74:75], v12 offset:27744
    ds_read_b64 v[76:77], v12 offset:30016
    ds_read_b64 v[78:79], v12 offset:30048
    v_mfma_f32_16x16x32_bf16 v[16:19], v[56:59], v[48:51], v[16:19]
    v_mfma_f32_16x16x32_bf16 v[20:23], v[60:63], v[48:51], v[20:23]
    v_mfma_f32_16x16x32_bf16 v[24:27], v[64:67], v[48:51], v[24:27]
    v_mfma_f32_16x16x32_bf16 v[28:31], v[68:71], v[48:51], v[28:31]
    v_mfma_f32_16x16x32_bf16 v[32:35], v[56:59], v[52:55], v[32:35]
    v_mfma_f32_16x16x32_bf16 v[36:39], v[60:63], v[52:55], v[36:39]
    v_mfma_f32_16x16x32_bf16 v[40:43], v[64:67], v[52:55], v[40:43]
    v_mfma_f32_16x16x32_bf16 v[44:47], v[68:71], v[52:55], v[44:47]
    s_waitcnt lgkmcnt(0)
    v_mfma_f32_16x16x32_bf16 v[16:19], v[80:83], v[72:75], v[16:19]
    v_mfma_f32_16x16x32_bf16 v[20:23], v[84:87], v[72:75], v[20:23]
    v_mfma_f32_16x16x32_bf16 v[24:27], v[88:91], v[72:75], v[24:27]
    v_mfma_f32_16x16x32_bf16 v[28:31], v[92:95], v[72:75], v[28:31]
    v_mfma_f32_16x16x32_bf16 v[32:35], v[80:83], v[76:79], v[32:35]
    v_mfma_f32_16x16x32_bf16 v[36:39], v[84:87], v[76:79], v[36:39]
    v_mfma_f32_16x16x32_bf16 v[40:43], v[88:91], v[76:79], v[40:43]
    v_mfma_f32_16x16x32_bf16 v[44:47], v[92:95], v[76:79], v[44:47]
    s_waitcnt vmcnt(6)
    ds_write_b128 v8, v[96:99] offset:0
    ds_write_b128 v8, v[100:103] offset:4608
    ds_write_b128 v11, v[104:107] offset:0
    ds_write_b128 v11, v[108:111] offset:4608
    ds_write_b128 v11, v[112:115] offset:9216
    ds_write_b128 v11, v[116:119] offset:13824
    s_waitcnt lgkmcnt(0)
    s_barrier
    buffer_load_dwordx4 v[96:99], v7, s[40:43], s64 offen
    buffer_load_dwordx4 v[100:103], v7, s[40:43], s65 offen
    buffer_load_dwordx4 v[104:107], v10, s[60:63], s68 offen
    buffer_load_dwordx4 v[108:111], v10, s[60:63], s69 offen
    buffer_load_dwordx4 v[112:115], v10, s[60:63], s70 offen
    buffer_load_dwordx4 v[116:119], v10, s[60:63], s71 offen
    v_add_u32 v7, 128, v7
    v_add_u32 v10, 81920, v10
    ds_read_b64_tr_b16 v[56:57], v13 offset:0
    ds_read_b64_tr_b16 v[58:59], v13 offset:4608
    ds_read_b64_tr_b16 v[60:61], v13 offset:32
    ds_read_b64_tr_b16 v[62:63], v13 offset:4640
    ds_read_b64_tr_b16 v[64:65], v13 offset:64
    ds_read_b64_tr_b16 v[66:67], v13 offset:4672
    ds_read_b64_tr_b16 v[68:69], v13 offset:96
    ds_read_b64_tr_b16 v[70:71], v13 offset:4704
    ds_read_b64 v[48:49], v12 offset:0
    ds_read_b64 v[50:51], v12 offset:32
    ds_read_b64 v[52:53], v12 offset:2304
    ds_read_b64 v[54:55], v12 offset:2336
    s_waitcnt lgkmcnt(0)
    ds_read_b64_tr_b16 v[80:81], v13 offset:9216
    ds_read_b64_tr_b16 v[82:83], v13 offset:13824
    ds_read_b64_tr_b16 v[84:85], v13 offset:9248
    ds_read_b64_tr_b16 v[86:87], v13 offset:13856
    ds_read_b64_tr_b16 v[88:89], v13 offset:9280
    ds_read_b64_tr_b16 v[90:91], v13 offset:13888
    ds_read_b64_tr_b16 v[92:93], v13 offset:9312
    ds_read_b64_tr_b16 v[94:95], v13 offset:13920
    ds_read_b64 v[72:73], v12 offset:64
    ds_read_b64 v[74:75], v12 offset:96
    ds_read_b64 v[76:77], v12 offset:2368
    ds_read_b64 v[78:79], v12 offset:2400
    v_mfma_f32_16x16x32_bf16 v[16:19], v[56:59], v[48:51], v[16:19]
    v_mfma_f32_16x16x32_bf16 v[20:23], v[60:63], v[48:51], v[20:23]
    v_mfma_f32_16x16x32_bf16 v[24:27], v[64:67], v[48:51], v[24:27]
    v_mfma_f32_16x16x32_bf16 v[28:31], v[68:71], v[48:51], v[28:31]
    v_mfma_f32_16x16x32_bf16 v[32:35], v[56:59], v[52:55], v[32:35]
    v_mfma_f32_16x16x32_bf16 v[36:39], v[60:63], v[52:55], v[36:39]
    v_mfma_f32_16x16x32_bf16 v[40:43], v[64:67], v[52:55], v[40:43]
    v_mfma_f32_16x16x32_bf16 v[44:47], v[68:71], v[52:55], v[44:47]
    s_waitcnt lgkmcnt(0)
    v_mfma_f32_16x16x32_bf16 v[16:19], v[80:83], v[72:75], v[16:19]
    v_mfma_f32_16x16x32_bf16 v[20:23], v[84:87], v[72:75], v[20:23]
    v_mfma_f32_16x16x32_bf16 v[24:27], v[88:91], v[72:75], v[24:27]
    v_mfma_f32_16x16x32_bf16 v[28:31], v[92:95], v[72:75], v[28:31]
    v_mfma_f32_16x16x32_bf16 v[32:35], v[80:83], v[76:79], v[32:35]
    v_mfma_f32_16x16x32_bf16 v[36:39], v[84:87], v[76:79], v[36:39]
    v_mfma_f32_16x16x32_bf16 v[40:43], v[88:91], v[76:79], v[40:43]
    v_mfma_f32_16x16x32_bf16 v[44:47], v[92:95], v[76:79], v[44:47]
    s_waitcnt vmcnt(6)
    ds_write_b128 v8, v[120:123] offset:27648
    ds_write_b128 v8, v[124:127] offset:32256
    ds_write_b128 v11, v[128:131] offset:27648
    ds_write_b128 v11, v[132:135] offset:32256
    ds_write_b128 v11, v[136:139] offset:36864
    ds_write_b128 v11, v[140:143] offset:41472
    s_waitcnt lgkmcnt(0)
    s_barrier
    buffer_load_dwordx4 v[120:123], v7, s[40:43], s64 offen
    buffer_load_dwordx4 v[124:127], v7, s[40:43], s65 offen
    buffer_load_dwordx4 v[128:131], v10, s[60:63], s68 offen
    buffer_load_dwordx4 v[132:135], v10, s[60:63], s69 offen
    buffer_load_dwordx4 v[136:139], v10, s[60:63], s70 offen
    buffer_load_dwordx4 v[140:143], v10, s[60:63], s71 offen
    v_add_u32 v7, 128, v7
    v_add_u32 v10, 81920, v10
    ds_read_b64_tr_b16 v[56:57], v13 offset:27648
    ds_read_b64_tr_b16 v[58:59], v13 offset:32256
    ds_read_b64_tr_b16 v[60:61], v13 offset:27680
    ds_read_b64_tr_b16 v[62:63], v13 offset:32288
    ds_read_b64_tr_b16 v[64:65], v13 offset:27712
    ds_read_b64_tr_b16 v[66:67], v13 offset:32320
    ds_read_b64_tr_b16 v[68:69], v13 offset:27744
    ds_read_b64_tr_b16 v[70:71], v13 offset:32352
    ds_read_b64 v[48:49], v12 offset:27648
    ds_read_b64 v[50:51], v12 offset:27680
    ds_read_b64 v[52:53], v12 offset:29952
    ds_read_b64 v[54:55], v12 offset:29984
    s_waitcnt lgkmcnt(0)
    ds_read_b64_tr_b16 v[80:81], v13 offset:36864
    ds_read_b64_tr_b16 v[82:83], v13 offset:41472
    ds_read_b64_tr_b16 v[84:85], v13 offset:36896
    ds_read_b64_tr_b16 v[86:87], v13 offset:41504
    ds_read_b64_tr_b16 v[88:89], v13 offset:36928
    ds_read_b64_tr_b16 v[90:91], v13 offset:41536
    ds_read_b64_tr_b16 v[92:93], v13 offset:36960
    ds_read_b64_tr_b16 v[94:95], v13 offset:41568
    ds_read_b64 v[72:73], v12 offset:27712
    ds_read_b64 v[74:75], v12 offset:27744
    ds_read_b64 v[76:77], v12 offset:30016
    ds_read_b64 v[78:79], v12 offset:30048
    v_mfma_f32_16x16x32_bf16 v[16:19], v[56:59], v[48:51], v[16:19]
    v_mfma_f32_16x16x32_bf16 v[20:23], v[60:63], v[48:51], v[20:23]
    v_mfma_f32_16x16x32_bf16 v[24:27], v[64:67], v[48:51], v[24:27]
    v_mfma_f32_16x16x32_bf16 v[28:31], v[68:71], v[48:51], v[28:31]
    v_mfma_f32_16x16x32_bf16 v[32:35], v[56:59], v[52:55], v[32:35]
    v_mfma_f32_16x16x32_bf16 v[36:39], v[60:63], v[52:55], v[36:39]
    v_mfma_f32_16x16x32_bf16 v[40:43], v[64:67], v[52:55], v[40:43]
    v_mfma_f32_16x16x32_bf16 v[44:47], v[68:71], v[52:55], v[44:47]
    s_waitcnt lgkmcnt(0)
    v_mfma_f32_16x16x32_bf16 v[16:19], v[80:83], v[72:75], v[16:19]
    v_mfma_f32_16x16x32_bf16 v[20:23], v[84:87], v[72:75], v[20:23]
    v_mfma_f32_16x16x32_bf16 v[24:27], v[88:91], v[72:75], v[24:27]
    v_mfma_f32_16x16x32_bf16 v[28:31], v[92:95], v[72:75], v[28:31]
    v_mfma_f32_16x16x32_bf16 v[32:35], v[80:83], v[76:79], v[32:35]
    v_mfma_f32_16x16x32_bf16 v[36:39], v[84:87], v[76:79], v[36:39]
    v_mfma_f32_16x16x32_bf16 v[40:43], v[88:91], v[76:79], v[40:43]
    v_mfma_f32_16x16x32_bf16 v[44:47], v[92:95], v[76:79], v[44:47]
    s_waitcnt vmcnt(6)
    ds_write_b128 v8, v[96:99] offset:0
    ds_write_b128 v8, v[100:103] offset:4608
    ds_write_b128 v11, v[104:107] offset:0
    ds_write_b128 v11, v[108:111] offset:4608
    ds_write_b128 v11, v[112:115] offset:9216
    ds_write_b128 v11, v[116:119] offset:13824
    s_waitcnt lgkmcnt(0)
    s_barrier
    buffer_load_dwordx4 v[96:99], v7, s[40:43], s64 offen
    buffer_load_dwordx4 v[100:103], v7, s[40:43], s65 offen
    buffer_load_dwordx4 v[104:107], v10, s[60:63], s68 offen
    buffer_load_dwordx4 v[108:111], v10, s[60:63], s69 offen
    buffer_load_dwordx4 v[112:115], v10, s[60:63], s70 offen
    buffer_load_dwordx4 v[116:119], v10, s[60:63], s71 offen
    v_add_u32 v7, 128, v7
    v_add_u32 v10, 81920, v10
    ds_read_b64_tr_b16 v[56:57], v13 offset:0
    ds_read_b64_tr_b16 v[58:59], v13 offset:4608
    ds_read_b64_tr_b16 v[60:61], v13 offset:32
    ds_read_b64_tr_b16 v[62:63], v13 offset:4640
    ds_read_b64_tr_b16 v[64:65], v13 offset:64
    ds_read_b64_tr_b16 v[66:67], v13 offset:4672
    ds_read_b64_tr_b16 v[68:69], v13 offset:96
    ds_read_b64_tr_b16 v[70:71], v13 offset:4704
    ds_read_b64 v[48:49], v12 offset:0
    ds_read_b64 v[50:51], v12 offset:32
    ds_read_b64 v[52:53], v12 offset:2304
    ds_read_b64 v[54:55], v12 offset:2336
    s_waitcnt lgkmcnt(0)
    ds_read_b64_tr_b16 v[80:81], v13 offset:9216
    ds_read_b64_tr_b16 v[82:83], v13 offset:13824
    ds_read_b64_tr_b16 v[84:85], v13 offset:9248
    ds_read_b64_tr_b16 v[86:87], v13 offset:13856
    ds_read_b64_tr_b16 v[88:89], v13 offset:9280
    ds_read_b64_tr_b16 v[90:91], v13 offset:13888
    ds_read_b64_tr_b16 v[92:93], v13 offset:9312
    ds_read_b64_tr_b16 v[94:95], v13 offset:13920
    ds_read_b64 v[72:73], v12 offset:64
    ds_read_b64 v[74:75], v12 offset:96
    ds_read_b64 v[76:77], v12 offset:2368
    ds_read_b64 v[78:79], v12 offset:2400
    v_mfma_f32_16x16x32_bf16 v[16:19], v[56:59], v[48:51], v[16:19]
    v_mfma_f32_16x16x32_bf16 v[20:23], v[60:63], v[48:51], v[20:23]
    v_mfma_f32_16x16x32_bf16 v[24:27], v[64:67], v[48:51], v[24:27]
    v_mfma_f32_16x16x32_bf16 v[28:31], v[68:71], v[48:51], v[28:31]
    v_mfma_f32_16x16x32_bf16 v[32:35], v[56:59], v[52:55], v[32:35]
    v_mfma_f32_16x16x32_bf16 v[36:39], v[60:63], v[52:55], v[36:39]
    v_mfma_f32_16x16x32_bf16 v[40:43], v[64:67], v[52:55], v[40:43]
    v_mfma_f32_16x16x32_bf16 v[44:47], v[68:71], v[52:55], v[44:47]
    s_waitcnt lgkmcnt(0)
    v_mfma_f32_16x16x32_bf16 v[16:19], v[80:83], v[72:75], v[16:19]
    v_mfma_f32_16x16x32_bf16 v[20:23], v[84:87], v[72:75], v[20:23]
    v_mfma_f32_16x16x32_bf16 v[24:27], v[88:91], v[72:75], v[24:27]
    v_mfma_f32_16x16x32_bf16 v[28:31], v[92:95], v[72:75], v[28:31]
    v_mfma_f32_16x16x32_bf16 v[32:35], v[80:83], v[76:79], v[32:35]
    v_mfma_f32_16x16x32_bf16 v[36:39], v[84:87], v[76:79], v[36:39]
    v_mfma_f32_16x16x32_bf16 v[40:43], v[88:91], v[76:79], v[40:43]
    v_mfma_f32_16x16x32_bf16 v[44:47], v[92:95], v[76:79], v[44:47]
    s_waitcnt vmcnt(6)
    ds_write_b128 v8, v[120:123] offset:27648
    ds_write_b128 v8, v[124:127] offset:32256
    ds_write_b128 v11, v[128:131] offset:27648
    ds_write_b128 v11, v[132:135] offset:32256
    ds_write_b128 v11, v[136:139] offset:36864
    ds_write_b128 v11, v[140:143] offset:41472
    s_waitcnt lgkmcnt(0)
    s_barrier
    buffer_load_dwordx4 v[120:123], v7, s[40:43], s64 offen
    buffer_load_dwordx4 v[124:127], v7, s[40:43], s65 offen
    buffer_load_dwordx4 v[128:131], v10, s[60:63], s68 offen
    buffer_load_dwordx4 v[132:135], v10, s[60:63], s69 offen
    buffer_load_dwordx4 v[136:139], v10, s[60:63], s70 offen
    buffer_load_dwordx4 v[140:143], v10, s[60:63], s71 offen
    v_add_u32 v7, 128, v7
    v_add_u32 v10, 81920, v10
    ds_read_b64_tr_b16 v[56:57], v13 offset:27648
    ds_read_b64_tr_b16 v[58:59], v13 offset:32256
    ds_read_b64_tr_b16 v[60:61], v13 offset:27680
    ds_read_b64_tr_b16 v[62:63], v13 offset:32288
    ds_read_b64_tr_b16 v[64:65], v13 offset:27712
    ds_read_b64_tr_b16 v[66:67], v13 offset:32320
    ds_read_b64_tr_b16 v[68:69], v13 offset:27744
    ds_read_b64_tr_b16 v[70:71], v13 offset:32352
    ds_read_b64 v[48:49], v12 offset:27648
    ds_read_b64 v[50:51], v12 offset:27680
    ds_read_b64 v[52:53], v12 offset:29952
    ds_read_b64 v[54:55], v12 offset:29984
    s_waitcnt lgkmcnt(0)
    ds_read_b64_tr_b16 v[80:81], v13 offset:36864
    ds_read_b64_tr_b16 v[82:83], v13 offset:41472
    ds_read_b64_tr_b16 v[84:85], v13 offset:36896
    ds_read_b64_tr_b16 v[86:87], v13 offset:41504
    ds_read_b64_tr_b16 v[88:89], v13 offset:36928
    ds_read_b64_tr_b16 v[90:91], v13 offset:41536
    ds_read_b64_tr_b16 v[92:93], v13 offset:36960
    ds_read_b64_tr_b16 v[94:95], v13 offset:41568
    ds_read_b64 v[72:73], v12 offset:27712
    ds_read_b64 v[74:75], v12 offset:27744
    ds_read_b64 v[76:77], v12 offset:30016
    ds_read_b64 v[78:79], v12 offset:30048
    v_mfma_f32_16x16x32_bf16 v[16:19], v[56:59], v[48:51], v[16:19]
    v_mfma_f32_16x16x32_bf16 v[20:23], v[60:63], v[48:51], v[20:23]
    v_mfma_f32_16x16x32_bf16 v[24:27], v[64:67], v[48:51], v[24:27]
    v_mfma_f32_16x16x32_bf16 v[28:31], v[68:71], v[48:51], v[28:31]
    v_mfma_f32_16x16x32_bf16 v[32:35], v[56:59], v[52:55], v[32:35]
    v_mfma_f32_16x16x32_bf16 v[36:39], v[60:63], v[52:55], v[36:39]
    v_mfma_f32_16x16x32_bf16 v[40:43], v[64:67], v[52:55], v[40:43]
    v_mfma_f32_16x16x32_bf16 v[44:47], v[68:71], v[52:55], v[44:47]
    s_waitcnt lgkmcnt(0)
    v_mfma_f32_16x16x32_bf16 v[16:19], v[80:83], v[72:75], v[16:19]
    v_mfma_f32_16x16x32_bf16 v[20:23], v[84:87], v[72:75], v[20:23]
    v_mfma_f32_16x16x32_bf16 v[24:27], v[88:91], v[72:75], v[24:27]
    v_mfma_f32_16x16x32_bf16 v[28:31], v[92:95], v[72:75], v[28:31]
    v_mfma_f32_16x16x32_bf16 v[32:35], v[80:83], v[76:79], v[32:35]
    v_mfma_f32_16x16x32_bf16 v[36:39], v[84:87], v[76:79], v[36:39]
    v_mfma_f32_16x16x32_bf16 v[40:43], v[88:91], v[76:79], v[40:43]
    v_mfma_f32_16x16x32_bf16 v[44:47], v[92:95], v[76:79], v[44:47]
    s_waitcnt vmcnt(6)
    ds_write_b128 v8, v[96:99] offset:0
    ds_write_b128 v8, v[100:103] offset:4608
    ds_write_b128 v11, v[104:107] offset:0
    ds_write_b128 v11, v[108:111] offset:4608
    ds_write_b128 v11, v[112:115] offset:9216
    ds_write_b128 v11, v[116:119] offset:13824
    s_waitcnt lgkmcnt(0)
    s_barrier
    buffer_load_dwordx4 v[96:99], v7, s[40:43], s64 offen
    buffer_load_dwordx4 v[100:103], v7, s[40:43], s65 offen
    buffer_load_dwordx4 v[104:107], v10, s[60:63], s68 offen
    buffer_load_dwordx4 v[108:111], v10, s[60:63], s69 offen
    buffer_load_dwordx4 v[112:115], v10, s[60:63], s70 offen
    buffer_load_dwordx4 v[116:119], v10, s[60:63], s71 offen
    v_add_u32 v7, 128, v7
    v_add_u32 v10, 81920, v10
    ds_read_b64_tr_b16 v[56:57], v13 offset:0
    ds_read_b64_tr_b16 v[58:59], v13 offset:4608
    ds_read_b64_tr_b16 v[60:61], v13 offset:32
    ds_read_b64_tr_b16 v[62:63], v13 offset:4640
    ds_read_b64_tr_b16 v[64:65], v13 offset:64
    ds_read_b64_tr_b16 v[66:67], v13 offset:4672
    ds_read_b64_tr_b16 v[68:69], v13 offset:96
    ds_read_b64_tr_b16 v[70:71], v13 offset:4704
    ds_read_b64 v[48:49], v12 offset:0
    ds_read_b64 v[50:51], v12 offset:32
    ds_read_b64 v[52:53], v12 offset:2304
    ds_read_b64 v[54:55], v12 offset:2336
    s_waitcnt lgkmcnt(0)
    ds_read_b64_tr_b16 v[80:81], v13 offset:9216
    ds_read_b64_tr_b16 v[82:83], v13 offset:13824
    ds_read_b64_tr_b16 v[84:85], v13 offset:9248
    ds_read_b64_tr_b16 v[86:87], v13 offset:13856
    ds_read_b64_tr_b16 v[88:89], v13 offset:9280
    ds_read_b64_tr_b16 v[90:91], v13 offset:13888
    ds_read_b64_tr_b16 v[92:93], v13 offset:9312
    ds_read_b64_tr_b16 v[94:95], v13 offset:13920
    ds_read_b64 v[72:73], v12 offset:64
    ds_read_b64 v[74:75], v12 offset:96
    ds_read_b64 v[76:77], v12 offset:2368
    ds_read_b64 v[78:79], v12 offset:2400
    v_mfma_f32_16x16x32_bf16 v[16:19], v[56:59], v[48:51], v[16:19]
    v_mfma_f32_16x16x32_bf16 v[20:23], v[60:63], v[48:51], v[20:23]
    v_mfma_f32_16x16x32_bf16 v[24:27], v[64:67], v[48:51], v[24:27]
    v_mfma_f32_16x16x32_bf16 v[28:31], v[68:71], v[48:51], v[28:31]
    v_mfma_f32_16x16x32_bf16 v[32:35], v[56:59], v[52:55], v[32:35]
    v_mfma_f32_16x16x32_bf16 v[36:39], v[60:63], v[52:55], v[36:39]
    v_mfma_f32_16x16x32_bf16 v[40:43], v[64:67], v[52:55], v[40:43]
    v_mfma_f32_16x16x32_bf16 v[44:47], v[68:71], v[52:55], v[44:47]
    s_waitcnt lgkmcnt(0)
    v_mfma_f32_16x16x32_bf16 v[16:19], v[80:83], v[72:75], v[16:19]
    v_mfma_f32_16x16x32_bf16 v[20:23], v[84:87], v[72:75], v[20:23]
    v_mfma_f32_16x16x32_bf16 v[24:27], v[88:91], v[72:75], v[24:27]
    v_mfma_f32_16x16x32_bf16 v[28:31], v[92:95], v[72:75], v[28:31]
    v_mfma_f32_16x16x32_bf16 v[32:35], v[80:83], v[76:79], v[32:35]
    v_mfma_f32_16x16x32_bf16 v[36:39], v[84:87], v[76:79], v[36:39]
    v_mfma_f32_16x16x32_bf16 v[40:43], v[88:91], v[76:79], v[40:43]
    v_mfma_f32_16x16x32_bf16 v[44:47], v[92:95], v[76:79], v[44:47]
    s_waitcnt vmcnt(6)
    ds_write_b128 v8, v[120:123] offset:27648
    ds_write_b128 v8, v[124:127] offset:32256
    ds_write_b128 v11, v[128:131] offset:27648
    ds_write_b128 v11, v[132:135] offset:32256
    ds_write_b128 v11, v[136:139] offset:36864
    ds_write_b128 v11, v[140:143] offset:41472
    s_waitcnt lgkmcnt(0)
    s_barrier
    buffer_load_dwordx4 v[120:123], v7, s[40:43], s64 offen
    buffer_load_dwordx4 v[124:127], v7, s[40:43], s65 offen
    buffer_load_dwordx4 v[128:131], v10, s[60:63], s68 offen
    buffer_load_dwordx4 v[132:135], v10, s[60:63], s69 offen
    buffer_load_dwordx4 v[136:139], v10, s[60:63], s70 offen
    buffer_load_dwordx4 v[140:143], v10, s[60:63], s71 offen
    v_add_u32 v7, 128, v7
    v_add_u32 v10, 81920, v10
    ds_read_b64_tr_b16 v[56:57], v13 offset:27648
    ds_read_b64_tr_b16 v[58:59], v13 offset:32256
    ds_read_b64_tr_b16 v[60:61], v13 offset:27680
    ds_read_b64_tr_b16 v[62:63], v13 offset:32288
    ds_read_b64_tr_b16 v[64:65], v13 offset:27712
    ds_read_b64_tr_b16 v[66:67], v13 offset:32320
    ds_read_b64_tr_b16 v[68:69], v13 offset:27744
    ds_read_b64_tr_b16 v[70:71], v13 offset:32352
    ds_read_b64 v[48:49], v12 offset:27648
    ds_read_b64 v[50:51], v12 offset:27680
    ds_read_b64 v[52:53], v12 offset:29952
    ds_read_b64 v[54:55], v12 offset:29984
    s_waitcnt lgkmcnt(0)
    ds_read_b64_tr_b16 v[80:81], v13 offset:36864
    ds_read_b64_tr_b16 v[82:83], v13 offset:41472
    ds_read_b64_tr_b16 v[84:85], v13 offset:36896
    ds_read_b64_tr_b16 v[86:87], v13 offset:41504
    ds_read_b64_tr_b16 v[88:89], v13 offset:36928
    ds_read_b64_tr_b16 v[90:91], v13 offset:41536
    ds_read_b64_tr_b16 v[92:93], v13 offset:36960
    ds_read_b64_tr_b16 v[94:95], v13 offset:41568
    ds_read_b64 v[72:73], v12 offset:27712
    ds_read_b64 v[74:75], v12 offset:27744
    ds_read_b64 v[76:77], v12 offset:30016
    ds_read_b64 v[78:79], v12 offset:30048
    v_mfma_f32_16x16x32_bf16 v[16:19], v[56:59], v[48:51], v[16:19]
    v_mfma_f32_16x16x32_bf16 v[20:23], v[60:63], v[48:51], v[20:23]
    v_mfma_f32_16x16x32_bf16 v[24:27], v[64:67], v[48:51], v[24:27]
    v_mfma_f32_16x16x32_bf16 v[28:31], v[68:71], v[48:51], v[28:31]
    v_mfma_f32_16x16x32_bf16 v[32:35], v[56:59], v[52:55], v[32:35]
    v_mfma_f32_16x16x32_bf16 v[36:39], v[60:63], v[52:55], v[36:39]
    v_mfma_f32_16x16x32_bf16 v[40:43], v[64:67], v[52:55], v[40:43]
    v_mfma_f32_16x16x32_bf16 v[44:47], v[68:71], v[52:55], v[44:47]
    s_waitcnt lgkmcnt(0)
    v_mfma_f32_16x16x32_bf16 v[16:19], v[80:83], v[72:75], v[16:19]
    v_mfma_f32_16x16x32_bf16 v[20:23], v[84:87], v[72:75], v[20:23]
    v_mfma_f32_16x16x32_bf16 v[24:27], v[88:91], v[72:75], v[24:27]
    v_mfma_f32_16x16x32_bf16 v[28:31], v[92:95], v[72:75], v[28:31]
    v_mfma_f32_16x16x32_bf16 v[32:35], v[80:83], v[76:79], v[32:35]
    v_mfma_f32_16x16x32_bf16 v[36:39], v[84:87], v[76:79], v[36:39]
    v_mfma_f32_16x16x32_bf16 v[40:43], v[88:91], v[76:79], v[40:43]
    v_mfma_f32_16x16x32_bf16 v[44:47], v[92:95], v[76:79], v[44:47]
    s_waitcnt vmcnt(6)
    ds_write_b128 v8, v[96:99] offset:0
    ds_write_b128 v8, v[100:103] offset:4608
    ds_write_b128 v11, v[104:107] offset:0
    ds_write_b128 v11, v[108:111] offset:4608
    ds_write_b128 v11, v[112:115] offset:9216
    ds_write_b128 v11, v[116:119] offset:13824
    s_waitcnt lgkmcnt(0)
    s_barrier
    buffer_load_dwordx4 v[96:99], v7, s[40:43], s64 offen
    buffer_load_dwordx4 v[100:103], v7, s[40:43], s65 offen
    buffer_load_dwordx4 v[104:107], v10, s[60:63], s68 offen
    buffer_load_dwordx4 v[108:111], v10, s[60:63], s69 offen
    buffer_load_dwordx4 v[112:115], v10, s[60:63], s70 offen
    buffer_load_dwordx4 v[116:119], v10, s[60:63], s71 offen
    v_add_u32 v7, 128, v7
    v_add_u32 v10, 81920, v10
    ds_read_b64_tr_b16 v[56:57], v13 offset:0
    ds_read_b64_tr_b16 v[58:59], v13 offset:4608
    ds_read_b64_tr_b16 v[60:61], v13 offset:32
    ds_read_b64_tr_b16 v[62:63], v13 offset:4640
    ds_read_b64_tr_b16 v[64:65], v13 offset:64
    ds_read_b64_tr_b16 v[66:67], v13 offset:4672
    ds_read_b64_tr_b16 v[68:69], v13 offset:96
    ds_read_b64_tr_b16 v[70:71], v13 offset:4704
    ds_read_b64 v[48:49], v12 offset:0
    ds_read_b64 v[50:51], v12 offset:32
    ds_read_b64 v[52:53], v12 offset:2304
    ds_read_b64 v[54:55], v12 offset:2336
    s_waitcnt lgkmcnt(0)
    ds_read_b64_tr_b16 v[80:81], v13 offset:9216
    ds_read_b64_tr_b16 v[82:83], v13 offset:13824
    ds_read_b64_tr_b16 v[84:85], v13 offset:9248
    ds_read_b64_tr_b16 v[86:87], v13 offset:13856
    ds_read_b64_tr_b16 v[88:89], v13 offset:9280
    ds_read_b64_tr_b16 v[90:91], v13 offset:13888
    ds_read_b64_tr_b16 v[92:93], v13 offset:9312
    ds_read_b64_tr_b16 v[94:95], v13 offset:13920
    ds_read_b64 v[72:73], v12 offset:64
    ds_read_b64 v[74:75], v12 offset:96
    ds_read_b64 v[76:77], v12 offset:2368
    ds_read_b64 v[78:79], v12 offset:2400
    v_mfma_f32_16x16x32_bf16 v[16:19], v[56:59], v[48:51], v[16:19]
    v_mfma_f32_16x16x32_bf16 v[20:23], v[60:63], v[48:51], v[20:23]
    v_mfma_f32_16x16x32_bf16 v[24:27], v[64:67], v[48:51], v[24:27]
    v_mfma_f32_16x16x32_bf16 v[28:31], v[68:71], v[48:51], v[28:31]
    v_mfma_f32_16x16x32_bf16 v[32:35], v[56:59], v[52:55], v[32:35]
    v_mfma_f32_16x16x32_bf16 v[36:39], v[60:63], v[52:55], v[36:39]
    v_mfma_f32_16x16x32_bf16 v[40:43], v[64:67], v[52:55], v[40:43]
    v_mfma_f32_16x16x32_bf16 v[44:47], v[68:71], v[52:55], v[44:47]
    s_waitcnt lgkmcnt(0)
    v_mfma_f32_16x16x32_bf16 v[16:19], v[80:83], v[72:75], v[16:19]
    v_mfma_f32_16x16x32_bf16 v[20:23], v[84:87], v[72:75], v[20:23]
    v_mfma_f32_16x16x32_bf16 v[24:27], v[88:91], v[72:75], v[24:27]
    v_mfma_f32_16x16x32_bf16 v[28:31], v[92:95], v[72:75], v[28:31]
    v_mfma_f32_16x16x32_bf16 v[32:35], v[80:83], v[76:79], v[32:35]
    v_mfma_f32_16x16x32_bf16 v[36:39], v[84:87], v[76:79], v[36:39]
    v_mfma_f32_16x16x32_bf16 v[40:43], v[88:91], v[76:79], v[40:43]
    v_mfma_f32_16x16x32_bf16 v[44:47], v[92:95], v[76:79], v[44:47]
    s_waitcnt vmcnt(6)
    ds_write_b128 v8, v[120:123] offset:27648
    ds_write_b128 v8, v[124:127] offset:32256
    ds_write_b128 v11, v[128:131] offset:27648
    ds_write_b128 v11, v[132:135] offset:32256
    ds_write_b128 v11, v[136:139] offset:36864
    ds_write_b128 v11, v[140:143] offset:41472
    s_waitcnt lgkmcnt(0)
    s_barrier
    buffer_load_dwordx4 v[120:123], v7, s[40:43], s64 offen
    buffer_load_dwordx4 v[124:127], v7, s[40:43], s65 offen
    buffer_load_dwordx4 v[128:131], v10, s[60:63], s68 offen
    buffer_load_dwordx4 v[132:135], v10, s[60:63], s69 offen
    buffer_load_dwordx4 v[136:139], v10, s[60:63], s70 offen
    buffer_load_dwordx4 v[140:143], v10, s[60:63], s71 offen
    v_add_u32 v7, 128, v7
    v_add_u32 v10, 81920, v10
    ds_read_b64_tr_b16 v[56:57], v13 offset:27648
    ds_read_b64_tr_b16 v[58:59], v13 offset:32256
    ds_read_b64_tr_b16 v[60:61], v13 offset:27680
    ds_read_b64_tr_b16 v[62:63], v13 offset:32288
    ds_read_b64_tr_b16 v[64:65], v13 offset:27712
    ds_read_b64_tr_b16 v[66:67], v13 offset:32320
    ds_read_b64_tr_b16 v[68:69], v13 offset:27744
    ds_read_b64_tr_b16 v[70:71], v13 offset:32352
    ds_read_b64 v[48:49], v12 offset:27648
    ds_read_b64 v[50:51], v12 offset:27680
    ds_read_b64 v[52:53], v12 offset:29952
    ds_read_b64 v[54:55], v12 offset:29984
    s_waitcnt lgkmcnt(0)
    ds_read_b64_tr_b16 v[80:81], v13 offset:36864
    ds_read_b64_tr_b16 v[82:83], v13 offset:41472
    ds_read_b64_tr_b16 v[84:85], v13 offset:36896
    ds_read_b64_tr_b16 v[86:87], v13 offset:41504
    ds_read_b64_tr_b16 v[88:89], v13 offset:36928
    ds_read_b64_tr_b16 v[90:91], v13 offset:41536
    ds_read_b64_tr_b16 v[92:93], v13 offset:36960
    ds_read_b64_tr_b16 v[94:95], v13 offset:41568
    ds_read_b64 v[72:73], v12 offset:27712
    ds_read_b64 v[74:75], v12 offset:27744
    ds_read_b64 v[76:77], v12 offset:30016
    ds_read_b64 v[78:79], v12 offset:30048
    v_mfma_f32_16x16x32_bf16 v[16:19], v[56:59], v[48:51], v[16:19]
    v_mfma_f32_16x16x32_bf16 v[20:23], v[60:63], v[48:51], v[20:23]
    v_mfma_f32_16x16x32_bf16 v[24:27], v[64:67], v[48:51], v[24:27]
    v_mfma_f32_16x16x32_bf16 v[28:31], v[68:71], v[48:51], v[28:31]
    v_mfma_f32_16x16x32_bf16 v[32:35], v[56:59], v[52:55], v[32:35]
    v_mfma_f32_16x16x32_bf16 v[36:39], v[60:63], v[52:55], v[36:39]
    v_mfma_f32_16x16x32_bf16 v[40:43], v[64:67], v[52:55], v[40:43]
    v_mfma_f32_16x16x32_bf16 v[44:47], v[68:71], v[52:55], v[44:47]
    s_waitcnt lgkmcnt(0)
    v_mfma_f32_16x16x32_bf16 v[16:19], v[80:83], v[72:75], v[16:19]
    v_mfma_f32_16x16x32_bf16 v[20:23], v[84:87], v[72:75], v[20:23]
    v_mfma_f32_16x16x32_bf16 v[24:27], v[88:91], v[72:75], v[24:27]
    v_mfma_f32_16x16x32_bf16 v[28:31], v[92:95], v[72:75], v[28:31]
    v_mfma_f32_16x16x32_bf16 v[32:35], v[80:83], v[76:79], v[32:35]
    v_mfma_f32_16x16x32_bf16 v[36:39], v[84:87], v[76:79], v[36:39]
    v_mfma_f32_16x16x32_bf16 v[40:43], v[88:91], v[76:79], v[40:43]
    v_mfma_f32_16x16x32_bf16 v[44:47], v[92:95], v[76:79], v[44:47]
    s_waitcnt vmcnt(6)
    ds_write_b128 v8, v[96:99] offset:0
    ds_write_b128 v8, v[100:103] offset:4608
    ds_write_b128 v11, v[104:107] offset:0
    ds_write_b128 v11, v[108:111] offset:4608
    ds_write_b128 v11, v[112:115] offset:9216
    ds_write_b128 v11, v[116:119] offset:13824
    s_waitcnt lgkmcnt(0)
    s_barrier
    buffer_load_dwordx4 v[96:99], v7, s[40:43], s64 offen
    buffer_load_dwordx4 v[100:103], v7, s[40:43], s65 offen
    buffer_load_dwordx4 v[104:107], v10, s[60:63], s68 offen
    buffer_load_dwordx4 v[108:111], v10, s[60:63], s69 offen
    buffer_load_dwordx4 v[112:115], v10, s[60:63], s70 offen
    buffer_load_dwordx4 v[116:119], v10, s[60:63], s71 offen
    v_add_u32 v7, 128, v7
    v_add_u32 v10, 81920, v10
    ds_read_b64_tr_b16 v[56:57], v13 offset:0
    ds_read_b64_tr_b16 v[58:59], v13 offset:4608
    ds_read_b64_tr_b16 v[60:61], v13 offset:32
    ds_read_b64_tr_b16 v[62:63], v13 offset:4640
    ds_read_b64_tr_b16 v[64:65], v13 offset:64
    ds_read_b64_tr_b16 v[66:67], v13 offset:4672
    ds_read_b64_tr_b16 v[68:69], v13 offset:96
    ds_read_b64_tr_b16 v[70:71], v13 offset:4704
    ds_read_b64 v[48:49], v12 offset:0
    ds_read_b64 v[50:51], v12 offset:32
    ds_read_b64 v[52:53], v12 offset:2304
    ds_read_b64 v[54:55], v12 offset:2336
    s_waitcnt lgkmcnt(0)
    ds_read_b64_tr_b16 v[80:81], v13 offset:9216
    ds_read_b64_tr_b16 v[82:83], v13 offset:13824
    ds_read_b64_tr_b16 v[84:85], v13 offset:9248
    ds_read_b64_tr_b16 v[86:87], v13 offset:13856
    ds_read_b64_tr_b16 v[88:89], v13 offset:9280
    ds_read_b64_tr_b16 v[90:91], v13 offset:13888
    ds_read_b64_tr_b16 v[92:93], v13 offset:9312
    ds_read_b64_tr_b16 v[94:95], v13 offset:13920
    ds_read_b64 v[72:73], v12 offset:64
    ds_read_b64 v[74:75], v12 offset:96
    ds_read_b64 v[76:77], v12 offset:2368
    ds_read_b64 v[78:79], v12 offset:2400
    v_mfma_f32_16x16x32_bf16 v[16:19], v[56:59], v[48:51], v[16:19]
    v_mfma_f32_16x16x32_bf16 v[20:23], v[60:63], v[48:51], v[20:23]
    v_mfma_f32_16x16x32_bf16 v[24:27], v[64:67], v[48:51], v[24:27]
    v_mfma_f32_16x16x32_bf16 v[28:31], v[68:71], v[48:51], v[28:31]
    v_mfma_f32_16x16x32_bf16 v[32:35], v[56:59], v[52:55], v[32:35]
    v_mfma_f32_16x16x32_bf16 v[36:39], v[60:63], v[52:55], v[36:39]
    v_mfma_f32_16x16x32_bf16 v[40:43], v[64:67], v[52:55], v[40:43]
    v_mfma_f32_16x16x32_bf16 v[44:47], v[68:71], v[52:55], v[44:47]
    s_waitcnt lgkmcnt(0)
    v_mfma_f32_16x16x32_bf16 v[16:19], v[80:83], v[72:75], v[16:19]
    v_mfma_f32_16x16x32_bf16 v[20:23], v[84:87], v[72:75], v[20:23]
    v_mfma_f32_16x16x32_bf16 v[24:27], v[88:91], v[72:75], v[24:27]
    v_mfma_f32_16x16x32_bf16 v[28:31], v[92:95], v[72:75], v[28:31]
    v_mfma_f32_16x16x32_bf16 v[32:35], v[80:83], v[76:79], v[32:35]
    v_mfma_f32_16x16x32_bf16 v[36:39], v[84:87], v[76:79], v[36:39]
    v_mfma_f32_16x16x32_bf16 v[40:43], v[88:91], v[76:79], v[40:43]
    v_mfma_f32_16x16x32_bf16 v[44:47], v[92:95], v[76:79], v[44:47]
    s_waitcnt vmcnt(6)
    ds_write_b128 v8, v[120:123] offset:27648
    ds_write_b128 v8, v[124:127] offset:32256
    ds_write_b128 v11, v[128:131] offset:27648
    ds_write_b128 v11, v[132:135] offset:32256
    ds_write_b128 v11, v[136:139] offset:36864
    ds_write_b128 v11, v[140:143] offset:41472
    s_waitcnt lgkmcnt(0)
    s_barrier
    buffer_load_dwordx4 v[120:123], v7, s[40:43], s64 offen
    buffer_load_dwordx4 v[124:127], v7, s[40:43], s65 offen
    buffer_load_dwordx4 v[128:131], v10, s[60:63], s68 offen
    buffer_load_dwordx4 v[132:135], v10, s[60:63], s69 offen
    buffer_load_dwordx4 v[136:139], v10, s[60:63], s70 offen
    buffer_load_dwordx4 v[140:143], v10, s[60:63], s71 offen
    v_add_u32 v7, 128, v7
    v_add_u32 v10, 81920, v10
    ds_read_b64_tr_b16 v[56:57], v13 offset:27648
    ds_read_b64_tr_b16 v[58:59], v13 offset:32256
    ds_read_b64_tr_b16 v[60:61], v13 offset:27680
    ds_read_b64_tr_b16 v[62:63], v13 offset:32288
    ds_read_b64_tr_b16 v[64:65], v13 offset:27712
    ds_read_b64_tr_b16 v[66:67], v13 offset:32320
    ds_read_b64_tr_b16 v[68:69], v13 offset:27744
    ds_read_b64_tr_b16 v[70:71], v13 offset:32352
    ds_read_b64 v[48:49], v12 offset:27648
    ds_read_b64 v[50:51], v12 offset:27680
    ds_read_b64 v[52:53], v12 offset:29952
    ds_read_b64 v[54:55], v12 offset:29984
    s_waitcnt lgkmcnt(0)
    ds_read_b64_tr_b16 v[80:81], v13 offset:36864
    ds_read_b64_tr_b16 v[82:83], v13 offset:41472
    ds_read_b64_tr_b16 v[84:85], v13 offset:36896
    ds_read_b64_tr_b16 v[86:87], v13 offset:41504
    ds_read_b64_tr_b16 v[88:89], v13 offset:36928
    ds_read_b64_tr_b16 v[90:91], v13 offset:41536
    ds_read_b64_tr_b16 v[92:93], v13 offset:36960
    ds_read_b64_tr_b16 v[94:95], v13 offset:41568
    ds_read_b64 v[72:73], v12 offset:27712
    ds_read_b64 v[74:75], v12 offset:27744
    ds_read_b64 v[76:77], v12 offset:30016
    ds_read_b64 v[78:79], v12 offset:30048
    v_mfma_f32_16x16x32_bf16 v[16:19], v[56:59], v[48:51], v[16:19]
    v_mfma_f32_16x16x32_bf16 v[20:23], v[60:63], v[48:51], v[20:23]
    v_mfma_f32_16x16x32_bf16 v[24:27], v[64:67], v[48:51], v[24:27]
    v_mfma_f32_16x16x32_bf16 v[28:31], v[68:71], v[48:51], v[28:31]
    v_mfma_f32_16x16x32_bf16 v[32:35], v[56:59], v[52:55], v[32:35]
    v_mfma_f32_16x16x32_bf16 v[36:39], v[60:63], v[52:55], v[36:39]
    v_mfma_f32_16x16x32_bf16 v[40:43], v[64:67], v[52:55], v[40:43]
    v_mfma_f32_16x16x32_bf16 v[44:47], v[68:71], v[52:55], v[44:47]
    s_waitcnt lgkmcnt(0)
    v_mfma_f32_16x16x32_bf16 v[16:19], v[80:83], v[72:75], v[16:19]
    v_mfma_f32_16x16x32_bf16 v[20:23], v[84:87], v[72:75], v[20:23]
    v_mfma_f32_16x16x32_bf16 v[24:27], v[88:91], v[72:75], v[24:27]
    v_mfma_f32_16x16x32_bf16 v[28:31], v[92:95], v[72:75], v[28:31]
    v_mfma_f32_16x16x32_bf16 v[32:35], v[80:83], v[76:79], v[32:35]
    v_mfma_f32_16x16x32_bf16 v[36:39], v[84:87], v[76:79], v[36:39]
    v_mfma_f32_16x16x32_bf16 v[40:43], v[88:91], v[76:79], v[40:43]
    v_mfma_f32_16x16x32_bf16 v[44:47], v[92:95], v[76:79], v[44:47]
    s_waitcnt vmcnt(6)
    ds_write_b128 v8, v[96:99] offset:0
    ds_write_b128 v8, v[100:103] offset:4608
    ds_write_b128 v11, v[104:107] offset:0
    ds_write_b128 v11, v[108:111] offset:4608
    ds_write_b128 v11, v[112:115] offset:9216
    ds_write_b128 v11, v[116:119] offset:13824
    s_waitcnt lgkmcnt(0)
    s_barrier
    buffer_load_dwordx4 v[96:99], v7, s[40:43], s64 offen
    buffer_load_dwordx4 v[100:103], v7, s[40:43], s65 offen
    buffer_load_dwordx4 v[104:107], v10, s[60:63], s68 offen
    buffer_load_dwordx4 v[108:111], v10, s[60:63], s69 offen
    buffer_load_dwordx4 v[112:115], v10, s[60:63], s70 offen
    buffer_load_dwordx4 v[116:119], v10, s[60:63], s71 offen
    v_add_u32 v7, 128, v7
    v_add_u32 v10, 81920, v10
    ds_read_b64_tr_b16 v[56:57], v13 offset:0
    ds_read_b64_tr_b16 v[58:59], v13 offset:4608
    ds_read_b64_tr_b16 v[60:61], v13 offset:32
    ds_read_b64_tr_b16 v[62:63], v13 offset:4640
    ds_read_b64_tr_b16 v[64:65], v13 offset:64
    ds_read_b64_tr_b16 v[66:67], v13 offset:4672
    ds_read_b64_tr_b16 v[68:69], v13 offset:96
    ds_read_b64_tr_b16 v[70:71], v13 offset:4704
    ds_read_b64 v[48:49], v12 offset:0
    ds_read_b64 v[50:51], v12 offset:32
    ds_read_b64 v[52:53], v12 offset:2304
    ds_read_b64 v[54:55], v12 offset:2336
    s_waitcnt lgkmcnt(0)
    ds_read_b64_tr_b16 v[80:81], v13 offset:9216
    ds_read_b64_tr_b16 v[82:83], v13 offset:13824
    ds_read_b64_tr_b16 v[84:85], v13 offset:9248
    ds_read_b64_tr_b16 v[86:87], v13 offset:13856
    ds_read_b64_tr_b16 v[88:89], v13 offset:9280
    ds_read_b64_tr_b16 v[90:91], v13 offset:13888
    ds_read_b64_tr_b16 v[92:93], v13 offset:9312
    ds_read_b64_tr_b16 v[94:95], v13 offset:13920
    ds_read_b64 v[72:73], v12 offset:64
    ds_read_b64 v[74:75], v12 offset:96
    ds_read_b64 v[76:77], v12 offset:2368
    ds_read_b64 v[78:79], v12 offset:2400
    v_mfma_f32_16x16x32_bf16 v[16:19], v[56:59], v[48:51], v[16:19]
    v_mfma_f32_16x16x32_bf16 v[20:23], v[60:63], v[48:51], v[20:23]
    v_mfma_f32_16x16x32_bf16 v[24:27], v[64:67], v[48:51], v[24:27]
    v_mfma_f32_16x16x32_bf16 v[28:31], v[68:71], v[48:51], v[28:31]
    v_mfma_f32_16x16x32_bf16 v[32:35], v[56:59], v[52:55], v[32:35]
    v_mfma_f32_16x16x32_bf16 v[36:39], v[60:63], v[52:55], v[36:39]
    v_mfma_f32_16x16x32_bf16 v[40:43], v[64:67], v[52:55], v[40:43]
    v_mfma_f32_16x16x32_bf16 v[44:47], v[68:71], v[52:55], v[44:47]
    s_waitcnt lgkmcnt(0)
    v_mfma_f32_16x16x32_bf16 v[16:19], v[80:83], v[72:75], v[16:19]
    v_mfma_f32_16x16x32_bf16 v[20:23], v[84:87], v[72:75], v[20:23]
    v_mfma_f32_16x16x32_bf16 v[24:27], v[88:91], v[72:75], v[24:27]
    v_mfma_f32_16x16x32_bf16 v[28:31], v[92:95], v[72:75], v[28:31]
    v_mfma_f32_16x16x32_bf16 v[32:35], v[80:83], v[76:79], v[32:35]
    v_mfma_f32_16x16x32_bf16 v[36:39], v[84:87], v[76:79], v[36:39]
    v_mfma_f32_16x16x32_bf16 v[40:43], v[88:91], v[76:79], v[40:43]
    v_mfma_f32_16x16x32_bf16 v[44:47], v[92:95], v[76:79], v[44:47]
    s_waitcnt vmcnt(6)
    ds_write_b128 v8, v[120:123] offset:27648
    ds_write_b128 v8, v[124:127] offset:32256
    ds_write_b128 v11, v[128:131] offset:27648
    ds_write_b128 v11, v[132:135] offset:32256
    ds_write_b128 v11, v[136:139] offset:36864
    ds_write_b128 v11, v[140:143] offset:41472
    s_waitcnt lgkmcnt(0)
    s_barrier
    ds_read_b64_tr_b16 v[56:57], v13 offset:27648
    ds_read_b64_tr_b16 v[58:59], v13 offset:32256
    ds_read_b64_tr_b16 v[60:61], v13 offset:27680
    ds_read_b64_tr_b16 v[62:63], v13 offset:32288
    ds_read_b64_tr_b16 v[64:65], v13 offset:27712
    ds_read_b64_tr_b16 v[66:67], v13 offset:32320
    ds_read_b64_tr_b16 v[68:69], v13 offset:27744
    ds_read_b64_tr_b16 v[70:71], v13 offset:32352
    ds_read_b64 v[48:49], v12 offset:27648
    ds_read_b64 v[50:51], v12 offset:27680
    ds_read_b64 v[52:53], v12 offset:29952
    ds_read_b64 v[54:55], v12 offset:29984
    s_waitcnt lgkmcnt(0)
    ds_read_b64_tr_b16 v[80:81], v13 offset:36864
    ds_read_b64_tr_b16 v[82:83], v13 offset:41472
    ds_read_b64_tr_b16 v[84:85], v13 offset:36896
    ds_read_b64_tr_b16 v[86:87], v13 offset:41504
    ds_read_b64_tr_b16 v[88:89], v13 offset:36928
    ds_read_b64_tr_b16 v[90:91], v13 offset:41536
    ds_read_b64_tr_b16 v[92:93], v13 offset:36960
    ds_read_b64_tr_b16 v[94:95], v13 offset:41568
    ds_read_b64 v[72:73], v12 offset:27712
    ds_read_b64 v[74:75], v12 offset:27744
    ds_read_b64 v[76:77], v12 offset:30016
    ds_read_b64 v[78:79], v12 offset:30048
    v_mfma_f32_16x16x32_bf16 v[16:19], v[56:59], v[48:51], v[16:19]
    v_mfma_f32_16x16x32_bf16 v[20:23], v[60:63], v[48:51], v[20:23]
    v_mfma_f32_16x16x32_bf16 v[24:27], v[64:67], v[48:51], v[24:27]
    v_mfma_f32_16x16x32_bf16 v[28:31], v[68:71], v[48:51], v[28:31]
    v_mfma_f32_16x16x32_bf16 v[32:35], v[56:59], v[52:55], v[32:35]
    v_mfma_f32_16x16x32_bf16 v[36:39], v[60:63], v[52:55], v[36:39]
    v_mfma_f32_16x16x32_bf16 v[40:43], v[64:67], v[52:55], v[40:43]
    v_mfma_f32_16x16x32_bf16 v[44:47], v[68:71], v[52:55], v[44:47]
    s_waitcnt lgkmcnt(0)
    v_mfma_f32_16x16x32_bf16 v[16:19], v[80:83], v[72:75], v[16:19]
    v_mfma_f32_16x16x32_bf16 v[20:23], v[84:87], v[72:75], v[20:23]
    v_mfma_f32_16x16x32_bf16 v[24:27], v[88:91], v[72:75], v[24:27]
    v_mfma_f32_16x16x32_bf16 v[28:31], v[92:95], v[72:75], v[28:31]
    v_mfma_f32_16x16x32_bf16 v[32:35], v[80:83], v[76:79], v[32:35]
    v_mfma_f32_16x16x32_bf16 v[36:39], v[84:87], v[76:79], v[36:39]
    v_mfma_f32_16x16x32_bf16 v[40:43], v[88:91], v[76:79], v[40:43]
    v_mfma_f32_16x16x32_bf16 v[44:47], v[92:95], v[76:79], v[44:47]
    s_waitcnt vmcnt(0)
    ds_write_b128 v8, v[96:99] offset:0
    ds_write_b128 v8, v[100:103] offset:4608
    ds_write_b128 v11, v[104:107] offset:0
    ds_write_b128 v11, v[108:111] offset:4608
    ds_write_b128 v11, v[112:115] offset:9216
    ds_write_b128 v11, v[116:119] offset:13824
    s_waitcnt lgkmcnt(0)
    s_barrier
    ds_read_b64_tr_b16 v[56:57], v13 offset:0
    ds_read_b64_tr_b16 v[58:59], v13 offset:4608
    ds_read_b64_tr_b16 v[60:61], v13 offset:32
    ds_read_b64_tr_b16 v[62:63], v13 offset:4640
    ds_read_b64_tr_b16 v[64:65], v13 offset:64
    ds_read_b64_tr_b16 v[66:67], v13 offset:4672
    ds_read_b64_tr_b16 v[68:69], v13 offset:96
    ds_read_b64_tr_b16 v[70:71], v13 offset:4704
    ds_read_b64 v[48:49], v12 offset:0
    ds_read_b64 v[50:51], v12 offset:32
    ds_read_b64 v[52:53], v12 offset:2304
    ds_read_b64 v[54:55], v12 offset:2336
    s_waitcnt lgkmcnt(0)
    ds_read_b64_tr_b16 v[80:81], v13 offset:9216
    ds_read_b64_tr_b16 v[82:83], v13 offset:13824
    ds_read_b64_tr_b16 v[84:85], v13 offset:9248
    ds_read_b64_tr_b16 v[86:87], v13 offset:13856
    ds_read_b64_tr_b16 v[88:89], v13 offset:9280
    ds_read_b64_tr_b16 v[90:91], v13 offset:13888
    ds_read_b64_tr_b16 v[92:93], v13 offset:9312
    ds_read_b64_tr_b16 v[94:95], v13 offset:13920
    ds_read_b64 v[72:73], v12 offset:64
    ds_read_b64 v[74:75], v12 offset:96
    ds_read_b64 v[76:77], v12 offset:2368
    ds_read_b64 v[78:79], v12 offset:2400
    v_mfma_f32_16x16x32_bf16 v[16:19], v[56:59], v[48:51], v[16:19]
    v_mfma_f32_16x16x32_bf16 v[20:23], v[60:63], v[48:51], v[20:23]
    v_mfma_f32_16x16x32_bf16 v[24:27], v[64:67], v[48:51], v[24:27]
    v_mfma_f32_16x16x32_bf16 v[28:31], v[68:71], v[48:51], v[28:31]
    v_mfma_f32_16x16x32_bf16 v[32:35], v[56:59], v[52:55], v[32:35]
    v_mfma_f32_16x16x32_bf16 v[36:39], v[60:63], v[52:55], v[36:39]
    v_mfma_f32_16x16x32_bf16 v[40:43], v[64:67], v[52:55], v[40:43]
    v_mfma_f32_16x16x32_bf16 v[44:47], v[68:71], v[52:55], v[44:47]
    s_waitcnt lgkmcnt(0)
    v_mfma_f32_16x16x32_bf16 v[16:19], v[80:83], v[72:75], v[16:19]
    v_mfma_f32_16x16x32_bf16 v[20:23], v[84:87], v[72:75], v[20:23]
    v_mfma_f32_16x16x32_bf16 v[24:27], v[88:91], v[72:75], v[24:27]
    v_mfma_f32_16x16x32_bf16 v[28:31], v[92:95], v[72:75], v[28:31]
    v_mfma_f32_16x16x32_bf16 v[32:35], v[80:83], v[76:79], v[32:35]
    v_mfma_f32_16x16x32_bf16 v[36:39], v[84:87], v[76:79], v[36:39]
    v_mfma_f32_16x16x32_bf16 v[40:43], v[88:91], v[76:79], v[40:43]
    v_mfma_f32_16x16x32_bf16 v[44:47], v[92:95], v[76:79], v[44:47]
    s_nop 7
    s_nop 7
    s_mul_i32 s7, s4, 64
    s_mul_i32 s12, s10, 32
    s_add_u32 s7, s7, s12
    v_add_u32 v5, s7, v3
    v_mul_u32_u24 v5, 1280, v5
    s_lshl_b32 s12, s5, 8
    s_lshl_b32 s13, s11, 7
    s_add_u32 s12, s12, s13
    v_lshl_add_u32 v5, v4, 3, v5
    v_add_u32 v5, s12, v5
    buffer_load_dwordx2 v[96:97], v5, s[56:59], 0 offen offset:0
    buffer_load_dwordx2 v[98:99], v5, s[56:59], 0 offen offset:32
    buffer_load_dwordx2 v[100:101], v5, s[56:59], 0 offen offset:64
    buffer_load_dwordx2 v[102:103], v5, s[56:59], 0 offen offset:96
    s_waitcnt vmcnt(0)
    v_lshlrev_b32 v104, 16, v96
    v_and_b32 v105, 0xffff0000, v96
    v_add_f32 v16, v16, v104
    v_add_f32 v17, v17, v105
    v_lshlrev_b32 v104, 16, v97
    v_and_b32 v105, 0xffff0000, v97
    v_add_f32 v18, v18, v104
    v_add_f32 v19, v19, v105
    v_cvt_pk_bf16_f32 v106, v16, v17
    v_cvt_pk_bf16_f32 v107, v18, v19
    buffer_store_dwordx2 v[106:107], v5, s[52:55], 0 offen offset:0
    s_nop 1
    v_lshlrev_b32 v104, 16, v98
    v_and_b32 v105, 0xffff0000, v98
    v_add_f32 v20, v20, v104
    v_add_f32 v21, v21, v105
    v_lshlrev_b32 v104, 16, v99
    v_and_b32 v105, 0xffff0000, v99
    v_add_f32 v22, v22, v104
    v_add_f32 v23, v23, v105
    v_cvt_pk_bf16_f32 v106, v20, v21
    v_cvt_pk_bf16_f32 v107, v22, v23
    buffer_store_dwordx2 v[106:107], v5, s[52:55], 0 offen offset:32
    s_nop 1
    v_lshlrev_b32 v104, 16, v100
    v_and_b32 v105, 0xffff0000, v100
    v_add_f32 v24, v24, v104
    v_add_f32 v25, v25, v105
    v_lshlrev_b32 v104, 16, v101
    v_and_b32 v105, 0xffff0000, v101
    v_add_f32 v26, v26, v104
    v_add_f32 v27, v27, v105
    v_cvt_pk_bf16_f32 v106, v24, v25
    v_cvt_pk_bf16_f32 v107, v26, v27
    buffer_store_dwordx2 v[106:107], v5, s[52:55], 0 offen offset:64
    s_nop 1
    v_lshlrev_b32 v104, 16, v102
    v_and_b32 v105, 0xffff0000, v102
    v_add_f32 v28, v28, v104
    v_add_f32 v29, v29, v105
    v_lshlrev_b32 v104, 16, v103
    v_and_b32 v105, 0xffff0000, v103
    v_add_f32 v30, v30, v104
    v_add_f32 v31, v31, v105
    v_cvt_pk_bf16_f32 v106, v28, v29
    v_cvt_pk_bf16_f32 v107, v30, v31
    buffer_store_dwordx2 v[106:107], v5, s[52:55], 0 offen offset:96
    s_nop 1
    v_add_u32 v5, 20480, v5
    buffer_load_dwordx2 v[96:97], v5, s[56:59], 0 offen offset:0
    buffer_load_dwordx2 v[98:99], v5, s[56:59], 0 offen offset:32
    buffer_load_dwordx2 v[100:101], v5, s[56:59], 0 offen offset:64
    buffer_load_dwordx2 v[102:103], v5, s[56:59], 0 offen offset:96
    s_waitcnt vmcnt(0)
    v_lshlrev_b32 v104, 16, v96
    v_and_b32 v105, 0xffff0000, v96
    v_add_f32 v32, v32, v104
    v_add_f32 v33, v33, v105
    v_lshlrev_b32 v104, 16, v97
    v_and_b32 v105, 0xffff0000, v97
    v_add_f32 v34, v34, v104
    v_add_f32 v35, v35, v105
    v_cvt_pk_bf16_f32 v106, v32, v33
    v_cvt_pk_bf16_f32 v107, v34, v35
    buffer_store_dwordx2 v[106:107], v5, s[52:55], 0 offen offset:0
    s_nop 1
    v_lshlrev_b32 v104, 16, v98
    v_and_b32 v105, 0xffff0000, v98
    v_add_f32 v36, v36, v104
    v_add_f32 v37, v37, v105
    v_lshlrev_b32 v104, 16, v99
    v_and_b32 v105, 0xffff0000, v99
    v_add_f32 v38, v38, v104
    v_add_f32 v39, v39, v105
    v_cvt_pk_bf16_f32 v106, v36, v37
    v_cvt_pk_bf16_f32 v107, v38, v39
    buffer_store_dwordx2 v[106:107], v5, s[52:55], 0 offen offset:32
    s_nop 1
    v_lshlrev_b32 v104, 16, v100
    v_and_b32 v105, 0xffff0000, v100
    v_add_f32 v40, v40, v104
    v_add_f32 v41, v41, v105
    v_lshlrev_b32 v104, 16, v101
    v_and_b32 v105, 0xffff0000, v101
    v_add_f32 v42, v42, v104
    v_add_f32 v43, v43, v105
    v_cvt_pk_bf16_f32 v106, v40, v41
    v_cvt_pk_bf16_f32 v107, v42, v43
    buffer_store_dwordx2 v[106:107], v5, s[52:55], 0 offen offset:64
    s_nop 1
    v_lshlrev_b32 v104, 16, v102
    v_and_b32 v105, 0xffff0000, v102
    v_add_f32 v44, v44, v104
    v_add_f32 v45, v45, v105
    v_lshlrev_b32 v104, 16, v103
    v_and_b32 v105, 0xffff0000, v103
    v_add_f32 v46, v46, v104
    v_add_f32 v47, v47, v105
    v_cvt_pk_bf16_f32 v106, v44, v45
    v_cvt_pk_bf16_f32 v107, v46, v47
    buffer_store_dwordx2 v[106:107], v5, s[52:55], 0 offen offset:96
    s_nop 1
down_0_kernel_end:
    s_endpgm
.globl ln1_1_kernel
.p2align 8
.type ln1_1_kernel,@function
ln1_1_kernel:
    s_cmp_ge_u32 s2, 512
    s_cbranch_scc1 ln1_1_kernel_end
    s_load_dwordx16 s[16:31], s[0:1], 0
    s_load_dwordx4 s[32:35], s[0:1], 64
    s_load_dwordx2 s[36:37], s[0:1], 80
    s_waitcnt lgkmcnt(0)
    s_add_u32 s40, s36, 0x2000000
    s_addc_u32 s41, s37, 0
    s_mov_b32 s42, 0x280000
    s_mov_b32 s43, 0x00020000
    s_mov_b32 s44, s36
    s_mov_b32 s45, s37
    s_mov_b32 s46, 0x280000
    s_mov_b32 s47, 0x00020000
    v_lshrrev_b32 v1, 6, v0
    v_and_b32 v2, 63, v0
    s_lshl_b32 s3, s2, 2
    v_add_u32 v1, s3, v1
    v_mul_u32_u24 v3, 1280, v1
    v_mul_u32_u24 v4, 20, v2
    v_add_u32 v3, v3, v4
    buffer_load_dwordx4 v[8:11], v3, s[40:43], 0 offen
    buffer_load_dword v12, v3, s[40:43], 0 offen offset:16
    s_waitcnt vmcnt(0)
    v_lshlrev_b32 v16, 16, v8
    v_and_b32 v17, 0xffff0000, v8
    v_lshlrev_b32 v18, 16, v9
    v_and_b32 v19, 0xffff0000, v9
    v_lshlrev_b32 v20, 16, v10
    v_and_b32 v21, 0xffff0000, v10
    v_lshlrev_b32 v22, 16, v11
    v_and_b32 v23, 0xffff0000, v11
    v_lshlrev_b32 v24, 16, v12
    v_and_b32 v25, 0xffff0000, v12
    v_add_f32 v30, v16, v17
    v_add_f32 v30, v30, v18
    v_add_f32 v30, v30, v19
    v_add_f32 v30, v30, v20
    v_add_f32 v30, v30, v21
    v_add_f32 v30, v30, v22
    v_add_f32 v30, v30, v23
    v_add_f32 v30, v30, v24
    v_add_f32 v30, v30, v25
    ds_swizzle_b32 v31, v30 offset:0x41f
    s_waitcnt lgkmcnt(0)
    v_add_f32 v30, v30, v31
    ds_swizzle_b32 v31, v30 offset:0x81f
    s_waitcnt lgkmcnt(0)
    v_add_f32 v30, v30, v31
    ds_swizzle_b32 v31, v30 offset:0x101f
    s_waitcnt lgkmcnt(0)
    v_add_f32 v30, v30, v31
    ds_swizzle_b32 v31, v30 offset:0x201f
    s_waitcnt lgkmcnt(0)
    v_add_f32 v30, v30, v31
    ds_swizzle_b32 v31, v30 offset:0x401f
    s_waitcnt lgkmcnt(0)
    v_add_f32 v30, v30, v31
    s_nop 1
    v_readlane_b32 s4, v30, 0
    v_readlane_b32 s5, v30, 32
    s_nop 1
    v_mov_b32 v30, s4
    v_add_f32 v30, s5, v30
    v_mul_f32 v30, 0x3acccccd, v30
    v_sub_f32 v16, v16, v30
    v_sub_f32 v17, v17, v30
    v_sub_f32 v18, v18, v30
    v_sub_f32 v19, v19, v30
    v_sub_f32 v20, v20, v30
    v_sub_f32 v21, v21, v30
    v_sub_f32 v22, v22, v30
    v_sub_f32 v23, v23, v30
    v_sub_f32 v24, v24, v30
    v_sub_f32 v25, v25, v30
    v_mul_f32 v32, v16, v16
    v_fmac_f32 v32, v17, v17
    v_fmac_f32 v32, v18, v18
    v_fmac_f32 v32, v19, v19
    v_fmac_f32 v32, v20, v20
    v_fmac_f32 v32, v21, v21
    v_fmac_f32 v32, v22, v22
    v_fmac_f32 v32, v23, v23
    v_fmac_f32 v32, v24, v24
    v_fmac_f32 v32, v25, v25
    ds_swizzle_b32 v31, v32 offset:0x41f
    s_waitcnt lgkmcnt(0)
    v_add_f32 v32, v32, v31
    ds_swizzle_b32 v31, v32 offset:0x81f
    s_waitcnt lgkmcnt(0)
    v_add_f32 v32, v32, v31
    ds_swizzle_b32 v31, v32 offset:0x101f
    s_waitcnt lgkmcnt(0)
    v_add_f32 v32, v32, v31
    ds_swizzle_b32 v31, v32 offset:0x201f
    s_waitcnt lgkmcnt(0)
    v_add_f32 v32, v32, v31
    ds_swizzle_b32 v31, v32 offset:0x401f
    s_waitcnt lgkmcnt(0)
    v_add_f32 v32, v32, v31
    s_nop 1
    v_readlane_b32 s4, v32, 0
    v_readlane_b32 s5, v32, 32
    s_nop 1
    v_mov_b32 v32, s4
    v_add_f32 v32, s5, v32
    v_mov_b32 v33, 0x3727c5ac
    v_fmac_f32 v33, 0x3acccccd, v32
    v_rsq_f32 v33, v33
    s_nop 0
    v_mul_f32 v16, v16, v33
    v_mul_f32 v17, v17, v33
    v_mul_f32 v18, v18, v33
    v_mul_f32 v19, v19, v33
    v_mul_f32 v20, v20, v33
    v_mul_f32 v21, v21, v33
    v_mul_f32 v22, v22, v33
    v_mul_f32 v23, v23, v33
    v_mul_f32 v24, v24, v33
    v_mul_f32 v25, v25, v33
    v_cvt_pk_bf16_f32 v8, v16, v17
    v_cvt_pk_bf16_f32 v9, v18, v19
    v_cvt_pk_bf16_f32 v10, v20, v21
    v_cvt_pk_bf16_f32 v11, v22, v23
    v_cvt_pk_bf16_f32 v12, v24, v25
    buffer_store_dwordx4 v[8:11], v3, s[44:47], 0 offen
    buffer_store_dword v12, v3, s[44:47], 0 offen offset:16
ln1_1_kernel_end:
    s_endpgm
.globl qkv_1_kernel
.p2align 8
.type qkv_1_kernel,@function
qkv_1_kernel:
    s_cmp_ge_u32 s2, 240
    s_cbranch_scc1 qkv_1_kernel_end
    s_load_dwordx16 s[16:31], s[0:1], 0
    s_load_dwordx4 s[32:35], s[0:1], 64
    s_load_dwordx2 s[36:37], s[0:1], 80
    s_waitcnt lgkmcnt(0)
    s_mov_b32 s40, s36
    s_mov_b32 s41, s37
    s_mov_b32 s42, 0x280000
    s_mov_b32 s43, 0x00020000
    s_mov_b32 s44, s18
    s_mov_b32 s45, s19
    s_mov_b32 s46, 0x258000
    s_mov_b32 s47, 0x00020000
    s_add_u32 s52, s36, 0x400000
    s_addc_u32 s53, s37, 0
    s_mov_b32 s54, 0x780000
    s_mov_b32 s55, 0x00020000
    s_and_b32 s4, s2, 15
    s_lshr_b32 s5, s2, 4
    v_lshrrev_b32 v1, 6, v0
    s_nop 0
    v_readfirstlane_b32 s6, v1
    v_and_b32 v2, 63, v0
    v_and_b32 v3, 15, v0
    v_bfe_u32 v4, v0, 4, 2
    v_lshrrev_b32 v5, 3, v0
    v_and_b32 v6, 7, v0
    s_mul_i32 s7, s4, 163840
    v_mul_u32_u24 v7, 1280, v5
    v_lshl_add_u32 v7, v6, 4, v7
    v_add_u32 v7, s7, v7
    v_mul_u32_u24 v8, 144, v5
    v_lshl_add_u32 v8, v6, 4, v8
    v_and_b32 v9, 127, v0
    v_lshrrev_b32 v9, 3, v9
    s_lshr_b32 s8, s6, 1
    v_mul_u32_u24 v10, 3840, v9
    v_lshl_add_u32 v10, v6, 4, v10
    s_lshl_b32 s9, s5, 8
    s_lshl_b32 s10, s8, 7
    s_add_u32 s9, s9, s10
    s_mov_b32 s60, s44
    s_mov_b32 s61, s45
    s_mov_b32 s62, s46
    s_mov_b32 s63, s47
    v_add_u32 v10, s9, v10
    v_mul_u32_u24 v11, 288, v9
    v_lshl_add_u32 v11, v6, 4, v11
    s_lshl_b32 s10, s8, 7
    v_add_u32 v11, s10, v11
    v_add_u32 v11, 18432, v11
    s_mov_b32 s64, 0
    s_mov_b32 s65, 40960
    s_mov_b32 s66, 81920
    s_mov_b32 s67, 122880
    s_mov_b32 s68, 0
    s_mov_b32 s69, 61440
    s_mov_b32 s70, 122880
    s_mov_b32 s71, 184320
    s_lshr_b32 s10, s6, 1
    s_and_b32 s11, s6, 1
    s_mul_i32 s12, s10, 9216
    v_mul_u32_u24 v12, 144, v3
    v_lshl_add_u32 v12, v4, 3, v12
    v_add_u32 v12, s12, v12
    v_lshrrev_b32 v13, 2, v3
    v_lshl_add_u32 v13, v4, 2, v13
    v_mul_u32_u24 v13, 288, v13
    v_and_b32 v14, 3, v3
    v_lshl_add_u32 v13, v14, 3, v13
    s_lshl_b32 s13, s11, 7
    s_add_u32 s13, s13, 18432
    v_add_u32 v13, s13, v13
    v_mov_b32 v16, 0
    v_mov_b32 v17, 0
    v_mov_b32 v18, 0
    v_mov_b32 v19, 0
    v_mov_b32 v20, 0
    v_mov_b32 v21, 0
    v_mov_b32 v22, 0
    v_mov_b32 v23, 0
    v_mov_b32 v24, 0
    v_mov_b32 v25, 0
    v_mov_b32 v26, 0
    v_mov_b32 v27, 0
    v_mov_b32 v28, 0
    v_mov_b32 v29, 0
    v_mov_b32 v30, 0
    v_mov_b32 v31, 0
    v_mov_b32 v32, 0
    v_mov_b32 v33, 0
    v_mov_b32 v34, 0
    v_mov_b32 v35, 0
    v_mov_b32 v36, 0
    v_mov_b32 v37, 0
    v_mov_b32 v38, 0
    v_mov_b32 v39, 0
    v_mov_b32 v40, 0
    v_mov_b32 v41, 0
    v_mov_b32 v42, 0
    v_mov_b32 v43, 0
    v_mov_b32 v44, 0
    v_mov_b32 v45, 0
    v_mov_b32 v46, 0
    v_mov_b32 v47, 0
    v_mov_b32 v48, 0
    v_mov_b32 v49, 0
    v_mov_b32 v50, 0
    v_mov_b32 v51, 0
    v_mov_b32 v52, 0
    v_mov_b32 v53, 0
    v_mov_b32 v54, 0
    v_mov_b32 v55, 0
    v_mov_b32 v56, 0
    v_mov_b32 v57, 0
    v_mov_b32 v58, 0
    v_mov_b32 v59, 0
    v_mov_b32 v60, 0
    v_mov_b32 v61, 0
    v_mov_b32 v62, 0
    v_mov_b32 v63, 0
    v_mov_b32 v64, 0
    v_mov_b32 v65, 0
    v_mov_b32 v66, 0
    v_mov_b32 v67, 0
    v_mov_b32 v68, 0
    v_mov_b32 v69, 0
    v_mov_b32 v70, 0
    v_mov_b32 v71, 0
    v_mov_b32 v72, 0
    v_mov_b32 v73, 0
    v_mov_b32 v74, 0
    v_mov_b32 v75, 0
    v_mov_b32 v76, 0
    v_mov_b32 v77, 0
    v_mov_b32 v78, 0
    v_mov_b32 v79, 0
    buffer_load_dwordx4 v[144:147], v7, s[40:43], s64 offen
    buffer_load_dwordx4 v[148:151], v7, s[40:43], s65 offen
    buffer_load_dwordx4 v[152:155], v7, s[40:43], s66 offen
    buffer_load_dwordx4 v[156:159], v7, s[40:43], s67 offen
    buffer_load_dwordx4 v[160:163], v10, s[60:63], s68 offen
    buffer_load_dwordx4 v[164:167], v10, s[60:63], s69 offen
    buffer_load_dwordx4 v[168:171], v10, s[60:63], s70 offen
    buffer_load_dwordx4 v[172:175], v10, s[60:63], s71 offen
    v_add_u32 v7, 128, v7
    v_add_u32 v10, 245760, v10
    buffer_load_dwordx4 v[176:179], v7, s[40:43], s64 offen
    buffer_load_dwordx4 v[180:183], v7, s[40:43], s65 offen
    buffer_load_dwordx4 v[184:187], v7, s[40:43], s66 offen
    buffer_load_dwordx4 v[188:191], v7, s[40:43], s67 offen
    buffer_load_dwordx4 v[192:195], v10, s[60:63], s68 offen
    buffer_load_dwordx4 v[196:199], v10, s[60:63], s69 offen
    buffer_load_dwordx4 v[200:203], v10, s[60:63], s70 offen
    buffer_load_dwordx4 v[204:207], v10, s[60:63], s71 offen
    v_add_u32 v7, 128, v7
    v_add_u32 v10, 245760, v10
    s_waitcnt vmcnt(8)
    ds_write_b128 v8, v[144:147] offset:0
    ds_write_b128 v8, v[148:151] offset:4608
    ds_write_b128 v8, v[152:155] offset:9216
    ds_write_b128 v8, v[156:159] offset:13824
    ds_write_b128 v11, v[160:163] offset:0
    ds_write_b128 v11, v[164:167] offset:4608
    ds_write_b128 v11, v[168:171] offset:9216
    ds_write_b128 v11, v[172:175] offset:13824
    s_waitcnt lgkmcnt(0)
    s_barrier
    buffer_load_dwordx4 v[144:147], v7, s[40:43], s64 offen
    buffer_load_dwordx4 v[148:151], v7, s[40:43], s65 offen
    buffer_load_dwordx4 v[152:155], v7, s[40:43], s66 offen
    buffer_load_dwordx4 v[156:159], v7, s[40:43], s67 offen
    buffer_load_dwordx4 v[160:163], v10, s[60:63], s68 offen
    buffer_load_dwordx4 v[164:167], v10, s[60:63], s69 offen
    buffer_load_dwordx4 v[168:171], v10, s[60:63], s70 offen
    buffer_load_dwordx4 v[172:175], v10, s[60:63], s71 offen
    v_add_u32 v7, 128, v7
    v_add_u32 v10, 245760, v10
    ds_read_b64_tr_b16 v[96:97], v13 offset:0
    ds_read_b64_tr_b16 v[98:99], v13 offset:4608
    ds_read_b64_tr_b16 v[100:101], v13 offset:32
    ds_read_b64_tr_b16 v[102:103], v13 offset:4640
    ds_read_b64_tr_b16 v[104:105], v13 offset:64
    ds_read_b64_tr_b16 v[106:107], v13 offset:4672
    ds_read_b64_tr_b16 v[108:109], v13 offset:96
    ds_read_b64_tr_b16 v[110:111], v13 offset:4704
    ds_read_b64 v[80:81], v12 offset:0
    ds_read_b64 v[82:83], v12 offset:32
    ds_read_b64 v[84:85], v12 offset:2304
    ds_read_b64 v[86:87], v12 offset:2336
    ds_read_b64 v[88:89], v12 offset:4608
    ds_read_b64 v[90:91], v12 offset:4640
    ds_read_b64 v[92:93], v12 offset:6912
    ds_read_b64 v[94:95], v12 offset:6944
    s_waitcnt lgkmcnt(0)
    ds_read_b64_tr_b16 v[128:129], v13 offset:9216
    ds_read_b64_tr_b16 v[130:131], v13 offset:13824
    ds_read_b64_tr_b16 v[132:133], v13 offset:9248
    ds_read_b64_tr_b16 v[134:135], v13 offset:13856
    ds_read_b64_tr_b16 v[136:137], v13 offset:9280
    ds_read_b64_tr_b16 v[138:139], v13 offset:13888
    ds_read_b64_tr_b16 v[140:141], v13 offset:9312
    ds_read_b64_tr_b16 v[142:143], v13 offset:13920
    ds_read_b64 v[112:113], v12 offset:64
    ds_read_b64 v[114:115], v12 offset:96
    ds_read_b64 v[116:117], v12 offset:2368
    ds_read_b64 v[118:119], v12 offset:2400
    ds_read_b64 v[120:121], v12 offset:4672
    ds_read_b64 v[122:123], v12 offset:4704
    ds_read_b64 v[124:125], v12 offset:6976
    ds_read_b64 v[126:127], v12 offset:7008
    v_mfma_f32_16x16x32_bf16 v[16:19], v[96:99], v[80:83], v[16:19]
    v_mfma_f32_16x16x32_bf16 v[20:23], v[100:103], v[80:83], v[20:23]
    v_mfma_f32_16x16x32_bf16 v[24:27], v[104:107], v[80:83], v[24:27]
    v_mfma_f32_16x16x32_bf16 v[28:31], v[108:111], v[80:83], v[28:31]
    v_mfma_f32_16x16x32_bf16 v[32:35], v[96:99], v[84:87], v[32:35]
    v_mfma_f32_16x16x32_bf16 v[36:39], v[100:103], v[84:87], v[36:39]
    v_mfma_f32_16x16x32_bf16 v[40:43], v[104:107], v[84:87], v[40:43]
    v_mfma_f32_16x16x32_bf16 v[44:47], v[108:111], v[84:87], v[44:47]
    v_mfma_f32_16x16x32_bf16 v[48:51], v[96:99], v[88:91], v[48:51]
    v_mfma_f32_16x16x32_bf16 v[52:55], v[100:103], v[88:91], v[52:55]
    v_mfma_f32_16x16x32_bf16 v[56:59], v[104:107], v[88:91], v[56:59]
    v_mfma_f32_16x16x32_bf16 v[60:63], v[108:111], v[88:91], v[60:63]
    v_mfma_f32_16x16x32_bf16 v[64:67], v[96:99], v[92:95], v[64:67]
    v_mfma_f32_16x16x32_bf16 v[68:71], v[100:103], v[92:95], v[68:71]
    v_mfma_f32_16x16x32_bf16 v[72:75], v[104:107], v[92:95], v[72:75]
    v_mfma_f32_16x16x32_bf16 v[76:79], v[108:111], v[92:95], v[76:79]
    s_waitcnt lgkmcnt(0)
    v_mfma_f32_16x16x32_bf16 v[16:19], v[128:131], v[112:115], v[16:19]
    v_mfma_f32_16x16x32_bf16 v[20:23], v[132:135], v[112:115], v[20:23]
    v_mfma_f32_16x16x32_bf16 v[24:27], v[136:139], v[112:115], v[24:27]
    v_mfma_f32_16x16x32_bf16 v[28:31], v[140:143], v[112:115], v[28:31]
    v_mfma_f32_16x16x32_bf16 v[32:35], v[128:131], v[116:119], v[32:35]
    v_mfma_f32_16x16x32_bf16 v[36:39], v[132:135], v[116:119], v[36:39]
    v_mfma_f32_16x16x32_bf16 v[40:43], v[136:139], v[116:119], v[40:43]
    v_mfma_f32_16x16x32_bf16 v[44:47], v[140:143], v[116:119], v[44:47]
    v_mfma_f32_16x16x32_bf16 v[48:51], v[128:131], v[120:123], v[48:51]
    v_mfma_f32_16x16x32_bf16 v[52:55], v[132:135], v[120:123], v[52:55]
    v_mfma_f32_16x16x32_bf16 v[56:59], v[136:139], v[120:123], v[56:59]
    v_mfma_f32_16x16x32_bf16 v[60:63], v[140:143], v[120:123], v[60:63]
    v_mfma_f32_16x16x32_bf16 v[64:67], v[128:131], v[124:127], v[64:67]
    v_mfma_f32_16x16x32_bf16 v[68:71], v[132:135], v[124:127], v[68:71]
    v_mfma_f32_16x16x32_bf16 v[72:75], v[136:139], v[124:127], v[72:75]
    v_mfma_f32_16x16x32_bf16 v[76:79], v[140:143], v[124:127], v[76:79]
    s_waitcnt vmcnt(8)
    ds_write_b128 v8, v[176:179] offset:36864
    ds_write_b128 v8, v[180:183] offset:41472
    ds_write_b128 v8, v[184:187] offset:46080
    ds_write_b128 v8, v[188:191] offset:50688
    ds_write_b128 v11, v[192:195] offset:36864
    ds_write_b128 v11, v[196:199] offset:41472
    ds_write_b128 v11, v[200:203] offset:46080
    ds_write_b128 v11, v[204:207] offset:50688
    s_waitcnt lgkmcnt(0)
    s_barrier
    buffer_load_dwordx4 v[176:179], v7, s[40:43], s64 offen
    buffer_load_dwordx4 v[180:183], v7, s[40:43], s65 offen
    buffer_load_dwordx4 v[184:187], v7, s[40:43], s66 offen
    buffer_load_dwordx4 v[188:191], v7, s[40:43], s67 offen
    buffer_load_dwordx4 v[192:195], v10, s[60:63], s68 offen
    buffer_load_dwordx4 v[196:199], v10, s[60:63], s69 offen
    buffer_load_dwordx4 v[200:203], v10, s[60:63], s70 offen
    buffer_load_dwordx4 v[204:207], v10, s[60:63], s71 offen
    v_add_u32 v7, 128, v7
    v_add_u32 v10, 245760, v10
    ds_read_b64_tr_b16 v[96:97], v13 offset:36864
    ds_read_b64_tr_b16 v[98:99], v13 offset:41472
    ds_read_b64_tr_b16 v[100:101], v13 offset:36896
    ds_read_b64_tr_b16 v[102:103], v13 offset:41504
    ds_read_b64_tr_b16 v[104:105], v13 offset:36928
    ds_read_b64_tr_b16 v[106:107], v13 offset:41536
    ds_read_b64_tr_b16 v[108:109], v13 offset:36960
    ds_read_b64_tr_b16 v[110:111], v13 offset:41568
    ds_read_b64 v[80:81], v12 offset:36864
    ds_read_b64 v[82:83], v12 offset:36896
    ds_read_b64 v[84:85], v12 offset:39168
    ds_read_b64 v[86:87], v12 offset:39200
    ds_read_b64 v[88:89], v12 offset:41472
    ds_read_b64 v[90:91], v12 offset:41504
    ds_read_b64 v[92:93], v12 offset:43776
    ds_read_b64 v[94:95], v12 offset:43808
    s_waitcnt lgkmcnt(0)
    ds_read_b64_tr_b16 v[128:129], v13 offset:46080
    ds_read_b64_tr_b16 v[130:131], v13 offset:50688
    ds_read_b64_tr_b16 v[132:133], v13 offset:46112
    ds_read_b64_tr_b16 v[134:135], v13 offset:50720
    ds_read_b64_tr_b16 v[136:137], v13 offset:46144
    ds_read_b64_tr_b16 v[138:139], v13 offset:50752
    ds_read_b64_tr_b16 v[140:141], v13 offset:46176
    ds_read_b64_tr_b16 v[142:143], v13 offset:50784
    ds_read_b64 v[112:113], v12 offset:36928
    ds_read_b64 v[114:115], v12 offset:36960
    ds_read_b64 v[116:117], v12 offset:39232
    ds_read_b64 v[118:119], v12 offset:39264
    ds_read_b64 v[120:121], v12 offset:41536
    ds_read_b64 v[122:123], v12 offset:41568
    ds_read_b64 v[124:125], v12 offset:43840
    ds_read_b64 v[126:127], v12 offset:43872
    v_mfma_f32_16x16x32_bf16 v[16:19], v[96:99], v[80:83], v[16:19]
    v_mfma_f32_16x16x32_bf16 v[20:23], v[100:103], v[80:83], v[20:23]
    v_mfma_f32_16x16x32_bf16 v[24:27], v[104:107], v[80:83], v[24:27]
    v_mfma_f32_16x16x32_bf16 v[28:31], v[108:111], v[80:83], v[28:31]
    v_mfma_f32_16x16x32_bf16 v[32:35], v[96:99], v[84:87], v[32:35]
    v_mfma_f32_16x16x32_bf16 v[36:39], v[100:103], v[84:87], v[36:39]
    v_mfma_f32_16x16x32_bf16 v[40:43], v[104:107], v[84:87], v[40:43]
    v_mfma_f32_16x16x32_bf16 v[44:47], v[108:111], v[84:87], v[44:47]
    v_mfma_f32_16x16x32_bf16 v[48:51], v[96:99], v[88:91], v[48:51]
    v_mfma_f32_16x16x32_bf16 v[52:55], v[100:103], v[88:91], v[52:55]
    v_mfma_f32_16x16x32_bf16 v[56:59], v[104:107], v[88:91], v[56:59]
    v_mfma_f32_16x16x32_bf16 v[60:63], v[108:111], v[88:91], v[60:63]
    v_mfma_f32_16x16x32_bf16 v[64:67], v[96:99], v[92:95], v[64:67]
    v_mfma_f32_16x16x32_bf16 v[68:71], v[100:103], v[92:95], v[68:71]
    v_mfma_f32_16x16x32_bf16 v[72:75], v[104:107], v[92:95], v[72:75]
    v_mfma_f32_16x16x32_bf16 v[76:79], v[108:111], v[92:95], v[76:79]
    s_waitcnt lgkmcnt(0)
    v_mfma_f32_16x16x32_bf16 v[16:19], v[128:131], v[112:115], v[16:19]
    v_mfma_f32_16x16x32_bf16 v[20:23], v[132:135], v[112:115], v[20:23]
    v_mfma_f32_16x16x32_bf16 v[24:27], v[136:139], v[112:115], v[24:27]
    v_mfma_f32_16x16x32_bf16 v[28:31], v[140:143], v[112:115], v[28:31]
    v_mfma_f32_16x16x32_bf16 v[32:35], v[128:131], v[116:119], v[32:35]
    v_mfma_f32_16x16x32_bf16 v[36:39], v[132:135], v[116:119], v[36:39]
    v_mfma_f32_16x16x32_bf16 v[40:43], v[136:139], v[116:119], v[40:43]
    v_mfma_f32_16x16x32_bf16 v[44:47], v[140:143], v[116:119], v[44:47]
    v_mfma_f32_16x16x32_bf16 v[48:51], v[128:131], v[120:123], v[48:51]
    v_mfma_f32_16x16x32_bf16 v[52:55], v[132:135], v[120:123], v[52:55]
    v_mfma_f32_16x16x32_bf16 v[56:59], v[136:139], v[120:123], v[56:59]
    v_mfma_f32_16x16x32_bf16 v[60:63], v[140:143], v[120:123], v[60:63]
    v_mfma_f32_16x16x32_bf16 v[64:67], v[128:131], v[124:127], v[64:67]
    v_mfma_f32_16x16x32_bf16 v[68:71], v[132:135], v[124:127], v[68:71]
    v_mfma_f32_16x16x32_bf16 v[72:75], v[136:139], v[124:127], v[72:75]
    v_mfma_f32_16x16x32_bf16 v[76:79], v[140:143], v[124:127], v[76:79]
    s_waitcnt vmcnt(8)
    ds_write_b128 v8, v[144:147] offset:0
    ds_write_b128 v8, v[148:151] offset:4608
    ds_write_b128 v8, v[152:155] offset:9216
    ds_write_b128 v8, v[156:159] offset:13824
    ds_write_b128 v11, v[160:163] offset:0
    ds_write_b128 v11, v[164:167] offset:4608
    ds_write_b128 v11, v[168:171] offset:9216
    ds_write_b128 v11, v[172:175] offset:13824
    s_waitcnt lgkmcnt(0)
    s_barrier
    buffer_load_dwordx4 v[144:147], v7, s[40:43], s64 offen
    buffer_load_dwordx4 v[148:151], v7, s[40:43], s65 offen
    buffer_load_dwordx4 v[152:155], v7, s[40:43], s66 offen
    buffer_load_dwordx4 v[156:159], v7, s[40:43], s67 offen
    buffer_load_dwordx4 v[160:163], v10, s[60:63], s68 offen
    buffer_load_dwordx4 v[164:167], v10, s[60:63], s69 offen
    buffer_load_dwordx4 v[168:171], v10, s[60:63], s70 offen
    buffer_load_dwordx4 v[172:175], v10, s[60:63], s71 offen
    v_add_u32 v7, 128, v7
    v_add_u32 v10, 245760, v10
    ds_read_b64_tr_b16 v[96:97], v13 offset:0
    ds_read_b64_tr_b16 v[98:99], v13 offset:4608
    ds_read_b64_tr_b16 v[100:101], v13 offset:32
    ds_read_b64_tr_b16 v[102:103], v13 offset:4640
    ds_read_b64_tr_b16 v[104:105], v13 offset:64
    ds_read_b64_tr_b16 v[106:107], v13 offset:4672
    ds_read_b64_tr_b16 v[108:109], v13 offset:96
    ds_read_b64_tr_b16 v[110:111], v13 offset:4704
    ds_read_b64 v[80:81], v12 offset:0
    ds_read_b64 v[82:83], v12 offset:32
    ds_read_b64 v[84:85], v12 offset:2304
    ds_read_b64 v[86:87], v12 offset:2336
    ds_read_b64 v[88:89], v12 offset:4608
    ds_read_b64 v[90:91], v12 offset:4640
    ds_read_b64 v[92:93], v12 offset:6912
    ds_read_b64 v[94:95], v12 offset:6944
    s_waitcnt lgkmcnt(0)
    ds_read_b64_tr_b16 v[128:129], v13 offset:9216
    ds_read_b64_tr_b16 v[130:131], v13 offset:13824
    ds_read_b64_tr_b16 v[132:133], v13 offset:9248
    ds_read_b64_tr_b16 v[134:135], v13 offset:13856
    ds_read_b64_tr_b16 v[136:137], v13 offset:9280
    ds_read_b64_tr_b16 v[138:139], v13 offset:13888
    ds_read_b64_tr_b16 v[140:141], v13 offset:9312
    ds_read_b64_tr_b16 v[142:143], v13 offset:13920
    ds_read_b64 v[112:113], v12 offset:64
    ds_read_b64 v[114:115], v12 offset:96
    ds_read_b64 v[116:117], v12 offset:2368
    ds_read_b64 v[118:119], v12 offset:2400
    ds_read_b64 v[120:121], v12 offset:4672
    ds_read_b64 v[122:123], v12 offset:4704
    ds_read_b64 v[124:125], v12 offset:6976
    ds_read_b64 v[126:127], v12 offset:7008
    v_mfma_f32_16x16x32_bf16 v[16:19], v[96:99], v[80:83], v[16:19]
    v_mfma_f32_16x16x32_bf16 v[20:23], v[100:103], v[80:83], v[20:23]
    v_mfma_f32_16x16x32_bf16 v[24:27], v[104:107], v[80:83], v[24:27]
    v_mfma_f32_16x16x32_bf16 v[28:31], v[108:111], v[80:83], v[28:31]
    v_mfma_f32_16x16x32_bf16 v[32:35], v[96:99], v[84:87], v[32:35]
    v_mfma_f32_16x16x32_bf16 v[36:39], v[100:103], v[84:87], v[36:39]
    v_mfma_f32_16x16x32_bf16 v[40:43], v[104:107], v[84:87], v[40:43]
    v_mfma_f32_16x16x32_bf16 v[44:47], v[108:111], v[84:87], v[44:47]
    v_mfma_f32_16x16x32_bf16 v[48:51], v[96:99], v[88:91], v[48:51]
    v_mfma_f32_16x16x32_bf16 v[52:55], v[100:103], v[88:91], v[52:55]
    v_mfma_f32_16x16x32_bf16 v[56:59], v[104:107], v[88:91], v[56:59]
    v_mfma_f32_16x16x32_bf16 v[60:63], v[108:111], v[88:91], v[60:63]
    v_mfma_f32_16x16x32_bf16 v[64:67], v[96:99], v[92:95], v[64:67]
    v_mfma_f32_16x16x32_bf16 v[68:71], v[100:103], v[92:95], v[68:71]
    v_mfma_f32_16x16x32_bf16 v[72:75], v[104:107], v[92:95], v[72:75]
    v_mfma_f32_16x16x32_bf16 v[76:79], v[108:111], v[92:95], v[76:79]
    s_waitcnt lgkmcnt(0)
    v_mfma_f32_16x16x32_bf16 v[16:19], v[128:131], v[112:115], v[16:19]
    v_mfma_f32_16x16x32_bf16 v[20:23], v[132:135], v[112:115], v[20:23]
    v_mfma_f32_16x16x32_bf16 v[24:27], v[136:139], v[112:115], v[24:27]
    v_mfma_f32_16x16x32_bf16 v[28:31], v[140:143], v[112:115], v[28:31]
    v_mfma_f32_16x16x32_bf16 v[32:35], v[128:131], v[116:119], v[32:35]
    v_mfma_f32_16x16x32_bf16 v[36:39], v[132:135], v[116:119], v[36:39]
    v_mfma_f32_16x16x32_bf16 v[40:43], v[136:139], v[116:119], v[40:43]
    v_mfma_f32_16x16x32_bf16 v[44:47], v[140:143], v[116:119], v[44:47]
    v_mfma_f32_16x16x32_bf16 v[48:51], v[128:131], v[120:123], v[48:51]
    v_mfma_f32_16x16x32_bf16 v[52:55], v[132:135], v[120:123], v[52:55]
    v_mfma_f32_16x16x32_bf16 v[56:59], v[136:139], v[120:123], v[56:59]
    v_mfma_f32_16x16x32_bf16 v[60:63], v[140:143], v[120:123], v[60:63]
    v_mfma_f32_16x16x32_bf16 v[64:67], v[128:131], v[124:127], v[64:67]
    v_mfma_f32_16x16x32_bf16 v[68:71], v[132:135], v[124:127], v[68:71]
    v_mfma_f32_16x16x32_bf16 v[72:75], v[136:139], v[124:127], v[72:75]
    v_mfma_f32_16x16x32_bf16 v[76:79], v[140:143], v[124:127], v[76:79]
    s_waitcnt vmcnt(8)
    ds_write_b128 v8, v[176:179] offset:36864
    ds_write_b128 v8, v[180:183] offset:41472
    ds_write_b128 v8, v[184:187] offset:46080
    ds_write_b128 v8, v[188:191] offset:50688
    ds_write_b128 v11, v[192:195] offset:36864
    ds_write_b128 v11, v[196:199] offset:41472
    ds_write_b128 v11, v[200:203] offset:46080
    ds_write_b128 v11, v[204:207] offset:50688
    s_waitcnt lgkmcnt(0)
    s_barrier
    buffer_load_dwordx4 v[176:179], v7, s[40:43], s64 offen
    buffer_load_dwordx4 v[180:183], v7, s[40:43], s65 offen
    buffer_load_dwordx4 v[184:187], v7, s[40:43], s66 offen
    buffer_load_dwordx4 v[188:191], v7, s[40:43], s67 offen
    buffer_load_dwordx4 v[192:195], v10, s[60:63], s68 offen
    buffer_load_dwordx4 v[196:199], v10, s[60:63], s69 offen
    buffer_load_dwordx4 v[200:203], v10, s[60:63], s70 offen
    buffer_load_dwordx4 v[204:207], v10, s[60:63], s71 offen
    v_add_u32 v7, 128, v7
    v_add_u32 v10, 245760, v10
    ds_read_b64_tr_b16 v[96:97], v13 offset:36864
    ds_read_b64_tr_b16 v[98:99], v13 offset:41472
    ds_read_b64_tr_b16 v[100:101], v13 offset:36896
    ds_read_b64_tr_b16 v[102:103], v13 offset:41504
    ds_read_b64_tr_b16 v[104:105], v13 offset:36928
    ds_read_b64_tr_b16 v[106:107], v13 offset:41536
    ds_read_b64_tr_b16 v[108:109], v13 offset:36960
    ds_read_b64_tr_b16 v[110:111], v13 offset:41568
    ds_read_b64 v[80:81], v12 offset:36864
    ds_read_b64 v[82:83], v12 offset:36896
    ds_read_b64 v[84:85], v12 offset:39168
    ds_read_b64 v[86:87], v12 offset:39200
    ds_read_b64 v[88:89], v12 offset:41472
    ds_read_b64 v[90:91], v12 offset:41504
    ds_read_b64 v[92:93], v12 offset:43776
    ds_read_b64 v[94:95], v12 offset:43808
    s_waitcnt lgkmcnt(0)
    ds_read_b64_tr_b16 v[128:129], v13 offset:46080
    ds_read_b64_tr_b16 v[130:131], v13 offset:50688
    ds_read_b64_tr_b16 v[132:133], v13 offset:46112
    ds_read_b64_tr_b16 v[134:135], v13 offset:50720
    ds_read_b64_tr_b16 v[136:137], v13 offset:46144
    ds_read_b64_tr_b16 v[138:139], v13 offset:50752
    ds_read_b64_tr_b16 v[140:141], v13 offset:46176
    ds_read_b64_tr_b16 v[142:143], v13 offset:50784
    ds_read_b64 v[112:113], v12 offset:36928
    ds_read_b64 v[114:115], v12 offset:36960
    ds_read_b64 v[116:117], v12 offset:39232
    ds_read_b64 v[118:119], v12 offset:39264
    ds_read_b64 v[120:121], v12 offset:41536
    ds_read_b64 v[122:123], v12 offset:41568
    ds_read_b64 v[124:125], v12 offset:43840
    ds_read_b64 v[126:127], v12 offset:43872
    v_mfma_f32_16x16x32_bf16 v[16:19], v[96:99], v[80:83], v[16:19]
    v_mfma_f32_16x16x32_bf16 v[20:23], v[100:103], v[80:83], v[20:23]
    v_mfma_f32_16x16x32_bf16 v[24:27], v[104:107], v[80:83], v[24:27]
    v_mfma_f32_16x16x32_bf16 v[28:31], v[108:111], v[80:83], v[28:31]
    v_mfma_f32_16x16x32_bf16 v[32:35], v[96:99], v[84:87], v[32:35]
    v_mfma_f32_16x16x32_bf16 v[36:39], v[100:103], v[84:87], v[36:39]
    v_mfma_f32_16x16x32_bf16 v[40:43], v[104:107], v[84:87], v[40:43]
    v_mfma_f32_16x16x32_bf16 v[44:47], v[108:111], v[84:87], v[44:47]
    v_mfma_f32_16x16x32_bf16 v[48:51], v[96:99], v[88:91], v[48:51]
    v_mfma_f32_16x16x32_bf16 v[52:55], v[100:103], v[88:91], v[52:55]
    v_mfma_f32_16x16x32_bf16 v[56:59], v[104:107], v[88:91], v[56:59]
    v_mfma_f32_16x16x32_bf16 v[60:63], v[108:111], v[88:91], v[60:63]
    v_mfma_f32_16x16x32_bf16 v[64:67], v[96:99], v[92:95], v[64:67]
    v_mfma_f32_16x16x32_bf16 v[68:71], v[100:103], v[92:95], v[68:71]
    v_mfma_f32_16x16x32_bf16 v[72:75], v[104:107], v[92:95], v[72:75]
    v_mfma_f32_16x16x32_bf16 v[76:79], v[108:111], v[92:95], v[76:79]
    s_waitcnt lgkmcnt(0)
    v_mfma_f32_16x16x32_bf16 v[16:19], v[128:131], v[112:115], v[16:19]
    v_mfma_f32_16x16x32_bf16 v[20:23], v[132:135], v[112:115], v[20:23]
    v_mfma_f32_16x16x32_bf16 v[24:27], v[136:139], v[112:115], v[24:27]
    v_mfma_f32_16x16x32_bf16 v[28:31], v[140:143], v[112:115], v[28:31]
    v_mfma_f32_16x16x32_bf16 v[32:35], v[128:131], v[116:119], v[32:35]
    v_mfma_f32_16x16x32_bf16 v[36:39], v[132:135], v[116:119], v[36:39]
    v_mfma_f32_16x16x32_bf16 v[40:43], v[136:139], v[116:119], v[40:43]
    v_mfma_f32_16x16x32_bf16 v[44:47], v[140:143], v[116:119], v[44:47]
    v_mfma_f32_16x16x32_bf16 v[48:51], v[128:131], v[120:123], v[48:51]
    v_mfma_f32_16x16x32_bf16 v[52:55], v[132:135], v[120:123], v[52:55]
    v_mfma_f32_16x16x32_bf16 v[56:59], v[136:139], v[120:123], v[56:59]
    v_mfma_f32_16x16x32_bf16 v[60:63], v[140:143], v[120:123], v[60:63]
    v_mfma_f32_16x16x32_bf16 v[64:67], v[128:131], v[124:127], v[64:67]
    v_mfma_f32_16x16x32_bf16 v[68:71], v[132:135], v[124:127], v[68:71]
    v_mfma_f32_16x16x32_bf16 v[72:75], v[136:139], v[124:127], v[72:75]
    v_mfma_f32_16x16x32_bf16 v[76:79], v[140:143], v[124:127], v[76:79]
    s_waitcnt vmcnt(8)
    ds_write_b128 v8, v[144:147] offset:0
    ds_write_b128 v8, v[148:151] offset:4608
    ds_write_b128 v8, v[152:155] offset:9216
    ds_write_b128 v8, v[156:159] offset:13824
    ds_write_b128 v11, v[160:163] offset:0
    ds_write_b128 v11, v[164:167] offset:4608
    ds_write_b128 v11, v[168:171] offset:9216
    ds_write_b128 v11, v[172:175] offset:13824
    s_waitcnt lgkmcnt(0)
    s_barrier
    buffer_load_dwordx4 v[144:147], v7, s[40:43], s64 offen
    buffer_load_dwordx4 v[148:151], v7, s[40:43], s65 offen
    buffer_load_dwordx4 v[152:155], v7, s[40:43], s66 offen
    buffer_load_dwordx4 v[156:159], v7, s[40:43], s67 offen
    buffer_load_dwordx4 v[160:163], v10, s[60:63], s68 offen
    buffer_load_dwordx4 v[164:167], v10, s[60:63], s69 offen
    buffer_load_dwordx4 v[168:171], v10, s[60:63], s70 offen
    buffer_load_dwordx4 v[172:175], v10, s[60:63], s71 offen
    v_add_u32 v7, 128, v7
    v_add_u32 v10, 245760, v10
    ds_read_b64_tr_b16 v[96:97], v13 offset:0
    ds_read_b64_tr_b16 v[98:99], v13 offset:4608
    ds_read_b64_tr_b16 v[100:101], v13 offset:32
    ds_read_b64_tr_b16 v[102:103], v13 offset:4640
    ds_read_b64_tr_b16 v[104:105], v13 offset:64
    ds_read_b64_tr_b16 v[106:107], v13 offset:4672
    ds_read_b64_tr_b16 v[108:109], v13 offset:96
    ds_read_b64_tr_b16 v[110:111], v13 offset:4704
    ds_read_b64 v[80:81], v12 offset:0
    ds_read_b64 v[82:83], v12 offset:32
    ds_read_b64 v[84:85], v12 offset:2304
    ds_read_b64 v[86:87], v12 offset:2336
    ds_read_b64 v[88:89], v12 offset:4608
    ds_read_b64 v[90:91], v12 offset:4640
    ds_read_b64 v[92:93], v12 offset:6912
    ds_read_b64 v[94:95], v12 offset:6944
    s_waitcnt lgkmcnt(0)
    ds_read_b64_tr_b16 v[128:129], v13 offset:9216
    ds_read_b64_tr_b16 v[130:131], v13 offset:13824
    ds_read_b64_tr_b16 v[132:133], v13 offset:9248
    ds_read_b64_tr_b16 v[134:135], v13 offset:13856
    ds_read_b64_tr_b16 v[136:137], v13 offset:9280
    ds_read_b64_tr_b16 v[138:139], v13 offset:13888
    ds_read_b64_tr_b16 v[140:141], v13 offset:9312
    ds_read_b64_tr_b16 v[142:143], v13 offset:13920
    ds_read_b64 v[112:113], v12 offset:64
    ds_read_b64 v[114:115], v12 offset:96
    ds_read_b64 v[116:117], v12 offset:2368
    ds_read_b64 v[118:119], v12 offset:2400
    ds_read_b64 v[120:121], v12 offset:4672
    ds_read_b64 v[122:123], v12 offset:4704
    ds_read_b64 v[124:125], v12 offset:6976
    ds_read_b64 v[126:127], v12 offset:7008
    v_mfma_f32_16x16x32_bf16 v[16:19], v[96:99], v[80:83], v[16:19]
    v_mfma_f32_16x16x32_bf16 v[20:23], v[100:103], v[80:83], v[20:23]
    v_mfma_f32_16x16x32_bf16 v[24:27], v[104:107], v[80:83], v[24:27]
    v_mfma_f32_16x16x32_bf16 v[28:31], v[108:111], v[80:83], v[28:31]
    v_mfma_f32_16x16x32_bf16 v[32:35], v[96:99], v[84:87], v[32:35]
    v_mfma_f32_16x16x32_bf16 v[36:39], v[100:103], v[84:87], v[36:39]
    v_mfma_f32_16x16x32_bf16 v[40:43], v[104:107], v[84:87], v[40:43]
    v_mfma_f32_16x16x32_bf16 v[44:47], v[108:111], v[84:87], v[44:47]
    v_mfma_f32_16x16x32_bf16 v[48:51], v[96:99], v[88:91], v[48:51]
    v_mfma_f32_16x16x32_bf16 v[52:55], v[100:103], v[88:91], v[52:55]
    v_mfma_f32_16x16x32_bf16 v[56:59], v[104:107], v[88:91], v[56:59]
    v_mfma_f32_16x16x32_bf16 v[60:63], v[108:111], v[88:91], v[60:63]
    v_mfma_f32_16x16x32_bf16 v[64:67], v[96:99], v[92:95], v[64:67]
    v_mfma_f32_16x16x32_bf16 v[68:71], v[100:103], v[92:95], v[68:71]
    v_mfma_f32_16x16x32_bf16 v[72:75], v[104:107], v[92:95], v[72:75]
    v_mfma_f32_16x16x32_bf16 v[76:79], v[108:111], v[92:95], v[76:79]
    s_waitcnt lgkmcnt(0)
    v_mfma_f32_16x16x32_bf16 v[16:19], v[128:131], v[112:115], v[16:19]
    v_mfma_f32_16x16x32_bf16 v[20:23], v[132:135], v[112:115], v[20:23]
    v_mfma_f32_16x16x32_bf16 v[24:27], v[136:139], v[112:115], v[24:27]
    v_mfma_f32_16x16x32_bf16 v[28:31], v[140:143], v[112:115], v[28:31]
    v_mfma_f32_16x16x32_bf16 v[32:35], v[128:131], v[116:119], v[32:35]
    v_mfma_f32_16x16x32_bf16 v[36:39], v[132:135], v[116:119], v[36:39]
    v_mfma_f32_16x16x32_bf16 v[40:43], v[136:139], v[116:119], v[40:43]
    v_mfma_f32_16x16x32_bf16 v[44:47], v[140:143], v[116:119], v[44:47]
    v_mfma_f32_16x16x32_bf16 v[48:51], v[128:131], v[120:123], v[48:51]
    v_mfma_f32_16x16x32_bf16 v[52:55], v[132:135], v[120:123], v[52:55]
    v_mfma_f32_16x16x32_bf16 v[56:59], v[136:139], v[120:123], v[56:59]
    v_mfma_f32_16x16x32_bf16 v[60:63], v[140:143], v[120:123], v[60:63]
    v_mfma_f32_16x16x32_bf16 v[64:67], v[128:131], v[124:127], v[64:67]
    v_mfma_f32_16x16x32_bf16 v[68:71], v[132:135], v[124:127], v[68:71]
    v_mfma_f32_16x16x32_bf16 v[72:75], v[136:139], v[124:127], v[72:75]
    v_mfma_f32_16x16x32_bf16 v[76:79], v[140:143], v[124:127], v[76:79]
    s_waitcnt vmcnt(8)
    ds_write_b128 v8, v[176:179] offset:36864
    ds_write_b128 v8, v[180:183] offset:41472
    ds_write_b128 v8, v[184:187] offset:46080
    ds_write_b128 v8, v[188:191] offset:50688
    ds_write_b128 v11, v[192:195] offset:36864
    ds_write_b128 v11, v[196:199] offset:41472
    ds_write_b128 v11, v[200:203] offset:46080
    ds_write_b128 v11, v[204:207] offset:50688
    s_waitcnt lgkmcnt(0)
    s_barrier
    buffer_load_dwordx4 v[176:179], v7, s[40:43], s64 offen
    buffer_load_dwordx4 v[180:183], v7, s[40:43], s65 offen
    buffer_load_dwordx4 v[184:187], v7, s[40:43], s66 offen
    buffer_load_dwordx4 v[188:191], v7, s[40:43], s67 offen
    buffer_load_dwordx4 v[192:195], v10, s[60:63], s68 offen
    buffer_load_dwordx4 v[196:199], v10, s[60:63], s69 offen
    buffer_load_dwordx4 v[200:203], v10, s[60:63], s70 offen
    buffer_load_dwordx4 v[204:207], v10, s[60:63], s71 offen
    v_add_u32 v7, 128, v7
    v_add_u32 v10, 245760, v10
    ds_read_b64_tr_b16 v[96:97], v13 offset:36864
    ds_read_b64_tr_b16 v[98:99], v13 offset:41472
    ds_read_b64_tr_b16 v[100:101], v13 offset:36896
    ds_read_b64_tr_b16 v[102:103], v13 offset:41504
    ds_read_b64_tr_b16 v[104:105], v13 offset:36928
    ds_read_b64_tr_b16 v[106:107], v13 offset:41536
    ds_read_b64_tr_b16 v[108:109], v13 offset:36960
    ds_read_b64_tr_b16 v[110:111], v13 offset:41568
    ds_read_b64 v[80:81], v12 offset:36864
    ds_read_b64 v[82:83], v12 offset:36896
    ds_read_b64 v[84:85], v12 offset:39168
    ds_read_b64 v[86:87], v12 offset:39200
    ds_read_b64 v[88:89], v12 offset:41472
    ds_read_b64 v[90:91], v12 offset:41504
    ds_read_b64 v[92:93], v12 offset:43776
    ds_read_b64 v[94:95], v12 offset:43808
    s_waitcnt lgkmcnt(0)
    ds_read_b64_tr_b16 v[128:129], v13 offset:46080
    ds_read_b64_tr_b16 v[130:131], v13 offset:50688
    ds_read_b64_tr_b16 v[132:133], v13 offset:46112
    ds_read_b64_tr_b16 v[134:135], v13 offset:50720
    ds_read_b64_tr_b16 v[136:137], v13 offset:46144
    ds_read_b64_tr_b16 v[138:139], v13 offset:50752
    ds_read_b64_tr_b16 v[140:141], v13 offset:46176
    ds_read_b64_tr_b16 v[142:143], v13 offset:50784
    ds_read_b64 v[112:113], v12 offset:36928
    ds_read_b64 v[114:115], v12 offset:36960
    ds_read_b64 v[116:117], v12 offset:39232
    ds_read_b64 v[118:119], v12 offset:39264
    ds_read_b64 v[120:121], v12 offset:41536
    ds_read_b64 v[122:123], v12 offset:41568
    ds_read_b64 v[124:125], v12 offset:43840
    ds_read_b64 v[126:127], v12 offset:43872
    v_mfma_f32_16x16x32_bf16 v[16:19], v[96:99], v[80:83], v[16:19]
    v_mfma_f32_16x16x32_bf16 v[20:23], v[100:103], v[80:83], v[20:23]
    v_mfma_f32_16x16x32_bf16 v[24:27], v[104:107], v[80:83], v[24:27]
    v_mfma_f32_16x16x32_bf16 v[28:31], v[108:111], v[80:83], v[28:31]
    v_mfma_f32_16x16x32_bf16 v[32:35], v[96:99], v[84:87], v[32:35]
    v_mfma_f32_16x16x32_bf16 v[36:39], v[100:103], v[84:87], v[36:39]
    v_mfma_f32_16x16x32_bf16 v[40:43], v[104:107], v[84:87], v[40:43]
    v_mfma_f32_16x16x32_bf16 v[44:47], v[108:111], v[84:87], v[44:47]
    v_mfma_f32_16x16x32_bf16 v[48:51], v[96:99], v[88:91], v[48:51]
    v_mfma_f32_16x16x32_bf16 v[52:55], v[100:103], v[88:91], v[52:55]
    v_mfma_f32_16x16x32_bf16 v[56:59], v[104:107], v[88:91], v[56:59]
    v_mfma_f32_16x16x32_bf16 v[60:63], v[108:111], v[88:91], v[60:63]
    v_mfma_f32_16x16x32_bf16 v[64:67], v[96:99], v[92:95], v[64:67]
    v_mfma_f32_16x16x32_bf16 v[68:71], v[100:103], v[92:95], v[68:71]
    v_mfma_f32_16x16x32_bf16 v[72:75], v[104:107], v[92:95], v[72:75]
    v_mfma_f32_16x16x32_bf16 v[76:79], v[108:111], v[92:95], v[76:79]
    s_waitcnt lgkmcnt(0)
    v_mfma_f32_16x16x32_bf16 v[16:19], v[128:131], v[112:115], v[16:19]
    v_mfma_f32_16x16x32_bf16 v[20:23], v[132:135], v[112:115], v[20:23]
    v_mfma_f32_16x16x32_bf16 v[24:27], v[136:139], v[112:115], v[24:27]
    v_mfma_f32_16x16x32_bf16 v[28:31], v[140:143], v[112:115], v[28:31]
    v_mfma_f32_16x16x32_bf16 v[32:35], v[128:131], v[116:119], v[32:35]
    v_mfma_f32_16x16x32_bf16 v[36:39], v[132:135], v[116:119], v[36:39]
    v_mfma_f32_16x16x32_bf16 v[40:43], v[136:139], v[116:119], v[40:43]
    v_mfma_f32_16x16x32_bf16 v[44:47], v[140:143], v[116:119], v[44:47]
    v_mfma_f32_16x16x32_bf16 v[48:51], v[128:131], v[120:123], v[48:51]
    v_mfma_f32_16x16x32_bf16 v[52:55], v[132:135], v[120:123], v[52:55]
    v_mfma_f32_16x16x32_bf16 v[56:59], v[136:139], v[120:123], v[56:59]
    v_mfma_f32_16x16x32_bf16 v[60:63], v[140:143], v[120:123], v[60:63]
    v_mfma_f32_16x16x32_bf16 v[64:67], v[128:131], v[124:127], v[64:67]
    v_mfma_f32_16x16x32_bf16 v[68:71], v[132:135], v[124:127], v[68:71]
    v_mfma_f32_16x16x32_bf16 v[72:75], v[136:139], v[124:127], v[72:75]
    v_mfma_f32_16x16x32_bf16 v[76:79], v[140:143], v[124:127], v[76:79]
    s_waitcnt vmcnt(8)
    ds_write_b128 v8, v[144:147] offset:0
    ds_write_b128 v8, v[148:151] offset:4608
    ds_write_b128 v8, v[152:155] offset:9216
    ds_write_b128 v8, v[156:159] offset:13824
    ds_write_b128 v11, v[160:163] offset:0
    ds_write_b128 v11, v[164:167] offset:4608
    ds_write_b128 v11, v[168:171] offset:9216
    ds_write_b128 v11, v[172:175] offset:13824
    s_waitcnt lgkmcnt(0)
    s_barrier
    buffer_load_dwordx4 v[144:147], v7, s[40:43], s64 offen
    buffer_load_dwordx4 v[148:151], v7, s[40:43], s65 offen
    buffer_load_dwordx4 v[152:155], v7, s[40:43], s66 offen
    buffer_load_dwordx4 v[156:159], v7, s[40:43], s67 offen
    buffer_load_dwordx4 v[160:163], v10, s[60:63], s68 offen
    buffer_load_dwordx4 v[164:167], v10, s[60:63], s69 offen
    buffer_load_dwordx4 v[168:171], v10, s[60:63], s70 offen
    buffer_load_dwordx4 v[172:175], v10, s[60:63], s71 offen
    v_add_u32 v7, 128, v7
    v_add_u32 v10, 245760, v10
    ds_read_b64_tr_b16 v[96:97], v13 offset:0
    ds_read_b64_tr_b16 v[98:99], v13 offset:4608
    ds_read_b64_tr_b16 v[100:101], v13 offset:32
    ds_read_b64_tr_b16 v[102:103], v13 offset:4640
    ds_read_b64_tr_b16 v[104:105], v13 offset:64
    ds_read_b64_tr_b16 v[106:107], v13 offset:4672
    ds_read_b64_tr_b16 v[108:109], v13 offset:96
    ds_read_b64_tr_b16 v[110:111], v13 offset:4704
    ds_read_b64 v[80:81], v12 offset:0
    ds_read_b64 v[82:83], v12 offset:32
    ds_read_b64 v[84:85], v12 offset:2304
    ds_read_b64 v[86:87], v12 offset:2336
    ds_read_b64 v[88:89], v12 offset:4608
    ds_read_b64 v[90:91], v12 offset:4640
    ds_read_b64 v[92:93], v12 offset:6912
    ds_read_b64 v[94:95], v12 offset:6944
    s_waitcnt lgkmcnt(0)
    ds_read_b64_tr_b16 v[128:129], v13 offset:9216
    ds_read_b64_tr_b16 v[130:131], v13 offset:13824
    ds_read_b64_tr_b16 v[132:133], v13 offset:9248
    ds_read_b64_tr_b16 v[134:135], v13 offset:13856
    ds_read_b64_tr_b16 v[136:137], v13 offset:9280
    ds_read_b64_tr_b16 v[138:139], v13 offset:13888
    ds_read_b64_tr_b16 v[140:141], v13 offset:9312
    ds_read_b64_tr_b16 v[142:143], v13 offset:13920
    ds_read_b64 v[112:113], v12 offset:64
    ds_read_b64 v[114:115], v12 offset:96
    ds_read_b64 v[116:117], v12 offset:2368
    ds_read_b64 v[118:119], v12 offset:2400
    ds_read_b64 v[120:121], v12 offset:4672
    ds_read_b64 v[122:123], v12 offset:4704
    ds_read_b64 v[124:125], v12 offset:6976
    ds_read_b64 v[126:127], v12 offset:7008
    v_mfma_f32_16x16x32_bf16 v[16:19], v[96:99], v[80:83], v[16:19]
    v_mfma_f32_16x16x32_bf16 v[20:23], v[100:103], v[80:83], v[20:23]
    v_mfma_f32_16x16x32_bf16 v[24:27], v[104:107], v[80:83], v[24:27]
    v_mfma_f32_16x16x32_bf16 v[28:31], v[108:111], v[80:83], v[28:31]
    v_mfma_f32_16x16x32_bf16 v[32:35], v[96:99], v[84:87], v[32:35]
    v_mfma_f32_16x16x32_bf16 v[36:39], v[100:103], v[84:87], v[36:39]
    v_mfma_f32_16x16x32_bf16 v[40:43], v[104:107], v[84:87], v[40:43]
    v_mfma_f32_16x16x32_bf16 v[44:47], v[108:111], v[84:87], v[44:47]
    v_mfma_f32_16x16x32_bf16 v[48:51], v[96:99], v[88:91], v[48:51]
    v_mfma_f32_16x16x32_bf16 v[52:55], v[100:103], v[88:91], v[52:55]
    v_mfma_f32_16x16x32_bf16 v[56:59], v[104:107], v[88:91], v[56:59]
    v_mfma_f32_16x16x32_bf16 v[60:63], v[108:111], v[88:91], v[60:63]
    v_mfma_f32_16x16x32_bf16 v[64:67], v[96:99], v[92:95], v[64:67]
    v_mfma_f32_16x16x32_bf16 v[68:71], v[100:103], v[92:95], v[68:71]
    v_mfma_f32_16x16x32_bf16 v[72:75], v[104:107], v[92:95], v[72:75]
    v_mfma_f32_16x16x32_bf16 v[76:79], v[108:111], v[92:95], v[76:79]
    s_waitcnt lgkmcnt(0)
    v_mfma_f32_16x16x32_bf16 v[16:19], v[128:131], v[112:115], v[16:19]
    v_mfma_f32_16x16x32_bf16 v[20:23], v[132:135], v[112:115], v[20:23]
    v_mfma_f32_16x16x32_bf16 v[24:27], v[136:139], v[112:115], v[24:27]
    v_mfma_f32_16x16x32_bf16 v[28:31], v[140:143], v[112:115], v[28:31]
    v_mfma_f32_16x16x32_bf16 v[32:35], v[128:131], v[116:119], v[32:35]
    v_mfma_f32_16x16x32_bf16 v[36:39], v[132:135], v[116:119], v[36:39]
    v_mfma_f32_16x16x32_bf16 v[40:43], v[136:139], v[116:119], v[40:43]
    v_mfma_f32_16x16x32_bf16 v[44:47], v[140:143], v[116:119], v[44:47]
    v_mfma_f32_16x16x32_bf16 v[48:51], v[128:131], v[120:123], v[48:51]
    v_mfma_f32_16x16x32_bf16 v[52:55], v[132:135], v[120:123], v[52:55]
    v_mfma_f32_16x16x32_bf16 v[56:59], v[136:139], v[120:123], v[56:59]
    v_mfma_f32_16x16x32_bf16 v[60:63], v[140:143], v[120:123], v[60:63]
    v_mfma_f32_16x16x32_bf16 v[64:67], v[128:131], v[124:127], v[64:67]
    v_mfma_f32_16x16x32_bf16 v[68:71], v[132:135], v[124:127], v[68:71]
    v_mfma_f32_16x16x32_bf16 v[72:75], v[136:139], v[124:127], v[72:75]
    v_mfma_f32_16x16x32_bf16 v[76:79], v[140:143], v[124:127], v[76:79]
    s_waitcnt vmcnt(8)
    ds_write_b128 v8, v[176:179] offset:36864
    ds_write_b128 v8, v[180:183] offset:41472
    ds_write_b128 v8, v[184:187] offset:46080
    ds_write_b128 v8, v[188:191] offset:50688
    ds_write_b128 v11, v[192:195] offset:36864
    ds_write_b128 v11, v[196:199] offset:41472
    ds_write_b128 v11, v[200:203] offset:46080
    ds_write_b128 v11, v[204:207] offset:50688
    s_waitcnt lgkmcnt(0)
    s_barrier
    buffer_load_dwordx4 v[176:179], v7, s[40:43], s64 offen
    buffer_load_dwordx4 v[180:183], v7, s[40:43], s65 offen
    buffer_load_dwordx4 v[184:187], v7, s[40:43], s66 offen
    buffer_load_dwordx4 v[188:191], v7, s[40:43], s67 offen
    buffer_load_dwordx4 v[192:195], v10, s[60:63], s68 offen
    buffer_load_dwordx4 v[196:199], v10, s[60:63], s69 offen
    buffer_load_dwordx4 v[200:203], v10, s[60:63], s70 offen
    buffer_load_dwordx4 v[204:207], v10, s[60:63], s71 offen
    v_add_u32 v7, 128, v7
    v_add_u32 v10, 245760, v10
    ds_read_b64_tr_b16 v[96:97], v13 offset:36864
    ds_read_b64_tr_b16 v[98:99], v13 offset:41472
    ds_read_b64_tr_b16 v[100:101], v13 offset:36896
    ds_read_b64_tr_b16 v[102:103], v13 offset:41504
    ds_read_b64_tr_b16 v[104:105], v13 offset:36928
    ds_read_b64_tr_b16 v[106:107], v13 offset:41536
    ds_read_b64_tr_b16 v[108:109], v13 offset:36960
    ds_read_b64_tr_b16 v[110:111], v13 offset:41568
    ds_read_b64 v[80:81], v12 offset:36864
    ds_read_b64 v[82:83], v12 offset:36896
    ds_read_b64 v[84:85], v12 offset:39168
    ds_read_b64 v[86:87], v12 offset:39200
    ds_read_b64 v[88:89], v12 offset:41472
    ds_read_b64 v[90:91], v12 offset:41504
    ds_read_b64 v[92:93], v12 offset:43776
    ds_read_b64 v[94:95], v12 offset:43808
    s_waitcnt lgkmcnt(0)
    ds_read_b64_tr_b16 v[128:129], v13 offset:46080
    ds_read_b64_tr_b16 v[130:131], v13 offset:50688
    ds_read_b64_tr_b16 v[132:133], v13 offset:46112
    ds_read_b64_tr_b16 v[134:135], v13 offset:50720
    ds_read_b64_tr_b16 v[136:137], v13 offset:46144
    ds_read_b64_tr_b16 v[138:139], v13 offset:50752
    ds_read_b64_tr_b16 v[140:141], v13 offset:46176
    ds_read_b64_tr_b16 v[142:143], v13 offset:50784
    ds_read_b64 v[112:113], v12 offset:36928
    ds_read_b64 v[114:115], v12 offset:36960
    ds_read_b64 v[116:117], v12 offset:39232
    ds_read_b64 v[118:119], v12 offset:39264
    ds_read_b64 v[120:121], v12 offset:41536
    ds_read_b64 v[122:123], v12 offset:41568
    ds_read_b64 v[124:125], v12 offset:43840
    ds_read_b64 v[126:127], v12 offset:43872
    v_mfma_f32_16x16x32_bf16 v[16:19], v[96:99], v[80:83], v[16:19]
    v_mfma_f32_16x16x32_bf16 v[20:23], v[100:103], v[80:83], v[20:23]
    v_mfma_f32_16x16x32_bf16 v[24:27], v[104:107], v[80:83], v[24:27]
    v_mfma_f32_16x16x32_bf16 v[28:31], v[108:111], v[80:83], v[28:31]
    v_mfma_f32_16x16x32_bf16 v[32:35], v[96:99], v[84:87], v[32:35]
    v_mfma_f32_16x16x32_bf16 v[36:39], v[100:103], v[84:87], v[36:39]
    v_mfma_f32_16x16x32_bf16 v[40:43], v[104:107], v[84:87], v[40:43]
    v_mfma_f32_16x16x32_bf16 v[44:47], v[108:111], v[84:87], v[44:47]
    v_mfma_f32_16x16x32_bf16 v[48:51], v[96:99], v[88:91], v[48:51]
    v_mfma_f32_16x16x32_bf16 v[52:55], v[100:103], v[88:91], v[52:55]
    v_mfma_f32_16x16x32_bf16 v[56:59], v[104:107], v[88:91], v[56:59]
    v_mfma_f32_16x16x32_bf16 v[60:63], v[108:111], v[88:91], v[60:63]
    v_mfma_f32_16x16x32_bf16 v[64:67], v[96:99], v[92:95], v[64:67]
    v_mfma_f32_16x16x32_bf16 v[68:71], v[100:103], v[92:95], v[68:71]
    v_mfma_f32_16x16x32_bf16 v[72:75], v[104:107], v[92:95], v[72:75]
    v_mfma_f32_16x16x32_bf16 v[76:79], v[108:111], v[92:95], v[76:79]
    s_waitcnt lgkmcnt(0)
    v_mfma_f32_16x16x32_bf16 v[16:19], v[128:131], v[112:115], v[16:19]
    v_mfma_f32_16x16x32_bf16 v[20:23], v[132:135], v[112:115], v[20:23]
    v_mfma_f32_16x16x32_bf16 v[24:27], v[136:139], v[112:115], v[24:27]
    v_mfma_f32_16x16x32_bf16 v[28:31], v[140:143], v[112:115], v[28:31]
    v_mfma_f32_16x16x32_bf16 v[32:35], v[128:131], v[116:119], v[32:35]
    v_mfma_f32_16x16x32_bf16 v[36:39], v[132:135], v[116:119], v[36:39]
    v_mfma_f32_16x16x32_bf16 v[40:43], v[136:139], v[116:119], v[40:43]
    v_mfma_f32_16x16x32_bf16 v[44:47], v[140:143], v[116:119], v[44:47]
    v_mfma_f32_16x16x32_bf16 v[48:51], v[128:131], v[120:123], v[48:51]
    v_mfma_f32_16x16x32_bf16 v[52:55], v[132:135], v[120:123], v[52:55]
    v_mfma_f32_16x16x32_bf16 v[56:59], v[136:139], v[120:123], v[56:59]
    v_mfma_f32_16x16x32_bf16 v[60:63], v[140:143], v[120:123], v[60:63]
    v_mfma_f32_16x16x32_bf16 v[64:67], v[128:131], v[124:127], v[64:67]
    v_mfma_f32_16x16x32_bf16 v[68:71], v[132:135], v[124:127], v[68:71]
    v_mfma_f32_16x16x32_bf16 v[72:75], v[136:139], v[124:127], v[72:75]
    v_mfma_f32_16x16x32_bf16 v[76:79], v[140:143], v[124:127], v[76:79]
    s_waitcnt vmcnt(8)
    ds_write_b128 v8, v[144:147] offset:0
    ds_write_b128 v8, v[148:151] offset:4608
    ds_write_b128 v8, v[152:155] offset:9216
    ds_write_b128 v8, v[156:159] offset:13824
    ds_write_b128 v11, v[160:163] offset:0
    ds_write_b128 v11, v[164:167] offset:4608
    ds_write_b128 v11, v[168:171] offset:9216
    ds_write_b128 v11, v[172:175] offset:13824
    s_waitcnt lgkmcnt(0)
    s_barrier
    ds_read_b64_tr_b16 v[96:97], v13 offset:0
    ds_read_b64_tr_b16 v[98:99], v13 offset:4608
    ds_read_b64_tr_b16 v[100:101], v13 offset:32
    ds_read_b64_tr_b16 v[102:103], v13 offset:4640
    ds_read_b64_tr_b16 v[104:105], v13 offset:64
    ds_read_b64_tr_b16 v[106:107], v13 offset:4672
    ds_read_b64_tr_b16 v[108:109], v13 offset:96
    ds_read_b64_tr_b16 v[110:111], v13 offset:4704
    ds_read_b64 v[80:81], v12 offset:0
    ds_read_b64 v[82:83], v12 offset:32
    ds_read_b64 v[84:85], v12 offset:2304
    ds_read_b64 v[86:87], v12 offset:2336
    ds_read_b64 v[88:89], v12 offset:4608
    ds_read_b64 v[90:91], v12 offset:4640
    ds_read_b64 v[92:93], v12 offset:6912
    ds_read_b64 v[94:95], v12 offset:6944
    s_waitcnt lgkmcnt(0)
    ds_read_b64_tr_b16 v[128:129], v13 offset:9216
    ds_read_b64_tr_b16 v[130:131], v13 offset:13824
    ds_read_b64_tr_b16 v[132:133], v13 offset:9248
    ds_read_b64_tr_b16 v[134:135], v13 offset:13856
    ds_read_b64_tr_b16 v[136:137], v13 offset:9280
    ds_read_b64_tr_b16 v[138:139], v13 offset:13888
    ds_read_b64_tr_b16 v[140:141], v13 offset:9312
    ds_read_b64_tr_b16 v[142:143], v13 offset:13920
    ds_read_b64 v[112:113], v12 offset:64
    ds_read_b64 v[114:115], v12 offset:96
    ds_read_b64 v[116:117], v12 offset:2368
    ds_read_b64 v[118:119], v12 offset:2400
    ds_read_b64 v[120:121], v12 offset:4672
    ds_read_b64 v[122:123], v12 offset:4704
    ds_read_b64 v[124:125], v12 offset:6976
    ds_read_b64 v[126:127], v12 offset:7008
    v_mfma_f32_16x16x32_bf16 v[16:19], v[96:99], v[80:83], v[16:19]
    v_mfma_f32_16x16x32_bf16 v[20:23], v[100:103], v[80:83], v[20:23]
    v_mfma_f32_16x16x32_bf16 v[24:27], v[104:107], v[80:83], v[24:27]
    v_mfma_f32_16x16x32_bf16 v[28:31], v[108:111], v[80:83], v[28:31]
    v_mfma_f32_16x16x32_bf16 v[32:35], v[96:99], v[84:87], v[32:35]
    v_mfma_f32_16x16x32_bf16 v[36:39], v[100:103], v[84:87], v[36:39]
    v_mfma_f32_16x16x32_bf16 v[40:43], v[104:107], v[84:87], v[40:43]
    v_mfma_f32_16x16x32_bf16 v[44:47], v[108:111], v[84:87], v[44:47]
    v_mfma_f32_16x16x32_bf16 v[48:51], v[96:99], v[88:91], v[48:51]
    v_mfma_f32_16x16x32_bf16 v[52:55], v[100:103], v[88:91], v[52:55]
    v_mfma_f32_16x16x32_bf16 v[56:59], v[104:107], v[88:91], v[56:59]
    v_mfma_f32_16x16x32_bf16 v[60:63], v[108:111], v[88:91], v[60:63]
    v_mfma_f32_16x16x32_bf16 v[64:67], v[96:99], v[92:95], v[64:67]
    v_mfma_f32_16x16x32_bf16 v[68:71], v[100:103], v[92:95], v[68:71]
    v_mfma_f32_16x16x32_bf16 v[72:75], v[104:107], v[92:95], v[72:75]
    v_mfma_f32_16x16x32_bf16 v[76:79], v[108:111], v[92:95], v[76:79]
    s_waitcnt lgkmcnt(0)
    v_mfma_f32_16x16x32_bf16 v[16:19], v[128:131], v[112:115], v[16:19]
    v_mfma_f32_16x16x32_bf16 v[20:23], v[132:135], v[112:115], v[20:23]
    v_mfma_f32_16x16x32_bf16 v[24:27], v[136:139], v[112:115], v[24:27]
    v_mfma_f32_16x16x32_bf16 v[28:31], v[140:143], v[112:115], v[28:31]
    v_mfma_f32_16x16x32_bf16 v[32:35], v[128:131], v[116:119], v[32:35]
    v_mfma_f32_16x16x32_bf16 v[36:39], v[132:135], v[116:119], v[36:39]
    v_mfma_f32_16x16x32_bf16 v[40:43], v[136:139], v[116:119], v[40:43]
    v_mfma_f32_16x16x32_bf16 v[44:47], v[140:143], v[116:119], v[44:47]
    v_mfma_f32_16x16x32_bf16 v[48:51], v[128:131], v[120:123], v[48:51]
    v_mfma_f32_16x16x32_bf16 v[52:55], v[132:135], v[120:123], v[52:55]
    v_mfma_f32_16x16x32_bf16 v[56:59], v[136:139], v[120:123], v[56:59]
    v_mfma_f32_16x16x32_bf16 v[60:63], v[140:143], v[120:123], v[60:63]
    v_mfma_f32_16x16x32_bf16 v[64:67], v[128:131], v[124:127], v[64:67]
    v_mfma_f32_16x16x32_bf16 v[68:71], v[132:135], v[124:127], v[68:71]
    v_mfma_f32_16x16x32_bf16 v[72:75], v[136:139], v[124:127], v[72:75]
    v_mfma_f32_16x16x32_bf16 v[76:79], v[140:143], v[124:127], v[76:79]
    s_waitcnt vmcnt(0)
    ds_write_b128 v8, v[176:179] offset:36864
    ds_write_b128 v8, v[180:183] offset:41472
    ds_write_b128 v8, v[184:187] offset:46080
    ds_write_b128 v8, v[188:191] offset:50688
    ds_write_b128 v11, v[192:195] offset:36864
    ds_write_b128 v11, v[196:199] offset:41472
    ds_write_b128 v11, v[200:203] offset:46080
    ds_write_b128 v11, v[204:207] offset:50688
    s_waitcnt lgkmcnt(0)
    s_barrier
    ds_read_b64_tr_b16 v[96:97], v13 offset:36864
    ds_read_b64_tr_b16 v[98:99], v13 offset:41472
    ds_read_b64_tr_b16 v[100:101], v13 offset:36896
    ds_read_b64_tr_b16 v[102:103], v13 offset:41504
    ds_read_b64_tr_b16 v[104:105], v13 offset:36928
    ds_read_b64_tr_b16 v[106:107], v13 offset:41536
    ds_read_b64_tr_b16 v[108:109], v13 offset:36960
    ds_read_b64_tr_b16 v[110:111], v13 offset:41568
    ds_read_b64 v[80:81], v12 offset:36864
    ds_read_b64 v[82:83], v12 offset:36896
    ds_read_b64 v[84:85], v12 offset:39168
    ds_read_b64 v[86:87], v12 offset:39200
    ds_read_b64 v[88:89], v12 offset:41472
    ds_read_b64 v[90:91], v12 offset:41504
    ds_read_b64 v[92:93], v12 offset:43776
    ds_read_b64 v[94:95], v12 offset:43808
    s_waitcnt lgkmcnt(0)
    ds_read_b64_tr_b16 v[128:129], v13 offset:46080
    ds_read_b64_tr_b16 v[130:131], v13 offset:50688
    ds_read_b64_tr_b16 v[132:133], v13 offset:46112
    ds_read_b64_tr_b16 v[134:135], v13 offset:50720
    ds_read_b64_tr_b16 v[136:137], v13 offset:46144
    ds_read_b64_tr_b16 v[138:139], v13 offset:50752
    ds_read_b64_tr_b16 v[140:141], v13 offset:46176
    ds_read_b64_tr_b16 v[142:143], v13 offset:50784
    ds_read_b64 v[112:113], v12 offset:36928
    ds_read_b64 v[114:115], v12 offset:36960
    ds_read_b64 v[116:117], v12 offset:39232
    ds_read_b64 v[118:119], v12 offset:39264
    ds_read_b64 v[120:121], v12 offset:41536
    ds_read_b64 v[122:123], v12 offset:41568
    ds_read_b64 v[124:125], v12 offset:43840
    ds_read_b64 v[126:127], v12 offset:43872
    v_mfma_f32_16x16x32_bf16 v[16:19], v[96:99], v[80:83], v[16:19]
    v_mfma_f32_16x16x32_bf16 v[20:23], v[100:103], v[80:83], v[20:23]
    v_mfma_f32_16x16x32_bf16 v[24:27], v[104:107], v[80:83], v[24:27]
    v_mfma_f32_16x16x32_bf16 v[28:31], v[108:111], v[80:83], v[28:31]
    v_mfma_f32_16x16x32_bf16 v[32:35], v[96:99], v[84:87], v[32:35]
    v_mfma_f32_16x16x32_bf16 v[36:39], v[100:103], v[84:87], v[36:39]
    v_mfma_f32_16x16x32_bf16 v[40:43], v[104:107], v[84:87], v[40:43]
    v_mfma_f32_16x16x32_bf16 v[44:47], v[108:111], v[84:87], v[44:47]
    v_mfma_f32_16x16x32_bf16 v[48:51], v[96:99], v[88:91], v[48:51]
    v_mfma_f32_16x16x32_bf16 v[52:55], v[100:103], v[88:91], v[52:55]
    v_mfma_f32_16x16x32_bf16 v[56:59], v[104:107], v[88:91], v[56:59]
    v_mfma_f32_16x16x32_bf16 v[60:63], v[108:111], v[88:91], v[60:63]
    v_mfma_f32_16x16x32_bf16 v[64:67], v[96:99], v[92:95], v[64:67]
    v_mfma_f32_16x16x32_bf16 v[68:71], v[100:103], v[92:95], v[68:71]
    v_mfma_f32_16x16x32_bf16 v[72:75], v[104:107], v[92:95], v[72:75]
    v_mfma_f32_16x16x32_bf16 v[76:79], v[108:111], v[92:95], v[76:79]
    s_waitcnt lgkmcnt(0)
    v_mfma_f32_16x16x32_bf16 v[16:19], v[128:131], v[112:115], v[16:19]
    v_mfma_f32_16x16x32_bf16 v[20:23], v[132:135], v[112:115], v[20:23]
    v_mfma_f32_16x16x32_bf16 v[24:27], v[136:139], v[112:115], v[24:27]
    v_mfma_f32_16x16x32_bf16 v[28:31], v[140:143], v[112:115], v[28:31]
    v_mfma_f32_16x16x32_bf16 v[32:35], v[128:131], v[116:119], v[32:35]
    v_mfma_f32_16x16x32_bf16 v[36:39], v[132:135], v[116:119], v[36:39]
    v_mfma_f32_16x16x32_bf16 v[40:43], v[136:139], v[116:119], v[40:43]
    v_mfma_f32_16x16x32_bf16 v[44:47], v[140:143], v[116:119], v[44:47]
    v_mfma_f32_16x16x32_bf16 v[48:51], v[128:131], v[120:123], v[48:51]
    v_mfma_f32_16x16x32_bf16 v[52:55], v[132:135], v[120:123], v[52:55]
    v_mfma_f32_16x16x32_bf16 v[56:59], v[136:139], v[120:123], v[56:59]
    v_mfma_f32_16x16x32_bf16 v[60:63], v[140:143], v[120:123], v[60:63]
    v_mfma_f32_16x16x32_bf16 v[64:67], v[128:131], v[124:127], v[64:67]
    v_mfma_f32_16x16x32_bf16 v[68:71], v[132:135], v[124:127], v[68:71]
    v_mfma_f32_16x16x32_bf16 v[72:75], v[136:139], v[124:127], v[72:75]
    v_mfma_f32_16x16x32_bf16 v[76:79], v[140:143], v[124:127], v[76:79]
    s_nop 7
    s_nop 7
    s_mul_i32 s7, s4, 128
    s_mul_i32 s12, s10, 64
    s_add_u32 s7, s7, s12
    v_add_u32 v5, s7, v3
    v_mul_u32_u24 v5, 3840, v5
    s_lshl_b32 s12, s5, 8
    s_lshl_b32 s13, s11, 7
    s_add_u32 s12, s12, s13
    v_lshl_add_u32 v5, v4, 3, v5
    v_add_u32 v5, s12, v5
    v_cvt_pk_bf16_f32 v154, v16, v17
    v_cvt_pk_bf16_f32 v155, v18, v19
    buffer_store_dwordx2 v[154:155], v5, s[52:55], 0 offen offset:0
    s_nop 1
    v_cvt_pk_bf16_f32 v154, v20, v21
    v_cvt_pk_bf16_f32 v155, v22, v23
    buffer_store_dwordx2 v[154:155], v5, s[52:55], 0 offen offset:32
    s_nop 1
    v_cvt_pk_bf16_f32 v154, v24, v25
    v_cvt_pk_bf16_f32 v155, v26, v27
    buffer_store_dwordx2 v[154:155], v5, s[52:55], 0 offen offset:64
    s_nop 1
    v_cvt_pk_bf16_f32 v154, v28, v29
    v_cvt_pk_bf16_f32 v155, v30, v31
    buffer_store_dwordx2 v[154:155], v5, s[52:55], 0 offen offset:96
    s_nop 1
    v_add_u32 v5, 61440, v5
    v_cvt_pk_bf16_f32 v154, v32, v33
    v_cvt_pk_bf16_f32 v155, v34, v35
    buffer_store_dwordx2 v[154:155], v5, s[52:55], 0 offen offset:0
    s_nop 1
    v_cvt_pk_bf16_f32 v154, v36, v37
    v_cvt_pk_bf16_f32 v155, v38, v39
    buffer_store_dwordx2 v[154:155], v5, s[52:55], 0 offen offset:32
    s_nop 1
    v_cvt_pk_bf16_f32 v154, v40, v41
    v_cvt_pk_bf16_f32 v155, v42, v43
    buffer_store_dwordx2 v[154:155], v5, s[52:55], 0 offen offset:64
    s_nop 1
    v_cvt_pk_bf16_f32 v154, v44, v45
    v_cvt_pk_bf16_f32 v155, v46, v47
    buffer_store_dwordx2 v[154:155], v5, s[52:55], 0 offen offset:96
    s_nop 1
    v_add_u32 v5, 61440, v5
    v_cvt_pk_bf16_f32 v154, v48, v49
    v_cvt_pk_bf16_f32 v155, v50, v51
    buffer_store_dwordx2 v[154:155], v5, s[52:55], 0 offen offset:0
    s_nop 1
    v_cvt_pk_bf16_f32 v154, v52, v53
    v_cvt_pk_bf16_f32 v155, v54, v55
    buffer_store_dwordx2 v[154:155], v5, s[52:55], 0 offen offset:32
    s_nop 1
    v_cvt_pk_bf16_f32 v154, v56, v57
    v_cvt_pk_bf16_f32 v155, v58, v59
    buffer_store_dwordx2 v[154:155], v5, s[52:55], 0 offen offset:64
    s_nop 1
    v_cvt_pk_bf16_f32 v154, v60, v61
    v_cvt_pk_bf16_f32 v155, v62, v63
    buffer_store_dwordx2 v[154:155], v5, s[52:55], 0 offen offset:96
    s_nop 1
    v_add_u32 v5, 61440, v5
    v_cvt_pk_bf16_f32 v154, v64, v65
    v_cvt_pk_bf16_f32 v155, v66, v67
    buffer_store_dwordx2 v[154:155], v5, s[52:55], 0 offen offset:0
    s_nop 1
    v_cvt_pk_bf16_f32 v154, v68, v69
    v_cvt_pk_bf16_f32 v155, v70, v71
    buffer_store_dwordx2 v[154:155], v5, s[52:55], 0 offen offset:32
    s_nop 1
    v_cvt_pk_bf16_f32 v154, v72, v73
    v_cvt_pk_bf16_f32 v155, v74, v75
    buffer_store_dwordx2 v[154:155], v5, s[52:55], 0 offen offset:64
    s_nop 1
    v_cvt_pk_bf16_f32 v154, v76, v77
    v_cvt_pk_bf16_f32 v155, v78, v79
    buffer_store_dwordx2 v[154:155], v5, s[52:55], 0 offen offset:96
    s_nop 1
qkv_1_kernel_end:
    s_endpgm
.globl kv_1_kernel
.p2align 8
.type kv_1_kernel,@function
kv_1_kernel:
    s_cmp_ge_u32 s2, 256
    s_cbranch_scc1 kv_1_kernel_end
    s_load_dwordx16 s[16:31], s[0:1], 0
    s_load_dwordx4 s[32:35], s[0:1], 64
    s_load_dwordx2 s[36:37], s[0:1], 80
    s_waitcnt lgkmcnt(0)
    s_and_b32 s4, s2, 31
    s_lshr_b32 s5, s2, 5
    s_mov_b32 s48, s20
    s_mov_b32 s49, s21
    s_mov_b32 s50, 0x6400
    s_mov_b32 s51, 0x00020000
    s_mul_i32 s7, s4, 800
    v_lshlrev_b32 v40, 2, v0
    v_cmp_gt_u32 vcc, 200, v0
    s_and_saveexec_b64 s[8:9], vcc
    buffer_load_dword v41, v40, s[48:51], s7 offen
    s_waitcnt vmcnt(0)
    v_lshlrev_b32 v42, 16, v41
    v_and_b32 v43, 0xffff0000, v41
    v_lshlrev_b32 v40, 3, v0
    ds_write_b64 v40, v[42:43] offset:0
    s_mov_b64 exec, s[8:9]
    s_add_u32 s40, s36, 0x400000
    s_addc_u32 s41, s37, 0
    s_mov_b32 s42, 0x780000
    s_mov_b32 s43, 0x00020000
    s_add_u32 s44, s36, 0xc00000
    s_addc_u32 s45, s37, 0
    s_mov_b32 s46, 0x180000
    s_mov_b32 s47, 0x00020000
    s_lshl_b32 s6, s5, 8
    v_add_u32 v1, s6, v0
    v_mul_u32_u24 v1, 3840, v1
    s_mul_i32 s7, s4, 40
    s_add_u32 s7, s7, 1280
    v_add_u32 v1, s7, v1
    buffer_load_dwordx2 v[44:45], v1, s[40:43], 0 offen offset:0
    buffer_load_dwordx2 v[46:47], v1, s[40:43], 0 offen offset:8
    buffer_load_dwordx2 v[48:49], v1, s[40:43], 0 offen offset:16
    buffer_load_dwordx2 v[50:51], v1, s[40:43], 0 offen offset:24
    buffer_load_dwordx2 v[52:53], v1, s[40:43], 0 offen offset:32
    buffer_load_dwordx2 v[54:55], v1, s[40:43], 0 offen offset:1280
    buffer_load_dwordx2 v[56:57], v1, s[40:43], 0 offen offset:1288
    buffer_load_dwordx2 v[58:59], v1, s[40:43], 0 offen offset:1296
    buffer_load_dwordx2 v[60:61], v1, s[40:43], 0 offen offset:1304
    buffer_load_dwordx2 v[62:63], v1, s[40:43], 0 offen offset:1312
    s_waitcnt vmcnt(0) lgkmcnt(0)
    s_barrier
    v_lshlrev_b32 v64, 16, v44
    v_and_b32 v65, 0xffff0000, v44
    v_lshlrev_b32 v66, 16, v45
    v_and_b32 v67, 0xffff0000, v45
    v_lshlrev_b32 v68, 16, v46
    v_and_b32 v69, 0xffff0000, v46
    v_lshlrev_b32 v70, 16, v47
    v_and_b32 v71, 0xffff0000, v47
    v_lshlrev_b32 v72, 16, v48
    v_and_b32 v73, 0xffff0000, v48
    v_lshlrev_b32 v74, 16, v49
    v_and_b32 v75, 0xffff0000, v49
    v_lshlrev_b32 v76, 16, v50
    v_and_b32 v77, 0xffff0000, v50
    v_lshlrev_b32 v78, 16, v51
    v_and_b32 v79, 0xffff0000, v51
    v_lshlrev_b32 v80, 16, v52
    v_and_b32 v81, 0xffff0000, v52
    v_lshlrev_b32 v82, 16, v53
    v_and_b32 v83, 0xffff0000, v53
    v_mov_b32 v2, 0
    v_mov_b32 v84, 0
    v_mov_b32 v85, 0
    v_mov_b32 v86, 0
    v_mov_b32 v87, 0
    v_mov_b32 v88, 0
    v_mov_b32 v89, 0
    v_mov_b32 v90, 0
    v_mov_b32 v91, 0
    v_mov_b32 v92, 0
    v_mov_b32 v93, 0
    v_mov_b32 v94, 0
    v_mov_b32 v95, 0
    v_mov_b32 v96, 0
    v_mov_b32 v97, 0
    v_mov_b32 v98, 0
    v_mov_b32 v99, 0
    v_mov_b32 v100, 0
    v_mov_b32 v101, 0
    v_mov_b32 v102, 0
    v_mov_b32 v103, 0
    ds_read_b128 v[128:131], v2 offset:0
    ds_read_b128 v[132:135], v2 offset:16
    ds_read_b128 v[136:139], v2 offset:32
    ds_read_b128 v[140:143], v2 offset:48
    ds_read_b128 v[144:147], v2 offset:64
    ds_read_b128 v[148:151], v2 offset:80
    ds_read_b128 v[152:155], v2 offset:96
    ds_read_b128 v[156:159], v2 offset:112
    ds_read_b128 v[160:163], v2 offset:128
    ds_read_b128 v[164:167], v2 offset:144
    s_waitcnt lgkmcnt(5)
    v_pk_fma_f32 v[84:85], v[64:65], v[128:129], v[84:85] op_sel:[0,0,0] op_sel_hi:[0,1,1]
    v_pk_fma_f32 v[86:87], v[64:65], v[130:131], v[86:87] op_sel:[0,0,0] op_sel_hi:[0,1,1]
    v_pk_fma_f32 v[88:89], v[64:65], v[132:133], v[88:89] op_sel:[0,0,0] op_sel_hi:[0,1,1]
    v_pk_fma_f32 v[90:91], v[64:65], v[134:135], v[90:91] op_sel:[0,0,0] op_sel_hi:[0,1,1]
    v_pk_fma_f32 v[92:93], v[64:65], v[136:137], v[92:93] op_sel:[0,0,0] op_sel_hi:[0,1,1]
    v_pk_fma_f32 v[94:95], v[64:65], v[138:139], v[94:95] op_sel:[0,0,0] op_sel_hi:[0,1,1]
    v_pk_fma_f32 v[96:97], v[64:65], v[140:141], v[96:97] op_sel:[0,0,0] op_sel_hi:[0,1,1]
    v_pk_fma_f32 v[98:99], v[64:65], v[142:143], v[98:99] op_sel:[0,0,0] op_sel_hi:[0,1,1]
    v_pk_fma_f32 v[100:101], v[64:65], v[144:145], v[100:101] op_sel:[0,0,0] op_sel_hi:[0,1,1]
    v_pk_fma_f32 v[102:103], v[64:65], v[146:147], v[102:103] op_sel:[0,0,0] op_sel_hi:[0,1,1]
    ds_read_b128 v[128:131], v2 offset:160
    ds_read_b128 v[132:135], v2 offset:176
    ds_read_b128 v[136:139], v2 offset:192
    ds_read_b128 v[140:143], v2 offset:208
    ds_read_b128 v[144:147], v2 offset:224
    s_waitcnt lgkmcnt(5)
    v_pk_fma_f32 v[84:85], v[64:65], v[148:149], v[84:85] op_sel:[1,0,0] op_sel_hi:[1,1,1]
    v_pk_fma_f32 v[86:87], v[64:65], v[150:151], v[86:87] op_sel:[1,0,0] op_sel_hi:[1,1,1]
    v_pk_fma_f32 v[88:89], v[64:65], v[152:153], v[88:89] op_sel:[1,0,0] op_sel_hi:[1,1,1]
    v_pk_fma_f32 v[90:91], v[64:65], v[154:155], v[90:91] op_sel:[1,0,0] op_sel_hi:[1,1,1]
    v_pk_fma_f32 v[92:93], v[64:65], v[156:157], v[92:93] op_sel:[1,0,0] op_sel_hi:[1,1,1]
    v_pk_fma_f32 v[94:95], v[64:65], v[158:159], v[94:95] op_sel:[1,0,0] op_sel_hi:[1,1,1]
    v_pk_fma_f32 v[96:97], v[64:65], v[160:161], v[96:97] op_sel:[1,0,0] op_sel_hi:[1,1,1]
    v_pk_fma_f32 v[98:99], v[64:65], v[162:163], v[98:99] op_sel:[1,0,0] op_sel_hi:[1,1,1]
    v_pk_fma_f32 v[100:101], v[64:65], v[164:165], v[100:101] op_sel:[1,0,0] op_sel_hi:[1,1,1]
    v_pk_fma_f32 v[102:103], v[64:65], v[166:167], v[102:103] op_sel:[1,0,0] op_sel_hi:[1,1,1]
    ds_read_b128 v[148:151], v2 offset:240
    ds_read_b128 v[152:155], v2 offset:256
    ds_read_b128 v[156:159], v2 offset:272
    ds_read_b128 v[160:163], v2 offset:288
    ds_read_b128 v[164:167], v2 offset:304
    s_waitcnt lgkmcnt(5)
    v_pk_fma_f32 v[84:85], v[66:67], v[128:129], v[84:85] op_sel:[0,0,0] op_sel_hi:[0,1,1]
    v_pk_fma_f32 v[86:87], v[66:67], v[130:131], v[86:87] op_sel:[0,0,0] op_sel_hi:[0,1,1]
    v_pk_fma_f32 v[88:89], v[66:67], v[132:133], v[88:89] op_sel:[0,0,0] op_sel_hi:[0,1,1]
    v_pk_fma_f32 v[90:91], v[66:67], v[134:135], v[90:91] op_sel:[0,0,0] op_sel_hi:[0,1,1]
    v_pk_fma_f32 v[92:93], v[66:67], v[136:137], v[92:93] op_sel:[0,0,0] op_sel_hi:[0,1,1]
    v_pk_fma_f32 v[94:95], v[66:67], v[138:139], v[94:95] op_sel:[0,0,0] op_sel_hi:[0,1,1]
    v_pk_fma_f32 v[96:97], v[66:67], v[140:141], v[96:97] op_sel:[0,0,0] op_sel_hi:[0,1,1]
    v_pk_fma_f32 v[98:99], v[66:67], v[142:143], v[98:99] op_sel:[0,0,0] op_sel_hi:[0,1,1]
    v_pk_fma_f32 v[100:101], v[66:67], v[144:145], v[100:101] op_sel:[0,0,0] op_sel_hi:[0,1,1]
    v_pk_fma_f32 v[102:103], v[66:67], v[146:147], v[102:103] op_sel:[0,0,0] op_sel_hi:[0,1,1]
    ds_read_b128 v[128:131], v2 offset:320
    ds_read_b128 v[132:135], v2 offset:336
    ds_read_b128 v[136:139], v2 offset:352
    ds_read_b128 v[140:143], v2 offset:368
    ds_read_b128 v[144:147], v2 offset:384
    s_waitcnt lgkmcnt(5)
    v_pk_fma_f32 v[84:85], v[66:67], v[148:149], v[84:85] op_sel:[1,0,0] op_sel_hi:[1,1,1]
    v_pk_fma_f32 v[86:87], v[66:67], v[150:151], v[86:87] op_sel:[1,0,0] op_sel_hi:[1,1,1]
    v_pk_fma_f32 v[88:89], v[66:67], v[152:153], v[88:89] op_sel:[1,0,0] op_sel_hi:[1,1,1]
    v_pk_fma_f32 v[90:91], v[66:67], v[154:155], v[90:91] op_sel:[1,0,0] op_sel_hi:[1,1,1]
    v_pk_fma_f32 v[92:93], v[66:67], v[156:157], v[92:93] op_sel:[1,0,0] op_sel_hi:[1,1,1]
    v_pk_fma_f32 v[94:95], v[66:67], v[158:159], v[94:95] op_sel:[1,0,0] op_sel_hi:[1,1,1]
    v_pk_fma_f32 v[96:97], v[66:67], v[160:161], v[96:97] op_sel:[1,0,0] op_sel_hi:[1,1,1]
    v_pk_fma_f32 v[98:99], v[66:67], v[162:163], v[98:99] op_sel:[1,0,0] op_sel_hi:[1,1,1]
    v_pk_fma_f32 v[100:101], v[66:67], v[164:165], v[100:101] op_sel:[1,0,0] op_sel_hi:[1,1,1]
    v_pk_fma_f32 v[102:103], v[66:67], v[166:167], v[102:103] op_sel:[1,0,0] op_sel_hi:[1,1,1]
    ds_read_b128 v[148:151], v2 offset:400
    ds_read_b128 v[152:155], v2 offset:416
    ds_read_b128 v[156:159], v2 offset:432
    ds_read_b128 v[160:163], v2 offset:448
    ds_read_b128 v[164:167], v2 offset:464
    s_waitcnt lgkmcnt(5)
    v_pk_fma_f32 v[84:85], v[68:69], v[128:129], v[84:85] op_sel:[0,0,0] op_sel_hi:[0,1,1]
    v_pk_fma_f32 v[86:87], v[68:69], v[130:131], v[86:87] op_sel:[0,0,0] op_sel_hi:[0,1,1]
    v_pk_fma_f32 v[88:89], v[68:69], v[132:133], v[88:89] op_sel:[0,0,0] op_sel_hi:[0,1,1]
    v_pk_fma_f32 v[90:91], v[68:69], v[134:135], v[90:91] op_sel:[0,0,0] op_sel_hi:[0,1,1]
    v_pk_fma_f32 v[92:93], v[68:69], v[136:137], v[92:93] op_sel:[0,0,0] op_sel_hi:[0,1,1]
    v_pk_fma_f32 v[94:95], v[68:69], v[138:139], v[94:95] op_sel:[0,0,0] op_sel_hi:[0,1,1]
    v_pk_fma_f32 v[96:97], v[68:69], v[140:141], v[96:97] op_sel:[0,0,0] op_sel_hi:[0,1,1]
    v_pk_fma_f32 v[98:99], v[68:69], v[142:143], v[98:99] op_sel:[0,0,0] op_sel_hi:[0,1,1]
    v_pk_fma_f32 v[100:101], v[68:69], v[144:145], v[100:101] op_sel:[0,0,0] op_sel_hi:[0,1,1]
    v_pk_fma_f32 v[102:103], v[68:69], v[146:147], v[102:103] op_sel:[0,0,0] op_sel_hi:[0,1,1]
    ds_read_b128 v[128:131], v2 offset:480
    ds_read_b128 v[132:135], v2 offset:496
    ds_read_b128 v[136:139], v2 offset:512
    ds_read_b128 v[140:143], v2 offset:528
    ds_read_b128 v[144:147], v2 offset:544
    s_waitcnt lgkmcnt(5)
    v_pk_fma_f32 v[84:85], v[68:69], v[148:149], v[84:85] op_sel:[1,0,0] op_sel_hi:[1,1,1]
    v_pk_fma_f32 v[86:87], v[68:69], v[150:151], v[86:87] op_sel:[1,0,0] op_sel_hi:[1,1,1]
    v_pk_fma_f32 v[88:89], v[68:69], v[152:153], v[88:89] op_sel:[1,0,0] op_sel_hi:[1,1,1]
    v_pk_fma_f32 v[90:91], v[68:69], v[154:155], v[90:91] op_sel:[1,0,0] op_sel_hi:[1,1,1]
    v_pk_fma_f32 v[92:93], v[68:69], v[156:157], v[92:93] op_sel:[1,0,0] op_sel_hi:[1,1,1]
    v_pk_fma_f32 v[94:95], v[68:69], v[158:159], v[94:95] op_sel:[1,0,0] op_sel_hi:[1,1,1]
    v_pk_fma_f32 v[96:97], v[68:69], v[160:161], v[96:97] op_sel:[1,0,0] op_sel_hi:[1,1,1]
    v_pk_fma_f32 v[98:99], v[68:69], v[162:163], v[98:99] op_sel:[1,0,0] op_sel_hi:[1,1,1]
    v_pk_fma_f32 v[100:101], v[68:69], v[164:165], v[100:101] op_sel:[1,0,0] op_sel_hi:[1,1,1]
    v_pk_fma_f32 v[102:103], v[68:69], v[166:167], v[102:103] op_sel:[1,0,0] op_sel_hi:[1,1,1]
    ds_read_b128 v[148:151], v2 offset:560
    ds_read_b128 v[152:155], v2 offset:576
    ds_read_b128 v[156:159], v2 offset:592
    ds_read_b128 v[160:163], v2 offset:608
    ds_read_b128 v[164:167], v2 offset:624
    s_waitcnt lgkmcnt(5)
    v_pk_fma_f32 v[84:85], v[70:71], v[128:129], v[84:85] op_sel:[0,0,0] op_sel_hi:[0,1,1]
    v_pk_fma_f32 v[86:87], v[70:71], v[130:131], v[86:87] op_sel:[0,0,0] op_sel_hi:[0,1,1]
    v_pk_fma_f32 v[88:89], v[70:71], v[132:133], v[88:89] op_sel:[0,0,0] op_sel_hi:[0,1,1]
    v_pk_fma_f32 v[90:91], v[70:71], v[134:135], v[90:91] op_sel:[0,0,0] op_sel_hi:[0,1,1]
    v_pk_fma_f32 v[92:93], v[70:71], v[136:137], v[92:93] op_sel:[0,0,0] op_sel_hi:[0,1,1]
    v_pk_fma_f32 v[94:95], v[70:71], v[138:139], v[94:95] op_sel:[0,0,0] op_sel_hi:[0,1,1]
    v_pk_fma_f32 v[96:97], v[70:71], v[140:141], v[96:97] op_sel:[0,0,0] op_sel_hi:[0,1,1]
    v_pk_fma_f32 v[98:99], v[70:71], v[142:143], v[98:99] op_sel:[0,0,0] op_sel_hi:[0,1,1]
    v_pk_fma_f32 v[100:101], v[70:71], v[144:145], v[100:101] op_sel:[0,0,0] op_sel_hi:[0,1,1]
    v_pk_fma_f32 v[102:103], v[70:71], v[146:147], v[102:103] op_sel:[0,0,0] op_sel_hi:[0,1,1]
    ds_read_b128 v[128:131], v2 offset:640
    ds_read_b128 v[132:135], v2 offset:656
    ds_read_b128 v[136:139], v2 offset:672
    ds_read_b128 v[140:143], v2 offset:688
    ds_read_b128 v[144:147], v2 offset:704
    s_waitcnt lgkmcnt(5)
    v_pk_fma_f32 v[84:85], v[70:71], v[148:149], v[84:85] op_sel:[1,0,0] op_sel_hi:[1,1,1]
    v_pk_fma_f32 v[86:87], v[70:71], v[150:151], v[86:87] op_sel:[1,0,0] op_sel_hi:[1,1,1]
    v_pk_fma_f32 v[88:89], v[70:71], v[152:153], v[88:89] op_sel:[1,0,0] op_sel_hi:[1,1,1]
    v_pk_fma_f32 v[90:91], v[70:71], v[154:155], v[90:91] op_sel:[1,0,0] op_sel_hi:[1,1,1]
    v_pk_fma_f32 v[92:93], v[70:71], v[156:157], v[92:93] op_sel:[1,0,0] op_sel_hi:[1,1,1]
    v_pk_fma_f32 v[94:95], v[70:71], v[158:159], v[94:95] op_sel:[1,0,0] op_sel_hi:[1,1,1]
    v_pk_fma_f32 v[96:97], v[70:71], v[160:161], v[96:97] op_sel:[1,0,0] op_sel_hi:[1,1,1]
    v_pk_fma_f32 v[98:99], v[70:71], v[162:163], v[98:99] op_sel:[1,0,0] op_sel_hi:[1,1,1]
    v_pk_fma_f32 v[100:101], v[70:71], v[164:165], v[100:101] op_sel:[1,0,0] op_sel_hi:[1,1,1]
    v_pk_fma_f32 v[102:103], v[70:71], v[166:167], v[102:103] op_sel:[1,0,0] op_sel_hi:[1,1,1]
    ds_read_b128 v[148:151], v2 offset:720
    ds_read_b128 v[152:155], v2 offset:736
    ds_read_b128 v[156:159], v2 offset:752
    ds_read_b128 v[160:163], v2 offset:768
    ds_read_b128 v[164:167], v2 offset:784
    s_waitcnt lgkmcnt(5)
    v_pk_fma_f32 v[84:85], v[72:73], v[128:129], v[84:85] op_sel:[0,0,0] op_sel_hi:[0,1,1]
    v_pk_fma_f32 v[86:87], v[72:73], v[130:131], v[86:87] op_sel:[0,0,0] op_sel_hi:[0,1,1]
    v_pk_fma_f32 v[88:89], v[72:73], v[132:133], v[88:89] op_sel:[0,0,0] op_sel_hi:[0,1,1]
    v_pk_fma_f32 v[90:91], v[72:73], v[134:135], v[90:91] op_sel:[0,0,0] op_sel_hi:[0,1,1]
    v_pk_fma_f32 v[92:93], v[72:73], v[136:137], v[92:93] op_sel:[0,0,0] op_sel_hi:[0,1,1]
    v_pk_fma_f32 v[94:95], v[72:73], v[138:139], v[94:95] op_sel:[0,0,0] op_sel_hi:[0,1,1]
    v_pk_fma_f32 v[96:97], v[72:73], v[140:141], v[96:97] op_sel:[0,0,0] op_sel_hi:[0,1,1]
    v_pk_fma_f32 v[98:99], v[72:73], v[142:143], v[98:99] op_sel:[0,0,0] op_sel_hi:[0,1,1]
    v_pk_fma_f32 v[100:101], v[72:73], v[144:145], v[100:101] op_sel:[0,0,0] op_sel_hi:[0,1,1]
    v_pk_fma_f32 v[102:103], v[72:73], v[146:147], v[102:103] op_sel:[0,0,0] op_sel_hi:[0,1,1]
    ds_read_b128 v[128:131], v2 offset:800
    ds_read_b128 v[132:135], v2 offset:816
    ds_read_b128 v[136:139], v2 offset:832
    ds_read_b128 v[140:143], v2 offset:848
    ds_read_b128 v[144:147], v2 offset:864
    s_waitcnt lgkmcnt(5)
    v_pk_fma_f32 v[84:85], v[72:73], v[148:149], v[84:85] op_sel:[1,0,0] op_sel_hi:[1,1,1]
    v_pk_fma_f32 v[86:87], v[72:73], v[150:151], v[86:87] op_sel:[1,0,0] op_sel_hi:[1,1,1]
    v_pk_fma_f32 v[88:89], v[72:73], v[152:153], v[88:89] op_sel:[1,0,0] op_sel_hi:[1,1,1]
    v_pk_fma_f32 v[90:91], v[72:73], v[154:155], v[90:91] op_sel:[1,0,0] op_sel_hi:[1,1,1]
    v_pk_fma_f32 v[92:93], v[72:73], v[156:157], v[92:93] op_sel:[1,0,0] op_sel_hi:[1,1,1]
    v_pk_fma_f32 v[94:95], v[72:73], v[158:159], v[94:95] op_sel:[1,0,0] op_sel_hi:[1,1,1]
    v_pk_fma_f32 v[96:97], v[72:73], v[160:161], v[96:97] op_sel:[1,0,0] op_sel_hi:[1,1,1]
    v_pk_fma_f32 v[98:99], v[72:73], v[162:163], v[98:99] op_sel:[1,0,0] op_sel_hi:[1,1,1]
    v_pk_fma_f32 v[100:101], v[72:73], v[164:165], v[100:101] op_sel:[1,0,0] op_sel_hi:[1,1,1]
    v_pk_fma_f32 v[102:103], v[72:73], v[166:167], v[102:103] op_sel:[1,0,0] op_sel_hi:[1,1,1]
    ds_read_b128 v[148:151], v2 offset:880
    ds_read_b128 v[152:155], v2 offset:896
    ds_read_b128 v[156:159], v2 offset:912
    ds_read_b128 v[160:163], v2 offset:928
    ds_read_b128 v[164:167], v2 offset:944
    s_waitcnt lgkmcnt(5)
    v_pk_fma_f32 v[84:85], v[74:75], v[128:129], v[84:85] op_sel:[0,0,0] op_sel_hi:[0,1,1]
    v_pk_fma_f32 v[86:87], v[74:75], v[130:131], v[86:87] op_sel:[0,0,0] op_sel_hi:[0,1,1]
    v_pk_fma_f32 v[88:89], v[74:75], v[132:133], v[88:89] op_sel:[0,0,0] op_sel_hi:[0,1,1]
    v_pk_fma_f32 v[90:91], v[74:75], v[134:135], v[90:91] op_sel:[0,0,0] op_sel_hi:[0,1,1]
    v_pk_fma_f32 v[92:93], v[74:75], v[136:137], v[92:93] op_sel:[0,0,0] op_sel_hi:[0,1,1]
    v_pk_fma_f32 v[94:95], v[74:75], v[138:139], v[94:95] op_sel:[0,0,0] op_sel_hi:[0,1,1]
    v_pk_fma_f32 v[96:97], v[74:75], v[140:141], v[96:97] op_sel:[0,0,0] op_sel_hi:[0,1,1]
    v_pk_fma_f32 v[98:99], v[74:75], v[142:143], v[98:99] op_sel:[0,0,0] op_sel_hi:[0,1,1]
    v_pk_fma_f32 v[100:101], v[74:75], v[144:145], v[100:101] op_sel:[0,0,0] op_sel_hi:[0,1,1]
    v_pk_fma_f32 v[102:103], v[74:75], v[146:147], v[102:103] op_sel:[0,0,0] op_sel_hi:[0,1,1]
    ds_read_b128 v[128:131], v2 offset:960
    ds_read_b128 v[132:135], v2 offset:976
    ds_read_b128 v[136:139], v2 offset:992
    ds_read_b128 v[140:143], v2 offset:1008
    ds_read_b128 v[144:147], v2 offset:1024
    s_waitcnt lgkmcnt(5)
    v_pk_fma_f32 v[84:85], v[74:75], v[148:149], v[84:85] op_sel:[1,0,0] op_sel_hi:[1,1,1]
    v_pk_fma_f32 v[86:87], v[74:75], v[150:151], v[86:87] op_sel:[1,0,0] op_sel_hi:[1,1,1]
    v_pk_fma_f32 v[88:89], v[74:75], v[152:153], v[88:89] op_sel:[1,0,0] op_sel_hi:[1,1,1]
    v_pk_fma_f32 v[90:91], v[74:75], v[154:155], v[90:91] op_sel:[1,0,0] op_sel_hi:[1,1,1]
    v_pk_fma_f32 v[92:93], v[74:75], v[156:157], v[92:93] op_sel:[1,0,0] op_sel_hi:[1,1,1]
    v_pk_fma_f32 v[94:95], v[74:75], v[158:159], v[94:95] op_sel:[1,0,0] op_sel_hi:[1,1,1]
    v_pk_fma_f32 v[96:97], v[74:75], v[160:161], v[96:97] op_sel:[1,0,0] op_sel_hi:[1,1,1]
    v_pk_fma_f32 v[98:99], v[74:75], v[162:163], v[98:99] op_sel:[1,0,0] op_sel_hi:[1,1,1]
    v_pk_fma_f32 v[100:101], v[74:75], v[164:165], v[100:101] op_sel:[1,0,0] op_sel_hi:[1,1,1]
    v_pk_fma_f32 v[102:103], v[74:75], v[166:167], v[102:103] op_sel:[1,0,0] op_sel_hi:[1,1,1]
    ds_read_b128 v[148:151], v2 offset:1040
    ds_read_b128 v[152:155], v2 offset:1056
    ds_read_b128 v[156:159], v2 offset:1072
    ds_read_b128 v[160:163], v2 offset:1088
    ds_read_b128 v[164:167], v2 offset:1104
    s_waitcnt lgkmcnt(5)
    v_pk_fma_f32 v[84:85], v[76:77], v[128:129], v[84:85] op_sel:[0,0,0] op_sel_hi:[0,1,1]
    v_pk_fma_f32 v[86:87], v[76:77], v[130:131], v[86:87] op_sel:[0,0,0] op_sel_hi:[0,1,1]
    v_pk_fma_f32 v[88:89], v[76:77], v[132:133], v[88:89] op_sel:[0,0,0] op_sel_hi:[0,1,1]
    v_pk_fma_f32 v[90:91], v[76:77], v[134:135], v[90:91] op_sel:[0,0,0] op_sel_hi:[0,1,1]
    v_pk_fma_f32 v[92:93], v[76:77], v[136:137], v[92:93] op_sel:[0,0,0] op_sel_hi:[0,1,1]
    v_pk_fma_f32 v[94:95], v[76:77], v[138:139], v[94:95] op_sel:[0,0,0] op_sel_hi:[0,1,1]
    v_pk_fma_f32 v[96:97], v[76:77], v[140:141], v[96:97] op_sel:[0,0,0] op_sel_hi:[0,1,1]
    v_pk_fma_f32 v[98:99], v[76:77], v[142:143], v[98:99] op_sel:[0,0,0] op_sel_hi:[0,1,1]
    v_pk_fma_f32 v[100:101], v[76:77], v[144:145], v[100:101] op_sel:[0,0,0] op_sel_hi:[0,1,1]
    v_pk_fma_f32 v[102:103], v[76:77], v[146:147], v[102:103] op_sel:[0,0,0] op_sel_hi:[0,1,1]
    ds_read_b128 v[128:131], v2 offset:1120
    ds_read_b128 v[132:135], v2 offset:1136
    ds_read_b128 v[136:139], v2 offset:1152
    ds_read_b128 v[140:143], v2 offset:1168
    ds_read_b128 v[144:147], v2 offset:1184
    s_waitcnt lgkmcnt(5)
    v_pk_fma_f32 v[84:85], v[76:77], v[148:149], v[84:85] op_sel:[1,0,0] op_sel_hi:[1,1,1]
    v_pk_fma_f32 v[86:87], v[76:77], v[150:151], v[86:87] op_sel:[1,0,0] op_sel_hi:[1,1,1]
    v_pk_fma_f32 v[88:89], v[76:77], v[152:153], v[88:89] op_sel:[1,0,0] op_sel_hi:[1,1,1]
    v_pk_fma_f32 v[90:91], v[76:77], v[154:155], v[90:91] op_sel:[1,0,0] op_sel_hi:[1,1,1]
    v_pk_fma_f32 v[92:93], v[76:77], v[156:157], v[92:93] op_sel:[1,0,0] op_sel_hi:[1,1,1]
    v_pk_fma_f32 v[94:95], v[76:77], v[158:159], v[94:95] op_sel:[1,0,0] op_sel_hi:[1,1,1]
    v_pk_fma_f32 v[96:97], v[76:77], v[160:161], v[96:97] op_sel:[1,0,0] op_sel_hi:[1,1,1]
    v_pk_fma_f32 v[98:99], v[76:77], v[162:163], v[98:99] op_sel:[1,0,0] op_sel_hi:[1,1,1]
    v_pk_fma_f32 v[100:101], v[76:77], v[164:165], v[100:101] op_sel:[1,0,0] op_sel_hi:[1,1,1]
    v_pk_fma_f32 v[102:103], v[76:77], v[166:167], v[102:103] op_sel:[1,0,0] op_sel_hi:[1,1,1]
    ds_read_b128 v[148:151], v2 offset:1200
    ds_read_b128 v[152:155], v2 offset:1216
    ds_read_b128 v[156:159], v2 offset:1232
    ds_read_b128 v[160:163], v2 offset:1248
    ds_read_b128 v[164:167], v2 offset:1264
    s_waitcnt lgkmcnt(5)
    v_pk_fma_f32 v[84:85], v[78:79], v[128:129], v[84:85] op_sel:[0,0,0] op_sel_hi:[0,1,1]
    v_pk_fma_f32 v[86:87], v[78:79], v[130:131], v[86:87] op_sel:[0,0,0] op_sel_hi:[0,1,1]
    v_pk_fma_f32 v[88:89], v[78:79], v[132:133], v[88:89] op_sel:[0,0,0] op_sel_hi:[0,1,1]
    v_pk_fma_f32 v[90:91], v[78:79], v[134:135], v[90:91] op_sel:[0,0,0] op_sel_hi:[0,1,1]
    v_pk_fma_f32 v[92:93], v[78:79], v[136:137], v[92:93] op_sel:[0,0,0] op_sel_hi:[0,1,1]
    v_pk_fma_f32 v[94:95], v[78:79], v[138:139], v[94:95] op_sel:[0,0,0] op_sel_hi:[0,1,1]
    v_pk_fma_f32 v[96:97], v[78:79], v[140:141], v[96:97] op_sel:[0,0,0] op_sel_hi:[0,1,1]
    v_pk_fma_f32 v[98:99], v[78:79], v[142:143], v[98:99] op_sel:[0,0,0] op_sel_hi:[0,1,1]
    v_pk_fma_f32 v[100:101], v[78:79], v[144:145], v[100:101] op_sel:[0,0,0] op_sel_hi:[0,1,1]
    v_pk_fma_f32 v[102:103], v[78:79], v[146:147], v[102:103] op_sel:[0,0,0] op_sel_hi:[0,1,1]
    ds_read_b128 v[128:131], v2 offset:1280
    ds_read_b128 v[132:135], v2 offset:1296
    ds_read_b128 v[136:139], v2 offset:1312
    ds_read_b128 v[140:143], v2 offset:1328
    ds_read_b128 v[144:147], v2 offset:1344
    s_waitcnt lgkmcnt(5)
    v_pk_fma_f32 v[84:85], v[78:79], v[148:149], v[84:85] op_sel:[1,0,0] op_sel_hi:[1,1,1]
    v_pk_fma_f32 v[86:87], v[78:79], v[150:151], v[86:87] op_sel:[1,0,0] op_sel_hi:[1,1,1]
    v_pk_fma_f32 v[88:89], v[78:79], v[152:153], v[88:89] op_sel:[1,0,0] op_sel_hi:[1,1,1]
    v_pk_fma_f32 v[90:91], v[78:79], v[154:155], v[90:91] op_sel:[1,0,0] op_sel_hi:[1,1,1]
    v_pk_fma_f32 v[92:93], v[78:79], v[156:157], v[92:93] op_sel:[1,0,0] op_sel_hi:[1,1,1]
    v_pk_fma_f32 v[94:95], v[78:79], v[158:159], v[94:95] op_sel:[1,0,0] op_sel_hi:[1,1,1]
    v_pk_fma_f32 v[96:97], v[78:79], v[160:161], v[96:97] op_sel:[1,0,0] op_sel_hi:[1,1,1]
    v_pk_fma_f32 v[98:99], v[78:79], v[162:163], v[98:99] op_sel:[1,0,0] op_sel_hi:[1,1,1]
    v_pk_fma_f32 v[100:101], v[78:79], v[164:165], v[100:101] op_sel:[1,0,0] op_sel_hi:[1,1,1]
    v_pk_fma_f32 v[102:103], v[78:79], v[166:167], v[102:103] op_sel:[1,0,0] op_sel_hi:[1,1,1]
    ds_read_b128 v[148:151], v2 offset:1360
    ds_read_b128 v[152:155], v2 offset:1376
    ds_read_b128 v[156:159], v2 offset:1392
    ds_read_b128 v[160:163], v2 offset:1408
    ds_read_b128 v[164:167], v2 offset:1424
    s_waitcnt lgkmcnt(5)
    v_pk_fma_f32 v[84:85], v[80:81], v[128:129], v[84:85] op_sel:[0,0,0] op_sel_hi:[0,1,1]
    v_pk_fma_f32 v[86:87], v[80:81], v[130:131], v[86:87] op_sel:[0,0,0] op_sel_hi:[0,1,1]
    v_pk_fma_f32 v[88:89], v[80:81], v[132:133], v[88:89] op_sel:[0,0,0] op_sel_hi:[0,1,1]
    v_pk_fma_f32 v[90:91], v[80:81], v[134:135], v[90:91] op_sel:[0,0,0] op_sel_hi:[0,1,1]
    v_pk_fma_f32 v[92:93], v[80:81], v[136:137], v[92:93] op_sel:[0,0,0] op_sel_hi:[0,1,1]
    v_pk_fma_f32 v[94:95], v[80:81], v[138:139], v[94:95] op_sel:[0,0,0] op_sel_hi:[0,1,1]
    v_pk_fma_f32 v[96:97], v[80:81], v[140:141], v[96:97] op_sel:[0,0,0] op_sel_hi:[0,1,1]
    v_pk_fma_f32 v[98:99], v[80:81], v[142:143], v[98:99] op_sel:[0,0,0] op_sel_hi:[0,1,1]
    v_pk_fma_f32 v[100:101], v[80:81], v[144:145], v[100:101] op_sel:[0,0,0] op_sel_hi:[0,1,1]
    v_pk_fma_f32 v[102:103], v[80:81], v[146:147], v[102:103] op_sel:[0,0,0] op_sel_hi:[0,1,1]
    ds_read_b128 v[128:131], v2 offset:1440
    ds_read_b128 v[132:135], v2 offset:1456
    ds_read_b128 v[136:139], v2 offset:1472
    ds_read_b128 v[140:143], v2 offset:1488
    ds_read_b128 v[144:147], v2 offset:1504
    s_waitcnt lgkmcnt(5)
    v_pk_fma_f32 v[84:85], v[80:81], v[148:149], v[84:85] op_sel:[1,0,0] op_sel_hi:[1,1,1]
    v_pk_fma_f32 v[86:87], v[80:81], v[150:151], v[86:87] op_sel:[1,0,0] op_sel_hi:[1,1,1]
    v_pk_fma_f32 v[88:89], v[80:81], v[152:153], v[88:89] op_sel:[1,0,0] op_sel_hi:[1,1,1]
    v_pk_fma_f32 v[90:91], v[80:81], v[154:155], v[90:91] op_sel:[1,0,0] op_sel_hi:[1,1,1]
    v_pk_fma_f32 v[92:93], v[80:81], v[156:157], v[92:93] op_sel:[1,0,0] op_sel_hi:[1,1,1]
    v_pk_fma_f32 v[94:95], v[80:81], v[158:159], v[94:95] op_sel:[1,0,0] op_sel_hi:[1,1,1]
    v_pk_fma_f32 v[96:97], v[80:81], v[160:161], v[96:97] op_sel:[1,0,0] op_sel_hi:[1,1,1]
    v_pk_fma_f32 v[98:99], v[80:81], v[162:163], v[98:99] op_sel:[1,0,0] op_sel_hi:[1,1,1]
    v_pk_fma_f32 v[100:101], v[80:81], v[164:165], v[100:101] op_sel:[1,0,0] op_sel_hi:[1,1,1]
    v_pk_fma_f32 v[102:103], v[80:81], v[166:167], v[102:103] op_sel:[1,0,0] op_sel_hi:[1,1,1]
    ds_read_b128 v[148:151], v2 offset:1520
    ds_read_b128 v[152:155], v2 offset:1536
    ds_read_b128 v[156:159], v2 offset:1552
    ds_read_b128 v[160:163], v2 offset:1568
    ds_read_b128 v[164:167], v2 offset:1584
    s_waitcnt lgkmcnt(5)
    v_pk_fma_f32 v[84:85], v[82:83], v[128:129], v[84:85] op_sel:[0,0,0] op_sel_hi:[0,1,1]
    v_pk_fma_f32 v[86:87], v[82:83], v[130:131], v[86:87] op_sel:[0,0,0] op_sel_hi:[0,1,1]
    v_pk_fma_f32 v[88:89], v[82:83], v[132:133], v[88:89] op_sel:[0,0,0] op_sel_hi:[0,1,1]
    v_pk_fma_f32 v[90:91], v[82:83], v[134:135], v[90:91] op_sel:[0,0,0] op_sel_hi:[0,1,1]
    v_pk_fma_f32 v[92:93], v[82:83], v[136:137], v[92:93] op_sel:[0,0,0] op_sel_hi:[0,1,1]
    v_pk_fma_f32 v[94:95], v[82:83], v[138:139], v[94:95] op_sel:[0,0,0] op_sel_hi:[0,1,1]
    v_pk_fma_f32 v[96:97], v[82:83], v[140:141], v[96:97] op_sel:[0,0,0] op_sel_hi:[0,1,1]
    v_pk_fma_f32 v[98:99], v[82:83], v[142:143], v[98:99] op_sel:[0,0,0] op_sel_hi:[0,1,1]
    v_pk_fma_f32 v[100:101], v[82:83], v[144:145], v[100:101] op_sel:[0,0,0] op_sel_hi:[0,1,1]
    v_pk_fma_f32 v[102:103], v[82:83], v[146:147], v[102:103] op_sel:[0,0,0] op_sel_hi:[0,1,1]
    s_waitcnt lgkmcnt(0)
    v_pk_fma_f32 v[84:85], v[82:83], v[148:149], v[84:85] op_sel:[1,0,0] op_sel_hi:[1,1,1]
    v_pk_fma_f32 v[86:87], v[82:83], v[150:151], v[86:87] op_sel:[1,0,0] op_sel_hi:[1,1,1]
    v_pk_fma_f32 v[88:89], v[82:83], v[152:153], v[88:89] op_sel:[1,0,0] op_sel_hi:[1,1,1]
    v_pk_fma_f32 v[90:91], v[82:83], v[154:155], v[90:91] op_sel:[1,0,0] op_sel_hi:[1,1,1]
    v_pk_fma_f32 v[92:93], v[82:83], v[156:157], v[92:93] op_sel:[1,0,0] op_sel_hi:[1,1,1]
    v_pk_fma_f32 v[94:95], v[82:83], v[158:159], v[94:95] op_sel:[1,0,0] op_sel_hi:[1,1,1]
    v_pk_fma_f32 v[96:97], v[82:83], v[160:161], v[96:97] op_sel:[1,0,0] op_sel_hi:[1,1,1]
    v_pk_fma_f32 v[98:99], v[82:83], v[162:163], v[98:99] op_sel:[1,0,0] op_sel_hi:[1,1,1]
    v_pk_fma_f32 v[100:101], v[82:83], v[164:165], v[100:101] op_sel:[1,0,0] op_sel_hi:[1,1,1]
    v_pk_fma_f32 v[102:103], v[82:83], v[166:167], v[102:103] op_sel:[1,0,0] op_sel_hi:[1,1,1]
    v_cvt_pk_bf16_f32 v124, v84, v85
    v_lshlrev_b32 v84, 16, v124
    v_and_b32 v85, 0xffff0000, v124
    v_cvt_pk_bf16_f32 v124, v86, v87
    v_lshlrev_b32 v86, 16, v124
    v_and_b32 v87, 0xffff0000, v124
    v_cvt_pk_bf16_f32 v124, v88, v89
    v_lshlrev_b32 v88, 16, v124
    v_and_b32 v89, 0xffff0000, v124
    v_cvt_pk_bf16_f32 v124, v90, v91
    v_lshlrev_b32 v90, 16, v124
    v_and_b32 v91, 0xffff0000, v124
    v_cvt_pk_bf16_f32 v124, v92, v93
    v_lshlrev_b32 v92, 16, v124
    v_and_b32 v93, 0xffff0000, v124
    v_cvt_pk_bf16_f32 v124, v94, v95
    v_lshlrev_b32 v94, 16, v124
    v_and_b32 v95, 0xffff0000, v124
    v_cvt_pk_bf16_f32 v124, v96, v97
    v_lshlrev_b32 v96, 16, v124
    v_and_b32 v97, 0xffff0000, v124
    v_cvt_pk_bf16_f32 v124, v98, v99
    v_lshlrev_b32 v98, 16, v124
    v_and_b32 v99, 0xffff0000, v124
    v_cvt_pk_bf16_f32 v124, v100, v101
    v_lshlrev_b32 v100, 16, v124
    v_and_b32 v101, 0xffff0000, v124
    v_cvt_pk_bf16_f32 v124, v102, v103
    v_lshlrev_b32 v102, 16, v124
    v_and_b32 v103, 0xffff0000, v124
    v_max_f32 v124, v84, v85
    v_min_f32 v125, v84, v85
    v_max_f32 v124, v124, v86
    v_min_f32 v125, v125, v86
    v_max_f32 v124, v124, v87
    v_min_f32 v125, v125, v87
    v_max_f32 v124, v124, v88
    v_min_f32 v125, v125, v88
    v_max_f32 v124, v124, v89
    v_min_f32 v125, v125, v89
    v_max_f32 v124, v124, v90
    v_min_f32 v125, v125, v90
    v_max_f32 v124, v124, v91
    v_min_f32 v125, v125, v91
    v_max_f32 v124, v124, v92
    v_min_f32 v125, v125, v92
    v_max_f32 v124, v124, v93
    v_min_f32 v125, v125, v93
    v_max_f32 v124, v124, v94
    v_min_f32 v125, v125, v94
    v_max_f32 v124, v124, v95
    v_min_f32 v125, v125, v95
    v_max_f32 v124, v124, v96
    v_min_f32 v125, v125, v96
    v_max_f32 v124, v124, v97
    v_min_f32 v125, v125, v97
    v_max_f32 v124, v124, v98
    v_min_f32 v125, v125, v98
    v_max_f32 v124, v124, v99
    v_min_f32 v125, v125, v99
    v_max_f32 v124, v124, v100
    v_min_f32 v125, v125, v100
    v_max_f32 v124, v124, v101
    v_min_f32 v125, v125, v101
    v_max_f32 v124, v124, v102
    v_min_f32 v125, v125, v102
    v_max_f32 v124, v124, v103
    v_min_f32 v125, v125, v103
    v_sub_f32 v104, v125, v84
    v_mul_f32 v104, 0x3fb8aa3b, v104
    v_exp_f32 v104, v104
    v_sub_f32 v84, v84, v124
    v_mul_f32 v84, 0x3fb8aa3b, v84
    v_exp_f32 v84, v84
    v_sub_f32 v105, v125, v85
    v_mul_f32 v105, 0x3fb8aa3b, v105
    v_exp_f32 v105, v105
    v_sub_f32 v85, v85, v124
    v_mul_f32 v85, 0x3fb8aa3b, v85
    v_exp_f32 v85, v85
    v_sub_f32 v106, v125, v86
    v_mul_f32 v106, 0x3fb8aa3b, v106
    v_exp_f32 v106, v106
    v_sub_f32 v86, v86, v124
    v_mul_f32 v86, 0x3fb8aa3b, v86
    v_exp_f32 v86, v86
    v_sub_f32 v107, v125, v87
    v_mul_f32 v107, 0x3fb8aa3b, v107
    v_exp_f32 v107, v107
    v_sub_f32 v87, v87, v124
    v_mul_f32 v87, 0x3fb8aa3b, v87
    v_exp_f32 v87, v87
    v_sub_f32 v108, v125, v88
    v_mul_f32 v108, 0x3fb8aa3b, v108
    v_exp_f32 v108, v108
    v_sub_f32 v88, v88, v124
    v_mul_f32 v88, 0x3fb8aa3b, v88
    v_exp_f32 v88, v88
    v_sub_f32 v109, v125, v89
    v_mul_f32 v109, 0x3fb8aa3b, v109
    v_exp_f32 v109, v109
    v_sub_f32 v89, v89, v124
    v_mul_f32 v89, 0x3fb8aa3b, v89
    v_exp_f32 v89, v89
    v_sub_f32 v110, v125, v90
    v_mul_f32 v110, 0x3fb8aa3b, v110
    v_exp_f32 v110, v110
    v_sub_f32 v90, v90, v124
    v_mul_f32 v90, 0x3fb8aa3b, v90
    v_exp_f32 v90, v90
    v_sub_f32 v111, v125, v91
    v_mul_f32 v111, 0x3fb8aa3b, v111
    v_exp_f32 v111, v111
    v_sub_f32 v91, v91, v124
    v_mul_f32 v91, 0x3fb8aa3b, v91
    v_exp_f32 v91, v91
    v_sub_f32 v112, v125, v92
    v_mul_f32 v112, 0x3fb8aa3b, v112
    v_exp_f32 v112, v112
    v_sub_f32 v92, v92, v124
    v_mul_f32 v92, 0x3fb8aa3b, v92
    v_exp_f32 v92, v92
    v_sub_f32 v113, v125, v93
    v_mul_f32 v113, 0x3fb8aa3b, v113
    v_exp_f32 v113, v113
    v_sub_f32 v93, v93, v124
    v_mul_f32 v93, 0x3fb8aa3b, v93
    v_exp_f32 v93, v93
    v_sub_f32 v114, v125, v94
    v_mul_f32 v114, 0x3fb8aa3b, v114
    v_exp_f32 v114, v114
    v_sub_f32 v94, v94, v124
    v_mul_f32 v94, 0x3fb8aa3b, v94
    v_exp_f32 v94, v94
    v_sub_f32 v115, v125, v95
    v_mul_f32 v115, 0x3fb8aa3b, v115
    v_exp_f32 v115, v115
    v_sub_f32 v95, v95, v124
    v_mul_f32 v95, 0x3fb8aa3b, v95
    v_exp_f32 v95, v95
    v_sub_f32 v116, v125, v96
    v_mul_f32 v116, 0x3fb8aa3b, v116
    v_exp_f32 v116, v116
    v_sub_f32 v96, v96, v124
    v_mul_f32 v96, 0x3fb8aa3b, v96
    v_exp_f32 v96, v96
    v_sub_f32 v117, v125, v97
    v_mul_f32 v117, 0x3fb8aa3b, v117
    v_exp_f32 v117, v117
    v_sub_f32 v97, v97, v124
    v_mul_f32 v97, 0x3fb8aa3b, v97
    v_exp_f32 v97, v97
    v_sub_f32 v118, v125, v98
    v_mul_f32 v118, 0x3fb8aa3b, v118
    v_exp_f32 v118, v118
    v_sub_f32 v98, v98, v124
    v_mul_f32 v98, 0x3fb8aa3b, v98
    v_exp_f32 v98, v98
    v_sub_f32 v119, v125, v99
    v_mul_f32 v119, 0x3fb8aa3b, v119
    v_exp_f32 v119, v119
    v_sub_f32 v99, v99, v124
    v_mul_f32 v99, 0x3fb8aa3b, v99
    v_exp_f32 v99, v99
    v_sub_f32 v120, v125, v100
    v_mul_f32 v120, 0x3fb8aa3b, v120
    v_exp_f32 v120, v120
    v_sub_f32 v100, v100, v124
    v_mul_f32 v100, 0x3fb8aa3b, v100
    v_exp_f32 v100, v100
    v_sub_f32 v121, v125, v101
    v_mul_f32 v121, 0x3fb8aa3b, v121
    v_exp_f32 v121, v121
    v_sub_f32 v101, v101, v124
    v_mul_f32 v101, 0x3fb8aa3b, v101
    v_exp_f32 v101, v101
    v_sub_f32 v122, v125, v102
    v_mul_f32 v122, 0x3fb8aa3b, v122
    v_exp_f32 v122, v122
    v_sub_f32 v102, v102, v124
    v_mul_f32 v102, 0x3fb8aa3b, v102
    v_exp_f32 v102, v102
    v_sub_f32 v123, v125, v103
    v_mul_f32 v123, 0x3fb8aa3b, v123
    v_exp_f32 v123, v123
    v_sub_f32 v103, v103, v124
    v_mul_f32 v103, 0x3fb8aa3b, v103
    v_exp_f32 v103, v103
    s_nop 0
    v_add_f32 v126, v84, v85
    v_add_f32 v127, v104, v105
    v_add_f32 v126, v126, v86
    v_add_f32 v127, v127, v106
    v_add_f32 v126, v126, v87
    v_add_f32 v127, v127, v107
    v_add_f32 v126, v126, v88
    v_add_f32 v127, v127, v108
    v_add_f32 v126, v126, v89
    v_add_f32 v127, v127, v109
    v_add_f32 v126, v126, v90
    v_add_f32 v127, v127, v110
    v_add_f32 v126, v126, v91
    v_add_f32 v127, v127, v111
    v_add_f32 v126, v126, v92
    v_add_f32 v127, v127, v112
    v_add_f32 v126, v126, v93
    v_add_f32 v127, v127, v113
    v_add_f32 v126, v126, v94
    v_add_f32 v127, v127, v114
    v_add_f32 v126, v126, v95
    v_add_f32 v127, v127, v115
    v_add_f32 v126, v126, v96
    v_add_f32 v127, v127, v116
    v_add_f32 v126, v126, v97
    v_add_f32 v127, v127, v117
    v_add_f32 v126, v126, v98
    v_add_f32 v127, v127, v118
    v_add_f32 v126, v126, v99
    v_add_f32 v127, v127, v119
    v_add_f32 v126, v126, v100
    v_add_f32 v127, v127, v120
    v_add_f32 v126, v126, v101
    v_add_f32 v127, v127, v121
    v_add_f32 v126, v126, v102
    v_add_f32 v127, v127, v122
    v_add_f32 v126, v126, v103
    v_add_f32 v127, v127, v123
    v_rcp_f32 v126, v126
    v_rcp_f32 v127, v127
    s_nop 0
    v_mul_f32 v84, v84, v126
    v_mul_f32 v104, v104, v127
    v_mul_f32 v85, v85, v126
    v_mul_f32 v105, v105, v127
    v_mul_f32 v86, v86, v126
    v_mul_f32 v106, v106, v127
    v_mul_f32 v87, v87, v126
    v_mul_f32 v107, v107, v127
    v_mul_f32 v88, v88, v126
    v_mul_f32 v108, v108, v127
    v_mul_f32 v89, v89, v126
    v_mul_f32 v109, v109, v127
    v_mul_f32 v90, v90, v126
    v_mul_f32 v110, v110, v127
    v_mul_f32 v91, v91, v126
    v_mul_f32 v111, v111, v127
    v_mul_f32 v92, v92, v126
    v_mul_f32 v112, v112, v127
    v_mul_f32 v93, v93, v126
    v_mul_f32 v113, v113, v127
    v_mul_f32 v94, v94, v126
    v_mul_f32 v114, v114, v127
    v_mul_f32 v95, v95, v126
    v_mul_f32 v115, v115, v127
    v_mul_f32 v96, v96, v126
    v_mul_f32 v116, v116, v127
    v_mul_f32 v97, v97, v126
    v_mul_f32 v117, v117, v127
    v_mul_f32 v98, v98, v126
    v_mul_f32 v118, v118, v127
    v_mul_f32 v99, v99, v126
    v_mul_f32 v119, v119, v127
    v_mul_f32 v100, v100, v126
    v_mul_f32 v120, v120, v127
    v_mul_f32 v101, v101, v126
    v_mul_f32 v121, v121, v127
    v_mul_f32 v102, v102, v126
    v_mul_f32 v122, v122, v127
    v_mul_f32 v103, v103, v126
    v_mul_f32 v123, v123, v127
    v_lshlrev_b32 v3, 1, v0
    v_cvt_pk_bf16_f32 v4, v84, v85
    ds_write_b16 v3, v4 offset:2048
    ds_write_b16_d16_hi v3, v4 offset:2560
    v_cvt_pk_bf16_f32 v4, v86, v87
    ds_write_b16 v3, v4 offset:3072
    ds_write_b16_d16_hi v3, v4 offset:3584
    v_cvt_pk_bf16_f32 v4, v88, v89
    ds_write_b16 v3, v4 offset:4096
    ds_write_b16_d16_hi v3, v4 offset:4608
    v_cvt_pk_bf16_f32 v4, v90, v91
    ds_write_b16 v3, v4 offset:5120
    ds_write_b16_d16_hi v3, v4 offset:5632
    v_cvt_pk_bf16_f32 v4, v92, v93
    ds_write_b16 v3, v4 offset:6144
    ds_write_b16_d16_hi v3, v4 offset:6656
    v_cvt_pk_bf16_f32 v4, v94, v95
    ds_write_b16 v3, v4 offset:7168
    ds_write_b16_d16_hi v3, v4 offset:7680
    v_cvt_pk_bf16_f32 v4, v96, v97
    ds_write_b16 v3, v4 offset:8192
    ds_write_b16_d16_hi v3, v4 offset:8704
    v_cvt_pk_bf16_f32 v4, v98, v99
    ds_write_b16 v3, v4 offset:9216
    ds_write_b16_d16_hi v3, v4 offset:9728
    v_cvt_pk_bf16_f32 v4, v100, v101
    ds_write_b16 v3, v4 offset:10240
    ds_write_b16_d16_hi v3, v4 offset:10752
    v_cvt_pk_bf16_f32 v4, v102, v103
    ds_write_b16 v3, v4 offset:11264
    ds_write_b16_d16_hi v3, v4 offset:11776
    v_cvt_pk_bf16_f32 v4, v104, v105
    ds_write_b16 v3, v4 offset:12288
    ds_write_b16_d16_hi v3, v4 offset:12800
    v_cvt_pk_bf16_f32 v4, v106, v107
    ds_write_b16 v3, v4 offset:13312
    ds_write_b16_d16_hi v3, v4 offset:13824
    v_cvt_pk_bf16_f32 v4, v108, v109
    ds_write_b16 v3, v4 offset:14336
    ds_write_b16_d16_hi v3, v4 offset:14848
    v_cvt_pk_bf16_f32 v4, v110, v111
    ds_write_b16 v3, v4 offset:15360
    ds_write_b16_d16_hi v3, v4 offset:15872
    v_cvt_pk_bf16_f32 v4, v112, v113
    ds_write_b16 v3, v4 offset:16384
    ds_write_b16_d16_hi v3, v4 offset:16896
    v_cvt_pk_bf16_f32 v4, v114, v115
    ds_write_b16 v3, v4 offset:17408
    ds_write_b16_d16_hi v3, v4 offset:17920
    v_cvt_pk_bf16_f32 v4, v116, v117
    ds_write_b16 v3, v4 offset:18432
    ds_write_b16_d16_hi v3, v4 offset:18944
    v_cvt_pk_bf16_f32 v4, v118, v119
    ds_write_b16 v3, v4 offset:19456
    ds_write_b16_d16_hi v3, v4 offset:19968
    v_cvt_pk_bf16_f32 v4, v120, v121
    ds_write_b16 v3, v4 offset:20480
    ds_write_b16_d16_hi v3, v4 offset:20992
    v_cvt_pk_bf16_f32 v4, v122, v123
    ds_write_b16 v3, v4 offset:21504
    ds_write_b16_d16_hi v3, v4 offset:22016
    ds_write_b16 v3, v54 offset:26624
    ds_write_b16_d16_hi v3, v54 offset:27136
    ds_write_b16 v3, v55 offset:27648
    ds_write_b16_d16_hi v3, v55 offset:28160
    ds_write_b16 v3, v56 offset:28672
    ds_write_b16_d16_hi v3, v56 offset:29184
    ds_write_b16 v3, v57 offset:29696
    ds_write_b16_d16_hi v3, v57 offset:30208
    ds_write_b16 v3, v58 offset:30720
    ds_write_b16_d16_hi v3, v58 offset:31232
    ds_write_b16 v3, v59 offset:31744
    ds_write_b16_d16_hi v3, v59 offset:32256
    ds_write_b16 v3, v60 offset:32768
    ds_write_b16_d16_hi v3, v60 offset:33280
    ds_write_b16 v3, v61 offset:33792
    ds_write_b16_d16_hi v3, v61 offset:34304
    ds_write_b16 v3, v62 offset:34816
    ds_write_b16_d16_hi v3, v62 offset:35328
    ds_write_b16 v3, v63 offset:35840
    ds_write_b16_d16_hi v3, v63 offset:36352
    v_mov_b32 v4, 0x3f80
    ds_write_b16 v3, v4 offset:36864
    s_waitcnt lgkmcnt(0)
    s_barrier
    v_cmp_gt_u32 vcc, 64, v0
    s_and_saveexec_b64 s[8:9], vcc
    s_cbranch_execz kv_1_kernel_end
    v_and_b32 v5, 15, v0
    v_lshrrev_b32 v6, 4, v0
    v_lshlrev_b32 v7, 9, v5
    v_lshl_add_u32 v7, v6, 4, v7
    v_mov_b32 v128, 0
    v_mov_b32 v129, 0
    v_mov_b32 v130, 0
    v_mov_b32 v131, 0
    v_mov_b32 v132, 0
    v_mov_b32 v133, 0
    v_mov_b32 v134, 0
    v_mov_b32 v135, 0
    v_mov_b32 v136, 0
    v_mov_b32 v137, 0
    v_mov_b32 v138, 0
    v_mov_b32 v139, 0
    v_mov_b32 v140, 0
    v_mov_b32 v141, 0
    v_mov_b32 v142, 0
    v_mov_b32 v143, 0
    v_mov_b32 v144, 0
    v_mov_b32 v145, 0
    v_mov_b32 v146, 0
    v_mov_b32 v147, 0
    v_mov_b32 v148, 0
    v_mov_b32 v149, 0
    v_mov_b32 v150, 0
    v_mov_b32 v151, 0
    ds_read_b128 v[152:155], v7 offset:2048
    ds_read_b128 v[156:159], v7 offset:10240
    ds_read_b128 v[160:163], v7 offset:18432
    ds_read_b128 v[164:167], v7 offset:26624
    ds_read_b128 v[168:171], v7 offset:34816
    s_waitcnt lgkmcnt(0)
    v_mfma_f32_16x16x32_bf16 v[128:131], v[152:155], v[164:167], v[128:131]
    v_mfma_f32_16x16x32_bf16 v[132:135], v[152:155], v[168:171], v[132:135]
    v_mfma_f32_16x16x32_bf16 v[136:139], v[156:159], v[164:167], v[136:139]
    v_mfma_f32_16x16x32_bf16 v[140:143], v[156:159], v[168:171], v[140:143]
    v_mfma_f32_16x16x32_bf16 v[144:147], v[160:163], v[164:167], v[144:147]
    v_mfma_f32_16x16x32_bf16 v[148:151], v[160:163], v[168:171], v[148:151]
    s_nop 7
    ds_read_b128 v[152:155], v7 offset:2112
    ds_read_b128 v[156:159], v7 offset:10304
    ds_read_b128 v[160:163], v7 offset:18496
    ds_read_b128 v[164:167], v7 offset:26688
    ds_read_b128 v[168:171], v7 offset:34880
    s_waitcnt lgkmcnt(0)
    v_mfma_f32_16x16x32_bf16 v[128:131], v[152:155], v[164:167], v[128:131]
    v_mfma_f32_16x16x32_bf16 v[132:135], v[152:155], v[168:171], v[132:135]
    v_mfma_f32_16x16x32_bf16 v[136:139], v[156:159], v[164:167], v[136:139]
    v_mfma_f32_16x16x32_bf16 v[140:143], v[156:159], v[168:171], v[140:143]
    v_mfma_f32_16x16x32_bf16 v[144:147], v[160:163], v[164:167], v[144:147]
    v_mfma_f32_16x16x32_bf16 v[148:151], v[160:163], v[168:171], v[148:151]
    s_nop 7
    ds_read_b128 v[152:155], v7 offset:2176
    ds_read_b128 v[156:159], v7 offset:10368
    ds_read_b128 v[160:163], v7 offset:18560
    ds_read_b128 v[164:167], v7 offset:26752
    ds_read_b128 v[168:171], v7 offset:34944
    s_waitcnt lgkmcnt(0)
    v_mfma_f32_16x16x32_bf16 v[128:131], v[152:155], v[164:167], v[128:131]
    v_mfma_f32_16x16x32_bf16 v[132:135], v[152:155], v[168:171], v[132:135]
    v_mfma_f32_16x16x32_bf16 v[136:139], v[156:159], v[164:167], v[136:139]
    v_mfma_f32_16x16x32_bf16 v[140:143], v[156:159], v[168:171], v[140:143]
    v_mfma_f32_16x16x32_bf16 v[144:147], v[160:163], v[164:167], v[144:147]
    v_mfma_f32_16x16x32_bf16 v[148:151], v[160:163], v[168:171], v[148:151]
    s_nop 7
    ds_read_b128 v[152:155], v7 offset:2240
    ds_read_b128 v[156:159], v7 offset:10432
    ds_read_b128 v[160:163], v7 offset:18624
    ds_read_b128 v[164:167], v7 offset:26816
    ds_read_b128 v[168:171], v7 offset:35008
    s_waitcnt lgkmcnt(0)
    v_mfma_f32_16x16x32_bf16 v[128:131], v[152:155], v[164:167], v[128:131]
    v_mfma_f32_16x16x32_bf16 v[132:135], v[152:155], v[168:171], v[132:135]
    v_mfma_f32_16x16x32_bf16 v[136:139], v[156:159], v[164:167], v[136:139]
    v_mfma_f32_16x16x32_bf16 v[140:143], v[156:159], v[168:171], v[140:143]
    v_mfma_f32_16x16x32_bf16 v[144:147], v[160:163], v[164:167], v[144:147]
    v_mfma_f32_16x16x32_bf16 v[148:151], v[160:163], v[168:171], v[148:151]
    s_nop 7
    ds_read_b128 v[152:155], v7 offset:2304
    ds_read_b128 v[156:159], v7 offset:10496
    ds_read_b128 v[160:163], v7 offset:18688
    ds_read_b128 v[164:167], v7 offset:26880
    ds_read_b128 v[168:171], v7 offset:35072
    s_waitcnt lgkmcnt(0)
    v_mfma_f32_16x16x32_bf16 v[128:131], v[152:155], v[164:167], v[128:131]
    v_mfma_f32_16x16x32_bf16 v[132:135], v[152:155], v[168:171], v[132:135]
    v_mfma_f32_16x16x32_bf16 v[136:139], v[156:159], v[164:167], v[136:139]
    v_mfma_f32_16x16x32_bf16 v[140:143], v[156:159], v[168:171], v[140:143]
    v_mfma_f32_16x16x32_bf16 v[144:147], v[160:163], v[164:167], v[144:147]
    v_mfma_f32_16x16x32_bf16 v[148:151], v[160:163], v[168:171], v[148:151]
    s_nop 7
    ds_read_b128 v[152:155], v7 offset:2368
    ds_read_b128 v[156:159], v7 offset:10560
    ds_read_b128 v[160:163], v7 offset:18752
    ds_read_b128 v[164:167], v7 offset:26944
    ds_read_b128 v[168:171], v7 offset:35136
    s_waitcnt lgkmcnt(0)
    v_mfma_f32_16x16x32_bf16 v[128:131], v[152:155], v[164:167], v[128:131]
    v_mfma_f32_16x16x32_bf16 v[132:135], v[152:155], v[168:171], v[132:135]
    v_mfma_f32_16x16x32_bf16 v[136:139], v[156:159], v[164:167], v[136:139]
    v_mfma_f32_16x16x32_bf16 v[140:143], v[156:159], v[168:171], v[140:143]
    v_mfma_f32_16x16x32_bf16 v[144:147], v[160:163], v[164:167], v[144:147]
    v_mfma_f32_16x16x32_bf16 v[148:151], v[160:163], v[168:171], v[148:151]
    s_nop 7
    ds_read_b128 v[152:155], v7 offset:2432
    ds_read_b128 v[156:159], v7 offset:10624
    ds_read_b128 v[160:163], v7 offset:18816
    ds_read_b128 v[164:167], v7 offset:27008
    ds_read_b128 v[168:171], v7 offset:35200
    s_waitcnt lgkmcnt(0)
    v_mfma_f32_16x16x32_bf16 v[128:131], v[152:155], v[164:167], v[128:131]
    v_mfma_f32_16x16x32_bf16 v[132:135], v[152:155], v[168:171], v[132:135]
    v_mfma_f32_16x16x32_bf16 v[136:139], v[156:159], v[164:167], v[136:139]
    v_mfma_f32_16x16x32_bf16 v[140:143], v[156:159], v[168:171], v[140:143]
    v_mfma_f32_16x16x32_bf16 v[144:147], v[160:163], v[164:167], v[144:147]
    v_mfma_f32_16x16x32_bf16 v[148:151], v[160:163], v[168:171], v[148:151]
    s_nop 7
    ds_read_b128 v[152:155], v7 offset:2496
    ds_read_b128 v[156:159], v7 offset:10688
    ds_read_b128 v[160:163], v7 offset:18880
    ds_read_b128 v[164:167], v7 offset:27072
    ds_read_b128 v[168:171], v7 offset:35264
    s_waitcnt lgkmcnt(0)
    v_mfma_f32_16x16x32_bf16 v[128:131], v[152:155], v[164:167], v[128:131]
    v_mfma_f32_16x16x32_bf16 v[132:135], v[152:155], v[168:171], v[132:135]
    v_mfma_f32_16x16x32_bf16 v[136:139], v[156:159], v[164:167], v[136:139]
    v_mfma_f32_16x16x32_bf16 v[140:143], v[156:159], v[168:171], v[140:143]
    v_mfma_f32_16x16x32_bf16 v[144:147], v[160:163], v[164:167], v[144:147]
    v_mfma_f32_16x16x32_bf16 v[148:151], v[160:163], v[168:171], v[148:151]
    s_nop 7
    s_nop 7
    s_nop 7
    s_lshl_b32 s6, s2, 0
    s_mul_i32 s6, s2, 6144
    v_lshlrev_b32 v8, 9, v6
    v_lshl_add_u32 v8, v5, 2, v8
    v_add_u32 v8, s6, v8
    buffer_store_dword v128, v8, s[44:47], 0 offen offset:0
    buffer_store_dword v129, v8, s[44:47], 0 offen offset:128
    buffer_store_dword v130, v8, s[44:47], 0 offen offset:256
    buffer_store_dword v131, v8, s[44:47], 0 offen offset:384
    buffer_store_dword v132, v8, s[44:47], 0 offen offset:64
    buffer_store_dword v133, v8, s[44:47], 0 offen offset:192
    buffer_store_dword v134, v8, s[44:47], 0 offen offset:320
    buffer_store_dword v135, v8, s[44:47], 0 offen offset:448
    v_add_u32 v8, 2048, v8
    buffer_store_dword v136, v8, s[44:47], 0 offen offset:0
    buffer_store_dword v137, v8, s[44:47], 0 offen offset:128
    buffer_store_dword v138, v8, s[44:47], 0 offen offset:256
    buffer_store_dword v139, v8, s[44:47], 0 offen offset:384
    buffer_store_dword v140, v8, s[44:47], 0 offen offset:64
    buffer_store_dword v141, v8, s[44:47], 0 offen offset:192
    buffer_store_dword v142, v8, s[44:47], 0 offen offset:320
    buffer_store_dword v143, v8, s[44:47], 0 offen offset:448
    v_add_u32 v8, 2048, v8
    buffer_store_dword v144, v8, s[44:47], 0 offen offset:0
    buffer_store_dword v145, v8, s[44:47], 0 offen offset:128
    buffer_store_dword v146, v8, s[44:47], 0 offen offset:256
    buffer_store_dword v147, v8, s[44:47], 0 offen offset:384
    buffer_store_dword v148, v8, s[44:47], 0 offen offset:64
    buffer_store_dword v149, v8, s[44:47], 0 offen offset:192
    buffer_store_dword v150, v8, s[44:47], 0 offen offset:320
    buffer_store_dword v151, v8, s[44:47], 0 offen offset:448
    v_add_u32 v8, 2048, v8
kv_1_kernel_end:
    s_endpgm
.globl att_1_kernel
.p2align 8
.type att_1_kernel,@function
att_1_kernel:
    s_cmp_ge_u32 s2, 256
    s_cbranch_scc1 att_1_kernel_end
    s_load_dwordx16 s[16:31], s[0:1], 0
    s_load_dwordx4 s[32:35], s[0:1], 64
    s_load_dwordx2 s[36:37], s[0:1], 80
    s_waitcnt lgkmcnt(0)
    s_and_b32 s4, s2, 31
    s_lshr_b32 s5, s2, 5
    s_mov_b32 s48, s20
    s_mov_b32 s49, s21
    s_mov_b32 s50, 0x6400
    s_mov_b32 s51, 0x00020000
    s_mul_i32 s7, s4, 800
    v_lshlrev_b32 v40, 2, v0
    v_cmp_gt_u32 vcc, 200, v0
    s_and_saveexec_b64 s[8:9], vcc
    buffer_load_dword v41, v40, s[48:51], s7 offen
    s_waitcnt vmcnt(0)
    v_lshlrev_b32 v42, 16, v41
    v_and_b32 v43, 0xffff0000, v41
    v_lshlrev_b32 v40, 3, v0
    ds_write_b64 v40, v[42:43] offset:0
    s_mov_b64 exec, s[8:9]
    s_add_u32 s40, s36, 0x400000
    s_addc_u32 s41, s37, 0
    s_mov_b32 s42, 0x780000
    s_mov_b32 s43, 0x00020000
    s_add_u32 s44, s36, 0xc00000
    s_addc_u32 s45, s37, 0
    s_mov_b32 s46, 0x180000
    s_mov_b32 s47, 0x00020000
    s_add_u32 s52, s36, 0x1000000
    s_addc_u32 s53, s37, 0
    s_mov_b32 s54, 0x280000
    s_mov_b32 s55, 0x00020000
    s_lshl_b32 s6, s5, 8
    v_add_u32 v1, s6, v0
    v_mul_u32_u24 v1, 3840, v1
    s_mul_i32 s7, s4, 40
    v_add_u32 v1, s7, v1
    buffer_load_dwordx2 v[44:45], v1, s[40:43], 0 offen offset:0
    buffer_load_dwordx2 v[46:47], v1, s[40:43], 0 offen offset:8
    buffer_load_dwordx2 v[48:49], v1, s[40:43], 0 offen offset:16
    buffer_load_dwordx2 v[50:51], v1, s[40:43], 0 offen offset:24
    buffer_load_dwordx2 v[52:53], v1, s[40:43], 0 offen offset:32
    s_mul_i32 s7, s4, 6144
    v_lshlrev_b32 v2, 2, v0
    v_add_u32 v6, 4096, v2
    v_mov_b32 v54, 0
    v_mov_b32 v55, 0
    v_mov_b32 v56, 0
    v_mov_b32 v57, 0
    v_mov_b32 v58, 0
    buffer_load_dword v60, v2, s[44:47], s7 offen offset:0
    buffer_load_dword v61, v2, s[44:47], s7 offen offset:1024
    buffer_load_dword v62, v2, s[44:47], s7 offen offset:2048
    buffer_load_dword v63, v2, s[44:47], s7 offen offset:3072
    buffer_load_dword v64, v6, s[44:47], s7 offen offset:0
    s_waitcnt vmcnt(0)
    v_add_f32 v54, v54, v60
    v_add_f32 v55, v55, v61
    v_add_f32 v56, v56, v62
    v_add_f32 v57, v57, v63
    v_add_f32 v58, v58, v64
    s_add_u32 s7, s7, 196608
    buffer_load_dword v60, v2, s[44:47], s7 offen offset:0
    buffer_load_dword v61, v2, s[44:47], s7 offen offset:1024
    buffer_load_dword v62, v2, s[44:47], s7 offen offset:2048
    buffer_load_dword v63, v2, s[44:47], s7 offen offset:3072
    buffer_load_dword v64, v6, s[44:47], s7 offen offset:0
    s_waitcnt vmcnt(0)
    v_add_f32 v54, v54, v60
    v_add_f32 v55, v55, v61
    v_add_f32 v56, v56, v62
    v_add_f32 v57, v57, v63
    v_add_f32 v58, v58, v64
    s_add_u32 s7, s7, 196608
    buffer_load_dword v60, v2, s[44:47], s7 offen offset:0
    buffer_load_dword v61, v2, s[44:47], s7 offen offset:1024
    buffer_load_dword v62, v2, s[44:47], s7 offen offset:2048
    buffer_load_dword v63, v2, s[44:47], s7 offen offset:3072
    buffer_load_dword v64, v6, s[44:47], s7 offen offset:0
    s_waitcnt vmcnt(0)
    v_add_f32 v54, v54, v60
    v_add_f32 v55, v55, v61
    v_add_f32 v56, v56, v62
    v_add_f32 v57, v57, v63
    v_add_f32 v58, v58, v64
    s_add_u32 s7, s7, 196608
    buffer_load_dword v60, v2, s[44:47], s7 offen offset:0
    buffer_load_dword v61, v2, s[44:47], s7 offen offset:1024
    buffer_load_dword v62, v2, s[44:47], s7 offen offset:2048
    buffer_load_dword v63, v2, s[44:47], s7 offen offset:3072
    buffer_load_dword v64, v6, s[44:47], s7 offen offset:0
    s_waitcnt vmcnt(0)
    v_add_f32 v54, v54, v60
    v_add_f32 v55, v55, v61
    v_add_f32 v56, v56, v62
    v_add_f32 v57, v57, v63
    v_add_f32 v58, v58, v64
    s_add_u32 s7, s7, 196608
    buffer_load_dword v60, v2, s[44:47], s7 offen offset:0
    buffer_load_dword v61, v2, s[44:47], s7 offen offset:1024
    buffer_load_dword v62, v2, s[44:47], s7 offen offset:2048
    buffer_load_dword v63, v2, s[44:47], s7 offen offset:3072
    buffer_load_dword v64, v6, s[44:47], s7 offen offset:0
    s_waitcnt vmcnt(0)
    v_add_f32 v54, v54, v60
    v_add_f32 v55, v55, v61
    v_add_f32 v56, v56, v62
    v_add_f32 v57, v57, v63
    v_add_f32 v58, v58, v64
    s_add_u32 s7, s7, 196608
    buffer_load_dword v60, v2, s[44:47], s7 offen offset:0
    buffer_load_dword v61, v2, s[44:47], s7 offen offset:1024
    buffer_load_dword v62, v2, s[44:47], s7 offen offset:2048
    buffer_load_dword v63, v2, s[44:47], s7 offen offset:3072
    buffer_load_dword v64, v6, s[44:47], s7 offen offset:0
    s_waitcnt vmcnt(0)
    v_add_f32 v54, v54, v60
    v_add_f32 v55, v55, v61
    v_add_f32 v56, v56, v62
    v_add_f32 v57, v57, v63
    v_add_f32 v58, v58, v64
    s_add_u32 s7, s7, 196608
    buffer_load_dword v60, v2, s[44:47], s7 offen offset:0
    buffer_load_dword v61, v2, s[44:47], s7 offen offset:1024
    buffer_load_dword v62, v2, s[44:47], s7 offen offset:2048
    buffer_load_dword v63, v2, s[44:47], s7 offen offset:3072
    buffer_load_dword v64, v6, s[44:47], s7 offen offset:0
    s_waitcnt vmcnt(0)
    v_add_f32 v54, v54, v60
    v_add_f32 v55, v55, v61
    v_add_f32 v56, v56, v62
    v_add_f32 v57, v57, v63
    v_add_f32 v58, v58, v64
    s_add_u32 s7, s7, 196608
    buffer_load_dword v60, v2, s[44:47], s7 offen offset:0
    buffer_load_dword v61, v2, s[44:47], s7 offen offset:1024
    buffer_load_dword v62, v2, s[44:47], s7 offen offset:2048
    buffer_load_dword v63, v2, s[44:47], s7 offen offset:3072
    buffer_load_dword v64, v6, s[44:47], s7 offen offset:0
    s_waitcnt vmcnt(0)
    v_add_f32 v54, v54, v60
    v_add_f32 v55, v55, v61
    v_add_f32 v56, v56, v62
    v_add_f32 v57, v57, v63
    v_add_f32 v58, v58, v64
    s_add_u32 s7, s7, 196608
    v_and_b32 v3, 31, v0
    v_lshrrev_b32 v4, 5, v0
    v_mul_u32_u24 v4, 96, v4
    v_lshl_add_u32 v4, v3, 2, v4
    v_cmp_gt_u32 vcc, 24, v3
    s_and_saveexec_b64 s[8:9], vcc
    v_cvt_pk_bf16_f32 v5, v54, v54
    v_and_b32 v5, 0xffff0000, v5
    ds_write_b32 v4, v5 offset:2048
    v_cvt_pk_bf16_f32 v5, v55, v55
    v_and_b32 v5, 0xffff0000, v5
    ds_write_b32 v4, v5 offset:2816
    v_cvt_pk_bf16_f32 v5, v56, v56
    v_and_b32 v5, 0xffff0000, v5
    ds_write_b32 v4, v5 offset:3584
    v_cvt_pk_bf16_f32 v5, v57, v57
    v_and_b32 v5, 0xffff0000, v5
    ds_write_b32 v4, v5 offset:4352
    v_cvt_pk_bf16_f32 v5, v58, v58
    v_and_b32 v5, 0xffff0000, v5
    ds_write_b32 v4, v5 offset:5120
    s_mov_b64 exec, s[8:9]
    s_waitcnt vmcnt(0) lgkmcnt(0)
    s_barrier
    v_lshlrev_b32 v64, 16, v44
    v_and_b32 v65, 0xffff0000, v44
    v_lshlrev_b32 v66, 16, v45
    v_and_b32 v67, 0xffff0000, v45
    v_lshlrev_b32 v68, 16, v46
    v_and_b32 v69, 0xffff0000, v46
    v_lshlrev_b32 v70, 16, v47
    v_and_b32 v71, 0xffff0000, v47
    v_lshlrev_b32 v72, 16, v48
    v_and_b32 v73, 0xffff0000, v48
    v_lshlrev_b32 v74, 16, v49
    v_and_b32 v75, 0xffff0000, v49
    v_lshlrev_b32 v76, 16, v50
    v_and_b32 v77, 0xffff0000, v50
    v_lshlrev_b32 v78, 16, v51
    v_and_b32 v79, 0xffff0000, v51
    v_lshlrev_b32 v80, 16, v52
    v_and_b32 v81, 0xffff0000, v52
    v_lshlrev_b32 v82, 16, v53
    v_and_b32 v83, 0xffff0000, v53
    v_mov_b32 v2, 0
    v_mov_b32 v84, 0
    v_mov_b32 v85, 0
    v_mov_b32 v86, 0
    v_mov_b32 v87, 0
    v_mov_b32 v88, 0
    v_mov_b32 v89, 0
    v_mov_b32 v90, 0
    v_mov_b32 v91, 0
    v_mov_b32 v92, 0
    v_mov_b32 v93, 0
    v_mov_b32 v94, 0
    v_mov_b32 v95, 0
    v_mov_b32 v96, 0
    v_mov_b32 v97, 0
    v_mov_b32 v98, 0
    v_mov_b32 v99, 0
    v_mov_b32 v100, 0
    v_mov_b32 v101, 0
    v_mov_b32 v102, 0
    v_mov_b32 v103, 0
    ds_read_b128 v[128:131], v2 offset:0
    ds_read_b128 v[132:135], v2 offset:16
    ds_read_b128 v[136:139], v2 offset:32
    ds_read_b128 v[140:143], v2 offset:48
    ds_read_b128 v[144:147], v2 offset:64
    ds_read_b128 v[148:151], v2 offset:80
    ds_read_b128 v[152:155], v2 offset:96
    ds_read_b128 v[156:159], v2 offset:112
    ds_read_b128 v[160:163], v2 offset:128
    ds_read_b128 v[164:167], v2 offset:144
    s_waitcnt lgkmcnt(5)
    v_pk_fma_f32 v[84:85], v[64:65], v[128:129], v[84:85] op_sel:[0,0,0] op_sel_hi:[0,1,1]
    v_pk_fma_f32 v[86:87], v[64:65], v[130:131], v[86:87] op_sel:[0,0,0] op_sel_hi:[0,1,1]
    v_pk_fma_f32 v[88:89], v[64:65], v[132:133], v[88:89] op_sel:[0,0,0] op_sel_hi:[0,1,1]
    v_pk_fma_f32 v[90:91], v[64:65], v[134:135], v[90:91] op_sel:[0,0,0] op_sel_hi:[0,1,1]
    v_pk_fma_f32 v[92:93], v[64:65], v[136:137], v[92:93] op_sel:[0,0,0] op_sel_hi:[0,1,1]
    v_pk_fma_f32 v[94:95], v[64:65], v[138:139], v[94:95] op_sel:[0,0,0] op_sel_hi:[0,1,1]
    v_pk_fma_f32 v[96:97], v[64:65], v[140:141], v[96:97] op_sel:[0,0,0] op_sel_hi:[0,1,1]
    v_pk_fma_f32 v[98:99], v[64:65], v[142:143], v[98:99] op_sel:[0,0,0] op_sel_hi:[0,1,1]
    v_pk_fma_f32 v[100:101], v[64:65], v[144:145], v[100:101] op_sel:[0,0,0] op_sel_hi:[0,1,1]
    v_pk_fma_f32 v[102:103], v[64:65], v[146:147], v[102:103] op_sel:[0,0,0] op_sel_hi:[0,1,1]
    ds_read_b128 v[128:131], v2 offset:160
    ds_read_b128 v[132:135], v2 offset:176
    ds_read_b128 v[136:139], v2 offset:192
    ds_read_b128 v[140:143], v2 offset:208
    ds_read_b128 v[144:147], v2 offset:224
    s_waitcnt lgkmcnt(5)
    v_pk_fma_f32 v[84:85], v[64:65], v[148:149], v[84:85] op_sel:[1,0,0] op_sel_hi:[1,1,1]
    v_pk_fma_f32 v[86:87], v[64:65], v[150:151], v[86:87] op_sel:[1,0,0] op_sel_hi:[1,1,1]
    v_pk_fma_f32 v[88:89], v[64:65], v[152:153], v[88:89] op_sel:[1,0,0] op_sel_hi:[1,1,1]
    v_pk_fma_f32 v[90:91], v[64:65], v[154:155], v[90:91] op_sel:[1,0,0] op_sel_hi:[1,1,1]
    v_pk_fma_f32 v[92:93], v[64:65], v[156:157], v[92:93] op_sel:[1,0,0] op_sel_hi:[1,1,1]
    v_pk_fma_f32 v[94:95], v[64:65], v[158:159], v[94:95] op_sel:[1,0,0] op_sel_hi:[1,1,1]
    v_pk_fma_f32 v[96:97], v[64:65], v[160:161], v[96:97] op_sel:[1,0,0] op_sel_hi:[1,1,1]
    v_pk_fma_f32 v[98:99], v[64:65], v[162:163], v[98:99] op_sel:[1,0,0] op_sel_hi:[1,1,1]
    v_pk_fma_f32 v[100:101], v[64:65], v[164:165], v[100:101] op_sel:[1,0,0] op_sel_hi:[1,1,1]
    v_pk_fma_f32 v[102:103], v[64:65], v[166:167], v[102:103] op_sel:[1,0,0] op_sel_hi:[1,1,1]
    ds_read_b128 v[148:151], v2 offset:240
    ds_read_b128 v[152:155], v2 offset:256
    ds_read_b128 v[156:159], v2 offset:272
    ds_read_b128 v[160:163], v2 offset:288
    ds_read_b128 v[164:167], v2 offset:304
    s_waitcnt lgkmcnt(5)
    v_pk_fma_f32 v[84:85], v[66:67], v[128:129], v[84:85] op_sel:[0,0,0] op_sel_hi:[0,1,1]
    v_pk_fma_f32 v[86:87], v[66:67], v[130:131], v[86:87] op_sel:[0,0,0] op_sel_hi:[0,1,1]
    v_pk_fma_f32 v[88:89], v[66:67], v[132:133], v[88:89] op_sel:[0,0,0] op_sel_hi:[0,1,1]
    v_pk_fma_f32 v[90:91], v[66:67], v[134:135], v[90:91] op_sel:[0,0,0] op_sel_hi:[0,1,1]
    v_pk_fma_f32 v[92:93], v[66:67], v[136:137], v[92:93] op_sel:[0,0,0] op_sel_hi:[0,1,1]
    v_pk_fma_f32 v[94:95], v[66:67], v[138:139], v[94:95] op_sel:[0,0,0] op_sel_hi:[0,1,1]
    v_pk_fma_f32 v[96:97], v[66:67], v[140:141], v[96:97] op_sel:[0,0,0] op_sel_hi:[0,1,1]
    v_pk_fma_f32 v[98:99], v[66:67], v[142:143], v[98:99] op_sel:[0,0,0] op_sel_hi:[0,1,1]
    v_pk_fma_f32 v[100:101], v[66:67], v[144:145], v[100:101] op_sel:[0,0,0] op_sel_hi:[0,1,1]
    v_pk_fma_f32 v[102:103], v[66:67], v[146:147], v[102:103] op_sel:[0,0,0] op_sel_hi:[0,1,1]
    ds_read_b128 v[128:131], v2 offset:320
    ds_read_b128 v[132:135], v2 offset:336
    ds_read_b128 v[136:139], v2 offset:352
    ds_read_b128 v[140:143], v2 offset:368
    ds_read_b128 v[144:147], v2 offset:384
    s_waitcnt lgkmcnt(5)
    v_pk_fma_f32 v[84:85], v[66:67], v[148:149], v[84:85] op_sel:[1,0,0] op_sel_hi:[1,1,1]
    v_pk_fma_f32 v[86:87], v[66:67], v[150:151], v[86:87] op_sel:[1,0,0] op_sel_hi:[1,1,1]
    v_pk_fma_f32 v[88:89], v[66:67], v[152:153], v[88:89] op_sel:[1,0,0] op_sel_hi:[1,1,1]
    v_pk_fma_f32 v[90:91], v[66:67], v[154:155], v[90:91] op_sel:[1,0,0] op_sel_hi:[1,1,1]
    v_pk_fma_f32 v[92:93], v[66:67], v[156:157], v[92:93] op_sel:[1,0,0] op_sel_hi:[1,1,1]
    v_pk_fma_f32 v[94:95], v[66:67], v[158:159], v[94:95] op_sel:[1,0,0] op_sel_hi:[1,1,1]
    v_pk_fma_f32 v[96:97], v[66:67], v[160:161], v[96:97] op_sel:[1,0,0] op_sel_hi:[1,1,1]
    v_pk_fma_f32 v[98:99], v[66:67], v[162:163], v[98:99] op_sel:[1,0,0] op_sel_hi:[1,1,1]
    v_pk_fma_f32 v[100:101], v[66:67], v[164:165], v[100:101] op_sel:[1,0,0] op_sel_hi:[1,1,1]
    v_pk_fma_f32 v[102:103], v[66:67], v[166:167], v[102:103] op_sel:[1,0,0] op_sel_hi:[1,1,1]
    ds_read_b128 v[148:151], v2 offset:400
    ds_read_b128 v[152:155], v2 offset:416
    ds_read_b128 v[156:159], v2 offset:432
    ds_read_b128 v[160:163], v2 offset:448
    ds_read_b128 v[164:167], v2 offset:464
    s_waitcnt lgkmcnt(5)
    v_pk_fma_f32 v[84:85], v[68:69], v[128:129], v[84:85] op_sel:[0,0,0] op_sel_hi:[0,1,1]
    v_pk_fma_f32 v[86:87], v[68:69], v[130:131], v[86:87] op_sel:[0,0,0] op_sel_hi:[0,1,1]
    v_pk_fma_f32 v[88:89], v[68:69], v[132:133], v[88:89] op_sel:[0,0,0] op_sel_hi:[0,1,1]
    v_pk_fma_f32 v[90:91], v[68:69], v[134:135], v[90:91] op_sel:[0,0,0] op_sel_hi:[0,1,1]
    v_pk_fma_f32 v[92:93], v[68:69], v[136:137], v[92:93] op_sel:[0,0,0] op_sel_hi:[0,1,1]
    v_pk_fma_f32 v[94:95], v[68:69], v[138:139], v[94:95] op_sel:[0,0,0] op_sel_hi:[0,1,1]
    v_pk_fma_f32 v[96:97], v[68:69], v[140:141], v[96:97] op_sel:[0,0,0] op_sel_hi:[0,1,1]
    v_pk_fma_f32 v[98:99], v[68:69], v[142:143], v[98:99] op_sel:[0,0,0] op_sel_hi:[0,1,1]
    v_pk_fma_f32 v[100:101], v[68:69], v[144:145], v[100:101] op_sel:[0,0,0] op_sel_hi:[0,1,1]
    v_pk_fma_f32 v[102:103], v[68:69], v[146:147], v[102:103] op_sel:[0,0,0] op_sel_hi:[0,1,1]
    ds_read_b128 v[128:131], v2 offset:480
    ds_read_b128 v[132:135], v2 offset:496
    ds_read_b128 v[136:139], v2 offset:512
    ds_read_b128 v[140:143], v2 offset:528
    ds_read_b128 v[144:147], v2 offset:544
    s_waitcnt lgkmcnt(5)
    v_pk_fma_f32 v[84:85], v[68:69], v[148:149], v[84:85] op_sel:[1,0,0] op_sel_hi:[1,1,1]
    v_pk_fma_f32 v[86:87], v[68:69], v[150:151], v[86:87] op_sel:[1,0,0] op_sel_hi:[1,1,1]
    v_pk_fma_f32 v[88:89], v[68:69], v[152:153], v[88:89] op_sel:[1,0,0] op_sel_hi:[1,1,1]
    v_pk_fma_f32 v[90:91], v[68:69], v[154:155], v[90:91] op_sel:[1,0,0] op_sel_hi:[1,1,1]
    v_pk_fma_f32 v[92:93], v[68:69], v[156:157], v[92:93] op_sel:[1,0,0] op_sel_hi:[1,1,1]
    v_pk_fma_f32 v[94:95], v[68:69], v[158:159], v[94:95] op_sel:[1,0,0] op_sel_hi:[1,1,1]
    v_pk_fma_f32 v[96:97], v[68:69], v[160:161], v[96:97] op_sel:[1,0,0] op_sel_hi:[1,1,1]
    v_pk_fma_f32 v[98:99], v[68:69], v[162:163], v[98:99] op_sel:[1,0,0] op_sel_hi:[1,1,1]
    v_pk_fma_f32 v[100:101], v[68:69], v[164:165], v[100:101] op_sel:[1,0,0] op_sel_hi:[1,1,1]
    v_pk_fma_f32 v[102:103], v[68:69], v[166:167], v[102:103] op_sel:[1,0,0] op_sel_hi:[1,1,1]
    ds_read_b128 v[148:151], v2 offset:560
    ds_read_b128 v[152:155], v2 offset:576
    ds_read_b128 v[156:159], v2 offset:592
    ds_read_b128 v[160:163], v2 offset:608
    ds_read_b128 v[164:167], v2 offset:624
    s_waitcnt lgkmcnt(5)
    v_pk_fma_f32 v[84:85], v[70:71], v[128:129], v[84:85] op_sel:[0,0,0] op_sel_hi:[0,1,1]
    v_pk_fma_f32 v[86:87], v[70:71], v[130:131], v[86:87] op_sel:[0,0,0] op_sel_hi:[0,1,1]
    v_pk_fma_f32 v[88:89], v[70:71], v[132:133], v[88:89] op_sel:[0,0,0] op_sel_hi:[0,1,1]
    v_pk_fma_f32 v[90:91], v[70:71], v[134:135], v[90:91] op_sel:[0,0,0] op_sel_hi:[0,1,1]
    v_pk_fma_f32 v[92:93], v[70:71], v[136:137], v[92:93] op_sel:[0,0,0] op_sel_hi:[0,1,1]
    v_pk_fma_f32 v[94:95], v[70:71], v[138:139], v[94:95] op_sel:[0,0,0] op_sel_hi:[0,1,1]
    v_pk_fma_f32 v[96:97], v[70:71], v[140:141], v[96:97] op_sel:[0,0,0] op_sel_hi:[0,1,1]
    v_pk_fma_f32 v[98:99], v[70:71], v[142:143], v[98:99] op_sel:[0,0,0] op_sel_hi:[0,1,1]
    v_pk_fma_f32 v[100:101], v[70:71], v[144:145], v[100:101] op_sel:[0,0,0] op_sel_hi:[0,1,1]
    v_pk_fma_f32 v[102:103], v[70:71], v[146:147], v[102:103] op_sel:[0,0,0] op_sel_hi:[0,1,1]
    ds_read_b128 v[128:131], v2 offset:640
    ds_read_b128 v[132:135], v2 offset:656
    ds_read_b128 v[136:139], v2 offset:672
    ds_read_b128 v[140:143], v2 offset:688
    ds_read_b128 v[144:147], v2 offset:704
    s_waitcnt lgkmcnt(5)
    v_pk_fma_f32 v[84:85], v[70:71], v[148:149], v[84:85] op_sel:[1,0,0] op_sel_hi:[1,1,1]
    v_pk_fma_f32 v[86:87], v[70:71], v[150:151], v[86:87] op_sel:[1,0,0] op_sel_hi:[1,1,1]
    v_pk_fma_f32 v[88:89], v[70:71], v[152:153], v[88:89] op_sel:[1,0,0] op_sel_hi:[1,1,1]
    v_pk_fma_f32 v[90:91], v[70:71], v[154:155], v[90:91] op_sel:[1,0,0] op_sel_hi:[1,1,1]
    v_pk_fma_f32 v[92:93], v[70:71], v[156:157], v[92:93] op_sel:[1,0,0] op_sel_hi:[1,1,1]
    v_pk_fma_f32 v[94:95], v[70:71], v[158:159], v[94:95] op_sel:[1,0,0] op_sel_hi:[1,1,1]
    v_pk_fma_f32 v[96:97], v[70:71], v[160:161], v[96:97] op_sel:[1,0,0] op_sel_hi:[1,1,1]
    v_pk_fma_f32 v[98:99], v[70:71], v[162:163], v[98:99] op_sel:[1,0,0] op_sel_hi:[1,1,1]
    v_pk_fma_f32 v[100:101], v[70:71], v[164:165], v[100:101] op_sel:[1,0,0] op_sel_hi:[1,1,1]
    v_pk_fma_f32 v[102:103], v[70:71], v[166:167], v[102:103] op_sel:[1,0,0] op_sel_hi:[1,1,1]
    ds_read_b128 v[148:151], v2 offset:720
    ds_read_b128 v[152:155], v2 offset:736
    ds_read_b128 v[156:159], v2 offset:752
    ds_read_b128 v[160:163], v2 offset:768
    ds_read_b128 v[164:167], v2 offset:784
    s_waitcnt lgkmcnt(5)
    v_pk_fma_f32 v[84:85], v[72:73], v[128:129], v[84:85] op_sel:[0,0,0] op_sel_hi:[0,1,1]
    v_pk_fma_f32 v[86:87], v[72:73], v[130:131], v[86:87] op_sel:[0,0,0] op_sel_hi:[0,1,1]
    v_pk_fma_f32 v[88:89], v[72:73], v[132:133], v[88:89] op_sel:[0,0,0] op_sel_hi:[0,1,1]
    v_pk_fma_f32 v[90:91], v[72:73], v[134:135], v[90:91] op_sel:[0,0,0] op_sel_hi:[0,1,1]
    v_pk_fma_f32 v[92:93], v[72:73], v[136:137], v[92:93] op_sel:[0,0,0] op_sel_hi:[0,1,1]
    v_pk_fma_f32 v[94:95], v[72:73], v[138:139], v[94:95] op_sel:[0,0,0] op_sel_hi:[0,1,1]
    v_pk_fma_f32 v[96:97], v[72:73], v[140:141], v[96:97] op_sel:[0,0,0] op_sel_hi:[0,1,1]
    v_pk_fma_f32 v[98:99], v[72:73], v[142:143], v[98:99] op_sel:[0,0,0] op_sel_hi:[0,1,1]
    v_pk_fma_f32 v[100:101], v[72:73], v[144:145], v[100:101] op_sel:[0,0,0] op_sel_hi:[0,1,1]
    v_pk_fma_f32 v[102:103], v[72:73], v[146:147], v[102:103] op_sel:[0,0,0] op_sel_hi:[0,1,1]
    ds_read_b128 v[128:131], v2 offset:800
    ds_read_b128 v[132:135], v2 offset:816
    ds_read_b128 v[136:139], v2 offset:832
    ds_read_b128 v[140:143], v2 offset:848
    ds_read_b128 v[144:147], v2 offset:864
    s_waitcnt lgkmcnt(5)
    v_pk_fma_f32 v[84:85], v[72:73], v[148:149], v[84:85] op_sel:[1,0,0] op_sel_hi:[1,1,1]
    v_pk_fma_f32 v[86:87], v[72:73], v[150:151], v[86:87] op_sel:[1,0,0] op_sel_hi:[1,1,1]
    v_pk_fma_f32 v[88:89], v[72:73], v[152:153], v[88:89] op_sel:[1,0,0] op_sel_hi:[1,1,1]
    v_pk_fma_f32 v[90:91], v[72:73], v[154:155], v[90:91] op_sel:[1,0,0] op_sel_hi:[1,1,1]
    v_pk_fma_f32 v[92:93], v[72:73], v[156:157], v[92:93] op_sel:[1,0,0] op_sel_hi:[1,1,1]
    v_pk_fma_f32 v[94:95], v[72:73], v[158:159], v[94:95] op_sel:[1,0,0] op_sel_hi:[1,1,1]
    v_pk_fma_f32 v[96:97], v[72:73], v[160:161], v[96:97] op_sel:[1,0,0] op_sel_hi:[1,1,1]
    v_pk_fma_f32 v[98:99], v[72:73], v[162:163], v[98:99] op_sel:[1,0,0] op_sel_hi:[1,1,1]
    v_pk_fma_f32 v[100:101], v[72:73], v[164:165], v[100:101] op_sel:[1,0,0] op_sel_hi:[1,1,1]
    v_pk_fma_f32 v[102:103], v[72:73], v[166:167], v[102:103] op_sel:[1,0,0] op_sel_hi:[1,1,1]
    ds_read_b128 v[148:151], v2 offset:880
    ds_read_b128 v[152:155], v2 offset:896
    ds_read_b128 v[156:159], v2 offset:912
    ds_read_b128 v[160:163], v2 offset:928
    ds_read_b128 v[164:167], v2 offset:944
    s_waitcnt lgkmcnt(5)
    v_pk_fma_f32 v[84:85], v[74:75], v[128:129], v[84:85] op_sel:[0,0,0] op_sel_hi:[0,1,1]
    v_pk_fma_f32 v[86:87], v[74:75], v[130:131], v[86:87] op_sel:[0,0,0] op_sel_hi:[0,1,1]
    v_pk_fma_f32 v[88:89], v[74:75], v[132:133], v[88:89] op_sel:[0,0,0] op_sel_hi:[0,1,1]
    v_pk_fma_f32 v[90:91], v[74:75], v[134:135], v[90:91] op_sel:[0,0,0] op_sel_hi:[0,1,1]
    v_pk_fma_f32 v[92:93], v[74:75], v[136:137], v[92:93] op_sel:[0,0,0] op_sel_hi:[0,1,1]
    v_pk_fma_f32 v[94:95], v[74:75], v[138:139], v[94:95] op_sel:[0,0,0] op_sel_hi:[0,1,1]
    v_pk_fma_f32 v[96:97], v[74:75], v[140:141], v[96:97] op_sel:[0,0,0] op_sel_hi:[0,1,1]
    v_pk_fma_f32 v[98:99], v[74:75], v[142:143], v[98:99] op_sel:[0,0,0] op_sel_hi:[0,1,1]
    v_pk_fma_f32 v[100:101], v[74:75], v[144:145], v[100:101] op_sel:[0,0,0] op_sel_hi:[0,1,1]
    v_pk_fma_f32 v[102:103], v[74:75], v[146:147], v[102:103] op_sel:[0,0,0] op_sel_hi:[0,1,1]
    ds_read_b128 v[128:131], v2 offset:960
    ds_read_b128 v[132:135], v2 offset:976
    ds_read_b128 v[136:139], v2 offset:992
    ds_read_b128 v[140:143], v2 offset:1008
    ds_read_b128 v[144:147], v2 offset:1024
    s_waitcnt lgkmcnt(5)
    v_pk_fma_f32 v[84:85], v[74:75], v[148:149], v[84:85] op_sel:[1,0,0] op_sel_hi:[1,1,1]
    v_pk_fma_f32 v[86:87], v[74:75], v[150:151], v[86:87] op_sel:[1,0,0] op_sel_hi:[1,1,1]
    v_pk_fma_f32 v[88:89], v[74:75], v[152:153], v[88:89] op_sel:[1,0,0] op_sel_hi:[1,1,1]
    v_pk_fma_f32 v[90:91], v[74:75], v[154:155], v[90:91] op_sel:[1,0,0] op_sel_hi:[1,1,1]
    v_pk_fma_f32 v[92:93], v[74:75], v[156:157], v[92:93] op_sel:[1,0,0] op_sel_hi:[1,1,1]
    v_pk_fma_f32 v[94:95], v[74:75], v[158:159], v[94:95] op_sel:[1,0,0] op_sel_hi:[1,1,1]
    v_pk_fma_f32 v[96:97], v[74:75], v[160:161], v[96:97] op_sel:[1,0,0] op_sel_hi:[1,1,1]
    v_pk_fma_f32 v[98:99], v[74:75], v[162:163], v[98:99] op_sel:[1,0,0] op_sel_hi:[1,1,1]
    v_pk_fma_f32 v[100:101], v[74:75], v[164:165], v[100:101] op_sel:[1,0,0] op_sel_hi:[1,1,1]
    v_pk_fma_f32 v[102:103], v[74:75], v[166:167], v[102:103] op_sel:[1,0,0] op_sel_hi:[1,1,1]
    ds_read_b128 v[148:151], v2 offset:1040
    ds_read_b128 v[152:155], v2 offset:1056
    ds_read_b128 v[156:159], v2 offset:1072
    ds_read_b128 v[160:163], v2 offset:1088
    ds_read_b128 v[164:167], v2 offset:1104
    s_waitcnt lgkmcnt(5)
    v_pk_fma_f32 v[84:85], v[76:77], v[128:129], v[84:85] op_sel:[0,0,0] op_sel_hi:[0,1,1]
    v_pk_fma_f32 v[86:87], v[76:77], v[130:131], v[86:87] op_sel:[0,0,0] op_sel_hi:[0,1,1]
    v_pk_fma_f32 v[88:89], v[76:77], v[132:133], v[88:89] op_sel:[0,0,0] op_sel_hi:[0,1,1]
    v_pk_fma_f32 v[90:91], v[76:77], v[134:135], v[90:91] op_sel:[0,0,0] op_sel_hi:[0,1,1]
    v_pk_fma_f32 v[92:93], v[76:77], v[136:137], v[92:93] op_sel:[0,0,0] op_sel_hi:[0,1,1]
    v_pk_fma_f32 v[94:95], v[76:77], v[138:139], v[94:95] op_sel:[0,0,0] op_sel_hi:[0,1,1]
    v_pk_fma_f32 v[96:97], v[76:77], v[140:141], v[96:97] op_sel:[0,0,0] op_sel_hi:[0,1,1]
    v_pk_fma_f32 v[98:99], v[76:77], v[142:143], v[98:99] op_sel:[0,0,0] op_sel_hi:[0,1,1]
    v_pk_fma_f32 v[100:101], v[76:77], v[144:145], v[100:101] op_sel:[0,0,0] op_sel_hi:[0,1,1]
    v_pk_fma_f32 v[102:103], v[76:77], v[146:147], v[102:103] op_sel:[0,0,0] op_sel_hi:[0,1,1]
    ds_read_b128 v[128:131], v2 offset:1120
    ds_read_b128 v[132:135], v2 offset:1136
    ds_read_b128 v[136:139], v2 offset:1152
    ds_read_b128 v[140:143], v2 offset:1168
    ds_read_b128 v[144:147], v2 offset:1184
    s_waitcnt lgkmcnt(5)
    v_pk_fma_f32 v[84:85], v[76:77], v[148:149], v[84:85] op_sel:[1,0,0] op_sel_hi:[1,1,1]
    v_pk_fma_f32 v[86:87], v[76:77], v[150:151], v[86:87] op_sel:[1,0,0] op_sel_hi:[1,1,1]
    v_pk_fma_f32 v[88:89], v[76:77], v[152:153], v[88:89] op_sel:[1,0,0] op_sel_hi:[1,1,1]
    v_pk_fma_f32 v[90:91], v[76:77], v[154:155], v[90:91] op_sel:[1,0,0] op_sel_hi:[1,1,1]
    v_pk_fma_f32 v[92:93], v[76:77], v[156:157], v[92:93] op_sel:[1,0,0] op_sel_hi:[1,1,1]
    v_pk_fma_f32 v[94:95], v[76:77], v[158:159], v[94:95] op_sel:[1,0,0] op_sel_hi:[1,1,1]
    v_pk_fma_f32 v[96:97], v[76:77], v[160:161], v[96:97] op_sel:[1,0,0] op_sel_hi:[1,1,1]
    v_pk_fma_f32 v[98:99], v[76:77], v[162:163], v[98:99] op_sel:[1,0,0] op_sel_hi:[1,1,1]
    v_pk_fma_f32 v[100:101], v[76:77], v[164:165], v[100:101] op_sel:[1,0,0] op_sel_hi:[1,1,1]
    v_pk_fma_f32 v[102:103], v[76:77], v[166:167], v[102:103] op_sel:[1,0,0] op_sel_hi:[1,1,1]
    ds_read_b128 v[148:151], v2 offset:1200
    ds_read_b128 v[152:155], v2 offset:1216
    ds_read_b128 v[156:159], v2 offset:1232
    ds_read_b128 v[160:163], v2 offset:1248
    ds_read_b128 v[164:167], v2 offset:1264
    s_waitcnt lgkmcnt(5)
    v_pk_fma_f32 v[84:85], v[78:79], v[128:129], v[84:85] op_sel:[0,0,0] op_sel_hi:[0,1,1]
    v_pk_fma_f32 v[86:87], v[78:79], v[130:131], v[86:87] op_sel:[0,0,0] op_sel_hi:[0,1,1]
    v_pk_fma_f32 v[88:89], v[78:79], v[132:133], v[88:89] op_sel:[0,0,0] op_sel_hi:[0,1,1]
    v_pk_fma_f32 v[90:91], v[78:79], v[134:135], v[90:91] op_sel:[0,0,0] op_sel_hi:[0,1,1]
    v_pk_fma_f32 v[92:93], v[78:79], v[136:137], v[92:93] op_sel:[0,0,0] op_sel_hi:[0,1,1]
    v_pk_fma_f32 v[94:95], v[78:79], v[138:139], v[94:95] op_sel:[0,0,0] op_sel_hi:[0,1,1]
    v_pk_fma_f32 v[96:97], v[78:79], v[140:141], v[96:97] op_sel:[0,0,0] op_sel_hi:[0,1,1]
    v_pk_fma_f32 v[98:99], v[78:79], v[142:143], v[98:99] op_sel:[0,0,0] op_sel_hi:[0,1,1]
    v_pk_fma_f32 v[100:101], v[78:79], v[144:145], v[100:101] op_sel:[0,0,0] op_sel_hi:[0,1,1]
    v_pk_fma_f32 v[102:103], v[78:79], v[146:147], v[102:103] op_sel:[0,0,0] op_sel_hi:[0,1,1]
    ds_read_b128 v[128:131], v2 offset:1280
    ds_read_b128 v[132:135], v2 offset:1296
    ds_read_b128 v[136:139], v2 offset:1312
    ds_read_b128 v[140:143], v2 offset:1328
    ds_read_b128 v[144:147], v2 offset:1344
    s_waitcnt lgkmcnt(5)
    v_pk_fma_f32 v[84:85], v[78:79], v[148:149], v[84:85] op_sel:[1,0,0] op_sel_hi:[1,1,1]
    v_pk_fma_f32 v[86:87], v[78:79], v[150:151], v[86:87] op_sel:[1,0,0] op_sel_hi:[1,1,1]
    v_pk_fma_f32 v[88:89], v[78:79], v[152:153], v[88:89] op_sel:[1,0,0] op_sel_hi:[1,1,1]
    v_pk_fma_f32 v[90:91], v[78:79], v[154:155], v[90:91] op_sel:[1,0,0] op_sel_hi:[1,1,1]
    v_pk_fma_f32 v[92:93], v[78:79], v[156:157], v[92:93] op_sel:[1,0,0] op_sel_hi:[1,1,1]
    v_pk_fma_f32 v[94:95], v[78:79], v[158:159], v[94:95] op_sel:[1,0,0] op_sel_hi:[1,1,1]
    v_pk_fma_f32 v[96:97], v[78:79], v[160:161], v[96:97] op_sel:[1,0,0] op_sel_hi:[1,1,1]
    v_pk_fma_f32 v[98:99], v[78:79], v[162:163], v[98:99] op_sel:[1,0,0] op_sel_hi:[1,1,1]
    v_pk_fma_f32 v[100:101], v[78:79], v[164:165], v[100:101] op_sel:[1,0,0] op_sel_hi:[1,1,1]
    v_pk_fma_f32 v[102:103], v[78:79], v[166:167], v[102:103] op_sel:[1,0,0] op_sel_hi:[1,1,1]
    ds_read_b128 v[148:151], v2 offset:1360
    ds_read_b128 v[152:155], v2 offset:1376
    ds_read_b128 v[156:159], v2 offset:1392
    ds_read_b128 v[160:163], v2 offset:1408
    ds_read_b128 v[164:167], v2 offset:1424
    s_waitcnt lgkmcnt(5)
    v_pk_fma_f32 v[84:85], v[80:81], v[128:129], v[84:85] op_sel:[0,0,0] op_sel_hi:[0,1,1]
    v_pk_fma_f32 v[86:87], v[80:81], v[130:131], v[86:87] op_sel:[0,0,0] op_sel_hi:[0,1,1]
    v_pk_fma_f32 v[88:89], v[80:81], v[132:133], v[88:89] op_sel:[0,0,0] op_sel_hi:[0,1,1]
    v_pk_fma_f32 v[90:91], v[80:81], v[134:135], v[90:91] op_sel:[0,0,0] op_sel_hi:[0,1,1]
    v_pk_fma_f32 v[92:93], v[80:81], v[136:137], v[92:93] op_sel:[0,0,0] op_sel_hi:[0,1,1]
    v_pk_fma_f32 v[94:95], v[80:81], v[138:139], v[94:95] op_sel:[0,0,0] op_sel_hi:[0,1,1]
    v_pk_fma_f32 v[96:97], v[80:81], v[140:141], v[96:97] op_sel:[0,0,0] op_sel_hi:[0,1,1]
    v_pk_fma_f32 v[98:99], v[80:81], v[142:143], v[98:99] op_sel:[0,0,0] op_sel_hi:[0,1,1]
    v_pk_fma_f32 v[100:101], v[80:81], v[144:145], v[100:101] op_sel:[0,0,0] op_sel_hi:[0,1,1]
    v_pk_fma_f32 v[102:103], v[80:81], v[146:147], v[102:103] op_sel:[0,0,0] op_sel_hi:[0,1,1]
    ds_read_b128 v[128:131], v2 offset:1440
    ds_read_b128 v[132:135], v2 offset:1456
    ds_read_b128 v[136:139], v2 offset:1472
    ds_read_b128 v[140:143], v2 offset:1488
    ds_read_b128 v[144:147], v2 offset:1504
    s_waitcnt lgkmcnt(5)
    v_pk_fma_f32 v[84:85], v[80:81], v[148:149], v[84:85] op_sel:[1,0,0] op_sel_hi:[1,1,1]
    v_pk_fma_f32 v[86:87], v[80:81], v[150:151], v[86:87] op_sel:[1,0,0] op_sel_hi:[1,1,1]
    v_pk_fma_f32 v[88:89], v[80:81], v[152:153], v[88:89] op_sel:[1,0,0] op_sel_hi:[1,1,1]
    v_pk_fma_f32 v[90:91], v[80:81], v[154:155], v[90:91] op_sel:[1,0,0] op_sel_hi:[1,1,1]
    v_pk_fma_f32 v[92:93], v[80:81], v[156:157], v[92:93] op_sel:[1,0,0] op_sel_hi:[1,1,1]
    v_pk_fma_f32 v[94:95], v[80:81], v[158:159], v[94:95] op_sel:[1,0,0] op_sel_hi:[1,1,1]
    v_pk_fma_f32 v[96:97], v[80:81], v[160:161], v[96:97] op_sel:[1,0,0] op_sel_hi:[1,1,1]
    v_pk_fma_f32 v[98:99], v[80:81], v[162:163], v[98:99] op_sel:[1,0,0] op_sel_hi:[1,1,1]
    v_pk_fma_f32 v[100:101], v[80:81], v[164:165], v[100:101] op_sel:[1,0,0] op_sel_hi:[1,1,1]
    v_pk_fma_f32 v[102:103], v[80:81], v[166:167], v[102:103] op_sel:[1,0,0] op_sel_hi:[1,1,1]
    ds_read_b128 v[148:151], v2 offset:1520
    ds_read_b128 v[152:155], v2 offset:1536
    ds_read_b128 v[156:159], v2 offset:1552
    ds_read_b128 v[160:163], v2 offset:1568
    ds_read_b128 v[164:167], v2 offset:1584
    s_waitcnt lgkmcnt(5)
    v_pk_fma_f32 v[84:85], v[82:83], v[128:129], v[84:85] op_sel:[0,0,0] op_sel_hi:[0,1,1]
    v_pk_fma_f32 v[86:87], v[82:83], v[130:131], v[86:87] op_sel:[0,0,0] op_sel_hi:[0,1,1]
    v_pk_fma_f32 v[88:89], v[82:83], v[132:133], v[88:89] op_sel:[0,0,0] op_sel_hi:[0,1,1]
    v_pk_fma_f32 v[90:91], v[82:83], v[134:135], v[90:91] op_sel:[0,0,0] op_sel_hi:[0,1,1]
    v_pk_fma_f32 v[92:93], v[82:83], v[136:137], v[92:93] op_sel:[0,0,0] op_sel_hi:[0,1,1]
    v_pk_fma_f32 v[94:95], v[82:83], v[138:139], v[94:95] op_sel:[0,0,0] op_sel_hi:[0,1,1]
    v_pk_fma_f32 v[96:97], v[82:83], v[140:141], v[96:97] op_sel:[0,0,0] op_sel_hi:[0,1,1]
    v_pk_fma_f32 v[98:99], v[82:83], v[142:143], v[98:99] op_sel:[0,0,0] op_sel_hi:[0,1,1]
    v_pk_fma_f32 v[100:101], v[82:83], v[144:145], v[100:101] op_sel:[0,0,0] op_sel_hi:[0,1,1]
    v_pk_fma_f32 v[102:103], v[82:83], v[146:147], v[102:103] op_sel:[0,0,0] op_sel_hi:[0,1,1]
    s_waitcnt lgkmcnt(0)
    v_pk_fma_f32 v[84:85], v[82:83], v[148:149], v[84:85] op_sel:[1,0,0] op_sel_hi:[1,1,1]
    v_pk_fma_f32 v[86:87], v[82:83], v[150:151], v[86:87] op_sel:[1,0,0] op_sel_hi:[1,1,1]
    v_pk_fma_f32 v[88:89], v[82:83], v[152:153], v[88:89] op_sel:[1,0,0] op_sel_hi:[1,1,1]
    v_pk_fma_f32 v[90:91], v[82:83], v[154:155], v[90:91] op_sel:[1,0,0] op_sel_hi:[1,1,1]
    v_pk_fma_f32 v[92:93], v[82:83], v[156:157], v[92:93] op_sel:[1,0,0] op_sel_hi:[1,1,1]
    v_pk_fma_f32 v[94:95], v[82:83], v[158:159], v[94:95] op_sel:[1,0,0] op_sel_hi:[1,1,1]
    v_pk_fma_f32 v[96:97], v[82:83], v[160:161], v[96:97] op_sel:[1,0,0] op_sel_hi:[1,1,1]
    v_pk_fma_f32 v[98:99], v[82:83], v[162:163], v[98:99] op_sel:[1,0,0] op_sel_hi:[1,1,1]
    v_pk_fma_f32 v[100:101], v[82:83], v[164:165], v[100:101] op_sel:[1,0,0] op_sel_hi:[1,1,1]
    v_pk_fma_f32 v[102:103], v[82:83], v[166:167], v[102:103] op_sel:[1,0,0] op_sel_hi:[1,1,1]
    v_cvt_pk_bf16_f32 v124, v84, v85
    v_lshlrev_b32 v84, 16, v124
    v_and_b32 v85, 0xffff0000, v124
    v_cvt_pk_bf16_f32 v124, v86, v87
    v_lshlrev_b32 v86, 16, v124
    v_and_b32 v87, 0xffff0000, v124
    v_cvt_pk_bf16_f32 v124, v88, v89
    v_lshlrev_b32 v88, 16, v124
    v_and_b32 v89, 0xffff0000, v124
    v_cvt_pk_bf16_f32 v124, v90, v91
    v_lshlrev_b32 v90, 16, v124
    v_and_b32 v91, 0xffff0000, v124
    v_cvt_pk_bf16_f32 v124, v92, v93
    v_lshlrev_b32 v92, 16, v124
    v_and_b32 v93, 0xffff0000, v124
    v_cvt_pk_bf16_f32 v124, v94, v95
    v_lshlrev_b32 v94, 16, v124
    v_and_b32 v95, 0xffff0000, v124
    v_cvt_pk_bf16_f32 v124, v96, v97
    v_lshlrev_b32 v96, 16, v124
    v_and_b32 v97, 0xffff0000, v124
    v_cvt_pk_bf16_f32 v124, v98, v99
    v_lshlrev_b32 v98, 16, v124
    v_and_b32 v99, 0xffff0000, v124
    v_cvt_pk_bf16_f32 v124, v100, v101
    v_lshlrev_b32 v100, 16, v124
    v_and_b32 v101, 0xffff0000, v124
    v_cvt_pk_bf16_f32 v124, v102, v103
    v_lshlrev_b32 v102, 16, v124
    v_and_b32 v103, 0xffff0000, v124
    v_max_f32 v124, v84, v85
    v_min_f32 v125, v84, v85
    v_max_f32 v124, v124, v86
    v_min_f32 v125, v125, v86
    v_max_f32 v124, v124, v87
    v_min_f32 v125, v125, v87
    v_max_f32 v124, v124, v88
    v_min_f32 v125, v125, v88
    v_max_f32 v124, v124, v89
    v_min_f32 v125, v125, v89
    v_max_f32 v124, v124, v90
    v_min_f32 v125, v125, v90
    v_max_f32 v124, v124, v91
    v_min_f32 v125, v125, v91
    v_max_f32 v124, v124, v92
    v_min_f32 v125, v125, v92
    v_max_f32 v124, v124, v93
    v_min_f32 v125, v125, v93
    v_max_f32 v124, v124, v94
    v_min_f32 v125, v125, v94
    v_max_f32 v124, v124, v95
    v_min_f32 v125, v125, v95
    v_max_f32 v124, v124, v96
    v_min_f32 v125, v125, v96
    v_max_f32 v124, v124, v97
    v_min_f32 v125, v125, v97
    v_max_f32 v124, v124, v98
    v_min_f32 v125, v125, v98
    v_max_f32 v124, v124, v99
    v_min_f32 v125, v125, v99
    v_max_f32 v124, v124, v100
    v_min_f32 v125, v125, v100
    v_max_f32 v124, v124, v101
    v_min_f32 v125, v125, v101
    v_max_f32 v124, v124, v102
    v_min_f32 v125, v125, v102
    v_max_f32 v124, v124, v103
    v_min_f32 v125, v125, v103
    v_sub_f32 v104, v125, v84
    v_mul_f32 v104, 0x3fb8aa3b, v104
    v_exp_f32 v104, v104
    v_sub_f32 v84, v84, v124
    v_mul_f32 v84, 0x3fb8aa3b, v84
    v_exp_f32 v84, v84
    v_sub_f32 v105, v125, v85
    v_mul_f32 v105, 0x3fb8aa3b, v105
    v_exp_f32 v105, v105
    v_sub_f32 v85, v85, v124
    v_mul_f32 v85, 0x3fb8aa3b, v85
    v_exp_f32 v85, v85
    v_sub_f32 v106, v125, v86
    v_mul_f32 v106, 0x3fb8aa3b, v106
    v_exp_f32 v106, v106
    v_sub_f32 v86, v86, v124
    v_mul_f32 v86, 0x3fb8aa3b, v86
    v_exp_f32 v86, v86
    v_sub_f32 v107, v125, v87
    v_mul_f32 v107, 0x3fb8aa3b, v107
    v_exp_f32 v107, v107
    v_sub_f32 v87, v87, v124
    v_mul_f32 v87, 0x3fb8aa3b, v87
    v_exp_f32 v87, v87
    v_sub_f32 v108, v125, v88
    v_mul_f32 v108, 0x3fb8aa3b, v108
    v_exp_f32 v108, v108
    v_sub_f32 v88, v88, v124
    v_mul_f32 v88, 0x3fb8aa3b, v88
    v_exp_f32 v88, v88
    v_sub_f32 v109, v125, v89
    v_mul_f32 v109, 0x3fb8aa3b, v109
    v_exp_f32 v109, v109
    v_sub_f32 v89, v89, v124
    v_mul_f32 v89, 0x3fb8aa3b, v89
    v_exp_f32 v89, v89
    v_sub_f32 v110, v125, v90
    v_mul_f32 v110, 0x3fb8aa3b, v110
    v_exp_f32 v110, v110
    v_sub_f32 v90, v90, v124
    v_mul_f32 v90, 0x3fb8aa3b, v90
    v_exp_f32 v90, v90
    v_sub_f32 v111, v125, v91
    v_mul_f32 v111, 0x3fb8aa3b, v111
    v_exp_f32 v111, v111
    v_sub_f32 v91, v91, v124
    v_mul_f32 v91, 0x3fb8aa3b, v91
    v_exp_f32 v91, v91
    v_sub_f32 v112, v125, v92
    v_mul_f32 v112, 0x3fb8aa3b, v112
    v_exp_f32 v112, v112
    v_sub_f32 v92, v92, v124
    v_mul_f32 v92, 0x3fb8aa3b, v92
    v_exp_f32 v92, v92
    v_sub_f32 v113, v125, v93
    v_mul_f32 v113, 0x3fb8aa3b, v113
    v_exp_f32 v113, v113
    v_sub_f32 v93, v93, v124
    v_mul_f32 v93, 0x3fb8aa3b, v93
    v_exp_f32 v93, v93
    v_sub_f32 v114, v125, v94
    v_mul_f32 v114, 0x3fb8aa3b, v114
    v_exp_f32 v114, v114
    v_sub_f32 v94, v94, v124
    v_mul_f32 v94, 0x3fb8aa3b, v94
    v_exp_f32 v94, v94
    v_sub_f32 v115, v125, v95
    v_mul_f32 v115, 0x3fb8aa3b, v115
    v_exp_f32 v115, v115
    v_sub_f32 v95, v95, v124
    v_mul_f32 v95, 0x3fb8aa3b, v95
    v_exp_f32 v95, v95
    v_sub_f32 v116, v125, v96
    v_mul_f32 v116, 0x3fb8aa3b, v116
    v_exp_f32 v116, v116
    v_sub_f32 v96, v96, v124
    v_mul_f32 v96, 0x3fb8aa3b, v96
    v_exp_f32 v96, v96
    v_sub_f32 v117, v125, v97
    v_mul_f32 v117, 0x3fb8aa3b, v117
    v_exp_f32 v117, v117
    v_sub_f32 v97, v97, v124
    v_mul_f32 v97, 0x3fb8aa3b, v97
    v_exp_f32 v97, v97
    v_sub_f32 v118, v125, v98
    v_mul_f32 v118, 0x3fb8aa3b, v118
    v_exp_f32 v118, v118
    v_sub_f32 v98, v98, v124
    v_mul_f32 v98, 0x3fb8aa3b, v98
    v_exp_f32 v98, v98
    v_sub_f32 v119, v125, v99
    v_mul_f32 v119, 0x3fb8aa3b, v119
    v_exp_f32 v119, v119
    v_sub_f32 v99, v99, v124
    v_mul_f32 v99, 0x3fb8aa3b, v99
    v_exp_f32 v99, v99
    v_sub_f32 v120, v125, v100
    v_mul_f32 v120, 0x3fb8aa3b, v120
    v_exp_f32 v120, v120
    v_sub_f32 v100, v100, v124
    v_mul_f32 v100, 0x3fb8aa3b, v100
    v_exp_f32 v100, v100
    v_sub_f32 v121, v125, v101
    v_mul_f32 v121, 0x3fb8aa3b, v121
    v_exp_f32 v121, v121
    v_sub_f32 v101, v101, v124
    v_mul_f32 v101, 0x3fb8aa3b, v101
    v_exp_f32 v101, v101
    v_sub_f32 v122, v125, v102
    v_mul_f32 v122, 0x3fb8aa3b, v122
    v_exp_f32 v122, v122
    v_sub_f32 v102, v102, v124
    v_mul_f32 v102, 0x3fb8aa3b, v102
    v_exp_f32 v102, v102
    v_sub_f32 v123, v125, v103
    v_mul_f32 v123, 0x3fb8aa3b, v123
    v_exp_f32 v123, v123
    v_sub_f32 v103, v103, v124
    v_mul_f32 v103, 0x3fb8aa3b, v103
    v_exp_f32 v103, v103
    s_nop 0
    v_add_f32 v126, v84, v85
    v_add_f32 v127, v104, v105
    v_add_f32 v126, v126, v86
    v_add_f32 v127, v127, v106
    v_add_f32 v126, v126, v87
    v_add_f32 v127, v127, v107
    v_add_f32 v126, v126, v88
    v_add_f32 v127, v127, v108
    v_add_f32 v126, v126, v89
    v_add_f32 v127, v127, v109
    v_add_f32 v126, v126, v90
    v_add_f32 v127, v127, v110
    v_add_f32 v126, v126, v91
    v_add_f32 v127, v127, v111
    v_add_f32 v126, v126, v92
    v_add_f32 v127, v127, v112
    v_add_f32 v126, v126, v93
    v_add_f32 v127, v127, v113
    v_add_f32 v126, v126, v94
    v_add_f32 v127, v127, v114
    v_add_f32 v126, v126, v95
    v_add_f32 v127, v127, v115
    v_add_f32 v126, v126, v96
    v_add_f32 v127, v127, v116
    v_add_f32 v126, v126, v97
    v_add_f32 v127, v127, v117
    v_add_f32 v126, v126, v98
    v_add_f32 v127, v127, v118
    v_add_f32 v126, v126, v99
    v_add_f32 v127, v127, v119
    v_add_f32 v126, v126, v100
    v_add_f32 v127, v127, v120
    v_add_f32 v126, v126, v101
    v_add_f32 v127, v127, v121
    v_add_f32 v126, v126, v102
    v_add_f32 v127, v127, v122
    v_add_f32 v126, v126, v103
    v_add_f32 v127, v127, v123
    v_rcp_f32 v126, v126
    v_rcp_f32 v127, v127
    s_nop 0
    v_mul_f32 v84, v84, v126
    v_mul_f32 v104, v104, v127
    v_mul_f32 v85, v85, v126
    v_mul_f32 v105, v105, v127
    v_mul_f32 v86, v86, v126
    v_mul_f32 v106, v106, v127
    v_mul_f32 v87, v87, v126
    v_mul_f32 v107, v107, v127
    v_mul_f32 v88, v88, v126
    v_mul_f32 v108, v108, v127
    v_mul_f32 v89, v89, v126
    v_mul_f32 v109, v109, v127
    v_mul_f32 v90, v90, v126
    v_mul_f32 v110, v110, v127
    v_mul_f32 v91, v91, v126
    v_mul_f32 v111, v111, v127
    v_mul_f32 v92, v92, v126
    v_mul_f32 v112, v112, v127
    v_mul_f32 v93, v93, v126
    v_mul_f32 v113, v113, v127
    v_mul_f32 v94, v94, v126
    v_mul_f32 v114, v114, v127
    v_mul_f32 v95, v95, v126
    v_mul_f32 v115, v115, v127
    v_mul_f32 v96, v96, v126
    v_mul_f32 v116, v116, v127
    v_mul_f32 v97, v97, v126
    v_mul_f32 v117, v117, v127
    v_mul_f32 v98, v98, v126
    v_mul_f32 v118, v118, v127
    v_mul_f32 v99, v99, v126
    v_mul_f32 v119, v119, v127
    v_mul_f32 v100, v100, v126
    v_mul_f32 v120, v120, v127
    v_mul_f32 v101, v101, v126
    v_mul_f32 v121, v121, v127
    v_mul_f32 v102, v102, v126
    v_mul_f32 v122, v122, v127
    v_mul_f32 v103, v103, v126
    v_mul_f32 v123, v123, v127
    v_cvt_pk_bf16_f32 v124, v84, v85
    v_lshlrev_b32 v84, 16, v124
    v_and_b32 v85, 0xffff0000, v124
    v_cvt_pk_bf16_f32 v124, v86, v87
    v_lshlrev_b32 v86, 16, v124
    v_and_b32 v87, 0xffff0000, v124
    v_cvt_pk_bf16_f32 v124, v88, v89
    v_lshlrev_b32 v88, 16, v124
    v_and_b32 v89, 0xffff0000, v124
    v_cvt_pk_bf16_f32 v124, v90, v91
    v_lshlrev_b32 v90, 16, v124
    v_and_b32 v91, 0xffff0000, v124
    v_cvt_pk_bf16_f32 v124, v92, v93
    v_lshlrev_b32 v92, 16, v124
    v_and_b32 v93, 0xffff0000, v124
    v_cvt_pk_bf16_f32 v124, v94, v95
    v_lshlrev_b32 v94, 16, v124
    v_and_b32 v95, 0xffff0000, v124
    v_cvt_pk_bf16_f32 v124, v96, v97
    v_lshlrev_b32 v96, 16, v124
    v_and_b32 v97, 0xffff0000, v124
    v_cvt_pk_bf16_f32 v124, v98, v99
    v_lshlrev_b32 v98, 16, v124
    v_and_b32 v99, 0xffff0000, v124
    v_cvt_pk_bf16_f32 v124, v100, v101
    v_lshlrev_b32 v100, 16, v124
    v_and_b32 v101, 0xffff0000, v124
    v_cvt_pk_bf16_f32 v124, v102, v103
    v_lshlrev_b32 v102, 16, v124
    v_and_b32 v103, 0xffff0000, v124
    v_cvt_pk_bf16_f32 v124, v104, v105
    v_lshlrev_b32 v104, 16, v124
    v_and_b32 v105, 0xffff0000, v124
    v_cvt_pk_bf16_f32 v124, v106, v107
    v_lshlrev_b32 v106, 16, v124
    v_and_b32 v107, 0xffff0000, v124
    v_cvt_pk_bf16_f32 v124, v108, v109
    v_lshlrev_b32 v108, 16, v124
    v_and_b32 v109, 0xffff0000, v124
    v_cvt_pk_bf16_f32 v124, v110, v111
    v_lshlrev_b32 v110, 16, v124
    v_and_b32 v111, 0xffff0000, v124
    v_cvt_pk_bf16_f32 v124, v112, v113
    v_lshlrev_b32 v112, 16, v124
    v_and_b32 v113, 0xffff0000, v124
    v_cvt_pk_bf16_f32 v124, v114, v115
    v_lshlrev_b32 v114, 16, v124
    v_and_b32 v115, 0xffff0000, v124
    v_cvt_pk_bf16_f32 v124, v116, v117
    v_lshlrev_b32 v116, 16, v124
    v_and_b32 v117, 0xffff0000, v124
    v_cvt_pk_bf16_f32 v124, v118, v119
    v_lshlrev_b32 v118, 16, v124
    v_and_b32 v119, 0xffff0000, v124
    v_cvt_pk_bf16_f32 v124, v120, v121
    v_lshlrev_b32 v120, 16, v124
    v_and_b32 v121, 0xffff0000, v124
    v_cvt_pk_bf16_f32 v124, v122, v123
    v_lshlrev_b32 v122, 16, v124
    v_and_b32 v123, 0xffff0000, v124
    v_mov_b32 v64, 0
    v_mov_b32 v65, 0
    v_mov_b32 v66, 0
    v_mov_b32 v67, 0
    v_mov_b32 v68, 0
    v_mov_b32 v69, 0
    v_mov_b32 v70, 0
    v_mov_b32 v71, 0
    v_mov_b32 v72, 0
    v_mov_b32 v73, 0
    v_mov_b32 v74, 0
    v_mov_b32 v75, 0
    v_mov_b32 v76, 0
    v_mov_b32 v77, 0
    v_mov_b32 v78, 0
    v_mov_b32 v79, 0
    v_mov_b32 v80, 0
    v_mov_b32 v81, 0
    v_mov_b32 v82, 0
    v_mov_b32 v83, 0
    v_mov_b32 v128, 0x358637bd
    ds_read_b128 v[168:171], v2 offset:2048
    ds_read_b128 v[172:175], v2 offset:2064
    ds_read_b128 v[176:179], v2 offset:2080
    ds_read_b128 v[180:183], v2 offset:2096
    ds_read_b128 v[184:187], v2 offset:2112
    ds_read_b128 v[188:191], v2 offset:2128
    ds_read_b128 v[192:195], v2 offset:2144
    ds_read_b128 v[196:199], v2 offset:2160
    ds_read_b128 v[200:203], v2 offset:2176
    ds_read_b128 v[204:207], v2 offset:2192
    ds_read_b128 v[208:211], v2 offset:2208
    ds_read_b128 v[212:215], v2 offset:2224
    s_waitcnt lgkmcnt(6)
    v_pk_fma_f32 v[64:65], v[84:85], v[168:169], v[64:65] op_sel:[0,0,0] op_sel_hi:[0,1,1]
    v_pk_fma_f32 v[66:67], v[84:85], v[170:171], v[66:67] op_sel:[0,0,0] op_sel_hi:[0,1,1]
    v_pk_fma_f32 v[68:69], v[84:85], v[172:173], v[68:69] op_sel:[0,0,0] op_sel_hi:[0,1,1]
    v_pk_fma_f32 v[70:71], v[84:85], v[174:175], v[70:71] op_sel:[0,0,0] op_sel_hi:[0,1,1]
    v_pk_fma_f32 v[72:73], v[84:85], v[176:177], v[72:73] op_sel:[0,0,0] op_sel_hi:[0,1,1]
    v_pk_fma_f32 v[74:75], v[84:85], v[178:179], v[74:75] op_sel:[0,0,0] op_sel_hi:[0,1,1]
    v_pk_fma_f32 v[76:77], v[84:85], v[180:181], v[76:77] op_sel:[0,0,0] op_sel_hi:[0,1,1]
    v_pk_fma_f32 v[78:79], v[84:85], v[182:183], v[78:79] op_sel:[0,0,0] op_sel_hi:[0,1,1]
    v_pk_fma_f32 v[80:81], v[84:85], v[184:185], v[80:81] op_sel:[0,0,0] op_sel_hi:[0,1,1]
    v_pk_fma_f32 v[82:83], v[84:85], v[186:187], v[82:83] op_sel:[0,0,0] op_sel_hi:[0,1,1]
    v_fmac_f32 v128, v84, v188
    ds_read_b128 v[168:171], v2 offset:2240
    ds_read_b128 v[172:175], v2 offset:2256
    ds_read_b128 v[176:179], v2 offset:2272
    ds_read_b128 v[180:183], v2 offset:2288
    ds_read_b128 v[184:187], v2 offset:2304
    ds_read_b128 v[188:191], v2 offset:2320
    s_waitcnt lgkmcnt(6)
    v_pk_fma_f32 v[64:65], v[84:85], v[192:193], v[64:65] op_sel:[1,0,0] op_sel_hi:[1,1,1]
    v_pk_fma_f32 v[66:67], v[84:85], v[194:195], v[66:67] op_sel:[1,0,0] op_sel_hi:[1,1,1]
    v_pk_fma_f32 v[68:69], v[84:85], v[196:197], v[68:69] op_sel:[1,0,0] op_sel_hi:[1,1,1]
    v_pk_fma_f32 v[70:71], v[84:85], v[198:199], v[70:71] op_sel:[1,0,0] op_sel_hi:[1,1,1]
    v_pk_fma_f32 v[72:73], v[84:85], v[200:201], v[72:73] op_sel:[1,0,0] op_sel_hi:[1,1,1]
    v_pk_fma_f32 v[74:75], v[84:85], v[202:203], v[74:75] op_sel:[1,0,0] op_sel_hi:[1,1,1]
    v_pk_fma_f32 v[76:77], v[84:85], v[204:205], v[76:77] op_sel:[1,0,0] op_sel_hi:[1,1,1]
    v_pk_fma_f32 v[78:79], v[84:85], v[206:207], v[78:79] op_sel:[1,0,0] op_sel_hi:[1,1,1]
    v_pk_fma_f32 v[80:81], v[84:85], v[208:209], v[80:81] op_sel:[1,0,0] op_sel_hi:[1,1,1]
    v_pk_fma_f32 v[82:83], v[84:85], v[210:211], v[82:83] op_sel:[1,0,0] op_sel_hi:[1,1,1]
    v_fmac_f32 v128, v85, v212
    ds_read_b128 v[192:195], v2 offset:2336
    ds_read_b128 v[196:199], v2 offset:2352
    ds_read_b128 v[200:203], v2 offset:2368
    ds_read_b128 v[204:207], v2 offset:2384
    ds_read_b128 v[208:211], v2 offset:2400
    ds_read_b128 v[212:215], v2 offset:2416
    s_waitcnt lgkmcnt(6)
    v_pk_fma_f32 v[64:65], v[86:87], v[168:169], v[64:65] op_sel:[0,0,0] op_sel_hi:[0,1,1]
    v_pk_fma_f32 v[66:67], v[86:87], v[170:171], v[66:67] op_sel:[0,0,0] op_sel_hi:[0,1,1]
    v_pk_fma_f32 v[68:69], v[86:87], v[172:173], v[68:69] op_sel:[0,0,0] op_sel_hi:[0,1,1]
    v_pk_fma_f32 v[70:71], v[86:87], v[174:175], v[70:71] op_sel:[0,0,0] op_sel_hi:[0,1,1]
    v_pk_fma_f32 v[72:73], v[86:87], v[176:177], v[72:73] op_sel:[0,0,0] op_sel_hi:[0,1,1]
    v_pk_fma_f32 v[74:75], v[86:87], v[178:179], v[74:75] op_sel:[0,0,0] op_sel_hi:[0,1,1]
    v_pk_fma_f32 v[76:77], v[86:87], v[180:181], v[76:77] op_sel:[0,0,0] op_sel_hi:[0,1,1]
    v_pk_fma_f32 v[78:79], v[86:87], v[182:183], v[78:79] op_sel:[0,0,0] op_sel_hi:[0,1,1]
    v_pk_fma_f32 v[80:81], v[86:87], v[184:185], v[80:81] op_sel:[0,0,0] op_sel_hi:[0,1,1]
    v_pk_fma_f32 v[82:83], v[86:87], v[186:187], v[82:83] op_sel:[0,0,0] op_sel_hi:[0,1,1]
    v_fmac_f32 v128, v86, v188
    ds_read_b128 v[168:171], v2 offset:2432
    ds_read_b128 v[172:175], v2 offset:2448
    ds_read_b128 v[176:179], v2 offset:2464
    ds_read_b128 v[180:183], v2 offset:2480
    ds_read_b128 v[184:187], v2 offset:2496
    ds_read_b128 v[188:191], v2 offset:2512
    s_waitcnt lgkmcnt(6)
    v_pk_fma_f32 v[64:65], v[86:87], v[192:193], v[64:65] op_sel:[1,0,0] op_sel_hi:[1,1,1]
    v_pk_fma_f32 v[66:67], v[86:87], v[194:195], v[66:67] op_sel:[1,0,0] op_sel_hi:[1,1,1]
    v_pk_fma_f32 v[68:69], v[86:87], v[196:197], v[68:69] op_sel:[1,0,0] op_sel_hi:[1,1,1]
    v_pk_fma_f32 v[70:71], v[86:87], v[198:199], v[70:71] op_sel:[1,0,0] op_sel_hi:[1,1,1]
    v_pk_fma_f32 v[72:73], v[86:87], v[200:201], v[72:73] op_sel:[1,0,0] op_sel_hi:[1,1,1]
    v_pk_fma_f32 v[74:75], v[86:87], v[202:203], v[74:75] op_sel:[1,0,0] op_sel_hi:[1,1,1]
    v_pk_fma_f32 v[76:77], v[86:87], v[204:205], v[76:77] op_sel:[1,0,0] op_sel_hi:[1,1,1]
    v_pk_fma_f32 v[78:79], v[86:87], v[206:207], v[78:79] op_sel:[1,0,0] op_sel_hi:[1,1,1]
    v_pk_fma_f32 v[80:81], v[86:87], v[208:209], v[80:81] op_sel:[1,0,0] op_sel_hi:[1,1,1]
    v_pk_fma_f32 v[82:83], v[86:87], v[210:211], v[82:83] op_sel:[1,0,0] op_sel_hi:[1,1,1]
    v_fmac_f32 v128, v87, v212
    ds_read_b128 v[192:195], v2 offset:2528
    ds_read_b128 v[196:199], v2 offset:2544
    ds_read_b128 v[200:203], v2 offset:2560
    ds_read_b128 v[204:207], v2 offset:2576
    ds_read_b128 v[208:211], v2 offset:2592
    ds_read_b128 v[212:215], v2 offset:2608
    s_waitcnt lgkmcnt(6)
    v_pk_fma_f32 v[64:65], v[88:89], v[168:169], v[64:65] op_sel:[0,0,0] op_sel_hi:[0,1,1]
    v_pk_fma_f32 v[66:67], v[88:89], v[170:171], v[66:67] op_sel:[0,0,0] op_sel_hi:[0,1,1]
    v_pk_fma_f32 v[68:69], v[88:89], v[172:173], v[68:69] op_sel:[0,0,0] op_sel_hi:[0,1,1]
    v_pk_fma_f32 v[70:71], v[88:89], v[174:175], v[70:71] op_sel:[0,0,0] op_sel_hi:[0,1,1]
    v_pk_fma_f32 v[72:73], v[88:89], v[176:177], v[72:73] op_sel:[0,0,0] op_sel_hi:[0,1,1]
    v_pk_fma_f32 v[74:75], v[88:89], v[178:179], v[74:75] op_sel:[0,0,0] op_sel_hi:[0,1,1]
    v_pk_fma_f32 v[76:77], v[88:89], v[180:181], v[76:77] op_sel:[0,0,0] op_sel_hi:[0,1,1]
    v_pk_fma_f32 v[78:79], v[88:89], v[182:183], v[78:79] op_sel:[0,0,0] op_sel_hi:[0,1,1]
    v_pk_fma_f32 v[80:81], v[88:89], v[184:185], v[80:81] op_sel:[0,0,0] op_sel_hi:[0,1,1]
    v_pk_fma_f32 v[82:83], v[88:89], v[186:187], v[82:83] op_sel:[0,0,0] op_sel_hi:[0,1,1]
    v_fmac_f32 v128, v88, v188
    ds_read_b128 v[168:171], v2 offset:2624
    ds_read_b128 v[172:175], v2 offset:2640
    ds_read_b128 v[176:179], v2 offset:2656
    ds_read_b128 v[180:183], v2 offset:2672
    ds_read_b128 v[184:187], v2 offset:2688
    ds_read_b128 v[188:191], v2 offset:2704
    s_waitcnt lgkmcnt(6)
    v_pk_fma_f32 v[64:65], v[88:89], v[192:193], v[64:65] op_sel:[1,0,0] op_sel_hi:[1,1,1]
    v_pk_fma_f32 v[66:67], v[88:89], v[194:195], v[66:67] op_sel:[1,0,0] op_sel_hi:[1,1,1]
    v_pk_fma_f32 v[68:69], v[88:89], v[196:197], v[68:69] op_sel:[1,0,0] op_sel_hi:[1,1,1]
    v_pk_fma_f32 v[70:71], v[88:89], v[198:199], v[70:71] op_sel:[1,0,0] op_sel_hi:[1,1,1]
    v_pk_fma_f32 v[72:73], v[88:89], v[200:201], v[72:73] op_sel:[1,0,0] op_sel_hi:[1,1,1]
    v_pk_fma_f32 v[74:75], v[88:89], v[202:203], v[74:75] op_sel:[1,0,0] op_sel_hi:[1,1,1]
    v_pk_fma_f32 v[76:77], v[88:89], v[204:205], v[76:77] op_sel:[1,0,0] op_sel_hi:[1,1,1]
    v_pk_fma_f32 v[78:79], v[88:89], v[206:207], v[78:79] op_sel:[1,0,0] op_sel_hi:[1,1,1]
    v_pk_fma_f32 v[80:81], v[88:89], v[208:209], v[80:81] op_sel:[1,0,0] op_sel_hi:[1,1,1]
    v_pk_fma_f32 v[82:83], v[88:89], v[210:211], v[82:83] op_sel:[1,0,0] op_sel_hi:[1,1,1]
    v_fmac_f32 v128, v89, v212
    ds_read_b128 v[192:195], v2 offset:2720
    ds_read_b128 v[196:199], v2 offset:2736
    ds_read_b128 v[200:203], v2 offset:2752
    ds_read_b128 v[204:207], v2 offset:2768
    ds_read_b128 v[208:211], v2 offset:2784
    ds_read_b128 v[212:215], v2 offset:2800
    s_waitcnt lgkmcnt(6)
    v_pk_fma_f32 v[64:65], v[90:91], v[168:169], v[64:65] op_sel:[0,0,0] op_sel_hi:[0,1,1]
    v_pk_fma_f32 v[66:67], v[90:91], v[170:171], v[66:67] op_sel:[0,0,0] op_sel_hi:[0,1,1]
    v_pk_fma_f32 v[68:69], v[90:91], v[172:173], v[68:69] op_sel:[0,0,0] op_sel_hi:[0,1,1]
    v_pk_fma_f32 v[70:71], v[90:91], v[174:175], v[70:71] op_sel:[0,0,0] op_sel_hi:[0,1,1]
    v_pk_fma_f32 v[72:73], v[90:91], v[176:177], v[72:73] op_sel:[0,0,0] op_sel_hi:[0,1,1]
    v_pk_fma_f32 v[74:75], v[90:91], v[178:179], v[74:75] op_sel:[0,0,0] op_sel_hi:[0,1,1]
    v_pk_fma_f32 v[76:77], v[90:91], v[180:181], v[76:77] op_sel:[0,0,0] op_sel_hi:[0,1,1]
    v_pk_fma_f32 v[78:79], v[90:91], v[182:183], v[78:79] op_sel:[0,0,0] op_sel_hi:[0,1,1]
    v_pk_fma_f32 v[80:81], v[90:91], v[184:185], v[80:81] op_sel:[0,0,0] op_sel_hi:[0,1,1]
    v_pk_fma_f32 v[82:83], v[90:91], v[186:187], v[82:83] op_sel:[0,0,0] op_sel_hi:[0,1,1]
    v_fmac_f32 v128, v90, v188
    ds_read_b128 v[168:171], v2 offset:2816
    ds_read_b128 v[172:175], v2 offset:2832
    ds_read_b128 v[176:179], v2 offset:2848
    ds_read_b128 v[180:183], v2 offset:2864
    ds_read_b128 v[184:187], v2 offset:2880
    ds_read_b128 v[188:191], v2 offset:2896
    s_waitcnt lgkmcnt(6)
    v_pk_fma_f32 v[64:65], v[90:91], v[192:193], v[64:65] op_sel:[1,0,0] op_sel_hi:[1,1,1]
    v_pk_fma_f32 v[66:67], v[90:91], v[194:195], v[66:67] op_sel:[1,0,0] op_sel_hi:[1,1,1]
    v_pk_fma_f32 v[68:69], v[90:91], v[196:197], v[68:69] op_sel:[1,0,0] op_sel_hi:[1,1,1]
    v_pk_fma_f32 v[70:71], v[90:91], v[198:199], v[70:71] op_sel:[1,0,0] op_sel_hi:[1,1,1]
    v_pk_fma_f32 v[72:73], v[90:91], v[200:201], v[72:73] op_sel:[1,0,0] op_sel_hi:[1,1,1]
    v_pk_fma_f32 v[74:75], v[90:91], v[202:203], v[74:75] op_sel:[1,0,0] op_sel_hi:[1,1,1]
    v_pk_fma_f32 v[76:77], v[90:91], v[204:205], v[76:77] op_sel:[1,0,0] op_sel_hi:[1,1,1]
    v_pk_fma_f32 v[78:79], v[90:91], v[206:207], v[78:79] op_sel:[1,0,0] op_sel_hi:[1,1,1]
    v_pk_fma_f32 v[80:81], v[90:91], v[208:209], v[80:81] op_sel:[1,0,0] op_sel_hi:[1,1,1]
    v_pk_fma_f32 v[82:83], v[90:91], v[210:211], v[82:83] op_sel:[1,0,0] op_sel_hi:[1,1,1]
    v_fmac_f32 v128, v91, v212
    ds_read_b128 v[192:195], v2 offset:2912
    ds_read_b128 v[196:199], v2 offset:2928
    ds_read_b128 v[200:203], v2 offset:2944
    ds_read_b128 v[204:207], v2 offset:2960
    ds_read_b128 v[208:211], v2 offset:2976
    ds_read_b128 v[212:215], v2 offset:2992
    s_waitcnt lgkmcnt(6)
    v_pk_fma_f32 v[64:65], v[92:93], v[168:169], v[64:65] op_sel:[0,0,0] op_sel_hi:[0,1,1]
    v_pk_fma_f32 v[66:67], v[92:93], v[170:171], v[66:67] op_sel:[0,0,0] op_sel_hi:[0,1,1]
    v_pk_fma_f32 v[68:69], v[92:93], v[172:173], v[68:69] op_sel:[0,0,0] op_sel_hi:[0,1,1]
    v_pk_fma_f32 v[70:71], v[92:93], v[174:175], v[70:71] op_sel:[0,0,0] op_sel_hi:[0,1,1]
    v_pk_fma_f32 v[72:73], v[92:93], v[176:177], v[72:73] op_sel:[0,0,0] op_sel_hi:[0,1,1]
    v_pk_fma_f32 v[74:75], v[92:93], v[178:179], v[74:75] op_sel:[0,0,0] op_sel_hi:[0,1,1]
    v_pk_fma_f32 v[76:77], v[92:93], v[180:181], v[76:77] op_sel:[0,0,0] op_sel_hi:[0,1,1]
    v_pk_fma_f32 v[78:79], v[92:93], v[182:183], v[78:79] op_sel:[0,0,0] op_sel_hi:[0,1,1]
    v_pk_fma_f32 v[80:81], v[92:93], v[184:185], v[80:81] op_sel:[0,0,0] op_sel_hi:[0,1,1]
    v_pk_fma_f32 v[82:83], v[92:93], v[186:187], v[82:83] op_sel:[0,0,0] op_sel_hi:[0,1,1]
    v_fmac_f32 v128, v92, v188
    ds_read_b128 v[168:171], v2 offset:3008
    ds_read_b128 v[172:175], v2 offset:3024
    ds_read_b128 v[176:179], v2 offset:3040
    ds_read_b128 v[180:183], v2 offset:3056
    ds_read_b128 v[184:187], v2 offset:3072
    ds_read_b128 v[188:191], v2 offset:3088
    s_waitcnt lgkmcnt(6)
    v_pk_fma_f32 v[64:65], v[92:93], v[192:193], v[64:65] op_sel:[1,0,0] op_sel_hi:[1,1,1]
    v_pk_fma_f32 v[66:67], v[92:93], v[194:195], v[66:67] op_sel:[1,0,0] op_sel_hi:[1,1,1]
    v_pk_fma_f32 v[68:69], v[92:93], v[196:197], v[68:69] op_sel:[1,0,0] op_sel_hi:[1,1,1]
    v_pk_fma_f32 v[70:71], v[92:93], v[198:199], v[70:71] op_sel:[1,0,0] op_sel_hi:[1,1,1]
    v_pk_fma_f32 v[72:73], v[92:93], v[200:201], v[72:73] op_sel:[1,0,0] op_sel_hi:[1,1,1]
    v_pk_fma_f32 v[74:75], v[92:93], v[202:203], v[74:75] op_sel:[1,0,0] op_sel_hi:[1,1,1]
    v_pk_fma_f32 v[76:77], v[92:93], v[204:205], v[76:77] op_sel:[1,0,0] op_sel_hi:[1,1,1]
    v_pk_fma_f32 v[78:79], v[92:93], v[206:207], v[78:79] op_sel:[1,0,0] op_sel_hi:[1,1,1]
    v_pk_fma_f32 v[80:81], v[92:93], v[208:209], v[80:81] op_sel:[1,0,0] op_sel_hi:[1,1,1]
    v_pk_fma_f32 v[82:83], v[92:93], v[210:211], v[82:83] op_sel:[1,0,0] op_sel_hi:[1,1,1]
    v_fmac_f32 v128, v93, v212
    ds_read_b128 v[192:195], v2 offset:3104
    ds_read_b128 v[196:199], v2 offset:3120
    ds_read_b128 v[200:203], v2 offset:3136
    ds_read_b128 v[204:207], v2 offset:3152
    ds_read_b128 v[208:211], v2 offset:3168
    ds_read_b128 v[212:215], v2 offset:3184
    s_waitcnt lgkmcnt(6)
    v_pk_fma_f32 v[64:65], v[94:95], v[168:169], v[64:65] op_sel:[0,0,0] op_sel_hi:[0,1,1]
    v_pk_fma_f32 v[66:67], v[94:95], v[170:171], v[66:67] op_sel:[0,0,0] op_sel_hi:[0,1,1]
    v_pk_fma_f32 v[68:69], v[94:95], v[172:173], v[68:69] op_sel:[0,0,0] op_sel_hi:[0,1,1]
    v_pk_fma_f32 v[70:71], v[94:95], v[174:175], v[70:71] op_sel:[0,0,0] op_sel_hi:[0,1,1]
    v_pk_fma_f32 v[72:73], v[94:95], v[176:177], v[72:73] op_sel:[0,0,0] op_sel_hi:[0,1,1]
    v_pk_fma_f32 v[74:75], v[94:95], v[178:179], v[74:75] op_sel:[0,0,0] op_sel_hi:[0,1,1]
    v_pk_fma_f32 v[76:77], v[94:95], v[180:181], v[76:77] op_sel:[0,0,0] op_sel_hi:[0,1,1]
    v_pk_fma_f32 v[78:79], v[94:95], v[182:183], v[78:79] op_sel:[0,0,0] op_sel_hi:[0,1,1]
    v_pk_fma_f32 v[80:81], v[94:95], v[184:185], v[80:81] op_sel:[0,0,0] op_sel_hi:[0,1,1]
    v_pk_fma_f32 v[82:83], v[94:95], v[186:187], v[82:83] op_sel:[0,0,0] op_sel_hi:[0,1,1]
    v_fmac_f32 v128, v94, v188
    ds_read_b128 v[168:171], v2 offset:3200
    ds_read_b128 v[172:175], v2 offset:3216
    ds_read_b128 v[176:179], v2 offset:3232
    ds_read_b128 v[180:183], v2 offset:3248
    ds_read_b128 v[184:187], v2 offset:3264
    ds_read_b128 v[188:191], v2 offset:3280
    s_waitcnt lgkmcnt(6)
    v_pk_fma_f32 v[64:65], v[94:95], v[192:193], v[64:65] op_sel:[1,0,0] op_sel_hi:[1,1,1]
    v_pk_fma_f32 v[66:67], v[94:95], v[194:195], v[66:67] op_sel:[1,0,0] op_sel_hi:[1,1,1]
    v_pk_fma_f32 v[68:69], v[94:95], v[196:197], v[68:69] op_sel:[1,0,0] op_sel_hi:[1,1,1]
    v_pk_fma_f32 v[70:71], v[94:95], v[198:199], v[70:71] op_sel:[1,0,0] op_sel_hi:[1,1,1]
    v_pk_fma_f32 v[72:73], v[94:95], v[200:201], v[72:73] op_sel:[1,0,0] op_sel_hi:[1,1,1]
    v_pk_fma_f32 v[74:75], v[94:95], v[202:203], v[74:75] op_sel:[1,0,0] op_sel_hi:[1,1,1]
    v_pk_fma_f32 v[76:77], v[94:95], v[204:205], v[76:77] op_sel:[1,0,0] op_sel_hi:[1,1,1]
    v_pk_fma_f32 v[78:79], v[94:95], v[206:207], v[78:79] op_sel:[1,0,0] op_sel_hi:[1,1,1]
    v_pk_fma_f32 v[80:81], v[94:95], v[208:209], v[80:81] op_sel:[1,0,0] op_sel_hi:[1,1,1]
    v_pk_fma_f32 v[82:83], v[94:95], v[210:211], v[82:83] op_sel:[1,0,0] op_sel_hi:[1,1,1]
    v_fmac_f32 v128, v95, v212
    ds_read_b128 v[192:195], v2 offset:3296
    ds_read_b128 v[196:199], v2 offset:3312
    ds_read_b128 v[200:203], v2 offset:3328
    ds_read_b128 v[204:207], v2 offset:3344
    ds_read_b128 v[208:211], v2 offset:3360
    ds_read_b128 v[212:215], v2 offset:3376
    s_waitcnt lgkmcnt(6)
    v_pk_fma_f32 v[64:65], v[96:97], v[168:169], v[64:65] op_sel:[0,0,0] op_sel_hi:[0,1,1]
    v_pk_fma_f32 v[66:67], v[96:97], v[170:171], v[66:67] op_sel:[0,0,0] op_sel_hi:[0,1,1]
    v_pk_fma_f32 v[68:69], v[96:97], v[172:173], v[68:69] op_sel:[0,0,0] op_sel_hi:[0,1,1]
    v_pk_fma_f32 v[70:71], v[96:97], v[174:175], v[70:71] op_sel:[0,0,0] op_sel_hi:[0,1,1]
    v_pk_fma_f32 v[72:73], v[96:97], v[176:177], v[72:73] op_sel:[0,0,0] op_sel_hi:[0,1,1]
    v_pk_fma_f32 v[74:75], v[96:97], v[178:179], v[74:75] op_sel:[0,0,0] op_sel_hi:[0,1,1]
    v_pk_fma_f32 v[76:77], v[96:97], v[180:181], v[76:77] op_sel:[0,0,0] op_sel_hi:[0,1,1]
    v_pk_fma_f32 v[78:79], v[96:97], v[182:183], v[78:79] op_sel:[0,0,0] op_sel_hi:[0,1,1]
    v_pk_fma_f32 v[80:81], v[96:97], v[184:185], v[80:81] op_sel:[0,0,0] op_sel_hi:[0,1,1]
    v_pk_fma_f32 v[82:83], v[96:97], v[186:187], v[82:83] op_sel:[0,0,0] op_sel_hi:[0,1,1]
    v_fmac_f32 v128, v96, v188
    ds_read_b128 v[168:171], v2 offset:3392
    ds_read_b128 v[172:175], v2 offset:3408
    ds_read_b128 v[176:179], v2 offset:3424
    ds_read_b128 v[180:183], v2 offset:3440
    ds_read_b128 v[184:187], v2 offset:3456
    ds_read_b128 v[188:191], v2 offset:3472
    s_waitcnt lgkmcnt(6)
    v_pk_fma_f32 v[64:65], v[96:97], v[192:193], v[64:65] op_sel:[1,0,0] op_sel_hi:[1,1,1]
    v_pk_fma_f32 v[66:67], v[96:97], v[194:195], v[66:67] op_sel:[1,0,0] op_sel_hi:[1,1,1]
    v_pk_fma_f32 v[68:69], v[96:97], v[196:197], v[68:69] op_sel:[1,0,0] op_sel_hi:[1,1,1]
    v_pk_fma_f32 v[70:71], v[96:97], v[198:199], v[70:71] op_sel:[1,0,0] op_sel_hi:[1,1,1]
    v_pk_fma_f32 v[72:73], v[96:97], v[200:201], v[72:73] op_sel:[1,0,0] op_sel_hi:[1,1,1]
    v_pk_fma_f32 v[74:75], v[96:97], v[202:203], v[74:75] op_sel:[1,0,0] op_sel_hi:[1,1,1]
    v_pk_fma_f32 v[76:77], v[96:97], v[204:205], v[76:77] op_sel:[1,0,0] op_sel_hi:[1,1,1]
    v_pk_fma_f32 v[78:79], v[96:97], v[206:207], v[78:79] op_sel:[1,0,0] op_sel_hi:[1,1,1]
    v_pk_fma_f32 v[80:81], v[96:97], v[208:209], v[80:81] op_sel:[1,0,0] op_sel_hi:[1,1,1]
    v_pk_fma_f32 v[82:83], v[96:97], v[210:211], v[82:83] op_sel:[1,0,0] op_sel_hi:[1,1,1]
    v_fmac_f32 v128, v97, v212
    ds_read_b128 v[192:195], v2 offset:3488
    ds_read_b128 v[196:199], v2 offset:3504
    ds_read_b128 v[200:203], v2 offset:3520
    ds_read_b128 v[204:207], v2 offset:3536
    ds_read_b128 v[208:211], v2 offset:3552
    ds_read_b128 v[212:215], v2 offset:3568
    s_waitcnt lgkmcnt(6)
    v_pk_fma_f32 v[64:65], v[98:99], v[168:169], v[64:65] op_sel:[0,0,0] op_sel_hi:[0,1,1]
    v_pk_fma_f32 v[66:67], v[98:99], v[170:171], v[66:67] op_sel:[0,0,0] op_sel_hi:[0,1,1]
    v_pk_fma_f32 v[68:69], v[98:99], v[172:173], v[68:69] op_sel:[0,0,0] op_sel_hi:[0,1,1]
    v_pk_fma_f32 v[70:71], v[98:99], v[174:175], v[70:71] op_sel:[0,0,0] op_sel_hi:[0,1,1]
    v_pk_fma_f32 v[72:73], v[98:99], v[176:177], v[72:73] op_sel:[0,0,0] op_sel_hi:[0,1,1]
    v_pk_fma_f32 v[74:75], v[98:99], v[178:179], v[74:75] op_sel:[0,0,0] op_sel_hi:[0,1,1]
    v_pk_fma_f32 v[76:77], v[98:99], v[180:181], v[76:77] op_sel:[0,0,0] op_sel_hi:[0,1,1]
    v_pk_fma_f32 v[78:79], v[98:99], v[182:183], v[78:79] op_sel:[0,0,0] op_sel_hi:[0,1,1]
    v_pk_fma_f32 v[80:81], v[98:99], v[184:185], v[80:81] op_sel:[0,0,0] op_sel_hi:[0,1,1]
    v_pk_fma_f32 v[82:83], v[98:99], v[186:187], v[82:83] op_sel:[0,0,0] op_sel_hi:[0,1,1]
    v_fmac_f32 v128, v98, v188
    ds_read_b128 v[168:171], v2 offset:3584
    ds_read_b128 v[172:175], v2 offset:3600
    ds_read_b128 v[176:179], v2 offset:3616
    ds_read_b128 v[180:183], v2 offset:3632
    ds_read_b128 v[184:187], v2 offset:3648
    ds_read_b128 v[188:191], v2 offset:3664
    s_waitcnt lgkmcnt(6)
    v_pk_fma_f32 v[64:65], v[98:99], v[192:193], v[64:65] op_sel:[1,0,0] op_sel_hi:[1,1,1]
    v_pk_fma_f32 v[66:67], v[98:99], v[194:195], v[66:67] op_sel:[1,0,0] op_sel_hi:[1,1,1]
    v_pk_fma_f32 v[68:69], v[98:99], v[196:197], v[68:69] op_sel:[1,0,0] op_sel_hi:[1,1,1]
    v_pk_fma_f32 v[70:71], v[98:99], v[198:199], v[70:71] op_sel:[1,0,0] op_sel_hi:[1,1,1]
    v_pk_fma_f32 v[72:73], v[98:99], v[200:201], v[72:73] op_sel:[1,0,0] op_sel_hi:[1,1,1]
    v_pk_fma_f32 v[74:75], v[98:99], v[202:203], v[74:75] op_sel:[1,0,0] op_sel_hi:[1,1,1]
    v_pk_fma_f32 v[76:77], v[98:99], v[204:205], v[76:77] op_sel:[1,0,0] op_sel_hi:[1,1,1]
    v_pk_fma_f32 v[78:79], v[98:99], v[206:207], v[78:79] op_sel:[1,0,0] op_sel_hi:[1,1,1]
    v_pk_fma_f32 v[80:81], v[98:99], v[208:209], v[80:81] op_sel:[1,0,0] op_sel_hi:[1,1,1]
    v_pk_fma_f32 v[82:83], v[98:99], v[210:211], v[82:83] op_sel:[1,0,0] op_sel_hi:[1,1,1]
    v_fmac_f32 v128, v99, v212
    ds_read_b128 v[192:195], v2 offset:3680
    ds_read_b128 v[196:199], v2 offset:3696
    ds_read_b128 v[200:203], v2 offset:3712
    ds_read_b128 v[204:207], v2 offset:3728
    ds_read_b128 v[208:211], v2 offset:3744
    ds_read_b128 v[212:215], v2 offset:3760
    s_waitcnt lgkmcnt(6)
    v_pk_fma_f32 v[64:65], v[100:101], v[168:169], v[64:65] op_sel:[0,0,0] op_sel_hi:[0,1,1]
    v_pk_fma_f32 v[66:67], v[100:101], v[170:171], v[66:67] op_sel:[0,0,0] op_sel_hi:[0,1,1]
    v_pk_fma_f32 v[68:69], v[100:101], v[172:173], v[68:69] op_sel:[0,0,0] op_sel_hi:[0,1,1]
    v_pk_fma_f32 v[70:71], v[100:101], v[174:175], v[70:71] op_sel:[0,0,0] op_sel_hi:[0,1,1]
    v_pk_fma_f32 v[72:73], v[100:101], v[176:177], v[72:73] op_sel:[0,0,0] op_sel_hi:[0,1,1]
    v_pk_fma_f32 v[74:75], v[100:101], v[178:179], v[74:75] op_sel:[0,0,0] op_sel_hi:[0,1,1]
    v_pk_fma_f32 v[76:77], v[100:101], v[180:181], v[76:77] op_sel:[0,0,0] op_sel_hi:[0,1,1]
    v_pk_fma_f32 v[78:79], v[100:101], v[182:183], v[78:79] op_sel:[0,0,0] op_sel_hi:[0,1,1]
    v_pk_fma_f32 v[80:81], v[100:101], v[184:185], v[80:81] op_sel:[0,0,0] op_sel_hi:[0,1,1]
    v_pk_fma_f32 v[82:83], v[100:101], v[186:187], v[82:83] op_sel:[0,0,0] op_sel_hi:[0,1,1]
    v_fmac_f32 v128, v100, v188
    ds_read_b128 v[168:171], v2 offset:3776
    ds_read_b128 v[172:175], v2 offset:3792
    ds_read_b128 v[176:179], v2 offset:3808
    ds_read_b128 v[180:183], v2 offset:3824
    ds_read_b128 v[184:187], v2 offset:3840
    ds_read_b128 v[188:191], v2 offset:3856
    s_waitcnt lgkmcnt(6)
    v_pk_fma_f32 v[64:65], v[100:101], v[192:193], v[64:65] op_sel:[1,0,0] op_sel_hi:[1,1,1]
    v_pk_fma_f32 v[66:67], v[100:101], v[194:195], v[66:67] op_sel:[1,0,0] op_sel_hi:[1,1,1]
    v_pk_fma_f32 v[68:69], v[100:101], v[196:197], v[68:69] op_sel:[1,0,0] op_sel_hi:[1,1,1]
    v_pk_fma_f32 v[70:71], v[100:101], v[198:199], v[70:71] op_sel:[1,0,0] op_sel_hi:[1,1,1]
    v_pk_fma_f32 v[72:73], v[100:101], v[200:201], v[72:73] op_sel:[1,0,0] op_sel_hi:[1,1,1]
    v_pk_fma_f32 v[74:75], v[100:101], v[202:203], v[74:75] op_sel:[1,0,0] op_sel_hi:[1,1,1]
    v_pk_fma_f32 v[76:77], v[100:101], v[204:205], v[76:77] op_sel:[1,0,0] op_sel_hi:[1,1,1]
    v_pk_fma_f32 v[78:79], v[100:101], v[206:207], v[78:79] op_sel:[1,0,0] op_sel_hi:[1,1,1]
    v_pk_fma_f32 v[80:81], v[100:101], v[208:209], v[80:81] op_sel:[1,0,0] op_sel_hi:[1,1,1]
    v_pk_fma_f32 v[82:83], v[100:101], v[210:211], v[82:83] op_sel:[1,0,0] op_sel_hi:[1,1,1]
    v_fmac_f32 v128, v101, v212
    ds_read_b128 v[192:195], v2 offset:3872
    ds_read_b128 v[196:199], v2 offset:3888
    ds_read_b128 v[200:203], v2 offset:3904
    ds_read_b128 v[204:207], v2 offset:3920
    ds_read_b128 v[208:211], v2 offset:3936
    ds_read_b128 v[212:215], v2 offset:3952
    s_waitcnt lgkmcnt(6)
    v_pk_fma_f32 v[64:65], v[102:103], v[168:169], v[64:65] op_sel:[0,0,0] op_sel_hi:[0,1,1]
    v_pk_fma_f32 v[66:67], v[102:103], v[170:171], v[66:67] op_sel:[0,0,0] op_sel_hi:[0,1,1]
    v_pk_fma_f32 v[68:69], v[102:103], v[172:173], v[68:69] op_sel:[0,0,0] op_sel_hi:[0,1,1]
    v_pk_fma_f32 v[70:71], v[102:103], v[174:175], v[70:71] op_sel:[0,0,0] op_sel_hi:[0,1,1]
    v_pk_fma_f32 v[72:73], v[102:103], v[176:177], v[72:73] op_sel:[0,0,0] op_sel_hi:[0,1,1]
    v_pk_fma_f32 v[74:75], v[102:103], v[178:179], v[74:75] op_sel:[0,0,0] op_sel_hi:[0,1,1]
    v_pk_fma_f32 v[76:77], v[102:103], v[180:181], v[76:77] op_sel:[0,0,0] op_sel_hi:[0,1,1]
    v_pk_fma_f32 v[78:79], v[102:103], v[182:183], v[78:79] op_sel:[0,0,0] op_sel_hi:[0,1,1]
    v_pk_fma_f32 v[80:81], v[102:103], v[184:185], v[80:81] op_sel:[0,0,0] op_sel_hi:[0,1,1]
    v_pk_fma_f32 v[82:83], v[102:103], v[186:187], v[82:83] op_sel:[0,0,0] op_sel_hi:[0,1,1]
    v_fmac_f32 v128, v102, v188
    ds_read_b128 v[168:171], v2 offset:3968
    ds_read_b128 v[172:175], v2 offset:3984
    ds_read_b128 v[176:179], v2 offset:4000
    ds_read_b128 v[180:183], v2 offset:4016
    ds_read_b128 v[184:187], v2 offset:4032
    ds_read_b128 v[188:191], v2 offset:4048
    s_waitcnt lgkmcnt(6)
    v_pk_fma_f32 v[64:65], v[102:103], v[192:193], v[64:65] op_sel:[1,0,0] op_sel_hi:[1,1,1]
    v_pk_fma_f32 v[66:67], v[102:103], v[194:195], v[66:67] op_sel:[1,0,0] op_sel_hi:[1,1,1]
    v_pk_fma_f32 v[68:69], v[102:103], v[196:197], v[68:69] op_sel:[1,0,0] op_sel_hi:[1,1,1]
    v_pk_fma_f32 v[70:71], v[102:103], v[198:199], v[70:71] op_sel:[1,0,0] op_sel_hi:[1,1,1]
    v_pk_fma_f32 v[72:73], v[102:103], v[200:201], v[72:73] op_sel:[1,0,0] op_sel_hi:[1,1,1]
    v_pk_fma_f32 v[74:75], v[102:103], v[202:203], v[74:75] op_sel:[1,0,0] op_sel_hi:[1,1,1]
    v_pk_fma_f32 v[76:77], v[102:103], v[204:205], v[76:77] op_sel:[1,0,0] op_sel_hi:[1,1,1]
    v_pk_fma_f32 v[78:79], v[102:103], v[206:207], v[78:79] op_sel:[1,0,0] op_sel_hi:[1,1,1]
    v_pk_fma_f32 v[80:81], v[102:103], v[208:209], v[80:81] op_sel:[1,0,0] op_sel_hi:[1,1,1]
    v_pk_fma_f32 v[82:83], v[102:103], v[210:211], v[82:83] op_sel:[1,0,0] op_sel_hi:[1,1,1]
    v_fmac_f32 v128, v103, v212
    ds_read_b128 v[192:195], v2 offset:4064
    ds_read_b128 v[196:199], v2 offset:4080
    ds_read_b128 v[200:203], v2 offset:4096
    ds_read_b128 v[204:207], v2 offset:4112
    ds_read_b128 v[208:211], v2 offset:4128
    ds_read_b128 v[212:215], v2 offset:4144
    s_waitcnt lgkmcnt(6)
    v_pk_fma_f32 v[64:65], v[104:105], v[168:169], v[64:65] op_sel:[0,0,0] op_sel_hi:[0,1,1]
    v_pk_fma_f32 v[66:67], v[104:105], v[170:171], v[66:67] op_sel:[0,0,0] op_sel_hi:[0,1,1]
    v_pk_fma_f32 v[68:69], v[104:105], v[172:173], v[68:69] op_sel:[0,0,0] op_sel_hi:[0,1,1]
    v_pk_fma_f32 v[70:71], v[104:105], v[174:175], v[70:71] op_sel:[0,0,0] op_sel_hi:[0,1,1]
    v_pk_fma_f32 v[72:73], v[104:105], v[176:177], v[72:73] op_sel:[0,0,0] op_sel_hi:[0,1,1]
    v_pk_fma_f32 v[74:75], v[104:105], v[178:179], v[74:75] op_sel:[0,0,0] op_sel_hi:[0,1,1]
    v_pk_fma_f32 v[76:77], v[104:105], v[180:181], v[76:77] op_sel:[0,0,0] op_sel_hi:[0,1,1]
    v_pk_fma_f32 v[78:79], v[104:105], v[182:183], v[78:79] op_sel:[0,0,0] op_sel_hi:[0,1,1]
    v_pk_fma_f32 v[80:81], v[104:105], v[184:185], v[80:81] op_sel:[0,0,0] op_sel_hi:[0,1,1]
    v_pk_fma_f32 v[82:83], v[104:105], v[186:187], v[82:83] op_sel:[0,0,0] op_sel_hi:[0,1,1]
    v_fmac_f32 v128, v104, v188
    ds_read_b128 v[168:171], v2 offset:4160
    ds_read_b128 v[172:175], v2 offset:4176
    ds_read_b128 v[176:179], v2 offset:4192
    ds_read_b128 v[180:183], v2 offset:4208
    ds_read_b128 v[184:187], v2 offset:4224
    ds_read_b128 v[188:191], v2 offset:4240
    s_waitcnt lgkmcnt(6)
    v_pk_fma_f32 v[64:65], v[104:105], v[192:193], v[64:65] op_sel:[1,0,0] op_sel_hi:[1,1,1]
    v_pk_fma_f32 v[66:67], v[104:105], v[194:195], v[66:67] op_sel:[1,0,0] op_sel_hi:[1,1,1]
    v_pk_fma_f32 v[68:69], v[104:105], v[196:197], v[68:69] op_sel:[1,0,0] op_sel_hi:[1,1,1]
    v_pk_fma_f32 v[70:71], v[104:105], v[198:199], v[70:71] op_sel:[1,0,0] op_sel_hi:[1,1,1]
    v_pk_fma_f32 v[72:73], v[104:105], v[200:201], v[72:73] op_sel:[1,0,0] op_sel_hi:[1,1,1]
    v_pk_fma_f32 v[74:75], v[104:105], v[202:203], v[74:75] op_sel:[1,0,0] op_sel_hi:[1,1,1]
    v_pk_fma_f32 v[76:77], v[104:105], v[204:205], v[76:77] op_sel:[1,0,0] op_sel_hi:[1,1,1]
    v_pk_fma_f32 v[78:79], v[104:105], v[206:207], v[78:79] op_sel:[1,0,0] op_sel_hi:[1,1,1]
    v_pk_fma_f32 v[80:81], v[104:105], v[208:209], v[80:81] op_sel:[1,0,0] op_sel_hi:[1,1,1]
    v_pk_fma_f32 v[82:83], v[104:105], v[210:211], v[82:83] op_sel:[1,0,0] op_sel_hi:[1,1,1]
    v_fmac_f32 v128, v105, v212
    ds_read_b128 v[192:195], v2 offset:4256
    ds_read_b128 v[196:199], v2 offset:4272
    ds_read_b128 v[200:203], v2 offset:4288
    ds_read_b128 v[204:207], v2 offset:4304
    ds_read_b128 v[208:211], v2 offset:4320
    ds_read_b128 v[212:215], v2 offset:4336
    s_waitcnt lgkmcnt(6)
    v_pk_fma_f32 v[64:65], v[106:107], v[168:169], v[64:65] op_sel:[0,0,0] op_sel_hi:[0,1,1]
    v_pk_fma_f32 v[66:67], v[106:107], v[170:171], v[66:67] op_sel:[0,0,0] op_sel_hi:[0,1,1]
    v_pk_fma_f32 v[68:69], v[106:107], v[172:173], v[68:69] op_sel:[0,0,0] op_sel_hi:[0,1,1]
    v_pk_fma_f32 v[70:71], v[106:107], v[174:175], v[70:71] op_sel:[0,0,0] op_sel_hi:[0,1,1]
    v_pk_fma_f32 v[72:73], v[106:107], v[176:177], v[72:73] op_sel:[0,0,0] op_sel_hi:[0,1,1]
    v_pk_fma_f32 v[74:75], v[106:107], v[178:179], v[74:75] op_sel:[0,0,0] op_sel_hi:[0,1,1]
    v_pk_fma_f32 v[76:77], v[106:107], v[180:181], v[76:77] op_sel:[0,0,0] op_sel_hi:[0,1,1]
    v_pk_fma_f32 v[78:79], v[106:107], v[182:183], v[78:79] op_sel:[0,0,0] op_sel_hi:[0,1,1]
    v_pk_fma_f32 v[80:81], v[106:107], v[184:185], v[80:81] op_sel:[0,0,0] op_sel_hi:[0,1,1]
    v_pk_fma_f32 v[82:83], v[106:107], v[186:187], v[82:83] op_sel:[0,0,0] op_sel_hi:[0,1,1]
    v_fmac_f32 v128, v106, v188
    ds_read_b128 v[168:171], v2 offset:4352
    ds_read_b128 v[172:175], v2 offset:4368
    ds_read_b128 v[176:179], v2 offset:4384
    ds_read_b128 v[180:183], v2 offset:4400
    ds_read_b128 v[184:187], v2 offset:4416
    ds_read_b128 v[188:191], v2 offset:4432
    s_waitcnt lgkmcnt(6)
    v_pk_fma_f32 v[64:65], v[106:107], v[192:193], v[64:65] op_sel:[1,0,0] op_sel_hi:[1,1,1]
    v_pk_fma_f32 v[66:67], v[106:107], v[194:195], v[66:67] op_sel:[1,0,0] op_sel_hi:[1,1,1]
    v_pk_fma_f32 v[68:69], v[106:107], v[196:197], v[68:69] op_sel:[1,0,0] op_sel_hi:[1,1,1]
    v_pk_fma_f32 v[70:71], v[106:107], v[198:199], v[70:71] op_sel:[1,0,0] op_sel_hi:[1,1,1]
    v_pk_fma_f32 v[72:73], v[106:107], v[200:201], v[72:73] op_sel:[1,0,0] op_sel_hi:[1,1,1]
    v_pk_fma_f32 v[74:75], v[106:107], v[202:203], v[74:75] op_sel:[1,0,0] op_sel_hi:[1,1,1]
    v_pk_fma_f32 v[76:77], v[106:107], v[204:205], v[76:77] op_sel:[1,0,0] op_sel_hi:[1,1,1]
    v_pk_fma_f32 v[78:79], v[106:107], v[206:207], v[78:79] op_sel:[1,0,0] op_sel_hi:[1,1,1]
    v_pk_fma_f32 v[80:81], v[106:107], v[208:209], v[80:81] op_sel:[1,0,0] op_sel_hi:[1,1,1]
    v_pk_fma_f32 v[82:83], v[106:107], v[210:211], v[82:83] op_sel:[1,0,0] op_sel_hi:[1,1,1]
    v_fmac_f32 v128, v107, v212
    ds_read_b128 v[192:195], v2 offset:4448
    ds_read_b128 v[196:199], v2 offset:4464
    ds_read_b128 v[200:203], v2 offset:4480
    ds_read_b128 v[204:207], v2 offset:4496
    ds_read_b128 v[208:211], v2 offset:4512
    ds_read_b128 v[212:215], v2 offset:4528
    s_waitcnt lgkmcnt(6)
    v_pk_fma_f32 v[64:65], v[108:109], v[168:169], v[64:65] op_sel:[0,0,0] op_sel_hi:[0,1,1]
    v_pk_fma_f32 v[66:67], v[108:109], v[170:171], v[66:67] op_sel:[0,0,0] op_sel_hi:[0,1,1]
    v_pk_fma_f32 v[68:69], v[108:109], v[172:173], v[68:69] op_sel:[0,0,0] op_sel_hi:[0,1,1]
    v_pk_fma_f32 v[70:71], v[108:109], v[174:175], v[70:71] op_sel:[0,0,0] op_sel_hi:[0,1,1]
    v_pk_fma_f32 v[72:73], v[108:109], v[176:177], v[72:73] op_sel:[0,0,0] op_sel_hi:[0,1,1]
    v_pk_fma_f32 v[74:75], v[108:109], v[178:179], v[74:75] op_sel:[0,0,0] op_sel_hi:[0,1,1]
    v_pk_fma_f32 v[76:77], v[108:109], v[180:181], v[76:77] op_sel:[0,0,0] op_sel_hi:[0,1,1]
    v_pk_fma_f32 v[78:79], v[108:109], v[182:183], v[78:79] op_sel:[0,0,0] op_sel_hi:[0,1,1]
    v_pk_fma_f32 v[80:81], v[108:109], v[184:185], v[80:81] op_sel:[0,0,0] op_sel_hi:[0,1,1]
    v_pk_fma_f32 v[82:83], v[108:109], v[186:187], v[82:83] op_sel:[0,0,0] op_sel_hi:[0,1,1]
    v_fmac_f32 v128, v108, v188
    ds_read_b128 v[168:171], v2 offset:4544
    ds_read_b128 v[172:175], v2 offset:4560
    ds_read_b128 v[176:179], v2 offset:4576
    ds_read_b128 v[180:183], v2 offset:4592
    ds_read_b128 v[184:187], v2 offset:4608
    ds_read_b128 v[188:191], v2 offset:4624
    s_waitcnt lgkmcnt(6)
    v_pk_fma_f32 v[64:65], v[108:109], v[192:193], v[64:65] op_sel:[1,0,0] op_sel_hi:[1,1,1]
    v_pk_fma_f32 v[66:67], v[108:109], v[194:195], v[66:67] op_sel:[1,0,0] op_sel_hi:[1,1,1]
    v_pk_fma_f32 v[68:69], v[108:109], v[196:197], v[68:69] op_sel:[1,0,0] op_sel_hi:[1,1,1]
    v_pk_fma_f32 v[70:71], v[108:109], v[198:199], v[70:71] op_sel:[1,0,0] op_sel_hi:[1,1,1]
    v_pk_fma_f32 v[72:73], v[108:109], v[200:201], v[72:73] op_sel:[1,0,0] op_sel_hi:[1,1,1]
    v_pk_fma_f32 v[74:75], v[108:109], v[202:203], v[74:75] op_sel:[1,0,0] op_sel_hi:[1,1,1]
    v_pk_fma_f32 v[76:77], v[108:109], v[204:205], v[76:77] op_sel:[1,0,0] op_sel_hi:[1,1,1]
    v_pk_fma_f32 v[78:79], v[108:109], v[206:207], v[78:79] op_sel:[1,0,0] op_sel_hi:[1,1,1]
    v_pk_fma_f32 v[80:81], v[108:109], v[208:209], v[80:81] op_sel:[1,0,0] op_sel_hi:[1,1,1]
    v_pk_fma_f32 v[82:83], v[108:109], v[210:211], v[82:83] op_sel:[1,0,0] op_sel_hi:[1,1,1]
    v_fmac_f32 v128, v109, v212
    ds_read_b128 v[192:195], v2 offset:4640
    ds_read_b128 v[196:199], v2 offset:4656
    ds_read_b128 v[200:203], v2 offset:4672
    ds_read_b128 v[204:207], v2 offset:4688
    ds_read_b128 v[208:211], v2 offset:4704
    ds_read_b128 v[212:215], v2 offset:4720
    s_waitcnt lgkmcnt(6)
    v_pk_fma_f32 v[64:65], v[110:111], v[168:169], v[64:65] op_sel:[0,0,0] op_sel_hi:[0,1,1]
    v_pk_fma_f32 v[66:67], v[110:111], v[170:171], v[66:67] op_sel:[0,0,0] op_sel_hi:[0,1,1]
    v_pk_fma_f32 v[68:69], v[110:111], v[172:173], v[68:69] op_sel:[0,0,0] op_sel_hi:[0,1,1]
    v_pk_fma_f32 v[70:71], v[110:111], v[174:175], v[70:71] op_sel:[0,0,0] op_sel_hi:[0,1,1]
    v_pk_fma_f32 v[72:73], v[110:111], v[176:177], v[72:73] op_sel:[0,0,0] op_sel_hi:[0,1,1]
    v_pk_fma_f32 v[74:75], v[110:111], v[178:179], v[74:75] op_sel:[0,0,0] op_sel_hi:[0,1,1]
    v_pk_fma_f32 v[76:77], v[110:111], v[180:181], v[76:77] op_sel:[0,0,0] op_sel_hi:[0,1,1]
    v_pk_fma_f32 v[78:79], v[110:111], v[182:183], v[78:79] op_sel:[0,0,0] op_sel_hi:[0,1,1]
    v_pk_fma_f32 v[80:81], v[110:111], v[184:185], v[80:81] op_sel:[0,0,0] op_sel_hi:[0,1,1]
    v_pk_fma_f32 v[82:83], v[110:111], v[186:187], v[82:83] op_sel:[0,0,0] op_sel_hi:[0,1,1]
    v_fmac_f32 v128, v110, v188
    ds_read_b128 v[168:171], v2 offset:4736
    ds_read_b128 v[172:175], v2 offset:4752
    ds_read_b128 v[176:179], v2 offset:4768
    ds_read_b128 v[180:183], v2 offset:4784
    ds_read_b128 v[184:187], v2 offset:4800
    ds_read_b128 v[188:191], v2 offset:4816
    s_waitcnt lgkmcnt(6)
    v_pk_fma_f32 v[64:65], v[110:111], v[192:193], v[64:65] op_sel:[1,0,0] op_sel_hi:[1,1,1]
    v_pk_fma_f32 v[66:67], v[110:111], v[194:195], v[66:67] op_sel:[1,0,0] op_sel_hi:[1,1,1]
    v_pk_fma_f32 v[68:69], v[110:111], v[196:197], v[68:69] op_sel:[1,0,0] op_sel_hi:[1,1,1]
    v_pk_fma_f32 v[70:71], v[110:111], v[198:199], v[70:71] op_sel:[1,0,0] op_sel_hi:[1,1,1]
    v_pk_fma_f32 v[72:73], v[110:111], v[200:201], v[72:73] op_sel:[1,0,0] op_sel_hi:[1,1,1]
    v_pk_fma_f32 v[74:75], v[110:111], v[202:203], v[74:75] op_sel:[1,0,0] op_sel_hi:[1,1,1]
    v_pk_fma_f32 v[76:77], v[110:111], v[204:205], v[76:77] op_sel:[1,0,0] op_sel_hi:[1,1,1]
    v_pk_fma_f32 v[78:79], v[110:111], v[206:207], v[78:79] op_sel:[1,0,0] op_sel_hi:[1,1,1]
    v_pk_fma_f32 v[80:81], v[110:111], v[208:209], v[80:81] op_sel:[1,0,0] op_sel_hi:[1,1,1]
    v_pk_fma_f32 v[82:83], v[110:111], v[210:211], v[82:83] op_sel:[1,0,0] op_sel_hi:[1,1,1]
    v_fmac_f32 v128, v111, v212
    ds_read_b128 v[192:195], v2 offset:4832
    ds_read_b128 v[196:199], v2 offset:4848
    ds_read_b128 v[200:203], v2 offset:4864
    ds_read_b128 v[204:207], v2 offset:4880
    ds_read_b128 v[208:211], v2 offset:4896
    ds_read_b128 v[212:215], v2 offset:4912
    s_waitcnt lgkmcnt(6)
    v_pk_fma_f32 v[64:65], v[112:113], v[168:169], v[64:65] op_sel:[0,0,0] op_sel_hi:[0,1,1]
    v_pk_fma_f32 v[66:67], v[112:113], v[170:171], v[66:67] op_sel:[0,0,0] op_sel_hi:[0,1,1]
    v_pk_fma_f32 v[68:69], v[112:113], v[172:173], v[68:69] op_sel:[0,0,0] op_sel_hi:[0,1,1]
    v_pk_fma_f32 v[70:71], v[112:113], v[174:175], v[70:71] op_sel:[0,0,0] op_sel_hi:[0,1,1]
    v_pk_fma_f32 v[72:73], v[112:113], v[176:177], v[72:73] op_sel:[0,0,0] op_sel_hi:[0,1,1]
    v_pk_fma_f32 v[74:75], v[112:113], v[178:179], v[74:75] op_sel:[0,0,0] op_sel_hi:[0,1,1]
    v_pk_fma_f32 v[76:77], v[112:113], v[180:181], v[76:77] op_sel:[0,0,0] op_sel_hi:[0,1,1]
    v_pk_fma_f32 v[78:79], v[112:113], v[182:183], v[78:79] op_sel:[0,0,0] op_sel_hi:[0,1,1]
    v_pk_fma_f32 v[80:81], v[112:113], v[184:185], v[80:81] op_sel:[0,0,0] op_sel_hi:[0,1,1]
    v_pk_fma_f32 v[82:83], v[112:113], v[186:187], v[82:83] op_sel:[0,0,0] op_sel_hi:[0,1,1]
    v_fmac_f32 v128, v112, v188
    ds_read_b128 v[168:171], v2 offset:4928
    ds_read_b128 v[172:175], v2 offset:4944
    ds_read_b128 v[176:179], v2 offset:4960
    ds_read_b128 v[180:183], v2 offset:4976
    ds_read_b128 v[184:187], v2 offset:4992
    ds_read_b128 v[188:191], v2 offset:5008
    s_waitcnt lgkmcnt(6)
    v_pk_fma_f32 v[64:65], v[112:113], v[192:193], v[64:65] op_sel:[1,0,0] op_sel_hi:[1,1,1]
    v_pk_fma_f32 v[66:67], v[112:113], v[194:195], v[66:67] op_sel:[1,0,0] op_sel_hi:[1,1,1]
    v_pk_fma_f32 v[68:69], v[112:113], v[196:197], v[68:69] op_sel:[1,0,0] op_sel_hi:[1,1,1]
    v_pk_fma_f32 v[70:71], v[112:113], v[198:199], v[70:71] op_sel:[1,0,0] op_sel_hi:[1,1,1]
    v_pk_fma_f32 v[72:73], v[112:113], v[200:201], v[72:73] op_sel:[1,0,0] op_sel_hi:[1,1,1]
    v_pk_fma_f32 v[74:75], v[112:113], v[202:203], v[74:75] op_sel:[1,0,0] op_sel_hi:[1,1,1]
    v_pk_fma_f32 v[76:77], v[112:113], v[204:205], v[76:77] op_sel:[1,0,0] op_sel_hi:[1,1,1]
    v_pk_fma_f32 v[78:79], v[112:113], v[206:207], v[78:79] op_sel:[1,0,0] op_sel_hi:[1,1,1]
    v_pk_fma_f32 v[80:81], v[112:113], v[208:209], v[80:81] op_sel:[1,0,0] op_sel_hi:[1,1,1]
    v_pk_fma_f32 v[82:83], v[112:113], v[210:211], v[82:83] op_sel:[1,0,0] op_sel_hi:[1,1,1]
    v_fmac_f32 v128, v113, v212
    ds_read_b128 v[192:195], v2 offset:5024
    ds_read_b128 v[196:199], v2 offset:5040
    ds_read_b128 v[200:203], v2 offset:5056
    ds_read_b128 v[204:207], v2 offset:5072
    ds_read_b128 v[208:211], v2 offset:5088
    ds_read_b128 v[212:215], v2 offset:5104
    s_waitcnt lgkmcnt(6)
    v_pk_fma_f32 v[64:65], v[114:115], v[168:169], v[64:65] op_sel:[0,0,0] op_sel_hi:[0,1,1]
    v_pk_fma_f32 v[66:67], v[114:115], v[170:171], v[66:67] op_sel:[0,0,0] op_sel_hi:[0,1,1]
    v_pk_fma_f32 v[68:69], v[114:115], v[172:173], v[68:69] op_sel:[0,0,0] op_sel_hi:[0,1,1]
    v_pk_fma_f32 v[70:71], v[114:115], v[174:175], v[70:71] op_sel:[0,0,0] op_sel_hi:[0,1,1]
    v_pk_fma_f32 v[72:73], v[114:115], v[176:177], v[72:73] op_sel:[0,0,0] op_sel_hi:[0,1,1]
    v_pk_fma_f32 v[74:75], v[114:115], v[178:179], v[74:75] op_sel:[0,0,0] op_sel_hi:[0,1,1]
    v_pk_fma_f32 v[76:77], v[114:115], v[180:181], v[76:77] op_sel:[0,0,0] op_sel_hi:[0,1,1]
    v_pk_fma_f32 v[78:79], v[114:115], v[182:183], v[78:79] op_sel:[0,0,0] op_sel_hi:[0,1,1]
    v_pk_fma_f32 v[80:81], v[114:115], v[184:185], v[80:81] op_sel:[0,0,0] op_sel_hi:[0,1,1]
    v_pk_fma_f32 v[82:83], v[114:115], v[186:187], v[82:83] op_sel:[0,0,0] op_sel_hi:[0,1,1]
    v_fmac_f32 v128, v114, v188
    ds_read_b128 v[168:171], v2 offset:5120
    ds_read_b128 v[172:175], v2 offset:5136
    ds_read_b128 v[176:179], v2 offset:5152
    ds_read_b128 v[180:183], v2 offset:5168
    ds_read_b128 v[184:187], v2 offset:5184
    ds_read_b128 v[188:191], v2 offset:5200
    s_waitcnt lgkmcnt(6)
    v_pk_fma_f32 v[64:65], v[114:115], v[192:193], v[64:65] op_sel:[1,0,0] op_sel_hi:[1,1,1]
    v_pk_fma_f32 v[66:67], v[114:115], v[194:195], v[66:67] op_sel:[1,0,0] op_sel_hi:[1,1,1]
    v_pk_fma_f32 v[68:69], v[114:115], v[196:197], v[68:69] op_sel:[1,0,0] op_sel_hi:[1,1,1]
    v_pk_fma_f32 v[70:71], v[114:115], v[198:199], v[70:71] op_sel:[1,0,0] op_sel_hi:[1,1,1]
    v_pk_fma_f32 v[72:73], v[114:115], v[200:201], v[72:73] op_sel:[1,0,0] op_sel_hi:[1,1,1]
    v_pk_fma_f32 v[74:75], v[114:115], v[202:203], v[74:75] op_sel:[1,0,0] op_sel_hi:[1,1,1]
    v_pk_fma_f32 v[76:77], v[114:115], v[204:205], v[76:77] op_sel:[1,0,0] op_sel_hi:[1,1,1]
    v_pk_fma_f32 v[78:79], v[114:115], v[206:207], v[78:79] op_sel:[1,0,0] op_sel_hi:[1,1,1]
    v_pk_fma_f32 v[80:81], v[114:115], v[208:209], v[80:81] op_sel:[1,0,0] op_sel_hi:[1,1,1]
    v_pk_fma_f32 v[82:83], v[114:115], v[210:211], v[82:83] op_sel:[1,0,0] op_sel_hi:[1,1,1]
    v_fmac_f32 v128, v115, v212
    ds_read_b128 v[192:195], v2 offset:5216
    ds_read_b128 v[196:199], v2 offset:5232
    ds_read_b128 v[200:203], v2 offset:5248
    ds_read_b128 v[204:207], v2 offset:5264
    ds_read_b128 v[208:211], v2 offset:5280
    ds_read_b128 v[212:215], v2 offset:5296
    s_waitcnt lgkmcnt(6)
    v_pk_fma_f32 v[64:65], v[116:117], v[168:169], v[64:65] op_sel:[0,0,0] op_sel_hi:[0,1,1]
    v_pk_fma_f32 v[66:67], v[116:117], v[170:171], v[66:67] op_sel:[0,0,0] op_sel_hi:[0,1,1]
    v_pk_fma_f32 v[68:69], v[116:117], v[172:173], v[68:69] op_sel:[0,0,0] op_sel_hi:[0,1,1]
    v_pk_fma_f32 v[70:71], v[116:117], v[174:175], v[70:71] op_sel:[0,0,0] op_sel_hi:[0,1,1]
    v_pk_fma_f32 v[72:73], v[116:117], v[176:177], v[72:73] op_sel:[0,0,0] op_sel_hi:[0,1,1]
    v_pk_fma_f32 v[74:75], v[116:117], v[178:179], v[74:75] op_sel:[0,0,0] op_sel_hi:[0,1,1]
    v_pk_fma_f32 v[76:77], v[116:117], v[180:181], v[76:77] op_sel:[0,0,0] op_sel_hi:[0,1,1]
    v_pk_fma_f32 v[78:79], v[116:117], v[182:183], v[78:79] op_sel:[0,0,0] op_sel_hi:[0,1,1]
    v_pk_fma_f32 v[80:81], v[116:117], v[184:185], v[80:81] op_sel:[0,0,0] op_sel_hi:[0,1,1]
    v_pk_fma_f32 v[82:83], v[116:117], v[186:187], v[82:83] op_sel:[0,0,0] op_sel_hi:[0,1,1]
    v_fmac_f32 v128, v116, v188
    ds_read_b128 v[168:171], v2 offset:5312
    ds_read_b128 v[172:175], v2 offset:5328
    ds_read_b128 v[176:179], v2 offset:5344
    ds_read_b128 v[180:183], v2 offset:5360
    ds_read_b128 v[184:187], v2 offset:5376
    ds_read_b128 v[188:191], v2 offset:5392
    s_waitcnt lgkmcnt(6)
    v_pk_fma_f32 v[64:65], v[116:117], v[192:193], v[64:65] op_sel:[1,0,0] op_sel_hi:[1,1,1]
    v_pk_fma_f32 v[66:67], v[116:117], v[194:195], v[66:67] op_sel:[1,0,0] op_sel_hi:[1,1,1]
    v_pk_fma_f32 v[68:69], v[116:117], v[196:197], v[68:69] op_sel:[1,0,0] op_sel_hi:[1,1,1]
    v_pk_fma_f32 v[70:71], v[116:117], v[198:199], v[70:71] op_sel:[1,0,0] op_sel_hi:[1,1,1]
    v_pk_fma_f32 v[72:73], v[116:117], v[200:201], v[72:73] op_sel:[1,0,0] op_sel_hi:[1,1,1]
    v_pk_fma_f32 v[74:75], v[116:117], v[202:203], v[74:75] op_sel:[1,0,0] op_sel_hi:[1,1,1]
    v_pk_fma_f32 v[76:77], v[116:117], v[204:205], v[76:77] op_sel:[1,0,0] op_sel_hi:[1,1,1]
    v_pk_fma_f32 v[78:79], v[116:117], v[206:207], v[78:79] op_sel:[1,0,0] op_sel_hi:[1,1,1]
    v_pk_fma_f32 v[80:81], v[116:117], v[208:209], v[80:81] op_sel:[1,0,0] op_sel_hi:[1,1,1]
    v_pk_fma_f32 v[82:83], v[116:117], v[210:211], v[82:83] op_sel:[1,0,0] op_sel_hi:[1,1,1]
    v_fmac_f32 v128, v117, v212
    ds_read_b128 v[192:195], v2 offset:5408
    ds_read_b128 v[196:199], v2 offset:5424
    ds_read_b128 v[200:203], v2 offset:5440
    ds_read_b128 v[204:207], v2 offset:5456
    ds_read_b128 v[208:211], v2 offset:5472
    ds_read_b128 v[212:215], v2 offset:5488
    s_waitcnt lgkmcnt(6)
    v_pk_fma_f32 v[64:65], v[118:119], v[168:169], v[64:65] op_sel:[0,0,0] op_sel_hi:[0,1,1]
    v_pk_fma_f32 v[66:67], v[118:119], v[170:171], v[66:67] op_sel:[0,0,0] op_sel_hi:[0,1,1]
    v_pk_fma_f32 v[68:69], v[118:119], v[172:173], v[68:69] op_sel:[0,0,0] op_sel_hi:[0,1,1]
    v_pk_fma_f32 v[70:71], v[118:119], v[174:175], v[70:71] op_sel:[0,0,0] op_sel_hi:[0,1,1]
    v_pk_fma_f32 v[72:73], v[118:119], v[176:177], v[72:73] op_sel:[0,0,0] op_sel_hi:[0,1,1]
    v_pk_fma_f32 v[74:75], v[118:119], v[178:179], v[74:75] op_sel:[0,0,0] op_sel_hi:[0,1,1]
    v_pk_fma_f32 v[76:77], v[118:119], v[180:181], v[76:77] op_sel:[0,0,0] op_sel_hi:[0,1,1]
    v_pk_fma_f32 v[78:79], v[118:119], v[182:183], v[78:79] op_sel:[0,0,0] op_sel_hi:[0,1,1]
    v_pk_fma_f32 v[80:81], v[118:119], v[184:185], v[80:81] op_sel:[0,0,0] op_sel_hi:[0,1,1]
    v_pk_fma_f32 v[82:83], v[118:119], v[186:187], v[82:83] op_sel:[0,0,0] op_sel_hi:[0,1,1]
    v_fmac_f32 v128, v118, v188
    ds_read_b128 v[168:171], v2 offset:5504
    ds_read_b128 v[172:175], v2 offset:5520
    ds_read_b128 v[176:179], v2 offset:5536
    ds_read_b128 v[180:183], v2 offset:5552
    ds_read_b128 v[184:187], v2 offset:5568
    ds_read_b128 v[188:191], v2 offset:5584
    s_waitcnt lgkmcnt(6)
    v_pk_fma_f32 v[64:65], v[118:119], v[192:193], v[64:65] op_sel:[1,0,0] op_sel_hi:[1,1,1]
    v_pk_fma_f32 v[66:67], v[118:119], v[194:195], v[66:67] op_sel:[1,0,0] op_sel_hi:[1,1,1]
    v_pk_fma_f32 v[68:69], v[118:119], v[196:197], v[68:69] op_sel:[1,0,0] op_sel_hi:[1,1,1]
    v_pk_fma_f32 v[70:71], v[118:119], v[198:199], v[70:71] op_sel:[1,0,0] op_sel_hi:[1,1,1]
    v_pk_fma_f32 v[72:73], v[118:119], v[200:201], v[72:73] op_sel:[1,0,0] op_sel_hi:[1,1,1]
    v_pk_fma_f32 v[74:75], v[118:119], v[202:203], v[74:75] op_sel:[1,0,0] op_sel_hi:[1,1,1]
    v_pk_fma_f32 v[76:77], v[118:119], v[204:205], v[76:77] op_sel:[1,0,0] op_sel_hi:[1,1,1]
    v_pk_fma_f32 v[78:79], v[118:119], v[206:207], v[78:79] op_sel:[1,0,0] op_sel_hi:[1,1,1]
    v_pk_fma_f32 v[80:81], v[118:119], v[208:209], v[80:81] op_sel:[1,0,0] op_sel_hi:[1,1,1]
    v_pk_fma_f32 v[82:83], v[118:119], v[210:211], v[82:83] op_sel:[1,0,0] op_sel_hi:[1,1,1]
    v_fmac_f32 v128, v119, v212
    ds_read_b128 v[192:195], v2 offset:5600
    ds_read_b128 v[196:199], v2 offset:5616
    ds_read_b128 v[200:203], v2 offset:5632
    ds_read_b128 v[204:207], v2 offset:5648
    ds_read_b128 v[208:211], v2 offset:5664
    ds_read_b128 v[212:215], v2 offset:5680
    s_waitcnt lgkmcnt(6)
    v_pk_fma_f32 v[64:65], v[120:121], v[168:169], v[64:65] op_sel:[0,0,0] op_sel_hi:[0,1,1]
    v_pk_fma_f32 v[66:67], v[120:121], v[170:171], v[66:67] op_sel:[0,0,0] op_sel_hi:[0,1,1]
    v_pk_fma_f32 v[68:69], v[120:121], v[172:173], v[68:69] op_sel:[0,0,0] op_sel_hi:[0,1,1]
    v_pk_fma_f32 v[70:71], v[120:121], v[174:175], v[70:71] op_sel:[0,0,0] op_sel_hi:[0,1,1]
    v_pk_fma_f32 v[72:73], v[120:121], v[176:177], v[72:73] op_sel:[0,0,0] op_sel_hi:[0,1,1]
    v_pk_fma_f32 v[74:75], v[120:121], v[178:179], v[74:75] op_sel:[0,0,0] op_sel_hi:[0,1,1]
    v_pk_fma_f32 v[76:77], v[120:121], v[180:181], v[76:77] op_sel:[0,0,0] op_sel_hi:[0,1,1]
    v_pk_fma_f32 v[78:79], v[120:121], v[182:183], v[78:79] op_sel:[0,0,0] op_sel_hi:[0,1,1]
    v_pk_fma_f32 v[80:81], v[120:121], v[184:185], v[80:81] op_sel:[0,0,0] op_sel_hi:[0,1,1]
    v_pk_fma_f32 v[82:83], v[120:121], v[186:187], v[82:83] op_sel:[0,0,0] op_sel_hi:[0,1,1]
    v_fmac_f32 v128, v120, v188
    ds_read_b128 v[168:171], v2 offset:5696
    ds_read_b128 v[172:175], v2 offset:5712
    ds_read_b128 v[176:179], v2 offset:5728
    ds_read_b128 v[180:183], v2 offset:5744
    ds_read_b128 v[184:187], v2 offset:5760
    ds_read_b128 v[188:191], v2 offset:5776
    s_waitcnt lgkmcnt(6)
    v_pk_fma_f32 v[64:65], v[120:121], v[192:193], v[64:65] op_sel:[1,0,0] op_sel_hi:[1,1,1]
    v_pk_fma_f32 v[66:67], v[120:121], v[194:195], v[66:67] op_sel:[1,0,0] op_sel_hi:[1,1,1]
    v_pk_fma_f32 v[68:69], v[120:121], v[196:197], v[68:69] op_sel:[1,0,0] op_sel_hi:[1,1,1]
    v_pk_fma_f32 v[70:71], v[120:121], v[198:199], v[70:71] op_sel:[1,0,0] op_sel_hi:[1,1,1]
    v_pk_fma_f32 v[72:73], v[120:121], v[200:201], v[72:73] op_sel:[1,0,0] op_sel_hi:[1,1,1]
    v_pk_fma_f32 v[74:75], v[120:121], v[202:203], v[74:75] op_sel:[1,0,0] op_sel_hi:[1,1,1]
    v_pk_fma_f32 v[76:77], v[120:121], v[204:205], v[76:77] op_sel:[1,0,0] op_sel_hi:[1,1,1]
    v_pk_fma_f32 v[78:79], v[120:121], v[206:207], v[78:79] op_sel:[1,0,0] op_sel_hi:[1,1,1]
    v_pk_fma_f32 v[80:81], v[120:121], v[208:209], v[80:81] op_sel:[1,0,0] op_sel_hi:[1,1,1]
    v_pk_fma_f32 v[82:83], v[120:121], v[210:211], v[82:83] op_sel:[1,0,0] op_sel_hi:[1,1,1]
    v_fmac_f32 v128, v121, v212
    ds_read_b128 v[192:195], v2 offset:5792
    ds_read_b128 v[196:199], v2 offset:5808
    ds_read_b128 v[200:203], v2 offset:5824
    ds_read_b128 v[204:207], v2 offset:5840
    ds_read_b128 v[208:211], v2 offset:5856
    ds_read_b128 v[212:215], v2 offset:5872
    s_waitcnt lgkmcnt(6)
    v_pk_fma_f32 v[64:65], v[122:123], v[168:169], v[64:65] op_sel:[0,0,0] op_sel_hi:[0,1,1]
    v_pk_fma_f32 v[66:67], v[122:123], v[170:171], v[66:67] op_sel:[0,0,0] op_sel_hi:[0,1,1]
    v_pk_fma_f32 v[68:69], v[122:123], v[172:173], v[68:69] op_sel:[0,0,0] op_sel_hi:[0,1,1]
    v_pk_fma_f32 v[70:71], v[122:123], v[174:175], v[70:71] op_sel:[0,0,0] op_sel_hi:[0,1,1]
    v_pk_fma_f32 v[72:73], v[122:123], v[176:177], v[72:73] op_sel:[0,0,0] op_sel_hi:[0,1,1]
    v_pk_fma_f32 v[74:75], v[122:123], v[178:179], v[74:75] op_sel:[0,0,0] op_sel_hi:[0,1,1]
    v_pk_fma_f32 v[76:77], v[122:123], v[180:181], v[76:77] op_sel:[0,0,0] op_sel_hi:[0,1,1]
    v_pk_fma_f32 v[78:79], v[122:123], v[182:183], v[78:79] op_sel:[0,0,0] op_sel_hi:[0,1,1]
    v_pk_fma_f32 v[80:81], v[122:123], v[184:185], v[80:81] op_sel:[0,0,0] op_sel_hi:[0,1,1]
    v_pk_fma_f32 v[82:83], v[122:123], v[186:187], v[82:83] op_sel:[0,0,0] op_sel_hi:[0,1,1]
    v_fmac_f32 v128, v122, v188
    s_waitcnt lgkmcnt(0)
    v_pk_fma_f32 v[64:65], v[122:123], v[192:193], v[64:65] op_sel:[1,0,0] op_sel_hi:[1,1,1]
    v_pk_fma_f32 v[66:67], v[122:123], v[194:195], v[66:67] op_sel:[1,0,0] op_sel_hi:[1,1,1]
    v_pk_fma_f32 v[68:69], v[122:123], v[196:197], v[68:69] op_sel:[1,0,0] op_sel_hi:[1,1,1]
    v_pk_fma_f32 v[70:71], v[122:123], v[198:199], v[70:71] op_sel:[1,0,0] op_sel_hi:[1,1,1]
    v_pk_fma_f32 v[72:73], v[122:123], v[200:201], v[72:73] op_sel:[1,0,0] op_sel_hi:[1,1,1]
    v_pk_fma_f32 v[74:75], v[122:123], v[202:203], v[74:75] op_sel:[1,0,0] op_sel_hi:[1,1,1]
    v_pk_fma_f32 v[76:77], v[122:123], v[204:205], v[76:77] op_sel:[1,0,0] op_sel_hi:[1,1,1]
    v_pk_fma_f32 v[78:79], v[122:123], v[206:207], v[78:79] op_sel:[1,0,0] op_sel_hi:[1,1,1]
    v_pk_fma_f32 v[80:81], v[122:123], v[208:209], v[80:81] op_sel:[1,0,0] op_sel_hi:[1,1,1]
    v_pk_fma_f32 v[82:83], v[122:123], v[210:211], v[82:83] op_sel:[1,0,0] op_sel_hi:[1,1,1]
    v_fmac_f32 v128, v123, v212
    v_rcp_f32 v128, v128
    s_nop 0
    v_mul_f32 v64, v64, v128
    v_mul_f32 v65, v65, v128
    v_mul_f32 v66, v66, v128
    v_mul_f32 v67, v67, v128
    v_mul_f32 v68, v68, v128
    v_mul_f32 v69, v69, v128
    v_mul_f32 v70, v70, v128
    v_mul_f32 v71, v71, v128
    v_mul_f32 v72, v72, v128
    v_mul_f32 v73, v73, v128
    v_mul_f32 v74, v74, v128
    v_mul_f32 v75, v75, v128
    v_mul_f32 v76, v76, v128
    v_mul_f32 v77, v77, v128
    v_mul_f32 v78, v78, v128
    v_mul_f32 v79, v79, v128
    v_mul_f32 v80, v80, v128
    v_mul_f32 v81, v81, v128
    v_mul_f32 v82, v82, v128
    v_mul_f32 v83, v83, v128
    v_cvt_pk_bf16_f32 v44, v64, v65
    v_cvt_pk_bf16_f32 v45, v66, v67
    v_cvt_pk_bf16_f32 v46, v68, v69
    v_cvt_pk_bf16_f32 v47, v70, v71
    v_cvt_pk_bf16_f32 v48, v72, v73
    v_cvt_pk_bf16_f32 v49, v74, v75
    v_cvt_pk_bf16_f32 v50, v76, v77
    v_cvt_pk_bf16_f32 v51, v78, v79
    v_cvt_pk_bf16_f32 v52, v80, v81
    v_cvt_pk_bf16_f32 v53, v82, v83
    s_lshl_b32 s6, s5, 8
    v_add_u32 v1, s6, v0
    v_mul_u32_u24 v1, 1280, v1
    s_mul_i32 s7, s4, 40
    v_add_u32 v1, s7, v1
    buffer_store_dwordx2 v[44:45], v1, s[52:55], 0 offen offset:0
    buffer_store_dwordx2 v[46:47], v1, s[52:55], 0 offen offset:8
    buffer_store_dwordx2 v[48:49], v1, s[52:55], 0 offen offset:16
    buffer_store_dwordx2 v[50:51], v1, s[52:55], 0 offen offset:24
    buffer_store_dwordx2 v[52:53], v1, s[52:55], 0 offen offset:32
att_1_kernel_end:
    s_endpgm
.globl wo_1_kernel
.p2align 8
.type wo_1_kernel,@function
wo_1_kernel:
    s_cmp_ge_u32 s2, 160
    s_cbranch_scc1 wo_1_kernel_end
    s_load_dwordx16 s[16:31], s[0:1], 0
    s_load_dwordx4 s[32:35], s[0:1], 64
    s_load_dwordx2 s[36:37], s[0:1], 80
    s_waitcnt lgkmcnt(0)
    s_add_u32 s40, s36, 0x1000000
    s_addc_u32 s41, s37, 0
    s_mov_b32 s42, 0x280000
    s_mov_b32 s43, 0x00020000
    s_mov_b32 s44, s22
    s_mov_b32 s45, s23
    s_mov_b32 s46, 0xc8000
    s_mov_b32 s47, 0x00020000
    s_add_u32 s52, s36, 0x1400000
    s_addc_u32 s53, s37, 0
    s_mov_b32 s54, 0x280000
    s_mov_b32 s55, 0x00020000
    s_add_u32 s56, s36, 0x2000000
    s_addc_u32 s57, s37, 0
    s_mov_b32 s58, 0x280000
    s_mov_b32 s59, 0x00020000
    s_and_b32 s4, s2, 31
    s_lshr_b32 s5, s2, 5
    v_lshrrev_b32 v1, 6, v0
    s_nop 0
    v_readfirstlane_b32 s6, v1
    v_and_b32 v2, 63, v0
    v_and_b32 v3, 15, v0
    v_bfe_u32 v4, v0, 4, 2
    v_lshrrev_b32 v5, 3, v0
    v_and_b32 v6, 7, v0
    s_mul_i32 s7, s4, 81920
    v_mul_u32_u24 v7, 1280, v5
    v_lshl_add_u32 v7, v6, 4, v7
    v_add_u32 v7, s7, v7
    v_mul_u32_u24 v8, 144, v5
    v_lshl_add_u32 v8, v6, 4, v8
    v_and_b32 v9, 127, v0
    v_lshrrev_b32 v9, 3, v9
    s_lshr_b32 s8, s6, 1
    v_mul_u32_u24 v10, 1280, v9
    v_lshl_add_u32 v10, v6, 4, v10
    s_lshl_b32 s9, s5, 8
    s_lshl_b32 s10, s8, 7
    s_add_u32 s9, s9, s10
    s_mov_b32 s60, s44
    s_mov_b32 s61, s45
    s_mov_b32 s62, s46
    s_mov_b32 s63, s47
    v_add_u32 v10, s9, v10
    v_mul_u32_u24 v11, 288, v9
    v_lshl_add_u32 v11, v6, 4, v11
    s_lshl_b32 s10, s8, 7
    v_add_u32 v11, s10, v11
    v_add_u32 v11, 9216, v11
    s_mov_b32 s64, 0
    s_mov_b32 s65, 40960
    s_mov_b32 s68, 0
    s_mov_b32 s69, 20480
    s_mov_b32 s70, 40960
    s_mov_b32 s71, 61440
    s_lshr_b32 s10, s6, 1
    s_and_b32 s11, s6, 1
    s_mul_i32 s12, s10, 4608
    v_mul_u32_u24 v12, 144, v3
    v_lshl_add_u32 v12, v4, 3, v12
    v_add_u32 v12, s12, v12
    v_lshrrev_b32 v13, 2, v3
    v_lshl_add_u32 v13, v4, 2, v13
    v_mul_u32_u24 v13, 288, v13
    v_and_b32 v14, 3, v3
    v_lshl_add_u32 v13, v14, 3, v13
    s_lshl_b32 s13, s11, 7
    s_add_u32 s13, s13, 9216
    v_add_u32 v13, s13, v13
    v_mov_b32 v16, 0
    v_mov_b32 v17, 0
    v_mov_b32 v18, 0
    v_mov_b32 v19, 0
    v_mov_b32 v20, 0
    v_mov_b32 v21, 0
    v_mov_b32 v22, 0
    v_mov_b32 v23, 0
    v_mov_b32 v24, 0
    v_mov_b32 v25, 0
    v_mov_b32 v26, 0
    v_mov_b32 v27, 0
    v_mov_b32 v28, 0
    v_mov_b32 v29, 0
    v_mov_b32 v30, 0
    v_mov_b32 v31, 0
    v_mov_b32 v32, 0
    v_mov_b32 v33, 0
    v_mov_b32 v34, 0
    v_mov_b32 v35, 0
    v_mov_b32 v36, 0
    v_mov_b32 v37, 0
    v_mov_b32 v38, 0
    v_mov_b32 v39, 0
    v_mov_b32 v40, 0
    v_mov_b32 v41, 0
    v_mov_b32 v42, 0
    v_mov_b32 v43, 0
    v_mov_b32 v44, 0
    v_mov_b32 v45, 0
    v_mov_b32 v46, 0
    v_mov_b32 v47, 0
    buffer_load_dwordx4 v[96:99], v7, s[40:43], s64 offen
    buffer_load_dwordx4 v[100:103], v7, s[40:43], s65 offen
    buffer_load_dwordx4 v[104:107], v10, s[60:63], s68 offen
    buffer_load_dwordx4 v[108:111], v10, s[60:63], s69 offen
    buffer_load_dwordx4 v[112:115], v10, s[60:63], s70 offen
    buffer_load_dwordx4 v[116:119], v10, s[60:63], s71 offen
    v_add_u32 v7, 128, v7
    v_add_u32 v10, 81920, v10
    buffer_load_dwordx4 v[120:123], v7, s[40:43], s64 offen
    buffer_load_dwordx4 v[124:127], v7, s[40:43], s65 offen
    buffer_load_dwordx4 v[128:131], v10, s[60:63], s68 offen
    buffer_load_dwordx4 v[132:135], v10, s[60:63], s69 offen
    buffer_load_dwordx4 v[136:139], v10, s[60:63], s70 offen
    buffer_load_dwordx4 v[140:143], v10, s[60:63], s71 offen
    v_add_u32 v7, 128, v7
    v_add_u32 v10, 81920, v10
    s_waitcnt vmcnt(6)
    ds_write_b128 v8, v[96:99] offset:0
    ds_write_b128 v8, v[100:103] offset:4608
    ds_write_b128 v11, v[104:107] offset:0
    ds_write_b128 v11, v[108:111] offset:4608
    ds_write_b128 v11, v[112:115] offset:9216
    ds_write_b128 v11, v[116:119] offset:13824
    s_waitcnt lgkmcnt(0)
    s_barrier
    buffer_load_dwordx4 v[96:99], v7, s[40:43], s64 offen
    buffer_load_dwordx4 v[100:103], v7, s[40:43], s65 offen
    buffer_load_dwordx4 v[104:107], v10, s[60:63], s68 offen
    buffer_load_dwordx4 v[108:111], v10, s[60:63], s69 offen
    buffer_load_dwordx4 v[112:115], v10, s[60:63], s70 offen
    buffer_load_dwordx4 v[116:119], v10, s[60:63], s71 offen
    v_add_u32 v7, 128, v7
    v_add_u32 v10, 81920, v10
    ds_read_b64_tr_b16 v[56:57], v13 offset:0
    ds_read_b64_tr_b16 v[58:59], v13 offset:4608
    ds_read_b64_tr_b16 v[60:61], v13 offset:32
    ds_read_b64_tr_b16 v[62:63], v13 offset:4640
    ds_read_b64_tr_b16 v[64:65], v13 offset:64
    ds_read_b64_tr_b16 v[66:67], v13 offset:4672
    ds_read_b64_tr_b16 v[68:69], v13 offset:96
    ds_read_b64_tr_b16 v[70:71], v13 offset:4704
    ds_read_b64 v[48:49], v12 offset:0
    ds_read_b64 v[50:51], v12 offset:32
    ds_read_b64 v[52:53], v12 offset:2304
    ds_read_b64 v[54:55], v12 offset:2336
    s_waitcnt lgkmcnt(0)
    ds_read_b64_tr_b16 v[80:81], v13 offset:9216
    ds_read_b64_tr_b16 v[82:83], v13 offset:13824
    ds_read_b64_tr_b16 v[84:85], v13 offset:9248
    ds_read_b64_tr_b16 v[86:87], v13 offset:13856
    ds_read_b64_tr_b16 v[88:89], v13 offset:9280
    ds_read_b64_tr_b16 v[90:91], v13 offset:13888
    ds_read_b64_tr_b16 v[92:93], v13 offset:9312
    ds_read_b64_tr_b16 v[94:95], v13 offset:13920
    ds_read_b64 v[72:73], v12 offset:64
    ds_read_b64 v[74:75], v12 offset:96
    ds_read_b64 v[76:77], v12 offset:2368
    ds_read_b64 v[78:79], v12 offset:2400
    v_mfma_f32_16x16x32_bf16 v[16:19], v[56:59], v[48:51], v[16:19]
    v_mfma_f32_16x16x32_bf16 v[20:23], v[60:63], v[48:51], v[20:23]
    v_mfma_f32_16x16x32_bf16 v[24:27], v[64:67], v[48:51], v[24:27]
    v_mfma_f32_16x16x32_bf16 v[28:31], v[68:71], v[48:51], v[28:31]
    v_mfma_f32_16x16x32_bf16 v[32:35], v[56:59], v[52:55], v[32:35]
    v_mfma_f32_16x16x32_bf16 v[36:39], v[60:63], v[52:55], v[36:39]
    v_mfma_f32_16x16x32_bf16 v[40:43], v[64:67], v[52:55], v[40:43]
    v_mfma_f32_16x16x32_bf16 v[44:47], v[68:71], v[52:55], v[44:47]
    s_waitcnt lgkmcnt(0)
    v_mfma_f32_16x16x32_bf16 v[16:19], v[80:83], v[72:75], v[16:19]
    v_mfma_f32_16x16x32_bf16 v[20:23], v[84:87], v[72:75], v[20:23]
    v_mfma_f32_16x16x32_bf16 v[24:27], v[88:91], v[72:75], v[24:27]
    v_mfma_f32_16x16x32_bf16 v[28:31], v[92:95], v[72:75], v[28:31]
    v_mfma_f32_16x16x32_bf16 v[32:35], v[80:83], v[76:79], v[32:35]
    v_mfma_f32_16x16x32_bf16 v[36:39], v[84:87], v[76:79], v[36:39]
    v_mfma_f32_16x16x32_bf16 v[40:43], v[88:91], v[76:79], v[40:43]
    v_mfma_f32_16x16x32_bf16 v[44:47], v[92:95], v[76:79], v[44:47]
    s_waitcnt vmcnt(6)
    ds_write_b128 v8, v[120:123] offset:27648
    ds_write_b128 v8, v[124:127] offset:32256
    ds_write_b128 v11, v[128:131] offset:27648
    ds_write_b128 v11, v[132:135] offset:32256
    ds_write_b128 v11, v[136:139] offset:36864
    ds_write_b128 v11, v[140:143] offset:41472
    s_waitcnt lgkmcnt(0)
    s_barrier
    buffer_load_dwordx4 v[120:123], v7, s[40:43], s64 offen
    buffer_load_dwordx4 v[124:127], v7, s[40:43], s65 offen
    buffer_load_dwordx4 v[128:131], v10, s[60:63], s68 offen
    buffer_load_dwordx4 v[132:135], v10, s[60:63], s69 offen
    buffer_load_dwordx4 v[136:139], v10, s[60:63], s70 offen
    buffer_load_dwordx4 v[140:143], v10, s[60:63], s71 offen
    v_add_u32 v7, 128, v7
    v_add_u32 v10, 81920, v10
    ds_read_b64_tr_b16 v[56:57], v13 offset:27648
    ds_read_b64_tr_b16 v[58:59], v13 offset:32256
    ds_read_b64_tr_b16 v[60:61], v13 offset:27680
    ds_read_b64_tr_b16 v[62:63], v13 offset:32288
    ds_read_b64_tr_b16 v[64:65], v13 offset:27712
    ds_read_b64_tr_b16 v[66:67], v13 offset:32320
    ds_read_b64_tr_b16 v[68:69], v13 offset:27744
    ds_read_b64_tr_b16 v[70:71], v13 offset:32352
    ds_read_b64 v[48:49], v12 offset:27648
    ds_read_b64 v[50:51], v12 offset:27680
    ds_read_b64 v[52:53], v12 offset:29952
    ds_read_b64 v[54:55], v12 offset:29984
    s_waitcnt lgkmcnt(0)
    ds_read_b64_tr_b16 v[80:81], v13 offset:36864
    ds_read_b64_tr_b16 v[82:83], v13 offset:41472
    ds_read_b64_tr_b16 v[84:85], v13 offset:36896
    ds_read_b64_tr_b16 v[86:87], v13 offset:41504
    ds_read_b64_tr_b16 v[88:89], v13 offset:36928
    ds_read_b64_tr_b16 v[90:91], v13 offset:41536
    ds_read_b64_tr_b16 v[92:93], v13 offset:36960
    ds_read_b64_tr_b16 v[94:95], v13 offset:41568
    ds_read_b64 v[72:73], v12 offset:27712
    ds_read_b64 v[74:75], v12 offset:27744
    ds_read_b64 v[76:77], v12 offset:30016
    ds_read_b64 v[78:79], v12 offset:30048
    v_mfma_f32_16x16x32_bf16 v[16:19], v[56:59], v[48:51], v[16:19]
    v_mfma_f32_16x16x32_bf16 v[20:23], v[60:63], v[48:51], v[20:23]
    v_mfma_f32_16x16x32_bf16 v[24:27], v[64:67], v[48:51], v[24:27]
    v_mfma_f32_16x16x32_bf16 v[28:31], v[68:71], v[48:51], v[28:31]
    v_mfma_f32_16x16x32_bf16 v[32:35], v[56:59], v[52:55], v[32:35]
    v_mfma_f32_16x16x32_bf16 v[36:39], v[60:63], v[52:55], v[36:39]
    v_mfma_f32_16x16x32_bf16 v[40:43], v[64:67], v[52:55], v[40:43]
    v_mfma_f32_16x16x32_bf16 v[44:47], v[68:71], v[52:55], v[44:47]
    s_waitcnt lgkmcnt(0)
    v_mfma_f32_16x16x32_bf16 v[16:19], v[80:83], v[72:75], v[16:19]
    v_mfma_f32_16x16x32_bf16 v[20:23], v[84:87], v[72:75], v[20:23]
    v_mfma_f32_16x16x32_bf16 v[24:27], v[88:91], v[72:75], v[24:27]
    v_mfma_f32_16x16x32_bf16 v[28:31], v[92:95], v[72:75], v[28:31]
    v_mfma_f32_16x16x32_bf16 v[32:35], v[80:83], v[76:79], v[32:35]
    v_mfma_f32_16x16x32_bf16 v[36:39], v[84:87], v[76:79], v[36:39]
    v_mfma_f32_16x16x32_bf16 v[40:43], v[88:91], v[76:79], v[40:43]
    v_mfma_f32_16x16x32_bf16 v[44:47], v[92:95], v[76:79], v[44:47]
    s_waitcnt vmcnt(6)
    ds_write_b128 v8, v[96:99] offset:0
    ds_write_b128 v8, v[100:103] offset:4608
    ds_write_b128 v11, v[104:107] offset:0
    ds_write_b128 v11, v[108:111] offset:4608
    ds_write_b128 v11, v[112:115] offset:9216
    ds_write_b128 v11, v[116:119] offset:13824
    s_waitcnt lgkmcnt(0)
    s_barrier
    buffer_load_dwordx4 v[96:99], v7, s[40:43], s64 offen
    buffer_load_dwordx4 v[100:103], v7, s[40:43], s65 offen
    buffer_load_dwordx4 v[104:107], v10, s[60:63], s68 offen
    buffer_load_dwordx4 v[108:111], v10, s[60:63], s69 offen
    buffer_load_dwordx4 v[112:115], v10, s[60:63], s70 offen
    buffer_load_dwordx4 v[116:119], v10, s[60:63], s71 offen
    v_add_u32 v7, 128, v7
    v_add_u32 v10, 81920, v10
    ds_read_b64_tr_b16 v[56:57], v13 offset:0
    ds_read_b64_tr_b16 v[58:59], v13 offset:4608
    ds_read_b64_tr_b16 v[60:61], v13 offset:32
    ds_read_b64_tr_b16 v[62:63], v13 offset:4640
    ds_read_b64_tr_b16 v[64:65], v13 offset:64
    ds_read_b64_tr_b16 v[66:67], v13 offset:4672
    ds_read_b64_tr_b16 v[68:69], v13 offset:96
    ds_read_b64_tr_b16 v[70:71], v13 offset:4704
    ds_read_b64 v[48:49], v12 offset:0
    ds_read_b64 v[50:51], v12 offset:32
    ds_read_b64 v[52:53], v12 offset:2304
    ds_read_b64 v[54:55], v12 offset:2336
    s_waitcnt lgkmcnt(0)
    ds_read_b64_tr_b16 v[80:81], v13 offset:9216
    ds_read_b64_tr_b16 v[82:83], v13 offset:13824
    ds_read_b64_tr_b16 v[84:85], v13 offset:9248
    ds_read_b64_tr_b16 v[86:87], v13 offset:13856
    ds_read_b64_tr_b16 v[88:89], v13 offset:9280
    ds_read_b64_tr_b16 v[90:91], v13 offset:13888
    ds_read_b64_tr_b16 v[92:93], v13 offset:9312
    ds_read_b64_tr_b16 v[94:95], v13 offset:13920
    ds_read_b64 v[72:73], v12 offset:64
    ds_read_b64 v[74:75], v12 offset:96
    ds_read_b64 v[76:77], v12 offset:2368
    ds_read_b64 v[78:79], v12 offset:2400
    v_mfma_f32_16x16x32_bf16 v[16:19], v[56:59], v[48:51], v[16:19]
    v_mfma_f32_16x16x32_bf16 v[20:23], v[60:63], v[48:51], v[20:23]
    v_mfma_f32_16x16x32_bf16 v[24:27], v[64:67], v[48:51], v[24:27]
    v_mfma_f32_16x16x32_bf16 v[28:31], v[68:71], v[48:51], v[28:31]
    v_mfma_f32_16x16x32_bf16 v[32:35], v[56:59], v[52:55], v[32:35]
    v_mfma_f32_16x16x32_bf16 v[36:39], v[60:63], v[52:55], v[36:39]
    v_mfma_f32_16x16x32_bf16 v[40:43], v[64:67], v[52:55], v[40:43]
    v_mfma_f32_16x16x32_bf16 v[44:47], v[68:71], v[52:55], v[44:47]
    s_waitcnt lgkmcnt(0)
    v_mfma_f32_16x16x32_bf16 v[16:19], v[80:83], v[72:75], v[16:19]
    v_mfma_f32_16x16x32_bf16 v[20:23], v[84:87], v[72:75], v[20:23]
    v_mfma_f32_16x16x32_bf16 v[24:27], v[88:91], v[72:75], v[24:27]
    v_mfma_f32_16x16x32_bf16 v[28:31], v[92:95], v[72:75], v[28:31]
    v_mfma_f32_16x16x32_bf16 v[32:35], v[80:83], v[76:79], v[32:35]
    v_mfma_f32_16x16x32_bf16 v[36:39], v[84:87], v[76:79], v[36:39]
    v_mfma_f32_16x16x32_bf16 v[40:43], v[88:91], v[76:79], v[40:43]
    v_mfma_f32_16x16x32_bf16 v[44:47], v[92:95], v[76:79], v[44:47]
    s_waitcnt vmcnt(6)
    ds_write_b128 v8, v[120:123] offset:27648
    ds_write_b128 v8, v[124:127] offset:32256
    ds_write_b128 v11, v[128:131] offset:27648
    ds_write_b128 v11, v[132:135] offset:32256
    ds_write_b128 v11, v[136:139] offset:36864
    ds_write_b128 v11, v[140:143] offset:41472
    s_waitcnt lgkmcnt(0)
    s_barrier
    buffer_load_dwordx4 v[120:123], v7, s[40:43], s64 offen
    buffer_load_dwordx4 v[124:127], v7, s[40:43], s65 offen
    buffer_load_dwordx4 v[128:131], v10, s[60:63], s68 offen
    buffer_load_dwordx4 v[132:135], v10, s[60:63], s69 offen
    buffer_load_dwordx4 v[136:139], v10, s[60:63], s70 offen
    buffer_load_dwordx4 v[140:143], v10, s[60:63], s71 offen
    v_add_u32 v7, 128, v7
    v_add_u32 v10, 81920, v10
    ds_read_b64_tr_b16 v[56:57], v13 offset:27648
    ds_read_b64_tr_b16 v[58:59], v13 offset:32256
    ds_read_b64_tr_b16 v[60:61], v13 offset:27680
    ds_read_b64_tr_b16 v[62:63], v13 offset:32288
    ds_read_b64_tr_b16 v[64:65], v13 offset:27712
    ds_read_b64_tr_b16 v[66:67], v13 offset:32320
    ds_read_b64_tr_b16 v[68:69], v13 offset:27744
    ds_read_b64_tr_b16 v[70:71], v13 offset:32352
    ds_read_b64 v[48:49], v12 offset:27648
    ds_read_b64 v[50:51], v12 offset:27680
    ds_read_b64 v[52:53], v12 offset:29952
    ds_read_b64 v[54:55], v12 offset:29984
    s_waitcnt lgkmcnt(0)
    ds_read_b64_tr_b16 v[80:81], v13 offset:36864
    ds_read_b64_tr_b16 v[82:83], v13 offset:41472
    ds_read_b64_tr_b16 v[84:85], v13 offset:36896
    ds_read_b64_tr_b16 v[86:87], v13 offset:41504
    ds_read_b64_tr_b16 v[88:89], v13 offset:36928
    ds_read_b64_tr_b16 v[90:91], v13 offset:41536
    ds_read_b64_tr_b16 v[92:93], v13 offset:36960
    ds_read_b64_tr_b16 v[94:95], v13 offset:41568
    ds_read_b64 v[72:73], v12 offset:27712
    ds_read_b64 v[74:75], v12 offset:27744
    ds_read_b64 v[76:77], v12 offset:30016
    ds_read_b64 v[78:79], v12 offset:30048
    v_mfma_f32_16x16x32_bf16 v[16:19], v[56:59], v[48:51], v[16:19]
    v_mfma_f32_16x16x32_bf16 v[20:23], v[60:63], v[48:51], v[20:23]
    v_mfma_f32_16x16x32_bf16 v[24:27], v[64:67], v[48:51], v[24:27]
    v_mfma_f32_16x16x32_bf16 v[28:31], v[68:71], v[48:51], v[28:31]
    v_mfma_f32_16x16x32_bf16 v[32:35], v[56:59], v[52:55], v[32:35]
    v_mfma_f32_16x16x32_bf16 v[36:39], v[60:63], v[52:55], v[36:39]
    v_mfma_f32_16x16x32_bf16 v[40:43], v[64:67], v[52:55], v[40:43]
    v_mfma_f32_16x16x32_bf16 v[44:47], v[68:71], v[52:55], v[44:47]
    s_waitcnt lgkmcnt(0)
    v_mfma_f32_16x16x32_bf16 v[16:19], v[80:83], v[72:75], v[16:19]
    v_mfma_f32_16x16x32_bf16 v[20:23], v[84:87], v[72:75], v[20:23]
    v_mfma_f32_16x16x32_bf16 v[24:27], v[88:91], v[72:75], v[24:27]
    v_mfma_f32_16x16x32_bf16 v[28:31], v[92:95], v[72:75], v[28:31]
    v_mfma_f32_16x16x32_bf16 v[32:35], v[80:83], v[76:79], v[32:35]
    v_mfma_f32_16x16x32_bf16 v[36:39], v[84:87], v[76:79], v[36:39]
    v_mfma_f32_16x16x32_bf16 v[40:43], v[88:91], v[76:79], v[40:43]
    v_mfma_f32_16x16x32_bf16 v[44:47], v[92:95], v[76:79], v[44:47]
    s_waitcnt vmcnt(6)
    ds_write_b128 v8, v[96:99] offset:0
    ds_write_b128 v8, v[100:103] offset:4608
    ds_write_b128 v11, v[104:107] offset:0
    ds_write_b128 v11, v[108:111] offset:4608
    ds_write_b128 v11, v[112:115] offset:9216
    ds_write_b128 v11, v[116:119] offset:13824
    s_waitcnt lgkmcnt(0)
    s_barrier
    buffer_load_dwordx4 v[96:99], v7, s[40:43], s64 offen
    buffer_load_dwordx4 v[100:103], v7, s[40:43], s65 offen
    buffer_load_dwordx4 v[104:107], v10, s[60:63], s68 offen
    buffer_load_dwordx4 v[108:111], v10, s[60:63], s69 offen
    buffer_load_dwordx4 v[112:115], v10, s[60:63], s70 offen
    buffer_load_dwordx4 v[116:119], v10, s[60:63], s71 offen
    v_add_u32 v7, 128, v7
    v_add_u32 v10, 81920, v10
    ds_read_b64_tr_b16 v[56:57], v13 offset:0
    ds_read_b64_tr_b16 v[58:59], v13 offset:4608
    ds_read_b64_tr_b16 v[60:61], v13 offset:32
    ds_read_b64_tr_b16 v[62:63], v13 offset:4640
    ds_read_b64_tr_b16 v[64:65], v13 offset:64
    ds_read_b64_tr_b16 v[66:67], v13 offset:4672
    ds_read_b64_tr_b16 v[68:69], v13 offset:96
    ds_read_b64_tr_b16 v[70:71], v13 offset:4704
    ds_read_b64 v[48:49], v12 offset:0
    ds_read_b64 v[50:51], v12 offset:32
    ds_read_b64 v[52:53], v12 offset:2304
    ds_read_b64 v[54:55], v12 offset:2336
    s_waitcnt lgkmcnt(0)
    ds_read_b64_tr_b16 v[80:81], v13 offset:9216
    ds_read_b64_tr_b16 v[82:83], v13 offset:13824
    ds_read_b64_tr_b16 v[84:85], v13 offset:9248
    ds_read_b64_tr_b16 v[86:87], v13 offset:13856
    ds_read_b64_tr_b16 v[88:89], v13 offset:9280
    ds_read_b64_tr_b16 v[90:91], v13 offset:13888
    ds_read_b64_tr_b16 v[92:93], v13 offset:9312
    ds_read_b64_tr_b16 v[94:95], v13 offset:13920
    ds_read_b64 v[72:73], v12 offset:64
    ds_read_b64 v[74:75], v12 offset:96
    ds_read_b64 v[76:77], v12 offset:2368
    ds_read_b64 v[78:79], v12 offset:2400
    v_mfma_f32_16x16x32_bf16 v[16:19], v[56:59], v[48:51], v[16:19]
    v_mfma_f32_16x16x32_bf16 v[20:23], v[60:63], v[48:51], v[20:23]
    v_mfma_f32_16x16x32_bf16 v[24:27], v[64:67], v[48:51], v[24:27]
    v_mfma_f32_16x16x32_bf16 v[28:31], v[68:71], v[48:51], v[28:31]
    v_mfma_f32_16x16x32_bf16 v[32:35], v[56:59], v[52:55], v[32:35]
    v_mfma_f32_16x16x32_bf16 v[36:39], v[60:63], v[52:55], v[36:39]
    v_mfma_f32_16x16x32_bf16 v[40:43], v[64:67], v[52:55], v[40:43]
    v_mfma_f32_16x16x32_bf16 v[44:47], v[68:71], v[52:55], v[44:47]
    s_waitcnt lgkmcnt(0)
    v_mfma_f32_16x16x32_bf16 v[16:19], v[80:83], v[72:75], v[16:19]
    v_mfma_f32_16x16x32_bf16 v[20:23], v[84:87], v[72:75], v[20:23]
    v_mfma_f32_16x16x32_bf16 v[24:27], v[88:91], v[72:75], v[24:27]
    v_mfma_f32_16x16x32_bf16 v[28:31], v[92:95], v[72:75], v[28:31]
    v_mfma_f32_16x16x32_bf16 v[32:35], v[80:83], v[76:79], v[32:35]
    v_mfma_f32_16x16x32_bf16 v[36:39], v[84:87], v[76:79], v[36:39]
    v_mfma_f32_16x16x32_bf16 v[40:43], v[88:91], v[76:79], v[40:43]
    v_mfma_f32_16x16x32_bf16 v[44:47], v[92:95], v[76:79], v[44:47]
    s_waitcnt vmcnt(6)
    ds_write_b128 v8, v[120:123] offset:27648
    ds_write_b128 v8, v[124:127] offset:32256
    ds_write_b128 v11, v[128:131] offset:27648
    ds_write_b128 v11, v[132:135] offset:32256
    ds_write_b128 v11, v[136:139] offset:36864
    ds_write_b128 v11, v[140:143] offset:41472
    s_waitcnt lgkmcnt(0)
    s_barrier
    buffer_load_dwordx4 v[120:123], v7, s[40:43], s64 offen
    buffer_load_dwordx4 v[124:127], v7, s[40:43], s65 offen
    buffer_load_dwordx4 v[128:131], v10, s[60:63], s68 offen
    buffer_load_dwordx4 v[132:135], v10, s[60:63], s69 offen
    buffer_load_dwordx4 v[136:139], v10, s[60:63], s70 offen
    buffer_load_dwordx4 v[140:143], v10, s[60:63], s71 offen
    v_add_u32 v7, 128, v7
    v_add_u32 v10, 81920, v10
    ds_read_b64_tr_b16 v[56:57], v13 offset:27648
    ds_read_b64_tr_b16 v[58:59], v13 offset:32256
    ds_read_b64_tr_b16 v[60:61], v13 offset:27680
    ds_read_b64_tr_b16 v[62:63], v13 offset:32288
    ds_read_b64_tr_b16 v[64:65], v13 offset:27712
    ds_read_b64_tr_b16 v[66:67], v13 offset:32320
    ds_read_b64_tr_b16 v[68:69], v13 offset:27744
    ds_read_b64_tr_b16 v[70:71], v13 offset:32352
    ds_read_b64 v[48:49], v12 offset:27648
    ds_read_b64 v[50:51], v12 offset:27680
    ds_read_b64 v[52:53], v12 offset:29952
    ds_read_b64 v[54:55], v12 offset:29984
    s_waitcnt lgkmcnt(0)
    ds_read_b64_tr_b16 v[80:81], v13 offset:36864
    ds_read_b64_tr_b16 v[82:83], v13 offset:41472
    ds_read_b64_tr_b16 v[84:85], v13 offset:36896
    ds_read_b64_tr_b16 v[86:87], v13 offset:41504
    ds_read_b64_tr_b16 v[88:89], v13 offset:36928
    ds_read_b64_tr_b16 v[90:91], v13 offset:41536
    ds_read_b64_tr_b16 v[92:93], v13 offset:36960
    ds_read_b64_tr_b16 v[94:95], v13 offset:41568
    ds_read_b64 v[72:73], v12 offset:27712
    ds_read_b64 v[74:75], v12 offset:27744
    ds_read_b64 v[76:77], v12 offset:30016
    ds_read_b64 v[78:79], v12 offset:30048
    v_mfma_f32_16x16x32_bf16 v[16:19], v[56:59], v[48:51], v[16:19]
    v_mfma_f32_16x16x32_bf16 v[20:23], v[60:63], v[48:51], v[20:23]
    v_mfma_f32_16x16x32_bf16 v[24:27], v[64:67], v[48:51], v[24:27]
    v_mfma_f32_16x16x32_bf16 v[28:31], v[68:71], v[48:51], v[28:31]
    v_mfma_f32_16x16x32_bf16 v[32:35], v[56:59], v[52:55], v[32:35]
    v_mfma_f32_16x16x32_bf16 v[36:39], v[60:63], v[52:55], v[36:39]
    v_mfma_f32_16x16x32_bf16 v[40:43], v[64:67], v[52:55], v[40:43]
    v_mfma_f32_16x16x32_bf16 v[44:47], v[68:71], v[52:55], v[44:47]
    s_waitcnt lgkmcnt(0)
    v_mfma_f32_16x16x32_bf16 v[16:19], v[80:83], v[72:75], v[16:19]
    v_mfma_f32_16x16x32_bf16 v[20:23], v[84:87], v[72:75], v[20:23]
    v_mfma_f32_16x16x32_bf16 v[24:27], v[88:91], v[72:75], v[24:27]
    v_mfma_f32_16x16x32_bf16 v[28:31], v[92:95], v[72:75], v[28:31]
    v_mfma_f32_16x16x32_bf16 v[32:35], v[80:83], v[76:79], v[32:35]
    v_mfma_f32_16x16x32_bf16 v[36:39], v[84:87], v[76:79], v[36:39]
    v_mfma_f32_16x16x32_bf16 v[40:43], v[88:91], v[76:79], v[40:43]
    v_mfma_f32_16x16x32_bf16 v[44:47], v[92:95], v[76:79], v[44:47]
    s_waitcnt vmcnt(6)
    ds_write_b128 v8, v[96:99] offset:0
    ds_write_b128 v8, v[100:103] offset:4608
    ds_write_b128 v11, v[104:107] offset:0
    ds_write_b128 v11, v[108:111] offset:4608
    ds_write_b128 v11, v[112:115] offset:9216
    ds_write_b128 v11, v[116:119] offset:13824
    s_waitcnt lgkmcnt(0)
    s_barrier
    buffer_load_dwordx4 v[96:99], v7, s[40:43], s64 offen
    buffer_load_dwordx4 v[100:103], v7, s[40:43], s65 offen
    buffer_load_dwordx4 v[104:107], v10, s[60:63], s68 offen
    buffer_load_dwordx4 v[108:111], v10, s[60:63], s69 offen
    buffer_load_dwordx4 v[112:115], v10, s[60:63], s70 offen
    buffer_load_dwordx4 v[116:119], v10, s[60:63], s71 offen
    v_add_u32 v7, 128, v7
    v_add_u32 v10, 81920, v10
    ds_read_b64_tr_b16 v[56:57], v13 offset:0
    ds_read_b64_tr_b16 v[58:59], v13 offset:4608
    ds_read_b64_tr_b16 v[60:61], v13 offset:32
    ds_read_b64_tr_b16 v[62:63], v13 offset:4640
    ds_read_b64_tr_b16 v[64:65], v13 offset:64
    ds_read_b64_tr_b16 v[66:67], v13 offset:4672
    ds_read_b64_tr_b16 v[68:69], v13 offset:96
    ds_read_b64_tr_b16 v[70:71], v13 offset:4704
    ds_read_b64 v[48:49], v12 offset:0
    ds_read_b64 v[50:51], v12 offset:32
    ds_read_b64 v[52:53], v12 offset:2304
    ds_read_b64 v[54:55], v12 offset:2336
    s_waitcnt lgkmcnt(0)
    ds_read_b64_tr_b16 v[80:81], v13 offset:9216
    ds_read_b64_tr_b16 v[82:83], v13 offset:13824
    ds_read_b64_tr_b16 v[84:85], v13 offset:9248
    ds_read_b64_tr_b16 v[86:87], v13 offset:13856
    ds_read_b64_tr_b16 v[88:89], v13 offset:9280
    ds_read_b64_tr_b16 v[90:91], v13 offset:13888
    ds_read_b64_tr_b16 v[92:93], v13 offset:9312
    ds_read_b64_tr_b16 v[94:95], v13 offset:13920
    ds_read_b64 v[72:73], v12 offset:64
    ds_read_b64 v[74:75], v12 offset:96
    ds_read_b64 v[76:77], v12 offset:2368
    ds_read_b64 v[78:79], v12 offset:2400
    v_mfma_f32_16x16x32_bf16 v[16:19], v[56:59], v[48:51], v[16:19]
    v_mfma_f32_16x16x32_bf16 v[20:23], v[60:63], v[48:51], v[20:23]
    v_mfma_f32_16x16x32_bf16 v[24:27], v[64:67], v[48:51], v[24:27]
    v_mfma_f32_16x16x32_bf16 v[28:31], v[68:71], v[48:51], v[28:31]
    v_mfma_f32_16x16x32_bf16 v[32:35], v[56:59], v[52:55], v[32:35]
    v_mfma_f32_16x16x32_bf16 v[36:39], v[60:63], v[52:55], v[36:39]
    v_mfma_f32_16x16x32_bf16 v[40:43], v[64:67], v[52:55], v[40:43]
    v_mfma_f32_16x16x32_bf16 v[44:47], v[68:71], v[52:55], v[44:47]
    s_waitcnt lgkmcnt(0)
    v_mfma_f32_16x16x32_bf16 v[16:19], v[80:83], v[72:75], v[16:19]
    v_mfma_f32_16x16x32_bf16 v[20:23], v[84:87], v[72:75], v[20:23]
    v_mfma_f32_16x16x32_bf16 v[24:27], v[88:91], v[72:75], v[24:27]
    v_mfma_f32_16x16x32_bf16 v[28:31], v[92:95], v[72:75], v[28:31]
    v_mfma_f32_16x16x32_bf16 v[32:35], v[80:83], v[76:79], v[32:35]
    v_mfma_f32_16x16x32_bf16 v[36:39], v[84:87], v[76:79], v[36:39]
    v_mfma_f32_16x16x32_bf16 v[40:43], v[88:91], v[76:79], v[40:43]
    v_mfma_f32_16x16x32_bf16 v[44:47], v[92:95], v[76:79], v[44:47]
    s_waitcnt vmcnt(6)
    ds_write_b128 v8, v[120:123] offset:27648
    ds_write_b128 v8, v[124:127] offset:32256
    ds_write_b128 v11, v[128:131] offset:27648
    ds_write_b128 v11, v[132:135] offset:32256
    ds_write_b128 v11, v[136:139] offset:36864
    ds_write_b128 v11, v[140:143] offset:41472
    s_waitcnt lgkmcnt(0)
    s_barrier
    buffer_load_dwordx4 v[120:123], v7, s[40:43], s64 offen
    buffer_load_dwordx4 v[124:127], v7, s[40:43], s65 offen
    buffer_load_dwordx4 v[128:131], v10, s[60:63], s68 offen
    buffer_load_dwordx4 v[132:135], v10, s[60:63], s69 offen
    buffer_load_dwordx4 v[136:139], v10, s[60:63], s70 offen
    buffer_load_dwordx4 v[140:143], v10, s[60:63], s71 offen
    v_add_u32 v7, 128, v7
    v_add_u32 v10, 81920, v10
    ds_read_b64_tr_b16 v[56:57], v13 offset:27648
    ds_read_b64_tr_b16 v[58:59], v13 offset:32256
    ds_read_b64_tr_b16 v[60:61], v13 offset:27680
    ds_read_b64_tr_b16 v[62:63], v13 offset:32288
    ds_read_b64_tr_b16 v[64:65], v13 offset:27712
    ds_read_b64_tr_b16 v[66:67], v13 offset:32320
    ds_read_b64_tr_b16 v[68:69], v13 offset:27744
    ds_read_b64_tr_b16 v[70:71], v13 offset:32352
    ds_read_b64 v[48:49], v12 offset:27648
    ds_read_b64 v[50:51], v12 offset:27680
    ds_read_b64 v[52:53], v12 offset:29952
    ds_read_b64 v[54:55], v12 offset:29984
    s_waitcnt lgkmcnt(0)
    ds_read_b64_tr_b16 v[80:81], v13 offset:36864
    ds_read_b64_tr_b16 v[82:83], v13 offset:41472
    ds_read_b64_tr_b16 v[84:85], v13 offset:36896
    ds_read_b64_tr_b16 v[86:87], v13 offset:41504
    ds_read_b64_tr_b16 v[88:89], v13 offset:36928
    ds_read_b64_tr_b16 v[90:91], v13 offset:41536
    ds_read_b64_tr_b16 v[92:93], v13 offset:36960
    ds_read_b64_tr_b16 v[94:95], v13 offset:41568
    ds_read_b64 v[72:73], v12 offset:27712
    ds_read_b64 v[74:75], v12 offset:27744
    ds_read_b64 v[76:77], v12 offset:30016
    ds_read_b64 v[78:79], v12 offset:30048
    v_mfma_f32_16x16x32_bf16 v[16:19], v[56:59], v[48:51], v[16:19]
    v_mfma_f32_16x16x32_bf16 v[20:23], v[60:63], v[48:51], v[20:23]
    v_mfma_f32_16x16x32_bf16 v[24:27], v[64:67], v[48:51], v[24:27]
    v_mfma_f32_16x16x32_bf16 v[28:31], v[68:71], v[48:51], v[28:31]
    v_mfma_f32_16x16x32_bf16 v[32:35], v[56:59], v[52:55], v[32:35]
    v_mfma_f32_16x16x32_bf16 v[36:39], v[60:63], v[52:55], v[36:39]
    v_mfma_f32_16x16x32_bf16 v[40:43], v[64:67], v[52:55], v[40:43]
    v_mfma_f32_16x16x32_bf16 v[44:47], v[68:71], v[52:55], v[44:47]
    s_waitcnt lgkmcnt(0)
    v_mfma_f32_16x16x32_bf16 v[16:19], v[80:83], v[72:75], v[16:19]
    v_mfma_f32_16x16x32_bf16 v[20:23], v[84:87], v[72:75], v[20:23]
    v_mfma_f32_16x16x32_bf16 v[24:27], v[88:91], v[72:75], v[24:27]
    v_mfma_f32_16x16x32_bf16 v[28:31], v[92:95], v[72:75], v[28:31]
    v_mfma_f32_16x16x32_bf16 v[32:35], v[80:83], v[76:79], v[32:35]
    v_mfma_f32_16x16x32_bf16 v[36:39], v[84:87], v[76:79], v[36:39]
    v_mfma_f32_16x16x32_bf16 v[40:43], v[88:91], v[76:79], v[40:43]
    v_mfma_f32_16x16x32_bf16 v[44:47], v[92:95], v[76:79], v[44:47]
    s_waitcnt vmcnt(6)
    ds_write_b128 v8, v[96:99] offset:0
    ds_write_b128 v8, v[100:103] offset:4608
    ds_write_b128 v11, v[104:107] offset:0
    ds_write_b128 v11, v[108:111] offset:4608
    ds_write_b128 v11, v[112:115] offset:9216
    ds_write_b128 v11, v[116:119] offset:13824
    s_waitcnt lgkmcnt(0)
    s_barrier
    ds_read_b64_tr_b16 v[56:57], v13 offset:0
    ds_read_b64_tr_b16 v[58:59], v13 offset:4608
    ds_read_b64_tr_b16 v[60:61], v13 offset:32
    ds_read_b64_tr_b16 v[62:63], v13 offset:4640
    ds_read_b64_tr_b16 v[64:65], v13 offset:64
    ds_read_b64_tr_b16 v[66:67], v13 offset:4672
    ds_read_b64_tr_b16 v[68:69], v13 offset:96
    ds_read_b64_tr_b16 v[70:71], v13 offset:4704
    ds_read_b64 v[48:49], v12 offset:0
    ds_read_b64 v[50:51], v12 offset:32
    ds_read_b64 v[52:53], v12 offset:2304
    ds_read_b64 v[54:55], v12 offset:2336
    s_waitcnt lgkmcnt(0)
    ds_read_b64_tr_b16 v[80:81], v13 offset:9216
    ds_read_b64_tr_b16 v[82:83], v13 offset:13824
    ds_read_b64_tr_b16 v[84:85], v13 offset:9248
    ds_read_b64_tr_b16 v[86:87], v13 offset:13856
    ds_read_b64_tr_b16 v[88:89], v13 offset:9280
    ds_read_b64_tr_b16 v[90:91], v13 offset:13888
    ds_read_b64_tr_b16 v[92:93], v13 offset:9312
    ds_read_b64_tr_b16 v[94:95], v13 offset:13920
    ds_read_b64 v[72:73], v12 offset:64
    ds_read_b64 v[74:75], v12 offset:96
    ds_read_b64 v[76:77], v12 offset:2368
    ds_read_b64 v[78:79], v12 offset:2400
    v_mfma_f32_16x16x32_bf16 v[16:19], v[56:59], v[48:51], v[16:19]
    v_mfma_f32_16x16x32_bf16 v[20:23], v[60:63], v[48:51], v[20:23]
    v_mfma_f32_16x16x32_bf16 v[24:27], v[64:67], v[48:51], v[24:27]
    v_mfma_f32_16x16x32_bf16 v[28:31], v[68:71], v[48:51], v[28:31]
    v_mfma_f32_16x16x32_bf16 v[32:35], v[56:59], v[52:55], v[32:35]
    v_mfma_f32_16x16x32_bf16 v[36:39], v[60:63], v[52:55], v[36:39]
    v_mfma_f32_16x16x32_bf16 v[40:43], v[64:67], v[52:55], v[40:43]
    v_mfma_f32_16x16x32_bf16 v[44:47], v[68:71], v[52:55], v[44:47]
    s_waitcnt lgkmcnt(0)
    v_mfma_f32_16x16x32_bf16 v[16:19], v[80:83], v[72:75], v[16:19]
    v_mfma_f32_16x16x32_bf16 v[20:23], v[84:87], v[72:75], v[20:23]
    v_mfma_f32_16x16x32_bf16 v[24:27], v[88:91], v[72:75], v[24:27]
    v_mfma_f32_16x16x32_bf16 v[28:31], v[92:95], v[72:75], v[28:31]
    v_mfma_f32_16x16x32_bf16 v[32:35], v[80:83], v[76:79], v[32:35]
    v_mfma_f32_16x16x32_bf16 v[36:39], v[84:87], v[76:79], v[36:39]
    v_mfma_f32_16x16x32_bf16 v[40:43], v[88:91], v[76:79], v[40:43]
    v_mfma_f32_16x16x32_bf16 v[44:47], v[92:95], v[76:79], v[44:47]
    s_waitcnt vmcnt(0)
    ds_write_b128 v8, v[120:123] offset:27648
    ds_write_b128 v8, v[124:127] offset:32256
    ds_write_b128 v11, v[128:131] offset:27648
    ds_write_b128 v11, v[132:135] offset:32256
    ds_write_b128 v11, v[136:139] offset:36864
    ds_write_b128 v11, v[140:143] offset:41472
    s_waitcnt lgkmcnt(0)
    s_barrier
    ds_read_b64_tr_b16 v[56:57], v13 offset:27648
    ds_read_b64_tr_b16 v[58:59], v13 offset:32256
    ds_read_b64_tr_b16 v[60:61], v13 offset:27680
    ds_read_b64_tr_b16 v[62:63], v13 offset:32288
    ds_read_b64_tr_b16 v[64:65], v13 offset:27712
    ds_read_b64_tr_b16 v[66:67], v13 offset:32320
    ds_read_b64_tr_b16 v[68:69], v13 offset:27744
    ds_read_b64_tr_b16 v[70:71], v13 offset:32352
    ds_read_b64 v[48:49], v12 offset:27648
    ds_read_b64 v[50:51], v12 offset:27680
    ds_read_b64 v[52:53], v12 offset:29952
    ds_read_b64 v[54:55], v12 offset:29984
    s_waitcnt lgkmcnt(0)
    ds_read_b64_tr_b16 v[80:81], v13 offset:36864
    ds_read_b64_tr_b16 v[82:83], v13 offset:41472
    ds_read_b64_tr_b16 v[84:85], v13 offset:36896
    ds_read_b64_tr_b16 v[86:87], v13 offset:41504
    ds_read_b64_tr_b16 v[88:89], v13 offset:36928
    ds_read_b64_tr_b16 v[90:91], v13 offset:41536
    ds_read_b64_tr_b16 v[92:93], v13 offset:36960
    ds_read_b64_tr_b16 v[94:95], v13 offset:41568
    ds_read_b64 v[72:73], v12 offset:27712
    ds_read_b64 v[74:75], v12 offset:27744
    ds_read_b64 v[76:77], v12 offset:30016
    ds_read_b64 v[78:79], v12 offset:30048
    v_mfma_f32_16x16x32_bf16 v[16:19], v[56:59], v[48:51], v[16:19]
    v_mfma_f32_16x16x32_bf16 v[20:23], v[60:63], v[48:51], v[20:23]
    v_mfma_f32_16x16x32_bf16 v[24:27], v[64:67], v[48:51], v[24:27]
    v_mfma_f32_16x16x32_bf16 v[28:31], v[68:71], v[48:51], v[28:31]
    v_mfma_f32_16x16x32_bf16 v[32:35], v[56:59], v[52:55], v[32:35]
    v_mfma_f32_16x16x32_bf16 v[36:39], v[60:63], v[52:55], v[36:39]
    v_mfma_f32_16x16x32_bf16 v[40:43], v[64:67], v[52:55], v[40:43]
    v_mfma_f32_16x16x32_bf16 v[44:47], v[68:71], v[52:55], v[44:47]
    s_waitcnt lgkmcnt(0)
    v_mfma_f32_16x16x32_bf16 v[16:19], v[80:83], v[72:75], v[16:19]
    v_mfma_f32_16x16x32_bf16 v[20:23], v[84:87], v[72:75], v[20:23]
    v_mfma_f32_16x16x32_bf16 v[24:27], v[88:91], v[72:75], v[24:27]
    v_mfma_f32_16x16x32_bf16 v[28:31], v[92:95], v[72:75], v[28:31]
    v_mfma_f32_16x16x32_bf16 v[32:35], v[80:83], v[76:79], v[32:35]
    v_mfma_f32_16x16x32_bf16 v[36:39], v[84:87], v[76:79], v[36:39]
    v_mfma_f32_16x16x32_bf16 v[40:43], v[88:91], v[76:79], v[40:43]
    v_mfma_f32_16x16x32_bf16 v[44:47], v[92:95], v[76:79], v[44:47]
    s_nop 7
    s_nop 7
    s_mul_i32 s7, s4, 64
    s_mul_i32 s12, s10, 32
    s_add_u32 s7, s7, s12
    v_add_u32 v5, s7, v3
    v_mul_u32_u24 v5, 1280, v5
    s_lshl_b32 s12, s5, 8
    s_lshl_b32 s13, s11, 7
    s_add_u32 s12, s12, s13
    v_lshl_add_u32 v5, v4, 3, v5
    v_add_u32 v5, s12, v5
    buffer_load_dwordx2 v[96:97], v5, s[56:59], 0 offen offset:0
    buffer_load_dwordx2 v[98:99], v5, s[56:59], 0 offen offset:32
    buffer_load_dwordx2 v[100:101], v5, s[56:59], 0 offen offset:64
    buffer_load_dwordx2 v[102:103], v5, s[56:59], 0 offen offset:96
    s_waitcnt vmcnt(0)
    v_lshlrev_b32 v104, 16, v96
    v_and_b32 v105, 0xffff0000, v96
    v_add_f32 v16, v16, v104
    v_add_f32 v17, v17, v105
    v_lshlrev_b32 v104, 16, v97
    v_and_b32 v105, 0xffff0000, v97
    v_add_f32 v18, v18, v104
    v_add_f32 v19, v19, v105
    v_cvt_pk_bf16_f32 v106, v16, v17
    v_cvt_pk_bf16_f32 v107, v18, v19
    buffer_store_dwordx2 v[106:107], v5, s[52:55], 0 offen offset:0
    s_nop 1
    v_lshlrev_b32 v104, 16, v98
    v_and_b32 v105, 0xffff0000, v98
    v_add_f32 v20, v20, v104
    v_add_f32 v21, v21, v105
    v_lshlrev_b32 v104, 16, v99
    v_and_b32 v105, 0xffff0000, v99
    v_add_f32 v22, v22, v104
    v_add_f32 v23, v23, v105
    v_cvt_pk_bf16_f32 v106, v20, v21
    v_cvt_pk_bf16_f32 v107, v22, v23
    buffer_store_dwordx2 v[106:107], v5, s[52:55], 0 offen offset:32
    s_nop 1
    v_lshlrev_b32 v104, 16, v100
    v_and_b32 v105, 0xffff0000, v100
    v_add_f32 v24, v24, v104
    v_add_f32 v25, v25, v105
    v_lshlrev_b32 v104, 16, v101
    v_and_b32 v105, 0xffff0000, v101
    v_add_f32 v26, v26, v104
    v_add_f32 v27, v27, v105
    v_cvt_pk_bf16_f32 v106, v24, v25
    v_cvt_pk_bf16_f32 v107, v26, v27
    buffer_store_dwordx2 v[106:107], v5, s[52:55], 0 offen offset:64
    s_nop 1
    v_lshlrev_b32 v104, 16, v102
    v_and_b32 v105, 0xffff0000, v102
    v_add_f32 v28, v28, v104
    v_add_f32 v29, v29, v105
    v_lshlrev_b32 v104, 16, v103
    v_and_b32 v105, 0xffff0000, v103
    v_add_f32 v30, v30, v104
    v_add_f32 v31, v31, v105
    v_cvt_pk_bf16_f32 v106, v28, v29
    v_cvt_pk_bf16_f32 v107, v30, v31
    buffer_store_dwordx2 v[106:107], v5, s[52:55], 0 offen offset:96
    s_nop 1
    v_add_u32 v5, 20480, v5
    buffer_load_dwordx2 v[96:97], v5, s[56:59], 0 offen offset:0
    buffer_load_dwordx2 v[98:99], v5, s[56:59], 0 offen offset:32
    buffer_load_dwordx2 v[100:101], v5, s[56:59], 0 offen offset:64
    buffer_load_dwordx2 v[102:103], v5, s[56:59], 0 offen offset:96
    s_waitcnt vmcnt(0)
    v_lshlrev_b32 v104, 16, v96
    v_and_b32 v105, 0xffff0000, v96
    v_add_f32 v32, v32, v104
    v_add_f32 v33, v33, v105
    v_lshlrev_b32 v104, 16, v97
    v_and_b32 v105, 0xffff0000, v97
    v_add_f32 v34, v34, v104
    v_add_f32 v35, v35, v105
    v_cvt_pk_bf16_f32 v106, v32, v33
    v_cvt_pk_bf16_f32 v107, v34, v35
    buffer_store_dwordx2 v[106:107], v5, s[52:55], 0 offen offset:0
    s_nop 1
    v_lshlrev_b32 v104, 16, v98
    v_and_b32 v105, 0xffff0000, v98
    v_add_f32 v36, v36, v104
    v_add_f32 v37, v37, v105
    v_lshlrev_b32 v104, 16, v99
    v_and_b32 v105, 0xffff0000, v99
    v_add_f32 v38, v38, v104
    v_add_f32 v39, v39, v105
    v_cvt_pk_bf16_f32 v106, v36, v37
    v_cvt_pk_bf16_f32 v107, v38, v39
    buffer_store_dwordx2 v[106:107], v5, s[52:55], 0 offen offset:32
    s_nop 1
    v_lshlrev_b32 v104, 16, v100
    v_and_b32 v105, 0xffff0000, v100
    v_add_f32 v40, v40, v104
    v_add_f32 v41, v41, v105
    v_lshlrev_b32 v104, 16, v101
    v_and_b32 v105, 0xffff0000, v101
    v_add_f32 v42, v42, v104
    v_add_f32 v43, v43, v105
    v_cvt_pk_bf16_f32 v106, v40, v41
    v_cvt_pk_bf16_f32 v107, v42, v43
    buffer_store_dwordx2 v[106:107], v5, s[52:55], 0 offen offset:64
    s_nop 1
    v_lshlrev_b32 v104, 16, v102
    v_and_b32 v105, 0xffff0000, v102
    v_add_f32 v44, v44, v104
    v_add_f32 v45, v45, v105
    v_lshlrev_b32 v104, 16, v103
    v_and_b32 v105, 0xffff0000, v103
    v_add_f32 v46, v46, v104
    v_add_f32 v47, v47, v105
    v_cvt_pk_bf16_f32 v106, v44, v45
    v_cvt_pk_bf16_f32 v107, v46, v47
    buffer_store_dwordx2 v[106:107], v5, s[52:55], 0 offen offset:96
    s_nop 1
wo_1_kernel_end:
    s_endpgm
.globl ln2_1_kernel
.p2align 8
.type ln2_1_kernel,@function
ln2_1_kernel:
    s_cmp_ge_u32 s2, 512
    s_cbranch_scc1 ln2_1_kernel_end
    s_load_dwordx16 s[16:31], s[0:1], 0
    s_load_dwordx4 s[32:35], s[0:1], 64
    s_load_dwordx2 s[36:37], s[0:1], 80
    s_waitcnt lgkmcnt(0)
    s_add_u32 s40, s36, 0x1400000
    s_addc_u32 s41, s37, 0
    s_mov_b32 s42, 0x280000
    s_mov_b32 s43, 0x00020000
    s_mov_b32 s44, s36
    s_mov_b32 s45, s37
    s_mov_b32 s46, 0x280000
    s_mov_b32 s47, 0x00020000
    v_lshrrev_b32 v1, 6, v0
    v_and_b32 v2, 63, v0
    s_lshl_b32 s3, s2, 2
    v_add_u32 v1, s3, v1
    v_mul_u32_u24 v3, 1280, v1
    v_mul_u32_u24 v4, 20, v2
    v_add_u32 v3, v3, v4
    buffer_load_dwordx4 v[8:11], v3, s[40:43], 0 offen
    buffer_load_dword v12, v3, s[40:43], 0 offen offset:16
    s_waitcnt vmcnt(0)
    v_lshlrev_b32 v16, 16, v8
    v_and_b32 v17, 0xffff0000, v8
    v_lshlrev_b32 v18, 16, v9
    v_and_b32 v19, 0xffff0000, v9
    v_lshlrev_b32 v20, 16, v10
    v_and_b32 v21, 0xffff0000, v10
    v_lshlrev_b32 v22, 16, v11
    v_and_b32 v23, 0xffff0000, v11
    v_lshlrev_b32 v24, 16, v12
    v_and_b32 v25, 0xffff0000, v12
    v_add_f32 v30, v16, v17
    v_add_f32 v30, v30, v18
    v_add_f32 v30, v30, v19
    v_add_f32 v30, v30, v20
    v_add_f32 v30, v30, v21
    v_add_f32 v30, v30, v22
    v_add_f32 v30, v30, v23
    v_add_f32 v30, v30, v24
    v_add_f32 v30, v30, v25
    ds_swizzle_b32 v31, v30 offset:0x41f
    s_waitcnt lgkmcnt(0)
    v_add_f32 v30, v30, v31
    ds_swizzle_b32 v31, v30 offset:0x81f
    s_waitcnt lgkmcnt(0)
    v_add_f32 v30, v30, v31
    ds_swizzle_b32 v31, v30 offset:0x101f
    s_waitcnt lgkmcnt(0)
    v_add_f32 v30, v30, v31
    ds_swizzle_b32 v31, v30 offset:0x201f
    s_waitcnt lgkmcnt(0)
    v_add_f32 v30, v30, v31
    ds_swizzle_b32 v31, v30 offset:0x401f
    s_waitcnt lgkmcnt(0)
    v_add_f32 v30, v30, v31
    s_nop 1
    v_readlane_b32 s4, v30, 0
    v_readlane_b32 s5, v30, 32
    s_nop 1
    v_mov_b32 v30, s4
    v_add_f32 v30, s5, v30
    v_mul_f32 v30, 0x3acccccd, v30
    v_sub_f32 v16, v16, v30
    v_sub_f32 v17, v17, v30
    v_sub_f32 v18, v18, v30
    v_sub_f32 v19, v19, v30
    v_sub_f32 v20, v20, v30
    v_sub_f32 v21, v21, v30
    v_sub_f32 v22, v22, v30
    v_sub_f32 v23, v23, v30
    v_sub_f32 v24, v24, v30
    v_sub_f32 v25, v25, v30
    v_mul_f32 v32, v16, v16
    v_fmac_f32 v32, v17, v17
    v_fmac_f32 v32, v18, v18
    v_fmac_f32 v32, v19, v19
    v_fmac_f32 v32, v20, v20
    v_fmac_f32 v32, v21, v21
    v_fmac_f32 v32, v22, v22
    v_fmac_f32 v32, v23, v23
    v_fmac_f32 v32, v24, v24
    v_fmac_f32 v32, v25, v25
    ds_swizzle_b32 v31, v32 offset:0x41f
    s_waitcnt lgkmcnt(0)
    v_add_f32 v32, v32, v31
    ds_swizzle_b32 v31, v32 offset:0x81f
    s_waitcnt lgkmcnt(0)
    v_add_f32 v32, v32, v31
    ds_swizzle_b32 v31, v32 offset:0x101f
    s_waitcnt lgkmcnt(0)
    v_add_f32 v32, v32, v31
    ds_swizzle_b32 v31, v32 offset:0x201f
    s_waitcnt lgkmcnt(0)
    v_add_f32 v32, v32, v31
    ds_swizzle_b32 v31, v32 offset:0x401f
    s_waitcnt lgkmcnt(0)
    v_add_f32 v32, v32, v31
    s_nop 1
    v_readlane_b32 s4, v32, 0
    v_readlane_b32 s5, v32, 32
    s_nop 1
    v_mov_b32 v32, s4
    v_add_f32 v32, s5, v32
    v_mov_b32 v33, 0x3727c5ac
    v_fmac_f32 v33, 0x3acccccd, v32
    v_rsq_f32 v33, v33
    s_nop 0
    v_mul_f32 v16, v16, v33
    v_mul_f32 v17, v17, v33
    v_mul_f32 v18, v18, v33
    v_mul_f32 v19, v19, v33
    v_mul_f32 v20, v20, v33
    v_mul_f32 v21, v21, v33
    v_mul_f32 v22, v22, v33
    v_mul_f32 v23, v23, v33
    v_mul_f32 v24, v24, v33
    v_mul_f32 v25, v25, v33
    v_cvt_pk_bf16_f32 v8, v16, v17
    v_cvt_pk_bf16_f32 v9, v18, v19
    v_cvt_pk_bf16_f32 v10, v20, v21
    v_cvt_pk_bf16_f32 v11, v22, v23
    v_cvt_pk_bf16_f32 v12, v24, v25
    buffer_store_dwordx4 v[8:11], v3, s[44:47], 0 offen
    buffer_store_dword v12, v3, s[44:47], 0 offen offset:16
ln2_1_kernel_end:
    s_endpgm
.globl gu_1_kernel
.p2align 8
.type gu_1_kernel,@function
gu_1_kernel:
    s_cmp_ge_u32 s2, 432
    s_cbranch_scc1 gu_1_kernel_end
    s_load_dwordx16 s[16:31], s[0:1], 0
    s_load_dwordx4 s[32:35], s[0:1], 64
    s_load_dwordx2 s[36:37], s[0:1], 80
    s_waitcnt lgkmcnt(0)
    s_mov_b32 s40, s36
    s_mov_b32 s41, s37
    s_mov_b32 s42, 0x280000
    s_mov_b32 s43, 0x00020000
    s_mov_b32 s44, s26
    s_mov_b32 s45, s27
    s_mov_b32 s46, 0x21c000
    s_mov_b32 s47, 0x00020000
    s_mov_b32 s48, s28
    s_mov_b32 s49, s29
    s_mov_b32 s50, 0x21c000
    s_mov_b32 s51, 0x00020000
    s_add_u32 s52, s36, 0x1800000
    s_addc_u32 s53, s37, 0
    s_mov_b32 s54, 0x6c0000
    s_mov_b32 s55, 0x00020000
    s_and_b32 s4, s2, 15
    s_lshr_b32 s5, s2, 4
    v_lshrrev_b32 v1, 6, v0
    s_nop 0
    v_readfirstlane_b32 s6, v1
    v_and_b32 v2, 63, v0
    v_and_b32 v3, 15, v0
    v_bfe_u32 v4, v0, 4, 2
    v_lshrrev_b32 v5, 3, v0
    v_and_b32 v6, 7, v0
    s_mul_i32 s7, s4, 163840
    v_mul_u32_u24 v7, 1280, v5
    v_lshl_add_u32 v7, v6, 4, v7
    v_add_u32 v7, s7, v7
    v_mul_u32_u24 v8, 144, v5
    v_lshl_add_u32 v8, v6, 4, v8
    v_and_b32 v9, 127, v0
    v_lshrrev_b32 v9, 3, v9
    s_lshr_b32 s8, s6, 1
    v_mul_u32_u24 v10, 3456, v9
    v_lshl_add_u32 v10, v6, 4, v10
    s_lshl_b32 s9, s5, 7
    s_cmp_eq_u32 s8, 0
    s_cselect_b32 s60, s44, s48
    s_cselect_b32 s61, s45, s49
    s_cselect_b32 s62, s46, s50
    s_cselect_b32 s63, s47, s51
    v_add_u32 v10, s9, v10
    v_mul_u32_u24 v11, 288, v9
    v_lshl_add_u32 v11, v6, 4, v11
    s_lshl_b32 s10, s8, 7
    v_add_u32 v11, s10, v11
    v_add_u32 v11, 18432, v11
    s_mov_b32 s64, 0
    s_mov_b32 s65, 40960
    s_mov_b32 s66, 81920
    s_mov_b32 s67, 122880
    s_mov_b32 s68, 0
    s_mov_b32 s69, 55296
    s_mov_b32 s70, 110592
    s_mov_b32 s71, 165888
    s_lshr_b32 s10, s6, 1
    s_and_b32 s11, s6, 1
    s_mul_i32 s12, s10, 9216
    v_mul_u32_u24 v12, 144, v3
    v_lshl_add_u32 v12, v4, 3, v12
    v_add_u32 v12, s12, v12
    v_lshrrev_b32 v13, 2, v3
    v_lshl_add_u32 v13, v4, 2, v13
    v_mul_u32_u24 v13, 288, v13
    v_and_b32 v14, 3, v3
    v_lshl_add_u32 v13, v14, 3, v13
    s_lshl_b32 s13, s11, 6
    s_add_u32 s13, s13, 18432
    v_add_u32 v13, s13, v13
    v_mov_b32 v16, 0
    v_mov_b32 v17, 0
    v_mov_b32 v18, 0
    v_mov_b32 v19, 0
    v_mov_b32 v20, 0
    v_mov_b32 v21, 0
    v_mov_b32 v22, 0
    v_mov_b32 v23, 0
    v_mov_b32 v24, 0
    v_mov_b32 v25, 0
    v_mov_b32 v26, 0
    v_mov_b32 v27, 0
    v_mov_b32 v28, 0
    v_mov_b32 v29, 0
    v_mov_b32 v30, 0
    v_mov_b32 v31, 0
    v_mov_b32 v32, 0
    v_mov_b32 v33, 0
    v_mov_b32 v34, 0
    v_mov_b32 v35, 0
    v_mov_b32 v36, 0
    v_mov_b32 v37, 0
    v_mov_b32 v38, 0
    v_mov_b32 v39, 0
    v_mov_b32 v40, 0
    v_mov_b32 v41, 0
    v_mov_b32 v42, 0
    v_mov_b32 v43, 0
    v_mov_b32 v44, 0
    v_mov_b32 v45, 0
    v_mov_b32 v46, 0
    v_mov_b32 v47, 0
    v_mov_b32 v48, 0
    v_mov_b32 v49, 0
    v_mov_b32 v50, 0
    v_mov_b32 v51, 0
    v_mov_b32 v52, 0
    v_mov_b32 v53, 0
    v_mov_b32 v54, 0
    v_mov_b32 v55, 0
    v_mov_b32 v56, 0
    v_mov_b32 v57, 0
    v_mov_b32 v58, 0
    v_mov_b32 v59, 0
    v_mov_b32 v60, 0
    v_mov_b32 v61, 0
    v_mov_b32 v62, 0
    v_mov_b32 v63, 0
    v_mov_b32 v64, 0
    v_mov_b32 v65, 0
    v_mov_b32 v66, 0
    v_mov_b32 v67, 0
    v_mov_b32 v68, 0
    v_mov_b32 v69, 0
    v_mov_b32 v70, 0
    v_mov_b32 v71, 0
    v_mov_b32 v72, 0
    v_mov_b32 v73, 0
    v_mov_b32 v74, 0
    v_mov_b32 v75, 0
    v_mov_b32 v76, 0
    v_mov_b32 v77, 0
    v_mov_b32 v78, 0
    v_mov_b32 v79, 0
    buffer_load_dwordx4 v[144:147], v7, s[40:43], s64 offen
    buffer_load_dwordx4 v[148:151], v7, s[40:43], s65 offen
    buffer_load_dwordx4 v[152:155], v7, s[40:43], s66 offen
    buffer_load_dwordx4 v[156:159], v7, s[40:43], s67 offen
    buffer_load_dwordx4 v[160:163], v10, s[60:63], s68 offen
    buffer_load_dwordx4 v[164:167], v10, s[60:63], s69 offen
    buffer_load_dwordx4 v[168:171], v10, s[60:63], s70 offen
    buffer_load_dwordx4 v[172:175], v10, s[60:63], s71 offen
    v_add_u32 v7, 128, v7
    v_add_u32 v10, 221184, v10
    buffer_load_dwordx4 v[176:179], v7, s[40:43], s64 offen
    buffer_load_dwordx4 v[180:183], v7, s[40:43], s65 offen
    buffer_load_dwordx4 v[184:187], v7, s[40:43], s66 offen
    buffer_load_dwordx4 v[188:191], v7, s[40:43], s67 offen
    buffer_load_dwordx4 v[192:195], v10, s[60:63], s68 offen
    buffer_load_dwordx4 v[196:199], v10, s[60:63], s69 offen
    buffer_load_dwordx4 v[200:203], v10, s[60:63], s70 offen
    buffer_load_dwordx4 v[204:207], v10, s[60:63], s71 offen
    v_add_u32 v7, 128, v7
    v_add_u32 v10, 221184, v10
    s_waitcnt vmcnt(8)
    ds_write_b128 v8, v[144:147] offset:0
    ds_write_b128 v8, v[148:151] offset:4608
    ds_write_b128 v8, v[152:155] offset:9216
    ds_write_b128 v8, v[156:159] offset:13824
    ds_write_b128 v11, v[160:163] offset:0
    ds_write_b128 v11, v[164:167] offset:4608
    ds_write_b128 v11, v[168:171] offset:9216
    ds_write_b128 v11, v[172:175] offset:13824
    s_waitcnt lgkmcnt(0)
    s_barrier
    buffer_load_dwordx4 v[144:147], v7, s[40:43], s64 offen
    buffer_load_dwordx4 v[148:151], v7, s[40:43], s65 offen
    buffer_load_dwordx4 v[152:155], v7, s[40:43], s66 offen
    buffer_load_dwordx4 v[156:159], v7, s[40:43], s67 offen
    buffer_load_dwordx4 v[160:163], v10, s[60:63], s68 offen
    buffer_load_dwordx4 v[164:167], v10, s[60:63], s69 offen
    buffer_load_dwordx4 v[168:171], v10, s[60:63], s70 offen
    buffer_load_dwordx4 v[172:175], v10, s[60:63], s71 offen
    v_add_u32 v7, 128, v7
    v_add_u32 v10, 221184, v10
    ds_read_b64_tr_b16 v[96:97], v13 offset:0
    ds_read_b64_tr_b16 v[98:99], v13 offset:4608
    ds_read_b64_tr_b16 v[100:101], v13 offset:32
    ds_read_b64_tr_b16 v[102:103], v13 offset:4640
    ds_read_b64_tr_b16 v[104:105], v13 offset:128
    ds_read_b64_tr_b16 v[106:107], v13 offset:4736
    ds_read_b64_tr_b16 v[108:109], v13 offset:160
    ds_read_b64_tr_b16 v[110:111], v13 offset:4768
    ds_read_b64 v[80:81], v12 offset:0
    ds_read_b64 v[82:83], v12 offset:32
    ds_read_b64 v[84:85], v12 offset:2304
    ds_read_b64 v[86:87], v12 offset:2336
    ds_read_b64 v[88:89], v12 offset:4608
    ds_read_b64 v[90:91], v12 offset:4640
    ds_read_b64 v[92:93], v12 offset:6912
    ds_read_b64 v[94:95], v12 offset:6944
    s_waitcnt lgkmcnt(0)
    ds_read_b64_tr_b16 v[128:129], v13 offset:9216
    ds_read_b64_tr_b16 v[130:131], v13 offset:13824
    ds_read_b64_tr_b16 v[132:133], v13 offset:9248
    ds_read_b64_tr_b16 v[134:135], v13 offset:13856
    ds_read_b64_tr_b16 v[136:137], v13 offset:9344
    ds_read_b64_tr_b16 v[138:139], v13 offset:13952
    ds_read_b64_tr_b16 v[140:141], v13 offset:9376
    ds_read_b64_tr_b16 v[142:143], v13 offset:13984
    ds_read_b64 v[112:113], v12 offset:64
    ds_read_b64 v[114:115], v12 offset:96
    ds_read_b64 v[116:117], v12 offset:2368
    ds_read_b64 v[118:119], v12 offset:2400
    ds_read_b64 v[120:121], v12 offset:4672
    ds_read_b64 v[122:123], v12 offset:4704
    ds_read_b64 v[124:125], v12 offset:6976
    ds_read_b64 v[126:127], v12 offset:7008
    v_mfma_f32_16x16x32_bf16 v[16:19], v[96:99], v[80:83], v[16:19]
    v_mfma_f32_16x16x32_bf16 v[20:23], v[100:103], v[80:83], v[20:23]
    v_mfma_f32_16x16x32_bf16 v[24:27], v[104:107], v[80:83], v[24:27]
    v_mfma_f32_16x16x32_bf16 v[28:31], v[108:111], v[80:83], v[28:31]
    v_mfma_f32_16x16x32_bf16 v[32:35], v[96:99], v[84:87], v[32:35]
    v_mfma_f32_16x16x32_bf16 v[36:39], v[100:103], v[84:87], v[36:39]
    v_mfma_f32_16x16x32_bf16 v[40:43], v[104:107], v[84:87], v[40:43]
    v_mfma_f32_16x16x32_bf16 v[44:47], v[108:111], v[84:87], v[44:47]
    v_mfma_f32_16x16x32_bf16 v[48:51], v[96:99], v[88:91], v[48:51]
    v_mfma_f32_16x16x32_bf16 v[52:55], v[100:103], v[88:91], v[52:55]
    v_mfma_f32_16x16x32_bf16 v[56:59], v[104:107], v[88:91], v[56:59]
    v_mfma_f32_16x16x32_bf16 v[60:63], v[108:111], v[88:91], v[60:63]
    v_mfma_f32_16x16x32_bf16 v[64:67], v[96:99], v[92:95], v[64:67]
    v_mfma_f32_16x16x32_bf16 v[68:71], v[100:103], v[92:95], v[68:71]
    v_mfma_f32_16x16x32_bf16 v[72:75], v[104:107], v[92:95], v[72:75]
    v_mfma_f32_16x16x32_bf16 v[76:79], v[108:111], v[92:95], v[76:79]
    s_waitcnt lgkmcnt(0)
    v_mfma_f32_16x16x32_bf16 v[16:19], v[128:131], v[112:115], v[16:19]
    v_mfma_f32_16x16x32_bf16 v[20:23], v[132:135], v[112:115], v[20:23]
    v_mfma_f32_16x16x32_bf16 v[24:27], v[136:139], v[112:115], v[24:27]
    v_mfma_f32_16x16x32_bf16 v[28:31], v[140:143], v[112:115], v[28:31]
    v_mfma_f32_16x16x32_bf16 v[32:35], v[128:131], v[116:119], v[32:35]
    v_mfma_f32_16x16x32_bf16 v[36:39], v[132:135], v[116:119], v[36:39]
    v_mfma_f32_16x16x32_bf16 v[40:43], v[136:139], v[116:119], v[40:43]
    v_mfma_f32_16x16x32_bf16 v[44:47], v[140:143], v[116:119], v[44:47]
    v_mfma_f32_16x16x32_bf16 v[48:51], v[128:131], v[120:123], v[48:51]
    v_mfma_f32_16x16x32_bf16 v[52:55], v[132:135], v[120:123], v[52:55]
    v_mfma_f32_16x16x32_bf16 v[56:59], v[136:139], v[120:123], v[56:59]
    v_mfma_f32_16x16x32_bf16 v[60:63], v[140:143], v[120:123], v[60:63]
    v_mfma_f32_16x16x32_bf16 v[64:67], v[128:131], v[124:127], v[64:67]
    v_mfma_f32_16x16x32_bf16 v[68:71], v[132:135], v[124:127], v[68:71]
    v_mfma_f32_16x16x32_bf16 v[72:75], v[136:139], v[124:127], v[72:75]
    v_mfma_f32_16x16x32_bf16 v[76:79], v[140:143], v[124:127], v[76:79]
    s_waitcnt vmcnt(8)
    ds_write_b128 v8, v[176:179] offset:36864
    ds_write_b128 v8, v[180:183] offset:41472
    ds_write_b128 v8, v[184:187] offset:46080
    ds_write_b128 v8, v[188:191] offset:50688
    ds_write_b128 v11, v[192:195] offset:36864
    ds_write_b128 v11, v[196:199] offset:41472
    ds_write_b128 v11, v[200:203] offset:46080
    ds_write_b128 v11, v[204:207] offset:50688
    s_waitcnt lgkmcnt(0)
    s_barrier
    buffer_load_dwordx4 v[176:179], v7, s[40:43], s64 offen
    buffer_load_dwordx4 v[180:183], v7, s[40:43], s65 offen
    buffer_load_dwordx4 v[184:187], v7, s[40:43], s66 offen
    buffer_load_dwordx4 v[188:191], v7, s[40:43], s67 offen
    buffer_load_dwordx4 v[192:195], v10, s[60:63], s68 offen
    buffer_load_dwordx4 v[196:199], v10, s[60:63], s69 offen
    buffer_load_dwordx4 v[200:203], v10, s[60:63], s70 offen
    buffer_load_dwordx4 v[204:207], v10, s[60:63], s71 offen
    v_add_u32 v7, 128, v7
    v_add_u32 v10, 221184, v10
    ds_read_b64_tr_b16 v[96:97], v13 offset:36864
    ds_read_b64_tr_b16 v[98:99], v13 offset:41472
    ds_read_b64_tr_b16 v[100:101], v13 offset:36896
    ds_read_b64_tr_b16 v[102:103], v13 offset:41504
    ds_read_b64_tr_b16 v[104:105], v13 offset:36992
    ds_read_b64_tr_b16 v[106:107], v13 offset:41600
    ds_read_b64_tr_b16 v[108:109], v13 offset:37024
    ds_read_b64_tr_b16 v[110:111], v13 offset:41632
    ds_read_b64 v[80:81], v12 offset:36864
    ds_read_b64 v[82:83], v12 offset:36896
    ds_read_b64 v[84:85], v12 offset:39168
    ds_read_b64 v[86:87], v12 offset:39200
    ds_read_b64 v[88:89], v12 offset:41472
    ds_read_b64 v[90:91], v12 offset:41504
    ds_read_b64 v[92:93], v12 offset:43776
    ds_read_b64 v[94:95], v12 offset:43808
    s_waitcnt lgkmcnt(0)
    ds_read_b64_tr_b16 v[128:129], v13 offset:46080
    ds_read_b64_tr_b16 v[130:131], v13 offset:50688
    ds_read_b64_tr_b16 v[132:133], v13 offset:46112
    ds_read_b64_tr_b16 v[134:135], v13 offset:50720
    ds_read_b64_tr_b16 v[136:137], v13 offset:46208
    ds_read_b64_tr_b16 v[138:139], v13 offset:50816
    ds_read_b64_tr_b16 v[140:141], v13 offset:46240
    ds_read_b64_tr_b16 v[142:143], v13 offset:50848
    ds_read_b64 v[112:113], v12 offset:36928
    ds_read_b64 v[114:115], v12 offset:36960
    ds_read_b64 v[116:117], v12 offset:39232
    ds_read_b64 v[118:119], v12 offset:39264
    ds_read_b64 v[120:121], v12 offset:41536
    ds_read_b64 v[122:123], v12 offset:41568
    ds_read_b64 v[124:125], v12 offset:43840
    ds_read_b64 v[126:127], v12 offset:43872
    v_mfma_f32_16x16x32_bf16 v[16:19], v[96:99], v[80:83], v[16:19]
    v_mfma_f32_16x16x32_bf16 v[20:23], v[100:103], v[80:83], v[20:23]
    v_mfma_f32_16x16x32_bf16 v[24:27], v[104:107], v[80:83], v[24:27]
    v_mfma_f32_16x16x32_bf16 v[28:31], v[108:111], v[80:83], v[28:31]
    v_mfma_f32_16x16x32_bf16 v[32:35], v[96:99], v[84:87], v[32:35]
    v_mfma_f32_16x16x32_bf16 v[36:39], v[100:103], v[84:87], v[36:39]
    v_mfma_f32_16x16x32_bf16 v[40:43], v[104:107], v[84:87], v[40:43]
    v_mfma_f32_16x16x32_bf16 v[44:47], v[108:111], v[84:87], v[44:47]
    v_mfma_f32_16x16x32_bf16 v[48:51], v[96:99], v[88:91], v[48:51]
    v_mfma_f32_16x16x32_bf16 v[52:55], v[100:103], v[88:91], v[52:55]
    v_mfma_f32_16x16x32_bf16 v[56:59], v[104:107], v[88:91], v[56:59]
    v_mfma_f32_16x16x32_bf16 v[60:63], v[108:111], v[88:91], v[60:63]
    v_mfma_f32_16x16x32_bf16 v[64:67], v[96:99], v[92:95], v[64:67]
    v_mfma_f32_16x16x32_bf16 v[68:71], v[100:103], v[92:95], v[68:71]
    v_mfma_f32_16x16x32_bf16 v[72:75], v[104:107], v[92:95], v[72:75]
    v_mfma_f32_16x16x32_bf16 v[76:79], v[108:111], v[92:95], v[76:79]
    s_waitcnt lgkmcnt(0)
    v_mfma_f32_16x16x32_bf16 v[16:19], v[128:131], v[112:115], v[16:19]
    v_mfma_f32_16x16x32_bf16 v[20:23], v[132:135], v[112:115], v[20:23]
    v_mfma_f32_16x16x32_bf16 v[24:27], v[136:139], v[112:115], v[24:27]
    v_mfma_f32_16x16x32_bf16 v[28:31], v[140:143], v[112:115], v[28:31]
    v_mfma_f32_16x16x32_bf16 v[32:35], v[128:131], v[116:119], v[32:35]
    v_mfma_f32_16x16x32_bf16 v[36:39], v[132:135], v[116:119], v[36:39]
    v_mfma_f32_16x16x32_bf16 v[40:43], v[136:139], v[116:119], v[40:43]
    v_mfma_f32_16x16x32_bf16 v[44:47], v[140:143], v[116:119], v[44:47]
    v_mfma_f32_16x16x32_bf16 v[48:51], v[128:131], v[120:123], v[48:51]
    v_mfma_f32_16x16x32_bf16 v[52:55], v[132:135], v[120:123], v[52:55]
    v_mfma_f32_16x16x32_bf16 v[56:59], v[136:139], v[120:123], v[56:59]
    v_mfma_f32_16x16x32_bf16 v[60:63], v[140:143], v[120:123], v[60:63]
    v_mfma_f32_16x16x32_bf16 v[64:67], v[128:131], v[124:127], v[64:67]
    v_mfma_f32_16x16x32_bf16 v[68:71], v[132:135], v[124:127], v[68:71]
    v_mfma_f32_16x16x32_bf16 v[72:75], v[136:139], v[124:127], v[72:75]
    v_mfma_f32_16x16x32_bf16 v[76:79], v[140:143], v[124:127], v[76:79]
    s_waitcnt vmcnt(8)
    ds_write_b128 v8, v[144:147] offset:0
    ds_write_b128 v8, v[148:151] offset:4608
    ds_write_b128 v8, v[152:155] offset:9216
    ds_write_b128 v8, v[156:159] offset:13824
    ds_write_b128 v11, v[160:163] offset:0
    ds_write_b128 v11, v[164:167] offset:4608
    ds_write_b128 v11, v[168:171] offset:9216
    ds_write_b128 v11, v[172:175] offset:13824
    s_waitcnt lgkmcnt(0)
    s_barrier
    buffer_load_dwordx4 v[144:147], v7, s[40:43], s64 offen
    buffer_load_dwordx4 v[148:151], v7, s[40:43], s65 offen
    buffer_load_dwordx4 v[152:155], v7, s[40:43], s66 offen
    buffer_load_dwordx4 v[156:159], v7, s[40:43], s67 offen
    buffer_load_dwordx4 v[160:163], v10, s[60:63], s68 offen
    buffer_load_dwordx4 v[164:167], v10, s[60:63], s69 offen
    buffer_load_dwordx4 v[168:171], v10, s[60:63], s70 offen
    buffer_load_dwordx4 v[172:175], v10, s[60:63], s71 offen
    v_add_u32 v7, 128, v7
    v_add_u32 v10, 221184, v10
    ds_read_b64_tr_b16 v[96:97], v13 offset:0
    ds_read_b64_tr_b16 v[98:99], v13 offset:4608
    ds_read_b64_tr_b16 v[100:101], v13 offset:32
    ds_read_b64_tr_b16 v[102:103], v13 offset:4640
    ds_read_b64_tr_b16 v[104:105], v13 offset:128
    ds_read_b64_tr_b16 v[106:107], v13 offset:4736
    ds_read_b64_tr_b16 v[108:109], v13 offset:160
    ds_read_b64_tr_b16 v[110:111], v13 offset:4768
    ds_read_b64 v[80:81], v12 offset:0
    ds_read_b64 v[82:83], v12 offset:32
    ds_read_b64 v[84:85], v12 offset:2304
    ds_read_b64 v[86:87], v12 offset:2336
    ds_read_b64 v[88:89], v12 offset:4608
    ds_read_b64 v[90:91], v12 offset:4640
    ds_read_b64 v[92:93], v12 offset:6912
    ds_read_b64 v[94:95], v12 offset:6944
    s_waitcnt lgkmcnt(0)
    ds_read_b64_tr_b16 v[128:129], v13 offset:9216
    ds_read_b64_tr_b16 v[130:131], v13 offset:13824
    ds_read_b64_tr_b16 v[132:133], v13 offset:9248
    ds_read_b64_tr_b16 v[134:135], v13 offset:13856
    ds_read_b64_tr_b16 v[136:137], v13 offset:9344
    ds_read_b64_tr_b16 v[138:139], v13 offset:13952
    ds_read_b64_tr_b16 v[140:141], v13 offset:9376
    ds_read_b64_tr_b16 v[142:143], v13 offset:13984
    ds_read_b64 v[112:113], v12 offset:64
    ds_read_b64 v[114:115], v12 offset:96
    ds_read_b64 v[116:117], v12 offset:2368
    ds_read_b64 v[118:119], v12 offset:2400
    ds_read_b64 v[120:121], v12 offset:4672
    ds_read_b64 v[122:123], v12 offset:4704
    ds_read_b64 v[124:125], v12 offset:6976
    ds_read_b64 v[126:127], v12 offset:7008
    v_mfma_f32_16x16x32_bf16 v[16:19], v[96:99], v[80:83], v[16:19]
    v_mfma_f32_16x16x32_bf16 v[20:23], v[100:103], v[80:83], v[20:23]
    v_mfma_f32_16x16x32_bf16 v[24:27], v[104:107], v[80:83], v[24:27]
    v_mfma_f32_16x16x32_bf16 v[28:31], v[108:111], v[80:83], v[28:31]
    v_mfma_f32_16x16x32_bf16 v[32:35], v[96:99], v[84:87], v[32:35]
    v_mfma_f32_16x16x32_bf16 v[36:39], v[100:103], v[84:87], v[36:39]
    v_mfma_f32_16x16x32_bf16 v[40:43], v[104:107], v[84:87], v[40:43]
    v_mfma_f32_16x16x32_bf16 v[44:47], v[108:111], v[84:87], v[44:47]
    v_mfma_f32_16x16x32_bf16 v[48:51], v[96:99], v[88:91], v[48:51]
    v_mfma_f32_16x16x32_bf16 v[52:55], v[100:103], v[88:91], v[52:55]
    v_mfma_f32_16x16x32_bf16 v[56:59], v[104:107], v[88:91], v[56:59]
    v_mfma_f32_16x16x32_bf16 v[60:63], v[108:111], v[88:91], v[60:63]
    v_mfma_f32_16x16x32_bf16 v[64:67], v[96:99], v[92:95], v[64:67]
    v_mfma_f32_16x16x32_bf16 v[68:71], v[100:103], v[92:95], v[68:71]
    v_mfma_f32_16x16x32_bf16 v[72:75], v[104:107], v[92:95], v[72:75]
    v_mfma_f32_16x16x32_bf16 v[76:79], v[108:111], v[92:95], v[76:79]
    s_waitcnt lgkmcnt(0)
    v_mfma_f32_16x16x32_bf16 v[16:19], v[128:131], v[112:115], v[16:19]
    v_mfma_f32_16x16x32_bf16 v[20:23], v[132:135], v[112:115], v[20:23]
    v_mfma_f32_16x16x32_bf16 v[24:27], v[136:139], v[112:115], v[24:27]
    v_mfma_f32_16x16x32_bf16 v[28:31], v[140:143], v[112:115], v[28:31]
    v_mfma_f32_16x16x32_bf16 v[32:35], v[128:131], v[116:119], v[32:35]
    v_mfma_f32_16x16x32_bf16 v[36:39], v[132:135], v[116:119], v[36:39]
    v_mfma_f32_16x16x32_bf16 v[40:43], v[136:139], v[116:119], v[40:43]
    v_mfma_f32_16x16x32_bf16 v[44:47], v[140:143], v[116:119], v[44:47]
    v_mfma_f32_16x16x32_bf16 v[48:51], v[128:131], v[120:123], v[48:51]
    v_mfma_f32_16x16x32_bf16 v[52:55], v[132:135], v[120:123], v[52:55]
    v_mfma_f32_16x16x32_bf16 v[56:59], v[136:139], v[120:123], v[56:59]
    v_mfma_f32_16x16x32_bf16 v[60:63], v[140:143], v[120:123], v[60:63]
    v_mfma_f32_16x16x32_bf16 v[64:67], v[128:131], v[124:127], v[64:67]
    v_mfma_f32_16x16x32_bf16 v[68:71], v[132:135], v[124:127], v[68:71]
    v_mfma_f32_16x16x32_bf16 v[72:75], v[136:139], v[124:127], v[72:75]
    v_mfma_f32_16x16x32_bf16 v[76:79], v[140:143], v[124:127], v[76:79]
    s_waitcnt vmcnt(8)
    ds_write_b128 v8, v[176:179] offset:36864
    ds_write_b128 v8, v[180:183] offset:41472
    ds_write_b128 v8, v[184:187] offset:46080
    ds_write_b128 v8, v[188:191] offset:50688
    ds_write_b128 v11, v[192:195] offset:36864
    ds_write_b128 v11, v[196:199] offset:41472
    ds_write_b128 v11, v[200:203] offset:46080
    ds_write_b128 v11, v[204:207] offset:50688
    s_waitcnt lgkmcnt(0)
    s_barrier
    buffer_load_dwordx4 v[176:179], v7, s[40:43], s64 offen
    buffer_load_dwordx4 v[180:183], v7, s[40:43], s65 offen
    buffer_load_dwordx4 v[184:187], v7, s[40:43], s66 offen
    buffer_load_dwordx4 v[188:191], v7, s[40:43], s67 offen
    buffer_load_dwordx4 v[192:195], v10, s[60:63], s68 offen
    buffer_load_dwordx4 v[196:199], v10, s[60:63], s69 offen
    buffer_load_dwordx4 v[200:203], v10, s[60:63], s70 offen
    buffer_load_dwordx4 v[204:207], v10, s[60:63], s71 offen
    v_add_u32 v7, 128, v7
    v_add_u32 v10, 221184, v10
    ds_read_b64_tr_b16 v[96:97], v13 offset:36864
    ds_read_b64_tr_b16 v[98:99], v13 offset:41472
    ds_read_b64_tr_b16 v[100:101], v13 offset:36896
    ds_read_b64_tr_b16 v[102:103], v13 offset:41504
    ds_read_b64_tr_b16 v[104:105], v13 offset:36992
    ds_read_b64_tr_b16 v[106:107], v13 offset:41600
    ds_read_b64_tr_b16 v[108:109], v13 offset:37024
    ds_read_b64_tr_b16 v[110:111], v13 offset:41632
    ds_read_b64 v[80:81], v12 offset:36864
    ds_read_b64 v[82:83], v12 offset:36896
    ds_read_b64 v[84:85], v12 offset:39168
    ds_read_b64 v[86:87], v12 offset:39200
    ds_read_b64 v[88:89], v12 offset:41472
    ds_read_b64 v[90:91], v12 offset:41504
    ds_read_b64 v[92:93], v12 offset:43776
    ds_read_b64 v[94:95], v12 offset:43808
    s_waitcnt lgkmcnt(0)
    ds_read_b64_tr_b16 v[128:129], v13 offset:46080
    ds_read_b64_tr_b16 v[130:131], v13 offset:50688
    ds_read_b64_tr_b16 v[132:133], v13 offset:46112
    ds_read_b64_tr_b16 v[134:135], v13 offset:50720
    ds_read_b64_tr_b16 v[136:137], v13 offset:46208
    ds_read_b64_tr_b16 v[138:139], v13 offset:50816
    ds_read_b64_tr_b16 v[140:141], v13 offset:46240
    ds_read_b64_tr_b16 v[142:143], v13 offset:50848
    ds_read_b64 v[112:113], v12 offset:36928
    ds_read_b64 v[114:115], v12 offset:36960
    ds_read_b64 v[116:117], v12 offset:39232
    ds_read_b64 v[118:119], v12 offset:39264
    ds_read_b64 v[120:121], v12 offset:41536
    ds_read_b64 v[122:123], v12 offset:41568
    ds_read_b64 v[124:125], v12 offset:43840
    ds_read_b64 v[126:127], v12 offset:43872
    v_mfma_f32_16x16x32_bf16 v[16:19], v[96:99], v[80:83], v[16:19]
    v_mfma_f32_16x16x32_bf16 v[20:23], v[100:103], v[80:83], v[20:23]
    v_mfma_f32_16x16x32_bf16 v[24:27], v[104:107], v[80:83], v[24:27]
    v_mfma_f32_16x16x32_bf16 v[28:31], v[108:111], v[80:83], v[28:31]
    v_mfma_f32_16x16x32_bf16 v[32:35], v[96:99], v[84:87], v[32:35]
    v_mfma_f32_16x16x32_bf16 v[36:39], v[100:103], v[84:87], v[36:39]
    v_mfma_f32_16x16x32_bf16 v[40:43], v[104:107], v[84:87], v[40:43]
    v_mfma_f32_16x16x32_bf16 v[44:47], v[108:111], v[84:87], v[44:47]
    v_mfma_f32_16x16x32_bf16 v[48:51], v[96:99], v[88:91], v[48:51]
    v_mfma_f32_16x16x32_bf16 v[52:55], v[100:103], v[88:91], v[52:55]
    v_mfma_f32_16x16x32_bf16 v[56:59], v[104:107], v[88:91], v[56:59]
    v_mfma_f32_16x16x32_bf16 v[60:63], v[108:111], v[88:91], v[60:63]
    v_mfma_f32_16x16x32_bf16 v[64:67], v[96:99], v[92:95], v[64:67]
    v_mfma_f32_16x16x32_bf16 v[68:71], v[100:103], v[92:95], v[68:71]
    v_mfma_f32_16x16x32_bf16 v[72:75], v[104:107], v[92:95], v[72:75]
    v_mfma_f32_16x16x32_bf16 v[76:79], v[108:111], v[92:95], v[76:79]
    s_waitcnt lgkmcnt(0)
    v_mfma_f32_16x16x32_bf16 v[16:19], v[128:131], v[112:115], v[16:19]
    v_mfma_f32_16x16x32_bf16 v[20:23], v[132:135], v[112:115], v[20:23]
    v_mfma_f32_16x16x32_bf16 v[24:27], v[136:139], v[112:115], v[24:27]
    v_mfma_f32_16x16x32_bf16 v[28:31], v[140:143], v[112:115], v[28:31]
    v_mfma_f32_16x16x32_bf16 v[32:35], v[128:131], v[116:119], v[32:35]
    v_mfma_f32_16x16x32_bf16 v[36:39], v[132:135], v[116:119], v[36:39]
    v_mfma_f32_16x16x32_bf16 v[40:43], v[136:139], v[116:119], v[40:43]
    v_mfma_f32_16x16x32_bf16 v[44:47], v[140:143], v[116:119], v[44:47]
    v_mfma_f32_16x16x32_bf16 v[48:51], v[128:131], v[120:123], v[48:51]
    v_mfma_f32_16x16x32_bf16 v[52:55], v[132:135], v[120:123], v[52:55]
    v_mfma_f32_16x16x32_bf16 v[56:59], v[136:139], v[120:123], v[56:59]
    v_mfma_f32_16x16x32_bf16 v[60:63], v[140:143], v[120:123], v[60:63]
    v_mfma_f32_16x16x32_bf16 v[64:67], v[128:131], v[124:127], v[64:67]
    v_mfma_f32_16x16x32_bf16 v[68:71], v[132:135], v[124:127], v[68:71]
    v_mfma_f32_16x16x32_bf16 v[72:75], v[136:139], v[124:127], v[72:75]
    v_mfma_f32_16x16x32_bf16 v[76:79], v[140:143], v[124:127], v[76:79]
    s_waitcnt vmcnt(8)
    ds_write_b128 v8, v[144:147] offset:0
    ds_write_b128 v8, v[148:151] offset:4608
    ds_write_b128 v8, v[152:155] offset:9216
    ds_write_b128 v8, v[156:159] offset:13824
    ds_write_b128 v11, v[160:163] offset:0
    ds_write_b128 v11, v[164:167] offset:4608
    ds_write_b128 v11, v[168:171] offset:9216
    ds_write_b128 v11, v[172:175] offset:13824
    s_waitcnt lgkmcnt(0)
    s_barrier
    buffer_load_dwordx4 v[144:147], v7, s[40:43], s64 offen
    buffer_load_dwordx4 v[148:151], v7, s[40:43], s65 offen
    buffer_load_dwordx4 v[152:155], v7, s[40:43], s66 offen
    buffer_load_dwordx4 v[156:159], v7, s[40:43], s67 offen
    buffer_load_dwordx4 v[160:163], v10, s[60:63], s68 offen
    buffer_load_dwordx4 v[164:167], v10, s[60:63], s69 offen
    buffer_load_dwordx4 v[168:171], v10, s[60:63], s70 offen
    buffer_load_dwordx4 v[172:175], v10, s[60:63], s71 offen
    v_add_u32 v7, 128, v7
    v_add_u32 v10, 221184, v10
    ds_read_b64_tr_b16 v[96:97], v13 offset:0
    ds_read_b64_tr_b16 v[98:99], v13 offset:4608
    ds_read_b64_tr_b16 v[100:101], v13 offset:32
    ds_read_b64_tr_b16 v[102:103], v13 offset:4640
    ds_read_b64_tr_b16 v[104:105], v13 offset:128
    ds_read_b64_tr_b16 v[106:107], v13 offset:4736
    ds_read_b64_tr_b16 v[108:109], v13 offset:160
    ds_read_b64_tr_b16 v[110:111], v13 offset:4768
    ds_read_b64 v[80:81], v12 offset:0
    ds_read_b64 v[82:83], v12 offset:32
    ds_read_b64 v[84:85], v12 offset:2304
    ds_read_b64 v[86:87], v12 offset:2336
    ds_read_b64 v[88:89], v12 offset:4608
    ds_read_b64 v[90:91], v12 offset:4640
    ds_read_b64 v[92:93], v12 offset:6912
    ds_read_b64 v[94:95], v12 offset:6944
    s_waitcnt lgkmcnt(0)
    ds_read_b64_tr_b16 v[128:129], v13 offset:9216
    ds_read_b64_tr_b16 v[130:131], v13 offset:13824
    ds_read_b64_tr_b16 v[132:133], v13 offset:9248
    ds_read_b64_tr_b16 v[134:135], v13 offset:13856
    ds_read_b64_tr_b16 v[136:137], v13 offset:9344
    ds_read_b64_tr_b16 v[138:139], v13 offset:13952
    ds_read_b64_tr_b16 v[140:141], v13 offset:9376
    ds_read_b64_tr_b16 v[142:143], v13 offset:13984
    ds_read_b64 v[112:113], v12 offset:64
    ds_read_b64 v[114:115], v12 offset:96
    ds_read_b64 v[116:117], v12 offset:2368
    ds_read_b64 v[118:119], v12 offset:2400
    ds_read_b64 v[120:121], v12 offset:4672
    ds_read_b64 v[122:123], v12 offset:4704
    ds_read_b64 v[124:125], v12 offset:6976
    ds_read_b64 v[126:127], v12 offset:7008
    v_mfma_f32_16x16x32_bf16 v[16:19], v[96:99], v[80:83], v[16:19]
    v_mfma_f32_16x16x32_bf16 v[20:23], v[100:103], v[80:83], v[20:23]
    v_mfma_f32_16x16x32_bf16 v[24:27], v[104:107], v[80:83], v[24:27]
    v_mfma_f32_16x16x32_bf16 v[28:31], v[108:111], v[80:83], v[28:31]
    v_mfma_f32_16x16x32_bf16 v[32:35], v[96:99], v[84:87], v[32:35]
    v_mfma_f32_16x16x32_bf16 v[36:39], v[100:103], v[84:87], v[36:39]
    v_mfma_f32_16x16x32_bf16 v[40:43], v[104:107], v[84:87], v[40:43]
    v_mfma_f32_16x16x32_bf16 v[44:47], v[108:111], v[84:87], v[44:47]
    v_mfma_f32_16x16x32_bf16 v[48:51], v[96:99], v[88:91], v[48:51]
    v_mfma_f32_16x16x32_bf16 v[52:55], v[100:103], v[88:91], v[52:55]
    v_mfma_f32_16x16x32_bf16 v[56:59], v[104:107], v[88:91], v[56:59]
    v_mfma_f32_16x16x32_bf16 v[60:63], v[108:111], v[88:91], v[60:63]
    v_mfma_f32_16x16x32_bf16 v[64:67], v[96:99], v[92:95], v[64:67]
    v_mfma_f32_16x16x32_bf16 v[68:71], v[100:103], v[92:95], v[68:71]
    v_mfma_f32_16x16x32_bf16 v[72:75], v[104:107], v[92:95], v[72:75]
    v_mfma_f32_16x16x32_bf16 v[76:79], v[108:111], v[92:95], v[76:79]
    s_waitcnt lgkmcnt(0)
    v_mfma_f32_16x16x32_bf16 v[16:19], v[128:131], v[112:115], v[16:19]
    v_mfma_f32_16x16x32_bf16 v[20:23], v[132:135], v[112:115], v[20:23]
    v_mfma_f32_16x16x32_bf16 v[24:27], v[136:139], v[112:115], v[24:27]
    v_mfma_f32_16x16x32_bf16 v[28:31], v[140:143], v[112:115], v[28:31]
    v_mfma_f32_16x16x32_bf16 v[32:35], v[128:131], v[116:119], v[32:35]
    v_mfma_f32_16x16x32_bf16 v[36:39], v[132:135], v[116:119], v[36:39]
    v_mfma_f32_16x16x32_bf16 v[40:43], v[136:139], v[116:119], v[40:43]
    v_mfma_f32_16x16x32_bf16 v[44:47], v[140:143], v[116:119], v[44:47]
    v_mfma_f32_16x16x32_bf16 v[48:51], v[128:131], v[120:123], v[48:51]
    v_mfma_f32_16x16x32_bf16 v[52:55], v[132:135], v[120:123], v[52:55]
    v_mfma_f32_16x16x32_bf16 v[56:59], v[136:139], v[120:123], v[56:59]
    v_mfma_f32_16x16x32_bf16 v[60:63], v[140:143], v[120:123], v[60:63]
    v_mfma_f32_16x16x32_bf16 v[64:67], v[128:131], v[124:127], v[64:67]
    v_mfma_f32_16x16x32_bf16 v[68:71], v[132:135], v[124:127], v[68:71]
    v_mfma_f32_16x16x32_bf16 v[72:75], v[136:139], v[124:127], v[72:75]
    v_mfma_f32_16x16x32_bf16 v[76:79], v[140:143], v[124:127], v[76:79]
    s_waitcnt vmcnt(8)
    ds_write_b128 v8, v[176:179] offset:36864
    ds_write_b128 v8, v[180:183] offset:41472
    ds_write_b128 v8, v[184:187] offset:46080
    ds_write_b128 v8, v[188:191] offset:50688
    ds_write_b128 v11, v[192:195] offset:36864
    ds_write_b128 v11, v[196:199] offset:41472
    ds_write_b128 v11, v[200:203] offset:46080
    ds_write_b128 v11, v[204:207] offset:50688
    s_waitcnt lgkmcnt(0)
    s_barrier
    buffer_load_dwordx4 v[176:179], v7, s[40:43], s64 offen
    buffer_load_dwordx4 v[180:183], v7, s[40:43], s65 offen
    buffer_load_dwordx4 v[184:187], v7, s[40:43], s66 offen
    buffer_load_dwordx4 v[188:191], v7, s[40:43], s67 offen
    buffer_load_dwordx4 v[192:195], v10, s[60:63], s68 offen
    buffer_load_dwordx4 v[196:199], v10, s[60:63], s69 offen
    buffer_load_dwordx4 v[200:203], v10, s[60:63], s70 offen
    buffer_load_dwordx4 v[204:207], v10, s[60:63], s71 offen
    v_add_u32 v7, 128, v7
    v_add_u32 v10, 221184, v10
    ds_read_b64_tr_b16 v[96:97], v13 offset:36864
    ds_read_b64_tr_b16 v[98:99], v13 offset:41472
    ds_read_b64_tr_b16 v[100:101], v13 offset:36896
    ds_read_b64_tr_b16 v[102:103], v13 offset:41504
    ds_read_b64_tr_b16 v[104:105], v13 offset:36992
    ds_read_b64_tr_b16 v[106:107], v13 offset:41600
    ds_read_b64_tr_b16 v[108:109], v13 offset:37024
    ds_read_b64_tr_b16 v[110:111], v13 offset:41632
    ds_read_b64 v[80:81], v12 offset:36864
    ds_read_b64 v[82:83], v12 offset:36896
    ds_read_b64 v[84:85], v12 offset:39168
    ds_read_b64 v[86:87], v12 offset:39200
    ds_read_b64 v[88:89], v12 offset:41472
    ds_read_b64 v[90:91], v12 offset:41504
    ds_read_b64 v[92:93], v12 offset:43776
    ds_read_b64 v[94:95], v12 offset:43808
    s_waitcnt lgkmcnt(0)
    ds_read_b64_tr_b16 v[128:129], v13 offset:46080
    ds_read_b64_tr_b16 v[130:131], v13 offset:50688
    ds_read_b64_tr_b16 v[132:133], v13 offset:46112
    ds_read_b64_tr_b16 v[134:135], v13 offset:50720
    ds_read_b64_tr_b16 v[136:137], v13 offset:46208
    ds_read_b64_tr_b16 v[138:139], v13 offset:50816
    ds_read_b64_tr_b16 v[140:141], v13 offset:46240
    ds_read_b64_tr_b16 v[142:143], v13 offset:50848
    ds_read_b64 v[112:113], v12 offset:36928
    ds_read_b64 v[114:115], v12 offset:36960
    ds_read_b64 v[116:117], v12 offset:39232
    ds_read_b64 v[118:119], v12 offset:39264
    ds_read_b64 v[120:121], v12 offset:41536
    ds_read_b64 v[122:123], v12 offset:41568
    ds_read_b64 v[124:125], v12 offset:43840
    ds_read_b64 v[126:127], v12 offset:43872
    v_mfma_f32_16x16x32_bf16 v[16:19], v[96:99], v[80:83], v[16:19]
    v_mfma_f32_16x16x32_bf16 v[20:23], v[100:103], v[80:83], v[20:23]
    v_mfma_f32_16x16x32_bf16 v[24:27], v[104:107], v[80:83], v[24:27]
    v_mfma_f32_16x16x32_bf16 v[28:31], v[108:111], v[80:83], v[28:31]
    v_mfma_f32_16x16x32_bf16 v[32:35], v[96:99], v[84:87], v[32:35]
    v_mfma_f32_16x16x32_bf16 v[36:39], v[100:103], v[84:87], v[36:39]
    v_mfma_f32_16x16x32_bf16 v[40:43], v[104:107], v[84:87], v[40:43]
    v_mfma_f32_16x16x32_bf16 v[44:47], v[108:111], v[84:87], v[44:47]
    v_mfma_f32_16x16x32_bf16 v[48:51], v[96:99], v[88:91], v[48:51]
    v_mfma_f32_16x16x32_bf16 v[52:55], v[100:103], v[88:91], v[52:55]
    v_mfma_f32_16x16x32_bf16 v[56:59], v[104:107], v[88:91], v[56:59]
    v_mfma_f32_16x16x32_bf16 v[60:63], v[108:111], v[88:91], v[60:63]
    v_mfma_f32_16x16x32_bf16 v[64:67], v[96:99], v[92:95], v[64:67]
    v_mfma_f32_16x16x32_bf16 v[68:71], v[100:103], v[92:95], v[68:71]
    v_mfma_f32_16x16x32_bf16 v[72:75], v[104:107], v[92:95], v[72:75]
    v_mfma_f32_16x16x32_bf16 v[76:79], v[108:111], v[92:95], v[76:79]
    s_waitcnt lgkmcnt(0)
    v_mfma_f32_16x16x32_bf16 v[16:19], v[128:131], v[112:115], v[16:19]
    v_mfma_f32_16x16x32_bf16 v[20:23], v[132:135], v[112:115], v[20:23]
    v_mfma_f32_16x16x32_bf16 v[24:27], v[136:139], v[112:115], v[24:27]
    v_mfma_f32_16x16x32_bf16 v[28:31], v[140:143], v[112:115], v[28:31]
    v_mfma_f32_16x16x32_bf16 v[32:35], v[128:131], v[116:119], v[32:35]
    v_mfma_f32_16x16x32_bf16 v[36:39], v[132:135], v[116:119], v[36:39]
    v_mfma_f32_16x16x32_bf16 v[40:43], v[136:139], v[116:119], v[40:43]
    v_mfma_f32_16x16x32_bf16 v[44:47], v[140:143], v[116:119], v[44:47]
    v_mfma_f32_16x16x32_bf16 v[48:51], v[128:131], v[120:123], v[48:51]
    v_mfma_f32_16x16x32_bf16 v[52:55], v[132:135], v[120:123], v[52:55]
    v_mfma_f32_16x16x32_bf16 v[56:59], v[136:139], v[120:123], v[56:59]
    v_mfma_f32_16x16x32_bf16 v[60:63], v[140:143], v[120:123], v[60:63]
    v_mfma_f32_16x16x32_bf16 v[64:67], v[128:131], v[124:127], v[64:67]
    v_mfma_f32_16x16x32_bf16 v[68:71], v[132:135], v[124:127], v[68:71]
    v_mfma_f32_16x16x32_bf16 v[72:75], v[136:139], v[124:127], v[72:75]
    v_mfma_f32_16x16x32_bf16 v[76:79], v[140:143], v[124:127], v[76:79]
    s_waitcnt vmcnt(8)
    ds_write_b128 v8, v[144:147] offset:0
    ds_write_b128 v8, v[148:151] offset:4608
    ds_write_b128 v8, v[152:155] offset:9216
    ds_write_b128 v8, v[156:159] offset:13824
    ds_write_b128 v11, v[160:163] offset:0
    ds_write_b128 v11, v[164:167] offset:4608
    ds_write_b128 v11, v[168:171] offset:9216
    ds_write_b128 v11, v[172:175] offset:13824
    s_waitcnt lgkmcnt(0)
    s_barrier
    buffer_load_dwordx4 v[144:147], v7, s[40:43], s64 offen
    buffer_load_dwordx4 v[148:151], v7, s[40:43], s65 offen
    buffer_load_dwordx4 v[152:155], v7, s[40:43], s66 offen
    buffer_load_dwordx4 v[156:159], v7, s[40:43], s67 offen
    buffer_load_dwordx4 v[160:163], v10, s[60:63], s68 offen
    buffer_load_dwordx4 v[164:167], v10, s[60:63], s69 offen
    buffer_load_dwordx4 v[168:171], v10, s[60:63], s70 offen
    buffer_load_dwordx4 v[172:175], v10, s[60:63], s71 offen
    v_add_u32 v7, 128, v7
    v_add_u32 v10, 221184, v10
    ds_read_b64_tr_b16 v[96:97], v13 offset:0
    ds_read_b64_tr_b16 v[98:99], v13 offset:4608
    ds_read_b64_tr_b16 v[100:101], v13 offset:32
    ds_read_b64_tr_b16 v[102:103], v13 offset:4640
    ds_read_b64_tr_b16 v[104:105], v13 offset:128
    ds_read_b64_tr_b16 v[106:107], v13 offset:4736
    ds_read_b64_tr_b16 v[108:109], v13 offset:160
    ds_read_b64_tr_b16 v[110:111], v13 offset:4768
    ds_read_b64 v[80:81], v12 offset:0
    ds_read_b64 v[82:83], v12 offset:32
    ds_read_b64 v[84:85], v12 offset:2304
    ds_read_b64 v[86:87], v12 offset:2336
    ds_read_b64 v[88:89], v12 offset:4608
    ds_read_b64 v[90:91], v12 offset:4640
    ds_read_b64 v[92:93], v12 offset:6912
    ds_read_b64 v[94:95], v12 offset:6944
    s_waitcnt lgkmcnt(0)
    ds_read_b64_tr_b16 v[128:129], v13 offset:9216
    ds_read_b64_tr_b16 v[130:131], v13 offset:13824
    ds_read_b64_tr_b16 v[132:133], v13 offset:9248
    ds_read_b64_tr_b16 v[134:135], v13 offset:13856
    ds_read_b64_tr_b16 v[136:137], v13 offset:9344
    ds_read_b64_tr_b16 v[138:139], v13 offset:13952
    ds_read_b64_tr_b16 v[140:141], v13 offset:9376
    ds_read_b64_tr_b16 v[142:143], v13 offset:13984
    ds_read_b64 v[112:113], v12 offset:64
    ds_read_b64 v[114:115], v12 offset:96
    ds_read_b64 v[116:117], v12 offset:2368
    ds_read_b64 v[118:119], v12 offset:2400
    ds_read_b64 v[120:121], v12 offset:4672
    ds_read_b64 v[122:123], v12 offset:4704
    ds_read_b64 v[124:125], v12 offset:6976
    ds_read_b64 v[126:127], v12 offset:7008
    v_mfma_f32_16x16x32_bf16 v[16:19], v[96:99], v[80:83], v[16:19]
    v_mfma_f32_16x16x32_bf16 v[20:23], v[100:103], v[80:83], v[20:23]
    v_mfma_f32_16x16x32_bf16 v[24:27], v[104:107], v[80:83], v[24:27]
    v_mfma_f32_16x16x32_bf16 v[28:31], v[108:111], v[80:83], v[28:31]
    v_mfma_f32_16x16x32_bf16 v[32:35], v[96:99], v[84:87], v[32:35]
    v_mfma_f32_16x16x32_bf16 v[36:39], v[100:103], v[84:87], v[36:39]
    v_mfma_f32_16x16x32_bf16 v[40:43], v[104:107], v[84:87], v[40:43]
    v_mfma_f32_16x16x32_bf16 v[44:47], v[108:111], v[84:87], v[44:47]
    v_mfma_f32_16x16x32_bf16 v[48:51], v[96:99], v[88:91], v[48:51]
    v_mfma_f32_16x16x32_bf16 v[52:55], v[100:103], v[88:91], v[52:55]
    v_mfma_f32_16x16x32_bf16 v[56:59], v[104:107], v[88:91], v[56:59]
    v_mfma_f32_16x16x32_bf16 v[60:63], v[108:111], v[88:91], v[60:63]
    v_mfma_f32_16x16x32_bf16 v[64:67], v[96:99], v[92:95], v[64:67]
    v_mfma_f32_16x16x32_bf16 v[68:71], v[100:103], v[92:95], v[68:71]
    v_mfma_f32_16x16x32_bf16 v[72:75], v[104:107], v[92:95], v[72:75]
    v_mfma_f32_16x16x32_bf16 v[76:79], v[108:111], v[92:95], v[76:79]
    s_waitcnt lgkmcnt(0)
    v_mfma_f32_16x16x32_bf16 v[16:19], v[128:131], v[112:115], v[16:19]
    v_mfma_f32_16x16x32_bf16 v[20:23], v[132:135], v[112:115], v[20:23]
    v_mfma_f32_16x16x32_bf16 v[24:27], v[136:139], v[112:115], v[24:27]
    v_mfma_f32_16x16x32_bf16 v[28:31], v[140:143], v[112:115], v[28:31]
    v_mfma_f32_16x16x32_bf16 v[32:35], v[128:131], v[116:119], v[32:35]
    v_mfma_f32_16x16x32_bf16 v[36:39], v[132:135], v[116:119], v[36:39]
    v_mfma_f32_16x16x32_bf16 v[40:43], v[136:139], v[116:119], v[40:43]
    v_mfma_f32_16x16x32_bf16 v[44:47], v[140:143], v[116:119], v[44:47]
    v_mfma_f32_16x16x32_bf16 v[48:51], v[128:131], v[120:123], v[48:51]
    v_mfma_f32_16x16x32_bf16 v[52:55], v[132:135], v[120:123], v[52:55]
    v_mfma_f32_16x16x32_bf16 v[56:59], v[136:139], v[120:123], v[56:59]
    v_mfma_f32_16x16x32_bf16 v[60:63], v[140:143], v[120:123], v[60:63]
    v_mfma_f32_16x16x32_bf16 v[64:67], v[128:131], v[124:127], v[64:67]
    v_mfma_f32_16x16x32_bf16 v[68:71], v[132:135], v[124:127], v[68:71]
    v_mfma_f32_16x16x32_bf16 v[72:75], v[136:139], v[124:127], v[72:75]
    v_mfma_f32_16x16x32_bf16 v[76:79], v[140:143], v[124:127], v[76:79]
    s_waitcnt vmcnt(8)
    ds_write_b128 v8, v[176:179] offset:36864
    ds_write_b128 v8, v[180:183] offset:41472
    ds_write_b128 v8, v[184:187] offset:46080
    ds_write_b128 v8, v[188:191] offset:50688
    ds_write_b128 v11, v[192:195] offset:36864
    ds_write_b128 v11, v[196:199] offset:41472
    ds_write_b128 v11, v[200:203] offset:46080
    ds_write_b128 v11, v[204:207] offset:50688
    s_waitcnt lgkmcnt(0)
    s_barrier
    buffer_load_dwordx4 v[176:179], v7, s[40:43], s64 offen
    buffer_load_dwordx4 v[180:183], v7, s[40:43], s65 offen
    buffer_load_dwordx4 v[184:187], v7, s[40:43], s66 offen
    buffer_load_dwordx4 v[188:191], v7, s[40:43], s67 offen
    buffer_load_dwordx4 v[192:195], v10, s[60:63], s68 offen
    buffer_load_dwordx4 v[196:199], v10, s[60:63], s69 offen
    buffer_load_dwordx4 v[200:203], v10, s[60:63], s70 offen
    buffer_load_dwordx4 v[204:207], v10, s[60:63], s71 offen
    v_add_u32 v7, 128, v7
    v_add_u32 v10, 221184, v10
    ds_read_b64_tr_b16 v[96:97], v13 offset:36864
    ds_read_b64_tr_b16 v[98:99], v13 offset:41472
    ds_read_b64_tr_b16 v[100:101], v13 offset:36896
    ds_read_b64_tr_b16 v[102:103], v13 offset:41504
    ds_read_b64_tr_b16 v[104:105], v13 offset:36992
    ds_read_b64_tr_b16 v[106:107], v13 offset:41600
    ds_read_b64_tr_b16 v[108:109], v13 offset:37024
    ds_read_b64_tr_b16 v[110:111], v13 offset:41632
    ds_read_b64 v[80:81], v12 offset:36864
    ds_read_b64 v[82:83], v12 offset:36896
    ds_read_b64 v[84:85], v12 offset:39168
    ds_read_b64 v[86:87], v12 offset:39200
    ds_read_b64 v[88:89], v12 offset:41472
    ds_read_b64 v[90:91], v12 offset:41504
    ds_read_b64 v[92:93], v12 offset:43776
    ds_read_b64 v[94:95], v12 offset:43808
    s_waitcnt lgkmcnt(0)
    ds_read_b64_tr_b16 v[128:129], v13 offset:46080
    ds_read_b64_tr_b16 v[130:131], v13 offset:50688
    ds_read_b64_tr_b16 v[132:133], v13 offset:46112
    ds_read_b64_tr_b16 v[134:135], v13 offset:50720
    ds_read_b64_tr_b16 v[136:137], v13 offset:46208
    ds_read_b64_tr_b16 v[138:139], v13 offset:50816
    ds_read_b64_tr_b16 v[140:141], v13 offset:46240
    ds_read_b64_tr_b16 v[142:143], v13 offset:50848
    ds_read_b64 v[112:113], v12 offset:36928
    ds_read_b64 v[114:115], v12 offset:36960
    ds_read_b64 v[116:117], v12 offset:39232
    ds_read_b64 v[118:119], v12 offset:39264
    ds_read_b64 v[120:121], v12 offset:41536
    ds_read_b64 v[122:123], v12 offset:41568
    ds_read_b64 v[124:125], v12 offset:43840
    ds_read_b64 v[126:127], v12 offset:43872
    v_mfma_f32_16x16x32_bf16 v[16:19], v[96:99], v[80:83], v[16:19]
    v_mfma_f32_16x16x32_bf16 v[20:23], v[100:103], v[80:83], v[20:23]
    v_mfma_f32_16x16x32_bf16 v[24:27], v[104:107], v[80:83], v[24:27]
    v_mfma_f32_16x16x32_bf16 v[28:31], v[108:111], v[80:83], v[28:31]
    v_mfma_f32_16x16x32_bf16 v[32:35], v[96:99], v[84:87], v[32:35]
    v_mfma_f32_16x16x32_bf16 v[36:39], v[100:103], v[84:87], v[36:39]
    v_mfma_f32_16x16x32_bf16 v[40:43], v[104:107], v[84:87], v[40:43]
    v_mfma_f32_16x16x32_bf16 v[44:47], v[108:111], v[84:87], v[44:47]
    v_mfma_f32_16x16x32_bf16 v[48:51], v[96:99], v[88:91], v[48:51]
    v_mfma_f32_16x16x32_bf16 v[52:55], v[100:103], v[88:91], v[52:55]
    v_mfma_f32_16x16x32_bf16 v[56:59], v[104:107], v[88:91], v[56:59]
    v_mfma_f32_16x16x32_bf16 v[60:63], v[108:111], v[88:91], v[60:63]
    v_mfma_f32_16x16x32_bf16 v[64:67], v[96:99], v[92:95], v[64:67]
    v_mfma_f32_16x16x32_bf16 v[68:71], v[100:103], v[92:95], v[68:71]
    v_mfma_f32_16x16x32_bf16 v[72:75], v[104:107], v[92:95], v[72:75]
    v_mfma_f32_16x16x32_bf16 v[76:79], v[108:111], v[92:95], v[76:79]
    s_waitcnt lgkmcnt(0)
    v_mfma_f32_16x16x32_bf16 v[16:19], v[128:131], v[112:115], v[16:19]
    v_mfma_f32_16x16x32_bf16 v[20:23], v[132:135], v[112:115], v[20:23]
    v_mfma_f32_16x16x32_bf16 v[24:27], v[136:139], v[112:115], v[24:27]
    v_mfma_f32_16x16x32_bf16 v[28:31], v[140:143], v[112:115], v[28:31]
    v_mfma_f32_16x16x32_bf16 v[32:35], v[128:131], v[116:119], v[32:35]
    v_mfma_f32_16x16x32_bf16 v[36:39], v[132:135], v[116:119], v[36:39]
    v_mfma_f32_16x16x32_bf16 v[40:43], v[136:139], v[116:119], v[40:43]
    v_mfma_f32_16x16x32_bf16 v[44:47], v[140:143], v[116:119], v[44:47]
    v_mfma_f32_16x16x32_bf16 v[48:51], v[128:131], v[120:123], v[48:51]
    v_mfma_f32_16x16x32_bf16 v[52:55], v[132:135], v[120:123], v[52:55]
    v_mfma_f32_16x16x32_bf16 v[56:59], v[136:139], v[120:123], v[56:59]
    v_mfma_f32_16x16x32_bf16 v[60:63], v[140:143], v[120:123], v[60:63]
    v_mfma_f32_16x16x32_bf16 v[64:67], v[128:131], v[124:127], v[64:67]
    v_mfma_f32_16x16x32_bf16 v[68:71], v[132:135], v[124:127], v[68:71]
    v_mfma_f32_16x16x32_bf16 v[72:75], v[136:139], v[124:127], v[72:75]
    v_mfma_f32_16x16x32_bf16 v[76:79], v[140:143], v[124:127], v[76:79]
    s_waitcnt vmcnt(8)
    ds_write_b128 v8, v[144:147] offset:0
    ds_write_b128 v8, v[148:151] offset:4608
    ds_write_b128 v8, v[152:155] offset:9216
    ds_write_b128 v8, v[156:159] offset:13824
    ds_write_b128 v11, v[160:163] offset:0
    ds_write_b128 v11, v[164:167] offset:4608
    ds_write_b128 v11, v[168:171] offset:9216
    ds_write_b128 v11, v[172:175] offset:13824
    s_waitcnt lgkmcnt(0)
    s_barrier
    ds_read_b64_tr_b16 v[96:97], v13 offset:0
    ds_read_b64_tr_b16 v[98:99], v13 offset:4608
    ds_read_b64_tr_b16 v[100:101], v13 offset:32
    ds_read_b64_tr_b16 v[102:103], v13 offset:4640
    ds_read_b64_tr_b16 v[104:105], v13 offset:128
    ds_read_b64_tr_b16 v[106:107], v13 offset:4736
    ds_read_b64_tr_b16 v[108:109], v13 offset:160
    ds_read_b64_tr_b16 v[110:111], v13 offset:4768
    ds_read_b64 v[80:81], v12 offset:0
    ds_read_b64 v[82:83], v12 offset:32
    ds_read_b64 v[84:85], v12 offset:2304
    ds_read_b64 v[86:87], v12 offset:2336
    ds_read_b64 v[88:89], v12 offset:4608
    ds_read_b64 v[90:91], v12 offset:4640
    ds_read_b64 v[92:93], v12 offset:6912
    ds_read_b64 v[94:95], v12 offset:6944
    s_waitcnt lgkmcnt(0)
    ds_read_b64_tr_b16 v[128:129], v13 offset:9216
    ds_read_b64_tr_b16 v[130:131], v13 offset:13824
    ds_read_b64_tr_b16 v[132:133], v13 offset:9248
    ds_read_b64_tr_b16 v[134:135], v13 offset:13856
    ds_read_b64_tr_b16 v[136:137], v13 offset:9344
    ds_read_b64_tr_b16 v[138:139], v13 offset:13952
    ds_read_b64_tr_b16 v[140:141], v13 offset:9376
    ds_read_b64_tr_b16 v[142:143], v13 offset:13984
    ds_read_b64 v[112:113], v12 offset:64
    ds_read_b64 v[114:115], v12 offset:96
    ds_read_b64 v[116:117], v12 offset:2368
    ds_read_b64 v[118:119], v12 offset:2400
    ds_read_b64 v[120:121], v12 offset:4672
    ds_read_b64 v[122:123], v12 offset:4704
    ds_read_b64 v[124:125], v12 offset:6976
    ds_read_b64 v[126:127], v12 offset:7008
    v_mfma_f32_16x16x32_bf16 v[16:19], v[96:99], v[80:83], v[16:19]
    v_mfma_f32_16x16x32_bf16 v[20:23], v[100:103], v[80:83], v[20:23]
    v_mfma_f32_16x16x32_bf16 v[24:27], v[104:107], v[80:83], v[24:27]
    v_mfma_f32_16x16x32_bf16 v[28:31], v[108:111], v[80:83], v[28:31]
    v_mfma_f32_16x16x32_bf16 v[32:35], v[96:99], v[84:87], v[32:35]
    v_mfma_f32_16x16x32_bf16 v[36:39], v[100:103], v[84:87], v[36:39]
    v_mfma_f32_16x16x32_bf16 v[40:43], v[104:107], v[84:87], v[40:43]
    v_mfma_f32_16x16x32_bf16 v[44:47], v[108:111], v[84:87], v[44:47]
    v_mfma_f32_16x16x32_bf16 v[48:51], v[96:99], v[88:91], v[48:51]
    v_mfma_f32_16x16x32_bf16 v[52:55], v[100:103], v[88:91], v[52:55]
    v_mfma_f32_16x16x32_bf16 v[56:59], v[104:107], v[88:91], v[56:59]
    v_mfma_f32_16x16x32_bf16 v[60:63], v[108:111], v[88:91], v[60:63]
    v_mfma_f32_16x16x32_bf16 v[64:67], v[96:99], v[92:95], v[64:67]
    v_mfma_f32_16x16x32_bf16 v[68:71], v[100:103], v[92:95], v[68:71]
    v_mfma_f32_16x16x32_bf16 v[72:75], v[104:107], v[92:95], v[72:75]
    v_mfma_f32_16x16x32_bf16 v[76:79], v[108:111], v[92:95], v[76:79]
    s_waitcnt lgkmcnt(0)
    v_mfma_f32_16x16x32_bf16 v[16:19], v[128:131], v[112:115], v[16:19]
    v_mfma_f32_16x16x32_bf16 v[20:23], v[132:135], v[112:115], v[20:23]
    v_mfma_f32_16x16x32_bf16 v[24:27], v[136:139], v[112:115], v[24:27]
    v_mfma_f32_16x16x32_bf16 v[28:31], v[140:143], v[112:115], v[28:31]
    v_mfma_f32_16x16x32_bf16 v[32:35], v[128:131], v[116:119], v[32:35]
    v_mfma_f32_16x16x32_bf16 v[36:39], v[132:135], v[116:119], v[36:39]
    v_mfma_f32_16x16x32_bf16 v[40:43], v[136:139], v[116:119], v[40:43]
    v_mfma_f32_16x16x32_bf16 v[44:47], v[140:143], v[116:119], v[44:47]
    v_mfma_f32_16x16x32_bf16 v[48:51], v[128:131], v[120:123], v[48:51]
    v_mfma_f32_16x16x32_bf16 v[52:55], v[132:135], v[120:123], v[52:55]
    v_mfma_f32_16x16x32_bf16 v[56:59], v[136:139], v[120:123], v[56:59]
    v_mfma_f32_16x16x32_bf16 v[60:63], v[140:143], v[120:123], v[60:63]
    v_mfma_f32_16x16x32_bf16 v[64:67], v[128:131], v[124:127], v[64:67]
    v_mfma_f32_16x16x32_bf16 v[68:71], v[132:135], v[124:127], v[68:71]
    v_mfma_f32_16x16x32_bf16 v[72:75], v[136:139], v[124:127], v[72:75]
    v_mfma_f32_16x16x32_bf16 v[76:79], v[140:143], v[124:127], v[76:79]
    s_waitcnt vmcnt(0)
    ds_write_b128 v8, v[176:179] offset:36864
    ds_write_b128 v8, v[180:183] offset:41472
    ds_write_b128 v8, v[184:187] offset:46080
    ds_write_b128 v8, v[188:191] offset:50688
    ds_write_b128 v11, v[192:195] offset:36864
    ds_write_b128 v11, v[196:199] offset:41472
    ds_write_b128 v11, v[200:203] offset:46080
    ds_write_b128 v11, v[204:207] offset:50688
    s_waitcnt lgkmcnt(0)
    s_barrier
    ds_read_b64_tr_b16 v[96:97], v13 offset:36864
    ds_read_b64_tr_b16 v[98:99], v13 offset:41472
    ds_read_b64_tr_b16 v[100:101], v13 offset:36896
    ds_read_b64_tr_b16 v[102:103], v13 offset:41504
    ds_read_b64_tr_b16 v[104:105], v13 offset:36992
    ds_read_b64_tr_b16 v[106:107], v13 offset:41600
    ds_read_b64_tr_b16 v[108:109], v13 offset:37024
    ds_read_b64_tr_b16 v[110:111], v13 offset:41632
    ds_read_b64 v[80:81], v12 offset:36864
    ds_read_b64 v[82:83], v12 offset:36896
    ds_read_b64 v[84:85], v12 offset:39168
    ds_read_b64 v[86:87], v12 offset:39200
    ds_read_b64 v[88:89], v12 offset:41472
    ds_read_b64 v[90:91], v12 offset:41504
    ds_read_b64 v[92:93], v12 offset:43776
    ds_read_b64 v[94:95], v12 offset:43808
    s_waitcnt lgkmcnt(0)
    ds_read_b64_tr_b16 v[128:129], v13 offset:46080
    ds_read_b64_tr_b16 v[130:131], v13 offset:50688
    ds_read_b64_tr_b16 v[132:133], v13 offset:46112
    ds_read_b64_tr_b16 v[134:135], v13 offset:50720
    ds_read_b64_tr_b16 v[136:137], v13 offset:46208
    ds_read_b64_tr_b16 v[138:139], v13 offset:50816
    ds_read_b64_tr_b16 v[140:141], v13 offset:46240
    ds_read_b64_tr_b16 v[142:143], v13 offset:50848
    ds_read_b64 v[112:113], v12 offset:36928
    ds_read_b64 v[114:115], v12 offset:36960
    ds_read_b64 v[116:117], v12 offset:39232
    ds_read_b64 v[118:119], v12 offset:39264
    ds_read_b64 v[120:121], v12 offset:41536
    ds_read_b64 v[122:123], v12 offset:41568
    ds_read_b64 v[124:125], v12 offset:43840
    ds_read_b64 v[126:127], v12 offset:43872
    v_mfma_f32_16x16x32_bf16 v[16:19], v[96:99], v[80:83], v[16:19]
    v_mfma_f32_16x16x32_bf16 v[20:23], v[100:103], v[80:83], v[20:23]
    v_mfma_f32_16x16x32_bf16 v[24:27], v[104:107], v[80:83], v[24:27]
    v_mfma_f32_16x16x32_bf16 v[28:31], v[108:111], v[80:83], v[28:31]
    v_mfma_f32_16x16x32_bf16 v[32:35], v[96:99], v[84:87], v[32:35]
    v_mfma_f32_16x16x32_bf16 v[36:39], v[100:103], v[84:87], v[36:39]
    v_mfma_f32_16x16x32_bf16 v[40:43], v[104:107], v[84:87], v[40:43]
    v_mfma_f32_16x16x32_bf16 v[44:47], v[108:111], v[84:87], v[44:47]
    v_mfma_f32_16x16x32_bf16 v[48:51], v[96:99], v[88:91], v[48:51]
    v_mfma_f32_16x16x32_bf16 v[52:55], v[100:103], v[88:91], v[52:55]
    v_mfma_f32_16x16x32_bf16 v[56:59], v[104:107], v[88:91], v[56:59]
    v_mfma_f32_16x16x32_bf16 v[60:63], v[108:111], v[88:91], v[60:63]
    v_mfma_f32_16x16x32_bf16 v[64:67], v[96:99], v[92:95], v[64:67]
    v_mfma_f32_16x16x32_bf16 v[68:71], v[100:103], v[92:95], v[68:71]
    v_mfma_f32_16x16x32_bf16 v[72:75], v[104:107], v[92:95], v[72:75]
    v_mfma_f32_16x16x32_bf16 v[76:79], v[108:111], v[92:95], v[76:79]
    s_waitcnt lgkmcnt(0)
    v_mfma_f32_16x16x32_bf16 v[16:19], v[128:131], v[112:115], v[16:19]
    v_mfma_f32_16x16x32_bf16 v[20:23], v[132:135], v[112:115], v[20:23]
    v_mfma_f32_16x16x32_bf16 v[24:27], v[136:139], v[112:115], v[24:27]
    v_mfma_f32_16x16x32_bf16 v[28:31], v[140:143], v[112:115], v[28:31]
    v_mfma_f32_16x16x32_bf16 v[32:35], v[128:131], v[116:119], v[32:35]
    v_mfma_f32_16x16x32_bf16 v[36:39], v[132:135], v[116:119], v[36:39]
    v_mfma_f32_16x16x32_bf16 v[40:43], v[136:139], v[116:119], v[40:43]
    v_mfma_f32_16x16x32_bf16 v[44:47], v[140:143], v[116:119], v[44:47]
    v_mfma_f32_16x16x32_bf16 v[48:51], v[128:131], v[120:123], v[48:51]
    v_mfma_f32_16x16x32_bf16 v[52:55], v[132:135], v[120:123], v[52:55]
    v_mfma_f32_16x16x32_bf16 v[56:59], v[136:139], v[120:123], v[56:59]
    v_mfma_f32_16x16x32_bf16 v[60:63], v[140:143], v[120:123], v[60:63]
    v_mfma_f32_16x16x32_bf16 v[64:67], v[128:131], v[124:127], v[64:67]
    v_mfma_f32_16x16x32_bf16 v[68:71], v[132:135], v[124:127], v[68:71]
    v_mfma_f32_16x16x32_bf16 v[72:75], v[136:139], v[124:127], v[72:75]
    v_mfma_f32_16x16x32_bf16 v[76:79], v[140:143], v[124:127], v[76:79]
    s_nop 7
    s_nop 7
    s_mul_i32 s7, s4, 128
    s_mul_i32 s12, s10, 64
    s_add_u32 s7, s7, s12
    v_add_u32 v5, s7, v3
    v_mul_u32_u24 v5, 3456, v5
    s_lshl_b32 s12, s5, 7
    s_lshl_b32 s13, s11, 6
    s_add_u32 s12, s12, s13
    v_lshl_add_u32 v5, v4, 3, v5
    v_add_u32 v5, s12, v5
    v_mov_b32 v6, 0x3d372713
    v_mul_f32 v144, v16, v16
    v_fma_f32 v144, v144, v6, 1.0
    v_mul_f32 v144, v144, v16
    v_mul_f32 v144, 0xc0135761, v144
    v_exp_f32 v144, v144
    s_nop 0
    v_add_f32 v144, 1.0, v144
    v_rcp_f32 v144, v144
    s_nop 0
    v_mul_f32 v144, v144, v16
    v_mul_f32 v144, v144, v24
    v_mul_f32 v145, v17, v17
    v_fma_f32 v145, v145, v6, 1.0
    v_mul_f32 v145, v145, v17
    v_mul_f32 v145, 0xc0135761, v145
    v_exp_f32 v145, v145
    s_nop 0
    v_add_f32 v145, 1.0, v145
    v_rcp_f32 v145, v145
    s_nop 0
    v_mul_f32 v145, v145, v17
    v_mul_f32 v145, v145, v25
    v_mul_f32 v146, v18, v18
    v_fma_f32 v146, v146, v6, 1.0
    v_mul_f32 v146, v146, v18
    v_mul_f32 v146, 0xc0135761, v146
    v_exp_f32 v146, v146
    s_nop 0
    v_add_f32 v146, 1.0, v146
    v_rcp_f32 v146, v146
    s_nop 0
    v_mul_f32 v146, v146, v18
    v_mul_f32 v146, v146, v26
    v_mul_f32 v147, v19, v19
    v_fma_f32 v147, v147, v6, 1.0
    v_mul_f32 v147, v147, v19
    v_mul_f32 v147, 0xc0135761, v147
    v_exp_f32 v147, v147
    s_nop 0
    v_add_f32 v147, 1.0, v147
    v_rcp_f32 v147, v147
    s_nop 0
    v_mul_f32 v147, v147, v19
    v_mul_f32 v147, v147, v27
    v_cvt_pk_bf16_f32 v148, v144, v145
    v_cvt_pk_bf16_f32 v149, v146, v147
    buffer_store_dwordx2 v[148:149], v5, s[52:55], 0 offen offset:0
    s_nop 1
    v_mul_f32 v144, v20, v20
    v_fma_f32 v144, v144, v6, 1.0
    v_mul_f32 v144, v144, v20
    v_mul_f32 v144, 0xc0135761, v144
    v_exp_f32 v144, v144
    s_nop 0
    v_add_f32 v144, 1.0, v144
    v_rcp_f32 v144, v144
    s_nop 0
    v_mul_f32 v144, v144, v20
    v_mul_f32 v144, v144, v28
    v_mul_f32 v145, v21, v21
    v_fma_f32 v145, v145, v6, 1.0
    v_mul_f32 v145, v145, v21
    v_mul_f32 v145, 0xc0135761, v145
    v_exp_f32 v145, v145
    s_nop 0
    v_add_f32 v145, 1.0, v145
    v_rcp_f32 v145, v145
    s_nop 0
    v_mul_f32 v145, v145, v21
    v_mul_f32 v145, v145, v29
    v_mul_f32 v146, v22, v22
    v_fma_f32 v146, v146, v6, 1.0
    v_mul_f32 v146, v146, v22
    v_mul_f32 v146, 0xc0135761, v146
    v_exp_f32 v146, v146
    s_nop 0
    v_add_f32 v146, 1.0, v146
    v_rcp_f32 v146, v146
    s_nop 0
    v_mul_f32 v146, v146, v22
    v_mul_f32 v146, v146, v30
    v_mul_f32 v147, v23, v23
    v_fma_f32 v147, v147, v6, 1.0
    v_mul_f32 v147, v147, v23
    v_mul_f32 v147, 0xc0135761, v147
    v_exp_f32 v147, v147
    s_nop 0
    v_add_f32 v147, 1.0, v147
    v_rcp_f32 v147, v147
    s_nop 0
    v_mul_f32 v147, v147, v23
    v_mul_f32 v147, v147, v31
    v_cvt_pk_bf16_f32 v148, v144, v145
    v_cvt_pk_bf16_f32 v149, v146, v147
    buffer_store_dwordx2 v[148:149], v5, s[52:55], 0 offen offset:32
    s_nop 1
    v_add_u32 v5, 55296, v5
    v_mul_f32 v144, v32, v32
    v_fma_f32 v144, v144, v6, 1.0
    v_mul_f32 v144, v144, v32
    v_mul_f32 v144, 0xc0135761, v144
    v_exp_f32 v144, v144
    s_nop 0
    v_add_f32 v144, 1.0, v144
    v_rcp_f32 v144, v144
    s_nop 0
    v_mul_f32 v144, v144, v32
    v_mul_f32 v144, v144, v40
    v_mul_f32 v145, v33, v33
    v_fma_f32 v145, v145, v6, 1.0
    v_mul_f32 v145, v145, v33
    v_mul_f32 v145, 0xc0135761, v145
    v_exp_f32 v145, v145
    s_nop 0
    v_add_f32 v145, 1.0, v145
    v_rcp_f32 v145, v145
    s_nop 0
    v_mul_f32 v145, v145, v33
    v_mul_f32 v145, v145, v41
    v_mul_f32 v146, v34, v34
    v_fma_f32 v146, v146, v6, 1.0
    v_mul_f32 v146, v146, v34
    v_mul_f32 v146, 0xc0135761, v146
    v_exp_f32 v146, v146
    s_nop 0
    v_add_f32 v146, 1.0, v146
    v_rcp_f32 v146, v146
    s_nop 0
    v_mul_f32 v146, v146, v34
    v_mul_f32 v146, v146, v42
    v_mul_f32 v147, v35, v35
    v_fma_f32 v147, v147, v6, 1.0
    v_mul_f32 v147, v147, v35
    v_mul_f32 v147, 0xc0135761, v147
    v_exp_f32 v147, v147
    s_nop 0
    v_add_f32 v147, 1.0, v147
    v_rcp_f32 v147, v147
    s_nop 0
    v_mul_f32 v147, v147, v35
    v_mul_f32 v147, v147, v43
    v_cvt_pk_bf16_f32 v148, v144, v145
    v_cvt_pk_bf16_f32 v149, v146, v147
    buffer_store_dwordx2 v[148:149], v5, s[52:55], 0 offen offset:0
    s_nop 1
    v_mul_f32 v144, v36, v36
    v_fma_f32 v144, v144, v6, 1.0
    v_mul_f32 v144, v144, v36
    v_mul_f32 v144, 0xc0135761, v144
    v_exp_f32 v144, v144
    s_nop 0
    v_add_f32 v144, 1.0, v144
    v_rcp_f32 v144, v144
    s_nop 0
    v_mul_f32 v144, v144, v36
    v_mul_f32 v144, v144, v44
    v_mul_f32 v145, v37, v37
    v_fma_f32 v145, v145, v6, 1.0
    v_mul_f32 v145, v145, v37
    v_mul_f32 v145, 0xc0135761, v145
    v_exp_f32 v145, v145
    s_nop 0
    v_add_f32 v145, 1.0, v145
    v_rcp_f32 v145, v145
    s_nop 0
    v_mul_f32 v145, v145, v37
    v_mul_f32 v145, v145, v45
    v_mul_f32 v146, v38, v38
    v_fma_f32 v146, v146, v6, 1.0
    v_mul_f32 v146, v146, v38
    v_mul_f32 v146, 0xc0135761, v146
    v_exp_f32 v146, v146
    s_nop 0
    v_add_f32 v146, 1.0, v146
    v_rcp_f32 v146, v146
    s_nop 0
    v_mul_f32 v146, v146, v38
    v_mul_f32 v146, v146, v46
    v_mul_f32 v147, v39, v39
    v_fma_f32 v147, v147, v6, 1.0
    v_mul_f32 v147, v147, v39
    v_mul_f32 v147, 0xc0135761, v147
    v_exp_f32 v147, v147
    s_nop 0
    v_add_f32 v147, 1.0, v147
    v_rcp_f32 v147, v147
    s_nop 0
    v_mul_f32 v147, v147, v39
    v_mul_f32 v147, v147, v47
    v_cvt_pk_bf16_f32 v148, v144, v145
    v_cvt_pk_bf16_f32 v149, v146, v147
    buffer_store_dwordx2 v[148:149], v5, s[52:55], 0 offen offset:32
    s_nop 1
    v_add_u32 v5, 55296, v5
    v_mul_f32 v144, v48, v48
    v_fma_f32 v144, v144, v6, 1.0
    v_mul_f32 v144, v144, v48
    v_mul_f32 v144, 0xc0135761, v144
    v_exp_f32 v144, v144
    s_nop 0
    v_add_f32 v144, 1.0, v144
    v_rcp_f32 v144, v144
    s_nop 0
    v_mul_f32 v144, v144, v48
    v_mul_f32 v144, v144, v56
    v_mul_f32 v145, v49, v49
    v_fma_f32 v145, v145, v6, 1.0
    v_mul_f32 v145, v145, v49
    v_mul_f32 v145, 0xc0135761, v145
    v_exp_f32 v145, v145
    s_nop 0
    v_add_f32 v145, 1.0, v145
    v_rcp_f32 v145, v145
    s_nop 0
    v_mul_f32 v145, v145, v49
    v_mul_f32 v145, v145, v57
    v_mul_f32 v146, v50, v50
    v_fma_f32 v146, v146, v6, 1.0
    v_mul_f32 v146, v146, v50
    v_mul_f32 v146, 0xc0135761, v146
    v_exp_f32 v146, v146
    s_nop 0
    v_add_f32 v146, 1.0, v146
    v_rcp_f32 v146, v146
    s_nop 0
    v_mul_f32 v146, v146, v50
    v_mul_f32 v146, v146, v58
    v_mul_f32 v147, v51, v51
    v_fma_f32 v147, v147, v6, 1.0
    v_mul_f32 v147, v147, v51
    v_mul_f32 v147, 0xc0135761, v147
    v_exp_f32 v147, v147
    s_nop 0
    v_add_f32 v147, 1.0, v147
    v_rcp_f32 v147, v147
    s_nop 0
    v_mul_f32 v147, v147, v51
    v_mul_f32 v147, v147, v59
    v_cvt_pk_bf16_f32 v148, v144, v145
    v_cvt_pk_bf16_f32 v149, v146, v147
    buffer_store_dwordx2 v[148:149], v5, s[52:55], 0 offen offset:0
    s_nop 1
    v_mul_f32 v144, v52, v52
    v_fma_f32 v144, v144, v6, 1.0
    v_mul_f32 v144, v144, v52
    v_mul_f32 v144, 0xc0135761, v144
    v_exp_f32 v144, v144
    s_nop 0
    v_add_f32 v144, 1.0, v144
    v_rcp_f32 v144, v144
    s_nop 0
    v_mul_f32 v144, v144, v52
    v_mul_f32 v144, v144, v60
    v_mul_f32 v145, v53, v53
    v_fma_f32 v145, v145, v6, 1.0
    v_mul_f32 v145, v145, v53
    v_mul_f32 v145, 0xc0135761, v145
    v_exp_f32 v145, v145
    s_nop 0
    v_add_f32 v145, 1.0, v145
    v_rcp_f32 v145, v145
    s_nop 0
    v_mul_f32 v145, v145, v53
    v_mul_f32 v145, v145, v61
    v_mul_f32 v146, v54, v54
    v_fma_f32 v146, v146, v6, 1.0
    v_mul_f32 v146, v146, v54
    v_mul_f32 v146, 0xc0135761, v146
    v_exp_f32 v146, v146
    s_nop 0
    v_add_f32 v146, 1.0, v146
    v_rcp_f32 v146, v146
    s_nop 0
    v_mul_f32 v146, v146, v54
    v_mul_f32 v146, v146, v62
    v_mul_f32 v147, v55, v55
    v_fma_f32 v147, v147, v6, 1.0
    v_mul_f32 v147, v147, v55
    v_mul_f32 v147, 0xc0135761, v147
    v_exp_f32 v147, v147
    s_nop 0
    v_add_f32 v147, 1.0, v147
    v_rcp_f32 v147, v147
    s_nop 0
    v_mul_f32 v147, v147, v55
    v_mul_f32 v147, v147, v63
    v_cvt_pk_bf16_f32 v148, v144, v145
    v_cvt_pk_bf16_f32 v149, v146, v147
    buffer_store_dwordx2 v[148:149], v5, s[52:55], 0 offen offset:32
    s_nop 1
    v_add_u32 v5, 55296, v5
    v_mul_f32 v144, v64, v64
    v_fma_f32 v144, v144, v6, 1.0
    v_mul_f32 v144, v144, v64
    v_mul_f32 v144, 0xc0135761, v144
    v_exp_f32 v144, v144
    s_nop 0
    v_add_f32 v144, 1.0, v144
    v_rcp_f32 v144, v144
    s_nop 0
    v_mul_f32 v144, v144, v64
    v_mul_f32 v144, v144, v72
    v_mul_f32 v145, v65, v65
    v_fma_f32 v145, v145, v6, 1.0
    v_mul_f32 v145, v145, v65
    v_mul_f32 v145, 0xc0135761, v145
    v_exp_f32 v145, v145
    s_nop 0
    v_add_f32 v145, 1.0, v145
    v_rcp_f32 v145, v145
    s_nop 0
    v_mul_f32 v145, v145, v65
    v_mul_f32 v145, v145, v73
    v_mul_f32 v146, v66, v66
    v_fma_f32 v146, v146, v6, 1.0
    v_mul_f32 v146, v146, v66
    v_mul_f32 v146, 0xc0135761, v146
    v_exp_f32 v146, v146
    s_nop 0
    v_add_f32 v146, 1.0, v146
    v_rcp_f32 v146, v146
    s_nop 0
    v_mul_f32 v146, v146, v66
    v_mul_f32 v146, v146, v74
    v_mul_f32 v147, v67, v67
    v_fma_f32 v147, v147, v6, 1.0
    v_mul_f32 v147, v147, v67
    v_mul_f32 v147, 0xc0135761, v147
    v_exp_f32 v147, v147
    s_nop 0
    v_add_f32 v147, 1.0, v147
    v_rcp_f32 v147, v147
    s_nop 0
    v_mul_f32 v147, v147, v67
    v_mul_f32 v147, v147, v75
    v_cvt_pk_bf16_f32 v148, v144, v145
    v_cvt_pk_bf16_f32 v149, v146, v147
    buffer_store_dwordx2 v[148:149], v5, s[52:55], 0 offen offset:0
    s_nop 1
    v_mul_f32 v144, v68, v68
    v_fma_f32 v144, v144, v6, 1.0
    v_mul_f32 v144, v144, v68
    v_mul_f32 v144, 0xc0135761, v144
    v_exp_f32 v144, v144
    s_nop 0
    v_add_f32 v144, 1.0, v144
    v_rcp_f32 v144, v144
    s_nop 0
    v_mul_f32 v144, v144, v68
    v_mul_f32 v144, v144, v76
    v_mul_f32 v145, v69, v69
    v_fma_f32 v145, v145, v6, 1.0
    v_mul_f32 v145, v145, v69
    v_mul_f32 v145, 0xc0135761, v145
    v_exp_f32 v145, v145
    s_nop 0
    v_add_f32 v145, 1.0, v145
    v_rcp_f32 v145, v145
    s_nop 0
    v_mul_f32 v145, v145, v69
    v_mul_f32 v145, v145, v77
    v_mul_f32 v146, v70, v70
    v_fma_f32 v146, v146, v6, 1.0
    v_mul_f32 v146, v146, v70
    v_mul_f32 v146, 0xc0135761, v146
    v_exp_f32 v146, v146
    s_nop 0
    v_add_f32 v146, 1.0, v146
    v_rcp_f32 v146, v146
    s_nop 0
    v_mul_f32 v146, v146, v70
    v_mul_f32 v146, v146, v78
    v_mul_f32 v147, v71, v71
    v_fma_f32 v147, v147, v6, 1.0
    v_mul_f32 v147, v147, v71
    v_mul_f32 v147, 0xc0135761, v147
    v_exp_f32 v147, v147
    s_nop 0
    v_add_f32 v147, 1.0, v147
    v_rcp_f32 v147, v147
    s_nop 0
    v_mul_f32 v147, v147, v71
    v_mul_f32 v147, v147, v79
    v_cvt_pk_bf16_f32 v148, v144, v145
    v_cvt_pk_bf16_f32 v149, v146, v147
    buffer_store_dwordx2 v[148:149], v5, s[52:55], 0 offen offset:32
    s_nop 1
gu_1_kernel_end:
    s_endpgm
.globl down_1_kernel
.p2align 8
.type down_1_kernel,@function
down_1_kernel:
    s_cmp_ge_u32 s2, 160
    s_cbranch_scc1 down_1_kernel_end
    s_load_dwordx16 s[16:31], s[0:1], 0
    s_load_dwordx4 s[32:35], s[0:1], 64
    s_load_dwordx2 s[36:37], s[0:1], 80
    s_waitcnt lgkmcnt(0)
    s_add_u32 s40, s36, 0x1800000
    s_addc_u32 s41, s37, 0
    s_mov_b32 s42, 0x6c0000
    s_mov_b32 s43, 0x00020000
    s_mov_b32 s44, s30
    s_mov_b32 s45, s31
    s_mov_b32 s46, 0x21c000
    s_mov_b32 s47, 0x00020000
    s_mov_b32 s52, s32
    s_mov_b32 s53, s33
    s_mov_b32 s54, 0x280000
    s_mov_b32 s55, 0x00020000
    s_add_u32 s56, s36, 0x1400000
    s_addc_u32 s57, s37, 0
    s_mov_b32 s58, 0x280000
    s_mov_b32 s59, 0x00020000
    s_and_b32 s4, s2, 31
    s_lshr_b32 s5, s2, 5
    v_lshrrev_b32 v1, 6, v0
    s_nop 0
    v_readfirstlane_b32 s6, v1
    v_and_b32 v2, 63, v0
    v_and_b32 v3, 15, v0
    v_bfe_u32 v4, v0, 4, 2
    v_lshrrev_b32 v5, 3, v0
    v_and_b32 v6, 7, v0
    s_mul_i32 s7, s4, 221184
    v_mul_u32_u24 v7, 3456, v5
    v_lshl_add_u32 v7, v6, 4, v7
    v_add_u32 v7, s7, v7
    v_mul_u32_u24 v8, 144, v5
    v_lshl_add_u32 v8, v6, 4, v8
    v_and_b32 v9, 127, v0
    v_lshrrev_b32 v9, 3, v9
    s_lshr_b32 s8, s6, 1
    v_mul_u32_u24 v10, 1280, v9
    v_lshl_add_u32 v10, v6, 4, v10
    s_lshl_b32 s9, s5, 8
    s_lshl_b32 s10, s8, 7
    s_add_u32 s9, s9, s10
    s_mov_b32 s60, s44
    s_mov_b32 s61, s45
    s_mov_b32 s62, s46
    s_mov_b32 s63, s47
    v_add_u32 v10, s9, v10
    v_mul_u32_u24 v11, 288, v9
    v_lshl_add_u32 v11, v6, 4, v11
    s_lshl_b32 s10, s8, 7
    v_add_u32 v11, s10, v11
    v_add_u32 v11, 9216, v11
    s_mov_b32 s64, 0
    s_mov_b32 s65, 110592
    s_mov_b32 s68, 0
    s_mov_b32 s69, 20480
    s_mov_b32 s70, 40960
    s_mov_b32 s71, 61440
    s_lshr_b32 s10, s6, 1
    s_and_b32 s11, s6, 1
    s_mul_i32 s12, s10, 4608
    v_mul_u32_u24 v12, 144, v3
    v_lshl_add_u32 v12, v4, 3, v12
    v_add_u32 v12, s12, v12
    v_lshrrev_b32 v13, 2, v3
    v_lshl_add_u32 v13, v4, 2, v13
    v_mul_u32_u24 v13, 288, v13
    v_and_b32 v14, 3, v3
    v_lshl_add_u32 v13, v14, 3, v13
    s_lshl_b32 s13, s11, 7
    s_add_u32 s13, s13, 9216
    v_add_u32 v13, s13, v13
    v_mov_b32 v16, 0
    v_mov_b32 v17, 0
    v_mov_b32 v18, 0
    v_mov_b32 v19, 0
    v_mov_b32 v20, 0
    v_mov_b32 v21, 0
    v_mov_b32 v22, 0
    v_mov_b32 v23, 0
    v_mov_b32 v24, 0
    v_mov_b32 v25, 0
    v_mov_b32 v26, 0
    v_mov_b32 v27, 0
    v_mov_b32 v28, 0
    v_mov_b32 v29, 0
    v_mov_b32 v30, 0
    v_mov_b32 v31, 0
    v_mov_b32 v32, 0
    v_mov_b32 v33, 0
    v_mov_b32 v34, 0
    v_mov_b32 v35, 0
    v_mov_b32 v36, 0
    v_mov_b32 v37, 0
    v_mov_b32 v38, 0
    v_mov_b32 v39, 0
    v_mov_b32 v40, 0
    v_mov_b32 v41, 0
    v_mov_b32 v42, 0
    v_mov_b32 v43, 0
    v_mov_b32 v44, 0
    v_mov_b32 v45, 0
    v_mov_b32 v46, 0
    v_mov_b32 v47, 0
    buffer_load_dwordx4 v[96:99], v7, s[40:43], s64 offen
    buffer_load_dwordx4 v[100:103], v7, s[40:43], s65 offen
    buffer_load_dwordx4 v[104:107], v10, s[60:63], s68 offen
    buffer_load_dwordx4 v[108:111], v10, s[60:63], s69 offen
    buffer_load_dwordx4 v[112:115], v10, s[60:63], s70 offen
    buffer_load_dwordx4 v[116:119], v10, s[60:63], s71 offen
    v_add_u32 v7, 128, v7
    v_add_u32 v10, 81920, v10
    buffer_load_dwordx4 v[120:123], v7, s[40:43], s64 offen
    buffer_load_dwordx4 v[124:127], v7, s[40:43], s65 offen
    buffer_load_dwordx4 v[128:131], v10, s[60:63], s68 offen
    buffer_load_dwordx4 v[132:135], v10, s[60:63], s69 offen
    buffer_load_dwordx4 v[136:139], v10, s[60:63], s70 offen
    buffer_load_dwordx4 v[140:143], v10, s[60:63], s71 offen
    v_add_u32 v7, 128, v7
    v_add_u32 v10, 81920, v10
    s_waitcnt vmcnt(6)
    ds_write_b128 v8, v[96:99] offset:0
    ds_write_b128 v8, v[100:103] offset:4608
    ds_write_b128 v11, v[104:107] offset:0
    ds_write_b128 v11, v[108:111] offset:4608
    ds_write_b128 v11, v[112:115] offset:9216
    ds_write_b128 v11, v[116:119] offset:13824
    s_waitcnt lgkmcnt(0)
    s_barrier
    buffer_load_dwordx4 v[96:99], v7, s[40:43], s64 offen
    buffer_load_dwordx4 v[100:103], v7, s[40:43], s65 offen
    buffer_load_dwordx4 v[104:107], v10, s[60:63], s68 offen
    buffer_load_dwordx4 v[108:111], v10, s[60:63], s69 offen
    buffer_load_dwordx4 v[112:115], v10, s[60:63], s70 offen
    buffer_load_dwordx4 v[116:119], v10, s[60:63], s71 offen
    v_add_u32 v7, 128, v7
    v_add_u32 v10, 81920, v10
    ds_read_b64_tr_b16 v[56:57], v13 offset:0
    ds_read_b64_tr_b16 v[58:59], v13 offset:4608
    ds_read_b64_tr_b16 v[60:61], v13 offset:32
    ds_read_b64_tr_b16 v[62:63], v13 offset:4640
    ds_read_b64_tr_b16 v[64:65], v13 offset:64
    ds_read_b64_tr_b16 v[66:67], v13 offset:4672
    ds_read_b64_tr_b16 v[68:69], v13 offset:96
    ds_read_b64_tr_b16 v[70:71], v13 offset:4704
    ds_read_b64 v[48:49], v12 offset:0
    ds_read_b64 v[50:51], v12 offset:32
    ds_read_b64 v[52:53], v12 offset:2304
    ds_read_b64 v[54:55], v12 offset:2336
    s_waitcnt lgkmcnt(0)
    ds_read_b64_tr_b16 v[80:81], v13 offset:9216
    ds_read_b64_tr_b16 v[82:83], v13 offset:13824
    ds_read_b64_tr_b16 v[84:85], v13 offset:9248
    ds_read_b64_tr_b16 v[86:87], v13 offset:13856
    ds_read_b64_tr_b16 v[88:89], v13 offset:9280
    ds_read_b64_tr_b16 v[90:91], v13 offset:13888
    ds_read_b64_tr_b16 v[92:93], v13 offset:9312
    ds_read_b64_tr_b16 v[94:95], v13 offset:13920
    ds_read_b64 v[72:73], v12 offset:64
    ds_read_b64 v[74:75], v12 offset:96
    ds_read_b64 v[76:77], v12 offset:2368
    ds_read_b64 v[78:79], v12 offset:2400
    v_mfma_f32_16x16x32_bf16 v[16:19], v[56:59], v[48:51], v[16:19]
    v_mfma_f32_16x16x32_bf16 v[20:23], v[60:63], v[48:51], v[20:23]
    v_mfma_f32_16x16x32_bf16 v[24:27], v[64:67], v[48:51], v[24:27]
    v_mfma_f32_16x16x32_bf16 v[28:31], v[68:71], v[48:51], v[28:31]
    v_mfma_f32_16x16x32_bf16 v[32:35], v[56:59], v[52:55], v[32:35]
    v_mfma_f32_16x16x32_bf16 v[36:39], v[60:63], v[52:55], v[36:39]
    v_mfma_f32_16x16x32_bf16 v[40:43], v[64:67], v[52:55], v[40:43]
    v_mfma_f32_16x16x32_bf16 v[44:47], v[68:71], v[52:55], v[44:47]
    s_waitcnt lgkmcnt(0)
    v_mfma_f32_16x16x32_bf16 v[16:19], v[80:83], v[72:75], v[16:19]
    v_mfma_f32_16x16x32_bf16 v[20:23], v[84:87], v[72:75], v[20:23]
    v_mfma_f32_16x16x32_bf16 v[24:27], v[88:91], v[72:75], v[24:27]
    v_mfma_f32_16x16x32_bf16 v[28:31], v[92:95], v[72:75], v[28:31]
    v_mfma_f32_16x16x32_bf16 v[32:35], v[80:83], v[76:79], v[32:35]
    v_mfma_f32_16x16x32_bf16 v[36:39], v[84:87], v[76:79], v[36:39]
    v_mfma_f32_16x16x32_bf16 v[40:43], v[88:91], v[76:79], v[40:43]
    v_mfma_f32_16x16x32_bf16 v[44:47], v[92:95], v[76:79], v[44:47]
    s_waitcnt vmcnt(6)
    ds_write_b128 v8, v[120:123] offset:27648
    ds_write_b128 v8, v[124:127] offset:32256
    ds_write_b128 v11, v[128:131] offset:27648
    ds_write_b128 v11, v[132:135] offset:32256
    ds_write_b128 v11, v[136:139] offset:36864
    ds_write_b128 v11, v[140:143] offset:41472
    s_waitcnt lgkmcnt(0)
    s_barrier
    buffer_load_dwordx4 v[120:123], v7, s[40:43], s64 offen
    buffer_load_dwordx4 v[124:127], v7, s[40:43], s65 offen
    buffer_load_dwordx4 v[128:131], v10, s[60:63], s68 offen
    buffer_load_dwordx4 v[132:135], v10, s[60:63], s69 offen
    buffer_load_dwordx4 v[136:139], v10, s[60:63], s70 offen
    buffer_load_dwordx4 v[140:143], v10, s[60:63], s71 offen
    v_add_u32 v7, 128, v7
    v_add_u32 v10, 81920, v10
    ds_read_b64_tr_b16 v[56:57], v13 offset:27648
    ds_read_b64_tr_b16 v[58:59], v13 offset:32256
    ds_read_b64_tr_b16 v[60:61], v13 offset:27680
    ds_read_b64_tr_b16 v[62:63], v13 offset:32288
    ds_read_b64_tr_b16 v[64:65], v13 offset:27712
    ds_read_b64_tr_b16 v[66:67], v13 offset:32320
    ds_read_b64_tr_b16 v[68:69], v13 offset:27744
    ds_read_b64_tr_b16 v[70:71], v13 offset:32352
    ds_read_b64 v[48:49], v12 offset:27648
    ds_read_b64 v[50:51], v12 offset:27680
    ds_read_b64 v[52:53], v12 offset:29952
    ds_read_b64 v[54:55], v12 offset:29984
    s_waitcnt lgkmcnt(0)
    ds_read_b64_tr_b16 v[80:81], v13 offset:36864
    ds_read_b64_tr_b16 v[82:83], v13 offset:41472
    ds_read_b64_tr_b16 v[84:85], v13 offset:36896
    ds_read_b64_tr_b16 v[86:87], v13 offset:41504
    ds_read_b64_tr_b16 v[88:89], v13 offset:36928
    ds_read_b64_tr_b16 v[90:91], v13 offset:41536
    ds_read_b64_tr_b16 v[92:93], v13 offset:36960
    ds_read_b64_tr_b16 v[94:95], v13 offset:41568
    ds_read_b64 v[72:73], v12 offset:27712
    ds_read_b64 v[74:75], v12 offset:27744
    ds_read_b64 v[76:77], v12 offset:30016
    ds_read_b64 v[78:79], v12 offset:30048
    v_mfma_f32_16x16x32_bf16 v[16:19], v[56:59], v[48:51], v[16:19]
    v_mfma_f32_16x16x32_bf16 v[20:23], v[60:63], v[48:51], v[20:23]
    v_mfma_f32_16x16x32_bf16 v[24:27], v[64:67], v[48:51], v[24:27]
    v_mfma_f32_16x16x32_bf16 v[28:31], v[68:71], v[48:51], v[28:31]
    v_mfma_f32_16x16x32_bf16 v[32:35], v[56:59], v[52:55], v[32:35]
    v_mfma_f32_16x16x32_bf16 v[36:39], v[60:63], v[52:55], v[36:39]
    v_mfma_f32_16x16x32_bf16 v[40:43], v[64:67], v[52:55], v[40:43]
    v_mfma_f32_16x16x32_bf16 v[44:47], v[68:71], v[52:55], v[44:47]
    s_waitcnt lgkmcnt(0)
    v_mfma_f32_16x16x32_bf16 v[16:19], v[80:83], v[72:75], v[16:19]
    v_mfma_f32_16x16x32_bf16 v[20:23], v[84:87], v[72:75], v[20:23]
    v_mfma_f32_16x16x32_bf16 v[24:27], v[88:91], v[72:75], v[24:27]
    v_mfma_f32_16x16x32_bf16 v[28:31], v[92:95], v[72:75], v[28:31]
    v_mfma_f32_16x16x32_bf16 v[32:35], v[80:83], v[76:79], v[32:35]
    v_mfma_f32_16x16x32_bf16 v[36:39], v[84:87], v[76:79], v[36:39]
    v_mfma_f32_16x16x32_bf16 v[40:43], v[88:91], v[76:79], v[40:43]
    v_mfma_f32_16x16x32_bf16 v[44:47], v[92:95], v[76:79], v[44:47]
    s_waitcnt vmcnt(6)
    ds_write_b128 v8, v[96:99] offset:0
    ds_write_b128 v8, v[100:103] offset:4608
    ds_write_b128 v11, v[104:107] offset:0
    ds_write_b128 v11, v[108:111] offset:4608
    ds_write_b128 v11, v[112:115] offset:9216
    ds_write_b128 v11, v[116:119] offset:13824
    s_waitcnt lgkmcnt(0)
    s_barrier
    buffer_load_dwordx4 v[96:99], v7, s[40:43], s64 offen
    buffer_load_dwordx4 v[100:103], v7, s[40:43], s65 offen
    buffer_load_dwordx4 v[104:107], v10, s[60:63], s68 offen
    buffer_load_dwordx4 v[108:111], v10, s[60:63], s69 offen
    buffer_load_dwordx4 v[112:115], v10, s[60:63], s70 offen
    buffer_load_dwordx4 v[116:119], v10, s[60:63], s71 offen
    v_add_u32 v7, 128, v7
    v_add_u32 v10, 81920, v10
    ds_read_b64_tr_b16 v[56:57], v13 offset:0
    ds_read_b64_tr_b16 v[58:59], v13 offset:4608
    ds_read_b64_tr_b16 v[60:61], v13 offset:32
    ds_read_b64_tr_b16 v[62:63], v13 offset:4640
    ds_read_b64_tr_b16 v[64:65], v13 offset:64
    ds_read_b64_tr_b16 v[66:67], v13 offset:4672
    ds_read_b64_tr_b16 v[68:69], v13 offset:96
    ds_read_b64_tr_b16 v[70:71], v13 offset:4704
    ds_read_b64 v[48:49], v12 offset:0
    ds_read_b64 v[50:51], v12 offset:32
    ds_read_b64 v[52:53], v12 offset:2304
    ds_read_b64 v[54:55], v12 offset:2336
    s_waitcnt lgkmcnt(0)
    ds_read_b64_tr_b16 v[80:81], v13 offset:9216
    ds_read_b64_tr_b16 v[82:83], v13 offset:13824
    ds_read_b64_tr_b16 v[84:85], v13 offset:9248
    ds_read_b64_tr_b16 v[86:87], v13 offset:13856
    ds_read_b64_tr_b16 v[88:89], v13 offset:9280
    ds_read_b64_tr_b16 v[90:91], v13 offset:13888
    ds_read_b64_tr_b16 v[92:93], v13 offset:9312
    ds_read_b64_tr_b16 v[94:95], v13 offset:13920
    ds_read_b64 v[72:73], v12 offset:64
    ds_read_b64 v[74:75], v12 offset:96
    ds_read_b64 v[76:77], v12 offset:2368
    ds_read_b64 v[78:79], v12 offset:2400
    v_mfma_f32_16x16x32_bf16 v[16:19], v[56:59], v[48:51], v[16:19]
    v_mfma_f32_16x16x32_bf16 v[20:23], v[60:63], v[48:51], v[20:23]
    v_mfma_f32_16x16x32_bf16 v[24:27], v[64:67], v[48:51], v[24:27]
    v_mfma_f32_16x16x32_bf16 v[28:31], v[68:71], v[48:51], v[28:31]
    v_mfma_f32_16x16x32_bf16 v[32:35], v[56:59], v[52:55], v[32:35]
    v_mfma_f32_16x16x32_bf16 v[36:39], v[60:63], v[52:55], v[36:39]
    v_mfma_f32_16x16x32_bf16 v[40:43], v[64:67], v[52:55], v[40:43]
    v_mfma_f32_16x16x32_bf16 v[44:47], v[68:71], v[52:55], v[44:47]
    s_waitcnt lgkmcnt(0)
    v_mfma_f32_16x16x32_bf16 v[16:19], v[80:83], v[72:75], v[16:19]
    v_mfma_f32_16x16x32_bf16 v[20:23], v[84:87], v[72:75], v[20:23]
    v_mfma_f32_16x16x32_bf16 v[24:27], v[88:91], v[72:75], v[24:27]
    v_mfma_f32_16x16x32_bf16 v[28:31], v[92:95], v[72:75], v[28:31]
    v_mfma_f32_16x16x32_bf16 v[32:35], v[80:83], v[76:79], v[32:35]
    v_mfma_f32_16x16x32_bf16 v[36:39], v[84:87], v[76:79], v[36:39]
    v_mfma_f32_16x16x32_bf16 v[40:43], v[88:91], v[76:79], v[40:43]
    v_mfma_f32_16x16x32_bf16 v[44:47], v[92:95], v[76:79], v[44:47]
    s_waitcnt vmcnt(6)
    ds_write_b128 v8, v[120:123] offset:27648
    ds_write_b128 v8, v[124:127] offset:32256
    ds_write_b128 v11, v[128:131] offset:27648
    ds_write_b128 v11, v[132:135] offset:32256
    ds_write_b128 v11, v[136:139] offset:36864
    ds_write_b128 v11, v[140:143] offset:41472
    s_waitcnt lgkmcnt(0)
    s_barrier
    buffer_load_dwordx4 v[120:123], v7, s[40:43], s64 offen
    buffer_load_dwordx4 v[124:127], v7, s[40:43], s65 offen
    buffer_load_dwordx4 v[128:131], v10, s[60:63], s68 offen
    buffer_load_dwordx4 v[132:135], v10, s[60:63], s69 offen
    buffer_load_dwordx4 v[136:139], v10, s[60:63], s70 offen
    buffer_load_dwordx4 v[140:143], v10, s[60:63], s71 offen
    v_add_u32 v7, 128, v7
    v_add_u32 v10, 81920, v10
    ds_read_b64_tr_b16 v[56:57], v13 offset:27648
    ds_read_b64_tr_b16 v[58:59], v13 offset:32256
    ds_read_b64_tr_b16 v[60:61], v13 offset:27680
    ds_read_b64_tr_b16 v[62:63], v13 offset:32288
    ds_read_b64_tr_b16 v[64:65], v13 offset:27712
    ds_read_b64_tr_b16 v[66:67], v13 offset:32320
    ds_read_b64_tr_b16 v[68:69], v13 offset:27744
    ds_read_b64_tr_b16 v[70:71], v13 offset:32352
    ds_read_b64 v[48:49], v12 offset:27648
    ds_read_b64 v[50:51], v12 offset:27680
    ds_read_b64 v[52:53], v12 offset:29952
    ds_read_b64 v[54:55], v12 offset:29984
    s_waitcnt lgkmcnt(0)
    ds_read_b64_tr_b16 v[80:81], v13 offset:36864
    ds_read_b64_tr_b16 v[82:83], v13 offset:41472
    ds_read_b64_tr_b16 v[84:85], v13 offset:36896
    ds_read_b64_tr_b16 v[86:87], v13 offset:41504
    ds_read_b64_tr_b16 v[88:89], v13 offset:36928
    ds_read_b64_tr_b16 v[90:91], v13 offset:41536
    ds_read_b64_tr_b16 v[92:93], v13 offset:36960
    ds_read_b64_tr_b16 v[94:95], v13 offset:41568
    ds_read_b64 v[72:73], v12 offset:27712
    ds_read_b64 v[74:75], v12 offset:27744
    ds_read_b64 v[76:77], v12 offset:30016
    ds_read_b64 v[78:79], v12 offset:30048
    v_mfma_f32_16x16x32_bf16 v[16:19], v[56:59], v[48:51], v[16:19]
    v_mfma_f32_16x16x32_bf16 v[20:23], v[60:63], v[48:51], v[20:23]
    v_mfma_f32_16x16x32_bf16 v[24:27], v[64:67], v[48:51], v[24:27]
    v_mfma_f32_16x16x32_bf16 v[28:31], v[68:71], v[48:51], v[28:31]
    v_mfma_f32_16x16x32_bf16 v[32:35], v[56:59], v[52:55], v[32:35]
    v_mfma_f32_16x16x32_bf16 v[36:39], v[60:63], v[52:55], v[36:39]
    v_mfma_f32_16x16x32_bf16 v[40:43], v[64:67], v[52:55], v[40:43]
    v_mfma_f32_16x16x32_bf16 v[44:47], v[68:71], v[52:55], v[44:47]
    s_waitcnt lgkmcnt(0)
    v_mfma_f32_16x16x32_bf16 v[16:19], v[80:83], v[72:75], v[16:19]
    v_mfma_f32_16x16x32_bf16 v[20:23], v[84:87], v[72:75], v[20:23]
    v_mfma_f32_16x16x32_bf16 v[24:27], v[88:91], v[72:75], v[24:27]
    v_mfma_f32_16x16x32_bf16 v[28:31], v[92:95], v[72:75], v[28:31]
    v_mfma_f32_16x16x32_bf16 v[32:35], v[80:83], v[76:79], v[32:35]
    v_mfma_f32_16x16x32_bf16 v[36:39], v[84:87], v[76:79], v[36:39]
    v_mfma_f32_16x16x32_bf16 v[40:43], v[88:91], v[76:79], v[40:43]
    v_mfma_f32_16x16x32_bf16 v[44:47], v[92:95], v[76:79], v[44:47]
    s_waitcnt vmcnt(6)
    ds_write_b128 v8, v[96:99] offset:0
    ds_write_b128 v8, v[100:103] offset:4608
    ds_write_b128 v11, v[104:107] offset:0
    ds_write_b128 v11, v[108:111] offset:4608
    ds_write_b128 v11, v[112:115] offset:9216
    ds_write_b128 v11, v[116:119] offset:13824
    s_waitcnt lgkmcnt(0)
    s_barrier
    buffer_load_dwordx4 v[96:99], v7, s[40:43], s64 offen
    buffer_load_dwordx4 v[100:103], v7, s[40:43], s65 offen
    buffer_load_dwordx4 v[104:107], v10, s[60:63], s68 offen
    buffer_load_dwordx4 v[108:111], v10, s[60:63], s69 offen
    buffer_load_dwordx4 v[112:115], v10, s[60:63], s70 offen
    buffer_load_dwordx4 v[116:119], v10, s[60:63], s71 offen
    v_add_u32 v7, 128, v7
    v_add_u32 v10, 81920, v10
    ds_read_b64_tr_b16 v[56:57], v13 offset:0
    ds_read_b64_tr_b16 v[58:59], v13 offset:4608
    ds_read_b64_tr_b16 v[60:61], v13 offset:32
    ds_read_b64_tr_b16 v[62:63], v13 offset:4640
    ds_read_b64_tr_b16 v[64:65], v13 offset:64
    ds_read_b64_tr_b16 v[66:67], v13 offset:4672
    ds_read_b64_tr_b16 v[68:69], v13 offset:96
    ds_read_b64_tr_b16 v[70:71], v13 offset:4704
    ds_read_b64 v[48:49], v12 offset:0
    ds_read_b64 v[50:51], v12 offset:32
    ds_read_b64 v[52:53], v12 offset:2304
    ds_read_b64 v[54:55], v12 offset:2336
    s_waitcnt lgkmcnt(0)
    ds_read_b64_tr_b16 v[80:81], v13 offset:9216
    ds_read_b64_tr_b16 v[82:83], v13 offset:13824
    ds_read_b64_tr_b16 v[84:85], v13 offset:9248
    ds_read_b64_tr_b16 v[86:87], v13 offset:13856
    ds_read_b64_tr_b16 v[88:89], v13 offset:9280
    ds_read_b64_tr_b16 v[90:91], v13 offset:13888
    ds_read_b64_tr_b16 v[92:93], v13 offset:9312
    ds_read_b64_tr_b16 v[94:95], v13 offset:13920
    ds_read_b64 v[72:73], v12 offset:64
    ds_read_b64 v[74:75], v12 offset:96
    ds_read_b64 v[76:77], v12 offset:2368
    ds_read_b64 v[78:79], v12 offset:2400
    v_mfma_f32_16x16x32_bf16 v[16:19], v[56:59], v[48:51], v[16:19]
    v_mfma_f32_16x16x32_bf16 v[20:23], v[60:63], v[48:51], v[20:23]
    v_mfma_f32_16x16x32_bf16 v[24:27], v[64:67], v[48:51], v[24:27]
    v_mfma_f32_16x16x32_bf16 v[28:31], v[68:71], v[48:51], v[28:31]
    v_mfma_f32_16x16x32_bf16 v[32:35], v[56:59], v[52:55], v[32:35]
    v_mfma_f32_16x16x32_bf16 v[36:39], v[60:63], v[52:55], v[36:39]
    v_mfma_f32_16x16x32_bf16 v[40:43], v[64:67], v[52:55], v[40:43]
    v_mfma_f32_16x16x32_bf16 v[44:47], v[68:71], v[52:55], v[44:47]
    s_waitcnt lgkmcnt(0)
    v_mfma_f32_16x16x32_bf16 v[16:19], v[80:83], v[72:75], v[16:19]
    v_mfma_f32_16x16x32_bf16 v[20:23], v[84:87], v[72:75], v[20:23]
    v_mfma_f32_16x16x32_bf16 v[24:27], v[88:91], v[72:75], v[24:27]
    v_mfma_f32_16x16x32_bf16 v[28:31], v[92:95], v[72:75], v[28:31]
    v_mfma_f32_16x16x32_bf16 v[32:35], v[80:83], v[76:79], v[32:35]
    v_mfma_f32_16x16x32_bf16 v[36:39], v[84:87], v[76:79], v[36:39]
    v_mfma_f32_16x16x32_bf16 v[40:43], v[88:91], v[76:79], v[40:43]
    v_mfma_f32_16x16x32_bf16 v[44:47], v[92:95], v[76:79], v[44:47]
    s_waitcnt vmcnt(6)
    ds_write_b128 v8, v[120:123] offset:27648
    ds_write_b128 v8, v[124:127] offset:32256
    ds_write_b128 v11, v[128:131] offset:27648
    ds_write_b128 v11, v[132:135] offset:32256
    ds_write_b128 v11, v[136:139] offset:36864
    ds_write_b128 v11, v[140:143] offset:41472
    s_waitcnt lgkmcnt(0)
    s_barrier
    buffer_load_dwordx4 v[120:123], v7, s[40:43], s64 offen
    buffer_load_dwordx4 v[124:127], v7, s[40:43], s65 offen
    buffer_load_dwordx4 v[128:131], v10, s[60:63], s68 offen
    buffer_load_dwordx4 v[132:135], v10, s[60:63], s69 offen
    buffer_load_dwordx4 v[136:139], v10, s[60:63], s70 offen
    buffer_load_dwordx4 v[140:143], v10, s[60:63], s71 offen
    v_add_u32 v7, 128, v7
    v_add_u32 v10, 81920, v10
    ds_read_b64_tr_b16 v[56:57], v13 offset:27648
    ds_read_b64_tr_b16 v[58:59], v13 offset:32256
    ds_read_b64_tr_b16 v[60:61], v13 offset:27680
    ds_read_b64_tr_b16 v[62:63], v13 offset:32288
    ds_read_b64_tr_b16 v[64:65], v13 offset:27712
    ds_read_b64_tr_b16 v[66:67], v13 offset:32320
    ds_read_b64_tr_b16 v[68:69], v13 offset:27744
    ds_read_b64_tr_b16 v[70:71], v13 offset:32352
    ds_read_b64 v[48:49], v12 offset:27648
    ds_read_b64 v[50:51], v12 offset:27680
    ds_read_b64 v[52:53], v12 offset:29952
    ds_read_b64 v[54:55], v12 offset:29984
    s_waitcnt lgkmcnt(0)
    ds_read_b64_tr_b16 v[80:81], v13 offset:36864
    ds_read_b64_tr_b16 v[82:83], v13 offset:41472
    ds_read_b64_tr_b16 v[84:85], v13 offset:36896
    ds_read_b64_tr_b16 v[86:87], v13 offset:41504
    ds_read_b64_tr_b16 v[88:89], v13 offset:36928
    ds_read_b64_tr_b16 v[90:91], v13 offset:41536
    ds_read_b64_tr_b16 v[92:93], v13 offset:36960
    ds_read_b64_tr_b16 v[94:95], v13 offset:41568
    ds_read_b64 v[72:73], v12 offset:27712
    ds_read_b64 v[74:75], v12 offset:27744
    ds_read_b64 v[76:77], v12 offset:30016
    ds_read_b64 v[78:79], v12 offset:30048
    v_mfma_f32_16x16x32_bf16 v[16:19], v[56:59], v[48:51], v[16:19]
    v_mfma_f32_16x16x32_bf16 v[20:23], v[60:63], v[48:51], v[20:23]
    v_mfma_f32_16x16x32_bf16 v[24:27], v[64:67], v[48:51], v[24:27]
    v_mfma_f32_16x16x32_bf16 v[28:31], v[68:71], v[48:51], v[28:31]
    v_mfma_f32_16x16x32_bf16 v[32:35], v[56:59], v[52:55], v[32:35]
    v_mfma_f32_16x16x32_bf16 v[36:39], v[60:63], v[52:55], v[36:39]
    v_mfma_f32_16x16x32_bf16 v[40:43], v[64:67], v[52:55], v[40:43]
    v_mfma_f32_16x16x32_bf16 v[44:47], v[68:71], v[52:55], v[44:47]
    s_waitcnt lgkmcnt(0)
    v_mfma_f32_16x16x32_bf16 v[16:19], v[80:83], v[72:75], v[16:19]
    v_mfma_f32_16x16x32_bf16 v[20:23], v[84:87], v[72:75], v[20:23]
    v_mfma_f32_16x16x32_bf16 v[24:27], v[88:91], v[72:75], v[24:27]
    v_mfma_f32_16x16x32_bf16 v[28:31], v[92:95], v[72:75], v[28:31]
    v_mfma_f32_16x16x32_bf16 v[32:35], v[80:83], v[76:79], v[32:35]
    v_mfma_f32_16x16x32_bf16 v[36:39], v[84:87], v[76:79], v[36:39]
    v_mfma_f32_16x16x32_bf16 v[40:43], v[88:91], v[76:79], v[40:43]
    v_mfma_f32_16x16x32_bf16 v[44:47], v[92:95], v[76:79], v[44:47]
    s_waitcnt vmcnt(6)
    ds_write_b128 v8, v[96:99] offset:0
    ds_write_b128 v8, v[100:103] offset:4608
    ds_write_b128 v11, v[104:107] offset:0
    ds_write_b128 v11, v[108:111] offset:4608
    ds_write_b128 v11, v[112:115] offset:9216
    ds_write_b128 v11, v[116:119] offset:13824
    s_waitcnt lgkmcnt(0)
    s_barrier
    buffer_load_dwordx4 v[96:99], v7, s[40:43], s64 offen
    buffer_load_dwordx4 v[100:103], v7, s[40:43], s65 offen
    buffer_load_dwordx4 v[104:107], v10, s[60:63], s68 offen
    buffer_load_dwordx4 v[108:111], v10, s[60:63], s69 offen
    buffer_load_dwordx4 v[112:115], v10, s[60:63], s70 offen
    buffer_load_dwordx4 v[116:119], v10, s[60:63], s71 offen
    v_add_u32 v7, 128, v7
    v_add_u32 v10, 81920, v10
    ds_read_b64_tr_b16 v[56:57], v13 offset:0
    ds_read_b64_tr_b16 v[58:59], v13 offset:4608
    ds_read_b64_tr_b16 v[60:61], v13 offset:32
    ds_read_b64_tr_b16 v[62:63], v13 offset:4640
    ds_read_b64_tr_b16 v[64:65], v13 offset:64
    ds_read_b64_tr_b16 v[66:67], v13 offset:4672
    ds_read_b64_tr_b16 v[68:69], v13 offset:96
    ds_read_b64_tr_b16 v[70:71], v13 offset:4704
    ds_read_b64 v[48:49], v12 offset:0
    ds_read_b64 v[50:51], v12 offset:32
    ds_read_b64 v[52:53], v12 offset:2304
    ds_read_b64 v[54:55], v12 offset:2336
    s_waitcnt lgkmcnt(0)
    ds_read_b64_tr_b16 v[80:81], v13 offset:9216
    ds_read_b64_tr_b16 v[82:83], v13 offset:13824
    ds_read_b64_tr_b16 v[84:85], v13 offset:9248
    ds_read_b64_tr_b16 v[86:87], v13 offset:13856
    ds_read_b64_tr_b16 v[88:89], v13 offset:9280
    ds_read_b64_tr_b16 v[90:91], v13 offset:13888
    ds_read_b64_tr_b16 v[92:93], v13 offset:9312
    ds_read_b64_tr_b16 v[94:95], v13 offset:13920
    ds_read_b64 v[72:73], v12 offset:64
    ds_read_b64 v[74:75], v12 offset:96
    ds_read_b64 v[76:77], v12 offset:2368
    ds_read_b64 v[78:79], v12 offset:2400
    v_mfma_f32_16x16x32_bf16 v[16:19], v[56:59], v[48:51], v[16:19]
    v_mfma_f32_16x16x32_bf16 v[20:23], v[60:63], v[48:51], v[20:23]
    v_mfma_f32_16x16x32_bf16 v[24:27], v[64:67], v[48:51], v[24:27]
    v_mfma_f32_16x16x32_bf16 v[28:31], v[68:71], v[48:51], v[28:31]
    v_mfma_f32_16x16x32_bf16 v[32:35], v[56:59], v[52:55], v[32:35]
    v_mfma_f32_16x16x32_bf16 v[36:39], v[60:63], v[52:55], v[36:39]
    v_mfma_f32_16x16x32_bf16 v[40:43], v[64:67], v[52:55], v[40:43]
    v_mfma_f32_16x16x32_bf16 v[44:47], v[68:71], v[52:55], v[44:47]
    s_waitcnt lgkmcnt(0)
    v_mfma_f32_16x16x32_bf16 v[16:19], v[80:83], v[72:75], v[16:19]
    v_mfma_f32_16x16x32_bf16 v[20:23], v[84:87], v[72:75], v[20:23]
    v_mfma_f32_16x16x32_bf16 v[24:27], v[88:91], v[72:75], v[24:27]
    v_mfma_f32_16x16x32_bf16 v[28:31], v[92:95], v[72:75], v[28:31]
    v_mfma_f32_16x16x32_bf16 v[32:35], v[80:83], v[76:79], v[32:35]
    v_mfma_f32_16x16x32_bf16 v[36:39], v[84:87], v[76:79], v[36:39]
    v_mfma_f32_16x16x32_bf16 v[40:43], v[88:91], v[76:79], v[40:43]
    v_mfma_f32_16x16x32_bf16 v[44:47], v[92:95], v[76:79], v[44:47]
    s_waitcnt vmcnt(6)
    ds_write_b128 v8, v[120:123] offset:27648
    ds_write_b128 v8, v[124:127] offset:32256
    ds_write_b128 v11, v[128:131] offset:27648
    ds_write_b128 v11, v[132:135] offset:32256
    ds_write_b128 v11, v[136:139] offset:36864
    ds_write_b128 v11, v[140:143] offset:41472
    s_waitcnt lgkmcnt(0)
    s_barrier
    buffer_load_dwordx4 v[120:123], v7, s[40:43], s64 offen
    buffer_load_dwordx4 v[124:127], v7, s[40:43], s65 offen
    buffer_load_dwordx4 v[128:131], v10, s[60:63], s68 offen
    buffer_load_dwordx4 v[132:135], v10, s[60:63], s69 offen
    buffer_load_dwordx4 v[136:139], v10, s[60:63], s70 offen
    buffer_load_dwordx4 v[140:143], v10, s[60:63], s71 offen
    v_add_u32 v7, 128, v7
    v_add_u32 v10, 81920, v10
    ds_read_b64_tr_b16 v[56:57], v13 offset:27648
    ds_read_b64_tr_b16 v[58:59], v13 offset:32256
    ds_read_b64_tr_b16 v[60:61], v13 offset:27680
    ds_read_b64_tr_b16 v[62:63], v13 offset:32288
    ds_read_b64_tr_b16 v[64:65], v13 offset:27712
    ds_read_b64_tr_b16 v[66:67], v13 offset:32320
    ds_read_b64_tr_b16 v[68:69], v13 offset:27744
    ds_read_b64_tr_b16 v[70:71], v13 offset:32352
    ds_read_b64 v[48:49], v12 offset:27648
    ds_read_b64 v[50:51], v12 offset:27680
    ds_read_b64 v[52:53], v12 offset:29952
    ds_read_b64 v[54:55], v12 offset:29984
    s_waitcnt lgkmcnt(0)
    ds_read_b64_tr_b16 v[80:81], v13 offset:36864
    ds_read_b64_tr_b16 v[82:83], v13 offset:41472
    ds_read_b64_tr_b16 v[84:85], v13 offset:36896
    ds_read_b64_tr_b16 v[86:87], v13 offset:41504
    ds_read_b64_tr_b16 v[88:89], v13 offset:36928
    ds_read_b64_tr_b16 v[90:91], v13 offset:41536
    ds_read_b64_tr_b16 v[92:93], v13 offset:36960
    ds_read_b64_tr_b16 v[94:95], v13 offset:41568
    ds_read_b64 v[72:73], v12 offset:27712
    ds_read_b64 v[74:75], v12 offset:27744
    ds_read_b64 v[76:77], v12 offset:30016
    ds_read_b64 v[78:79], v12 offset:30048
    v_mfma_f32_16x16x32_bf16 v[16:19], v[56:59], v[48:51], v[16:19]
    v_mfma_f32_16x16x32_bf16 v[20:23], v[60:63], v[48:51], v[20:23]
    v_mfma_f32_16x16x32_bf16 v[24:27], v[64:67], v[48:51], v[24:27]
    v_mfma_f32_16x16x32_bf16 v[28:31], v[68:71], v[48:51], v[28:31]
    v_mfma_f32_16x16x32_bf16 v[32:35], v[56:59], v[52:55], v[32:35]
    v_mfma_f32_16x16x32_bf16 v[36:39], v[60:63], v[52:55], v[36:39]
    v_mfma_f32_16x16x32_bf16 v[40:43], v[64:67], v[52:55], v[40:43]
    v_mfma_f32_16x16x32_bf16 v[44:47], v[68:71], v[52:55], v[44:47]
    s_waitcnt lgkmcnt(0)
    v_mfma_f32_16x16x32_bf16 v[16:19], v[80:83], v[72:75], v[16:19]
    v_mfma_f32_16x16x32_bf16 v[20:23], v[84:87], v[72:75], v[20:23]
    v_mfma_f32_16x16x32_bf16 v[24:27], v[88:91], v[72:75], v[24:27]
    v_mfma_f32_16x16x32_bf16 v[28:31], v[92:95], v[72:75], v[28:31]
    v_mfma_f32_16x16x32_bf16 v[32:35], v[80:83], v[76:79], v[32:35]
    v_mfma_f32_16x16x32_bf16 v[36:39], v[84:87], v[76:79], v[36:39]
    v_mfma_f32_16x16x32_bf16 v[40:43], v[88:91], v[76:79], v[40:43]
    v_mfma_f32_16x16x32_bf16 v[44:47], v[92:95], v[76:79], v[44:47]
    s_waitcnt vmcnt(6)
    ds_write_b128 v8, v[96:99] offset:0
    ds_write_b128 v8, v[100:103] offset:4608
    ds_write_b128 v11, v[104:107] offset:0
    ds_write_b128 v11, v[108:111] offset:4608
    ds_write_b128 v11, v[112:115] offset:9216
    ds_write_b128 v11, v[116:119] offset:13824
    s_waitcnt lgkmcnt(0)
    s_barrier
    buffer_load_dwordx4 v[96:99], v7, s[40:43], s64 offen
    buffer_load_dwordx4 v[100:103], v7, s[40:43], s65 offen
    buffer_load_dwordx4 v[104:107], v10, s[60:63], s68 offen
    buffer_load_dwordx4 v[108:111], v10, s[60:63], s69 offen
    buffer_load_dwordx4 v[112:115], v10, s[60:63], s70 offen
    buffer_load_dwordx4 v[116:119], v10, s[60:63], s71 offen
    v_add_u32 v7, 128, v7
    v_add_u32 v10, 81920, v10
    ds_read_b64_tr_b16 v[56:57], v13 offset:0
    ds_read_b64_tr_b16 v[58:59], v13 offset:4608
    ds_read_b64_tr_b16 v[60:61], v13 offset:32
    ds_read_b64_tr_b16 v[62:63], v13 offset:4640
    ds_read_b64_tr_b16 v[64:65], v13 offset:64
    ds_read_b64_tr_b16 v[66:67], v13 offset:4672
    ds_read_b64_tr_b16 v[68:69], v13 offset:96
    ds_read_b64_tr_b16 v[70:71], v13 offset:4704
    ds_read_b64 v[48:49], v12 offset:0
    ds_read_b64 v[50:51], v12 offset:32
    ds_read_b64 v[52:53], v12 offset:2304
    ds_read_b64 v[54:55], v12 offset:2336
    s_waitcnt lgkmcnt(0)
    ds_read_b64_tr_b16 v[80:81], v13 offset:9216
    ds_read_b64_tr_b16 v[82:83], v13 offset:13824
    ds_read_b64_tr_b16 v[84:85], v13 offset:9248
    ds_read_b64_tr_b16 v[86:87], v13 offset:13856
    ds_read_b64_tr_b16 v[88:89], v13 offset:9280
    ds_read_b64_tr_b16 v[90:91], v13 offset:13888
    ds_read_b64_tr_b16 v[92:93], v13 offset:9312
    ds_read_b64_tr_b16 v[94:95], v13 offset:13920
    ds_read_b64 v[72:73], v12 offset:64
    ds_read_b64 v[74:75], v12 offset:96
    ds_read_b64 v[76:77], v12 offset:2368
    ds_read_b64 v[78:79], v12 offset:2400
    v_mfma_f32_16x16x32_bf16 v[16:19], v[56:59], v[48:51], v[16:19]
    v_mfma_f32_16x16x32_bf16 v[20:23], v[60:63], v[48:51], v[20:23]
    v_mfma_f32_16x16x32_bf16 v[24:27], v[64:67], v[48:51], v[24:27]
    v_mfma_f32_16x16x32_bf16 v[28:31], v[68:71], v[48:51], v[28:31]
    v_mfma_f32_16x16x32_bf16 v[32:35], v[56:59], v[52:55], v[32:35]
    v_mfma_f32_16x16x32_bf16 v[36:39], v[60:63], v[52:55], v[36:39]
    v_mfma_f32_16x16x32_bf16 v[40:43], v[64:67], v[52:55], v[40:43]
    v_mfma_f32_16x16x32_bf16 v[44:47], v[68:71], v[52:55], v[44:47]
    s_waitcnt lgkmcnt(0)
    v_mfma_f32_16x16x32_bf16 v[16:19], v[80:83], v[72:75], v[16:19]
    v_mfma_f32_16x16x32_bf16 v[20:23], v[84:87], v[72:75], v[20:23]
    v_mfma_f32_16x16x32_bf16 v[24:27], v[88:91], v[72:75], v[24:27]
    v_mfma_f32_16x16x32_bf16 v[28:31], v[92:95], v[72:75], v[28:31]
    v_mfma_f32_16x16x32_bf16 v[32:35], v[80:83], v[76:79], v[32:35]
    v_mfma_f32_16x16x32_bf16 v[36:39], v[84:87], v[76:79], v[36:39]
    v_mfma_f32_16x16x32_bf16 v[40:43], v[88:91], v[76:79], v[40:43]
    v_mfma_f32_16x16x32_bf16 v[44:47], v[92:95], v[76:79], v[44:47]
    s_waitcnt vmcnt(6)
    ds_write_b128 v8, v[120:123] offset:27648
    ds_write_b128 v8, v[124:127] offset:32256
    ds_write_b128 v11, v[128:131] offset:27648
    ds_write_b128 v11, v[132:135] offset:32256
    ds_write_b128 v11, v[136:139] offset:36864
    ds_write_b128 v11, v[140:143] offset:41472
    s_waitcnt lgkmcnt(0)
    s_barrier
    buffer_load_dwordx4 v[120:123], v7, s[40:43], s64 offen
    buffer_load_dwordx4 v[124:127], v7, s[40:43], s65 offen
    buffer_load_dwordx4 v[128:131], v10, s[60:63], s68 offen
    buffer_load_dwordx4 v[132:135], v10, s[60:63], s69 offen
    buffer_load_dwordx4 v[136:139], v10, s[60:63], s70 offen
    buffer_load_dwordx4 v[140:143], v10, s[60:63], s71 offen
    v_add_u32 v7, 128, v7
    v_add_u32 v10, 81920, v10
    ds_read_b64_tr_b16 v[56:57], v13 offset:27648
    ds_read_b64_tr_b16 v[58:59], v13 offset:32256
    ds_read_b64_tr_b16 v[60:61], v13 offset:27680
    ds_read_b64_tr_b16 v[62:63], v13 offset:32288
    ds_read_b64_tr_b16 v[64:65], v13 offset:27712
    ds_read_b64_tr_b16 v[66:67], v13 offset:32320
    ds_read_b64_tr_b16 v[68:69], v13 offset:27744
    ds_read_b64_tr_b16 v[70:71], v13 offset:32352
    ds_read_b64 v[48:49], v12 offset:27648
    ds_read_b64 v[50:51], v12 offset:27680
    ds_read_b64 v[52:53], v12 offset:29952
    ds_read_b64 v[54:55], v12 offset:29984
    s_waitcnt lgkmcnt(0)
    ds_read_b64_tr_b16 v[80:81], v13 offset:36864
    ds_read_b64_tr_b16 v[82:83], v13 offset:41472
    ds_read_b64_tr_b16 v[84:85], v13 offset:36896
    ds_read_b64_tr_b16 v[86:87], v13 offset:41504
    ds_read_b64_tr_b16 v[88:89], v13 offset:36928
    ds_read_b64_tr_b16 v[90:91], v13 offset:41536
    ds_read_b64_tr_b16 v[92:93], v13 offset:36960
    ds_read_b64_tr_b16 v[94:95], v13 offset:41568
    ds_read_b64 v[72:73], v12 offset:27712
    ds_read_b64 v[74:75], v12 offset:27744
    ds_read_b64 v[76:77], v12 offset:30016
    ds_read_b64 v[78:79], v12 offset:30048
    v_mfma_f32_16x16x32_bf16 v[16:19], v[56:59], v[48:51], v[16:19]
    v_mfma_f32_16x16x32_bf16 v[20:23], v[60:63], v[48:51], v[20:23]
    v_mfma_f32_16x16x32_bf16 v[24:27], v[64:67], v[48:51], v[24:27]
    v_mfma_f32_16x16x32_bf16 v[28:31], v[68:71], v[48:51], v[28:31]
    v_mfma_f32_16x16x32_bf16 v[32:35], v[56:59], v[52:55], v[32:35]
    v_mfma_f32_16x16x32_bf16 v[36:39], v[60:63], v[52:55], v[36:39]
    v_mfma_f32_16x16x32_bf16 v[40:43], v[64:67], v[52:55], v[40:43]
    v_mfma_f32_16x16x32_bf16 v[44:47], v[68:71], v[52:55], v[44:47]
    s_waitcnt lgkmcnt(0)
    v_mfma_f32_16x16x32_bf16 v[16:19], v[80:83], v[72:75], v[16:19]
    v_mfma_f32_16x16x32_bf16 v[20:23], v[84:87], v[72:75], v[20:23]
    v_mfma_f32_16x16x32_bf16 v[24:27], v[88:91], v[72:75], v[24:27]
    v_mfma_f32_16x16x32_bf16 v[28:31], v[92:95], v[72:75], v[28:31]
    v_mfma_f32_16x16x32_bf16 v[32:35], v[80:83], v[76:79], v[32:35]
    v_mfma_f32_16x16x32_bf16 v[36:39], v[84:87], v[76:79], v[36:39]
    v_mfma_f32_16x16x32_bf16 v[40:43], v[88:91], v[76:79], v[40:43]
    v_mfma_f32_16x16x32_bf16 v[44:47], v[92:95], v[76:79], v[44:47]
    s_waitcnt vmcnt(6)
    ds_write_b128 v8, v[96:99] offset:0
    ds_write_b128 v8, v[100:103] offset:4608
    ds_write_b128 v11, v[104:107] offset:0
    ds_write_b128 v11, v[108:111] offset:4608
    ds_write_b128 v11, v[112:115] offset:9216
    ds_write_b128 v11, v[116:119] offset:13824
    s_waitcnt lgkmcnt(0)
    s_barrier
    buffer_load_dwordx4 v[96:99], v7, s[40:43], s64 offen
    buffer_load_dwordx4 v[100:103], v7, s[40:43], s65 offen
    buffer_load_dwordx4 v[104:107], v10, s[60:63], s68 offen
    buffer_load_dwordx4 v[108:111], v10, s[60:63], s69 offen
    buffer_load_dwordx4 v[112:115], v10, s[60:63], s70 offen
    buffer_load_dwordx4 v[116:119], v10, s[60:63], s71 offen
    v_add_u32 v7, 128, v7
    v_add_u32 v10, 81920, v10
    ds_read_b64_tr_b16 v[56:57], v13 offset:0
    ds_read_b64_tr_b16 v[58:59], v13 offset:4608
    ds_read_b64_tr_b16 v[60:61], v13 offset:32
    ds_read_b64_tr_b16 v[62:63], v13 offset:4640
    ds_read_b64_tr_b16 v[64:65], v13 offset:64
    ds_read_b64_tr_b16 v[66:67], v13 offset:4672
    ds_read_b64_tr_b16 v[68:69], v13 offset:96
    ds_read_b64_tr_b16 v[70:71], v13 offset:4704
    ds_read_b64 v[48:49], v12 offset:0
    ds_read_b64 v[50:51], v12 offset:32
    ds_read_b64 v[52:53], v12 offset:2304
    ds_read_b64 v[54:55], v12 offset:2336
    s_waitcnt lgkmcnt(0)
    ds_read_b64_tr_b16 v[80:81], v13 offset:9216
    ds_read_b64_tr_b16 v[82:83], v13 offset:13824
    ds_read_b64_tr_b16 v[84:85], v13 offset:9248
    ds_read_b64_tr_b16 v[86:87], v13 offset:13856
    ds_read_b64_tr_b16 v[88:89], v13 offset:9280
    ds_read_b64_tr_b16 v[90:91], v13 offset:13888
    ds_read_b64_tr_b16 v[92:93], v13 offset:9312
    ds_read_b64_tr_b16 v[94:95], v13 offset:13920
    ds_read_b64 v[72:73], v12 offset:64
    ds_read_b64 v[74:75], v12 offset:96
    ds_read_b64 v[76:77], v12 offset:2368
    ds_read_b64 v[78:79], v12 offset:2400
    v_mfma_f32_16x16x32_bf16 v[16:19], v[56:59], v[48:51], v[16:19]
    v_mfma_f32_16x16x32_bf16 v[20:23], v[60:63], v[48:51], v[20:23]
    v_mfma_f32_16x16x32_bf16 v[24:27], v[64:67], v[48:51], v[24:27]
    v_mfma_f32_16x16x32_bf16 v[28:31], v[68:71], v[48:51], v[28:31]
    v_mfma_f32_16x16x32_bf16 v[32:35], v[56:59], v[52:55], v[32:35]
    v_mfma_f32_16x16x32_bf16 v[36:39], v[60:63], v[52:55], v[36:39]
    v_mfma_f32_16x16x32_bf16 v[40:43], v[64:67], v[52:55], v[40:43]
    v_mfma_f32_16x16x32_bf16 v[44:47], v[68:71], v[52:55], v[44:47]
    s_waitcnt lgkmcnt(0)
    v_mfma_f32_16x16x32_bf16 v[16:19], v[80:83], v[72:75], v[16:19]
    v_mfma_f32_16x16x32_bf16 v[20:23], v[84:87], v[72:75], v[20:23]
    v_mfma_f32_16x16x32_bf16 v[24:27], v[88:91], v[72:75], v[24:27]
    v_mfma_f32_16x16x32_bf16 v[28:31], v[92:95], v[72:75], v[28:31]
    v_mfma_f32_16x16x32_bf16 v[32:35], v[80:83], v[76:79], v[32:35]
    v_mfma_f32_16x16x32_bf16 v[36:39], v[84:87], v[76:79], v[36:39]
    v_mfma_f32_16x16x32_bf16 v[40:43], v[88:91], v[76:79], v[40:43]
    v_mfma_f32_16x16x32_bf16 v[44:47], v[92:95], v[76:79], v[44:47]
    s_waitcnt vmcnt(6)
    ds_write_b128 v8, v[120:123] offset:27648
    ds_write_b128 v8, v[124:127] offset:32256
    ds_write_b128 v11, v[128:131] offset:27648
    ds_write_b128 v11, v[132:135] offset:32256
    ds_write_b128 v11, v[136:139] offset:36864
    ds_write_b128 v11, v[140:143] offset:41472
    s_waitcnt lgkmcnt(0)
    s_barrier
    buffer_load_dwordx4 v[120:123], v7, s[40:43], s64 offen
    buffer_load_dwordx4 v[124:127], v7, s[40:43], s65 offen
    buffer_load_dwordx4 v[128:131], v10, s[60:63], s68 offen
    buffer_load_dwordx4 v[132:135], v10, s[60:63], s69 offen
    buffer_load_dwordx4 v[136:139], v10, s[60:63], s70 offen
    buffer_load_dwordx4 v[140:143], v10, s[60:63], s71 offen
    v_add_u32 v7, 128, v7
    v_add_u32 v10, 81920, v10
    ds_read_b64_tr_b16 v[56:57], v13 offset:27648
    ds_read_b64_tr_b16 v[58:59], v13 offset:32256
    ds_read_b64_tr_b16 v[60:61], v13 offset:27680
    ds_read_b64_tr_b16 v[62:63], v13 offset:32288
    ds_read_b64_tr_b16 v[64:65], v13 offset:27712
    ds_read_b64_tr_b16 v[66:67], v13 offset:32320
    ds_read_b64_tr_b16 v[68:69], v13 offset:27744
    ds_read_b64_tr_b16 v[70:71], v13 offset:32352
    ds_read_b64 v[48:49], v12 offset:27648
    ds_read_b64 v[50:51], v12 offset:27680
    ds_read_b64 v[52:53], v12 offset:29952
    ds_read_b64 v[54:55], v12 offset:29984
    s_waitcnt lgkmcnt(0)
    ds_read_b64_tr_b16 v[80:81], v13 offset:36864
    ds_read_b64_tr_b16 v[82:83], v13 offset:41472
    ds_read_b64_tr_b16 v[84:85], v13 offset:36896
    ds_read_b64_tr_b16 v[86:87], v13 offset:41504
    ds_read_b64_tr_b16 v[88:89], v13 offset:36928
    ds_read_b64_tr_b16 v[90:91], v13 offset:41536
    ds_read_b64_tr_b16 v[92:93], v13 offset:36960
    ds_read_b64_tr_b16 v[94:95], v13 offset:41568
    ds_read_b64 v[72:73], v12 offset:27712
    ds_read_b64 v[74:75], v12 offset:27744
    ds_read_b64 v[76:77], v12 offset:30016
    ds_read_b64 v[78:79], v12 offset:30048
    v_mfma_f32_16x16x32_bf16 v[16:19], v[56:59], v[48:51], v[16:19]
    v_mfma_f32_16x16x32_bf16 v[20:23], v[60:63], v[48:51], v[20:23]
    v_mfma_f32_16x16x32_bf16 v[24:27], v[64:67], v[48:51], v[24:27]
    v_mfma_f32_16x16x32_bf16 v[28:31], v[68:71], v[48:51], v[28:31]
    v_mfma_f32_16x16x32_bf16 v[32:35], v[56:59], v[52:55], v[32:35]
    v_mfma_f32_16x16x32_bf16 v[36:39], v[60:63], v[52:55], v[36:39]
    v_mfma_f32_16x16x32_bf16 v[40:43], v[64:67], v[52:55], v[40:43]
    v_mfma_f32_16x16x32_bf16 v[44:47], v[68:71], v[52:55], v[44:47]
    s_waitcnt lgkmcnt(0)
    v_mfma_f32_16x16x32_bf16 v[16:19], v[80:83], v[72:75], v[16:19]
    v_mfma_f32_16x16x32_bf16 v[20:23], v[84:87], v[72:75], v[20:23]
    v_mfma_f32_16x16x32_bf16 v[24:27], v[88:91], v[72:75], v[24:27]
    v_mfma_f32_16x16x32_bf16 v[28:31], v[92:95], v[72:75], v[28:31]
    v_mfma_f32_16x16x32_bf16 v[32:35], v[80:83], v[76:79], v[32:35]
    v_mfma_f32_16x16x32_bf16 v[36:39], v[84:87], v[76:79], v[36:39]
    v_mfma_f32_16x16x32_bf16 v[40:43], v[88:91], v[76:79], v[40:43]
    v_mfma_f32_16x16x32_bf16 v[44:47], v[92:95], v[76:79], v[44:47]
    s_waitcnt vmcnt(6)
    ds_write_b128 v8, v[96:99] offset:0
    ds_write_b128 v8, v[100:103] offset:4608
    ds_write_b128 v11, v[104:107] offset:0
    ds_write_b128 v11, v[108:111] offset:4608
    ds_write_b128 v11, v[112:115] offset:9216
    ds_write_b128 v11, v[116:119] offset:13824
    s_waitcnt lgkmcnt(0)
    s_barrier
    buffer_load_dwordx4 v[96:99], v7, s[40:43], s64 offen
    buffer_load_dwordx4 v[100:103], v7, s[40:43], s65 offen
    buffer_load_dwordx4 v[104:107], v10, s[60:63], s68 offen
    buffer_load_dwordx4 v[108:111], v10, s[60:63], s69 offen
    buffer_load_dwordx4 v[112:115], v10, s[60:63], s70 offen
    buffer_load_dwordx4 v[116:119], v10, s[60:63], s71 offen
    v_add_u32 v7, 128, v7
    v_add_u32 v10, 81920, v10
    ds_read_b64_tr_b16 v[56:57], v13 offset:0
    ds_read_b64_tr_b16 v[58:59], v13 offset:4608
    ds_read_b64_tr_b16 v[60:61], v13 offset:32
    ds_read_b64_tr_b16 v[62:63], v13 offset:4640
    ds_read_b64_tr_b16 v[64:65], v13 offset:64
    ds_read_b64_tr_b16 v[66:67], v13 offset:4672
    ds_read_b64_tr_b16 v[68:69], v13 offset:96
    ds_read_b64_tr_b16 v[70:71], v13 offset:4704
    ds_read_b64 v[48:49], v12 offset:0
    ds_read_b64 v[50:51], v12 offset:32
    ds_read_b64 v[52:53], v12 offset:2304
    ds_read_b64 v[54:55], v12 offset:2336
    s_waitcnt lgkmcnt(0)
    ds_read_b64_tr_b16 v[80:81], v13 offset:9216
    ds_read_b64_tr_b16 v[82:83], v13 offset:13824
    ds_read_b64_tr_b16 v[84:85], v13 offset:9248
    ds_read_b64_tr_b16 v[86:87], v13 offset:13856
    ds_read_b64_tr_b16 v[88:89], v13 offset:9280
    ds_read_b64_tr_b16 v[90:91], v13 offset:13888
    ds_read_b64_tr_b16 v[92:93], v13 offset:9312
    ds_read_b64_tr_b16 v[94:95], v13 offset:13920
    ds_read_b64 v[72:73], v12 offset:64
    ds_read_b64 v[74:75], v12 offset:96
    ds_read_b64 v[76:77], v12 offset:2368
    ds_read_b64 v[78:79], v12 offset:2400
    v_mfma_f32_16x16x32_bf16 v[16:19], v[56:59], v[48:51], v[16:19]
    v_mfma_f32_16x16x32_bf16 v[20:23], v[60:63], v[48:51], v[20:23]
    v_mfma_f32_16x16x32_bf16 v[24:27], v[64:67], v[48:51], v[24:27]
    v_mfma_f32_16x16x32_bf16 v[28:31], v[68:71], v[48:51], v[28:31]
    v_mfma_f32_16x16x32_bf16 v[32:35], v[56:59], v[52:55], v[32:35]
    v_mfma_f32_16x16x32_bf16 v[36:39], v[60:63], v[52:55], v[36:39]
    v_mfma_f32_16x16x32_bf16 v[40:43], v[64:67], v[52:55], v[40:43]
    v_mfma_f32_16x16x32_bf16 v[44:47], v[68:71], v[52:55], v[44:47]
    s_waitcnt lgkmcnt(0)
    v_mfma_f32_16x16x32_bf16 v[16:19], v[80:83], v[72:75], v[16:19]
    v_mfma_f32_16x16x32_bf16 v[20:23], v[84:87], v[72:75], v[20:23]
    v_mfma_f32_16x16x32_bf16 v[24:27], v[88:91], v[72:75], v[24:27]
    v_mfma_f32_16x16x32_bf16 v[28:31], v[92:95], v[72:75], v[28:31]
    v_mfma_f32_16x16x32_bf16 v[32:35], v[80:83], v[76:79], v[32:35]
    v_mfma_f32_16x16x32_bf16 v[36:39], v[84:87], v[76:79], v[36:39]
    v_mfma_f32_16x16x32_bf16 v[40:43], v[88:91], v[76:79], v[40:43]
    v_mfma_f32_16x16x32_bf16 v[44:47], v[92:95], v[76:79], v[44:47]
    s_waitcnt vmcnt(6)
    ds_write_b128 v8, v[120:123] offset:27648
    ds_write_b128 v8, v[124:127] offset:32256
    ds_write_b128 v11, v[128:131] offset:27648
    ds_write_b128 v11, v[132:135] offset:32256
    ds_write_b128 v11, v[136:139] offset:36864
    ds_write_b128 v11, v[140:143] offset:41472
    s_waitcnt lgkmcnt(0)
    s_barrier
    buffer_load_dwordx4 v[120:123], v7, s[40:43], s64 offen
    buffer_load_dwordx4 v[124:127], v7, s[40:43], s65 offen
    buffer_load_dwordx4 v[128:131], v10, s[60:63], s68 offen
    buffer_load_dwordx4 v[132:135], v10, s[60:63], s69 offen
    buffer_load_dwordx4 v[136:139], v10, s[60:63], s70 offen
    buffer_load_dwordx4 v[140:143], v10, s[60:63], s71 offen
    v_add_u32 v7, 128, v7
    v_add_u32 v10, 81920, v10
    ds_read_b64_tr_b16 v[56:57], v13 offset:27648
    ds_read_b64_tr_b16 v[58:59], v13 offset:32256
    ds_read_b64_tr_b16 v[60:61], v13 offset:27680
    ds_read_b64_tr_b16 v[62:63], v13 offset:32288
    ds_read_b64_tr_b16 v[64:65], v13 offset:27712
    ds_read_b64_tr_b16 v[66:67], v13 offset:32320
    ds_read_b64_tr_b16 v[68:69], v13 offset:27744
    ds_read_b64_tr_b16 v[70:71], v13 offset:32352
    ds_read_b64 v[48:49], v12 offset:27648
    ds_read_b64 v[50:51], v12 offset:27680
    ds_read_b64 v[52:53], v12 offset:29952
    ds_read_b64 v[54:55], v12 offset:29984
    s_waitcnt lgkmcnt(0)
    ds_read_b64_tr_b16 v[80:81], v13 offset:36864
    ds_read_b64_tr_b16 v[82:83], v13 offset:41472
    ds_read_b64_tr_b16 v[84:85], v13 offset:36896
    ds_read_b64_tr_b16 v[86:87], v13 offset:41504
    ds_read_b64_tr_b16 v[88:89], v13 offset:36928
    ds_read_b64_tr_b16 v[90:91], v13 offset:41536
    ds_read_b64_tr_b16 v[92:93], v13 offset:36960
    ds_read_b64_tr_b16 v[94:95], v13 offset:41568
    ds_read_b64 v[72:73], v12 offset:27712
    ds_read_b64 v[74:75], v12 offset:27744
    ds_read_b64 v[76:77], v12 offset:30016
    ds_read_b64 v[78:79], v12 offset:30048
    v_mfma_f32_16x16x32_bf16 v[16:19], v[56:59], v[48:51], v[16:19]
    v_mfma_f32_16x16x32_bf16 v[20:23], v[60:63], v[48:51], v[20:23]
    v_mfma_f32_16x16x32_bf16 v[24:27], v[64:67], v[48:51], v[24:27]
    v_mfma_f32_16x16x32_bf16 v[28:31], v[68:71], v[48:51], v[28:31]
    v_mfma_f32_16x16x32_bf16 v[32:35], v[56:59], v[52:55], v[32:35]
    v_mfma_f32_16x16x32_bf16 v[36:39], v[60:63], v[52:55], v[36:39]
    v_mfma_f32_16x16x32_bf16 v[40:43], v[64:67], v[52:55], v[40:43]
    v_mfma_f32_16x16x32_bf16 v[44:47], v[68:71], v[52:55], v[44:47]
    s_waitcnt lgkmcnt(0)
    v_mfma_f32_16x16x32_bf16 v[16:19], v[80:83], v[72:75], v[16:19]
    v_mfma_f32_16x16x32_bf16 v[20:23], v[84:87], v[72:75], v[20:23]
    v_mfma_f32_16x16x32_bf16 v[24:27], v[88:91], v[72:75], v[24:27]
    v_mfma_f32_16x16x32_bf16 v[28:31], v[92:95], v[72:75], v[28:31]
    v_mfma_f32_16x16x32_bf16 v[32:35], v[80:83], v[76:79], v[32:35]
    v_mfma_f32_16x16x32_bf16 v[36:39], v[84:87], v[76:79], v[36:39]
    v_mfma_f32_16x16x32_bf16 v[40:43], v[88:91], v[76:79], v[40:43]
    v_mfma_f32_16x16x32_bf16 v[44:47], v[92:95], v[76:79], v[44:47]
    s_waitcnt vmcnt(6)
    ds_write_b128 v8, v[96:99] offset:0
    ds_write_b128 v8, v[100:103] offset:4608
    ds_write_b128 v11, v[104:107] offset:0
    ds_write_b128 v11, v[108:111] offset:4608
    ds_write_b128 v11, v[112:115] offset:9216
    ds_write_b128 v11, v[116:119] offset:13824
    s_waitcnt lgkmcnt(0)
    s_barrier
    buffer_load_dwordx4 v[96:99], v7, s[40:43], s64 offen
    buffer_load_dwordx4 v[100:103], v7, s[40:43], s65 offen
    buffer_load_dwordx4 v[104:107], v10, s[60:63], s68 offen
    buffer_load_dwordx4 v[108:111], v10, s[60:63], s69 offen
    buffer_load_dwordx4 v[112:115], v10, s[60:63], s70 offen
    buffer_load_dwordx4 v[116:119], v10, s[60:63], s71 offen
    v_add_u32 v7, 128, v7
    v_add_u32 v10, 81920, v10
    ds_read_b64_tr_b16 v[56:57], v13 offset:0
    ds_read_b64_tr_b16 v[58:59], v13 offset:4608
    ds_read_b64_tr_b16 v[60:61], v13 offset:32
    ds_read_b64_tr_b16 v[62:63], v13 offset:4640
    ds_read_b64_tr_b16 v[64:65], v13 offset:64
    ds_read_b64_tr_b16 v[66:67], v13 offset:4672
    ds_read_b64_tr_b16 v[68:69], v13 offset:96
    ds_read_b64_tr_b16 v[70:71], v13 offset:4704
    ds_read_b64 v[48:49], v12 offset:0
    ds_read_b64 v[50:51], v12 offset:32
    ds_read_b64 v[52:53], v12 offset:2304
    ds_read_b64 v[54:55], v12 offset:2336
    s_waitcnt lgkmcnt(0)
    ds_read_b64_tr_b16 v[80:81], v13 offset:9216
    ds_read_b64_tr_b16 v[82:83], v13 offset:13824
    ds_read_b64_tr_b16 v[84:85], v13 offset:9248
    ds_read_b64_tr_b16 v[86:87], v13 offset:13856
    ds_read_b64_tr_b16 v[88:89], v13 offset:9280
    ds_read_b64_tr_b16 v[90:91], v13 offset:13888
    ds_read_b64_tr_b16 v[92:93], v13 offset:9312
    ds_read_b64_tr_b16 v[94:95], v13 offset:13920
    ds_read_b64 v[72:73], v12 offset:64
    ds_read_b64 v[74:75], v12 offset:96
    ds_read_b64 v[76:77], v12 offset:2368
    ds_read_b64 v[78:79], v12 offset:2400
    v_mfma_f32_16x16x32_bf16 v[16:19], v[56:59], v[48:51], v[16:19]
    v_mfma_f32_16x16x32_bf16 v[20:23], v[60:63], v[48:51], v[20:23]
    v_mfma_f32_16x16x32_bf16 v[24:27], v[64:67], v[48:51], v[24:27]
    v_mfma_f32_16x16x32_bf16 v[28:31], v[68:71], v[48:51], v[28:31]
    v_mfma_f32_16x16x32_bf16 v[32:35], v[56:59], v[52:55], v[32:35]
    v_mfma_f32_16x16x32_bf16 v[36:39], v[60:63], v[52:55], v[36:39]
    v_mfma_f32_16x16x32_bf16 v[40:43], v[64:67], v[52:55], v[40:43]
    v_mfma_f32_16x16x32_bf16 v[44:47], v[68:71], v[52:55], v[44:47]
    s_waitcnt lgkmcnt(0)
    v_mfma_f32_16x16x32_bf16 v[16:19], v[80:83], v[72:75], v[16:19]
    v_mfma_f32_16x16x32_bf16 v[20:23], v[84:87], v[72:75], v[20:23]
    v_mfma_f32_16x16x32_bf16 v[24:27], v[88:91], v[72:75], v[24:27]
    v_mfma_f32_16x16x32_bf16 v[28:31], v[92:95], v[72:75], v[28:31]
    v_mfma_f32_16x16x32_bf16 v[32:35], v[80:83], v[76:79], v[32:35]
    v_mfma_f32_16x16x32_bf16 v[36:39], v[84:87], v[76:79], v[36:39]
    v_mfma_f32_16x16x32_bf16 v[40:43], v[88:91], v[76:79], v[40:43]
    v_mfma_f32_16x16x32_bf16 v[44:47], v[92:95], v[76:79], v[44:47]
    s_waitcnt vmcnt(6)
    ds_write_b128 v8, v[120:123] offset:27648
    ds_write_b128 v8, v[124:127] offset:32256
    ds_write_b128 v11, v[128:131] offset:27648
    ds_write_b128 v11, v[132:135] offset:32256
    ds_write_b128 v11, v[136:139] offset:36864
    ds_write_b128 v11, v[140:143] offset:41472
    s_waitcnt lgkmcnt(0)
    s_barrier
    buffer_load_dwordx4 v[120:123], v7, s[40:43], s64 offen
    buffer_load_dwordx4 v[124:127], v7, s[40:43], s65 offen
    buffer_load_dwordx4 v[128:131], v10, s[60:63], s68 offen
    buffer_load_dwordx4 v[132:135], v10, s[60:63], s69 offen
    buffer_load_dwordx4 v[136:139], v10, s[60:63], s70 offen
    buffer_load_dwordx4 v[140:143], v10, s[60:63], s71 offen
    v_add_u32 v7, 128, v7
    v_add_u32 v10, 81920, v10
    ds_read_b64_tr_b16 v[56:57], v13 offset:27648
    ds_read_b64_tr_b16 v[58:59], v13 offset:32256
    ds_read_b64_tr_b16 v[60:61], v13 offset:27680
    ds_read_b64_tr_b16 v[62:63], v13 offset:32288
    ds_read_b64_tr_b16 v[64:65], v13 offset:27712
    ds_read_b64_tr_b16 v[66:67], v13 offset:32320
    ds_read_b64_tr_b16 v[68:69], v13 offset:27744
    ds_read_b64_tr_b16 v[70:71], v13 offset:32352
    ds_read_b64 v[48:49], v12 offset:27648
    ds_read_b64 v[50:51], v12 offset:27680
    ds_read_b64 v[52:53], v12 offset:29952
    ds_read_b64 v[54:55], v12 offset:29984
    s_waitcnt lgkmcnt(0)
    ds_read_b64_tr_b16 v[80:81], v13 offset:36864
    ds_read_b64_tr_b16 v[82:83], v13 offset:41472
    ds_read_b64_tr_b16 v[84:85], v13 offset:36896
    ds_read_b64_tr_b16 v[86:87], v13 offset:41504
    ds_read_b64_tr_b16 v[88:89], v13 offset:36928
    ds_read_b64_tr_b16 v[90:91], v13 offset:41536
    ds_read_b64_tr_b16 v[92:93], v13 offset:36960
    ds_read_b64_tr_b16 v[94:95], v13 offset:41568
    ds_read_b64 v[72:73], v12 offset:27712
    ds_read_b64 v[74:75], v12 offset:27744
    ds_read_b64 v[76:77], v12 offset:30016
    ds_read_b64 v[78:79], v12 offset:30048
    v_mfma_f32_16x16x32_bf16 v[16:19], v[56:59], v[48:51], v[16:19]
    v_mfma_f32_16x16x32_bf16 v[20:23], v[60:63], v[48:51], v[20:23]
    v_mfma_f32_16x16x32_bf16 v[24:27], v[64:67], v[48:51], v[24:27]
    v_mfma_f32_16x16x32_bf16 v[28:31], v[68:71], v[48:51], v[28:31]
    v_mfma_f32_16x16x32_bf16 v[32:35], v[56:59], v[52:55], v[32:35]
    v_mfma_f32_16x16x32_bf16 v[36:39], v[60:63], v[52:55], v[36:39]
    v_mfma_f32_16x16x32_bf16 v[40:43], v[64:67], v[52:55], v[40:43]
    v_mfma_f32_16x16x32_bf16 v[44:47], v[68:71], v[52:55], v[44:47]
    s_waitcnt lgkmcnt(0)
    v_mfma_f32_16x16x32_bf16 v[16:19], v[80:83], v[72:75], v[16:19]
    v_mfma_f32_16x16x32_bf16 v[20:23], v[84:87], v[72:75], v[20:23]
    v_mfma_f32_16x16x32_bf16 v[24:27], v[88:91], v[72:75], v[24:27]
    v_mfma_f32_16x16x32_bf16 v[28:31], v[92:95], v[72:75], v[28:31]
    v_mfma_f32_16x16x32_bf16 v[32:35], v[80:83], v[76:79], v[32:35]
    v_mfma_f32_16x16x32_bf16 v[36:39], v[84:87], v[76:79], v[36:39]
    v_mfma_f32_16x16x32_bf16 v[40:43], v[88:91], v[76:79], v[40:43]
    v_mfma_f32_16x16x32_bf16 v[44:47], v[92:95], v[76:79], v[44:47]
    s_waitcnt vmcnt(6)
    ds_write_b128 v8, v[96:99] offset:0
    ds_write_b128 v8, v[100:103] offset:4608
    ds_write_b128 v11, v[104:107] offset:0
    ds_write_b128 v11, v[108:111] offset:4608
    ds_write_b128 v11, v[112:115] offset:9216
    ds_write_b128 v11, v[116:119] offset:13824
    s_waitcnt lgkmcnt(0)
    s_barrier
    buffer_load_dwordx4 v[96:99], v7, s[40:43], s64 offen
    buffer_load_dwordx4 v[100:103], v7, s[40:43], s65 offen
    buffer_load_dwordx4 v[104:107], v10, s[60:63], s68 offen
    buffer_load_dwordx4 v[108:111], v10, s[60:63], s69 offen
    buffer_load_dwordx4 v[112:115], v10, s[60:63], s70 offen
    buffer_load_dwordx4 v[116:119], v10, s[60:63], s71 offen
    v_add_u32 v7, 128, v7
    v_add_u32 v10, 81920, v10
    ds_read_b64_tr_b16 v[56:57], v13 offset:0
    ds_read_b64_tr_b16 v[58:59], v13 offset:4608
    ds_read_b64_tr_b16 v[60:61], v13 offset:32
    ds_read_b64_tr_b16 v[62:63], v13 offset:4640
    ds_read_b64_tr_b16 v[64:65], v13 offset:64
    ds_read_b64_tr_b16 v[66:67], v13 offset:4672
    ds_read_b64_tr_b16 v[68:69], v13 offset:96
    ds_read_b64_tr_b16 v[70:71], v13 offset:4704
    ds_read_b64 v[48:49], v12 offset:0
    ds_read_b64 v[50:51], v12 offset:32
    ds_read_b64 v[52:53], v12 offset:2304
    ds_read_b64 v[54:55], v12 offset:2336
    s_waitcnt lgkmcnt(0)
    ds_read_b64_tr_b16 v[80:81], v13 offset:9216
    ds_read_b64_tr_b16 v[82:83], v13 offset:13824
    ds_read_b64_tr_b16 v[84:85], v13 offset:9248
    ds_read_b64_tr_b16 v[86:87], v13 offset:13856
    ds_read_b64_tr_b16 v[88:89], v13 offset:9280
    ds_read_b64_tr_b16 v[90:91], v13 offset:13888
    ds_read_b64_tr_b16 v[92:93], v13 offset:9312
    ds_read_b64_tr_b16 v[94:95], v13 offset:13920
    ds_read_b64 v[72:73], v12 offset:64
    ds_read_b64 v[74:75], v12 offset:96
    ds_read_b64 v[76:77], v12 offset:2368
    ds_read_b64 v[78:79], v12 offset:2400
    v_mfma_f32_16x16x32_bf16 v[16:19], v[56:59], v[48:51], v[16:19]
    v_mfma_f32_16x16x32_bf16 v[20:23], v[60:63], v[48:51], v[20:23]
    v_mfma_f32_16x16x32_bf16 v[24:27], v[64:67], v[48:51], v[24:27]
    v_mfma_f32_16x16x32_bf16 v[28:31], v[68:71], v[48:51], v[28:31]
    v_mfma_f32_16x16x32_bf16 v[32:35], v[56:59], v[52:55], v[32:35]
    v_mfma_f32_16x16x32_bf16 v[36:39], v[60:63], v[52:55], v[36:39]
    v_mfma_f32_16x16x32_bf16 v[40:43], v[64:67], v[52:55], v[40:43]
    v_mfma_f32_16x16x32_bf16 v[44:47], v[68:71], v[52:55], v[44:47]
    s_waitcnt lgkmcnt(0)
    v_mfma_f32_16x16x32_bf16 v[16:19], v[80:83], v[72:75], v[16:19]
    v_mfma_f32_16x16x32_bf16 v[20:23], v[84:87], v[72:75], v[20:23]
    v_mfma_f32_16x16x32_bf16 v[24:27], v[88:91], v[72:75], v[24:27]
    v_mfma_f32_16x16x32_bf16 v[28:31], v[92:95], v[72:75], v[28:31]
    v_mfma_f32_16x16x32_bf16 v[32:35], v[80:83], v[76:79], v[32:35]
    v_mfma_f32_16x16x32_bf16 v[36:39], v[84:87], v[76:79], v[36:39]
    v_mfma_f32_16x16x32_bf16 v[40:43], v[88:91], v[76:79], v[40:43]
    v_mfma_f32_16x16x32_bf16 v[44:47], v[92:95], v[76:79], v[44:47]
    s_waitcnt vmcnt(6)
    ds_write_b128 v8, v[120:123] offset:27648
    ds_write_b128 v8, v[124:127] offset:32256
    ds_write_b128 v11, v[128:131] offset:27648
    ds_write_b128 v11, v[132:135] offset:32256
    ds_write_b128 v11, v[136:139] offset:36864
    ds_write_b128 v11, v[140:143] offset:41472
    s_waitcnt lgkmcnt(0)
    s_barrier
    buffer_load_dwordx4 v[120:123], v7, s[40:43], s64 offen
    buffer_load_dwordx4 v[124:127], v7, s[40:43], s65 offen
    buffer_load_dwordx4 v[128:131], v10, s[60:63], s68 offen
    buffer_load_dwordx4 v[132:135], v10, s[60:63], s69 offen
    buffer_load_dwordx4 v[136:139], v10, s[60:63], s70 offen
    buffer_load_dwordx4 v[140:143], v10, s[60:63], s71 offen
    v_add_u32 v7, 128, v7
    v_add_u32 v10, 81920, v10
    ds_read_b64_tr_b16 v[56:57], v13 offset:27648
    ds_read_b64_tr_b16 v[58:59], v13 offset:32256
    ds_read_b64_tr_b16 v[60:61], v13 offset:27680
    ds_read_b64_tr_b16 v[62:63], v13 offset:32288
    ds_read_b64_tr_b16 v[64:65], v13 offset:27712
    ds_read_b64_tr_b16 v[66:67], v13 offset:32320
    ds_read_b64_tr_b16 v[68:69], v13 offset:27744
    ds_read_b64_tr_b16 v[70:71], v13 offset:32352
    ds_read_b64 v[48:49], v12 offset:27648
    ds_read_b64 v[50:51], v12 offset:27680
    ds_read_b64 v[52:53], v12 offset:29952
    ds_read_b64 v[54:55], v12 offset:29984
    s_waitcnt lgkmcnt(0)
    ds_read_b64_tr_b16 v[80:81], v13 offset:36864
    ds_read_b64_tr_b16 v[82:83], v13 offset:41472
    ds_read_b64_tr_b16 v[84:85], v13 offset:36896
    ds_read_b64_tr_b16 v[86:87], v13 offset:41504
    ds_read_b64_tr_b16 v[88:89], v13 offset:36928
    ds_read_b64_tr_b16 v[90:91], v13 offset:41536
    ds_read_b64_tr_b16 v[92:93], v13 offset:36960
    ds_read_b64_tr_b16 v[94:95], v13 offset:41568
    ds_read_b64 v[72:73], v12 offset:27712
    ds_read_b64 v[74:75], v12 offset:27744
    ds_read_b64 v[76:77], v12 offset:30016
    ds_read_b64 v[78:79], v12 offset:30048
    v_mfma_f32_16x16x32_bf16 v[16:19], v[56:59], v[48:51], v[16:19]
    v_mfma_f32_16x16x32_bf16 v[20:23], v[60:63], v[48:51], v[20:23]
    v_mfma_f32_16x16x32_bf16 v[24:27], v[64:67], v[48:51], v[24:27]
    v_mfma_f32_16x16x32_bf16 v[28:31], v[68:71], v[48:51], v[28:31]
    v_mfma_f32_16x16x32_bf16 v[32:35], v[56:59], v[52:55], v[32:35]
    v_mfma_f32_16x16x32_bf16 v[36:39], v[60:63], v[52:55], v[36:39]
    v_mfma_f32_16x16x32_bf16 v[40:43], v[64:67], v[52:55], v[40:43]
    v_mfma_f32_16x16x32_bf16 v[44:47], v[68:71], v[52:55], v[44:47]
    s_waitcnt lgkmcnt(0)
    v_mfma_f32_16x16x32_bf16 v[16:19], v[80:83], v[72:75], v[16:19]
    v_mfma_f32_16x16x32_bf16 v[20:23], v[84:87], v[72:75], v[20:23]
    v_mfma_f32_16x16x32_bf16 v[24:27], v[88:91], v[72:75], v[24:27]
    v_mfma_f32_16x16x32_bf16 v[28:31], v[92:95], v[72:75], v[28:31]
    v_mfma_f32_16x16x32_bf16 v[32:35], v[80:83], v[76:79], v[32:35]
    v_mfma_f32_16x16x32_bf16 v[36:39], v[84:87], v[76:79], v[36:39]
    v_mfma_f32_16x16x32_bf16 v[40:43], v[88:91], v[76:79], v[40:43]
    v_mfma_f32_16x16x32_bf16 v[44:47], v[92:95], v[76:79], v[44:47]
    s_waitcnt vmcnt(6)
    ds_write_b128 v8, v[96:99] offset:0
    ds_write_b128 v8, v[100:103] offset:4608
    ds_write_b128 v11, v[104:107] offset:0
    ds_write_b128 v11, v[108:111] offset:4608
    ds_write_b128 v11, v[112:115] offset:9216
    ds_write_b128 v11, v[116:119] offset:13824
    s_waitcnt lgkmcnt(0)
    s_barrier
    buffer_load_dwordx4 v[96:99], v7, s[40:43], s64 offen
    buffer_load_dwordx4 v[100:103], v7, s[40:43], s65 offen
    buffer_load_dwordx4 v[104:107], v10, s[60:63], s68 offen
    buffer_load_dwordx4 v[108:111], v10, s[60:63], s69 offen
    buffer_load_dwordx4 v[112:115], v10, s[60:63], s70 offen
    buffer_load_dwordx4 v[116:119], v10, s[60:63], s71 offen
    v_add_u32 v7, 128, v7
    v_add_u32 v10, 81920, v10
    ds_read_b64_tr_b16 v[56:57], v13 offset:0
    ds_read_b64_tr_b16 v[58:59], v13 offset:4608
    ds_read_b64_tr_b16 v[60:61], v13 offset:32
    ds_read_b64_tr_b16 v[62:63], v13 offset:4640
    ds_read_b64_tr_b16 v[64:65], v13 offset:64
    ds_read_b64_tr_b16 v[66:67], v13 offset:4672
    ds_read_b64_tr_b16 v[68:69], v13 offset:96
    ds_read_b64_tr_b16 v[70:71], v13 offset:4704
    ds_read_b64 v[48:49], v12 offset:0
    ds_read_b64 v[50:51], v12 offset:32
    ds_read_b64 v[52:53], v12 offset:2304
    ds_read_b64 v[54:55], v12 offset:2336
    s_waitcnt lgkmcnt(0)
    ds_read_b64_tr_b16 v[80:81], v13 offset:9216
    ds_read_b64_tr_b16 v[82:83], v13 offset:13824
    ds_read_b64_tr_b16 v[84:85], v13 offset:9248
    ds_read_b64_tr_b16 v[86:87], v13 offset:13856
    ds_read_b64_tr_b16 v[88:89], v13 offset:9280
    ds_read_b64_tr_b16 v[90:91], v13 offset:13888
    ds_read_b64_tr_b16 v[92:93], v13 offset:9312
    ds_read_b64_tr_b16 v[94:95], v13 offset:13920
    ds_read_b64 v[72:73], v12 offset:64
    ds_read_b64 v[74:75], v12 offset:96
    ds_read_b64 v[76:77], v12 offset:2368
    ds_read_b64 v[78:79], v12 offset:2400
    v_mfma_f32_16x16x32_bf16 v[16:19], v[56:59], v[48:51], v[16:19]
    v_mfma_f32_16x16x32_bf16 v[20:23], v[60:63], v[48:51], v[20:23]
    v_mfma_f32_16x16x32_bf16 v[24:27], v[64:67], v[48:51], v[24:27]
    v_mfma_f32_16x16x32_bf16 v[28:31], v[68:71], v[48:51], v[28:31]
    v_mfma_f32_16x16x32_bf16 v[32:35], v[56:59], v[52:55], v[32:35]
    v_mfma_f32_16x16x32_bf16 v[36:39], v[60:63], v[52:55], v[36:39]
    v_mfma_f32_16x16x32_bf16 v[40:43], v[64:67], v[52:55], v[40:43]
    v_mfma_f32_16x16x32_bf16 v[44:47], v[68:71], v[52:55], v[44:47]
    s_waitcnt lgkmcnt(0)
    v_mfma_f32_16x16x32_bf16 v[16:19], v[80:83], v[72:75], v[16:19]
    v_mfma_f32_16x16x32_bf16 v[20:23], v[84:87], v[72:75], v[20:23]
    v_mfma_f32_16x16x32_bf16 v[24:27], v[88:91], v[72:75], v[24:27]
    v_mfma_f32_16x16x32_bf16 v[28:31], v[92:95], v[72:75], v[28:31]
    v_mfma_f32_16x16x32_bf16 v[32:35], v[80:83], v[76:79], v[32:35]
    v_mfma_f32_16x16x32_bf16 v[36:39], v[84:87], v[76:79], v[36:39]
    v_mfma_f32_16x16x32_bf16 v[40:43], v[88:91], v[76:79], v[40:43]
    v_mfma_f32_16x16x32_bf16 v[44:47], v[92:95], v[76:79], v[44:47]
    s_waitcnt vmcnt(6)
    ds_write_b128 v8, v[120:123] offset:27648
    ds_write_b128 v8, v[124:127] offset:32256
    ds_write_b128 v11, v[128:131] offset:27648
    ds_write_b128 v11, v[132:135] offset:32256
    ds_write_b128 v11, v[136:139] offset:36864
    ds_write_b128 v11, v[140:143] offset:41472
    s_waitcnt lgkmcnt(0)
    s_barrier
    buffer_load_dwordx4 v[120:123], v7, s[40:43], s64 offen
    buffer_load_dwordx4 v[124:127], v7, s[40:43], s65 offen
    buffer_load_dwordx4 v[128:131], v10, s[60:63], s68 offen
    buffer_load_dwordx4 v[132:135], v10, s[60:63], s69 offen
    buffer_load_dwordx4 v[136:139], v10, s[60:63], s70 offen
    buffer_load_dwordx4 v[140:143], v10, s[60:63], s71 offen
    v_add_u32 v7, 128, v7
    v_add_u32 v10, 81920, v10
    ds_read_b64_tr_b16 v[56:57], v13 offset:27648
    ds_read_b64_tr_b16 v[58:59], v13 offset:32256
    ds_read_b64_tr_b16 v[60:61], v13 offset:27680
    ds_read_b64_tr_b16 v[62:63], v13 offset:32288
    ds_read_b64_tr_b16 v[64:65], v13 offset:27712
    ds_read_b64_tr_b16 v[66:67], v13 offset:32320
    ds_read_b64_tr_b16 v[68:69], v13 offset:27744
    ds_read_b64_tr_b16 v[70:71], v13 offset:32352
    ds_read_b64 v[48:49], v12 offset:27648
    ds_read_b64 v[50:51], v12 offset:27680
    ds_read_b64 v[52:53], v12 offset:29952
    ds_read_b64 v[54:55], v12 offset:29984
    s_waitcnt lgkmcnt(0)
    ds_read_b64_tr_b16 v[80:81], v13 offset:36864
    ds_read_b64_tr_b16 v[82:83], v13 offset:41472
    ds_read_b64_tr_b16 v[84:85], v13 offset:36896
    ds_read_b64_tr_b16 v[86:87], v13 offset:41504
    ds_read_b64_tr_b16 v[88:89], v13 offset:36928
    ds_read_b64_tr_b16 v[90:91], v13 offset:41536
    ds_read_b64_tr_b16 v[92:93], v13 offset:36960
    ds_read_b64_tr_b16 v[94:95], v13 offset:41568
    ds_read_b64 v[72:73], v12 offset:27712
    ds_read_b64 v[74:75], v12 offset:27744
    ds_read_b64 v[76:77], v12 offset:30016
    ds_read_b64 v[78:79], v12 offset:30048
    v_mfma_f32_16x16x32_bf16 v[16:19], v[56:59], v[48:51], v[16:19]
    v_mfma_f32_16x16x32_bf16 v[20:23], v[60:63], v[48:51], v[20:23]
    v_mfma_f32_16x16x32_bf16 v[24:27], v[64:67], v[48:51], v[24:27]
    v_mfma_f32_16x16x32_bf16 v[28:31], v[68:71], v[48:51], v[28:31]
    v_mfma_f32_16x16x32_bf16 v[32:35], v[56:59], v[52:55], v[32:35]
    v_mfma_f32_16x16x32_bf16 v[36:39], v[60:63], v[52:55], v[36:39]
    v_mfma_f32_16x16x32_bf16 v[40:43], v[64:67], v[52:55], v[40:43]
    v_mfma_f32_16x16x32_bf16 v[44:47], v[68:71], v[52:55], v[44:47]
    s_waitcnt lgkmcnt(0)
    v_mfma_f32_16x16x32_bf16 v[16:19], v[80:83], v[72:75], v[16:19]
    v_mfma_f32_16x16x32_bf16 v[20:23], v[84:87], v[72:75], v[20:23]
    v_mfma_f32_16x16x32_bf16 v[24:27], v[88:91], v[72:75], v[24:27]
    v_mfma_f32_16x16x32_bf16 v[28:31], v[92:95], v[72:75], v[28:31]
    v_mfma_f32_16x16x32_bf16 v[32:35], v[80:83], v[76:79], v[32:35]
    v_mfma_f32_16x16x32_bf16 v[36:39], v[84:87], v[76:79], v[36:39]
    v_mfma_f32_16x16x32_bf16 v[40:43], v[88:91], v[76:79], v[40:43]
    v_mfma_f32_16x16x32_bf16 v[44:47], v[92:95], v[76:79], v[44:47]
    s_waitcnt vmcnt(6)
    ds_write_b128 v8, v[96:99] offset:0
    ds_write_b128 v8, v[100:103] offset:4608
    ds_write_b128 v11, v[104:107] offset:0
    ds_write_b128 v11, v[108:111] offset:4608
    ds_write_b128 v11, v[112:115] offset:9216
    ds_write_b128 v11, v[116:119] offset:13824
    s_waitcnt lgkmcnt(0)
    s_barrier
    buffer_load_dwordx4 v[96:99], v7, s[40:43], s64 offen
    buffer_load_dwordx4 v[100:103], v7, s[40:43], s65 offen
    buffer_load_dwordx4 v[104:107], v10, s[60:63], s68 offen
    buffer_load_dwordx4 v[108:111], v10, s[60:63], s69 offen
    buffer_load_dwordx4 v[112:115], v10, s[60:63], s70 offen
    buffer_load_dwordx4 v[116:119], v10, s[60:63], s71 offen
    v_add_u32 v7, 128, v7
    v_add_u32 v10, 81920, v10
    ds_read_b64_tr_b16 v[56:57], v13 offset:0
    ds_read_b64_tr_b16 v[58:59], v13 offset:4608
    ds_read_b64_tr_b16 v[60:61], v13 offset:32
    ds_read_b64_tr_b16 v[62:63], v13 offset:4640
    ds_read_b64_tr_b16 v[64:65], v13 offset:64
    ds_read_b64_tr_b16 v[66:67], v13 offset:4672
    ds_read_b64_tr_b16 v[68:69], v13 offset:96
    ds_read_b64_tr_b16 v[70:71], v13 offset:4704
    ds_read_b64 v[48:49], v12 offset:0
    ds_read_b64 v[50:51], v12 offset:32
    ds_read_b64 v[52:53], v12 offset:2304
    ds_read_b64 v[54:55], v12 offset:2336
    s_waitcnt lgkmcnt(0)
    ds_read_b64_tr_b16 v[80:81], v13 offset:9216
    ds_read_b64_tr_b16 v[82:83], v13 offset:13824
    ds_read_b64_tr_b16 v[84:85], v13 offset:9248
    ds_read_b64_tr_b16 v[86:87], v13 offset:13856
    ds_read_b64_tr_b16 v[88:89], v13 offset:9280
    ds_read_b64_tr_b16 v[90:91], v13 offset:13888
    ds_read_b64_tr_b16 v[92:93], v13 offset:9312
    ds_read_b64_tr_b16 v[94:95], v13 offset:13920
    ds_read_b64 v[72:73], v12 offset:64
    ds_read_b64 v[74:75], v12 offset:96
    ds_read_b64 v[76:77], v12 offset:2368
    ds_read_b64 v[78:79], v12 offset:2400
    v_mfma_f32_16x16x32_bf16 v[16:19], v[56:59], v[48:51], v[16:19]
    v_mfma_f32_16x16x32_bf16 v[20:23], v[60:63], v[48:51], v[20:23]
    v_mfma_f32_16x16x32_bf16 v[24:27], v[64:67], v[48:51], v[24:27]
    v_mfma_f32_16x16x32_bf16 v[28:31], v[68:71], v[48:51], v[28:31]
    v_mfma_f32_16x16x32_bf16 v[32:35], v[56:59], v[52:55], v[32:35]
    v_mfma_f32_16x16x32_bf16 v[36:39], v[60:63], v[52:55], v[36:39]
    v_mfma_f32_16x16x32_bf16 v[40:43], v[64:67], v[52:55], v[40:43]
    v_mfma_f32_16x16x32_bf16 v[44:47], v[68:71], v[52:55], v[44:47]
    s_waitcnt lgkmcnt(0)
    v_mfma_f32_16x16x32_bf16 v[16:19], v[80:83], v[72:75], v[16:19]
    v_mfma_f32_16x16x32_bf16 v[20:23], v[84:87], v[72:75], v[20:23]
    v_mfma_f32_16x16x32_bf16 v[24:27], v[88:91], v[72:75], v[24:27]
    v_mfma_f32_16x16x32_bf16 v[28:31], v[92:95], v[72:75], v[28:31]
    v_mfma_f32_16x16x32_bf16 v[32:35], v[80:83], v[76:79], v[32:35]
    v_mfma_f32_16x16x32_bf16 v[36:39], v[84:87], v[76:79], v[36:39]
    v_mfma_f32_16x16x32_bf16 v[40:43], v[88:91], v[76:79], v[40:43]
    v_mfma_f32_16x16x32_bf16 v[44:47], v[92:95], v[76:79], v[44:47]
    s_waitcnt vmcnt(6)
    ds_write_b128 v8, v[120:123] offset:27648
    ds_write_b128 v8, v[124:127] offset:32256
    ds_write_b128 v11, v[128:131] offset:27648
    ds_write_b128 v11, v[132:135] offset:32256
    ds_write_b128 v11, v[136:139] offset:36864
    ds_write_b128 v11, v[140:143] offset:41472
    s_waitcnt lgkmcnt(0)
    s_barrier
    buffer_load_dwordx4 v[120:123], v7, s[40:43], s64 offen
    buffer_load_dwordx4 v[124:127], v7, s[40:43], s65 offen
    buffer_load_dwordx4 v[128:131], v10, s[60:63], s68 offen
    buffer_load_dwordx4 v[132:135], v10, s[60:63], s69 offen
    buffer_load_dwordx4 v[136:139], v10, s[60:63], s70 offen
    buffer_load_dwordx4 v[140:143], v10, s[60:63], s71 offen
    v_add_u32 v7, 128, v7
    v_add_u32 v10, 81920, v10
    ds_read_b64_tr_b16 v[56:57], v13 offset:27648
    ds_read_b64_tr_b16 v[58:59], v13 offset:32256
    ds_read_b64_tr_b16 v[60:61], v13 offset:27680
    ds_read_b64_tr_b16 v[62:63], v13 offset:32288
    ds_read_b64_tr_b16 v[64:65], v13 offset:27712
    ds_read_b64_tr_b16 v[66:67], v13 offset:32320
    ds_read_b64_tr_b16 v[68:69], v13 offset:27744
    ds_read_b64_tr_b16 v[70:71], v13 offset:32352
    ds_read_b64 v[48:49], v12 offset:27648
    ds_read_b64 v[50:51], v12 offset:27680
    ds_read_b64 v[52:53], v12 offset:29952
    ds_read_b64 v[54:55], v12 offset:29984
    s_waitcnt lgkmcnt(0)
    ds_read_b64_tr_b16 v[80:81], v13 offset:36864
    ds_read_b64_tr_b16 v[82:83], v13 offset:41472
    ds_read_b64_tr_b16 v[84:85], v13 offset:36896
    ds_read_b64_tr_b16 v[86:87], v13 offset:41504
    ds_read_b64_tr_b16 v[88:89], v13 offset:36928
    ds_read_b64_tr_b16 v[90:91], v13 offset:41536
    ds_read_b64_tr_b16 v[92:93], v13 offset:36960
    ds_read_b64_tr_b16 v[94:95], v13 offset:41568
    ds_read_b64 v[72:73], v12 offset:27712
    ds_read_b64 v[74:75], v12 offset:27744
    ds_read_b64 v[76:77], v12 offset:30016
    ds_read_b64 v[78:79], v12 offset:30048
    v_mfma_f32_16x16x32_bf16 v[16:19], v[56:59], v[48:51], v[16:19]
    v_mfma_f32_16x16x32_bf16 v[20:23], v[60:63], v[48:51], v[20:23]
    v_mfma_f32_16x16x32_bf16 v[24:27], v[64:67], v[48:51], v[24:27]
    v_mfma_f32_16x16x32_bf16 v[28:31], v[68:71], v[48:51], v[28:31]
    v_mfma_f32_16x16x32_bf16 v[32:35], v[56:59], v[52:55], v[32:35]
    v_mfma_f32_16x16x32_bf16 v[36:39], v[60:63], v[52:55], v[36:39]
    v_mfma_f32_16x16x32_bf16 v[40:43], v[64:67], v[52:55], v[40:43]
    v_mfma_f32_16x16x32_bf16 v[44:47], v[68:71], v[52:55], v[44:47]
    s_waitcnt lgkmcnt(0)
    v_mfma_f32_16x16x32_bf16 v[16:19], v[80:83], v[72:75], v[16:19]
    v_mfma_f32_16x16x32_bf16 v[20:23], v[84:87], v[72:75], v[20:23]
    v_mfma_f32_16x16x32_bf16 v[24:27], v[88:91], v[72:75], v[24:27]
    v_mfma_f32_16x16x32_bf16 v[28:31], v[92:95], v[72:75], v[28:31]
    v_mfma_f32_16x16x32_bf16 v[32:35], v[80:83], v[76:79], v[32:35]
    v_mfma_f32_16x16x32_bf16 v[36:39], v[84:87], v[76:79], v[36:39]
    v_mfma_f32_16x16x32_bf16 v[40:43], v[88:91], v[76:79], v[40:43]
    v_mfma_f32_16x16x32_bf16 v[44:47], v[92:95], v[76:79], v[44:47]
    s_waitcnt vmcnt(6)
    ds_write_b128 v8, v[96:99] offset:0
    ds_write_b128 v8, v[100:103] offset:4608
    ds_write_b128 v11, v[104:107] offset:0
    ds_write_b128 v11, v[108:111] offset:4608
    ds_write_b128 v11, v[112:115] offset:9216
    ds_write_b128 v11, v[116:119] offset:13824
    s_waitcnt lgkmcnt(0)
    s_barrier
    buffer_load_dwordx4 v[96:99], v7, s[40:43], s64 offen
    buffer_load_dwordx4 v[100:103], v7, s[40:43], s65 offen
    buffer_load_dwordx4 v[104:107], v10, s[60:63], s68 offen
    buffer_load_dwordx4 v[108:111], v10, s[60:63], s69 offen
    buffer_load_dwordx4 v[112:115], v10, s[60:63], s70 offen
    buffer_load_dwordx4 v[116:119], v10, s[60:63], s71 offen
    v_add_u32 v7, 128, v7
    v_add_u32 v10, 81920, v10
    ds_read_b64_tr_b16 v[56:57], v13 offset:0
    ds_read_b64_tr_b16 v[58:59], v13 offset:4608
    ds_read_b64_tr_b16 v[60:61], v13 offset:32
    ds_read_b64_tr_b16 v[62:63], v13 offset:4640
    ds_read_b64_tr_b16 v[64:65], v13 offset:64
    ds_read_b64_tr_b16 v[66:67], v13 offset:4672
    ds_read_b64_tr_b16 v[68:69], v13 offset:96
    ds_read_b64_tr_b16 v[70:71], v13 offset:4704
    ds_read_b64 v[48:49], v12 offset:0
    ds_read_b64 v[50:51], v12 offset:32
    ds_read_b64 v[52:53], v12 offset:2304
    ds_read_b64 v[54:55], v12 offset:2336
    s_waitcnt lgkmcnt(0)
    ds_read_b64_tr_b16 v[80:81], v13 offset:9216
    ds_read_b64_tr_b16 v[82:83], v13 offset:13824
    ds_read_b64_tr_b16 v[84:85], v13 offset:9248
    ds_read_b64_tr_b16 v[86:87], v13 offset:13856
    ds_read_b64_tr_b16 v[88:89], v13 offset:9280
    ds_read_b64_tr_b16 v[90:91], v13 offset:13888
    ds_read_b64_tr_b16 v[92:93], v13 offset:9312
    ds_read_b64_tr_b16 v[94:95], v13 offset:13920
    ds_read_b64 v[72:73], v12 offset:64
    ds_read_b64 v[74:75], v12 offset:96
    ds_read_b64 v[76:77], v12 offset:2368
    ds_read_b64 v[78:79], v12 offset:2400
    v_mfma_f32_16x16x32_bf16 v[16:19], v[56:59], v[48:51], v[16:19]
    v_mfma_f32_16x16x32_bf16 v[20:23], v[60:63], v[48:51], v[20:23]
    v_mfma_f32_16x16x32_bf16 v[24:27], v[64:67], v[48:51], v[24:27]
    v_mfma_f32_16x16x32_bf16 v[28:31], v[68:71], v[48:51], v[28:31]
    v_mfma_f32_16x16x32_bf16 v[32:35], v[56:59], v[52:55], v[32:35]
    v_mfma_f32_16x16x32_bf16 v[36:39], v[60:63], v[52:55], v[36:39]
    v_mfma_f32_16x16x32_bf16 v[40:43], v[64:67], v[52:55], v[40:43]
    v_mfma_f32_16x16x32_bf16 v[44:47], v[68:71], v[52:55], v[44:47]
    s_waitcnt lgkmcnt(0)
    v_mfma_f32_16x16x32_bf16 v[16:19], v[80:83], v[72:75], v[16:19]
    v_mfma_f32_16x16x32_bf16 v[20:23], v[84:87], v[72:75], v[20:23]
    v_mfma_f32_16x16x32_bf16 v[24:27], v[88:91], v[72:75], v[24:27]
    v_mfma_f32_16x16x32_bf16 v[28:31], v[92:95], v[72:75], v[28:31]
    v_mfma_f32_16x16x32_bf16 v[32:35], v[80:83], v[76:79], v[32:35]
    v_mfma_f32_16x16x32_bf16 v[36:39], v[84:87], v[76:79], v[36:39]
    v_mfma_f32_16x16x32_bf16 v[40:43], v[88:91], v[76:79], v[40:43]
    v_mfma_f32_16x16x32_bf16 v[44:47], v[92:95], v[76:79], v[44:47]
    s_waitcnt vmcnt(6)
    ds_write_b128 v8, v[120:123] offset:27648
    ds_write_b128 v8, v[124:127] offset:32256
    ds_write_b128 v11, v[128:131] offset:27648
    ds_write_b128 v11, v[132:135] offset:32256
    ds_write_b128 v11, v[136:139] offset:36864
    ds_write_b128 v11, v[140:143] offset:41472
    s_waitcnt lgkmcnt(0)
    s_barrier
    buffer_load_dwordx4 v[120:123], v7, s[40:43], s64 offen
    buffer_load_dwordx4 v[124:127], v7, s[40:43], s65 offen
    buffer_load_dwordx4 v[128:131], v10, s[60:63], s68 offen
    buffer_load_dwordx4 v[132:135], v10, s[60:63], s69 offen
    buffer_load_dwordx4 v[136:139], v10, s[60:63], s70 offen
    buffer_load_dwordx4 v[140:143], v10, s[60:63], s71 offen
    v_add_u32 v7, 128, v7
    v_add_u32 v10, 81920, v10
    ds_read_b64_tr_b16 v[56:57], v13 offset:27648
    ds_read_b64_tr_b16 v[58:59], v13 offset:32256
    ds_read_b64_tr_b16 v[60:61], v13 offset:27680
    ds_read_b64_tr_b16 v[62:63], v13 offset:32288
    ds_read_b64_tr_b16 v[64:65], v13 offset:27712
    ds_read_b64_tr_b16 v[66:67], v13 offset:32320
    ds_read_b64_tr_b16 v[68:69], v13 offset:27744
    ds_read_b64_tr_b16 v[70:71], v13 offset:32352
    ds_read_b64 v[48:49], v12 offset:27648
    ds_read_b64 v[50:51], v12 offset:27680
    ds_read_b64 v[52:53], v12 offset:29952
    ds_read_b64 v[54:55], v12 offset:29984
    s_waitcnt lgkmcnt(0)
    ds_read_b64_tr_b16 v[80:81], v13 offset:36864
    ds_read_b64_tr_b16 v[82:83], v13 offset:41472
    ds_read_b64_tr_b16 v[84:85], v13 offset:36896
    ds_read_b64_tr_b16 v[86:87], v13 offset:41504
    ds_read_b64_tr_b16 v[88:89], v13 offset:36928
    ds_read_b64_tr_b16 v[90:91], v13 offset:41536
    ds_read_b64_tr_b16 v[92:93], v13 offset:36960
    ds_read_b64_tr_b16 v[94:95], v13 offset:41568
    ds_read_b64 v[72:73], v12 offset:27712
    ds_read_b64 v[74:75], v12 offset:27744
    ds_read_b64 v[76:77], v12 offset:30016
    ds_read_b64 v[78:79], v12 offset:30048
    v_mfma_f32_16x16x32_bf16 v[16:19], v[56:59], v[48:51], v[16:19]
    v_mfma_f32_16x16x32_bf16 v[20:23], v[60:63], v[48:51], v[20:23]
    v_mfma_f32_16x16x32_bf16 v[24:27], v[64:67], v[48:51], v[24:27]
    v_mfma_f32_16x16x32_bf16 v[28:31], v[68:71], v[48:51], v[28:31]
    v_mfma_f32_16x16x32_bf16 v[32:35], v[56:59], v[52:55], v[32:35]
    v_mfma_f32_16x16x32_bf16 v[36:39], v[60:63], v[52:55], v[36:39]
    v_mfma_f32_16x16x32_bf16 v[40:43], v[64:67], v[52:55], v[40:43]
    v_mfma_f32_16x16x32_bf16 v[44:47], v[68:71], v[52:55], v[44:47]
    s_waitcnt lgkmcnt(0)
    v_mfma_f32_16x16x32_bf16 v[16:19], v[80:83], v[72:75], v[16:19]
    v_mfma_f32_16x16x32_bf16 v[20:23], v[84:87], v[72:75], v[20:23]
    v_mfma_f32_16x16x32_bf16 v[24:27], v[88:91], v[72:75], v[24:27]
    v_mfma_f32_16x16x32_bf16 v[28:31], v[92:95], v[72:75], v[28:31]
    v_mfma_f32_16x16x32_bf16 v[32:35], v[80:83], v[76:79], v[32:35]
    v_mfma_f32_16x16x32_bf16 v[36:39], v[84:87], v[76:79], v[36:39]
    v_mfma_f32_16x16x32_bf16 v[40:43], v[88:91], v[76:79], v[40:43]
    v_mfma_f32_16x16x32_bf16 v[44:47], v[92:95], v[76:79], v[44:47]
    s_waitcnt vmcnt(6)
    ds_write_b128 v8, v[96:99] offset:0
    ds_write_b128 v8, v[100:103] offset:4608
    ds_write_b128 v11, v[104:107] offset:0
    ds_write_b128 v11, v[108:111] offset:4608
    ds_write_b128 v11, v[112:115] offset:9216
    ds_write_b128 v11, v[116:119] offset:13824
    s_waitcnt lgkmcnt(0)
    s_barrier
    buffer_load_dwordx4 v[96:99], v7, s[40:43], s64 offen
    buffer_load_dwordx4 v[100:103], v7, s[40:43], s65 offen
    buffer_load_dwordx4 v[104:107], v10, s[60:63], s68 offen
    buffer_load_dwordx4 v[108:111], v10, s[60:63], s69 offen
    buffer_load_dwordx4 v[112:115], v10, s[60:63], s70 offen
    buffer_load_dwordx4 v[116:119], v10, s[60:63], s71 offen
    v_add_u32 v7, 128, v7
    v_add_u32 v10, 81920, v10
    ds_read_b64_tr_b16 v[56:57], v13 offset:0
    ds_read_b64_tr_b16 v[58:59], v13 offset:4608
    ds_read_b64_tr_b16 v[60:61], v13 offset:32
    ds_read_b64_tr_b16 v[62:63], v13 offset:4640
    ds_read_b64_tr_b16 v[64:65], v13 offset:64
    ds_read_b64_tr_b16 v[66:67], v13 offset:4672
    ds_read_b64_tr_b16 v[68:69], v13 offset:96
    ds_read_b64_tr_b16 v[70:71], v13 offset:4704
    ds_read_b64 v[48:49], v12 offset:0
    ds_read_b64 v[50:51], v12 offset:32
    ds_read_b64 v[52:53], v12 offset:2304
    ds_read_b64 v[54:55], v12 offset:2336
    s_waitcnt lgkmcnt(0)
    ds_read_b64_tr_b16 v[80:81], v13 offset:9216
    ds_read_b64_tr_b16 v[82:83], v13 offset:13824
    ds_read_b64_tr_b16 v[84:85], v13 offset:9248
    ds_read_b64_tr_b16 v[86:87], v13 offset:13856
    ds_read_b64_tr_b16 v[88:89], v13 offset:9280
    ds_read_b64_tr_b16 v[90:91], v13 offset:13888
    ds_read_b64_tr_b16 v[92:93], v13 offset:9312
    ds_read_b64_tr_b16 v[94:95], v13 offset:13920
    ds_read_b64 v[72:73], v12 offset:64
    ds_read_b64 v[74:75], v12 offset:96
    ds_read_b64 v[76:77], v12 offset:2368
    ds_read_b64 v[78:79], v12 offset:2400
    v_mfma_f32_16x16x32_bf16 v[16:19], v[56:59], v[48:51], v[16:19]
    v_mfma_f32_16x16x32_bf16 v[20:23], v[60:63], v[48:51], v[20:23]
    v_mfma_f32_16x16x32_bf16 v[24:27], v[64:67], v[48:51], v[24:27]
    v_mfma_f32_16x16x32_bf16 v[28:31], v[68:71], v[48:51], v[28:31]
    v_mfma_f32_16x16x32_bf16 v[32:35], v[56:59], v[52:55], v[32:35]
    v_mfma_f32_16x16x32_bf16 v[36:39], v[60:63], v[52:55], v[36:39]
    v_mfma_f32_16x16x32_bf16 v[40:43], v[64:67], v[52:55], v[40:43]
    v_mfma_f32_16x16x32_bf16 v[44:47], v[68:71], v[52:55], v[44:47]
    s_waitcnt lgkmcnt(0)
    v_mfma_f32_16x16x32_bf16 v[16:19], v[80:83], v[72:75], v[16:19]
    v_mfma_f32_16x16x32_bf16 v[20:23], v[84:87], v[72:75], v[20:23]
    v_mfma_f32_16x16x32_bf16 v[24:27], v[88:91], v[72:75], v[24:27]
    v_mfma_f32_16x16x32_bf16 v[28:31], v[92:95], v[72:75], v[28:31]
    v_mfma_f32_16x16x32_bf16 v[32:35], v[80:83], v[76:79], v[32:35]
    v_mfma_f32_16x16x32_bf16 v[36:39], v[84:87], v[76:79], v[36:39]
    v_mfma_f32_16x16x32_bf16 v[40:43], v[88:91], v[76:79], v[40:43]
    v_mfma_f32_16x16x32_bf16 v[44:47], v[92:95], v[76:79], v[44:47]
    s_waitcnt vmcnt(6)
    ds_write_b128 v8, v[120:123] offset:27648
    ds_write_b128 v8, v[124:127] offset:32256
    ds_write_b128 v11, v[128:131] offset:27648
    ds_write_b128 v11, v[132:135] offset:32256
    ds_write_b128 v11, v[136:139] offset:36864
    ds_write_b128 v11, v[140:143] offset:41472
    s_waitcnt lgkmcnt(0)
    s_barrier
    ds_read_b64_tr_b16 v[56:57], v13 offset:27648
    ds_read_b64_tr_b16 v[58:59], v13 offset:32256
    ds_read_b64_tr_b16 v[60:61], v13 offset:27680
    ds_read_b64_tr_b16 v[62:63], v13 offset:32288
    ds_read_b64_tr_b16 v[64:65], v13 offset:27712
    ds_read_b64_tr_b16 v[66:67], v13 offset:32320
    ds_read_b64_tr_b16 v[68:69], v13 offset:27744
    ds_read_b64_tr_b16 v[70:71], v13 offset:32352
    ds_read_b64 v[48:49], v12 offset:27648
    ds_read_b64 v[50:51], v12 offset:27680
    ds_read_b64 v[52:53], v12 offset:29952
    ds_read_b64 v[54:55], v12 offset:29984
    s_waitcnt lgkmcnt(0)
    ds_read_b64_tr_b16 v[80:81], v13 offset:36864
    ds_read_b64_tr_b16 v[82:83], v13 offset:41472
    ds_read_b64_tr_b16 v[84:85], v13 offset:36896
    ds_read_b64_tr_b16 v[86:87], v13 offset:41504
    ds_read_b64_tr_b16 v[88:89], v13 offset:36928
    ds_read_b64_tr_b16 v[90:91], v13 offset:41536
    ds_read_b64_tr_b16 v[92:93], v13 offset:36960
    ds_read_b64_tr_b16 v[94:95], v13 offset:41568
    ds_read_b64 v[72:73], v12 offset:27712
    ds_read_b64 v[74:75], v12 offset:27744
    ds_read_b64 v[76:77], v12 offset:30016
    ds_read_b64 v[78:79], v12 offset:30048
    v_mfma_f32_16x16x32_bf16 v[16:19], v[56:59], v[48:51], v[16:19]
    v_mfma_f32_16x16x32_bf16 v[20:23], v[60:63], v[48:51], v[20:23]
    v_mfma_f32_16x16x32_bf16 v[24:27], v[64:67], v[48:51], v[24:27]
    v_mfma_f32_16x16x32_bf16 v[28:31], v[68:71], v[48:51], v[28:31]
    v_mfma_f32_16x16x32_bf16 v[32:35], v[56:59], v[52:55], v[32:35]
    v_mfma_f32_16x16x32_bf16 v[36:39], v[60:63], v[52:55], v[36:39]
    v_mfma_f32_16x16x32_bf16 v[40:43], v[64:67], v[52:55], v[40:43]
    v_mfma_f32_16x16x32_bf16 v[44:47], v[68:71], v[52:55], v[44:47]
    s_waitcnt lgkmcnt(0)
    v_mfma_f32_16x16x32_bf16 v[16:19], v[80:83], v[72:75], v[16:19]
    v_mfma_f32_16x16x32_bf16 v[20:23], v[84:87], v[72:75], v[20:23]
    v_mfma_f32_16x16x32_bf16 v[24:27], v[88:91], v[72:75], v[24:27]
    v_mfma_f32_16x16x32_bf16 v[28:31], v[92:95], v[72:75], v[28:31]
    v_mfma_f32_16x16x32_bf16 v[32:35], v[80:83], v[76:79], v[32:35]
    v_mfma_f32_16x16x32_bf16 v[36:39], v[84:87], v[76:79], v[36:39]
    v_mfma_f32_16x16x32_bf16 v[40:43], v[88:91], v[76:79], v[40:43]
    v_mfma_f32_16x16x32_bf16 v[44:47], v[92:95], v[76:79], v[44:47]
    s_waitcnt vmcnt(0)
    ds_write_b128 v8, v[96:99] offset:0
    ds_write_b128 v8, v[100:103] offset:4608
    ds_write_b128 v11, v[104:107] offset:0
    ds_write_b128 v11, v[108:111] offset:4608
    ds_write_b128 v11, v[112:115] offset:9216
    ds_write_b128 v11, v[116:119] offset:13824
    s_waitcnt lgkmcnt(0)
    s_barrier
    ds_read_b64_tr_b16 v[56:57], v13 offset:0
    ds_read_b64_tr_b16 v[58:59], v13 offset:4608
    ds_read_b64_tr_b16 v[60:61], v13 offset:32
    ds_read_b64_tr_b16 v[62:63], v13 offset:4640
    ds_read_b64_tr_b16 v[64:65], v13 offset:64
    ds_read_b64_tr_b16 v[66:67], v13 offset:4672
    ds_read_b64_tr_b16 v[68:69], v13 offset:96
    ds_read_b64_tr_b16 v[70:71], v13 offset:4704
    ds_read_b64 v[48:49], v12 offset:0
    ds_read_b64 v[50:51], v12 offset:32
    ds_read_b64 v[52:53], v12 offset:2304
    ds_read_b64 v[54:55], v12 offset:2336
    s_waitcnt lgkmcnt(0)
    ds_read_b64_tr_b16 v[80:81], v13 offset:9216
    ds_read_b64_tr_b16 v[82:83], v13 offset:13824
    ds_read_b64_tr_b16 v[84:85], v13 offset:9248
    ds_read_b64_tr_b16 v[86:87], v13 offset:13856
    ds_read_b64_tr_b16 v[88:89], v13 offset:9280
    ds_read_b64_tr_b16 v[90:91], v13 offset:13888
    ds_read_b64_tr_b16 v[92:93], v13 offset:9312
    ds_read_b64_tr_b16 v[94:95], v13 offset:13920
    ds_read_b64 v[72:73], v12 offset:64
    ds_read_b64 v[74:75], v12 offset:96
    ds_read_b64 v[76:77], v12 offset:2368
    ds_read_b64 v[78:79], v12 offset:2400
    v_mfma_f32_16x16x32_bf16 v[16:19], v[56:59], v[48:51], v[16:19]
    v_mfma_f32_16x16x32_bf16 v[20:23], v[60:63], v[48:51], v[20:23]
    v_mfma_f32_16x16x32_bf16 v[24:27], v[64:67], v[48:51], v[24:27]
    v_mfma_f32_16x16x32_bf16 v[28:31], v[68:71], v[48:51], v[28:31]
    v_mfma_f32_16x16x32_bf16 v[32:35], v[56:59], v[52:55], v[32:35]
    v_mfma_f32_16x16x32_bf16 v[36:39], v[60:63], v[52:55], v[36:39]
    v_mfma_f32_16x16x32_bf16 v[40:43], v[64:67], v[52:55], v[40:43]
    v_mfma_f32_16x16x32_bf16 v[44:47], v[68:71], v[52:55], v[44:47]
    s_waitcnt lgkmcnt(0)
    v_mfma_f32_16x16x32_bf16 v[16:19], v[80:83], v[72:75], v[16:19]
    v_mfma_f32_16x16x32_bf16 v[20:23], v[84:87], v[72:75], v[20:23]
    v_mfma_f32_16x16x32_bf16 v[24:27], v[88:91], v[72:75], v[24:27]
    v_mfma_f32_16x16x32_bf16 v[28:31], v[92:95], v[72:75], v[28:31]
    v_mfma_f32_16x16x32_bf16 v[32:35], v[80:83], v[76:79], v[32:35]
    v_mfma_f32_16x16x32_bf16 v[36:39], v[84:87], v[76:79], v[36:39]
    v_mfma_f32_16x16x32_bf16 v[40:43], v[88:91], v[76:79], v[40:43]
    v_mfma_f32_16x16x32_bf16 v[44:47], v[92:95], v[76:79], v[44:47]
    s_nop 7
    s_nop 7
    s_mul_i32 s7, s4, 64
    s_mul_i32 s12, s10, 32
    s_add_u32 s7, s7, s12
    v_add_u32 v5, s7, v3
    v_mul_u32_u24 v5, 1280, v5
    s_lshl_b32 s12, s5, 8
    s_lshl_b32 s13, s11, 7
    s_add_u32 s12, s12, s13
    v_lshl_add_u32 v5, v4, 3, v5
    v_add_u32 v5, s12, v5
    buffer_load_dwordx2 v[96:97], v5, s[56:59], 0 offen offset:0
    buffer_load_dwordx2 v[98:99], v5, s[56:59], 0 offen offset:32
    buffer_load_dwordx2 v[100:101], v5, s[56:59], 0 offen offset:64
    buffer_load_dwordx2 v[102:103], v5, s[56:59], 0 offen offset:96
    s_waitcnt vmcnt(0)
    v_lshlrev_b32 v104, 16, v96
    v_and_b32 v105, 0xffff0000, v96
    v_add_f32 v16, v16, v104
    v_add_f32 v17, v17, v105
    v_lshlrev_b32 v104, 16, v97
    v_and_b32 v105, 0xffff0000, v97
    v_add_f32 v18, v18, v104
    v_add_f32 v19, v19, v105
    v_cvt_pk_bf16_f32 v106, v16, v17
    v_cvt_pk_bf16_f32 v107, v18, v19
    buffer_store_dwordx2 v[106:107], v5, s[52:55], 0 offen offset:0
    s_nop 1
    v_lshlrev_b32 v104, 16, v98
    v_and_b32 v105, 0xffff0000, v98
    v_add_f32 v20, v20, v104
    v_add_f32 v21, v21, v105
    v_lshlrev_b32 v104, 16, v99
    v_and_b32 v105, 0xffff0000, v99
    v_add_f32 v22, v22, v104
    v_add_f32 v23, v23, v105
    v_cvt_pk_bf16_f32 v106, v20, v21
    v_cvt_pk_bf16_f32 v107, v22, v23
    buffer_store_dwordx2 v[106:107], v5, s[52:55], 0 offen offset:32
    s_nop 1
    v_lshlrev_b32 v104, 16, v100
    v_and_b32 v105, 0xffff0000, v100
    v_add_f32 v24, v24, v104
    v_add_f32 v25, v25, v105
    v_lshlrev_b32 v104, 16, v101
    v_and_b32 v105, 0xffff0000, v101
    v_add_f32 v26, v26, v104
    v_add_f32 v27, v27, v105
    v_cvt_pk_bf16_f32 v106, v24, v25
    v_cvt_pk_bf16_f32 v107, v26, v27
    buffer_store_dwordx2 v[106:107], v5, s[52:55], 0 offen offset:64
    s_nop 1
    v_lshlrev_b32 v104, 16, v102
    v_and_b32 v105, 0xffff0000, v102
    v_add_f32 v28, v28, v104
    v_add_f32 v29, v29, v105
    v_lshlrev_b32 v104, 16, v103
    v_and_b32 v105, 0xffff0000, v103
    v_add_f32 v30, v30, v104
    v_add_f32 v31, v31, v105
    v_cvt_pk_bf16_f32 v106, v28, v29
    v_cvt_pk_bf16_f32 v107, v30, v31
    buffer_store_dwordx2 v[106:107], v5, s[52:55], 0 offen offset:96
    s_nop 1
    v_add_u32 v5, 20480, v5
    buffer_load_dwordx2 v[96:97], v5, s[56:59], 0 offen offset:0
    buffer_load_dwordx2 v[98:99], v5, s[56:59], 0 offen offset:32
    buffer_load_dwordx2 v[100:101], v5, s[56:59], 0 offen offset:64
    buffer_load_dwordx2 v[102:103], v5, s[56:59], 0 offen offset:96
    s_waitcnt vmcnt(0)
    v_lshlrev_b32 v104, 16, v96
    v_and_b32 v105, 0xffff0000, v96
    v_add_f32 v32, v32, v104
    v_add_f32 v33, v33, v105
    v_lshlrev_b32 v104, 16, v97
    v_and_b32 v105, 0xffff0000, v97
    v_add_f32 v34, v34, v104
    v_add_f32 v35, v35, v105
    v_cvt_pk_bf16_f32 v106, v32, v33
    v_cvt_pk_bf16_f32 v107, v34, v35
    buffer_store_dwordx2 v[106:107], v5, s[52:55], 0 offen offset:0
    s_nop 1
    v_lshlrev_b32 v104, 16, v98
    v_and_b32 v105, 0xffff0000, v98
    v_add_f32 v36, v36, v104
    v_add_f32 v37, v37, v105
    v_lshlrev_b32 v104, 16, v99
    v_and_b32 v105, 0xffff0000, v99
    v_add_f32 v38, v38, v104
    v_add_f32 v39, v39, v105
    v_cvt_pk_bf16_f32 v106, v36, v37
    v_cvt_pk_bf16_f32 v107, v38, v39
    buffer_store_dwordx2 v[106:107], v5, s[52:55], 0 offen offset:32
    s_nop 1
    v_lshlrev_b32 v104, 16, v100
    v_and_b32 v105, 0xffff0000, v100
    v_add_f32 v40, v40, v104
    v_add_f32 v41, v41, v105
    v_lshlrev_b32 v104, 16, v101
    v_and_b32 v105, 0xffff0000, v101
    v_add_f32 v42, v42, v104
    v_add_f32 v43, v43, v105
    v_cvt_pk_bf16_f32 v106, v40, v41
    v_cvt_pk_bf16_f32 v107, v42, v43
    buffer_store_dwordx2 v[106:107], v5, s[52:55], 0 offen offset:64
    s_nop 1
    v_lshlrev_b32 v104, 16, v102
    v_and_b32 v105, 0xffff0000, v102
    v_add_f32 v44, v44, v104
    v_add_f32 v45, v45, v105
    v_lshlrev_b32 v104, 16, v103
    v_and_b32 v105, 0xffff0000, v103
    v_add_f32 v46, v46, v104
    v_add_f32 v47, v47, v105
    v_cvt_pk_bf16_f32 v106, v44, v45
    v_cvt_pk_bf16_f32 v107, v46, v47
    buffer_store_dwordx2 v[106:107], v5, s[52:55], 0 offen offset:96
    s_nop 1
down_1_kernel_end:
    s_endpgm
.section .rodata,"a"
.p2align 6
.amdhsa_kernel ln1_0_kernel
  .amdhsa_next_free_vgpr 40
  .amdhsa_next_free_sgpr 48
  .amdhsa_accum_offset 40
  .amdhsa_group_segment_fixed_size 0
  .amdhsa_kernarg_size 88
  .amdhsa_user_sgpr_count 2
  .amdhsa_user_sgpr_kernarg_segment_ptr 1
  .amdhsa_system_sgpr_workgroup_id_x 1
.end_amdhsa_kernel
.p2align 6
.amdhsa_kernel qkv_0_kernel
  .amdhsa_next_free_vgpr 208
  .amdhsa_next_free_sgpr 80
  .amdhsa_accum_offset 208
  .amdhsa_group_segment_fixed_size 0
  .amdhsa_kernarg_size 88
  .amdhsa_user_sgpr_count 2
  .amdhsa_user_sgpr_kernarg_segment_ptr 1
  .amdhsa_system_sgpr_workgroup_id_x 1
.end_amdhsa_kernel
.p2align 6
.amdhsa_kernel kv_0_kernel
  .amdhsa_next_free_vgpr 176
  .amdhsa_next_free_sgpr 64
  .amdhsa_accum_offset 176
  .amdhsa_group_segment_fixed_size 0
  .amdhsa_kernarg_size 88
  .amdhsa_user_sgpr_count 2
  .amdhsa_user_sgpr_kernarg_segment_ptr 1
  .amdhsa_system_sgpr_workgroup_id_x 1
.end_amdhsa_kernel
.p2align 6
.amdhsa_kernel att_0_kernel
  .amdhsa_next_free_vgpr 216
  .amdhsa_next_free_sgpr 64
  .amdhsa_accum_offset 216
  .amdhsa_group_segment_fixed_size 0
  .amdhsa_kernarg_size 88
  .amdhsa_user_sgpr_count 2
  .amdhsa_user_sgpr_kernarg_segment_ptr 1
  .amdhsa_system_sgpr_workgroup_id_x 1
.end_amdhsa_kernel
.p2align 6
.amdhsa_kernel wo_0_kernel
  .amdhsa_next_free_vgpr 144
  .amdhsa_next_free_sgpr 80
  .amdhsa_accum_offset 144
  .amdhsa_group_segment_fixed_size 0
  .amdhsa_kernarg_size 88
  .amdhsa_user_sgpr_count 2
  .amdhsa_user_sgpr_kernarg_segment_ptr 1
  .amdhsa_system_sgpr_workgroup_id_x 1
.end_amdhsa_kernel
.p2align 6
.amdhsa_kernel ln2_0_kernel
  .amdhsa_next_free_vgpr 40
  .amdhsa_next_free_sgpr 48
  .amdhsa_accum_offset 40
  .amdhsa_group_segment_fixed_size 0
  .amdhsa_kernarg_size 88
  .amdhsa_user_sgpr_count 2
  .amdhsa_user_sgpr_kernarg_segment_ptr 1
  .amdhsa_system_sgpr_workgroup_id_x 1
.end_amdhsa_kernel
.p2align 6
.amdhsa_kernel gu_0_kernel
  .amdhsa_next_free_vgpr 208
  .amdhsa_next_free_sgpr 80
  .amdhsa_accum_offset 208
  .amdhsa_group_segment_fixed_size 0
  .amdhsa_kernarg_size 88
  .amdhsa_user_sgpr_count 2
  .amdhsa_user_sgpr_kernarg_segment_ptr 1
  .amdhsa_system_sgpr_workgroup_id_x 1
.end_amdhsa_kernel
.p2align 6
.amdhsa_kernel down_0_kernel
  .amdhsa_next_free_vgpr 144
  .amdhsa_next_free_sgpr 80
  .amdhsa_accum_offset 144
  .amdhsa_group_segment_fixed_size 0
  .amdhsa_kernarg_size 88
  .amdhsa_user_sgpr_count 2
  .amdhsa_user_sgpr_kernarg_segment_ptr 1
  .amdhsa_system_sgpr_workgroup_id_x 1
.end_amdhsa_kernel
.p2align 6
.amdhsa_kernel ln1_1_kernel
  .amdhsa_next_free_vgpr 40
  .amdhsa_next_free_sgpr 48
  .amdhsa_accum_offset 40
  .amdhsa_group_segment_fixed_size 0
  .amdhsa_kernarg_size 88
  .amdhsa_user_sgpr_count 2
  .amdhsa_user_sgpr_kernarg_segment_ptr 1
  .amdhsa_system_sgpr_workgroup_id_x 1
.end_amdhsa_kernel
.p2align 6
.amdhsa_kernel qkv_1_kernel
  .amdhsa_next_free_vgpr 208
  .amdhsa_next_free_sgpr 80
  .amdhsa_accum_offset 208
  .amdhsa_group_segment_fixed_size 0
  .amdhsa_kernarg_size 88
  .amdhsa_user_sgpr_count 2
  .amdhsa_user_sgpr_kernarg_segment_ptr 1
  .amdhsa_system_sgpr_workgroup_id_x 1
.end_amdhsa_kernel
.p2align 6
.amdhsa_kernel kv_1_kernel
  .amdhsa_next_free_vgpr 176
  .amdhsa_next_free_sgpr 64
  .amdhsa_accum_offset 176
  .amdhsa_group_segment_fixed_size 0
  .amdhsa_kernarg_size 88
  .amdhsa_user_sgpr_count 2
  .amdhsa_user_sgpr_kernarg_segment_ptr 1
  .amdhsa_system_sgpr_workgroup_id_x 1
.end_amdhsa_kernel
.p2align 6
.amdhsa_kernel att_1_kernel
  .amdhsa_next_free_vgpr 216
  .amdhsa_next_free_sgpr 64
  .amdhsa_accum_offset 216
  .amdhsa_group_segment_fixed_size 0
  .amdhsa_kernarg_size 88
  .amdhsa_user_sgpr_count 2
  .amdhsa_user_sgpr_kernarg_segment_ptr 1
  .amdhsa_system_sgpr_workgroup_id_x 1
.end_amdhsa_kernel
.p2align 6
.amdhsa_kernel wo_1_kernel
  .amdhsa_next_free_vgpr 144
  .amdhsa_next_free_sgpr 80
  .amdhsa_accum_offset 144
  .amdhsa_group_segment_fixed_size 0
  .amdhsa_kernarg_size 88
  .amdhsa_user_sgpr_count 2
  .amdhsa_user_sgpr_kernarg_segment_ptr 1
  .amdhsa_system_sgpr_workgroup_id_x 1
.end_amdhsa_kernel
.p2align 6
.amdhsa_kernel ln2_1_kernel
  .amdhsa_next_free_vgpr 40
  .amdhsa_next_free_sgpr 48
  .amdhsa_accum_offset 40
  .amdhsa_group_segment_fixed_size 0
  .amdhsa_kernarg_size 88
  .amdhsa_user_sgpr_count 2
  .amdhsa_user_sgpr_kernarg_segment_ptr 1
  .amdhsa_system_sgpr_workgroup_id_x 1
.end_amdhsa_kernel
.p2align 6
.amdhsa_kernel gu_1_kernel
  .amdhsa_next_free_vgpr 208
  .amdhsa_next_free_sgpr 80
  .amdhsa_accum_offset 208
  .amdhsa_group_segment_fixed_size 0
  .amdhsa_kernarg_size 88
  .amdhsa_user_sgpr_count 2
  .amdhsa_user_sgpr_kernarg_segment_ptr 1
  .amdhsa_system_sgpr_workgroup_id_x 1
.end_amdhsa_kernel
.p2align 6
.amdhsa_kernel down_1_kernel
  .amdhsa_next_free_vgpr 144
  .amdhsa_next_free_sgpr 80
  .amdhsa_accum_offset 144
  .amdhsa_group_segment_fixed_size 0
  .amdhsa_kernarg_size 88
  .amdhsa_user_sgpr_count 2
  .amdhsa_user_sgpr_kernarg_segment_ptr 1
  .amdhsa_system_sgpr_workgroup_id_x 1
.end_amdhsa_kernel
```
